```python
import torch

def _softmax(x, axis=-1):
    return torch.softmax(x, dim=axis)
def _gelu(x):
    return torch.nn.functional.gelu(x, approximate="tanh")
def _silu(x):
    return torch.nn.functional.silu(x)
def _sigmoid(x):
    return torch.sigmoid(x)
def _layernorm(x, axis=-1, eps=1e-5):
    m = x.mean(dim=axis, keepdim=True)
    v = x.var(dim=axis, keepdim=True, unbiased=False)
    return (x - m) / torch.sqrt(v + eps)
def _scatter_add(tgt, idx, src, axis=0):
    return tgt.clone().index_add_(axis, idx, src)
def _segment_sum(src, seg, n):
    out = torch.zeros((n,) + src.shape[1:], dtype=src.dtype)
    return out.index_add_(0, seg, src)
def _pad(x, pw):
    flat = tuple(v for pair in reversed(pw) for v in pair)
    return torch.nn.functional.pad(x, flat)

kernel_name = 'gated_mix__linear_kernel_hedgehog__moe_arch_mod__prompt'

def setup_inputs():

    _w = (lambda a: (lambda t: t.to(torch.bfloat16) if t.is_floating_point() else t)(torch.as_tensor(a)))
    def _A_setup():
        B, S, D, H = 1, 2048, 1024, 32
        Dh = D // H
        return {
            "x": _w((lambda *s: torch.randn(*s, dtype=torch.bfloat16) * 0.05)(B, S, D)),
            "wqkv": _w((lambda *s: torch.randn(*s, dtype=torch.bfloat16) * 1.6)(D, 3 * D)),
            "w_phi": _w((lambda *s: torch.randn(*s, dtype=torch.bfloat16) * 1.6)(H, Dh, Dh) * (Dh ** -0.5)),
            "wo": _w((lambda *s: torch.randn(*s, dtype=torch.bfloat16) * 1.6)(D, D)),
        }
    _A_in = _A_setup()

    def _B_setup():
        B, S, D, F, C = 1, 2048, 1024, 3584, 1
        return {
            "x": _w((lambda *s: torch.randn(*s, dtype=torch.bfloat16) * 0.05)(B, S, D)),
            "w_r": _w((lambda *s: torch.randn(*s, dtype=torch.bfloat16) * 1.6)(D)),
            "w_gate": _w((lambda *s: torch.randn(*s, dtype=torch.bfloat16) * 0.8)(D, F)),
            "w_up": _w((lambda *s: torch.randn(*s, dtype=torch.bfloat16) * 0.8)(D, F)),
            "w_down": _w((lambda *s: torch.randn(*s, dtype=torch.bfloat16) * 0.8)(F, D)),
        }
    _B_in = _B_setup()

    return {
        "A_x": _A_in["x"],
        "A_wqkv": _A_in["wqkv"],
        "A_w_phi": _A_in["w_phi"],
        "A_wo": _A_in["wo"],
        "B_x": _B_in["x"],
        "B_w_r": _B_in["w_r"],
        "B_w_gate": _B_in["w_gate"],
        "B_w_up": _B_in["w_up"],
        "B_w_down": _B_in["w_down"],
        "gate_w": _w((lambda *s: torch.randn(*s, dtype=torch.bfloat16) * 0.05)(1024) * 16.0),
    }

def reference(A_x, A_wqkv, A_w_phi, A_wo, B_x, B_w_r, B_w_gate, B_w_up, B_w_down, gate_w):
    def _A_ref(x, wqkv, w_phi, wo):
        B, S, D = x.shape
        H = 32; Dh = D // H
        qkv = (lambda x, *d: x.permute(*d))((x @ wqkv).reshape(B, S, 3, H, Dh), 2, 0, 3, 1, 4)
        q, k, v = qkv[0], qkv[1], qkv[2]
        pq = torch.einsum("bhsd,hdf->bhsf", q, w_phi)
        pk = torch.einsum("bhsd,hdf->bhsf", k, w_phi)
        phi_q = torch.concatenate([_softmax(pq, axis=-1), _softmax(-pq, axis=-1)], axis=-1)
        phi_k = torch.concatenate([_softmax(pk, axis=-1), _softmax(-pk, axis=-1)], axis=-1)
        kv = torch.einsum("bhsf,bhsd->bhfd", phi_k, v)
        z  = torch.einsum("bhsf->bhf", phi_k)
        num = torch.einsum("bhqf,bhfd->bhqd", phi_q, kv)
        den = torch.einsum("bhqf,bhf->bhq", phi_q, z)[..., None] + 1e-6
        o = num / den
        return (lambda x, *d: x.permute(*d))(o, 0, 2, 1, 3).reshape(B, S, D) @ wo

    def _B_ref(x, w_r, w_gate, w_up, w_down):
        B, S, D = x.shape
        C = 1
        r = x @ w_r
        idx = torch.argsort(-r, axis=-1)[:, :C]
        idx_e = (lambda x, n, axis: torch.repeat_interleave(x, n, dim=axis))(idx.reshape(B, C, 1), D, axis=2)
        x_sel = (lambda x, i, axis: torch.take_along_dim(x, i, dim=axis))(x, idx_e, axis=1)
        g = _silu(x_sel @ w_gate)
        u = x_sel @ w_up
        y = (g * u) @ w_down
        r_sel = _sigmoid((lambda x, i, axis: torch.take_along_dim(x, i, dim=axis))(r, idx, axis=1))
        y = y * r_sel.reshape(B, C, 1)
        b_off = (torch.arange(B) * S).reshape(B, 1)
        flat_idx = (idx + b_off).reshape(B * C)
        zero = (x * 0.0).reshape(B * S, D)
        upd = _scatter_add(zero, flat_idx, y.reshape(B * C, D), axis=0)
        return x + upd.reshape(B, S, D)

    x = A_x
    g = _sigmoid((x * gate_w).sum(-1, keepdims=True))
    a = _A_ref(x, A_wqkv, A_w_phi, A_wo)
    b = _B_ref(x, B_w_r, B_w_gate, B_w_up, B_w_down)
    return g * a + (1 - g) * b
```

```asm
; @launch kernel=fk_kernel grid=(256,1,1) block=(512,1,1) lds=163840
.amdgcn_target "amdgcn-amd-amdhsa--gfx950"
.text
.globl fk_kernel
.p2align 8
.type fk_kernel,@function
fk_kernel:
    s_load_dwordx4 s[4:7], s[0:1], 0
    s_load_dwordx4 s[8:11], s[0:1], 16
    s_load_dwordx16 s[84:99], s[0:1], 40
    s_cmp_ge_u32 s2, 256
    s_cbranch_scc1 L_end
    v_lshrrev_b32 v1, 6, v0
    v_and_b32 v2, 63, v0
    v_readfirstlane_b32 s16, v1
    v_lshrrev_b32 v4, 3, v2
    v_lshlrev_b32 v5, 11, v4
    v_and_b32 v6, 7, v2
    v_lshrrev_b32 v7, 4, v2
    v_xor_b32 v8, v6, v7
    v_lshl_add_u32 v10, v8, 4, v5
    v_xor_b32 v8, 4, v8
    v_lshl_add_u32 v11, v8, 4, v5
    v_mul_u32_u24 v5, 6144, v4
    v_and_b32 v7, 1, v7
    v_lshlrev_b32 v7, 2, v7
    v_xor_b32 v8, v6, v7
    s_and_b32 s12, s2, 7
    s_lshr_b32 s13, s2, 3
    s_and_b32 s14, s12, 1
    s_lshl_b32 s14, s14, 3
    s_and_b32 s15, s13, 7
    s_add_u32 s14, s14, s15
    s_lshr_b32 s15, s12, 1
    s_lshl_b32 s15, s15, 2
    s_lshr_b32 s19, s13, 3
    s_xor_b32 s19, s19, 0
    s_add_u32 s15, s15, s19
    s_xor_b32 s15, s15, 0
    s_and_b32 s17, s16, 3
    s_and_b32 s19, s16, 1
    s_lshl_b32 s19, s19, 1
    v_xor_b32 v8, s19, v8
    v_lshl_add_u32 v12, v8, 4, v5
    s_lshl_b32 s19, s14, 18
    v_add_u32 v10, s19, v10
    v_add_u32 v11, s19, v11
    s_lshl_b32 s19, s15, 7
    v_add_u32 v12, s19, v12
    s_add_u32 s64, s14, s15
    s_and_b32 s64, s64, 3
    s_add_u32 s65, s12, 0
    s_and_b32 s65, s65, 3
    s_lshl_b32 s65, s65, 2
    s_and_b32 s72, s64, 3
    s_add_u32 s72, s72, s65
    s_mul_i32 s73, s72, 393216
    s_lshl_b32 s72, s72, 7
    s_lshl_b32 s74, s16, 15
    s_add_u32 s72, s72, s74
    s_mul_i32 s74, s16, 49152
    s_add_u32 s73, s73, s74
    s_lshl_b32 s75, s16, 10
    s_lshl_b32 m0, s16, 11
    s_add_u32 s74, s72, 16384
    s_waitcnt lgkmcnt(0)
    s_mov_b64 s[24:25], s[4:5]
    s_mov_b32 s26, 4194304
    s_mov_b32 s27, 0x00020000
    buffer_load_dwordx4 v10, s[24:27], s72 offen lds
    s_addk_i32 m0, 1024
    s_mov_b64 s[28:29], s[6:7]
    s_mov_b32 s30, 6291456
    s_mov_b32 s31, 0x00020000
    buffer_load_dwordx4 v11, s[24:27], s74 offen lds
    s_add_u32 m0, s75, 16384
    s_nop 0
    buffer_load_dwordx4 v12, s[28:31], s73 offen lds
    s_add_u32 m0, s75, 24576
    s_addk_i32 s73, 2048
    buffer_load_dwordx4 v12, s[28:31], s73 offen lds
    s_add_u32 m0, s75, 32768
    s_addk_i32 s73, 2048
    buffer_load_dwordx4 v12, s[28:31], s73 offen lds
    s_cmp_lt_u32 s16, 4
    s_cbranch_scc1 L_compute
    s_bfe_u32 s19, s14, 0x10002
    s_lshl_b32 s19, s19, 2
    s_add_u32 s19, s19, s17
    s_xor_b32 s3, s19, 4
    s_mul_i32 s66, s19, 49152
    s_mul_i32 s67, s3, 49152
    s_lshl_b32 s68, s19, 10
    s_add_u32 s68, s68, 16384
    s_lshl_b32 s69, s3, 10
    s_add_u32 s69, s69, 16384
    s_lshl_b32 s70, s17, 16
    s_lshl_b32 s71, s17, 12
    s_add_u32 s72, s64, 1
    s_and_b32 s72, s72, 3
    s_add_u32 s73, s65, 0
    s_and_b32 s73, s73, 15
    s_add_u32 s72, s72, s73
    s_mul_i32 s73, s72, 393216
    s_lshl_b32 s72, s72, 7
    s_add_u32 s74, s72, s70
    s_add_u32 s75, s73, s66
    s_add_u32 s76, s73, s67
    s_add_u32 m0, s71, 40960
    s_add_u32 s77, s74, 0
    buffer_load_dwordx4 v10, s[24:27], s77 offen lds
    s_add_u32 m0, s71, 41984
    s_add_u32 s77, s74, 16384
    buffer_load_dwordx4 v11, s[24:27], s77 offen lds
    s_add_u32 m0, s71, 43008
    s_add_u32 s77, s74, 32768
    buffer_load_dwordx4 v10, s[24:27], s77 offen lds
    s_add_u32 m0, s71, 44032
    s_add_u32 s77, s74, 49152
    buffer_load_dwordx4 v11, s[24:27], s77 offen lds
    s_add_u32 m0, s68, 40960
    s_add_u32 s77, s75, 0
    buffer_load_dwordx4 v12, s[28:31], s77 offen lds
    s_add_u32 m0, s68, 49152
    s_add_u32 s77, s75, 2048
    buffer_load_dwordx4 v12, s[28:31], s77 offen lds
    s_add_u32 m0, s68, 57344
    s_add_u32 s77, s75, 4096
    buffer_load_dwordx4 v12, s[28:31], s77 offen lds
    s_add_u32 m0, s69, 40960
    s_add_u32 s77, s76, 0
    buffer_load_dwordx4 v12, s[28:31], s77 offen lds
    s_mov_b64 s[32:33], s[98:99]
    s_mov_b32 s34, 16777216
    s_mov_b32 s35, 0x00020000
    s_mov_b64 s[36:37], s[96:97]
    s_mov_b32 s38, 256
    s_mov_b32 s39, 0x00020000
    s_mov_b64 s[40:41], s[84:85]
    s_mov_b32 s42, 2048
    s_mov_b32 s43, 0x00020000
    s_mov_b64 s[44:45], s[92:93]
    s_mov_b32 s46, 2048
    s_mov_b32 s47, 0x00020000
    s_mov_b64 s[48:49], s[86:87]
    s_mov_b32 s50, 7340032
    s_mov_b32 s51, 0x00020000
    s_mov_b64 s[52:53], s[88:89]
    s_mov_b32 s54, 7340032
    s_mov_b32 s55, 0x00020000
    s_mov_b64 s[56:57], s[90:91]
    s_mov_b32 s58, 7340032
    s_mov_b32 s59, 0x00020000
    s_mov_b64 s[60:61], s[10:11]
    s_mov_b32 s62, 2097152
    s_mov_b32 s63, 0x00020000
    s_mov_b32 s79, 0
    v_mov_b32 v13, 0
    v_lshlrev_b32 v3, 4, v2
    v_lshrrev_b32 v9, 4, v2
    v_and_b32 v8, 15, v2
    v_mul_u32_u24 v15, 7168, v9
    v_lshl_add_u32 v15, v8, 4, v15
    v_lshlrev_b32 v16, 11, v9
    v_lshl_add_u32 v16, v8, 4, v16
    v_lshrrev_b32 v19, 3, v2
    v_and_b32 v20, 7, v2
    v_lshlrev_b32 v17, 11, v19
    v_lshl_add_u32 v17, v20, 4, v17
    v_lshlrev_b32 v21, 1, v9
    v_xor_b32 v21, v20, v21
    v_lshlrev_b32 v18, 7, v19
    v_lshl_add_u32 v18, v21, 4, v18
    s_lshl_b32 s19, s17, 10
    s_add_u32 s19, s19, 32768
    v_add_u32 v18, s19, v18
    v_add_u32 v22, 65536, v18
    v_mov_b32 v23, 0xffff
    v_mov_b32 v24, 0xffff0000
    v_cmp_eq_u32 vcc, 0, v8
    s_nop 1
    v_cndmask_b32 v25, 0, v23, vcc
    v_cmp_eq_u32 vcc, 1, v8
    s_nop 1
    v_cndmask_b32 v4, v25, v24, vcc
    v_cmp_eq_u32 vcc, 2, v8
    s_nop 1
    v_cndmask_b32 v25, 0, v23, vcc
    v_cmp_eq_u32 vcc, 3, v8
    s_nop 1
    v_cndmask_b32 v5, v25, v24, vcc
    v_cmp_eq_u32 vcc, 4, v8
    s_nop 1
    v_cndmask_b32 v25, 0, v23, vcc
    v_cmp_eq_u32 vcc, 5, v8
    s_nop 1
    v_cndmask_b32 v6, v25, v24, vcc
    v_cmp_eq_u32 vcc, 6, v8
    s_nop 1
    v_cndmask_b32 v25, 0, v23, vcc
    v_cmp_eq_u32 vcc, 7, v8
    s_nop 1
    v_cndmask_b32 v7, v25, v24, vcc
    v_mov_b32 v23, 0x3ff
    v_and_b32 v36, 3, v2
    v_lshlrev_b32 v36, 2, v36
    v_mov_b32 v37, 0x7fc17fc1
    s_cmp_lt_u32 s2, 224
    s_cselect_b32 s50, s50, 0
    s_cselect_b32 s54, s54, 0
    s_lshl_b32 s0, s12, 7
    s_lshl_b32 s19, s17, 5
    s_add_u32 s0, s0, s19
    s_mul_i32 s1, s0, 7168
    s_lshl_b32 s19, s13, 8
    s_add_u32 s1, s1, s19
    s_waitcnt vmcnt(8)
    s_barrier
    s_add_u32 m0, s69, 49152
    s_add_u32 s77, s76, 2048
    buffer_load_dwordx4 v12, s[28:31], s77 offen lds
    s_add_u32 m0, s69, 57344
    s_add_u32 s77, s76, 4096
    buffer_load_dwordx4 v12, s[28:31], s77 offen lds
    s_add_u32 s72, s64, 2
    s_and_b32 s72, s72, 3
    s_add_u32 s73, s65, 0
    s_and_b32 s73, s73, 15
    s_add_u32 s72, s72, s73
    s_mul_i32 s73, s72, 393216
    s_lshl_b32 s72, s72, 7
    s_add_u32 s74, s72, s70
    s_add_u32 s75, s73, s66
    s_add_u32 s76, s73, s67
    s_add_u32 m0, s71, 81920
    s_add_u32 s77, s74, 0
    buffer_load_dwordx4 v10, s[24:27], s77 offen lds
    s_add_u32 m0, s71, 82944
    s_add_u32 s77, s74, 16384
    buffer_load_dwordx4 v11, s[24:27], s77 offen lds
    s_add_u32 m0, s71, 83968
    s_add_u32 s77, s74, 32768
    buffer_load_dwordx4 v10, s[24:27], s77 offen lds
    s_add_u32 m0, s71, 84992
    s_add_u32 s77, s74, 49152
    buffer_load_dwordx4 v11, s[24:27], s77 offen lds
    s_add_u32 m0, s68, 81920
    s_add_u32 s77, s75, 0
    buffer_load_dwordx4 v12, s[28:31], s77 offen lds
    s_add_u32 m0, s68, 90112
    s_add_u32 s77, s75, 2048
    buffer_load_dwordx4 v12, s[28:31], s77 offen lds
    s_add_u32 m0, s68, 98304
    s_add_u32 s77, s75, 4096
    buffer_load_dwordx4 v12, s[28:31], s77 offen lds
    s_add_u32 m0, s69, 81920
    s_add_u32 s77, s76, 0
    buffer_load_dwordx4 v12, s[28:31], s77 offen lds
    s_add_u32 m0, s69, 90112
    s_add_u32 s77, s76, 2048
    buffer_load_dwordx4 v12, s[28:31], s77 offen lds
    s_lshl_b32 s18, s14, 7
    s_lshl_b32 s19, s15, 3
    s_add_u32 s18, s18, s19
    s_lshl_b32 s19, s17, 1
    s_add_u32 s18, s18, s19
    s_lshl_b32 s19, s18, 11
    buffer_load_dwordx4 v[40:43], v3, s[24:27], s19 offen offset:0
    buffer_load_dwordx4 v[44:47], v3, s[24:27], s19 offen offset:1024
    buffer_load_dwordx4 v[48:51], v3, s[24:27], s19 offen offset:2048
    buffer_load_dwordx4 v[52:55], v3, s[24:27], s19 offen offset:3072
    buffer_load_dwordx4 v[56:59], v3, s[40:43], 0 offen offset:0
    buffer_load_dwordx4 v[60:63], v3, s[40:43], 0 offen offset:1024
    buffer_load_dwordx4 v[64:67], v3, s[44:47], 0 offen offset:0
    buffer_load_dwordx4 v[68:71], v3, s[44:47], 0 offen offset:1024
    s_waitcnt vmcnt(17)
    s_barrier
    s_add_u32 m0, s69, 98304
    s_add_u32 s77, s76, 4096
    buffer_load_dwordx4 v12, s[28:31], s77 offen lds
    s_add_u32 s72, s64, 3
    s_and_b32 s72, s72, 3
    s_add_u32 s73, s65, 0
    s_and_b32 s73, s73, 15
    s_add_u32 s72, s72, s73
    s_mul_i32 s73, s72, 393216
    s_lshl_b32 s72, s72, 7
    s_add_u32 s74, s72, s70
    s_add_u32 s75, s73, s66
    s_add_u32 s76, s73, s67
    s_add_u32 m0, s71, 122880
    s_add_u32 s77, s74, 0
    buffer_load_dwordx4 v10, s[24:27], s77 offen lds
    s_add_u32 m0, s71, 123904
    s_add_u32 s77, s74, 16384
    buffer_load_dwordx4 v11, s[24:27], s77 offen lds
    s_add_u32 m0, s71, 124928
    s_add_u32 s77, s74, 32768
    buffer_load_dwordx4 v10, s[24:27], s77 offen lds
    s_add_u32 m0, s71, 125952
    s_add_u32 s77, s74, 49152
    buffer_load_dwordx4 v11, s[24:27], s77 offen lds
    s_add_u32 m0, s68, 122880
    s_add_u32 s77, s75, 0
    buffer_load_dwordx4 v12, s[28:31], s77 offen lds
    s_add_u32 m0, s68, 131072
    s_add_u32 s77, s75, 2048
    buffer_load_dwordx4 v12, s[28:31], s77 offen lds
    s_add_u32 m0, s68, 139264
    s_add_u32 s77, s75, 4096
    buffer_load_dwordx4 v12, s[28:31], s77 offen lds
    s_add_u32 m0, s69, 122880
    s_add_u32 s77, s76, 0
    buffer_load_dwordx4 v12, s[28:31], s77 offen lds
    s_add_u32 m0, s69, 131072
    s_add_u32 s77, s76, 2048
    buffer_load_dwordx4 v12, s[28:31], s77 offen lds
    s_add_u32 m0, s69, 139264
    s_add_u32 s77, s76, 4096
    buffer_load_dwordx4 v12, s[28:31], s77 offen lds
    buffer_load_dword v14, v13, s[36:39], 0 offen offset:4 sc1
    s_waitcnt vmcnt(11)
    s_barrier
    s_add_u32 s72, s64, 0
    s_and_b32 s72, s72, 3
    s_add_u32 s73, s65, 4
    s_and_b32 s73, s73, 15
    s_add_u32 s72, s72, s73
    s_mul_i32 s73, s72, 393216
    s_lshl_b32 s72, s72, 7
    s_add_u32 s74, s72, s70
    s_add_u32 s75, s73, s66
    s_add_u32 s76, s73, s67
    s_add_u32 m0, s71, 0
    s_add_u32 s77, s74, 0
    buffer_load_dwordx4 v10, s[24:27], s77 offen lds
    s_add_u32 m0, s71, 1024
    s_add_u32 s77, s74, 16384
    buffer_load_dwordx4 v11, s[24:27], s77 offen lds
    s_add_u32 m0, s71, 2048
    s_add_u32 s77, s74, 32768
    buffer_load_dwordx4 v10, s[24:27], s77 offen lds
    s_add_u32 m0, s71, 3072
    s_add_u32 s77, s74, 49152
    buffer_load_dwordx4 v11, s[24:27], s77 offen lds
    s_add_u32 m0, s68, 0
    s_add_u32 s77, s75, 0
    buffer_load_dwordx4 v12, s[28:31], s77 offen lds
    s_add_u32 m0, s68, 8192
    s_add_u32 s77, s75, 2048
    buffer_load_dwordx4 v12, s[28:31], s77 offen lds
    s_add_u32 m0, s68, 16384
    s_add_u32 s77, s75, 4096
    buffer_load_dwordx4 v12, s[28:31], s77 offen lds
    s_add_u32 m0, s69, 0
    s_add_u32 s77, s76, 0
    buffer_load_dwordx4 v12, s[28:31], s77 offen lds
    s_add_u32 m0, s69, 8192
    s_add_u32 s77, s76, 2048
    buffer_load_dwordx4 v12, s[28:31], s77 offen lds
    s_add_u32 m0, s69, 16384
    s_add_u32 s77, s76, 4096
    buffer_load_dwordx4 v12, s[28:31], s77 offen lds
    s_add_u32 s72, s64, 1
    s_and_b32 s72, s72, 3
    s_add_u32 s73, s65, 4
    s_and_b32 s73, s73, 15
    s_add_u32 s72, s72, s73
    s_mul_i32 s73, s72, 393216
    s_lshl_b32 s72, s72, 7
    s_add_u32 s74, s72, s70
    s_add_u32 s75, s73, s66
    s_add_u32 s76, s73, s67
    s_add_u32 m0, s71, 40960
    s_add_u32 s77, s74, 0
    buffer_load_dwordx4 v10, s[24:27], s77 offen lds
    s_add_u32 m0, s71, 41984
    s_add_u32 s77, s74, 16384
    buffer_load_dwordx4 v11, s[24:27], s77 offen lds
    s_add_u32 m0, s71, 43008
    s_add_u32 s77, s74, 32768
    buffer_load_dwordx4 v10, s[24:27], s77 offen lds
    s_add_u32 m0, s71, 44032
    s_add_u32 s77, s74, 49152
    buffer_load_dwordx4 v11, s[24:27], s77 offen lds
    s_add_u32 m0, s68, 40960
    s_add_u32 s77, s75, 0
    buffer_load_dwordx4 v12, s[28:31], s77 offen lds
    s_add_u32 m0, s68, 49152
    s_add_u32 s77, s75, 2048
    buffer_load_dwordx4 v12, s[28:31], s77 offen lds
    s_add_u32 m0, s68, 57344
    s_add_u32 s77, s75, 4096
    buffer_load_dwordx4 v12, s[28:31], s77 offen lds
    s_add_u32 m0, s69, 40960
    s_add_u32 s77, s76, 0
    buffer_load_dwordx4 v12, s[28:31], s77 offen lds
    s_add_u32 m0, s69, 49152
    s_add_u32 s77, s76, 2048
    buffer_load_dwordx4 v12, s[28:31], s77 offen lds
    s_add_u32 m0, s69, 57344
    s_add_u32 s77, s76, 4096
    buffer_load_dwordx4 v12, s[28:31], s77 offen lds
    s_waitcnt vmcnt(21)
    s_barrier
    s_add_u32 s72, s64, 2
    s_and_b32 s72, s72, 3
    s_add_u32 s73, s65, 4
    s_and_b32 s73, s73, 15
    s_add_u32 s72, s72, s73
    s_mul_i32 s73, s72, 393216
    s_lshl_b32 s72, s72, 7
    s_add_u32 s74, s72, s70
    s_add_u32 s75, s73, s66
    s_add_u32 s76, s73, s67
    s_add_u32 m0, s71, 81920
    s_add_u32 s77, s74, 0
    buffer_load_dwordx4 v10, s[24:27], s77 offen lds
    s_add_u32 m0, s71, 82944
    s_add_u32 s77, s74, 16384
    buffer_load_dwordx4 v11, s[24:27], s77 offen lds
    s_add_u32 m0, s71, 83968
    s_add_u32 s77, s74, 32768
    buffer_load_dwordx4 v10, s[24:27], s77 offen lds
    s_add_u32 m0, s71, 84992
    s_add_u32 s77, s74, 49152
    buffer_load_dwordx4 v11, s[24:27], s77 offen lds
    s_add_u32 m0, s68, 81920
    s_add_u32 s77, s75, 0
    buffer_load_dwordx4 v12, s[28:31], s77 offen lds
    s_add_u32 m0, s68, 90112
    s_add_u32 s77, s75, 2048
    buffer_load_dwordx4 v12, s[28:31], s77 offen lds
    s_add_u32 m0, s68, 98304
    s_add_u32 s77, s75, 4096
    buffer_load_dwordx4 v12, s[28:31], s77 offen lds
    s_add_u32 m0, s69, 81920
    s_add_u32 s77, s76, 0
    buffer_load_dwordx4 v12, s[28:31], s77 offen lds
    s_add_u32 m0, s69, 90112
    s_add_u32 s77, s76, 2048
    buffer_load_dwordx4 v12, s[28:31], s77 offen lds
    s_add_u32 m0, s69, 98304
    s_add_u32 s77, s76, 4096
    buffer_load_dwordx4 v12, s[28:31], s77 offen lds
    s_waitcnt vmcnt(20)
    s_barrier
    s_add_u32 s72, s64, 3
    s_and_b32 s72, s72, 3
    s_add_u32 s73, s65, 4
    s_and_b32 s73, s73, 15
    s_add_u32 s72, s72, s73
    s_mul_i32 s73, s72, 393216
    s_lshl_b32 s72, s72, 7
    s_add_u32 s74, s72, s70
    s_add_u32 s75, s73, s66
    s_add_u32 s76, s73, s67
    s_add_u32 m0, s71, 122880
    s_add_u32 s77, s74, 0
    buffer_load_dwordx4 v10, s[24:27], s77 offen lds
    s_add_u32 m0, s71, 123904
    s_add_u32 s77, s74, 16384
    buffer_load_dwordx4 v11, s[24:27], s77 offen lds
    s_add_u32 m0, s71, 124928
    s_add_u32 s77, s74, 32768
    buffer_load_dwordx4 v10, s[24:27], s77 offen lds
    s_add_u32 m0, s71, 125952
    s_add_u32 s77, s74, 49152
    buffer_load_dwordx4 v11, s[24:27], s77 offen lds
    s_add_u32 m0, s68, 122880
    s_add_u32 s77, s75, 0
    buffer_load_dwordx4 v12, s[28:31], s77 offen lds
    s_add_u32 m0, s68, 131072
    s_add_u32 s77, s75, 2048
    buffer_load_dwordx4 v12, s[28:31], s77 offen lds
    s_add_u32 m0, s68, 139264
    s_add_u32 s77, s75, 4096
    buffer_load_dwordx4 v12, s[28:31], s77 offen lds
    s_add_u32 m0, s69, 122880
    s_add_u32 s77, s76, 0
    buffer_load_dwordx4 v12, s[28:31], s77 offen lds
    s_add_u32 m0, s69, 131072
    s_add_u32 s77, s76, 2048
    buffer_load_dwordx4 v12, s[28:31], s77 offen lds
    s_add_u32 m0, s69, 139264
    s_add_u32 s77, s76, 4096
    buffer_load_dwordx4 v12, s[28:31], s77 offen lds
    s_waitcnt vmcnt(52)
    s_waitcnt vmcnt(40)
    v_readfirstlane_b32 s78, v14
L_tg1:
    s_nop 1
    s_cmp_lg_u32 s78, 0
    s_cbranch_scc1 L_tk2
    buffer_load_dword v14, v13, s[36:39], 0 offen offset:4 sc1
    s_waitcnt vmcnt(0)
    v_readfirstlane_b32 s78, v14
    s_add_u32 s79, s79, 1
    s_cmp_lt_u32 s79, 32768
    s_cbranch_scc1 L_tg1
L_tk2:
    s_mul_i32 s80, s78, 0x9e3779b1
    s_lshr_b32 s80, s80, 22
    s_mul_i32 s81, s78, 0x85ebca77
    s_lshr_b32 s81, s81, 22
    s_mul_i32 s82, s78, 0xc2b2ae3d
    s_lshr_b32 s82, s82, 22
    s_mul_i32 s83, s78, 0x27d4eb2f
    s_lshr_b32 s83, s83, 22
    v_and_b32 v72, 0xffff, v64
    v_and_b32 v80, 0xffff0000, v64
    v_and_b32 v73, 0xffff, v65
    v_and_b32 v81, 0xffff0000, v65
    v_dot2_f32_bf16 v92, v40, v72, 0
    v_dot2_f32_bf16 v93, v40, v80, 0
    v_and_b32 v74, 0xffff, v66
    v_and_b32 v82, 0xffff0000, v66
    v_dot2_f32_bf16 v94, v41, v73, 0
    v_dot2_f32_bf16 v95, v41, v81, 0
    v_and_b32 v75, 0xffff, v67
    v_and_b32 v83, 0xffff0000, v67
    v_cvt_pk_bf16_f32 v92, v92, v93
    v_dot2_f32_bf16 v96, v42, v74, 0
    v_dot2_f32_bf16 v97, v42, v82, 0
    s_mov_b32 s19, 0x3f803f80
    v_and_b32 v76, 0xffff, v68
    v_and_b32 v84, 0xffff0000, v68
    v_dot2_f32_bf16 v89, v92, s19, 0
    v_cvt_pk_bf16_f32 v94, v94, v95
    v_dot2_f32_bf16 v98, v43, v75, 0
    v_dot2_f32_bf16 v99, v43, v83, 0
    v_and_b32 v77, 0xffff, v69
    v_and_b32 v85, 0xffff0000, v69
    v_dot2_f32_bf16 v89, v94, s19, v89
    v_cvt_pk_bf16_f32 v96, v96, v97
    v_dot2_f32_bf16 v92, v44, v76, 0
    v_dot2_f32_bf16 v93, v44, v84, 0
    v_and_b32 v78, 0xffff, v70
    v_and_b32 v86, 0xffff0000, v70
    v_dot2_f32_bf16 v89, v96, s19, v89
    v_cvt_pk_bf16_f32 v98, v98, v99
    v_dot2_f32_bf16 v94, v45, v77, 0
    v_dot2_f32_bf16 v95, v45, v85, 0
    v_and_b32 v79, 0xffff, v71
    v_and_b32 v87, 0xffff0000, v71
    v_dot2_f32_bf16 v89, v98, s19, v89
    v_cvt_pk_bf16_f32 v92, v92, v93
    v_dot2_f32_bf16 v96, v46, v78, 0
    v_dot2_f32_bf16 v97, v46, v86, 0
    v_dot2_f32_bf16 v89, v92, s19, v89
    v_cvt_pk_bf16_f32 v94, v94, v95
    v_dot2_f32_bf16 v98, v47, v79, 0
    v_dot2_f32_bf16 v99, v47, v87, 0
    v_dot2_f32_bf16 v92, v48, v72, 0
    v_dot2_f32_bf16 v93, v48, v80, 0
    v_dot2_f32_bf16 v89, v94, s19, v89
    v_cvt_pk_bf16_f32 v96, v96, v97
    v_dot2_f32_bf16 v94, v49, v73, 0
    v_dot2_f32_bf16 v95, v49, v81, 0
    v_dot2_f32_bf16 v89, v96, s19, v89
    v_cvt_pk_bf16_f32 v98, v98, v99
    v_cvt_pk_bf16_f32 v92, v92, v93
    v_dot2_f32_bf16 v96, v50, v74, 0
    v_dot2_f32_bf16 v97, v50, v82, 0
    v_dot2_f32_bf16 v89, v98, s19, v89
    v_dot2_f32_bf16 v88, v40, v56, 0
    v_dot2_f32_bf16 v90, v48, v56, 0
    v_dot2_f32_bf16 v91, v92, s19, 0
    v_cvt_pk_bf16_f32 v94, v94, v95
    v_dot2_f32_bf16 v98, v51, v75, 0
    v_dot2_f32_bf16 v99, v51, v83, 0
    v_dot2_f32_bf16 v88, v41, v57, v88
    v_dot2_f32_bf16 v90, v49, v57, v90
    v_dot2_f32_bf16 v91, v94, s19, v91
    v_cvt_pk_bf16_f32 v96, v96, v97
    v_dot2_f32_bf16 v92, v52, v76, 0
    v_dot2_f32_bf16 v93, v52, v84, 0
    v_dot2_f32_bf16 v88, v42, v58, v88
    v_dot2_f32_bf16 v90, v50, v58, v90
    v_dot2_f32_bf16 v91, v96, s19, v91
    v_cvt_pk_bf16_f32 v98, v98, v99
    v_dot2_f32_bf16 v94, v53, v77, 0
    v_dot2_f32_bf16 v95, v53, v85, 0
    v_dot2_f32_bf16 v88, v43, v59, v88
    v_dot2_f32_bf16 v90, v51, v59, v90
    v_dot2_f32_bf16 v91, v98, s19, v91
    v_cvt_pk_bf16_f32 v92, v92, v93
    v_dot2_f32_bf16 v96, v54, v78, 0
    v_dot2_f32_bf16 v97, v54, v86, 0
    v_dot2_f32_bf16 v88, v44, v60, v88
    v_dot2_f32_bf16 v90, v52, v60, v90
    v_dot2_f32_bf16 v91, v92, s19, v91
    v_cvt_pk_bf16_f32 v94, v94, v95
    v_dot2_f32_bf16 v98, v55, v79, 0
    v_dot2_f32_bf16 v99, v55, v87, 0
    v_dot2_f32_bf16 v88, v45, v61, v88
    v_dot2_f32_bf16 v90, v53, v61, v90
    v_dot2_f32_bf16 v91, v94, s19, v91
    v_cvt_pk_bf16_f32 v96, v96, v97
    v_dot2_f32_bf16 v88, v46, v62, v88
    v_dot2_f32_bf16 v90, v54, v62, v90
    v_dot2_f32_bf16 v91, v96, s19, v91
    v_cvt_pk_bf16_f32 v98, v98, v99
    v_dot2_f32_bf16 v88, v47, v63, v88
    v_dot2_f32_bf16 v90, v55, v63, v90
    v_dot2_f32_bf16 v91, v98, s19, v91
    s_nop 1
    v_permlane32_swap_b32 v88, v90
    v_permlane32_swap_b32 v89, v91
    v_add_f32 v88, v88, v90
    v_add_f32 v89, v89, v91
    v_mov_b32 v91, s78
    s_nop 0
    v_permlane16_swap_b32 v88, v89
    v_add_f32 v88, v88, v89
    s_nop 1
    v_add_f32_dpp v88, v88, v88 row_ror:8 row_mask:0xf bank_mask:0xf
    s_nop 1
    v_add_f32_dpp v88, v88, v88 row_ror:4 row_mask:0xf bank_mask:0xf
    s_nop 1
    v_add_f32_dpp v88, v88, v88 row_ror:2 row_mask:0xf bank_mask:0xf
    s_nop 1
    v_add_f32_dpp v88, v88, v88 row_ror:1 row_mask:0xf bank_mask:0xf
    v_cvt_pk_bf16_f32 v88, v88, v88
    v_ashrrev_i32 v90, 31, v88
    v_and_b32 v89, 0xffff0000, v88
    v_or_b32 v90, 0x80000000, v90
    v_mul_f32 v89, 0xbfb8aa3b, v89
    v_xor_b32 v90, v90, v88
    v_exp_f32 v89, v89
    v_lshrrev_b32 v90, 16, v90
    v_add_f32 v89, 1.0, v89
    v_readlane_b32 s84, v90, 0
    v_rcp_f32 v89, v89
    v_readlane_b32 s85, v90, 32
    s_lshl_b32 s84, s84, 11
    v_cvt_pk_bf16_f32 v89, v89, v89
    s_lshl_b32 s85, s85, 11
    s_sub_u32 s3, 2047, s18
    s_or_b32 s84, s84, s3
    v_readlane_b32 s20, v89, 16
    s_sub_u32 s3, s3, 1
    v_readlane_b32 s21, v89, 48
    s_or_b32 s85, s85, s3
    s_max_u32 s84, s84, s85
    s_and_b32 s20, s20, 0xffff
    s_and_b32 s21, s21, 0xffff0000
    s_or_b32 s20, s20, s21
    s_lshl_b32 s3, s18, 2
    s_add_u32 s21, s3, 4472832
    s_add_u32 s3, s3, 4464640
    v_mov_b32 v88, s84
    v_mov_b32 v89, s78
    v_mov_b32 v90, s20
    s_mov_b64 exec, 1
    buffer_store_dwordx2 v[88:89], v13, s[32:35], s3 offen sc1
    buffer_store_dwordx2 v[90:91], v13, s[32:35], s21 offen sc1
    s_mov_b64 exec, -1
    s_waitcnt vmcnt(22)
    s_barrier
    s_add_u32 s72, s64, 0
    s_and_b32 s72, s72, 3
    s_add_u32 s73, s65, 8
    s_and_b32 s73, s73, 15
    s_add_u32 s72, s72, s73
    s_mul_i32 s73, s72, 393216
    s_lshl_b32 s72, s72, 7
    s_add_u32 s74, s72, s70
    s_add_u32 s75, s73, s66
    s_add_u32 s76, s73, s67
    s_add_u32 m0, s71, 0
    s_add_u32 s77, s74, 0
    buffer_load_dwordx4 v10, s[24:27], s77 offen lds
    s_add_u32 m0, s71, 1024
    s_add_u32 s77, s74, 16384
    buffer_load_dwordx4 v11, s[24:27], s77 offen lds
    s_add_u32 m0, s71, 2048
    s_add_u32 s77, s74, 32768
    buffer_load_dwordx4 v10, s[24:27], s77 offen lds
    s_add_u32 m0, s71, 3072
    s_add_u32 s77, s74, 49152
    buffer_load_dwordx4 v11, s[24:27], s77 offen lds
    s_add_u32 m0, s68, 0
    s_add_u32 s77, s75, 0
    buffer_load_dwordx4 v12, s[28:31], s77 offen lds
    s_add_u32 m0, s68, 8192
    s_add_u32 s77, s75, 2048
    buffer_load_dwordx4 v12, s[28:31], s77 offen lds
    s_add_u32 m0, s68, 16384
    s_add_u32 s77, s75, 4096
    buffer_load_dwordx4 v12, s[28:31], s77 offen lds
    s_add_u32 m0, s69, 0
    s_add_u32 s77, s76, 0
    buffer_load_dwordx4 v12, s[28:31], s77 offen lds
    s_add_u32 m0, s69, 8192
    s_add_u32 s77, s76, 2048
    buffer_load_dwordx4 v12, s[28:31], s77 offen lds
    s_add_u32 m0, s69, 16384
    s_add_u32 s77, s76, 4096
    buffer_load_dwordx4 v12, s[28:31], s77 offen lds
    s_waitcnt vmcnt(22)
    s_barrier
    s_add_u32 s72, s64, 1
    s_and_b32 s72, s72, 3
    s_add_u32 s73, s65, 8
    s_and_b32 s73, s73, 15
    s_add_u32 s72, s72, s73
    s_mul_i32 s73, s72, 393216
    s_lshl_b32 s72, s72, 7
    s_add_u32 s74, s72, s70
    s_add_u32 s75, s73, s66
    s_add_u32 s76, s73, s67
    s_add_u32 m0, s71, 40960
    s_add_u32 s77, s74, 0
    buffer_load_dwordx4 v10, s[24:27], s77 offen lds
    s_add_u32 m0, s71, 41984
    s_add_u32 s77, s74, 16384
    buffer_load_dwordx4 v11, s[24:27], s77 offen lds
    s_add_u32 m0, s71, 43008
    s_add_u32 s77, s74, 32768
    buffer_load_dwordx4 v10, s[24:27], s77 offen lds
    s_add_u32 m0, s71, 44032
    s_add_u32 s77, s74, 49152
    buffer_load_dwordx4 v11, s[24:27], s77 offen lds
    s_add_u32 m0, s68, 40960
    s_add_u32 s77, s75, 0
    buffer_load_dwordx4 v12, s[28:31], s77 offen lds
    s_add_u32 m0, s68, 49152
    s_add_u32 s77, s75, 2048
    buffer_load_dwordx4 v12, s[28:31], s77 offen lds
    s_add_u32 m0, s68, 57344
    s_add_u32 s77, s75, 4096
    buffer_load_dwordx4 v12, s[28:31], s77 offen lds
    s_add_u32 m0, s69, 40960
    s_add_u32 s77, s76, 0
    buffer_load_dwordx4 v12, s[28:31], s77 offen lds
    s_add_u32 m0, s69, 49152
    s_add_u32 s77, s76, 2048
    buffer_load_dwordx4 v12, s[28:31], s77 offen lds
    s_add_u32 m0, s69, 57344
    s_add_u32 s77, s76, 4096
    buffer_load_dwordx4 v12, s[28:31], s77 offen lds
    s_waitcnt vmcnt(22)
    s_barrier
    s_add_u32 s72, s64, 2
    s_and_b32 s72, s72, 3
    s_add_u32 s73, s65, 8
    s_and_b32 s73, s73, 15
    s_add_u32 s72, s72, s73
    s_mul_i32 s73, s72, 393216
    s_lshl_b32 s72, s72, 7
    s_add_u32 s74, s72, s70
    s_add_u32 s75, s73, s66
    s_add_u32 s76, s73, s67
    s_add_u32 m0, s71, 81920
    s_add_u32 s77, s74, 0
    buffer_load_dwordx4 v10, s[24:27], s77 offen lds
    s_add_u32 m0, s71, 82944
    s_add_u32 s77, s74, 16384
    buffer_load_dwordx4 v11, s[24:27], s77 offen lds
    s_add_u32 m0, s71, 83968
    s_add_u32 s77, s74, 32768
    buffer_load_dwordx4 v10, s[24:27], s77 offen lds
    s_add_u32 m0, s71, 84992
    s_add_u32 s77, s74, 49152
    buffer_load_dwordx4 v11, s[24:27], s77 offen lds
    s_add_u32 m0, s68, 81920
    s_add_u32 s77, s75, 0
    buffer_load_dwordx4 v12, s[28:31], s77 offen lds
    s_add_u32 m0, s68, 90112
    s_add_u32 s77, s75, 2048
    buffer_load_dwordx4 v12, s[28:31], s77 offen lds
    s_add_u32 m0, s68, 98304
    s_add_u32 s77, s75, 4096
    buffer_load_dwordx4 v12, s[28:31], s77 offen lds
    s_add_u32 m0, s69, 81920
    s_add_u32 s77, s76, 0
    buffer_load_dwordx4 v12, s[28:31], s77 offen lds
    s_add_u32 m0, s69, 90112
    s_add_u32 s77, s76, 2048
    buffer_load_dwordx4 v12, s[28:31], s77 offen lds
    s_add_u32 m0, s69, 98304
    s_add_u32 s77, s76, 4096
    buffer_load_dwordx4 v12, s[28:31], s77 offen lds
    s_waitcnt vmcnt(20)
    s_barrier
    s_add_u32 s72, s64, 3
    s_and_b32 s72, s72, 3
    s_add_u32 s73, s65, 8
    s_and_b32 s73, s73, 15
    s_add_u32 s72, s72, s73
    s_mul_i32 s73, s72, 393216
    s_lshl_b32 s72, s72, 7
    s_add_u32 s74, s72, s70
    s_add_u32 s75, s73, s66
    s_add_u32 s76, s73, s67
    s_add_u32 m0, s71, 122880
    s_add_u32 s77, s74, 0
    buffer_load_dwordx4 v10, s[24:27], s77 offen lds
    s_add_u32 m0, s71, 123904
    s_add_u32 s77, s74, 16384
    buffer_load_dwordx4 v11, s[24:27], s77 offen lds
    s_add_u32 m0, s71, 124928
    s_add_u32 s77, s74, 32768
    buffer_load_dwordx4 v10, s[24:27], s77 offen lds
    s_add_u32 m0, s71, 125952
    s_add_u32 s77, s74, 49152
    buffer_load_dwordx4 v11, s[24:27], s77 offen lds
    s_add_u32 m0, s68, 122880
    s_add_u32 s77, s75, 0
    buffer_load_dwordx4 v12, s[28:31], s77 offen lds
    s_add_u32 m0, s68, 131072
    s_add_u32 s77, s75, 2048
    buffer_load_dwordx4 v12, s[28:31], s77 offen lds
    s_add_u32 m0, s68, 139264
    s_add_u32 s77, s75, 4096
    buffer_load_dwordx4 v12, s[28:31], s77 offen lds
    s_add_u32 m0, s69, 122880
    s_add_u32 s77, s76, 0
    buffer_load_dwordx4 v12, s[28:31], s77 offen lds
    s_add_u32 m0, s69, 131072
    s_add_u32 s77, s76, 2048
    buffer_load_dwordx4 v12, s[28:31], s77 offen lds
    s_add_u32 m0, s69, 139264
    s_add_u32 s77, s76, 4096
    buffer_load_dwordx4 v12, s[28:31], s77 offen lds
    s_waitcnt vmcnt(20)
    s_barrier
    s_add_u32 s72, s64, 0
    s_and_b32 s72, s72, 3
    s_add_u32 s73, s65, 12
    s_and_b32 s73, s73, 15
    s_add_u32 s72, s72, s73
    s_mul_i32 s73, s72, 393216
    s_lshl_b32 s72, s72, 7
    s_add_u32 s74, s72, s70
    s_add_u32 s75, s73, s66
    s_add_u32 s76, s73, s67
    s_add_u32 m0, s71, 0
    s_add_u32 s77, s74, 0
    buffer_load_dwordx4 v10, s[24:27], s77 offen lds
    s_add_u32 m0, s71, 1024
    s_add_u32 s77, s74, 16384
    buffer_load_dwordx4 v11, s[24:27], s77 offen lds
    s_add_u32 m0, s71, 2048
    s_add_u32 s77, s74, 32768
    buffer_load_dwordx4 v10, s[24:27], s77 offen lds
    s_add_u32 m0, s71, 3072
    s_add_u32 s77, s74, 49152
    buffer_load_dwordx4 v11, s[24:27], s77 offen lds
    s_add_u32 m0, s68, 0
    s_add_u32 s77, s75, 0
    buffer_load_dwordx4 v12, s[28:31], s77 offen lds
    s_add_u32 m0, s68, 8192
    s_add_u32 s77, s75, 2048
    buffer_load_dwordx4 v12, s[28:31], s77 offen lds
    s_add_u32 m0, s68, 16384
    s_add_u32 s77, s75, 4096
    buffer_load_dwordx4 v12, s[28:31], s77 offen lds
    s_add_u32 m0, s69, 0
    s_add_u32 s77, s76, 0
    buffer_load_dwordx4 v12, s[28:31], s77 offen lds
    s_add_u32 m0, s69, 8192
    s_add_u32 s77, s76, 2048
    buffer_load_dwordx4 v12, s[28:31], s77 offen lds
    s_add_u32 m0, s69, 16384
    s_add_u32 s77, s76, 4096
    buffer_load_dwordx4 v12, s[28:31], s77 offen lds
    s_waitcnt vmcnt(20)
    s_barrier
    s_add_u32 s72, s64, 1
    s_and_b32 s72, s72, 3
    s_add_u32 s73, s65, 12
    s_and_b32 s73, s73, 15
    s_add_u32 s72, s72, s73
    s_mul_i32 s73, s72, 393216
    s_lshl_b32 s72, s72, 7
    s_add_u32 s74, s72, s70
    s_add_u32 s75, s73, s66
    s_add_u32 s76, s73, s67
    s_add_u32 m0, s71, 40960
    s_add_u32 s77, s74, 0
    buffer_load_dwordx4 v10, s[24:27], s77 offen lds
    s_add_u32 m0, s71, 41984
    s_add_u32 s77, s74, 16384
    buffer_load_dwordx4 v11, s[24:27], s77 offen lds
    s_add_u32 m0, s71, 43008
    s_add_u32 s77, s74, 32768
    buffer_load_dwordx4 v10, s[24:27], s77 offen lds
    s_add_u32 m0, s71, 44032
    s_add_u32 s77, s74, 49152
    buffer_load_dwordx4 v11, s[24:27], s77 offen lds
    s_add_u32 m0, s68, 40960
    s_add_u32 s77, s75, 0
    buffer_load_dwordx4 v12, s[28:31], s77 offen lds
    s_add_u32 m0, s68, 49152
    s_add_u32 s77, s75, 2048
    buffer_load_dwordx4 v12, s[28:31], s77 offen lds
    s_add_u32 m0, s68, 57344
    s_add_u32 s77, s75, 4096
    buffer_load_dwordx4 v12, s[28:31], s77 offen lds
    s_add_u32 m0, s69, 40960
    s_add_u32 s77, s76, 0
    buffer_load_dwordx4 v12, s[28:31], s77 offen lds
    s_add_u32 m0, s69, 49152
    s_add_u32 s77, s76, 2048
    buffer_load_dwordx4 v12, s[28:31], s77 offen lds
    s_add_u32 m0, s69, 57344
    s_add_u32 s77, s76, 4096
    buffer_load_dwordx4 v12, s[28:31], s77 offen lds
    s_waitcnt vmcnt(20)
    s_barrier
    s_add_u32 s72, s64, 2
    s_and_b32 s72, s72, 3
    s_add_u32 s73, s65, 12
    s_and_b32 s73, s73, 15
    s_add_u32 s72, s72, s73
    s_mul_i32 s73, s72, 393216
    s_lshl_b32 s72, s72, 7
    s_add_u32 s74, s72, s70
    s_add_u32 s75, s73, s66
    s_add_u32 s76, s73, s67
    s_add_u32 m0, s71, 81920
    s_add_u32 s77, s74, 0
    buffer_load_dwordx4 v10, s[24:27], s77 offen lds
    s_add_u32 m0, s71, 82944
    s_add_u32 s77, s74, 16384
    buffer_load_dwordx4 v11, s[24:27], s77 offen lds
    s_add_u32 m0, s71, 83968
    s_add_u32 s77, s74, 32768
    buffer_load_dwordx4 v10, s[24:27], s77 offen lds
    s_add_u32 m0, s71, 84992
    s_add_u32 s77, s74, 49152
    buffer_load_dwordx4 v11, s[24:27], s77 offen lds
    s_add_u32 m0, s68, 81920
    s_add_u32 s77, s75, 0
    buffer_load_dwordx4 v12, s[28:31], s77 offen lds
    s_add_u32 m0, s68, 90112
    s_add_u32 s77, s75, 2048
    buffer_load_dwordx4 v12, s[28:31], s77 offen lds
    s_add_u32 m0, s68, 98304
    s_add_u32 s77, s75, 4096
    buffer_load_dwordx4 v12, s[28:31], s77 offen lds
    s_add_u32 m0, s69, 81920
    s_add_u32 s77, s76, 0
    buffer_load_dwordx4 v12, s[28:31], s77 offen lds
    s_add_u32 m0, s69, 90112
    s_add_u32 s77, s76, 2048
    buffer_load_dwordx4 v12, s[28:31], s77 offen lds
    s_add_u32 m0, s69, 98304
    s_add_u32 s77, s76, 4096
    buffer_load_dwordx4 v12, s[28:31], s77 offen lds
    s_lshl_b32 s19, s17, 11
    s_add_u32 s19, s19, 4464640
    buffer_load_dwordx4 v[28:31], v3, s[32:35], s19 offen offset:0 sc1
    buffer_load_dwordx4 v[32:35], v3, s[32:35], s19 offen offset:1024 sc1
    s_waitcnt vmcnt(22)
    s_barrier
    s_add_u32 s72, s64, 3
    s_and_b32 s72, s72, 3
    s_add_u32 s73, s65, 12
    s_and_b32 s73, s73, 15
    s_add_u32 s72, s72, s73
    s_mul_i32 s73, s72, 393216
    s_lshl_b32 s72, s72, 7
    s_add_u32 s74, s72, s70
    s_add_u32 s75, s73, s66
    s_add_u32 s76, s73, s67
    s_add_u32 m0, s71, 122880
    s_add_u32 s77, s74, 0
    buffer_load_dwordx4 v10, s[24:27], s77 offen lds
    s_add_u32 m0, s71, 123904
    s_add_u32 s77, s74, 16384
    buffer_load_dwordx4 v11, s[24:27], s77 offen lds
    s_add_u32 m0, s71, 124928
    s_add_u32 s77, s74, 32768
    buffer_load_dwordx4 v10, s[24:27], s77 offen lds
    s_add_u32 m0, s71, 125952
    s_add_u32 s77, s74, 49152
    buffer_load_dwordx4 v11, s[24:27], s77 offen lds
    s_add_u32 m0, s68, 122880
    s_add_u32 s77, s75, 0
    buffer_load_dwordx4 v12, s[28:31], s77 offen lds
    s_add_u32 m0, s68, 131072
    s_add_u32 s77, s75, 2048
    buffer_load_dwordx4 v12, s[28:31], s77 offen lds
    s_add_u32 m0, s68, 139264
    s_add_u32 s77, s75, 4096
    buffer_load_dwordx4 v12, s[28:31], s77 offen lds
    s_add_u32 m0, s69, 122880
    s_add_u32 s77, s76, 0
    buffer_load_dwordx4 v12, s[28:31], s77 offen lds
    s_add_u32 m0, s69, 131072
    s_add_u32 s77, s76, 2048
    buffer_load_dwordx4 v12, s[28:31], s77 offen lds
    s_add_u32 m0, s69, 139264
    s_add_u32 s77, s76, 4096
    buffer_load_dwordx4 v12, s[28:31], s77 offen lds
    s_waitcnt vmcnt(22)
    s_barrier
    buffer_load_dwordx4 v[100:103], v15, s[48:51], s1 offen nt
    buffer_load_dwordx4 v[132:135], v15, s[52:55], s1 offen nt
    s_add_u32 s1, s1, 28672
    buffer_load_dwordx4 v[104:107], v15, s[48:51], s1 offen nt
    buffer_load_dwordx4 v[136:139], v15, s[52:55], s1 offen nt
    s_add_u32 s1, s1, 28672
    buffer_load_dwordx4 v[108:111], v15, s[48:51], s1 offen nt
    buffer_load_dwordx4 v[140:143], v15, s[52:55], s1 offen nt
    s_add_u32 s1, s1, 28672
    s_mul_i32 s73, s13, 112
    s_mul_i32 s19, s17, 28
    s_add_u32 s73, s73, s19
    s_lshl_b32 s74, s73, 11
    s_lshl_b32 s19, s12, 8
    s_add_u32 s74, s74, s19
    s_lshr_b32 s67, s12, 2
    s_lshl_b32 s67, s67, 3
    s_lshr_b32 s19, s13, 2
    s_add_u32 s67, s67, s19
    s_lshl_b32 s68, s19, 2
    s_lshl_b32 s69, s67, 7
    s_lshl_b32 s19, s17, 14
    s_add_u32 s69, s69, s19
    s_waitcnt vmcnt(6)
    s_barrier
    s_cmp_lg_u32 s17, 0
    s_cbranch_scc1 L_z3
    v_mov_b32 v40, 0
    v_mov_b32 v41, 0
    v_mov_b32 v42, 0
    v_mov_b32 v43, 0
    s_mov_b64 exec, 15
    ds_write_b128 v3, v[40:43] offset:0
    ds_write_b32 v13, v37 offset:128
    s_mov_b64 exec, -1
L_z3:
    buffer_load_dwordx4 v[112:115], v15, s[48:51], s1 offen nt
    buffer_load_dwordx4 v[144:147], v15, s[52:55], s1 offen nt
    s_add_u32 s1, s1, 28672
    buffer_load_dwordx4 v[116:119], v15, s[48:51], s1 offen nt
    buffer_load_dwordx4 v[148:151], v15, s[52:55], s1 offen nt
    s_add_u32 s1, s1, 28672
    buffer_load_dwordx4 v[120:123], v15, s[48:51], s1 offen nt
    buffer_load_dwordx4 v[152:155], v15, s[52:55], s1 offen nt
    s_add_u32 s1, s1, 28672
    buffer_load_dwordx4 v[124:127], v15, s[48:51], s1 offen nt
    buffer_load_dwordx4 v[156:159], v15, s[52:55], s1 offen nt
    s_add_u32 s1, s1, 28672
    buffer_load_dwordx4 v[128:131], v15, s[48:51], s1 offen nt
    buffer_load_dwordx4 v[160:163], v15, s[52:55], s1 offen nt
    s_add_u32 s1, s1, 28672
    s_waitcnt vmcnt(26)
L_kp4:
    v_xor_b32 v29, s78, v29
    v_xor_b32 v31, s78, v31
    v_xor_b32 v33, s78, v33
    v_xor_b32 v35, s78, v35
    v_or3_b32 v29, v29, v31, v33
    v_max3_u32 v28, v28, v30, v32
    v_or_b32 v29, v29, v35
    v_max_u32 v28, v28, v34
    v_cmp_ne_u32 vcc, 0, v29
    s_cbranch_vccz L_kk5
    s_lshl_b32 s19, s17, 11
    s_add_u32 s19, s19, 4464640
    buffer_load_dwordx4 v[28:31], v3, s[32:35], s19 offen offset:0 sc1
    buffer_load_dwordx4 v[32:35], v3, s[32:35], s19 offen offset:1024 sc1
    s_waitcnt vmcnt(0)
    s_add_u32 s79, s79, 1
    s_cmp_lt_u32 s79, 32768
    s_cbranch_scc1 L_kp4
L_kk5:
L_fw6:
    ds_read_b32 v29, v13 offset:128
    s_waitcnt lgkmcnt(0)
    v_cmp_ne_u32 vcc, v29, v37
    s_cbranch_vccz L_fk7
    s_add_u32 s79, s79, 1
    s_cmp_lt_u32 s79, 32768
    s_cbranch_scc1 L_fw6
L_fk7:
    ds_max_u32 v13, v28 offset:16
    v_mov_b32 v26, 1
    s_mov_b64 exec, 1
    ds_add_u32 v13, v26 offset:0
    s_mov_b64 exec, -1
L_kc8:
    ds_read_b32 v26, v13 offset:0
    ds_read_b32 v27, v13 offset:16
    s_waitcnt lgkmcnt(0)
    v_readfirstlane_b32 s19, v26
    v_readfirstlane_b32 s71, v27
    s_nop 0
    s_cmp_ge_u32 s19, 4
    s_cbranch_scc1 L_kd9
    s_add_u32 s79, s79, 1
    s_cmp_lt_u32 s79, 32768
    s_cbranch_scc1 L_kc8
L_kd9:
    s_and_b32 s72, s71, 2047
    s_sub_u32 s72, 2047, s72
    s_lshl_b32 s19, s72, 11
    s_lshl_b32 s3, s0, 1
    s_add_u32 s19, s19, s3
    v_lshlrev_b32 v26, 3, v20
    v_lshl_add_u32 v26, v9, 1, v26
    buffer_load_ushort v27, v26, s[24:27], s19 offen
    s_lshl_b32 s19, s68, 16
    s_add_u32 s19, s19, s69
    buffer_load_dwordx4 v[192:195], v17, s[60:63], s19 offen
    s_add_u32 s68, s68, 1
    s_and_b32 s68, s68, 31
    s_lshl_b32 s19, s68, 16
    s_add_u32 s19, s19, s69
    buffer_load_dwordx4 v[196:199], v17, s[60:63], s19 offen
    s_add_u32 s68, s68, 1
    s_and_b32 s68, s68, 31
    s_lshl_b32 s19, s68, 16
    s_add_u32 s19, s19, s69
    buffer_load_dwordx4 v[200:203], v17, s[60:63], s19 offen
    s_add_u32 s68, s68, 1
    s_and_b32 s68, s68, 31
    s_lshl_b32 s19, s68, 16
    s_add_u32 s19, s19, s69
    buffer_load_dwordx4 v[204:207], v17, s[60:63], s19 offen
    s_add_u32 s68, s68, 1
    s_and_b32 s68, s68, 31
    s_lshl_b32 s19, s68, 16
    s_add_u32 s19, s19, s69
    buffer_load_dwordx4 v[208:211], v17, s[60:63], s19 offen
    s_add_u32 s68, s68, 1
    s_and_b32 s68, s68, 31
    s_lshl_b32 s19, s68, 16
    s_add_u32 s19, s19, s69
    buffer_load_dwordx4 v[212:215], v17, s[60:63], s19 offen
    s_add_u32 s68, s68, 1
    s_and_b32 s68, s68, 31
    s_lshl_b32 s19, s68, 16
    s_add_u32 s19, s19, s69
    buffer_load_dwordx4 v[216:219], v17, s[60:63], s19 offen
    s_add_u32 s68, s68, 1
    s_and_b32 s68, s68, 31
    s_lshl_b32 s19, s68, 16
    s_add_u32 s19, s19, s69
    buffer_load_dwordx4 v[220:223], v17, s[60:63], s19 offen
    s_add_u32 s68, s68, 1
    s_and_b32 s68, s68, 31
    s_lshl_b32 s19, s68, 16
    s_add_u32 s19, s19, s69
    buffer_load_dwordx4 v[224:227], v17, s[60:63], s19 offen
    s_add_u32 s68, s68, 1
    s_and_b32 s68, s68, 31
    s_lshl_b32 s19, s68, 16
    s_add_u32 s19, s19, s69
    buffer_load_dwordx4 v[228:231], v17, s[60:63], s19 offen
    s_add_u32 s68, s68, 1
    s_and_b32 s68, s68, 31
    s_lshl_b32 s19, s68, 16
    s_add_u32 s19, s19, s69
    buffer_load_dwordx4 v[232:235], v17, s[60:63], s19 offen
    s_add_u32 s68, s68, 1
    s_and_b32 s68, s68, 31
    s_lshl_b32 s19, s68, 16
    s_add_u32 s19, s19, s69
    buffer_load_dwordx4 v[236:239], v17, s[60:63], s19 offen
    s_add_u32 s68, s68, 1
    s_and_b32 s68, s68, 31
    s_lshl_b32 s19, s68, 16
    s_add_u32 s19, s19, s69
    buffer_load_dwordx4 v[240:243], v17, s[60:63], s19 offen
    s_add_u32 s68, s68, 1
    s_and_b32 s68, s68, 31
    s_lshl_b32 s19, s68, 16
    s_add_u32 s19, s19, s69
    buffer_load_dwordx4 v[244:247], v17, s[60:63], s19 offen
    s_add_u32 s68, s68, 1
    s_and_b32 s68, s68, 31
    s_lshl_b32 s19, s68, 16
    s_add_u32 s19, s19, s69
    buffer_load_dwordx4 v[248:251], v17, s[60:63], s19 offen
    s_add_u32 s68, s68, 1
    s_and_b32 s68, s68, 31
    s_lshl_b32 s19, s68, 16
    s_add_u32 s19, s19, s69
    buffer_load_dwordx4 v[252:255], v17, s[60:63], s19 offen
    s_add_u32 s68, s68, 1
    s_and_b32 s68, s68, 31
    s_waitcnt vmcnt(16)
    v_lshl_or_b32 v27, v27, 16, v27
    s_lshl_b32 s19, s17, 10
    s_add_u32 s19, s19, 26624
    v_and_b32_dpp v72, v27, v4 row_newbcast:0 row_mask:0xf bank_mask:0xf
    v_and_b32_dpp v73, v27, v5 row_newbcast:0 row_mask:0xf bank_mask:0xf
    v_and_b32_dpp v74, v27, v6 row_newbcast:0 row_mask:0xf bank_mask:0xf
    v_and_b32_dpp v75, v27, v7 row_newbcast:0 row_mask:0xf bank_mask:0xf
    v_and_b32_dpp v76, v27, v4 row_newbcast:1 row_mask:0xf bank_mask:0xf
    v_and_b32_dpp v77, v27, v5 row_newbcast:1 row_mask:0xf bank_mask:0xf
    v_mfma_f32_16x16x32_bf16 v[88:91], v[72:75], v[100:103], 0
    v_and_b32_dpp v78, v27, v6 row_newbcast:1 row_mask:0xf bank_mask:0xf
    v_and_b32_dpp v79, v27, v7 row_newbcast:1 row_mask:0xf bank_mask:0xf
    v_mfma_f32_16x16x32_bf16 v[92:95], v[72:75], v[132:135], 0
    v_and_b32_dpp v80, v27, v4 row_newbcast:2 row_mask:0xf bank_mask:0xf
    v_and_b32_dpp v81, v27, v5 row_newbcast:2 row_mask:0xf bank_mask:0xf
    v_mfma_f32_16x16x32_bf16 v[88:91], v[76:79], v[104:107], v[88:91]
    v_and_b32_dpp v82, v27, v6 row_newbcast:2 row_mask:0xf bank_mask:0xf
    v_and_b32_dpp v83, v27, v7 row_newbcast:2 row_mask:0xf bank_mask:0xf
    v_mfma_f32_16x16x32_bf16 v[92:95], v[76:79], v[136:139], v[92:95]
    v_and_b32_dpp v84, v27, v4 row_newbcast:3 row_mask:0xf bank_mask:0xf
    v_and_b32_dpp v85, v27, v5 row_newbcast:3 row_mask:0xf bank_mask:0xf
    v_mfma_f32_16x16x32_bf16 v[88:91], v[80:83], v[108:111], v[88:91]
    v_and_b32_dpp v86, v27, v6 row_newbcast:3 row_mask:0xf bank_mask:0xf
    v_and_b32_dpp v87, v27, v7 row_newbcast:3 row_mask:0xf bank_mask:0xf
    v_mfma_f32_16x16x32_bf16 v[92:95], v[80:83], v[140:143], v[92:95]
    v_and_b32_dpp v72, v27, v4 row_newbcast:4 row_mask:0xf bank_mask:0xf
    v_and_b32_dpp v73, v27, v5 row_newbcast:4 row_mask:0xf bank_mask:0xf
    v_mfma_f32_16x16x32_bf16 v[88:91], v[84:87], v[112:115], v[88:91]
    v_and_b32_dpp v74, v27, v6 row_newbcast:4 row_mask:0xf bank_mask:0xf
    v_and_b32_dpp v75, v27, v7 row_newbcast:4 row_mask:0xf bank_mask:0xf
    v_mfma_f32_16x16x32_bf16 v[92:95], v[84:87], v[144:147], v[92:95]
    v_and_b32_dpp v76, v27, v4 row_newbcast:5 row_mask:0xf bank_mask:0xf
    v_and_b32_dpp v77, v27, v5 row_newbcast:5 row_mask:0xf bank_mask:0xf
    v_mfma_f32_16x16x32_bf16 v[88:91], v[72:75], v[116:119], v[88:91]
    v_and_b32_dpp v78, v27, v6 row_newbcast:5 row_mask:0xf bank_mask:0xf
    v_and_b32_dpp v79, v27, v7 row_newbcast:5 row_mask:0xf bank_mask:0xf
    v_mfma_f32_16x16x32_bf16 v[92:95], v[72:75], v[148:151], v[92:95]
    v_and_b32_dpp v80, v27, v4 row_newbcast:6 row_mask:0xf bank_mask:0xf
    v_and_b32_dpp v81, v27, v5 row_newbcast:6 row_mask:0xf bank_mask:0xf
    v_mfma_f32_16x16x32_bf16 v[88:91], v[76:79], v[120:123], v[88:91]
    v_and_b32_dpp v82, v27, v6 row_newbcast:6 row_mask:0xf bank_mask:0xf
    v_and_b32_dpp v83, v27, v7 row_newbcast:6 row_mask:0xf bank_mask:0xf
    v_mfma_f32_16x16x32_bf16 v[92:95], v[76:79], v[152:155], v[92:95]
    v_and_b32_dpp v84, v27, v4 row_newbcast:7 row_mask:0xf bank_mask:0xf
    v_and_b32_dpp v85, v27, v5 row_newbcast:7 row_mask:0xf bank_mask:0xf
    v_mfma_f32_16x16x32_bf16 v[88:91], v[80:83], v[124:127], v[88:91]
    v_and_b32_dpp v86, v27, v6 row_newbcast:7 row_mask:0xf bank_mask:0xf
    v_and_b32_dpp v87, v27, v7 row_newbcast:7 row_mask:0xf bank_mask:0xf
    v_mfma_f32_16x16x32_bf16 v[92:95], v[80:83], v[156:159], v[92:95]
    v_add_u32 v26, s19, v3
    v_mov_b32 v28, 1
    v_mfma_f32_16x16x32_bf16 v[88:91], v[84:87], v[128:131], v[88:91]
    v_mfma_f32_16x16x32_bf16 v[92:95], v[84:87], v[160:163], v[92:95]
    s_nop 7
    v_permlane32_swap_b32 v88, v92
    v_permlane32_swap_b32 v89, v93
    v_permlane32_swap_b32 v90, v94
    v_permlane32_swap_b32 v91, v95
    ds_write_b128 v26, v[88:91]
    s_mov_b64 exec, 1
    ds_add_rtn_u32 v29, v13, v28 offset:32
    s_mov_b64 exec, -1
    s_waitcnt lgkmcnt(0)
    v_readfirstlane_b32 s19, v29
    s_nop 1
    s_cmp_lg_u32 s19, 3
    s_cbranch_scc1 L_gs10
    ds_read_b128 v[72:75], v3 offset:26624
    ds_read_b128 v[76:79], v3 offset:27648
    ds_read_b128 v[80:83], v3 offset:28672
    ds_read_b128 v[84:87], v3 offset:29696
    s_waitcnt lgkmcnt(0)
    v_pk_add_f32 v[72:73], v[72:73], v[76:77]
    v_pk_add_f32 v[74:75], v[74:75], v[78:79]
    v_pk_add_f32 v[80:81], v[80:81], v[84:85]
    v_pk_add_f32 v[82:83], v[82:83], v[86:87]
    v_pk_add_f32 v[72:73], v[72:73], v[80:81]
    v_pk_add_f32 v[74:75], v[74:75], v[82:83]
    v_bfi_b32 v72, v23, s80, v72
    v_bfi_b32 v73, v23, s81, v73
    v_bfi_b32 v74, v23, s82, v74
    v_bfi_b32 v75, v23, s83, v75
    s_cmp_ge_u32 s2, 224
    s_cbranch_scc1 L_gs10
    v_lshrrev_b32 v26, 5, v2
    v_mul_u32_u24 v26, 14336, v26
    v_lshl_add_u32 v26, v8, 5, v26
    v_and_b32 v29, 1, v9
    v_lshl_add_u32 v26, v29, 4, v26
    s_mul_i32 s19, s12, 28672
    s_lshl_b32 s3, s13, 9
    s_add_u32 s19, s19, s3
    s_add_u32 s19, s19, 4489216
    buffer_store_dwordx4 v[72:75], v26, s[32:35], s19 offen sc1
L_gs10:
    s_waitcnt vmcnt(8)
L_fw11:
    ds_read_b32 v29, v36 offset:144
    s_waitcnt lgkmcnt(0)
    v_cmp_ne_u32 vcc, v29, v37
    s_cbranch_vccz L_fk12
    s_add_u32 s79, s79, 1
    s_cmp_lt_u32 s79, 32768
    s_cbranch_scc1 L_fw11
L_fk12:
    ds_write_b128 v18, v[192:195] offset:0
    ds_write_b128 v18, v[196:199] offset:4096
    ds_write_b128 v18, v[200:203] offset:8192
    ds_write_b128 v18, v[204:207] offset:12288
    ds_write_b128 v18, v[208:211] offset:16384
    ds_write_b128 v18, v[212:215] offset:20480
    ds_write_b128 v18, v[216:219] offset:24576
    ds_write_b128 v18, v[220:223] offset:28672
    s_waitcnt vmcnt(0)
    ds_write_b128 v18, v[224:227] offset:32768
    ds_write_b128 v18, v[228:231] offset:36864
    ds_write_b128 v18, v[232:235] offset:40960
    ds_write_b128 v18, v[236:239] offset:45056
    ds_write_b128 v18, v[240:243] offset:49152
    ds_write_b128 v18, v[244:247] offset:53248
    ds_write_b128 v18, v[248:251] offset:57344
    ds_write_b128 v18, v[252:255] offset:61440
L_fw13:
    ds_read_b32 v29, v36 offset:176
    s_waitcnt lgkmcnt(0)
    v_cmp_ne_u32 vcc, v29, v37
    s_cbranch_vccz L_fk14
    s_add_u32 s79, s79, 1
    s_cmp_lt_u32 s79, 32768
    s_cbranch_scc1 L_fw13
L_fk14:
    v_min_u32 v26, 6, v20
    v_mul_u32_u24 v27, 28672, v19
    v_lshl_add_u32 v26, v26, 4, v27
    s_lshl_b32 s75, s73, 2
    s_add_u32 s75, s75, 4489216
    s_add_u32 s76, s75, 14336
    buffer_load_dwordx4 v[72:75], v26, s[32:35], s75 offen sc1
    buffer_load_dwordx4 v[76:79], v26, s[32:35], s76 offen sc1
    s_lshl_b32 s19, s68, 16
    s_add_u32 s19, s19, s69
    buffer_load_dwordx4 v[192:195], v17, s[60:63], s19 offen
    s_add_u32 s68, s68, 1
    s_and_b32 s68, s68, 31
    s_lshl_b32 s19, s68, 16
    s_add_u32 s19, s19, s69
    buffer_load_dwordx4 v[196:199], v17, s[60:63], s19 offen
    s_add_u32 s68, s68, 1
    s_and_b32 s68, s68, 31
    s_lshl_b32 s19, s68, 16
    s_add_u32 s19, s19, s69
    buffer_load_dwordx4 v[200:203], v17, s[60:63], s19 offen
    s_add_u32 s68, s68, 1
    s_and_b32 s68, s68, 31
    s_lshl_b32 s19, s68, 16
    s_add_u32 s19, s19, s69
    buffer_load_dwordx4 v[204:207], v17, s[60:63], s19 offen
    s_add_u32 s68, s68, 1
    s_and_b32 s68, s68, 31
    s_lshl_b32 s19, s68, 16
    s_add_u32 s19, s19, s69
    buffer_load_dwordx4 v[208:211], v17, s[60:63], s19 offen
    s_add_u32 s68, s68, 1
    s_and_b32 s68, s68, 31
    s_lshl_b32 s19, s68, 16
    s_add_u32 s19, s19, s69
    buffer_load_dwordx4 v[212:215], v17, s[60:63], s19 offen
    s_add_u32 s68, s68, 1
    s_and_b32 s68, s68, 31
    s_lshl_b32 s19, s68, 16
    s_add_u32 s19, s19, s69
    buffer_load_dwordx4 v[216:219], v17, s[60:63], s19 offen
    s_add_u32 s68, s68, 1
    s_and_b32 s68, s68, 31
    s_lshl_b32 s19, s68, 16
    s_add_u32 s19, s19, s69
    buffer_load_dwordx4 v[220:223], v17, s[60:63], s19 offen
    s_add_u32 s68, s68, 1
    s_and_b32 s68, s68, 31
    s_lshl_b32 s19, s68, 16
    s_add_u32 s19, s19, s69
    buffer_load_dwordx4 v[224:227], v17, s[60:63], s19 offen
    s_add_u32 s68, s68, 1
    s_and_b32 s68, s68, 31
    s_lshl_b32 s19, s68, 16
    s_add_u32 s19, s19, s69
    buffer_load_dwordx4 v[228:231], v17, s[60:63], s19 offen
    s_add_u32 s68, s68, 1
    s_and_b32 s68, s68, 31
    s_lshl_b32 s19, s68, 16
    s_add_u32 s19, s19, s69
    buffer_load_dwordx4 v[232:235], v17, s[60:63], s19 offen
    s_add_u32 s68, s68, 1
    s_and_b32 s68, s68, 31
    s_lshl_b32 s19, s68, 16
    s_add_u32 s19, s19, s69
    buffer_load_dwordx4 v[236:239], v17, s[60:63], s19 offen
    s_add_u32 s68, s68, 1
    s_and_b32 s68, s68, 31
    s_lshl_b32 s19, s68, 16
    s_add_u32 s19, s19, s69
    buffer_load_dwordx4 v[240:243], v17, s[60:63], s19 offen
    s_add_u32 s68, s68, 1
    s_and_b32 s68, s68, 31
    s_lshl_b32 s19, s68, 16
    s_add_u32 s19, s19, s69
    buffer_load_dwordx4 v[244:247], v17, s[60:63], s19 offen
    s_add_u32 s68, s68, 1
    s_and_b32 s68, s68, 31
    s_lshl_b32 s19, s68, 16
    s_add_u32 s19, s19, s69
    buffer_load_dwordx4 v[248:251], v17, s[60:63], s19 offen
    s_add_u32 s68, s68, 1
    s_and_b32 s68, s68, 31
    s_lshl_b32 s19, s68, 16
    s_add_u32 s19, s19, s69
    buffer_load_dwordx4 v[252:255], v17, s[60:63], s19 offen
    s_add_u32 s68, s68, 1
    s_and_b32 s68, s68, 31
    s_waitcnt vmcnt(8)
L_fw15:
    ds_read_b32 v29, v36 offset:160
    s_waitcnt lgkmcnt(0)
    v_cmp_ne_u32 vcc, v29, v37
    s_cbranch_vccz L_fk16
    s_add_u32 s79, s79, 1
    s_cmp_lt_u32 s79, 32768
    s_cbranch_scc1 L_fw15
L_fk16:
    ds_write_b128 v22, v[192:195] offset:0
    ds_write_b128 v22, v[196:199] offset:4096
    ds_write_b128 v22, v[200:203] offset:8192
    ds_write_b128 v22, v[204:207] offset:12288
    ds_write_b128 v22, v[208:211] offset:16384
    ds_write_b128 v22, v[212:215] offset:20480
    ds_write_b128 v22, v[216:219] offset:24576
    ds_write_b128 v22, v[220:223] offset:28672
    s_waitcnt vmcnt(0)
    ds_write_b128 v22, v[224:227] offset:32768
    ds_write_b128 v22, v[228:231] offset:36864
    ds_write_b128 v22, v[232:235] offset:40960
    ds_write_b128 v22, v[236:239] offset:45056
    ds_write_b128 v22, v[240:243] offset:49152
    ds_write_b128 v22, v[244:247] offset:53248
    ds_write_b128 v22, v[248:251] offset:57344
    ds_write_b128 v22, v[252:255] offset:61440
    s_lshl_b64 exec, 1, s17
    ds_write_b32 v36, v37 offset:208
    s_mov_b64 exec, -1
L_fw17:
    ds_read_b32 v29, v36 offset:192
    s_waitcnt lgkmcnt(0)
    v_cmp_ne_u32 vcc, v29, v37
    s_cbranch_vccz L_fk18
    s_add_u32 s79, s79, 1
    s_cmp_lt_u32 s79, 32768
    s_cbranch_scc1 L_fw17
L_fk18:
    buffer_load_dwordx4 v[164:167], v16, s[56:59], s74 offen nt
    s_add_u32 s74, s74, 8192
    buffer_load_dwordx4 v[168:171], v16, s[56:59], s74 offen nt
    s_add_u32 s74, s74, 8192
    buffer_load_dwordx4 v[172:175], v16, s[56:59], s74 offen nt
    s_add_u32 s74, s74, 8192
    buffer_load_dwordx4 v[176:179], v16, s[56:59], s74 offen nt
    s_add_u32 s74, s74, 8192
    buffer_load_dwordx4 v[180:183], v16, s[56:59], s74 offen nt
    s_add_u32 s74, s74, 8192
    buffer_load_dwordx4 v[184:187], v16, s[56:59], s74 offen nt
    s_add_u32 s74, s74, 8192
    buffer_load_dwordx4 v[188:191], v16, s[56:59], s74 offen nt
    s_add_u32 s74, s74, 8192
    s_waitcnt vmcnt(23)
L_gp19:
    v_xor_b32 v72, s80, v72
    v_xor_b32 v73, s81, v73
    v_xor_b32 v74, s82, v74
    v_xor_b32 v75, s83, v75
    v_xor_b32 v76, s80, v76
    v_xor_b32 v77, s81, v77
    v_xor_b32 v78, s82, v78
    v_xor_b32 v79, s83, v79
    v_or3_b32 v80, v72, v73, v74
    v_or3_b32 v81, v75, v76, v77
    v_or3_b32 v80, v80, v78, v79
    v_or_b32 v80, v80, v81
    v_and_b32 v80, v80, v23
    v_cmp_ne_u32 vcc, 0, v80
    s_cbranch_vccz L_gk20
    buffer_load_dwordx4 v[72:75], v26, s[32:35], s75 offen sc1
    buffer_load_dwordx4 v[76:79], v26, s[32:35], s76 offen sc1
    s_waitcnt vmcnt(0)
    s_add_u32 s79, s79, 1
    s_cmp_lt_u32 s79, 32768
    s_cbranch_scc1 L_gp19
L_gk20:
    s_waitcnt vmcnt(0)
    v_permlane32_swap_b32 v72, v74
    v_permlane32_swap_b32 v73, v75
    v_permlane32_swap_b32 v76, v78
    v_permlane32_swap_b32 v77, v79
    v_add_f32 v72, v72, v74
    v_add_f32 v73, v73, v75
    v_add_f32 v76, v76, v78
    v_add_f32 v77, v77, v79
    v_permlane16_swap_b32 v72, v73
    s_lshl_b32 s19, s17, 9
    v_permlane16_swap_b32 v76, v77
    v_add_f32 v72, v72, v73
    v_add_f32 v76, v76, v77
    s_add_u32 s19, s19, 30720
    v_add_f32_dpp v72, v72, v72 row_ror:8 row_mask:0xf bank_mask:0xf
    v_add_f32_dpp v76, v76, v76 row_ror:8 row_mask:0xf bank_mask:0xf
    v_add_u32 v26, s19, v3
    v_cvt_pk_bf16_f32 v72, v72, v76
    v_and_b32 v76, 0xffff0000, v72
    v_lshlrev_b32 v72, 16, v72
    v_mul_f32 v73, 0xbfb8aa3b, v72
    v_exp_f32 v73, v73
    s_nop 0
    v_add_f32 v73, 1.0, v73
    v_rcp_f32 v73, v73
    s_nop 0
    v_mul_f32 v73, v73, v72
    v_cvt_pk_bf16_f32 v73, v73, v73
    v_lshlrev_b32 v73, 16, v73
    v_mul_f32 v73, v73, v76
    v_cvt_pk_bf16_f32 v27, v73, v73
    s_nop 1
    v_and_b32_dpp v76, v27, v4 row_newbcast:0 row_mask:0xf bank_mask:0xf
    v_and_b32_dpp v77, v27, v5 row_newbcast:0 row_mask:0xf bank_mask:0xf
    v_and_b32_dpp v78, v27, v6 row_newbcast:0 row_mask:0xf bank_mask:0xf
    v_and_b32_dpp v79, v27, v7 row_newbcast:0 row_mask:0xf bank_mask:0xf
    v_and_b32_dpp v80, v27, v4 row_newbcast:1 row_mask:0xf bank_mask:0xf
    v_and_b32_dpp v81, v27, v5 row_newbcast:1 row_mask:0xf bank_mask:0xf
    v_mfma_f32_16x16x32_bf16 v[88:91], v[76:79], v[164:167], 0
    v_and_b32_dpp v82, v27, v6 row_newbcast:1 row_mask:0xf bank_mask:0xf
    v_and_b32_dpp v83, v27, v7 row_newbcast:1 row_mask:0xf bank_mask:0xf
    v_and_b32_dpp v84, v27, v4 row_newbcast:2 row_mask:0xf bank_mask:0xf
    v_and_b32_dpp v85, v27, v5 row_newbcast:2 row_mask:0xf bank_mask:0xf
    v_mfma_f32_16x16x32_bf16 v[88:91], v[80:83], v[168:171], v[88:91]
    v_and_b32_dpp v86, v27, v6 row_newbcast:2 row_mask:0xf bank_mask:0xf
    v_and_b32_dpp v87, v27, v7 row_newbcast:2 row_mask:0xf bank_mask:0xf
    v_and_b32_dpp v92, v27, v4 row_newbcast:3 row_mask:0xf bank_mask:0xf
    v_and_b32_dpp v93, v27, v5 row_newbcast:3 row_mask:0xf bank_mask:0xf
    v_mfma_f32_16x16x32_bf16 v[88:91], v[84:87], v[172:175], v[88:91]
    v_and_b32_dpp v94, v27, v6 row_newbcast:3 row_mask:0xf bank_mask:0xf
    v_and_b32_dpp v95, v27, v7 row_newbcast:3 row_mask:0xf bank_mask:0xf
    v_and_b32_dpp v76, v27, v4 row_newbcast:4 row_mask:0xf bank_mask:0xf
    v_and_b32_dpp v77, v27, v5 row_newbcast:4 row_mask:0xf bank_mask:0xf
    v_mfma_f32_16x16x32_bf16 v[88:91], v[92:95], v[176:179], v[88:91]
    v_and_b32_dpp v78, v27, v6 row_newbcast:4 row_mask:0xf bank_mask:0xf
    v_and_b32_dpp v79, v27, v7 row_newbcast:4 row_mask:0xf bank_mask:0xf
    v_and_b32_dpp v80, v27, v4 row_newbcast:5 row_mask:0xf bank_mask:0xf
    v_and_b32_dpp v81, v27, v5 row_newbcast:5 row_mask:0xf bank_mask:0xf
    v_mfma_f32_16x16x32_bf16 v[88:91], v[76:79], v[180:183], v[88:91]
    v_and_b32_dpp v82, v27, v6 row_newbcast:5 row_mask:0xf bank_mask:0xf
    v_and_b32_dpp v83, v27, v7 row_newbcast:5 row_mask:0xf bank_mask:0xf
    v_and_b32_dpp v84, v27, v4 row_newbcast:6 row_mask:0xf bank_mask:0xf
    v_and_b32_dpp v85, v27, v5 row_newbcast:6 row_mask:0xf bank_mask:0xf
    v_mfma_f32_16x16x32_bf16 v[88:91], v[80:83], v[184:187], v[88:91]
    v_and_b32_dpp v86, v27, v6 row_newbcast:6 row_mask:0xf bank_mask:0xf
    v_and_b32_dpp v87, v27, v7 row_newbcast:6 row_mask:0xf bank_mask:0xf
    s_nop 1
    v_mfma_f32_16x16x32_bf16 v[88:91], v[84:87], v[188:191], v[88:91]
    s_mov_b32 exec_hi, 0
    s_nop 6
    ds_write_b128 v26, v[88:91]
    s_mov_b64 exec, 1
    ds_add_rtn_u32 v29, v13, v28 offset:48
    s_mov_b64 exec, -1
    s_waitcnt lgkmcnt(0)
    v_readfirstlane_b32 s19, v29
    s_nop 1
    s_cmp_lg_u32 s19, 3
    s_cbranch_scc1 L_ys21
    ds_read_b128 v[72:75], v3 offset:30720
    ds_read_b128 v[76:79], v3 offset:31232
    ds_read_b128 v[80:83], v3 offset:31744
    ds_read_b128 v[84:87], v3 offset:32256
    s_waitcnt lgkmcnt(0)
    v_pk_add_f32 v[72:73], v[72:73], v[76:77]
    v_pk_add_f32 v[74:75], v[74:75], v[78:79]
    v_pk_add_f32 v[80:81], v[80:81], v[84:85]
    v_pk_add_f32 v[82:83], v[82:83], v[86:87]
    v_pk_add_f32 v[72:73], v[72:73], v[80:81]
    v_pk_add_f32 v[74:75], v[74:75], v[82:83]
    v_bfi_b32 v72, v23, s80, v72
    v_bfi_b32 v73, v23, s81, v73
    v_bfi_b32 v74, v23, s82, v74
    v_bfi_b32 v75, v23, s83, v75
    v_lshlrev_b32 v26, 5, v8
    v_lshl_add_u32 v26, v9, 4, v26
    s_lshl_b32 s19, s13, 12
    s_lshl_b32 s3, s12, 9
    s_add_u32 s19, s19, s3
    s_add_u32 s19, s19, 4718592
    s_mov_b32 exec_hi, 0
    buffer_store_dwordx4 v[72:75], v26, s[32:35], s19 offen sc1
    s_mov_b64 exec, -1
L_ys21:
    s_and_b32 s19, s12, 1
    s_lshl_b32 s19, s19, 1
    s_bfe_u32 s3, s12, 0x10001
    s_add_u32 s19, s19, s3
    s_lshl_b32 s19, s19, 2
    s_and_b32 s3, s13, 3
    s_add_u32 s19, s19, s3
    s_lshr_b32 s3, s72, 7
    s_xor_b32 s19, s19, s3
    s_or_b32 s19, s19, s17
    s_cmp_lg_u32 s19, 0
    s_cbranch_scc1 L_ldone
    v_lshlrev_b32 v26, 12, v9
    v_lshl_add_u32 v26, v8, 4, v26
    v_lshl_add_u32 v29, v8, 2, v9
    v_lshlrev_b32 v30, 1, v29
    v_lshlrev_b32 v29, 2, v29
    s_lshl_b32 s75, s67, 8
    s_add_u32 s75, s75, 4718592
    s_lshl_b32 s19, s72, 11
    s_lshl_b32 s3, s67, 7
    s_add_u32 s19, s19, s3
    s_lshr_b32 s76, s72, 1
    s_lshl_b32 s76, s76, 3
    s_add_u32 s76, s76, 4472832
    buffer_load_ushort v31, v30, s[24:27], s19 offen
L_yp22:
    buffer_load_dwordx2 v[32:33], v13, s[32:35], s76 offen sc1
    s_mov_b32 s19, s75
    buffer_load_dwordx4 v[100:103], v26, s[32:35], s19 offen sc1
    s_add_u32 s19, s19, 16384
    buffer_load_dwordx4 v[104:107], v26, s[32:35], s19 offen sc1
    s_add_u32 s19, s19, 16384
    buffer_load_dwordx4 v[108:111], v26, s[32:35], s19 offen sc1
    s_add_u32 s19, s19, 16384
    buffer_load_dwordx4 v[112:115], v26, s[32:35], s19 offen sc1
    s_add_u32 s19, s19, 16384
    buffer_load_dwordx4 v[116:119], v26, s[32:35], s19 offen sc1
    s_add_u32 s19, s19, 16384
    buffer_load_dwordx4 v[120:123], v26, s[32:35], s19 offen sc1
    s_add_u32 s19, s19, 16384
    buffer_load_dwordx4 v[124:127], v26, s[32:35], s19 offen sc1
    s_add_u32 s19, s19, 16384
    buffer_load_dwordx4 v[128:131], v26, s[32:35], s19 offen sc1
    s_add_u32 s19, s19, 16384
    s_waitcnt vmcnt(0)
    v_xor_b32 v33, s78, v33
    v_xor_b32 v100, s80, v100
    v_xor_b32 v101, s81, v101
    v_xor_b32 v102, s82, v102
    v_xor_b32 v103, s83, v103
    v_xor_b32 v104, s80, v104
    v_xor_b32 v105, s81, v105
    v_xor_b32 v106, s82, v106
    v_xor_b32 v107, s83, v107
    v_xor_b32 v108, s80, v108
    v_xor_b32 v109, s81, v109
    v_xor_b32 v110, s82, v110
    v_xor_b32 v111, s83, v111
    v_xor_b32 v112, s80, v112
    v_xor_b32 v113, s81, v113
    v_xor_b32 v114, s82, v114
    v_xor_b32 v115, s83, v115
    v_xor_b32 v116, s80, v116
    v_xor_b32 v117, s81, v117
    v_xor_b32 v118, s82, v118
    v_xor_b32 v119, s83, v119
    v_xor_b32 v120, s80, v120
    v_xor_b32 v121, s81, v121
    v_xor_b32 v122, s82, v122
    v_xor_b32 v123, s83, v123
    v_xor_b32 v124, s80, v124
    v_xor_b32 v125, s81, v125
    v_xor_b32 v126, s82, v126
    v_xor_b32 v127, s83, v127
    v_xor_b32 v128, s80, v128
    v_xor_b32 v129, s81, v129
    v_xor_b32 v130, s82, v130
    v_xor_b32 v131, s83, v131
    v_or_b32 v34, v100, v101
    v_or3_b32 v34, v34, v102, v103
    v_or3_b32 v34, v34, v104, v105
    v_or3_b32 v34, v34, v106, v107
    v_or3_b32 v34, v34, v108, v109
    v_or3_b32 v34, v34, v110, v111
    v_or3_b32 v34, v34, v112, v113
    v_or3_b32 v34, v34, v114, v115
    v_or3_b32 v34, v34, v116, v117
    v_or3_b32 v34, v34, v118, v119
    v_or3_b32 v34, v34, v120, v121
    v_or3_b32 v34, v34, v122, v123
    v_or3_b32 v34, v34, v124, v125
    v_or3_b32 v34, v34, v126, v127
    v_or3_b32 v34, v34, v128, v129
    v_or3_b32 v34, v34, v130, v131
    v_and_b32 v34, v34, v23
    v_or_b32 v34, v34, v33
    v_cmp_ne_u32 vcc, 0, v34
    s_cbranch_vccz L_yk23
    s_add_u32 s79, s79, 1
    s_cmp_lt_u32 s79, 32768
    s_cbranch_scc1 L_yp22
L_yk23:
    v_pk_add_f32 v[100:101], v[100:101], v[116:117]
    v_pk_add_f32 v[102:103], v[102:103], v[118:119]
    v_pk_add_f32 v[104:105], v[104:105], v[120:121]
    v_pk_add_f32 v[106:107], v[106:107], v[122:123]
    v_pk_add_f32 v[108:109], v[108:109], v[124:125]
    v_pk_add_f32 v[110:111], v[110:111], v[126:127]
    v_pk_add_f32 v[112:113], v[112:113], v[128:129]
    v_pk_add_f32 v[114:115], v[114:115], v[130:131]
    v_pk_add_f32 v[100:101], v[100:101], v[108:109]
    v_pk_add_f32 v[102:103], v[102:103], v[110:111]
    v_pk_add_f32 v[104:105], v[104:105], v[112:113]
    v_pk_add_f32 v[106:107], v[106:107], v[114:115]
    v_pk_add_f32 v[100:101], v[100:101], v[104:105]
    v_pk_add_f32 v[102:103], v[102:103], v[106:107]
    s_nop 1
    v_permlane32_swap_b32 v100, v102
    v_permlane32_swap_b32 v101, v103
    v_add_f32 v100, v100, v102
    v_add_f32 v101, v101, v103
    s_nop 1
    v_permlane16_swap_b32 v100, v101
    v_add_f32 v100, v100, v101
    s_lshr_b32 s19, s71, 11
    s_lshl_b32 s19, s19, 16
    s_not_b32 s3, s19
    s_ashr_i32 s3, s3, 31
    s_or_b32 s3, s3, 0x80000000
    s_xor_b32 s19, s19, s3
    s_and_b32 s19, s19, 0xffff0000
    v_mov_b32 v34, s19
    v_mul_f32 v34, 0xbfb8aa3b, v34
    v_exp_f32 v34, v34
    s_nop 0
    v_add_f32 v34, 1.0, v34
    v_rcp_f32 v34, v34
    s_nop 0
    v_cvt_pk_bf16_f32 v34, v34, v100
    v_and_b32 v35, 0xffff0000, v34
    v_lshlrev_b32 v34, 16, v34
    v_mul_f32 v34, v34, v35
    v_cvt_pk_bf16_f32 v34, v34, v34
    v_lshlrev_b32 v34, 16, v34
    v_lshlrev_b32 v31, 16, v31
    v_add_f32 v34, v34, v31
    s_and_b32 s3, s72, 1
    s_lshl_b32 s3, s3, 4
    v_lshrrev_b32 v32, s3, v32
    v_lshlrev_b32 v32, 16, v32
    v_sub_f32 v32, 1.0, v32
    v_cvt_pk_bf16_f32 v34, v34, v32
    v_and_b32 v35, 0xffff0000, v34
    v_lshlrev_b32 v34, 16, v34
    v_mul_f32 v34, v34, v35
    v_cvt_pk_bf16_f32 v34, v34, v34
    v_lshlrev_b32 v34, 16, v34
    v_mov_b32 v28, 1
    ds_write_b32 v29, v34 offset:512
    ds_write_b32 v13, v37 offset:224
    s_waitcnt lgkmcnt(0)
L_ldone:
    s_endpgm
L_compute:
    s_mov_b64 s[32:33], s[98:99]
    s_mov_b32 s34, 16777216
    s_mov_b32 s35, 0x00020000
    s_mov_b64 s[36:37], s[96:97]
    s_mov_b32 s38, 256
    s_mov_b32 s39, 0x00020000
    s_mov_b64 s[40:41], s[8:9]
    s_mov_b32 s42, 65536
    s_mov_b32 s43, 0x00020000
    s_mov_b64 s[44:45], s[94:95]
    s_mov_b32 s46, 4194304
    s_mov_b32 s47, 0x00020000
    s_mov_b64 s[48:49], s[86:87]
    s_mov_b32 s50, 7340032
    s_mov_b32 s51, 0x00020000
    s_mov_b64 s[52:53], s[88:89]
    s_mov_b32 s54, 7340032
    s_mov_b32 s55, 0x00020000
    s_mov_b64 s[56:57], s[90:91]
    s_mov_b32 s58, 7340032
    s_mov_b32 s59, 0x00020000
    s_mov_b64 s[60:61], s[10:11]
    s_mov_b32 s62, 2097152
    s_mov_b32 s63, 0x00020000
    s_mov_b32 s79, 0
    s_lshr_b32 s17, s16, 1
    s_and_b32 s18, s16, 1
    v_mov_b32 v13, 0
    v_and_b32 v4, 15, v2
    v_lshrrev_b32 v9, 4, v2
    s_or_b32 s19, s2, s16
    s_cmp_lg_u32 s19, 0
    s_cbranch_scc1 L_tp24
    s_memrealtime s[20:21]
    s_waitcnt lgkmcnt(0)
    s_or_b32 s20, s20, 1
    v_mov_b32 v3, s20
    s_mov_b64 exec, 1
    buffer_store_dword v3, v13, s[36:39], 0 offen offset:4 sc1
    s_mov_b64 exec, -1
L_tp24:
    s_lshl_b32 s67, s15, 1
    s_add_u32 s67, s67, s18
    s_lshl_b32 s19, s67, 11
    v_lshlrev_b32 v5, 6, v4
    v_lshl_add_u32 v5, v9, 3, v5
    buffer_load_dwordx2 v[60:61], v5, s[40:43], s19 offen offset:0
    buffer_load_dwordx2 v[62:63], v5, s[40:43], s19 offen offset:32
    buffer_load_dwordx2 v[64:65], v5, s[40:43], s19 offen offset:1024
    buffer_load_dwordx2 v[66:67], v5, s[40:43], s19 offen offset:1056
    s_lshl_b32 s19, s17, 13
    v_lshlrev_b32 v6, 7, v4
    v_add_u32 v6, s19, v6
    v_bfe_u32 v7, v2, 1, 3
    v_add_u32 v8, 0, v9
    v_xor_b32 v8, v8, v7
    v_lshl_add_u32 v20, v8, 4, v6
    v_add_u32 v8, 4, v9
    v_xor_b32 v8, v8, v7
    v_lshl_add_u32 v21, v8, 4, v6
    v_add_u32 v22, 40960, v20
    v_add_u32 v23, 40960, v21
    v_add_u32 v24, 81920, v20
    v_add_u32 v25, 81920, v21
    v_add_u32 v26, 122880, v20
    v_add_u32 v27, 122880, v21
    v_lshlrev_b32 v6, 10, v9
    v_bfe_u32 v7, v2, 2, 2
    v_lshl_add_u32 v6, v7, 7, v6
    v_bfe_u32 v7, v2, 3, 1
    v_xor_b32 v7, s18, v7
    v_lshl_add_u32 v6, v7, 6, v6
    v_bfe_u32 v7, v2, 4, 1
    v_lshl_add_u32 v6, v7, 5, v6
    v_and_b32 v7, 3, v2
    v_lshl_add_u32 v6, v7, 3, v6
    v_add_u32 v36, 16384, v6
    v_xor_b32 v37, 32, v36
    v_add_u32 v38, 57344, v6
    v_xor_b32 v39, 32, v38
    v_add_u32 v40, 98304, v6
    v_xor_b32 v41, 32, v40
    v_add_u32 v42, 139264, v6
    v_xor_b32 v43, 32, v42
    v_lshrrev_b32 v5, 2, v4
    v_and_b32 v6, 1, v4
    v_lshlrev_b32 v6, 4, v6
    v_mov_b32 v7, 0x3f80
    v_lshlrev_b32 v7, v6, v7
    v_cmp_eq_u32 vcc, v5, v9
    s_nop 1
    v_cndmask_b32 v7, 0, v7, vcc
    v_and_b32 v6, 2, v4
    v_cmp_eq_u32 vcc, 0, v6
    s_nop 1
    v_cndmask_b32 v52, 0, v7, vcc
    v_cndmask_b32 v53, v7, v13, vcc
    v_mov_b32 v56, 0x3f803f80
    v_mov_b32 v57, 0x3f803f80
    v_mov_b32 v58, 0x3f803f80
    v_mov_b32 v59, 0x3f803f80
    v_lshlrev_b32 v3, 4, v2
    v_lshlrev_b32 v12, 4, v9
    v_lshrrev_b32 v11, 5, v2
    v_lshlrev_b32 v8, 9, v11
    v_and_b32 v19, 16, v12
    v_add_u32 v8, v8, v19
    v_lshlrev_b32 v11, 2, v11
    v_lshl_add_u32 v11, v4, 4, v11
    v_lshlrev_b32 v9, 10, v9
    v_lshl_add_u32 v9, v4, 4, v9
    v_lshlrev_b32 v10, 3, v2
    s_xor_b32 s3, s16, 2
    s_mul_i32 s19, s3, 6144
    s_add_u32 s19, s19, 2048
    v_add_u32 v4, s19, v3
    s_mul_i32 s19, s16, 6144
    s_add_u32 s19, s19, 2048
    v_add_u32 v5, s19, v3
    v_lshlrev_b32 v7, 2, v2
    s_lshl_b32 s19, s3, 8
    s_add_u32 s19, s19, 1024
    v_add_u32 v6, s19, v7
    s_lshl_b32 s19, s16, 8
    s_add_u32 s19, s19, 1024
    v_add_u32 v7, s19, v7
    v_mov_b32 v15, 0x3ff
    v_mov_b32 v18, 0x7fc17fc1
    s_lshl_b32 s19, s16, 2
    v_mov_b32 v1, s19
    v_mov_b32 v19, -1
    s_lshl_b32 s19, s15, 2
    s_lshr_b32 s3, s14, 2
    s_add_u32 s19, s19, s3
    s_and_b32 s3, s14, 1
    s_bfe_u32 s20, s14, 0x10001
    s_lshl_b32 s20, s20, 3
    s_lshl_b32 s64, s19, 1
    s_add_u32 s64, s64, s3
    s_lshl_b32 s64, s64, 2
    s_add_u32 s64, s64, s16
    s_lshl_b32 s64, s64, 8
    s_add_u32 s64, s64, s20
    s_add_u32 s64, s64, 4325376
    s_lshl_b32 s65, s19, 1
    s_add_u32 s65, s65, s3
    s_lshl_b32 s65, s65, 1
    s_add_u32 s65, s65, s17
    s_lshl_b32 s65, s65, 4
    s_add_u32 s65, s65, s20
    s_lshl_b32 s3, s18, 2
    s_add_u32 s65, s65, s3
    s_add_u32 s65, s65, 4456448
    s_mov_b32 s74, 0x3fb8aa3b
    s_mov_b32 s76, 0xbfb8aa3b
    s_mov_b32 s75, 0
    s_mov_b32 s77, 0
    s_mov_b32 s69, 0
    s_mov_b32 s71, 0
    s_cmp_lg_u32 s17, 0
    s_cselect_b32 s68, s74, s76
    s_cselect_b32 s70, s76, s74
    s_cselect_b64 s[72:73], -1, 0
    s_mov_b32 s66, 0
    v_mov_b32 v160, 0
    v_mov_b32 v161, 0
    v_mov_b32 v162, 0
    v_mov_b32 v163, 0
    v_mov_b32 v164, 0
    v_mov_b32 v165, 0
    v_mov_b32 v166, 0
    v_mov_b32 v167, 0
    v_mov_b32 v168, 0
    v_mov_b32 v169, 0
    v_mov_b32 v170, 0
    v_mov_b32 v171, 0
    v_mov_b32 v172, 0
    v_mov_b32 v173, 0
    v_mov_b32 v174, 0
    v_mov_b32 v175, 0
    v_mov_b32 v176, 0
    v_mov_b32 v177, 0
    v_mov_b32 v178, 0
    v_mov_b32 v179, 0
    v_mov_b32 v180, 0
    v_mov_b32 v181, 0
    v_mov_b32 v182, 0
    v_mov_b32 v183, 0
    v_mov_b32 v184, 0
    v_mov_b32 v185, 0
    v_mov_b32 v186, 0
    v_mov_b32 v187, 0
    v_mov_b32 v188, 0
    v_mov_b32 v189, 0
    v_mov_b32 v190, 0
    v_mov_b32 v191, 0
    v_mov_b32 v192, 0
    v_mov_b32 v193, 0
    v_mov_b32 v194, 0
    v_mov_b32 v195, 0
    v_mov_b32 v196, 0
    v_mov_b32 v197, 0
    v_mov_b32 v198, 0
    v_mov_b32 v199, 0
    v_mov_b32 v200, 0
    v_mov_b32 v201, 0
    v_mov_b32 v202, 0
    v_mov_b32 v203, 0
    v_mov_b32 v204, 0
    v_mov_b32 v205, 0
    v_mov_b32 v206, 0
    v_mov_b32 v207, 0
    v_mov_b32 v208, 0
    v_mov_b32 v209, 0
    v_mov_b32 v210, 0
    v_mov_b32 v211, 0
    v_mov_b32 v212, 0
    v_mov_b32 v213, 0
    v_mov_b32 v214, 0
    v_mov_b32 v215, 0
    v_mov_b32 v216, 0
    v_mov_b32 v217, 0
    v_mov_b32 v218, 0
    v_mov_b32 v219, 0
    v_mov_b32 v220, 0
    v_mov_b32 v221, 0
    v_mov_b32 v222, 0
    v_mov_b32 v223, 0
    v_mov_b32 v224, 0
    v_mov_b32 v225, 0
    v_mov_b32 v226, 0
    v_mov_b32 v227, 0
    v_mov_b32 v228, 0
    v_mov_b32 v229, 0
    v_mov_b32 v230, 0
    v_mov_b32 v231, 0
    v_mov_b32 v232, 0
    v_mov_b32 v233, 0
    v_mov_b32 v234, 0
    v_mov_b32 v235, 0
    v_mov_b32 v236, 0
    v_mov_b32 v237, 0
    v_mov_b32 v238, 0
    v_mov_b32 v239, 0
    v_mov_b32 v240, 0
    v_mov_b32 v241, 0
    v_mov_b32 v242, 0
    v_mov_b32 v243, 0
    v_mov_b32 v244, 0
    v_mov_b32 v245, 0
    v_mov_b32 v246, 0
    v_mov_b32 v247, 0
    v_mov_b32 v248, 0
    v_mov_b32 v249, 0
    v_mov_b32 v250, 0
    v_mov_b32 v251, 0
    v_mov_b32 v252, 0
    v_mov_b32 v253, 0
    v_mov_b32 v254, 0
    v_mov_b32 v255, 0
    s_waitcnt vmcnt(4)
    s_barrier
    ds_read_b128 v[80:83], v20 offset:0
    ds_read_b64_tr_b16 v[96:97], v36 offset:0
    ds_read_b64_tr_b16 v[98:99], v36 offset:512
    ds_read_b128 v[84:87], v20 offset:2048
    ds_read_b128 v[88:91], v20 offset:4096
    ds_read_b128 v[92:95], v20 offset:6144
    ds_read_b64_tr_b16 v[100:101], v37 offset:0
    ds_read_b64_tr_b16 v[102:103], v37 offset:512
    ds_read_b64_tr_b16 v[104:105], v36 offset:8192
    ds_read_b64_tr_b16 v[106:107], v36 offset:8704
    ds_read_b64_tr_b16 v[108:109], v37 offset:8192
    ds_read_b64_tr_b16 v[110:111], v37 offset:8704
    ds_read_b64_tr_b16 v[112:113], v36 offset:16384
    ds_read_b64_tr_b16 v[114:115], v36 offset:16896
    ds_read_b64_tr_b16 v[116:117], v37 offset:16384
    ds_read_b64_tr_b16 v[118:119], v37 offset:16896
    s_mov_b32 exec_lo, 0xffff
    s_mov_b32 exec_hi, 0xffff
    buffer_store_dword v19, v11, s[32:35], s64 offen sc1
    s_lshl_b64 exec, 1, s16
    buffer_store_dword v19, v13, s[32:35], s65 offen sc1
    s_mov_b64 exec, -1
.p2align 6
L_loop:
    s_waitcnt lgkmcnt(10)
    v_mfma_f32_16x16x32_bf16 v[160:163], v[96:99], v[80:83], v[160:163]
    ds_read_b128 v[120:123], v21 offset:0
    v_mfma_f32_16x16x32_bf16 v[164:167], v[96:99], v[84:87], v[164:167]
    ds_read_b64_tr_b16 v[136:137], v36 offset:4096
    v_mfma_f32_16x16x32_bf16 v[168:171], v[96:99], v[88:91], v[168:171]
    ds_read_b64_tr_b16 v[138:139], v36 offset:4608
    v_mfma_f32_16x16x32_bf16 v[172:175], v[96:99], v[92:95], v[172:175]
    s_waitcnt lgkmcnt(11)
    v_mfma_f32_16x16x32_bf16 v[188:191], v[100:103], v[92:95], v[188:191]
    ds_read_b128 v[124:127], v21 offset:2048
    v_mfma_f32_16x16x32_bf16 v[184:187], v[100:103], v[88:91], v[184:187]
    ds_read_b128 v[128:131], v21 offset:4096
    v_mfma_f32_16x16x32_bf16 v[180:183], v[100:103], v[84:87], v[180:183]
    ds_read_b128 v[132:135], v21 offset:6144
    v_mfma_f32_16x16x32_bf16 v[176:179], v[100:103], v[80:83], v[176:179]
    s_waitcnt lgkmcnt(12)
    v_mfma_f32_16x16x32_bf16 v[192:195], v[104:107], v[80:83], v[192:195]
    ds_read_b64_tr_b16 v[140:141], v37 offset:4096
    v_mfma_f32_16x16x32_bf16 v[196:199], v[104:107], v[84:87], v[196:199]
    ds_read_b64_tr_b16 v[142:143], v37 offset:4608
    v_mfma_f32_16x16x32_bf16 v[200:203], v[104:107], v[88:91], v[200:203]
    ds_read_b64_tr_b16 v[144:145], v36 offset:12288
    v_mfma_f32_16x16x32_bf16 v[204:207], v[104:107], v[92:95], v[204:207]
    s_waitcnt lgkmcnt(13)
    v_mfma_f32_16x16x32_bf16 v[220:223], v[108:111], v[92:95], v[220:223]
    ds_read_b64_tr_b16 v[146:147], v36 offset:12800
    v_mfma_f32_16x16x32_bf16 v[216:219], v[108:111], v[88:91], v[216:219]
    ds_read_b64_tr_b16 v[148:149], v37 offset:12288
    v_mfma_f32_16x16x32_bf16 v[212:215], v[108:111], v[84:87], v[212:215]
    ds_read_b64_tr_b16 v[150:151], v37 offset:12800
    v_mfma_f32_16x16x32_bf16 v[208:211], v[108:111], v[80:83], v[208:211]
    s_waitcnt lgkmcnt(14)
    v_mfma_f32_16x16x32_bf16 v[224:227], v[80:83], v[112:115], v[224:227]
    ds_read_b64_tr_b16 v[152:153], v36 offset:20480
    v_mfma_f32_16x16x32_bf16 v[228:231], v[84:87], v[112:115], v[228:231]
    ds_read_b64_tr_b16 v[154:155], v36 offset:20992
    v_mfma_f32_16x16x32_bf16 v[232:235], v[88:91], v[112:115], v[232:235]
    ds_read_b64_tr_b16 v[156:157], v37 offset:20480
    v_mfma_f32_16x16x32_bf16 v[236:239], v[92:95], v[112:115], v[236:239]
    s_waitcnt lgkmcnt(15)
    v_mfma_f32_16x16x32_bf16 v[252:255], v[92:95], v[116:119], v[252:255]
    ds_read_b64_tr_b16 v[158:159], v37 offset:20992
    v_mfma_f32_16x16x32_bf16 v[248:251], v[88:91], v[116:119], v[248:251]
    v_mfma_f32_16x16x32_bf16 v[244:247], v[84:87], v[116:119], v[244:247]
    v_mfma_f32_16x16x32_bf16 v[240:243], v[80:83], v[116:119], v[240:243]
    s_waitcnt lgkmcnt(10)
    v_mfma_f32_16x16x32_bf16 v[160:163], v[136:139], v[120:123], v[160:163]
    v_mfma_f32_16x16x32_bf16 v[164:167], v[136:139], v[124:127], v[164:167]
    v_mfma_f32_16x16x32_bf16 v[168:171], v[136:139], v[128:131], v[168:171]
    v_mfma_f32_16x16x32_bf16 v[172:175], v[136:139], v[132:135], v[172:175]
    s_waitcnt lgkmcnt(0)
    s_barrier
    ds_read_b128 v[80:83], v22 offset:0
    v_mfma_f32_16x16x32_bf16 v[188:191], v[140:143], v[132:135], v[188:191]
    ds_read_b64_tr_b16 v[96:97], v38 offset:0
    v_mfma_f32_16x16x32_bf16 v[184:187], v[140:143], v[128:131], v[184:187]
    ds_read_b64_tr_b16 v[98:99], v38 offset:512
    v_mfma_f32_16x16x32_bf16 v[180:183], v[140:143], v[124:127], v[180:183]
    ds_read_b128 v[84:87], v22 offset:2048
    v_mfma_f32_16x16x32_bf16 v[176:179], v[140:143], v[120:123], v[176:179]
    ds_read_b128 v[88:91], v22 offset:4096
    v_mfma_f32_16x16x32_bf16 v[192:195], v[144:147], v[120:123], v[192:195]
    ds_read_b128 v[92:95], v22 offset:6144
    v_mfma_f32_16x16x32_bf16 v[196:199], v[144:147], v[124:127], v[196:199]
    ds_read_b64_tr_b16 v[100:101], v39 offset:0
    v_mfma_f32_16x16x32_bf16 v[200:203], v[144:147], v[128:131], v[200:203]
    ds_read_b64_tr_b16 v[102:103], v39 offset:512
    v_mfma_f32_16x16x32_bf16 v[204:207], v[144:147], v[132:135], v[204:207]
    ds_read_b64_tr_b16 v[104:105], v38 offset:8192
    v_mfma_f32_16x16x32_bf16 v[220:223], v[148:151], v[132:135], v[220:223]
    ds_read_b64_tr_b16 v[106:107], v38 offset:8704
    v_mfma_f32_16x16x32_bf16 v[216:219], v[148:151], v[128:131], v[216:219]
    ds_read_b64_tr_b16 v[108:109], v39 offset:8192
    v_mfma_f32_16x16x32_bf16 v[212:215], v[148:151], v[124:127], v[212:215]
    ds_read_b64_tr_b16 v[110:111], v39 offset:8704
    v_mfma_f32_16x16x32_bf16 v[208:211], v[148:151], v[120:123], v[208:211]
    ds_read_b64_tr_b16 v[112:113], v38 offset:16384
    v_mfma_f32_16x16x32_bf16 v[224:227], v[120:123], v[152:155], v[224:227]
    ds_read_b64_tr_b16 v[114:115], v38 offset:16896
    v_mfma_f32_16x16x32_bf16 v[228:231], v[124:127], v[152:155], v[228:231]
    ds_read_b64_tr_b16 v[116:117], v39 offset:16384
    v_mfma_f32_16x16x32_bf16 v[232:235], v[128:131], v[152:155], v[232:235]
    ds_read_b64_tr_b16 v[118:119], v39 offset:16896
    v_mfma_f32_16x16x32_bf16 v[236:239], v[132:135], v[152:155], v[236:239]
    v_mfma_f32_16x16x32_bf16 v[252:255], v[132:135], v[156:159], v[252:255]
    v_mfma_f32_16x16x32_bf16 v[248:251], v[128:131], v[156:159], v[248:251]
    v_mfma_f32_16x16x32_bf16 v[244:247], v[124:127], v[156:159], v[244:247]
    v_mfma_f32_16x16x32_bf16 v[240:243], v[120:123], v[156:159], v[240:243]
    s_cmp_eq_u32 s66, 2
    s_cbranch_scc1 L_mid
L_midret:
    s_waitcnt lgkmcnt(10)
    v_mfma_f32_16x16x32_bf16 v[160:163], v[96:99], v[80:83], v[160:163]
    ds_read_b128 v[120:123], v23 offset:0
    v_mfma_f32_16x16x32_bf16 v[164:167], v[96:99], v[84:87], v[164:167]
    ds_read_b64_tr_b16 v[136:137], v38 offset:4096
    v_mfma_f32_16x16x32_bf16 v[168:171], v[96:99], v[88:91], v[168:171]
    ds_read_b64_tr_b16 v[138:139], v38 offset:4608
    v_mfma_f32_16x16x32_bf16 v[172:175], v[96:99], v[92:95], v[172:175]
    s_waitcnt lgkmcnt(11)
    v_mfma_f32_16x16x32_bf16 v[188:191], v[100:103], v[92:95], v[188:191]
    ds_read_b128 v[124:127], v23 offset:2048
    v_mfma_f32_16x16x32_bf16 v[184:187], v[100:103], v[88:91], v[184:187]
    ds_read_b128 v[128:131], v23 offset:4096
    v_mfma_f32_16x16x32_bf16 v[180:183], v[100:103], v[84:87], v[180:183]
    ds_read_b128 v[132:135], v23 offset:6144
    v_mfma_f32_16x16x32_bf16 v[176:179], v[100:103], v[80:83], v[176:179]
    s_waitcnt lgkmcnt(12)
    v_mfma_f32_16x16x32_bf16 v[192:195], v[104:107], v[80:83], v[192:195]
    ds_read_b64_tr_b16 v[140:141], v39 offset:4096
    v_mfma_f32_16x16x32_bf16 v[196:199], v[104:107], v[84:87], v[196:199]
    ds_read_b64_tr_b16 v[142:143], v39 offset:4608
    v_mfma_f32_16x16x32_bf16 v[200:203], v[104:107], v[88:91], v[200:203]
    ds_read_b64_tr_b16 v[144:145], v38 offset:12288
    v_mfma_f32_16x16x32_bf16 v[204:207], v[104:107], v[92:95], v[204:207]
    s_waitcnt lgkmcnt(13)
    v_mfma_f32_16x16x32_bf16 v[220:223], v[108:111], v[92:95], v[220:223]
    ds_read_b64_tr_b16 v[146:147], v38 offset:12800
    v_mfma_f32_16x16x32_bf16 v[216:219], v[108:111], v[88:91], v[216:219]
    ds_read_b64_tr_b16 v[148:149], v39 offset:12288
    v_mfma_f32_16x16x32_bf16 v[212:215], v[108:111], v[84:87], v[212:215]
    ds_read_b64_tr_b16 v[150:151], v39 offset:12800
    v_mfma_f32_16x16x32_bf16 v[208:211], v[108:111], v[80:83], v[208:211]
    s_waitcnt lgkmcnt(14)
    v_mfma_f32_16x16x32_bf16 v[224:227], v[80:83], v[112:115], v[224:227]
    ds_read_b64_tr_b16 v[152:153], v38 offset:20480
    v_mfma_f32_16x16x32_bf16 v[228:231], v[84:87], v[112:115], v[228:231]
    ds_read_b64_tr_b16 v[154:155], v38 offset:20992
    v_mfma_f32_16x16x32_bf16 v[232:235], v[88:91], v[112:115], v[232:235]
    ds_read_b64_tr_b16 v[156:157], v39 offset:20480
    v_mfma_f32_16x16x32_bf16 v[236:239], v[92:95], v[112:115], v[236:239]
    s_waitcnt lgkmcnt(15)
    v_mfma_f32_16x16x32_bf16 v[252:255], v[92:95], v[116:119], v[252:255]
    ds_read_b64_tr_b16 v[158:159], v39 offset:20992
    v_mfma_f32_16x16x32_bf16 v[248:251], v[88:91], v[116:119], v[248:251]
    v_mfma_f32_16x16x32_bf16 v[244:247], v[84:87], v[116:119], v[244:247]
    v_mfma_f32_16x16x32_bf16 v[240:243], v[80:83], v[116:119], v[240:243]
    s_waitcnt lgkmcnt(10)
    v_mfma_f32_16x16x32_bf16 v[160:163], v[136:139], v[120:123], v[160:163]
    v_mfma_f32_16x16x32_bf16 v[164:167], v[136:139], v[124:127], v[164:167]
    v_mfma_f32_16x16x32_bf16 v[168:171], v[136:139], v[128:131], v[168:171]
    v_mfma_f32_16x16x32_bf16 v[172:175], v[136:139], v[132:135], v[172:175]
    s_cmp_eq_u32 s66, 3
    s_waitcnt lgkmcnt(0)
    s_barrier
L_nob:
    ds_read_b128 v[80:83], v24 offset:0
    v_mfma_f32_16x16x32_bf16 v[188:191], v[140:143], v[132:135], v[188:191]
    ds_read_b64_tr_b16 v[96:97], v40 offset:0
    v_mfma_f32_16x16x32_bf16 v[184:187], v[140:143], v[128:131], v[184:187]
    ds_read_b64_tr_b16 v[98:99], v40 offset:512
    v_mfma_f32_16x16x32_bf16 v[180:183], v[140:143], v[124:127], v[180:183]
    ds_read_b128 v[84:87], v24 offset:2048
    v_mfma_f32_16x16x32_bf16 v[176:179], v[140:143], v[120:123], v[176:179]
    ds_read_b128 v[88:91], v24 offset:4096
    v_mfma_f32_16x16x32_bf16 v[192:195], v[144:147], v[120:123], v[192:195]
    ds_read_b128 v[92:95], v24 offset:6144
    v_mfma_f32_16x16x32_bf16 v[196:199], v[144:147], v[124:127], v[196:199]
    ds_read_b64_tr_b16 v[100:101], v41 offset:0
    v_mfma_f32_16x16x32_bf16 v[200:203], v[144:147], v[128:131], v[200:203]
    ds_read_b64_tr_b16 v[102:103], v41 offset:512
    v_mfma_f32_16x16x32_bf16 v[204:207], v[144:147], v[132:135], v[204:207]
    ds_read_b64_tr_b16 v[104:105], v40 offset:8192
    v_mfma_f32_16x16x32_bf16 v[220:223], v[148:151], v[132:135], v[220:223]
    ds_read_b64_tr_b16 v[106:107], v40 offset:8704
    v_mfma_f32_16x16x32_bf16 v[216:219], v[148:151], v[128:131], v[216:219]
    ds_read_b64_tr_b16 v[108:109], v41 offset:8192
    v_mfma_f32_16x16x32_bf16 v[212:215], v[148:151], v[124:127], v[212:215]
    ds_read_b64_tr_b16 v[110:111], v41 offset:8704
    v_mfma_f32_16x16x32_bf16 v[208:211], v[148:151], v[120:123], v[208:211]
    ds_read_b64_tr_b16 v[112:113], v40 offset:16384
    v_mfma_f32_16x16x32_bf16 v[224:227], v[120:123], v[152:155], v[224:227]
    ds_read_b64_tr_b16 v[114:115], v40 offset:16896
    v_mfma_f32_16x16x32_bf16 v[228:231], v[124:127], v[152:155], v[228:231]
    ds_read_b64_tr_b16 v[116:117], v41 offset:16384
    v_mfma_f32_16x16x32_bf16 v[232:235], v[128:131], v[152:155], v[232:235]
    ds_read_b64_tr_b16 v[118:119], v41 offset:16896
    v_mfma_f32_16x16x32_bf16 v[236:239], v[132:135], v[152:155], v[236:239]
    v_mfma_f32_16x16x32_bf16 v[252:255], v[132:135], v[156:159], v[252:255]
    v_mfma_f32_16x16x32_bf16 v[248:251], v[128:131], v[156:159], v[248:251]
    v_mfma_f32_16x16x32_bf16 v[244:247], v[124:127], v[156:159], v[244:247]
    v_mfma_f32_16x16x32_bf16 v[240:243], v[120:123], v[156:159], v[240:243]
    s_waitcnt lgkmcnt(10)
    v_mfma_f32_16x16x32_bf16 v[160:163], v[96:99], v[80:83], v[160:163]
    ds_read_b128 v[120:123], v25 offset:0
    v_mfma_f32_16x16x32_bf16 v[164:167], v[96:99], v[84:87], v[164:167]
    ds_read_b64_tr_b16 v[136:137], v40 offset:4096
    v_mfma_f32_16x16x32_bf16 v[168:171], v[96:99], v[88:91], v[168:171]
    ds_read_b64_tr_b16 v[138:139], v40 offset:4608
    v_mfma_f32_16x16x32_bf16 v[172:175], v[96:99], v[92:95], v[172:175]
    s_waitcnt lgkmcnt(11)
    v_mfma_f32_16x16x32_bf16 v[188:191], v[100:103], v[92:95], v[188:191]
    ds_read_b128 v[124:127], v25 offset:2048
    v_mfma_f32_16x16x32_bf16 v[184:187], v[100:103], v[88:91], v[184:187]
    ds_read_b128 v[128:131], v25 offset:4096
    v_mfma_f32_16x16x32_bf16 v[180:183], v[100:103], v[84:87], v[180:183]
    ds_read_b128 v[132:135], v25 offset:6144
    v_mfma_f32_16x16x32_bf16 v[176:179], v[100:103], v[80:83], v[176:179]
    s_waitcnt lgkmcnt(12)
    v_mfma_f32_16x16x32_bf16 v[192:195], v[104:107], v[80:83], v[192:195]
    ds_read_b64_tr_b16 v[140:141], v41 offset:4096
    v_mfma_f32_16x16x32_bf16 v[196:199], v[104:107], v[84:87], v[196:199]
    ds_read_b64_tr_b16 v[142:143], v41 offset:4608
    v_mfma_f32_16x16x32_bf16 v[200:203], v[104:107], v[88:91], v[200:203]
    ds_read_b64_tr_b16 v[144:145], v40 offset:12288
    v_mfma_f32_16x16x32_bf16 v[204:207], v[104:107], v[92:95], v[204:207]
    s_waitcnt lgkmcnt(13)
    v_mfma_f32_16x16x32_bf16 v[220:223], v[108:111], v[92:95], v[220:223]
    ds_read_b64_tr_b16 v[146:147], v40 offset:12800
    v_mfma_f32_16x16x32_bf16 v[216:219], v[108:111], v[88:91], v[216:219]
    ds_read_b64_tr_b16 v[148:149], v41 offset:12288
    v_mfma_f32_16x16x32_bf16 v[212:215], v[108:111], v[84:87], v[212:215]
    ds_read_b64_tr_b16 v[150:151], v41 offset:12800
    v_mfma_f32_16x16x32_bf16 v[208:211], v[108:111], v[80:83], v[208:211]
    s_waitcnt lgkmcnt(14)
    v_mfma_f32_16x16x32_bf16 v[224:227], v[80:83], v[112:115], v[224:227]
    ds_read_b64_tr_b16 v[152:153], v40 offset:20480
    v_mfma_f32_16x16x32_bf16 v[228:231], v[84:87], v[112:115], v[228:231]
    ds_read_b64_tr_b16 v[154:155], v40 offset:20992
    v_mfma_f32_16x16x32_bf16 v[232:235], v[88:91], v[112:115], v[232:235]
    ds_read_b64_tr_b16 v[156:157], v41 offset:20480
    v_mfma_f32_16x16x32_bf16 v[236:239], v[92:95], v[112:115], v[236:239]
    s_waitcnt lgkmcnt(15)
    v_mfma_f32_16x16x32_bf16 v[252:255], v[92:95], v[116:119], v[252:255]
    ds_read_b64_tr_b16 v[158:159], v41 offset:20992
    v_mfma_f32_16x16x32_bf16 v[248:251], v[88:91], v[116:119], v[248:251]
    v_mfma_f32_16x16x32_bf16 v[244:247], v[84:87], v[116:119], v[244:247]
    v_mfma_f32_16x16x32_bf16 v[240:243], v[80:83], v[116:119], v[240:243]
    s_waitcnt lgkmcnt(10)
    v_mfma_f32_16x16x32_bf16 v[160:163], v[136:139], v[120:123], v[160:163]
    v_mfma_f32_16x16x32_bf16 v[164:167], v[136:139], v[124:127], v[164:167]
    v_mfma_f32_16x16x32_bf16 v[168:171], v[136:139], v[128:131], v[168:171]
    v_mfma_f32_16x16x32_bf16 v[172:175], v[136:139], v[132:135], v[172:175]
    s_cmp_eq_u32 s66, 3
    s_waitcnt lgkmcnt(0)
    s_cbranch_scc1 L_last
    s_barrier
    ds_read_b128 v[80:83], v26 offset:0
    v_mfma_f32_16x16x32_bf16 v[188:191], v[140:143], v[132:135], v[188:191]
    ds_read_b64_tr_b16 v[96:97], v42 offset:0
    v_mfma_f32_16x16x32_bf16 v[184:187], v[140:143], v[128:131], v[184:187]
    ds_read_b64_tr_b16 v[98:99], v42 offset:512
    v_mfma_f32_16x16x32_bf16 v[180:183], v[140:143], v[124:127], v[180:183]
    ds_read_b128 v[84:87], v26 offset:2048
    v_mfma_f32_16x16x32_bf16 v[176:179], v[140:143], v[120:123], v[176:179]
    ds_read_b128 v[88:91], v26 offset:4096
    v_mfma_f32_16x16x32_bf16 v[192:195], v[144:147], v[120:123], v[192:195]
    ds_read_b128 v[92:95], v26 offset:6144
    v_mfma_f32_16x16x32_bf16 v[196:199], v[144:147], v[124:127], v[196:199]
    ds_read_b64_tr_b16 v[100:101], v43 offset:0
    v_mfma_f32_16x16x32_bf16 v[200:203], v[144:147], v[128:131], v[200:203]
    ds_read_b64_tr_b16 v[102:103], v43 offset:512
    v_mfma_f32_16x16x32_bf16 v[204:207], v[144:147], v[132:135], v[204:207]
    ds_read_b64_tr_b16 v[104:105], v42 offset:8192
    v_mfma_f32_16x16x32_bf16 v[220:223], v[148:151], v[132:135], v[220:223]
    ds_read_b64_tr_b16 v[106:107], v42 offset:8704
    v_mfma_f32_16x16x32_bf16 v[216:219], v[148:151], v[128:131], v[216:219]
    ds_read_b64_tr_b16 v[108:109], v43 offset:8192
    v_mfma_f32_16x16x32_bf16 v[212:215], v[148:151], v[124:127], v[212:215]
    ds_read_b64_tr_b16 v[110:111], v43 offset:8704
    v_mfma_f32_16x16x32_bf16 v[208:211], v[148:151], v[120:123], v[208:211]
    ds_read_b64_tr_b16 v[112:113], v42 offset:16384
    v_mfma_f32_16x16x32_bf16 v[224:227], v[120:123], v[152:155], v[224:227]
    ds_read_b64_tr_b16 v[114:115], v42 offset:16896
    v_mfma_f32_16x16x32_bf16 v[228:231], v[124:127], v[152:155], v[228:231]
    ds_read_b64_tr_b16 v[116:117], v43 offset:16384
    v_mfma_f32_16x16x32_bf16 v[232:235], v[128:131], v[152:155], v[232:235]
    ds_read_b64_tr_b16 v[118:119], v43 offset:16896
    v_mfma_f32_16x16x32_bf16 v[236:239], v[132:135], v[152:155], v[236:239]
    v_mfma_f32_16x16x32_bf16 v[252:255], v[132:135], v[156:159], v[252:255]
    v_mfma_f32_16x16x32_bf16 v[248:251], v[128:131], v[156:159], v[248:251]
    v_mfma_f32_16x16x32_bf16 v[244:247], v[124:127], v[156:159], v[244:247]
    v_mfma_f32_16x16x32_bf16 v[240:243], v[120:123], v[156:159], v[240:243]
    s_waitcnt lgkmcnt(10)
    v_mfma_f32_16x16x32_bf16 v[160:163], v[96:99], v[80:83], v[160:163]
    ds_read_b128 v[120:123], v27 offset:0
    v_mfma_f32_16x16x32_bf16 v[164:167], v[96:99], v[84:87], v[164:167]
    ds_read_b64_tr_b16 v[136:137], v42 offset:4096
    v_mfma_f32_16x16x32_bf16 v[168:171], v[96:99], v[88:91], v[168:171]
    ds_read_b64_tr_b16 v[138:139], v42 offset:4608
    v_mfma_f32_16x16x32_bf16 v[172:175], v[96:99], v[92:95], v[172:175]
    s_waitcnt lgkmcnt(11)
    v_mfma_f32_16x16x32_bf16 v[188:191], v[100:103], v[92:95], v[188:191]
    ds_read_b128 v[124:127], v27 offset:2048
    v_mfma_f32_16x16x32_bf16 v[184:187], v[100:103], v[88:91], v[184:187]
    ds_read_b128 v[128:131], v27 offset:4096
    v_mfma_f32_16x16x32_bf16 v[180:183], v[100:103], v[84:87], v[180:183]
    ds_read_b128 v[132:135], v27 offset:6144
    v_mfma_f32_16x16x32_bf16 v[176:179], v[100:103], v[80:83], v[176:179]
    s_waitcnt lgkmcnt(12)
    v_mfma_f32_16x16x32_bf16 v[192:195], v[104:107], v[80:83], v[192:195]
    ds_read_b64_tr_b16 v[140:141], v43 offset:4096
    v_mfma_f32_16x16x32_bf16 v[196:199], v[104:107], v[84:87], v[196:199]
    ds_read_b64_tr_b16 v[142:143], v43 offset:4608
    v_mfma_f32_16x16x32_bf16 v[200:203], v[104:107], v[88:91], v[200:203]
    ds_read_b64_tr_b16 v[144:145], v42 offset:12288
    v_mfma_f32_16x16x32_bf16 v[204:207], v[104:107], v[92:95], v[204:207]
    s_waitcnt lgkmcnt(13)
    v_mfma_f32_16x16x32_bf16 v[220:223], v[108:111], v[92:95], v[220:223]
    ds_read_b64_tr_b16 v[146:147], v42 offset:12800
    v_mfma_f32_16x16x32_bf16 v[216:219], v[108:111], v[88:91], v[216:219]
    ds_read_b64_tr_b16 v[148:149], v43 offset:12288
    v_mfma_f32_16x16x32_bf16 v[212:215], v[108:111], v[84:87], v[212:215]
    ds_read_b64_tr_b16 v[150:151], v43 offset:12800
    v_mfma_f32_16x16x32_bf16 v[208:211], v[108:111], v[80:83], v[208:211]
    s_waitcnt lgkmcnt(14)
    v_mfma_f32_16x16x32_bf16 v[224:227], v[80:83], v[112:115], v[224:227]
    ds_read_b64_tr_b16 v[152:153], v42 offset:20480
    v_mfma_f32_16x16x32_bf16 v[228:231], v[84:87], v[112:115], v[228:231]
    ds_read_b64_tr_b16 v[154:155], v42 offset:20992
    v_mfma_f32_16x16x32_bf16 v[232:235], v[88:91], v[112:115], v[232:235]
    ds_read_b64_tr_b16 v[156:157], v43 offset:20480
    v_mfma_f32_16x16x32_bf16 v[236:239], v[92:95], v[112:115], v[236:239]
    s_waitcnt lgkmcnt(15)
    v_mfma_f32_16x16x32_bf16 v[252:255], v[92:95], v[116:119], v[252:255]
    ds_read_b64_tr_b16 v[158:159], v43 offset:20992
    v_mfma_f32_16x16x32_bf16 v[248:251], v[88:91], v[116:119], v[248:251]
    v_mfma_f32_16x16x32_bf16 v[244:247], v[84:87], v[116:119], v[244:247]
    v_mfma_f32_16x16x32_bf16 v[240:243], v[80:83], v[116:119], v[240:243]
    s_waitcnt lgkmcnt(10)
    v_mfma_f32_16x16x32_bf16 v[160:163], v[136:139], v[120:123], v[160:163]
    v_mfma_f32_16x16x32_bf16 v[164:167], v[136:139], v[124:127], v[164:167]
    v_mfma_f32_16x16x32_bf16 v[168:171], v[136:139], v[128:131], v[168:171]
    v_mfma_f32_16x16x32_bf16 v[172:175], v[136:139], v[132:135], v[172:175]
    s_waitcnt lgkmcnt(0)
    s_barrier
    ds_read_b128 v[80:83], v20 offset:0
    v_mfma_f32_16x16x32_bf16 v[188:191], v[140:143], v[132:135], v[188:191]
    ds_read_b64_tr_b16 v[96:97], v36 offset:0
    v_mfma_f32_16x16x32_bf16 v[184:187], v[140:143], v[128:131], v[184:187]
    ds_read_b64_tr_b16 v[98:99], v36 offset:512
    v_mfma_f32_16x16x32_bf16 v[180:183], v[140:143], v[124:127], v[180:183]
    ds_read_b128 v[84:87], v20 offset:2048
    v_mfma_f32_16x16x32_bf16 v[176:179], v[140:143], v[120:123], v[176:179]
    ds_read_b128 v[88:91], v20 offset:4096
    v_mfma_f32_16x16x32_bf16 v[192:195], v[144:147], v[120:123], v[192:195]
    ds_read_b128 v[92:95], v20 offset:6144
    v_mfma_f32_16x16x32_bf16 v[196:199], v[144:147], v[124:127], v[196:199]
    ds_read_b64_tr_b16 v[100:101], v37 offset:0
    v_mfma_f32_16x16x32_bf16 v[200:203], v[144:147], v[128:131], v[200:203]
    ds_read_b64_tr_b16 v[102:103], v37 offset:512
    v_mfma_f32_16x16x32_bf16 v[204:207], v[144:147], v[132:135], v[204:207]
    ds_read_b64_tr_b16 v[104:105], v36 offset:8192
    v_mfma_f32_16x16x32_bf16 v[220:223], v[148:151], v[132:135], v[220:223]
    ds_read_b64_tr_b16 v[106:107], v36 offset:8704
    v_mfma_f32_16x16x32_bf16 v[216:219], v[148:151], v[128:131], v[216:219]
    ds_read_b64_tr_b16 v[108:109], v37 offset:8192
    v_mfma_f32_16x16x32_bf16 v[212:215], v[148:151], v[124:127], v[212:215]
    ds_read_b64_tr_b16 v[110:111], v37 offset:8704
    v_mfma_f32_16x16x32_bf16 v[208:211], v[148:151], v[120:123], v[208:211]
    ds_read_b64_tr_b16 v[112:113], v36 offset:16384
    v_mfma_f32_16x16x32_bf16 v[224:227], v[120:123], v[152:155], v[224:227]
    ds_read_b64_tr_b16 v[114:115], v36 offset:16896
    v_mfma_f32_16x16x32_bf16 v[228:231], v[124:127], v[152:155], v[228:231]
    ds_read_b64_tr_b16 v[116:117], v37 offset:16384
    v_mfma_f32_16x16x32_bf16 v[232:235], v[128:131], v[152:155], v[232:235]
    ds_read_b64_tr_b16 v[118:119], v37 offset:16896
    v_mfma_f32_16x16x32_bf16 v[236:239], v[132:135], v[152:155], v[236:239]
    v_mfma_f32_16x16x32_bf16 v[252:255], v[132:135], v[156:159], v[252:255]
    v_mfma_f32_16x16x32_bf16 v[248:251], v[128:131], v[156:159], v[248:251]
    v_mfma_f32_16x16x32_bf16 v[244:247], v[124:127], v[156:159], v[244:247]
    v_mfma_f32_16x16x32_bf16 v[240:243], v[120:123], v[156:159], v[240:243]
    s_add_u32 s66, s66, 1
    s_branch L_loop
L_mid:
    s_waitcnt vmcnt(0)
    buffer_load_dword v14, v13, s[36:39], 0 offen offset:4 sc1
    v_mfma_f32_16x16x16_bf16 v[68:71], v[60:61], v[52:53], 0
    v_mfma_f32_16x16x16_bf16 v[72:75], v[62:63], v[52:53], 0
    v_mfma_f32_16x16x16_bf16 v[28:31], v[64:65], v[52:53], 0
    v_mfma_f32_16x16x16_bf16 v[32:35], v[66:67], v[52:53], 0
    s_nop 4
    v_cvt_pk_bf16_f32 v44, v68, v69
    v_cvt_pk_bf16_f32 v45, v70, v71
    v_cvt_pk_bf16_f32 v46, v28, v29
    v_cvt_pk_bf16_f32 v47, v30, v31
    v_cvt_pk_bf16_f32 v48, v72, v73
    v_cvt_pk_bf16_f32 v49, v74, v75
    v_cvt_pk_bf16_f32 v50, v32, v33
    v_cvt_pk_bf16_f32 v51, v34, v35
    s_branch L_midret
L_last:
    s_mov_b64 exec, 1
    ds_write_b32 v1, v18 offset:144
    s_mov_b64 exec, -1
    ds_read_b128 v[80:83], v26 offset:0
    ds_read_b64_tr_b16 v[104:105], v42 offset:8192
    ds_read_b64_tr_b16 v[106:107], v42 offset:8704
    ds_read_b128 v[84:87], v26 offset:2048
    ds_read_b128 v[88:91], v26 offset:4096
    ds_read_b128 v[92:95], v26 offset:6144
    ds_read_b64_tr_b16 v[108:109], v43 offset:8192
    ds_read_b64_tr_b16 v[110:111], v43 offset:8704
    ds_read_b128 v[60:63], v27 offset:0
    ds_read_b64_tr_b16 v[96:97], v42 offset:12288
    ds_read_b64_tr_b16 v[98:99], v42 offset:12800
    ds_read_b128 v[64:67], v27 offset:2048
    ds_read_b128 v[68:71], v27 offset:4096
    ds_read_b128 v[72:75], v27 offset:6144
    ds_read_b64_tr_b16 v[100:101], v43 offset:12288
    ds_read_b64_tr_b16 v[102:103], v43 offset:12800
    v_mfma_f32_16x16x32_bf16 v[192:195], v[144:147], v[120:123], v[192:195]
    s_lshl_b32 s19, s15, 4
    s_lshl_b32 s3, s18, 3
    v_mfma_f32_16x16x32_bf16 v[196:199], v[144:147], v[124:127], v[196:199]
    s_add_u32 s19, s19, s3
    s_lshl_b32 s3, s17, 2
    v_mfma_f32_16x16x32_bf16 v[200:203], v[144:147], v[128:131], v[200:203]
    s_add_u32 s19, s19, s3
    s_lshl_b32 s19, s19, 4
    v_mfma_f32_16x16x32_bf16 v[204:207], v[144:147], v[132:135], v[204:207]
    s_add_u32 s19, s19, s14
    s_lshl_b32 s20, s19, 10
    s_waitcnt lgkmcnt(8)
    ds_read_b64_tr_b16 v[112:113], v42 offset:16384
    ds_read_b64_tr_b16 v[114:115], v42 offset:16896
    ds_read_b64_tr_b16 v[116:117], v43 offset:16384
    ds_read_b64_tr_b16 v[118:119], v43 offset:16896
    v_mfma_f32_16x16x32_bf16 v[220:223], v[148:151], v[132:135], v[220:223]
    ds_read_b64_tr_b16 v[28:29], v42 offset:20480
    ds_read_b64_tr_b16 v[30:31], v42 offset:20992
    v_mfma_f32_16x16x32_bf16 v[216:219], v[148:151], v[128:131], v[216:219]
    ds_read_b64_tr_b16 v[32:33], v43 offset:20480
    ds_read_b64_tr_b16 v[34:35], v43 offset:20992
    v_mfma_f32_16x16x32_bf16 v[212:215], v[148:151], v[124:127], v[212:215]
    s_waitcnt lgkmcnt(8)
    s_lshl_b32 s21, s19, 5
    v_mfma_f32_16x16x32_bf16 v[208:211], v[148:151], v[120:123], v[208:211]
    s_add_u32 s21, s21, 4194304
    v_mfma_f32_16x16x32_bf16 v[192:195], v[104:107], v[80:83], v[192:195]
    v_mfma_f32_16x16x32_bf16 v[196:199], v[104:107], v[84:87], v[196:199]
    v_mfma_f32_16x16x32_bf16 v[200:203], v[104:107], v[88:91], v[200:203]
    v_mfma_f32_16x16x32_bf16 v[204:207], v[104:107], v[92:95], v[204:207]
    v_mfma_f32_16x16x32_bf16 v[220:223], v[108:111], v[92:95], v[220:223]
    s_waitcnt lgkmcnt(0)
    v_mfma_f32_16x16x32_bf16 v[216:219], v[108:111], v[88:91], v[216:219]
    v_mfma_f32_16x16x32_bf16 v[212:215], v[108:111], v[84:87], v[212:215]
    v_mfma_f32_16x16x32_bf16 v[208:211], v[108:111], v[80:83], v[208:211]
    v_mfma_f32_16x16x32_bf16 v[192:195], v[96:99], v[60:63], v[192:195]
    v_mfma_f32_16x16x32_bf16 v[196:199], v[96:99], v[64:67], v[196:199]
    v_mfma_f32_16x16x32_bf16 v[200:203], v[96:99], v[68:71], v[200:203]
    s_nop 5
    v_cvt_pk_bf16_f32 v192, v192, v193
    v_cvt_pk_bf16_f32 v193, v194, v195
    v_mfma_f32_16x16x32_bf16 v[204:207], v[96:99], v[72:75], v[204:207]
    v_cvt_pk_bf16_f32 v196, v196, v197
    v_cvt_pk_bf16_f32 v197, v198, v199
    v_mfma_f32_16x16x32_bf16 v[220:223], v[100:103], v[72:75], v[220:223]
    v_cvt_pk_bf16_f32 v200, v200, v201
    v_cvt_pk_bf16_f32 v201, v202, v203
    v_mfma_f32_16x16x32_bf16 v[216:219], v[100:103], v[68:71], v[216:219]
    s_nop 1
    v_cvt_pk_bf16_f32 v204, v204, v205
    v_cvt_pk_bf16_f32 v205, v206, v207
    v_mfma_f32_16x16x32_bf16 v[212:215], v[100:103], v[64:67], v[212:215]
    v_cvt_pk_bf16_f32 v206, v220, v221
    v_cvt_pk_bf16_f32 v207, v222, v223
    v_mfma_f32_16x16x32_bf16 v[208:211], v[100:103], v[60:63], v[208:211]
    v_cvt_pk_bf16_f32 v202, v216, v217
    v_cvt_pk_bf16_f32 v203, v218, v219
    v_mfma_f32_16x16x32_bf16 v[188:191], v[140:143], v[132:135], v[188:191]
    s_nop 1
    v_cvt_pk_bf16_f32 v198, v212, v213
    v_cvt_pk_bf16_f32 v199, v214, v215
    v_mfma_f32_16x16x32_bf16 v[184:187], v[140:143], v[128:131], v[184:187]
    v_cvt_pk_bf16_f32 v194, v208, v209
    v_cvt_pk_bf16_f32 v195, v210, v211
    v_mfma_f32_16x16x32_bf16 v[180:183], v[140:143], v[124:127], v[180:183]
    v_mfma_f32_16x16x32_bf16 v[176:179], v[140:143], v[120:123], v[176:179]
    v_mfma_f32_16x16x32_bf16 v[96:99], v[44:47], v[192:195], 0
    v_mfma_f32_16x16x32_bf16 v[104:107], v[44:47], v[196:199], 0
    v_mfma_f32_16x16x32_bf16 v[144:147], v[44:47], v[200:203], 0
    s_nop 5
    v_cvt_pk_bf16_f32 v208, v96, v97
    v_cvt_pk_bf16_f32 v209, v98, v99
    v_mfma_f32_16x16x32_bf16 v[136:139], v[44:47], v[204:207], 0
    v_cvt_pk_bf16_f32 v212, v104, v105
    v_cvt_pk_bf16_f32 v213, v106, v107
    v_mfma_f32_16x16x32_bf16 v[100:103], v[48:51], v[192:195], 0
    v_cvt_pk_bf16_f32 v216, v144, v145
    v_cvt_pk_bf16_f32 v217, v146, v147
    v_mfma_f32_16x16x32_bf16 v[108:111], v[48:51], v[196:199], 0
    s_nop 1
    v_cvt_pk_bf16_f32 v220, v136, v137
    v_cvt_pk_bf16_f32 v221, v138, v139
    v_mfma_f32_16x16x32_bf16 v[148:151], v[48:51], v[200:203], 0
    v_cvt_pk_bf16_f32 v210, v100, v101
    v_cvt_pk_bf16_f32 v211, v102, v103
    v_mfma_f32_16x16x32_bf16 v[140:143], v[48:51], v[204:207], 0
    v_cvt_pk_bf16_f32 v214, v108, v109
    v_cvt_pk_bf16_f32 v215, v110, v111
    v_lshlrev_b32 v96, 16, v208
    v_and_b32 v97, 0xffff0000, v208
    s_nop 0
    v_cvt_pk_bf16_f32 v218, v148, v149
    v_cvt_pk_bf16_f32 v219, v150, v151
    v_lshlrev_b32 v98, 16, v209
    v_lshlrev_b32 v104, 16, v212
    v_cvt_pk_bf16_f32 v222, v140, v141
    v_cvt_pk_bf16_f32 v223, v142, v143
    v_and_b32 v105, 0xffff0000, v212
    v_lshlrev_b32 v106, 16, v213
    v_lshlrev_b32 v144, 16, v216
    v_and_b32 v145, 0xffff0000, v216
    v_lshlrev_b32 v146, 16, v217
    v_lshlrev_b32 v136, 16, v220
    v_and_b32 v137, 0xffff0000, v220
    v_lshlrev_b32 v138, 16, v221
    v_and_b32 v99, 0xffff0000, v209
    v_lshlrev_b32 v100, 16, v210
    v_and_b32 v101, 0xffff0000, v210
    v_lshlrev_b32 v102, 16, v211
    v_and_b32 v103, 0xffff0000, v211
    v_and_b32 v107, 0xffff0000, v213
    v_lshlrev_b32 v108, 16, v214
    v_and_b32 v109, 0xffff0000, v214
    v_lshlrev_b32 v110, 16, v215
    v_and_b32 v111, 0xffff0000, v215
    v_and_b32 v147, 0xffff0000, v217
    v_lshlrev_b32 v148, 16, v218
    v_and_b32 v149, 0xffff0000, v218
    v_lshlrev_b32 v150, 16, v219
    v_and_b32 v151, 0xffff0000, v219
    v_and_b32 v139, 0xffff0000, v221
    v_lshlrev_b32 v140, 16, v222
    v_and_b32 v141, 0xffff0000, v222
    v_lshlrev_b32 v142, 16, v223
    v_and_b32 v143, 0xffff0000, v223
    v_max3_f32 v192, v96, v97, v98
    v_min3_f32 v196, v96, v97, v98
    v_max3_f32 v193, v104, v105, v106
    v_min3_f32 v197, v104, v105, v106
    v_max3_f32 v194, v144, v145, v146
    v_min3_f32 v198, v144, v145, v146
    v_max3_f32 v195, v136, v137, v138
    v_min3_f32 v199, v136, v137, v138
    v_max3_f32 v208, v99, v100, v101
    v_max3_f32 v192, v192, v102, v103
    v_min3_f32 v209, v99, v100, v101
    v_min3_f32 v196, v196, v102, v103
    v_max3_f32 v210, v107, v108, v109
    v_max3_f32 v193, v193, v110, v111
    v_min3_f32 v211, v107, v108, v109
    v_min3_f32 v197, v197, v110, v111
    v_max3_f32 v212, v147, v148, v149
    v_max3_f32 v194, v194, v150, v151
    v_min3_f32 v213, v147, v148, v149
    v_min3_f32 v198, v198, v150, v151
    v_max3_f32 v214, v139, v140, v141
    v_max3_f32 v195, v195, v142, v143
    v_min3_f32 v215, v139, v140, v141
    v_min3_f32 v199, v199, v142, v143
    v_max_f32 v192, v192, v208
    v_min_f32 v196, v196, v209
    v_max_f32 v193, v193, v210
    v_min_f32 v197, v197, v211
    v_max_f32 v194, v194, v212
    v_min_f32 v198, v198, v213
    v_max_f32 v195, v195, v214
    v_min_f32 v199, v199, v215
    v_permlane32_swap_b32 v192, v194
    v_permlane32_swap_b32 v193, v195
    v_permlane32_swap_b32 v196, v198
    v_permlane32_swap_b32 v197, v199
    v_max_f32 v192, v192, v194
    v_max_f32 v193, v193, v195
    v_min_f32 v196, v196, v198
    v_min_f32 v197, v197, v199
    v_permlane16_swap_b32 v192, v193
    v_mfma_f32_16x16x32_bf16 v[224:227], v[120:123], v[152:155], v[224:227]
    v_permlane16_swap_b32 v196, v197
    v_max_f32 v192, v192, v193
    v_min_f32 v196, v196, v197
    v_mfma_f32_16x16x32_bf16 v[232:235], v[128:131], v[152:155], v[232:235]
    v_cndmask_b32 v200, v196, v192, s[72:73]
    v_cndmask_b32 v204, v192, v196, s[72:73]
    v_mfma_f32_16x16x32_bf16 v[248:251], v[128:131], v[156:159], v[248:251]
    v_mul_f32 v200, s70, v200
    v_mul_f32 v204, s68, v204
    v_mfma_f32_16x16x32_bf16 v[240:243], v[120:123], v[156:159], v[240:243]
    v_mov_b32 v201, v200
    v_mov_b32 v205, v204
    v_mfma_f32_16x16x32_bf16 v[228:231], v[124:127], v[152:155], v[228:231]
    v_permlane16_swap_b32 v200, v201
    v_permlane16_swap_b32 v204, v205
    v_mfma_f32_16x16x32_bf16 v[236:239], v[132:135], v[152:155], v[236:239]
    v_mov_b32 v202, v200
    v_mov_b32 v203, v201
    v_mfma_f32_16x16x32_bf16 v[252:255], v[132:135], v[156:159], v[252:255]
    v_permlane32_swap_b32 v200, v202
    v_permlane32_swap_b32 v201, v203
    v_mfma_f32_16x16x32_bf16 v[244:247], v[124:127], v[156:159], v[244:247]
    v_mov_b32 v206, v204
    v_mov_b32 v207, v205
    v_mfma_f32_16x16x32_bf16 v[224:227], v[80:83], v[112:115], v[224:227]
    v_permlane32_swap_b32 v204, v206
    v_permlane32_swap_b32 v205, v207
    v_mfma_f32_16x16x32_bf16 v[232:235], v[88:91], v[112:115], v[232:235]
    v_mfma_f32_16x16x32_bf16 v[248:251], v[88:91], v[116:119], v[248:251]
    v_mfma_f32_16x16x32_bf16 v[240:243], v[80:83], v[116:119], v[240:243]
    v_pk_fma_f32 v[88:89], v[104:105], s[68:69], v[200:201] op_sel:[0,0,1] op_sel_hi:[1,0,1]
    v_pk_fma_f32 v[90:91], v[106:107], s[68:69], v[200:201] op_sel:[0,0,1] op_sel_hi:[1,0,1]
    v_mfma_f32_16x16x32_bf16 v[228:231], v[84:87], v[112:115], v[228:231]
    v_pk_fma_f32 v[80:81], v[96:97], s[68:69], v[200:201] op_sel_hi:[1,0,0]
    v_pk_fma_f32 v[82:83], v[98:99], s[68:69], v[200:201] op_sel_hi:[1,0,0]
    v_mfma_f32_16x16x32_bf16 v[236:239], v[92:95], v[112:115], v[236:239]
    v_exp_f32 v80, v80
    v_mfma_f32_16x16x32_bf16 v[252:255], v[92:95], v[116:119], v[252:255]
    v_exp_f32 v81, v81
    v_mfma_f32_16x16x32_bf16 v[244:247], v[84:87], v[116:119], v[244:247]
    v_pk_fma_f32 v[92:93], v[108:109], s[68:69], v[200:201] op_sel:[0,0,1] op_sel_hi:[1,0,1]
    v_exp_f32 v82, v82
    v_mfma_f32_16x16x32_bf16 v[224:227], v[60:63], v[28:31], v[224:227]
    v_pk_fma_f32 v[84:85], v[100:101], s[68:69], v[200:201] op_sel_hi:[1,0,0]
    v_exp_f32 v83, v83
    v_mfma_f32_16x16x32_bf16 v[232:235], v[68:71], v[28:31], v[232:235]
    v_exp_f32 v88, v88
    v_mfma_f32_16x16x32_bf16 v[248:251], v[68:71], v[32:35], v[248:251]
    v_exp_f32 v89, v89
    v_mfma_f32_16x16x32_bf16 v[240:243], v[60:63], v[32:35], v[240:243]
    v_pk_fma_f32 v[68:69], v[136:137], s[68:69], v[202:203] op_sel:[0,0,1] op_sel_hi:[1,0,1]
    v_pk_fma_f32 v[70:71], v[138:139], s[68:69], v[202:203] op_sel:[0,0,1] op_sel_hi:[1,0,1]
    v_mfma_f32_16x16x32_bf16 v[228:231], v[64:67], v[28:31], v[228:231]
    v_pk_fma_f32 v[60:61], v[144:145], s[68:69], v[202:203] op_sel_hi:[1,0,0]
    v_pk_fma_f32 v[62:63], v[146:147], s[68:69], v[202:203] op_sel_hi:[1,0,0]
    v_mfma_f32_16x16x32_bf16 v[236:239], v[72:75], v[28:31], v[236:239]
    v_exp_f32 v90, v90
    v_mfma_f32_16x16x32_bf16 v[252:255], v[72:75], v[32:35], v[252:255]
    v_exp_f32 v91, v91
    v_mfma_f32_16x16x32_bf16 v[244:247], v[64:67], v[32:35], v[244:247]
    v_pk_fma_f32 v[72:73], v[140:141], s[68:69], v[202:203] op_sel:[0,0,1] op_sel_hi:[1,0,1]
    v_exp_f32 v60, v60
    v_pk_fma_f32 v[64:65], v[148:149], s[68:69], v[202:203] op_sel_hi:[1,0,0]
    v_exp_f32 v61, v61
    v_exp_f32 v62, v62
    v_exp_f32 v63, v63
    v_exp_f32 v68, v68
    v_exp_f32 v69, v69
    v_exp_f32 v70, v70
    v_exp_f32 v71, v71
    v_pk_fma_f32 v[86:87], v[102:103], s[68:69], v[200:201] op_sel_hi:[1,0,0]
    v_pk_fma_f32 v[94:95], v[110:111], s[68:69], v[200:201] op_sel:[0,0,1] op_sel_hi:[1,0,1]
    v_pk_fma_f32 v[66:67], v[150:151], s[68:69], v[202:203] op_sel_hi:[1,0,0]
    v_pk_fma_f32 v[74:75], v[142:143], s[68:69], v[202:203] op_sel:[0,0,1] op_sel_hi:[1,0,1]
    v_exp_f32 v84, v84
    v_exp_f32 v85, v85
    v_exp_f32 v92, v92
    v_exp_f32 v93, v93
    v_exp_f32 v64, v64
    v_exp_f32 v65, v65
    v_exp_f32 v72, v72
    v_exp_f32 v73, v73
    v_pk_add_f32 v[208:209], v[80:81], v[82:83]
    v_pk_add_f32 v[210:211], v[88:89], v[90:91]
    v_pk_add_f32 v[212:213], v[60:61], v[62:63]
    v_pk_add_f32 v[214:215], v[68:69], v[70:71]
    v_exp_f32 v86, v86
    v_exp_f32 v87, v87
    v_exp_f32 v94, v94
    v_exp_f32 v95, v95
    v_exp_f32 v66, v66
    v_exp_f32 v67, v67
    v_exp_f32 v74, v74
    v_exp_f32 v75, v75
    v_pk_add_f32 v[208:209], v[208:209], v[84:85]
    v_pk_add_f32 v[210:211], v[210:211], v[92:93]
    v_pk_add_f32 v[212:213], v[212:213], v[64:65]
    v_pk_add_f32 v[214:215], v[214:215], v[72:73]
    v_pk_add_f32 v[208:209], v[208:209], v[86:87]
    v_pk_add_f32 v[210:211], v[210:211], v[94:95]
    v_pk_add_f32 v[212:213], v[212:213], v[66:67]
    v_pk_add_f32 v[214:215], v[214:215], v[74:75]
    v_add_f32 v192, v208, v209
    v_add_f32 v193, v210, v211
    v_add_f32 v194, v212, v213
    v_add_f32 v195, v214, v215
    v_pk_fma_f32 v[96:97], v[96:97], s[70:71], v[204:205] op_sel_hi:[1,0,0]
    v_permlane32_swap_b32 v192, v194
    v_permlane32_swap_b32 v193, v195
    v_add_f32 v192, v192, v194
    v_add_f32 v193, v193, v195
    v_pk_fma_f32 v[98:99], v[98:99], s[70:71], v[204:205] op_sel_hi:[1,0,0]
    v_pk_fma_f32 v[104:105], v[104:105], s[70:71], v[204:205] op_sel:[0,0,1] op_sel_hi:[1,0,1]
    v_permlane16_swap_b32 v192, v193
    v_pk_fma_f32 v[106:107], v[106:107], s[70:71], v[204:205] op_sel:[0,0,1] op_sel_hi:[1,0,1]
    v_add_f32 v192, v192, v193
    v_pk_fma_f32 v[144:145], v[144:145], s[70:71], v[206:207] op_sel_hi:[1,0,0]
    v_rcp_f32 v192, v192
    v_pk_fma_f32 v[146:147], v[146:147], s[70:71], v[206:207] op_sel_hi:[1,0,0]
    v_mov_b32 v193, v192
    v_pk_fma_f32 v[136:137], v[136:137], s[70:71], v[206:207] op_sel:[0,0,1] op_sel_hi:[1,0,1]
    v_pk_fma_f32 v[138:139], v[138:139], s[70:71], v[206:207] op_sel:[0,0,1] op_sel_hi:[1,0,1]
    v_permlane16_swap_b32 v192, v193
    v_pk_fma_f32 v[100:101], v[100:101], s[70:71], v[204:205] op_sel_hi:[1,0,0]
    v_mov_b32 v194, v192
    v_mov_b32 v195, v193
    v_pk_fma_f32 v[108:109], v[108:109], s[70:71], v[204:205] op_sel:[0,0,1] op_sel_hi:[1,0,1]
    v_permlane32_swap_b32 v192, v194
    v_permlane32_swap_b32 v193, v195
    v_pk_fma_f32 v[148:149], v[148:149], s[70:71], v[206:207] op_sel_hi:[1,0,0]
    v_pk_mul_f32 v[80:81], v[80:81], v[192:193] op_sel_hi:[1,0]
    v_pk_mul_f32 v[88:89], v[88:89], v[192:193] op_sel:[0,1] op_sel_hi:[1,1]
    v_pk_mul_f32 v[60:61], v[60:61], v[194:195] op_sel_hi:[1,0]
    v_pk_mul_f32 v[68:69], v[68:69], v[194:195] op_sel:[0,1] op_sel_hi:[1,1]
    v_pk_mul_f32 v[82:83], v[82:83], v[192:193] op_sel_hi:[1,0]
    v_pk_mul_f32 v[90:91], v[90:91], v[192:193] op_sel:[0,1] op_sel_hi:[1,1]
    v_pk_mul_f32 v[62:63], v[62:63], v[194:195] op_sel_hi:[1,0]
    v_pk_mul_f32 v[70:71], v[70:71], v[194:195] op_sel:[0,1] op_sel_hi:[1,1]
    v_pk_mul_f32 v[84:85], v[84:85], v[192:193] op_sel_hi:[1,0]
    v_pk_mul_f32 v[86:87], v[86:87], v[192:193] op_sel_hi:[1,0]
    v_cvt_pk_bf16_f32 v80, v80, v81
    v_pk_mul_f32 v[92:93], v[92:93], v[192:193] op_sel:[0,1] op_sel_hi:[1,1]
    v_pk_mul_f32 v[94:95], v[94:95], v[192:193] op_sel:[0,1] op_sel_hi:[1,1]
    v_cvt_pk_bf16_f32 v88, v88, v89
    v_pk_mul_f32 v[64:65], v[64:65], v[194:195] op_sel_hi:[1,0]
    v_pk_mul_f32 v[66:67], v[66:67], v[194:195] op_sel_hi:[1,0]
    v_cvt_pk_bf16_f32 v60, v60, v61
    v_pk_mul_f32 v[72:73], v[72:73], v[194:195] op_sel:[0,1] op_sel_hi:[1,1]
    v_pk_mul_f32 v[74:75], v[74:75], v[194:195] op_sel:[0,1] op_sel_hi:[1,1]
    v_cvt_pk_bf16_f32 v68, v68, v69
    v_cvt_pk_bf16_f32 v81, v82, v83
    v_cvt_pk_bf16_f32 v89, v90, v91
    v_cvt_pk_bf16_f32 v61, v62, v63
    v_cvt_pk_bf16_f32 v69, v70, v71
    v_cvt_pk_bf16_f32 v82, v84, v85
    v_cvt_pk_bf16_f32 v83, v86, v87
    v_cvt_pk_bf16_f32 v90, v92, v93
    v_cvt_pk_bf16_f32 v91, v94, v95
    v_cvt_pk_bf16_f32 v62, v64, v65
    v_cvt_pk_bf16_f32 v63, v66, v67
    v_cvt_pk_bf16_f32 v70, v72, v73
    v_cvt_pk_bf16_f32 v71, v74, v75
    v_pk_fma_f32 v[140:141], v[140:141], s[70:71], v[206:207] op_sel:[0,0,1] op_sel_hi:[1,0,1]
    v_exp_f32 v96, v96
    v_exp_f32 v97, v97
    v_exp_f32 v98, v98
    v_exp_f32 v99, v99
    v_exp_f32 v104, v104
    v_exp_f32 v105, v105
    v_exp_f32 v106, v106
    v_exp_f32 v107, v107
    v_exp_f32 v144, v144
    v_exp_f32 v145, v145
    v_exp_f32 v146, v146
    v_exp_f32 v147, v147
    v_exp_f32 v136, v136
    v_exp_f32 v137, v137
    v_exp_f32 v138, v138
    v_exp_f32 v139, v139
    v_pk_fma_f32 v[102:103], v[102:103], s[70:71], v[204:205] op_sel_hi:[1,0,0]
    v_pk_fma_f32 v[110:111], v[110:111], s[70:71], v[204:205] op_sel:[0,0,1] op_sel_hi:[1,0,1]
    v_pk_fma_f32 v[150:151], v[150:151], s[70:71], v[206:207] op_sel_hi:[1,0,0]
    v_pk_fma_f32 v[142:143], v[142:143], s[70:71], v[206:207] op_sel:[0,0,1] op_sel_hi:[1,0,1]
    v_exp_f32 v100, v100
    v_exp_f32 v101, v101
    v_exp_f32 v108, v108
    v_exp_f32 v109, v109
    v_exp_f32 v148, v148
    v_exp_f32 v149, v149
    v_exp_f32 v140, v140
    v_exp_f32 v141, v141
    v_pk_add_f32 v[216:217], v[96:97], v[98:99]
    v_pk_add_f32 v[218:219], v[104:105], v[106:107]
    v_pk_add_f32 v[220:221], v[144:145], v[146:147]
    v_pk_add_f32 v[222:223], v[136:137], v[138:139]
    v_exp_f32 v102, v102
    v_exp_f32 v103, v103
    v_exp_f32 v110, v110
    v_exp_f32 v111, v111
    v_exp_f32 v150, v150
    v_exp_f32 v151, v151
    v_exp_f32 v142, v142
    v_exp_f32 v143, v143
    v_pk_add_f32 v[216:217], v[216:217], v[100:101]
    v_pk_add_f32 v[218:219], v[218:219], v[108:109]
    v_pk_add_f32 v[220:221], v[220:221], v[148:149]
    v_pk_add_f32 v[222:223], v[222:223], v[140:141]
    v_pk_add_f32 v[216:217], v[216:217], v[102:103]
    v_pk_add_f32 v[218:219], v[218:219], v[110:111]
    v_pk_add_f32 v[220:221], v[220:221], v[150:151]
    v_pk_add_f32 v[222:223], v[222:223], v[142:143]
    v_add_f32 v196, v216, v217
    v_add_f32 v197, v218, v219
    v_add_f32 v198, v220, v221
    v_add_f32 v199, v222, v223
    v_mfma_f32_16x16x16_bf16 v[120:123], v[80:81], v[52:53], 0
    v_permlane32_swap_b32 v196, v198
    v_permlane32_swap_b32 v197, v199
    v_add_f32 v196, v196, v198
    v_add_f32 v197, v197, v199
    v_mfma_f32_16x16x16_bf16 v[124:127], v[88:89], v[52:53], 0
    s_nop 0
    v_permlane16_swap_b32 v196, v197
    v_cvt_pk_bf16_f32 v224, v224, v225
    v_mfma_f32_16x16x16_bf16 v[128:131], v[60:61], v[52:53], 0
    v_add_f32 v196, v196, v197
    v_cvt_pk_bf16_f32 v120, v120, v121
    v_mfma_f32_16x16x16_bf16 v[132:135], v[68:69], v[52:53], 0
    v_rcp_f32 v196, v196
    v_mfma_f32_16x16x16_bf16 v[112:115], v[82:83], v[52:53], 0
    v_mov_b32 v197, v196
    v_cvt_pk_bf16_f32 v225, v226, v227
    v_mfma_f32_16x16x16_bf16 v[116:119], v[90:91], v[52:53], 0
    v_cvt_pk_bf16_f32 v121, v122, v123
    v_cvt_pk_bf16_f32 v226, v228, v229
    v_mfma_f32_16x16x16_bf16 v[152:155], v[62:63], v[52:53], 0
    v_cvt_pk_bf16_f32 v227, v230, v231
    v_cvt_pk_bf16_f32 v122, v124, v125
    v_mfma_f32_16x16x16_bf16 v[156:159], v[70:71], v[52:53], 0
    v_cvt_pk_bf16_f32 v123, v126, v127
    v_permlane16_swap_b32 v196, v197
    v_cvt_pk_bf16_f32 v240, v240, v241
    v_cvt_pk_bf16_f32 v232, v232, v233
    v_cvt_pk_bf16_f32 v241, v242, v243
    v_cvt_pk_bf16_f32 v128, v128, v129
    v_mov_b32 v198, v196
    v_mov_b32 v199, v197
    v_cvt_pk_bf16_f32 v233, v234, v235
    v_cvt_pk_bf16_f32 v242, v244, v245
    v_cvt_pk_bf16_f32 v243, v246, v247
    v_cvt_pk_bf16_f32 v129, v130, v131
    v_mfma_f32_16x16x32_bf16 v[228:231], v[120:123], v[224:227], 0
    v_cvt_pk_bf16_f32 v234, v236, v237
    v_cvt_pk_bf16_f32 v235, v238, v239
    v_cvt_pk_bf16_f32 v130, v132, v133
    v_cvt_pk_bf16_f32 v131, v134, v135
    v_cvt_pk_bf16_f32 v112, v112, v113
    v_cvt_pk_bf16_f32 v248, v248, v249
    v_cvt_pk_bf16_f32 v113, v114, v115
    v_permlane32_swap_b32 v196, v198
    v_permlane32_swap_b32 v197, v199
    v_cvt_pk_bf16_f32 v249, v250, v251
    v_cvt_pk_bf16_f32 v114, v116, v117
    v_cvt_pk_bf16_f32 v115, v118, v119
    v_mfma_f32_16x16x32_bf16 v[236:239], v[120:123], v[240:243], 0
    v_cvt_pk_bf16_f32 v250, v252, v253
    v_cvt_pk_bf16_f32 v251, v254, v255
    v_mfma_f32_16x16x32_bf16 v[228:231], v[128:131], v[232:235], v[228:231]
    v_pk_mul_f32 v[96:97], v[96:97], v[196:197] op_sel_hi:[1,0]
    v_cvt_pk_bf16_f32 v152, v152, v153
    v_pk_mul_f32 v[98:99], v[98:99], v[196:197] op_sel_hi:[1,0]
    v_cvt_pk_bf16_f32 v153, v154, v155
    v_mfma_f32_16x16x32_bf16 v[244:247], v[112:115], v[224:227], 0
    v_cvt_pk_bf16_f32 v96, v96, v97
    v_pk_mul_f32 v[104:105], v[104:105], v[196:197] op_sel:[0,1] op_sel_hi:[1,1]
    v_cvt_pk_bf16_f32 v154, v156, v157
    v_cvt_pk_bf16_f32 v155, v158, v159
    v_mfma_f32_16x16x32_bf16 v[236:239], v[128:131], v[248:251], v[236:239]
    v_cvt_pk_bf16_f32 v97, v98, v99
    v_pk_mul_f32 v[106:107], v[106:107], v[196:197] op_sel:[0,1] op_sel_hi:[1,1]
    v_cvt_pk_bf16_f32 v104, v104, v105
    v_pk_mul_f32 v[144:145], v[144:145], v[198:199] op_sel_hi:[1,0]
    v_mfma_f32_16x16x32_bf16 v[252:255], v[112:115], v[240:243], 0
    v_cvt_pk_bf16_f32 v105, v106, v107
    v_pk_mul_f32 v[146:147], v[146:147], v[198:199] op_sel_hi:[1,0]
    v_mfma_f32_16x16x32_bf16 v[244:247], v[152:155], v[232:235], v[244:247]
    v_cvt_pk_bf16_f32 v144, v144, v145
    v_pk_mul_f32 v[136:137], v[136:137], v[198:199] op_sel:[0,1] op_sel_hi:[1,1]
    v_mfma_f32_16x16x16_bf16 v[80:83], v[96:97], v[52:53], 0
    v_cvt_pk_bf16_f32 v145, v146, v147
    v_pk_mul_f32 v[138:139], v[138:139], v[198:199] op_sel:[0,1] op_sel_hi:[1,1]
    v_mfma_f32_16x16x32_bf16 v[76:79], v[120:123], v[56:59], 0
    v_cvt_pk_bf16_f32 v136, v136, v137
    v_cvt_pk_bf16_f32 v137, v138, v139
    v_mfma_f32_16x16x16_bf16 v[84:87], v[104:105], v[52:53], 0
    ds_write_b128 v4, v[228:231] offset:0
    v_mfma_f32_16x16x32_bf16 v[252:255], v[152:155], v[248:251], v[252:255]
    v_pk_mul_f32 v[100:101], v[100:101], v[196:197] op_sel_hi:[1,0]
    v_pk_mul_f32 v[102:103], v[102:103], v[196:197] op_sel_hi:[1,0]
    v_mfma_f32_16x16x16_bf16 v[88:91], v[144:145], v[52:53], 0
    ds_write_b128 v4, v[236:239] offset:1024
    v_mfma_f32_16x16x32_bf16 v[20:23], v[112:115], v[56:59], 0
    v_cvt_pk_bf16_f32 v98, v100, v101
    v_cvt_pk_bf16_f32 v99, v102, v103
    v_mfma_f32_16x16x32_bf16 v[76:79], v[128:131], v[56:59], v[76:79]
    v_pk_mul_f32 v[108:109], v[108:109], v[196:197] op_sel:[0,1] op_sel_hi:[1,1]
    v_pk_mul_f32 v[110:111], v[110:111], v[196:197] op_sel:[0,1] op_sel_hi:[1,1]
    v_mfma_f32_16x16x16_bf16 v[92:95], v[136:137], v[52:53], 0
    ds_write_b128 v4, v[244:247] offset:2048
    v_mfma_f32_16x16x32_bf16 v[20:23], v[152:155], v[56:59], v[20:23]
    v_cvt_pk_bf16_f32 v106, v108, v109
    v_cvt_pk_bf16_f32 v107, v110, v111
    v_pk_mul_f32 v[148:149], v[148:149], v[198:199] op_sel_hi:[1,0]
    v_pk_mul_f32 v[150:151], v[150:151], v[198:199] op_sel_hi:[1,0]
    v_cvt_pk_bf16_f32 v80, v80, v81
    v_mfma_f32_16x16x16_bf16 v[60:63], v[98:99], v[52:53], 0
    v_cvt_pk_bf16_f32 v81, v82, v83
    v_cvt_pk_bf16_f32 v146, v148, v149
    v_cvt_pk_bf16_f32 v147, v150, v151
    v_pk_mul_f32 v[140:141], v[140:141], v[198:199] op_sel:[0,1] op_sel_hi:[1,1]
    v_pk_mul_f32 v[142:143], v[142:143], v[198:199] op_sel:[0,1] op_sel_hi:[1,1]
    v_cvt_pk_bf16_f32 v82, v84, v85
    v_cvt_pk_bf16_f32 v83, v86, v87
    ds_write_b128 v4, v[252:255] offset:3072
    v_mfma_f32_16x16x16_bf16 v[64:67], v[106:107], v[52:53], 0
    v_cvt_pk_bf16_f32 v138, v140, v141
    v_cvt_pk_bf16_f32 v139, v142, v143
    v_cvt_pk_bf16_f32 v88, v88, v89
    v_mfma_f32_16x16x16_bf16 v[68:71], v[146:147], v[52:53], 0
    v_cvt_pk_bf16_f32 v89, v90, v91
    ds_write_b128 v4, v[76:79] offset:4096
    v_mfma_f32_16x16x32_bf16 v[192:195], v[80:83], v[224:227], 0
    v_cvt_pk_bf16_f32 v90, v92, v93
    v_cvt_pk_bf16_f32 v91, v94, v95
    v_mfma_f32_16x16x32_bf16 v[196:199], v[80:83], v[240:243], 0
    ds_write_b128 v4, v[20:23] offset:5120
    v_mfma_f32_16x16x32_bf16 v[208:211], v[80:83], v[56:59], 0
    v_cvt_pk_bf16_f32 v60, v60, v61
    ds_write_b32 v6, v18
    v_mfma_f32_16x16x16_bf16 v[72:75], v[138:139], v[52:53], 0
    v_cvt_pk_bf16_f32 v61, v62, v63
    v_cvt_pk_bf16_f32 v62, v64, v65
    v_mfma_f32_16x16x32_bf16 v[192:195], v[88:91], v[232:235], v[192:195]
    v_cvt_pk_bf16_f32 v63, v66, v67
    v_cvt_pk_bf16_f32 v68, v68, v69
    v_mfma_f32_16x16x32_bf16 v[196:199], v[88:91], v[248:251], v[196:199]
    v_cvt_pk_bf16_f32 v69, v70, v71
    s_nop 0
    v_cvt_pk_bf16_f32 v70, v72, v73
    v_mfma_f32_16x16x32_bf16 v[208:211], v[88:91], v[56:59], v[208:211]
    v_cvt_pk_bf16_f32 v71, v74, v75
    ds_read_b32 v19, v7
    ds_read_b128 v[120:123], v5 offset:0
    ds_read_b128 v[124:127], v5 offset:1024
    v_mfma_f32_16x16x32_bf16 v[200:203], v[60:63], v[224:227], 0
    ds_read_b128 v[128:131], v5 offset:2048
    ds_read_b128 v[132:135], v5 offset:3072
    v_mfma_f32_16x16x32_bf16 v[204:207], v[60:63], v[240:243], 0
    ds_read_b128 v[112:115], v5 offset:4096
    ds_read_b128 v[116:119], v5 offset:5120
    v_mfma_f32_16x16x32_bf16 v[212:215], v[60:63], v[56:59], 0
    s_waitcnt vmcnt(0)
    v_readfirstlane_b32 s78, v14
    v_mfma_f32_16x16x32_bf16 v[200:203], v[68:71], v[232:235], v[200:203]
    v_mfma_f32_16x16x32_bf16 v[204:207], v[68:71], v[248:251], v[204:207]
    v_mfma_f32_16x16x32_bf16 v[212:215], v[68:71], v[56:59], v[212:215]
L_tg25:
    s_cmp_lg_u32 s78, 0
    s_cbranch_scc1 L_tk26
    buffer_load_dword v14, v13, s[36:39], 0 offen offset:4 sc1
    s_waitcnt vmcnt(0)
    v_readfirstlane_b32 s78, v14
    s_add_u32 s79, s79, 1
    s_cmp_lt_u32 s79, 32768
    s_cbranch_scc1 L_tg25
L_tk26:
    s_mul_i32 s80, s78, 0x9e3779b1
    s_lshr_b32 s80, s80, 22
    s_mul_i32 s81, s78, 0x85ebca77
    s_lshr_b32 s81, s81, 22
    s_mul_i32 s82, s78, 0xc2b2ae3d
    s_lshr_b32 s82, s82, 22
    s_mul_i32 s83, s78, 0x27d4eb2f
    s_lshr_b32 s83, s83, 22
L_ex27:
    s_waitcnt lgkmcnt(0)
    v_cmp_ne_u32 vcc, v19, v18
    s_cbranch_vccz L_ek28
    ds_read_b32 v19, v7
    ds_read_b128 v[120:123], v5 offset:0
    ds_read_b128 v[124:127], v5 offset:1024
    ds_read_b128 v[128:131], v5 offset:2048
    ds_read_b128 v[132:135], v5 offset:3072
    ds_read_b128 v[112:115], v5 offset:4096
    ds_read_b128 v[116:119], v5 offset:5120
    s_add_u32 s79, s79, 1
    s_cmp_lt_u32 s79, 32768
    s_cbranch_scc1 L_ex27
    s_waitcnt lgkmcnt(0)
L_ek28:
    v_pk_add_f32 v[192:193], v[192:193], v[120:121]
    v_pk_add_f32 v[194:195], v[194:195], v[122:123]
    v_bfi_b32 v192, v15, s80, v192
    v_bfi_b32 v193, v15, s81, v193
    v_bfi_b32 v194, v15, s82, v194
    v_bfi_b32 v195, v15, s83, v195
    v_pk_add_f32 v[196:197], v[196:197], v[124:125]
    v_pk_add_f32 v[198:199], v[198:199], v[126:127]
    v_bfi_b32 v196, v15, s80, v196
    v_bfi_b32 v197, v15, s81, v197
    v_bfi_b32 v198, v15, s82, v198
    v_bfi_b32 v199, v15, s83, v199
    v_pk_add_f32 v[200:201], v[200:201], v[128:129]
    v_pk_add_f32 v[202:203], v[202:203], v[130:131]
    buffer_store_dwordx4 v[192:195], v3, s[32:35], s20 offen sc1
    s_add_u32 s20, s20, 16384
    v_bfi_b32 v200, v15, s80, v200
    v_bfi_b32 v201, v15, s81, v201
    v_bfi_b32 v202, v15, s82, v202
    v_bfi_b32 v203, v15, s83, v203
    v_pk_add_f32 v[204:205], v[204:205], v[132:133]
    v_pk_add_f32 v[206:207], v[206:207], v[134:135]
    buffer_store_dwordx4 v[196:199], v3, s[32:35], s20 offen sc1
    s_add_u32 s20, s20, 16384
    v_bfi_b32 v204, v15, s80, v204
    v_bfi_b32 v205, v15, s81, v205
    v_bfi_b32 v206, v15, s82, v206
    v_bfi_b32 v207, v15, s83, v207
    v_pk_add_f32 v[208:209], v[208:209], v[112:113]
    v_pk_add_f32 v[210:211], v[210:211], v[114:115]
    v_pk_add_f32 v[212:213], v[212:213], v[116:117]
    v_pk_add_f32 v[214:215], v[214:215], v[118:119]
    buffer_store_dwordx4 v[200:203], v3, s[32:35], s20 offen sc1
    s_add_u32 s20, s20, 16384
    v_bfi_b32 v208, v15, s80, v208
    v_bfi_b32 v209, v15, s81, v209
    v_bfi_b32 v210, v15, s82, v210
    v_bfi_b32 v211, v15, s83, v211
    v_bfi_b32 v212, v15, s80, v212
    v_bfi_b32 v213, v15, s81, v213
    v_bfi_b32 v214, v15, s82, v214
    v_bfi_b32 v215, v15, s83, v215
    buffer_store_dwordx4 v[204:207], v3, s[32:35], s20 offen sc1
    s_mov_b32 exec_lo, 0x10001
    s_mov_b32 exec_hi, 0x10001
    buffer_store_dwordx4 v[208:211], v8, s[32:35], s21 offen offset:0 sc1
    buffer_store_dwordx4 v[212:215], v8, s[32:35], s21 offen offset:1024 sc1
    s_mov_b64 exec, -1
    ds_read_b128 v[80:83], v26 offset:0
    ds_read_b64_tr_b16 v[96:97], v42 offset:0
    ds_read_b64_tr_b16 v[98:99], v42 offset:512
    ds_read_b128 v[84:87], v26 offset:2048
    ds_read_b128 v[88:91], v26 offset:4096
    ds_read_b128 v[92:95], v26 offset:6144
    ds_read_b64_tr_b16 v[100:101], v43 offset:0
    ds_read_b64_tr_b16 v[102:103], v43 offset:512
    ds_read_b128 v[60:63], v27 offset:0
    ds_read_b64_tr_b16 v[104:105], v42 offset:4096
    ds_read_b64_tr_b16 v[106:107], v42 offset:4608
    ds_read_b128 v[64:67], v27 offset:2048
    ds_read_b128 v[68:71], v27 offset:4096
    ds_read_b128 v[72:75], v27 offset:6144
    ds_read_b64_tr_b16 v[108:109], v43 offset:4096
    ds_read_b64_tr_b16 v[110:111], v43 offset:4608
    s_mov_b64 exec, 1
    s_lshl_b32 s19, s15, 4
    s_add_u32 s19, s19, s14
    s_lshl_b32 s20, s19, 6
    s_add_u32 s20, s20, s16
    s_lshl_b32 s20, s20, 8
    s_lshl_b32 s21, s19, 9
    s_add_u32 s21, s21, 4194304
    s_waitcnt lgkmcnt(8)
    s_waitcnt lgkmcnt(0)
    ds_write_b32 v1, v18 offset:160
    s_mov_b64 exec, -1
    v_mfma_f32_16x16x32_bf16 v[160:163], v[96:99], v[80:83], v[160:163]
    v_and_b32 v19, 1, v2
    v_mov_b32 v16, s80
    v_mfma_f32_16x16x32_bf16 v[164:167], v[96:99], v[84:87], v[164:167]
    v_cmp_eq_u32 vcc, 0, v19
    v_mov_b32 v17, s81
    v_mfma_f32_16x16x32_bf16 v[168:171], v[96:99], v[88:91], v[168:171]
    v_mov_b32 v54, s82
    v_mov_b32 v55, s83
    v_mfma_f32_16x16x32_bf16 v[172:175], v[96:99], v[92:95], v[172:175]
    v_cndmask_b32 v16, v54, v16, vcc
    v_cndmask_b32 v17, v55, v17, vcc
    v_mfma_f32_16x16x32_bf16 v[188:191], v[100:103], v[92:95], v[188:191]
    v_mfma_f32_16x16x32_bf16 v[184:187], v[100:103], v[88:91], v[184:187]
    v_mfma_f32_16x16x32_bf16 v[180:183], v[100:103], v[84:87], v[180:183]
    v_mfma_f32_16x16x32_bf16 v[176:179], v[100:103], v[80:83], v[176:179]
    v_mfma_f32_16x16x32_bf16 v[160:163], v[104:107], v[60:63], v[160:163]
    v_mfma_f32_16x16x32_bf16 v[164:167], v[104:107], v[64:67], v[164:167]
    v_mfma_f32_16x16x32_bf16 v[168:171], v[104:107], v[68:71], v[168:171]
    s_nop 5
    v_cvt_pk_bf16_f32 v160, v160, v161
    v_cvt_pk_bf16_f32 v161, v162, v163
    v_mfma_f32_16x16x32_bf16 v[172:175], v[104:107], v[72:75], v[172:175]
    v_cvt_pk_bf16_f32 v164, v164, v165
    v_cvt_pk_bf16_f32 v165, v166, v167
    v_mfma_f32_16x16x32_bf16 v[188:191], v[108:111], v[72:75], v[188:191]
    v_cvt_pk_bf16_f32 v168, v168, v169
    v_cvt_pk_bf16_f32 v169, v170, v171
    v_mfma_f32_16x16x32_bf16 v[184:187], v[108:111], v[68:71], v[184:187]
    s_nop 1
    v_cvt_pk_bf16_f32 v172, v172, v173
    v_cvt_pk_bf16_f32 v173, v174, v175
    v_mfma_f32_16x16x32_bf16 v[180:183], v[108:111], v[64:67], v[180:183]
    v_cvt_pk_bf16_f32 v174, v188, v189
    v_cvt_pk_bf16_f32 v175, v190, v191
    v_mfma_f32_16x16x32_bf16 v[176:179], v[108:111], v[60:63], v[176:179]
    v_cvt_pk_bf16_f32 v170, v184, v185
    v_cvt_pk_bf16_f32 v171, v186, v187
    v_mfma_f32_16x16x32_bf16 v[136:139], v[44:47], v[172:175], 0
    s_nop 1
    v_cvt_pk_bf16_f32 v166, v180, v181
    v_cvt_pk_bf16_f32 v167, v182, v183
    v_mfma_f32_16x16x32_bf16 v[128:131], v[44:47], v[168:171], 0
    v_cvt_pk_bf16_f32 v162, v176, v177
    v_cvt_pk_bf16_f32 v163, v178, v179
    v_mfma_f32_16x16x32_bf16 v[120:123], v[44:47], v[164:167], 0
    v_cvt_pk_bf16_f32 v252, v136, v137
    v_cvt_pk_bf16_f32 v253, v138, v139
    v_mfma_f32_16x16x32_bf16 v[112:115], v[44:47], v[160:163], 0
    s_nop 1
    v_cvt_pk_bf16_f32 v248, v128, v129
    v_cvt_pk_bf16_f32 v249, v130, v131
    v_mfma_f32_16x16x32_bf16 v[116:119], v[48:51], v[160:163], 0
    v_cvt_pk_bf16_f32 v244, v120, v121
    v_cvt_pk_bf16_f32 v245, v122, v123
    v_mfma_f32_16x16x32_bf16 v[124:127], v[48:51], v[164:167], 0
    v_cvt_pk_bf16_f32 v240, v112, v113
    v_cvt_pk_bf16_f32 v241, v114, v115
    v_mfma_f32_16x16x32_bf16 v[132:135], v[48:51], v[168:171], 0
    s_nop 1
    v_cvt_pk_bf16_f32 v242, v116, v117
    v_cvt_pk_bf16_f32 v243, v118, v119
    v_mfma_f32_16x16x32_bf16 v[140:143], v[48:51], v[172:175], 0
    v_cvt_pk_bf16_f32 v246, v124, v125
    v_cvt_pk_bf16_f32 v247, v126, v127
    v_lshlrev_b32 v112, 16, v240
    v_and_b32 v113, 0xffff0000, v240
    v_cvt_pk_bf16_f32 v250, v132, v133
    v_cvt_pk_bf16_f32 v251, v134, v135
    v_lshlrev_b32 v114, 16, v241
    v_lshlrev_b32 v120, 16, v244
    v_cvt_pk_bf16_f32 v254, v140, v141
    v_cvt_pk_bf16_f32 v255, v142, v143
    v_and_b32 v121, 0xffff0000, v244
    v_lshlrev_b32 v122, 16, v245
    v_lshlrev_b32 v128, 16, v248
    v_and_b32 v129, 0xffff0000, v248
    v_lshlrev_b32 v130, 16, v249
    v_lshlrev_b32 v136, 16, v252
    v_and_b32 v137, 0xffff0000, v252
    v_lshlrev_b32 v138, 16, v253
    v_and_b32 v115, 0xffff0000, v241
    v_lshlrev_b32 v116, 16, v242
    v_and_b32 v117, 0xffff0000, v242
    v_lshlrev_b32 v118, 16, v243
    v_and_b32 v119, 0xffff0000, v243
    v_and_b32 v123, 0xffff0000, v245
    v_lshlrev_b32 v124, 16, v246
    v_and_b32 v125, 0xffff0000, v246
    v_lshlrev_b32 v126, 16, v247
    v_and_b32 v127, 0xffff0000, v247
    v_and_b32 v131, 0xffff0000, v249
    v_lshlrev_b32 v132, 16, v250
    v_and_b32 v133, 0xffff0000, v250
    v_lshlrev_b32 v134, 16, v251
    v_and_b32 v135, 0xffff0000, v251
    v_and_b32 v139, 0xffff0000, v253
    v_lshlrev_b32 v140, 16, v254
    v_and_b32 v141, 0xffff0000, v254
    v_lshlrev_b32 v142, 16, v255
    v_and_b32 v143, 0xffff0000, v255
    v_max3_f32 v176, v112, v113, v114
    v_min3_f32 v180, v112, v113, v114
    v_max3_f32 v177, v120, v121, v122
    v_min3_f32 v181, v120, v121, v122
    v_max3_f32 v178, v128, v129, v130
    v_min3_f32 v182, v128, v129, v130
    v_max3_f32 v179, v136, v137, v138
    v_min3_f32 v183, v136, v137, v138
    v_max3_f32 v240, v115, v116, v117
    v_max3_f32 v176, v176, v118, v119
    v_min3_f32 v241, v115, v116, v117
    v_min3_f32 v180, v180, v118, v119
    v_max3_f32 v242, v123, v124, v125
    v_max3_f32 v177, v177, v126, v127
    v_min3_f32 v243, v123, v124, v125
    v_min3_f32 v181, v181, v126, v127
    v_max3_f32 v244, v131, v132, v133
    v_max3_f32 v178, v178, v134, v135
    v_min3_f32 v245, v131, v132, v133
    v_min3_f32 v182, v182, v134, v135
    v_max3_f32 v246, v139, v140, v141
    v_max3_f32 v179, v179, v142, v143
    v_min3_f32 v247, v139, v140, v141
    v_min3_f32 v183, v183, v142, v143
    v_max_f32 v176, v176, v240
    v_min_f32 v180, v180, v241
    v_max_f32 v177, v177, v242
    v_min_f32 v181, v181, v243
    v_max_f32 v178, v178, v244
    v_min_f32 v182, v182, v245
    v_max_f32 v179, v179, v246
    v_min_f32 v183, v183, v247
    v_permlane32_swap_b32 v176, v178
    v_permlane32_swap_b32 v177, v179
    v_permlane32_swap_b32 v180, v182
    v_permlane32_swap_b32 v181, v183
    v_max_f32 v176, v176, v178
    v_max_f32 v177, v177, v179
    v_min_f32 v180, v180, v182
    v_min_f32 v181, v181, v183
    v_permlane16_swap_b32 v176, v177
    s_nop 0
    v_permlane16_swap_b32 v180, v181
    v_max_f32 v176, v176, v177
    v_min_f32 v180, v180, v181
    v_mul_f32 v184, s76, v176
    v_mul_f32 v188, s74, v180
    v_mov_b32 v185, v184
    v_mov_b32 v189, v188
    s_nop 0
    v_permlane16_swap_b32 v184, v185
    v_permlane16_swap_b32 v188, v189
    v_mov_b32 v186, v184
    v_mov_b32 v187, v185
    v_mov_b32 v190, v188
    v_mov_b32 v191, v189
    v_permlane32_swap_b32 v184, v186
    v_permlane32_swap_b32 v185, v187
    v_permlane32_swap_b32 v188, v190
    v_permlane32_swap_b32 v189, v191
    s_mov_b32 s19, s20
    buffer_load_dwordx4 v[192:195], v9, s[32:35], s19 offen sc1
    s_add_u32 s19, s19, 4096
    buffer_load_dwordx4 v[196:199], v9, s[32:35], s19 offen sc1
    s_add_u32 s19, s19, 4096
    buffer_load_dwordx4 v[200:203], v9, s[32:35], s19 offen sc1
    s_add_u32 s19, s19, 4096
    buffer_load_dwordx4 v[204:207], v9, s[32:35], s19 offen sc1
    buffer_load_dwordx2 v[208:209], v10, s[32:35], s21 offen sc1
    s_mov_b64 exec, 1
    ds_write_b32 v1, v18 offset:176
    s_mov_b64 exec, -1
    v_pk_fma_f32 v[144:145], v[112:113], s[74:75], v[184:185] op_sel_hi:[1,0,0]
    v_pk_fma_f32 v[146:147], v[114:115], s[74:75], v[184:185] op_sel_hi:[1,0,0]
    v_pk_fma_f32 v[152:153], v[120:121], s[74:75], v[184:185] op_sel:[0,0,1] op_sel_hi:[1,0,1]
    v_pk_fma_f32 v[154:155], v[122:123], s[74:75], v[184:185] op_sel:[0,0,1] op_sel_hi:[1,0,1]
    v_pk_fma_f32 v[224:225], v[128:129], s[74:75], v[186:187] op_sel_hi:[1,0,0]
    v_pk_fma_f32 v[226:227], v[130:131], s[74:75], v[186:187] op_sel_hi:[1,0,0]
    v_pk_fma_f32 v[232:233], v[136:137], s[74:75], v[186:187] op_sel:[0,0,1] op_sel_hi:[1,0,1]
    v_pk_fma_f32 v[234:235], v[138:139], s[74:75], v[186:187] op_sel:[0,0,1] op_sel_hi:[1,0,1]
    v_pk_fma_f32 v[148:149], v[116:117], s[74:75], v[184:185] op_sel_hi:[1,0,0]
    v_pk_fma_f32 v[156:157], v[124:125], s[74:75], v[184:185] op_sel:[0,0,1] op_sel_hi:[1,0,1]
    v_pk_fma_f32 v[228:229], v[132:133], s[74:75], v[186:187] op_sel_hi:[1,0,0]
    v_pk_fma_f32 v[236:237], v[140:141], s[74:75], v[186:187] op_sel:[0,0,1] op_sel_hi:[1,0,1]
    v_exp_f32 v144, v144
    v_exp_f32 v145, v145
    v_exp_f32 v146, v146
    v_exp_f32 v147, v147
    v_exp_f32 v152, v152
    v_exp_f32 v153, v153
    v_exp_f32 v154, v154
    v_exp_f32 v155, v155
    v_exp_f32 v224, v224
    v_exp_f32 v225, v225
    v_exp_f32 v226, v226
    v_exp_f32 v227, v227
    v_exp_f32 v232, v232
    v_exp_f32 v233, v233
    v_exp_f32 v234, v234
    v_exp_f32 v235, v235
    v_pk_fma_f32 v[150:151], v[118:119], s[74:75], v[184:185] op_sel_hi:[1,0,0]
    v_pk_fma_f32 v[158:159], v[126:127], s[74:75], v[184:185] op_sel:[0,0,1] op_sel_hi:[1,0,1]
    v_pk_fma_f32 v[230:231], v[134:135], s[74:75], v[186:187] op_sel_hi:[1,0,0]
    v_pk_fma_f32 v[238:239], v[142:143], s[74:75], v[186:187] op_sel:[0,0,1] op_sel_hi:[1,0,1]
    v_exp_f32 v148, v148
    v_exp_f32 v149, v149
    v_exp_f32 v156, v156
    v_exp_f32 v157, v157
    v_exp_f32 v228, v228
    v_exp_f32 v229, v229
    v_exp_f32 v236, v236
    v_exp_f32 v237, v237
    v_pk_add_f32 v[240:241], v[144:145], v[146:147]
    v_pk_add_f32 v[242:243], v[152:153], v[154:155]
    v_pk_add_f32 v[244:245], v[224:225], v[226:227]
    v_pk_add_f32 v[246:247], v[232:233], v[234:235]
    v_exp_f32 v150, v150
    v_exp_f32 v151, v151
    v_exp_f32 v158, v158
    v_exp_f32 v159, v159
    v_exp_f32 v230, v230
    v_exp_f32 v231, v231
    v_exp_f32 v238, v238
    v_exp_f32 v239, v239
    v_pk_add_f32 v[240:241], v[240:241], v[148:149]
    v_pk_add_f32 v[242:243], v[242:243], v[156:157]
    v_pk_add_f32 v[244:245], v[244:245], v[228:229]
    v_pk_add_f32 v[246:247], v[246:247], v[236:237]
    v_pk_add_f32 v[240:241], v[240:241], v[150:151]
    v_pk_add_f32 v[242:243], v[242:243], v[158:159]
    v_pk_add_f32 v[244:245], v[244:245], v[230:231]
    v_pk_add_f32 v[246:247], v[246:247], v[238:239]
    v_add_f32 v176, v240, v241
    v_add_f32 v177, v242, v243
    v_add_f32 v178, v244, v245
    v_add_f32 v179, v246, v247
    s_nop 0
    v_permlane32_swap_b32 v176, v178
    v_permlane32_swap_b32 v177, v179
    v_add_f32 v176, v176, v178
    v_add_f32 v177, v177, v179
    s_nop 1
    v_permlane16_swap_b32 v176, v177
    v_add_f32 v176, v176, v177
    v_rcp_f32 v176, v176
    s_nop 0
    v_mov_b32 v177, v176
    s_nop 1
    v_permlane16_swap_b32 v176, v177
    v_mov_b32 v178, v176
    v_mov_b32 v179, v177
    s_nop 0
    v_permlane32_swap_b32 v176, v178
    v_permlane32_swap_b32 v177, v179
    v_pk_mul_f32 v[144:145], v[144:145], v[176:177] op_sel_hi:[1,0]
    v_pk_mul_f32 v[152:153], v[152:153], v[176:177] op_sel:[0,1] op_sel_hi:[1,1]
    v_pk_mul_f32 v[224:225], v[224:225], v[178:179] op_sel_hi:[1,0]
    v_pk_mul_f32 v[232:233], v[232:233], v[178:179] op_sel:[0,1] op_sel_hi:[1,1]
    v_pk_mul_f32 v[146:147], v[146:147], v[176:177] op_sel_hi:[1,0]
    v_pk_mul_f32 v[154:155], v[154:155], v[176:177] op_sel:[0,1] op_sel_hi:[1,1]
    v_pk_mul_f32 v[226:227], v[226:227], v[178:179] op_sel_hi:[1,0]
    v_pk_mul_f32 v[234:235], v[234:235], v[178:179] op_sel:[0,1] op_sel_hi:[1,1]
    v_pk_mul_f32 v[148:149], v[148:149], v[176:177] op_sel_hi:[1,0]
    v_pk_mul_f32 v[150:151], v[150:151], v[176:177] op_sel_hi:[1,0]
    v_cvt_pk_bf16_f32 v144, v144, v145
    v_pk_mul_f32 v[156:157], v[156:157], v[176:177] op_sel:[0,1] op_sel_hi:[1,1]
    v_pk_mul_f32 v[158:159], v[158:159], v[176:177] op_sel:[0,1] op_sel_hi:[1,1]
    v_cvt_pk_bf16_f32 v152, v152, v153
    v_pk_mul_f32 v[228:229], v[228:229], v[178:179] op_sel_hi:[1,0]
    v_pk_mul_f32 v[230:231], v[230:231], v[178:179] op_sel_hi:[1,0]
    v_cvt_pk_bf16_f32 v224, v224, v225
    v_pk_mul_f32 v[236:237], v[236:237], v[178:179] op_sel:[0,1] op_sel_hi:[1,1]
    v_pk_mul_f32 v[238:239], v[238:239], v[178:179] op_sel:[0,1] op_sel_hi:[1,1]
    v_cvt_pk_bf16_f32 v232, v232, v233
    v_cvt_pk_bf16_f32 v145, v146, v147
    v_cvt_pk_bf16_f32 v153, v154, v155
    v_cvt_pk_bf16_f32 v225, v226, v227
    v_cvt_pk_bf16_f32 v233, v234, v235
    v_cvt_pk_bf16_f32 v146, v148, v149
    v_cvt_pk_bf16_f32 v147, v150, v151
    v_cvt_pk_bf16_f32 v154, v156, v157
    v_cvt_pk_bf16_f32 v155, v158, v159
    v_cvt_pk_bf16_f32 v226, v228, v229
    v_cvt_pk_bf16_f32 v227, v230, v231
    v_cvt_pk_bf16_f32 v234, v236, v237
    v_cvt_pk_bf16_f32 v235, v238, v239
L_h129:
    s_waitcnt vmcnt(0)
    v_xor_b32 v207, s83, v207
    v_xor_b32 v208, v16, v208
    v_xor_b32 v209, v17, v209
    v_xor_b32 v192, s80, v192
    v_or3_b32 v215, v207, v208, v209
    v_permlane32_swap_b32 v208, v209
    v_xor_b32 v193, s81, v193
    v_add_f32 v208, v208, v209
    v_xor_b32 v194, s82, v194
    v_xor_b32 v195, s83, v195
    v_xor_b32 v196, s80, v196
    v_xor_b32 v197, s81, v197
    v_xor_b32 v198, s82, v198
    v_xor_b32 v199, s83, v199
    v_xor_b32 v200, s80, v200
    v_xor_b32 v201, s81, v201
    v_xor_b32 v202, s82, v202
    v_xor_b32 v203, s83, v203
    v_xor_b32 v204, s80, v204
    v_xor_b32 v205, s81, v205
    v_xor_b32 v206, s82, v206
    v_mov_b32 v209, v208
    v_or3_b32 v210, v192, v193, v194
    v_or3_b32 v213, v195, v196, v197
    v_or3_b32 v211, v198, v199, v200
    v_or3_b32 v214, v201, v202, v203
    v_pk_add_f32 v[192:193], v[192:193], v[196:197]
    v_pk_add_f32 v[200:201], v[200:201], v[204:205]
    v_pk_add_f32 v[194:195], v[194:195], v[198:199]
    v_pk_add_f32 v[202:203], v[202:203], v[206:207]
    v_permlane16_swap_b32 v208, v209
    v_pk_add_f32 v[192:193], v[192:193], v[200:201]
    v_pk_add_f32 v[194:195], v[194:195], v[202:203]
    v_add_f32 v208, v208, v209
    v_or3_b32 v212, v204, v205, v206
    v_permlane32_swap_b32 v192, v194
    v_permlane32_swap_b32 v193, v195
    v_add_f32_dpp v208, v208, v208 row_ror:8 row_mask:0xf bank_mask:0xf
    v_pk_add_f32 v[192:193], v[192:193], v[194:195]
    v_or3_b32 v210, v210, v211, v212
    v_mov_b32 v194, v192
    v_mov_b32 v195, v193
    v_add_f32_dpp v208, v208, v208 row_ror:4 row_mask:0xf bank_mask:0xf
    v_or3_b32 v213, v213, v214, v215
    v_mov_b32 v209, v208
    v_or_b32 v210, v210, v213
    v_permlane16_swap_b32 v192, v194
    v_permlane16_swap_b32 v193, v195
    v_and_b32 v210, v210, v15
    v_pk_add_f32 v[192:193], v[192:193], v[194:195]
    v_permlane32_swap_b32 v208, v209
    v_cmp_ne_u32 vcc, 0, v210
    v_cvt_pk_bf16_f32 v192, v192, v193
    v_cvt_pk_bf16_f32 v208, v208, v209
    s_cbranch_vccz L_h1k30
    s_mov_b32 s19, s20
    buffer_load_dwordx4 v[192:195], v9, s[32:35], s19 offen sc1
    s_add_u32 s19, s19, 4096
    buffer_load_dwordx4 v[196:199], v9, s[32:35], s19 offen sc1
    s_add_u32 s19, s19, 4096
    buffer_load_dwordx4 v[200:203], v9, s[32:35], s19 offen sc1
    s_add_u32 s19, s19, 4096
    buffer_load_dwordx4 v[204:207], v9, s[32:35], s19 offen sc1
    buffer_load_dwordx2 v[208:209], v10, s[32:35], s21 offen sc1
    s_add_u32 s79, s79, 1
    s_cmp_lt_u32 s79, 32768
    s_cbranch_scc1 L_h129
    s_waitcnt vmcnt(0)
L_h1k30:
    s_mov_b32 exec_lo, 0xffff
    s_mov_b32 exec_hi, 0xffff
    buffer_store_dword v192, v11, s[32:35], s64 offen sc1
    s_lshl_b64 exec, 1, s16
    buffer_store_dword v208, v13, s[32:35], s65 offen sc1
    s_mov_b64 exec, -1
    v_pk_fma_f32 v[112:113], v[112:113], s[76:77], v[188:189] op_sel_hi:[1,0,0]
    v_pk_fma_f32 v[114:115], v[114:115], s[76:77], v[188:189] op_sel_hi:[1,0,0]
    v_pk_fma_f32 v[120:121], v[120:121], s[76:77], v[188:189] op_sel:[0,0,1] op_sel_hi:[1,0,1]
    v_pk_fma_f32 v[122:123], v[122:123], s[76:77], v[188:189] op_sel:[0,0,1] op_sel_hi:[1,0,1]
    v_pk_fma_f32 v[128:129], v[128:129], s[76:77], v[190:191] op_sel_hi:[1,0,0]
    v_pk_fma_f32 v[130:131], v[130:131], s[76:77], v[190:191] op_sel_hi:[1,0,0]
    v_pk_fma_f32 v[136:137], v[136:137], s[76:77], v[190:191] op_sel:[0,0,1] op_sel_hi:[1,0,1]
    v_pk_fma_f32 v[138:139], v[138:139], s[76:77], v[190:191] op_sel:[0,0,1] op_sel_hi:[1,0,1]
    v_pk_fma_f32 v[116:117], v[116:117], s[76:77], v[188:189] op_sel_hi:[1,0,0]
    v_pk_fma_f32 v[124:125], v[124:125], s[76:77], v[188:189] op_sel:[0,0,1] op_sel_hi:[1,0,1]
    v_pk_fma_f32 v[132:133], v[132:133], s[76:77], v[190:191] op_sel_hi:[1,0,0]
    v_pk_fma_f32 v[140:141], v[140:141], s[76:77], v[190:191] op_sel:[0,0,1] op_sel_hi:[1,0,1]
    v_exp_f32 v112, v112
    v_exp_f32 v113, v113
    v_exp_f32 v114, v114
    v_exp_f32 v115, v115
    v_exp_f32 v120, v120
    v_exp_f32 v121, v121
    v_exp_f32 v122, v122
    v_exp_f32 v123, v123
    v_exp_f32 v128, v128
    v_exp_f32 v129, v129
    v_exp_f32 v130, v130
    v_exp_f32 v131, v131
    v_exp_f32 v136, v136
    v_exp_f32 v137, v137
    v_exp_f32 v138, v138
    v_exp_f32 v139, v139
    v_pk_fma_f32 v[118:119], v[118:119], s[76:77], v[188:189] op_sel_hi:[1,0,0]
    v_pk_fma_f32 v[126:127], v[126:127], s[76:77], v[188:189] op_sel:[0,0,1] op_sel_hi:[1,0,1]
    v_pk_fma_f32 v[134:135], v[134:135], s[76:77], v[190:191] op_sel_hi:[1,0,0]
    v_pk_fma_f32 v[142:143], v[142:143], s[76:77], v[190:191] op_sel:[0,0,1] op_sel_hi:[1,0,1]
    v_exp_f32 v116, v116
    v_exp_f32 v117, v117
    v_exp_f32 v124, v124
    v_exp_f32 v125, v125
    v_exp_f32 v132, v132
    v_exp_f32 v133, v133
    v_exp_f32 v140, v140
    v_exp_f32 v141, v141
    v_pk_add_f32 v[248:249], v[112:113], v[114:115]
    v_pk_add_f32 v[250:251], v[120:121], v[122:123]
    v_pk_add_f32 v[252:253], v[128:129], v[130:131]
    v_pk_add_f32 v[254:255], v[136:137], v[138:139]
    v_exp_f32 v118, v118
    v_exp_f32 v119, v119
    v_exp_f32 v126, v126
    v_exp_f32 v127, v127
    v_exp_f32 v134, v134
    v_exp_f32 v135, v135
    v_exp_f32 v142, v142
    v_exp_f32 v143, v143
    v_pk_add_f32 v[248:249], v[248:249], v[116:117]
    v_pk_add_f32 v[250:251], v[250:251], v[124:125]
    v_pk_add_f32 v[252:253], v[252:253], v[132:133]
    v_pk_add_f32 v[254:255], v[254:255], v[140:141]
    v_pk_add_f32 v[248:249], v[248:249], v[118:119]
    v_pk_add_f32 v[250:251], v[250:251], v[126:127]
    v_pk_add_f32 v[252:253], v[252:253], v[134:135]
    v_pk_add_f32 v[254:255], v[254:255], v[142:143]
    v_add_f32 v180, v248, v249
    v_add_f32 v181, v250, v251
    v_add_f32 v182, v252, v253
    v_add_f32 v183, v254, v255
    s_and_b32 s19, s12, 1
    s_lshl_b32 s19, s19, 1
    v_permlane32_swap_b32 v180, v182
    v_permlane32_swap_b32 v181, v183
    s_bfe_u32 s3, s12, 0x10001
    s_add_u32 s19, s19, s3
    v_add_f32 v180, v180, v182
    v_add_f32 v181, v181, v183
    s_lshl_b32 s19, s19, 2
    s_and_b32 s3, s13, 3
    s_add_u32 s19, s19, s3
    v_permlane16_swap_b32 v180, v181
    s_lshl_b32 s68, s19, 2
    s_add_u32 s68, s68, s16
    v_add_f32 v180, v180, v181
    s_lshr_b32 s69, s12, 2
    v_and_b32 v19, 15, v2
    s_lshl_b32 s69, s69, 3
    v_rcp_f32 v180, v180
    s_lshr_b32 s3, s13, 2
    v_lshlrev_b32 v26, 11, v19
    v_and_b32 v54, 16, v2
    s_add_u32 s69, s69, s3
    s_lshl_b32 s70, s68, 16
    v_lshl_add_u32 v26, v54, 1, v26
    v_mov_b32 v181, v180
    s_lshl_b32 s3, s69, 7
    v_and_b32 v54, 32, v2
    s_add_u32 s70, s70, s3
    s_lshr_b32 s71, s68, 1
    v_lshrrev_b32 v54, 1, v54
    v_lshrrev_b32 v27, 1, v19
    v_permlane16_swap_b32 v180, v181
    s_lshl_b32 s71, s71, 7
    v_lshrrev_b32 v19, 2, v2
    s_add_u32 s71, s71, 4481024
    v_add_u32 v26, v26, v54
    v_mov_b32 v182, v180
    v_mov_b32 v183, v181
    s_lshl_b32 s72, s68, 7
    v_lshlrev_b32 v20, 7, v19
    v_and_b32 v54, 3, v2
    s_add_u32 s72, s72, 4472832
    s_add_u32 s73, s70, 32768
    v_lshl_add_u32 v20, v54, 3, v20
    v_bfe_u32 v19, v2, 3, 2
    v_permlane32_swap_b32 v180, v182
    v_permlane32_swap_b32 v181, v183
    buffer_load_dwordx4 v[28:31], v26, s[24:27], s70 offen offset:0
    s_lshl_b32 s19, s68, 16
    buffer_load_dwordx4 v[32:35], v26, s[24:27], s70 offen offset:64
    v_lshl_add_u32 v20, v19, 5, v20
    s_add_u32 s19, s19, 8388608
    v_pk_mul_f32 v[112:113], v[112:113], v[180:181] op_sel_hi:[1,0]
    v_pk_mul_f32 v[120:121], v[120:121], v[180:181] op_sel:[0,1] op_sel_hi:[1,1]
    v_pk_mul_f32 v[128:129], v[128:129], v[182:183] op_sel_hi:[1,0]
    v_pk_mul_f32 v[136:137], v[136:137], v[182:183] op_sel:[0,1] op_sel_hi:[1,1]
    v_lshlrev_b32 v27, 3, v27
    buffer_load_dwordx4 v[36:39], v26, s[24:27], s73 offen offset:0
    s_lshl_b32 s20, s67, 12
    v_pk_mul_f32 v[114:115], v[114:115], v[180:181] op_sel_hi:[1,0]
    v_pk_mul_f32 v[122:123], v[122:123], v[180:181] op_sel:[0,1] op_sel_hi:[1,1]
    v_pk_mul_f32 v[130:131], v[130:131], v[182:183] op_sel_hi:[1,0]
    v_pk_mul_f32 v[138:139], v[138:139], v[182:183] op_sel:[0,1] op_sel_hi:[1,1]
    buffer_load_dwordx4 v[40:43], v26, s[24:27], s73 offen offset:64
    v_add_u32 v20, 32768, v20
    v_add_u32 v24, s19, v3
    s_add_u32 s20, s20, 4325376
    v_pk_mul_f32 v[116:117], v[116:117], v[180:181] op_sel_hi:[1,0]
    v_pk_mul_f32 v[118:119], v[118:119], v[180:181] op_sel_hi:[1,0]
    v_cvt_pk_bf16_f32 v112, v112, v113
    v_pk_mul_f32 v[124:125], v[124:125], v[180:181] op_sel:[0,1] op_sel_hi:[1,1]
    v_pk_mul_f32 v[126:127], v[126:127], v[180:181] op_sel:[0,1] op_sel_hi:[1,1]
    v_cvt_pk_bf16_f32 v120, v120, v121
    v_pk_mul_f32 v[132:133], v[132:133], v[182:183] op_sel_hi:[1,0]
    v_pk_mul_f32 v[134:135], v[134:135], v[182:183] op_sel_hi:[1,0]
    v_cvt_pk_bf16_f32 v128, v128, v129
    v_pk_mul_f32 v[140:141], v[140:141], v[182:183] op_sel:[0,1] op_sel_hi:[1,1]
    v_pk_mul_f32 v[142:143], v[142:143], v[182:183] op_sel:[0,1] op_sel_hi:[1,1]
    v_cvt_pk_bf16_f32 v136, v136, v137
    buffer_load_dwordx2 v[76:77], v27, s[32:35], s72 offen offset:0 sc1
    s_lshl_b32 s21, s67, 7
    v_cvt_pk_bf16_f32 v113, v114, v115
    v_cvt_pk_bf16_f32 v121, v122, v123
    v_cvt_pk_bf16_f32 v129, v130, v131
    v_cvt_pk_bf16_f32 v137, v138, v139
    buffer_load_dwordx2 v[78:79], v27, s[32:35], s72 offen offset:64 sc1
    v_xor_b32 v21, 32, v20
    v_xor_b32 v22, 64, v20
    v_xor_b32 v23, 0x60, v20
    v_add_u32 v25, 32768, v24
    s_add_u32 s21, s21, 4456448
    v_cvt_pk_bf16_f32 v114, v116, v117
    v_cvt_pk_bf16_f32 v115, v118, v119
    v_cvt_pk_bf16_f32 v122, v124, v125
    v_cvt_pk_bf16_f32 v123, v126, v127
    v_cvt_pk_bf16_f32 v130, v132, v133
    v_cvt_pk_bf16_f32 v131, v134, v135
    v_cvt_pk_bf16_f32 v138, v140, v141
    v_cvt_pk_bf16_f32 v139, v142, v143
L_h231:
    buffer_load_dwordx4 v[60:63], v3, s[32:35], s20 offen offset:0 sc1
    buffer_load_dwordx4 v[64:67], v3, s[32:35], s20 offen offset:1024 sc1
    buffer_load_dwordx4 v[68:71], v3, s[32:35], s20 offen offset:2048 sc1
    buffer_load_dwordx4 v[72:75], v3, s[32:35], s20 offen offset:3072 sc1
    buffer_load_dwordx4 v[80:83], v12, s[32:35], s21 offen offset:0 sc1
    buffer_load_dwordx4 v[84:87], v12, s[32:35], s21 offen offset:64 sc1
    s_mov_b64 exec, 1
    ds_write_b32 v1, v18 offset:192
    s_mov_b64 exec, -1
    s_waitcnt vmcnt(0)
    v_max3_u32 v88, v60, v61, v62
    v_max3_u32 v89, v63, v64, v65
    v_max3_u32 v90, v66, v67, v68
    v_max3_u32 v91, v69, v70, v71
    v_max3_u32 v92, v72, v73, v74
    v_max3_u32 v93, v75, v80, v81
    v_max3_u32 v94, v82, v83, v84
    v_max3_u32 v95, v85, v86, v87
    v_max3_u32 v88, v88, v89, v90
    v_max3_u32 v91, v91, v92, v93
    v_max3_u32 v88, v88, v94, v95
    v_max_u32 v88, v88, v91
    v_cmp_eq_u32 vcc, -1, v88
    s_cbranch_vccz L_h2k32
    s_add_u32 s79, s79, 1
    s_cmp_lt_u32 s79, 32768
    s_cbranch_scc1 L_h231
L_h2k32:
    v_mfma_f32_16x16x32_bf16 v[160:163], v[80:83], v[144:147], 0
    s_mov_b32 s74, 0x358637bd
    s_lshl_b32 s19, s14, 1
    v_mfma_f32_16x16x32_bf16 v[164:167], v[80:83], v[152:155], 0
    s_add_u32 s19, s19, s17
    s_lshl_b32 s20, s19, 17
    v_mfma_f32_16x16x32_bf16 v[160:163], v[84:87], v[112:115], v[160:163]
    s_lshl_b32 s3, s67, 10
    s_add_u32 s20, s20, s3
    v_mfma_f32_16x16x32_bf16 v[164:167], v[84:87], v[120:123], v[164:167]
    s_add_u32 s20, s20, 8388608
    s_lshl_b32 s21, s19, 5
    v_mfma_f32_16x16x32_bf16 v[168:171], v[80:83], v[224:227], 0
    s_add_u32 s21, s21, s67
    s_lshl_b32 s21, s21, 2
    v_mfma_f32_16x16x32_bf16 v[172:175], v[80:83], v[232:235], 0
    s_nop 1
    v_cvt_pk_bf16_f32 v88, v160, v164
    s_add_u32 s21, s21, 4481024
    v_mfma_f32_16x16x32_bf16 v[168:171], v[84:87], v[128:131], v[168:171]
    v_and_b32 v89, 0xffff0000, v88
    v_lshlrev_b32 v88, 16, v88
    v_mfma_f32_16x16x32_bf16 v[172:175], v[84:87], v[136:139], v[172:175]
    v_pk_add_f32 v[88:89], v[88:89], s[74:75] op_sel_hi:[1,0]
    v_mov_b32 v19, s78
    v_mfma_f32_16x16x32_bf16 v[192:195], v[60:63], v[144:147], 0
    v_cvt_pk_bf16_f32 v88, v88, v89
    v_mfma_f32_16x16x32_bf16 v[196:199], v[64:67], v[144:147], 0
    s_nop 2
    v_cvt_pk_bf16_f32 v90, v168, v172
    v_and_b32 v89, 0xffff0000, v88
    v_mfma_f32_16x16x32_bf16 v[200:203], v[60:63], v[152:155], 0
    v_and_b32 v91, 0xffff0000, v90
    v_lshlrev_b32 v90, 16, v90
    v_mfma_f32_16x16x32_bf16 v[192:195], v[68:71], v[112:115], v[192:195]
    v_pk_add_f32 v[90:91], v[90:91], s[74:75] op_sel_hi:[1,0]
    v_lshlrev_b32 v88, 16, v88
    v_mfma_f32_16x16x32_bf16 v[204:207], v[64:67], v[152:155], 0
    v_cvt_pk_bf16_f32 v90, v90, v91
    v_rcp_f32 v88, v88
    v_mfma_f32_16x16x32_bf16 v[208:211], v[60:63], v[224:227], 0
    s_nop 1
    v_cvt_pk_bf16_f32 v96, v192, v193
    v_rcp_f32 v89, v89
    v_mfma_f32_16x16x32_bf16 v[196:199], v[72:75], v[112:115], v[196:199]
    v_cvt_pk_bf16_f32 v97, v194, v195
    v_and_b32 v91, 0xffff0000, v90
    v_mfma_f32_16x16x32_bf16 v[200:203], v[68:71], v[120:123], v[200:203]
    v_lshlrev_b32 v192, 16, v96
    v_and_b32 v193, 0xffff0000, v96
    v_mfma_f32_16x16x32_bf16 v[212:215], v[64:67], v[224:227], 0
    s_nop 1
    v_cvt_pk_bf16_f32 v98, v196, v197
    v_cvt_pk_bf16_f32 v99, v198, v199
    v_mfma_f32_16x16x32_bf16 v[216:219], v[60:63], v[232:235], 0
    v_cvt_pk_bf16_f32 v100, v200, v201
    v_lshlrev_b32 v90, 16, v90
    v_mfma_f32_16x16x32_bf16 v[204:207], v[72:75], v[120:123], v[204:207]
    v_lshlrev_b32 v194, 16, v97
    v_and_b32 v195, 0xffff0000, v97
    v_mfma_f32_16x16x32_bf16 v[208:211], v[68:71], v[128:131], v[208:211]
    v_cvt_pk_bf16_f32 v101, v202, v203
    v_lshlrev_b32 v196, 16, v98
    v_mfma_f32_16x16x32_bf16 v[220:223], v[64:67], v[232:235], 0
    v_and_b32 v197, 0xffff0000, v98
    v_lshlrev_b32 v198, 16, v99
    v_mfma_f32_16x16x32_bf16 v[212:215], v[72:75], v[128:131], v[212:215]
    v_and_b32 v199, 0xffff0000, v99
    v_pk_mul_f32 v[192:193], v[192:193], v[88:89] op_sel_hi:[1,0]
    v_mfma_f32_16x16x32_bf16 v[216:219], v[68:71], v[136:139], v[216:219]
    v_cvt_pk_bf16_f32 v102, v204, v205
    v_cvt_pk_bf16_f32 v103, v206, v207
    v_mfma_f32_16x16x32_bf16 v[220:223], v[72:75], v[136:139], v[220:223]
    v_lshlrev_b32 v200, 16, v100
    v_and_b32 v201, 0xffff0000, v100
    v_cvt_pk_bf16_f32 v104, v208, v209
    v_rcp_f32 v90, v90
    v_rcp_f32 v91, v91
    v_pk_mul_f32 v[194:195], v[194:195], v[88:89] op_sel_hi:[1,0]
    v_lshlrev_b32 v202, 16, v101
    v_and_b32 v203, 0xffff0000, v101
    v_cvt_pk_bf16_f32 v105, v210, v211
    v_pk_mul_f32 v[196:197], v[196:197], v[88:89] op_sel_hi:[1,0]
    v_pk_mul_f32 v[198:199], v[198:199], v[88:89] op_sel_hi:[1,0]
    v_cvt_pk_bf16_f32 v192, v192, v193
    v_lshlrev_b32 v204, 16, v102
    v_and_b32 v205, 0xffff0000, v102
    v_lshlrev_b32 v206, 16, v103
    v_and_b32 v207, 0xffff0000, v103
    v_pk_mul_f32 v[200:201], v[200:201], v[88:89] op_sel:[0,1] op_sel_hi:[1,1]
    v_cvt_pk_bf16_f32 v106, v212, v213
    v_cvt_pk_bf16_f32 v107, v214, v215
    v_lshlrev_b32 v208, 16, v104
    v_and_b32 v209, 0xffff0000, v104
    v_cvt_pk_bf16_f32 v108, v216, v217
    v_cvt_pk_bf16_f32 v193, v194, v195
    v_pk_mul_f32 v[202:203], v[202:203], v[88:89] op_sel:[0,1] op_sel_hi:[1,1]
    v_lshlrev_b32 v210, 16, v105
    v_and_b32 v211, 0xffff0000, v105
    v_cvt_pk_bf16_f32 v109, v218, v219
    v_cvt_pk_bf16_f32 v194, v196, v197
    v_cvt_pk_bf16_f32 v195, v198, v199
    v_pk_mul_f32 v[204:205], v[204:205], v[88:89] op_sel:[0,1] op_sel_hi:[1,1]
    v_pk_mul_f32 v[206:207], v[206:207], v[88:89] op_sel:[0,1] op_sel_hi:[1,1]
    v_cvt_pk_bf16_f32 v200, v200, v201
    v_lshlrev_b32 v212, 16, v106
    v_and_b32 v213, 0xffff0000, v106
    v_lshlrev_b32 v214, 16, v107
    v_and_b32 v215, 0xffff0000, v107
    v_pk_mul_f32 v[208:209], v[208:209], v[90:91] op_sel_hi:[1,0]
    v_cvt_pk_bf16_f32 v110, v220, v221
    v_cvt_pk_bf16_f32 v111, v222, v223
    v_lshlrev_b32 v216, 16, v108
    v_and_b32 v217, 0xffff0000, v108
    v_cvt_pk_bf16_f32 v201, v202, v203
    v_pk_mul_f32 v[210:211], v[210:211], v[90:91] op_sel_hi:[1,0]
    v_lshlrev_b32 v218, 16, v109
    v_and_b32 v219, 0xffff0000, v109
    buffer_store_dwordx4 v[192:195], v3, s[32:35], s20 offen sc1
    v_cvt_pk_bf16_f32 v202, v204, v205
    v_cvt_pk_bf16_f32 v203, v206, v207
    v_pk_mul_f32 v[212:213], v[212:213], v[90:91] op_sel_hi:[1,0]
    v_pk_mul_f32 v[214:215], v[214:215], v[90:91] op_sel_hi:[1,0]
    v_cvt_pk_bf16_f32 v208, v208, v209
    v_lshlrev_b32 v220, 16, v110
    v_and_b32 v221, 0xffff0000, v110
    v_lshlrev_b32 v222, 16, v111
    v_and_b32 v223, 0xffff0000, v111
    v_pk_mul_f32 v[216:217], v[216:217], v[90:91] op_sel:[0,1] op_sel_hi:[1,1]
    s_add_u32 s20, s20, 32768
    v_cvt_pk_bf16_f32 v209, v210, v211
    v_pk_mul_f32 v[218:219], v[218:219], v[90:91] op_sel:[0,1] op_sel_hi:[1,1]
    buffer_store_dwordx4 v[200:203], v3, s[32:35], s20 offen sc1
    v_cvt_pk_bf16_f32 v210, v212, v213
    v_cvt_pk_bf16_f32 v211, v214, v215
    v_pk_mul_f32 v[220:221], v[220:221], v[90:91] op_sel:[0,1] op_sel_hi:[1,1]
    v_pk_mul_f32 v[222:223], v[222:223], v[90:91] op_sel:[0,1] op_sel_hi:[1,1]
    v_cvt_pk_bf16_f32 v216, v216, v217
    s_add_u32 s20, s20, 32768
    v_cvt_pk_bf16_f32 v217, v218, v219
    buffer_store_dwordx4 v[208:211], v3, s[32:35], s20 offen sc1
    v_cvt_pk_bf16_f32 v218, v220, v221
    v_cvt_pk_bf16_f32 v219, v222, v223
    s_add_u32 s20, s20, 32768
    buffer_store_dwordx4 v[216:219], v3, s[32:35], s20 offen sc1
L_gc33:
    v_cmp_ne_u32 vcc, s78, v77
    v_cmp_ne_u32 s[74:75], s78, v79
    s_nop 1
    s_or_b64 vcc, vcc, s[74:75]
    s_cbranch_vccz L_gk34
    buffer_load_dwordx2 v[76:77], v27, s[32:35], s72 offen offset:0 sc1
    buffer_load_dwordx2 v[78:79], v27, s[32:35], s72 offen offset:64 sc1
    s_waitcnt vmcnt(0)
    s_add_u32 s79, s79, 1
    s_cmp_lt_u32 s79, 32768
    s_cbranch_scc1 L_gc33
L_gk34:
    v_and_b32 v54, 1, v2
    v_and_b32 v55, 31, v2
    v_lshlrev_b32 v54, 4, v54
    v_lshlrev_b32 v55, 2, v55
    v_lshrrev_b32 v80, v54, v76
    v_lshrrev_b32 v81, v54, v78
    v_lshlrev_b32 v82, 16, v80
    v_lshlrev_b32 v83, 16, v81
    v_sub_f32 v84, 1.0, v82
    v_sub_f32 v85, 1.0, v83
    v_cvt_pk_bf16_f32 v86, v13, v84
    v_cvt_pk_bf16_f32 v87, v13, v85
    v_lshrrev_b32 v84, 16, v86
    v_lshrrev_b32 v85, 16, v87
    v_dot2_f32_bf16 v128, v28, v84, 0
    v_dot2_f32_bf16 v129, v28, v86, 0
    v_dot2_f32_bf16 v130, v29, v84, 0
    v_dot2_f32_bf16 v131, v29, v86, 0
    v_dot2_f32_bf16 v132, v30, v84, 0
    v_dot2_f32_bf16 v133, v30, v86, 0
    v_dot2_f32_bf16 v134, v31, v84, 0
    v_dot2_f32_bf16 v135, v31, v86, 0
    v_dot2_f32_bf16 v136, v32, v84, 0
    v_dot2_f32_bf16 v137, v32, v86, 0
    v_dot2_f32_bf16 v138, v33, v84, 0
    v_dot2_f32_bf16 v139, v33, v86, 0
    v_dot2_f32_bf16 v140, v34, v84, 0
    v_dot2_f32_bf16 v141, v34, v86, 0
    v_dot2_f32_bf16 v142, v35, v84, 0
    v_dot2_f32_bf16 v143, v35, v86, 0
    v_dot2_f32_bf16 v144, v36, v85, 0
    v_dot2_f32_bf16 v145, v36, v87, 0
    v_dot2_f32_bf16 v146, v37, v85, 0
    v_dot2_f32_bf16 v147, v37, v87, 0
    v_dot2_f32_bf16 v148, v38, v85, 0
    v_dot2_f32_bf16 v149, v38, v87, 0
    v_dot2_f32_bf16 v150, v39, v85, 0
    v_dot2_f32_bf16 v151, v39, v87, 0
    v_dot2_f32_bf16 v152, v40, v85, 0
    v_dot2_f32_bf16 v153, v40, v87, 0
    v_dot2_f32_bf16 v154, v41, v85, 0
    v_dot2_f32_bf16 v155, v41, v87, 0
    v_dot2_f32_bf16 v156, v42, v85, 0
    v_dot2_f32_bf16 v157, v42, v87, 0
    v_dot2_f32_bf16 v158, v43, v85, 0
    v_dot2_f32_bf16 v159, v43, v87, 0
    v_cvt_pk_bf16_f32 v28, v128, v129
    v_cvt_pk_bf16_f32 v29, v130, v131
    v_cvt_pk_bf16_f32 v30, v132, v133
    v_cvt_pk_bf16_f32 v31, v134, v135
    v_cvt_pk_bf16_f32 v32, v136, v137
    v_cvt_pk_bf16_f32 v33, v138, v139
    v_cvt_pk_bf16_f32 v34, v140, v141
    v_cvt_pk_bf16_f32 v35, v142, v143
    v_cvt_pk_bf16_f32 v36, v144, v145
    v_cvt_pk_bf16_f32 v37, v146, v147
    v_cvt_pk_bf16_f32 v38, v148, v149
    v_cvt_pk_bf16_f32 v39, v150, v151
    v_cvt_pk_bf16_f32 v40, v152, v153
    v_cvt_pk_bf16_f32 v41, v154, v155
    v_cvt_pk_bf16_f32 v42, v156, v157
    v_cvt_pk_bf16_f32 v43, v158, v159
    s_lshr_b32 s3, s13, 2
    v_and_b32 v80, 0xffff, v80
    v_and_b32 v81, 0xffff, v81
    v_lshlrev_b32 v128, 16, v28
    v_and_b32 v129, 0xffff0000, v28
    v_lshlrev_b32 v130, 16, v29
    v_and_b32 v131, 0xffff0000, v29
    v_lshlrev_b32 v132, 16, v30
    v_and_b32 v133, 0xffff0000, v30
    v_lshlrev_b32 v134, 16, v31
    v_and_b32 v135, 0xffff0000, v31
    v_lshlrev_b32 v136, 16, v32
    v_and_b32 v137, 0xffff0000, v32
    v_lshlrev_b32 v138, 16, v33
    v_and_b32 v139, 0xffff0000, v33
    v_lshlrev_b32 v140, 16, v34
    v_and_b32 v141, 0xffff0000, v34
    v_lshlrev_b32 v142, 16, v35
    v_and_b32 v143, 0xffff0000, v35
    v_lshlrev_b32 v144, 16, v36
    v_and_b32 v145, 0xffff0000, v36
    v_lshlrev_b32 v146, 16, v37
    v_and_b32 v147, 0xffff0000, v37
    v_lshlrev_b32 v148, 16, v38
    v_and_b32 v149, 0xffff0000, v38
    v_lshlrev_b32 v150, 16, v39
    v_and_b32 v151, 0xffff0000, v39
    v_lshlrev_b32 v152, 16, v40
    v_and_b32 v153, 0xffff0000, v40
    v_lshlrev_b32 v154, 16, v41
    v_and_b32 v155, 0xffff0000, v41
    v_lshlrev_b32 v156, 16, v42
    v_and_b32 v157, 0xffff0000, v42
    v_lshlrev_b32 v158, 16, v43
    v_and_b32 v159, 0xffff0000, v43
    v_mov_b32 v160, 0
    v_mov_b32 v161, 0
    v_mov_b32 v162, 0
    v_mov_b32 v163, 0
    v_mov_b32 v164, 0
    v_mov_b32 v165, 0
    v_mov_b32 v166, 0
    v_mov_b32 v167, 0
    v_mov_b32 v168, 0
    v_mov_b32 v169, 0
    v_mov_b32 v170, 0
    v_mov_b32 v171, 0
    v_mov_b32 v172, 0
    v_mov_b32 v173, 0
    v_mov_b32 v174, 0
    v_mov_b32 v175, 0
    v_mov_b32 v176, 0
    v_mov_b32 v177, 0
    v_mov_b32 v178, 0
    v_mov_b32 v179, 0
    v_mov_b32 v180, 0
    v_mov_b32 v181, 0
    v_mov_b32 v182, 0
    v_mov_b32 v183, 0
    v_mov_b32 v184, 0
    v_mov_b32 v185, 0
    v_mov_b32 v186, 0
    v_mov_b32 v187, 0
    v_mov_b32 v188, 0
    v_mov_b32 v189, 0
    v_mov_b32 v190, 0
    v_mov_b32 v191, 0
    v_and_b32 v90, 12, v55
    s_lshl_b32 s76, s3, 12
    s_mov_b64 s[60:61], s[32:33]
    s_mov_b32 s62, 16777216
    s_waitcnt vmcnt(0)
    s_mov_b64 exec, 1
    buffer_store_dword v19, v13, s[32:35], s21 offen sc1
    s_mov_b64 exec, -1
L_of35:
    buffer_load_dword v54, v55, s[32:35], s71 offen sc1
    ds_read_b32 v88, v90 offset:208
    ds_read_b32 v89, v13 offset:16
    s_waitcnt vmcnt(0) lgkmcnt(0)
    v_cmp_ne_u32 vcc, s78, v54
    v_cmp_ne_u32 s[74:75], v88, v18
    s_nop 1
    s_or_b64 vcc, vcc, s[74:75]
    s_cbranch_vccz L_ofk36
    s_add_u32 s79, s79, 1
    s_cmp_lt_u32 s79, 32768
    s_cbranch_scc1 L_of35
L_ofk36:
    buffer_load_dwordx4 v[192:195], v24, s[60:63], s76 offen
    buffer_load_dwordx4 v[196:199], v25, s[60:63], s76 offen
    s_add_u32 s76, s76, 1024
    s_and_b32 s76, s76, 0x7fff
    buffer_load_dwordx4 v[200:203], v24, s[60:63], s76 offen
    buffer_load_dwordx4 v[204:207], v25, s[60:63], s76 offen
    s_add_u32 s76, s76, 1024
    s_and_b32 s76, s76, 0x7fff
    buffer_load_dwordx4 v[208:211], v24, s[60:63], s76 offen
    buffer_load_dwordx4 v[212:215], v25, s[60:63], s76 offen
    s_add_u32 s76, s76, 1024
    s_and_b32 s76, s76, 0x7fff
    buffer_load_dwordx4 v[216:219], v24, s[60:63], s76 offen
    buffer_load_dwordx4 v[220:223], v25, s[60:63], s76 offen
    s_add_u32 s76, s76, 1024
    s_and_b32 s76, s76, 0x7fff
    buffer_load_dwordx4 v[224:227], v24, s[60:63], s76 offen
    buffer_load_dwordx4 v[228:231], v25, s[60:63], s76 offen
    s_add_u32 s76, s76, 1024
    s_and_b32 s76, s76, 0x7fff
    buffer_load_dwordx4 v[232:235], v24, s[60:63], s76 offen
    buffer_load_dwordx4 v[236:239], v25, s[60:63], s76 offen
    s_add_u32 s76, s76, 1024
    s_and_b32 s76, s76, 0x7fff
    buffer_load_dwordx4 v[240:243], v24, s[60:63], s76 offen
    buffer_load_dwordx4 v[244:247], v25, s[60:63], s76 offen
    s_add_u32 s76, s76, 1024
    s_and_b32 s76, s76, 0x7fff
    buffer_load_dwordx4 v[248:251], v24, s[60:63], s76 offen
    buffer_load_dwordx4 v[252:255], v25, s[60:63], s76 offen
    s_add_u32 s76, s76, 1024
    s_and_b32 s76, s76, 0x7fff
    ds_read_b64_tr_b16 v[96:97], v20 offset:0
    ds_read_b64_tr_b16 v[98:99], v20 offset:2048
    ds_read_b64_tr_b16 v[100:101], v21 offset:0
    ds_read_b64_tr_b16 v[102:103], v21 offset:2048
    ds_read_b64_tr_b16 v[104:105], v22 offset:0
    ds_read_b64_tr_b16 v[106:107], v22 offset:2048
    ds_read_b64_tr_b16 v[108:109], v23 offset:0
    ds_read_b64_tr_b16 v[110:111], v23 offset:2048
    v_readfirstlane_b32 s77, v89
    s_mov_b32 s66, 0
    s_mov_b32 s3, 32768
.p2align 6
L_p5:
    s_cmp_eq_u32 s66, 3
    s_cselect_b32 s62, 0, s62
    s_cselect_b32 s3, 0, s3
    s_waitcnt vmcnt(14) lgkmcnt(6)
    v_mfma_f32_16x16x32_bf16 v[160:163], v[96:99], v[192:195], v[160:163]
    ds_read_b64_tr_b16 v[112:113], v20 offset:4096
    v_mfma_f32_16x16x32_bf16 v[176:179], v[96:99], v[196:199], v[176:179]
    ds_read_b64_tr_b16 v[114:115], v20 offset:6144
    s_waitcnt lgkmcnt(6)
    v_mfma_f32_16x16x32_bf16 v[164:167], v[100:103], v[192:195], v[164:167]
    ds_read_b64_tr_b16 v[116:117], v21 offset:4096
    v_mfma_f32_16x16x32_bf16 v[180:183], v[100:103], v[196:199], v[180:183]
    ds_read_b64_tr_b16 v[118:119], v21 offset:6144
    s_waitcnt lgkmcnt(6)
    v_mfma_f32_16x16x32_bf16 v[168:171], v[104:107], v[192:195], v[168:171]
    ds_read_b64_tr_b16 v[120:121], v22 offset:4096
    v_mfma_f32_16x16x32_bf16 v[184:187], v[104:107], v[196:199], v[184:187]
    ds_read_b64_tr_b16 v[122:123], v22 offset:6144
    s_waitcnt lgkmcnt(6)
    v_mfma_f32_16x16x32_bf16 v[172:175], v[108:111], v[192:195], v[172:175]
    ds_read_b64_tr_b16 v[124:125], v23 offset:4096
    v_mfma_f32_16x16x32_bf16 v[188:191], v[108:111], v[196:199], v[188:191]
    ds_read_b64_tr_b16 v[126:127], v23 offset:6144
    buffer_load_dwordx4 v[192:195], v24, s[60:63], s76 offen
    buffer_load_dwordx4 v[196:199], v25, s[60:63], s76 offen
    s_add_u32 s76, s76, 1024
    s_and_b32 s76, s76, 0x7fff
    s_waitcnt vmcnt(14) lgkmcnt(6)
    v_mfma_f32_16x16x32_bf16 v[160:163], v[112:115], v[200:203], v[160:163]
    ds_read_b64_tr_b16 v[96:97], v20 offset:8192
    v_mfma_f32_16x16x32_bf16 v[176:179], v[112:115], v[204:207], v[176:179]
    ds_read_b64_tr_b16 v[98:99], v20 offset:10240
    s_waitcnt lgkmcnt(6)
    v_mfma_f32_16x16x32_bf16 v[164:167], v[116:119], v[200:203], v[164:167]
    ds_read_b64_tr_b16 v[100:101], v21 offset:8192
    v_mfma_f32_16x16x32_bf16 v[180:183], v[116:119], v[204:207], v[180:183]
    ds_read_b64_tr_b16 v[102:103], v21 offset:10240
    s_waitcnt lgkmcnt(6)
    v_mfma_f32_16x16x32_bf16 v[168:171], v[120:123], v[200:203], v[168:171]
    ds_read_b64_tr_b16 v[104:105], v22 offset:8192
    v_mfma_f32_16x16x32_bf16 v[184:187], v[120:123], v[204:207], v[184:187]
    ds_read_b64_tr_b16 v[106:107], v22 offset:10240
    s_waitcnt lgkmcnt(6)
    v_mfma_f32_16x16x32_bf16 v[172:175], v[124:127], v[200:203], v[172:175]
    ds_read_b64_tr_b16 v[108:109], v23 offset:8192
    v_mfma_f32_16x16x32_bf16 v[188:191], v[124:127], v[204:207], v[188:191]
    ds_read_b64_tr_b16 v[110:111], v23 offset:10240
    buffer_load_dwordx4 v[200:203], v24, s[60:63], s76 offen
    buffer_load_dwordx4 v[204:207], v25, s[60:63], s76 offen
    s_add_u32 s76, s76, 1024
    s_and_b32 s76, s76, 0x7fff
    s_waitcnt vmcnt(14) lgkmcnt(6)
    v_mfma_f32_16x16x32_bf16 v[160:163], v[96:99], v[208:211], v[160:163]
    ds_read_b64_tr_b16 v[112:113], v20 offset:12288
    v_mfma_f32_16x16x32_bf16 v[176:179], v[96:99], v[212:215], v[176:179]
    ds_read_b64_tr_b16 v[114:115], v20 offset:14336
    s_waitcnt lgkmcnt(6)
    v_mfma_f32_16x16x32_bf16 v[164:167], v[100:103], v[208:211], v[164:167]
    ds_read_b64_tr_b16 v[116:117], v21 offset:12288
    v_mfma_f32_16x16x32_bf16 v[180:183], v[100:103], v[212:215], v[180:183]
    ds_read_b64_tr_b16 v[118:119], v21 offset:14336
    s_waitcnt lgkmcnt(6)
    v_mfma_f32_16x16x32_bf16 v[168:171], v[104:107], v[208:211], v[168:171]
    ds_read_b64_tr_b16 v[120:121], v22 offset:12288
    v_mfma_f32_16x16x32_bf16 v[184:187], v[104:107], v[212:215], v[184:187]
    ds_read_b64_tr_b16 v[122:123], v22 offset:14336
    s_waitcnt lgkmcnt(6)
    v_mfma_f32_16x16x32_bf16 v[172:175], v[108:111], v[208:211], v[172:175]
    ds_read_b64_tr_b16 v[124:125], v23 offset:12288
    v_mfma_f32_16x16x32_bf16 v[188:191], v[108:111], v[212:215], v[188:191]
    ds_read_b64_tr_b16 v[126:127], v23 offset:14336
    buffer_load_dwordx4 v[208:211], v24, s[60:63], s76 offen
    buffer_load_dwordx4 v[212:215], v25, s[60:63], s76 offen
    s_add_u32 s76, s76, 1024
    s_and_b32 s76, s76, 0x7fff
    s_waitcnt vmcnt(14) lgkmcnt(6)
    v_mfma_f32_16x16x32_bf16 v[160:163], v[112:115], v[216:219], v[160:163]
    ds_read_b64_tr_b16 v[96:97], v20 offset:16384
    v_mfma_f32_16x16x32_bf16 v[176:179], v[112:115], v[220:223], v[176:179]
    ds_read_b64_tr_b16 v[98:99], v20 offset:18432
    s_waitcnt lgkmcnt(6)
    v_mfma_f32_16x16x32_bf16 v[164:167], v[116:119], v[216:219], v[164:167]
    ds_read_b64_tr_b16 v[100:101], v21 offset:16384
    v_mfma_f32_16x16x32_bf16 v[180:183], v[116:119], v[220:223], v[180:183]
    ds_read_b64_tr_b16 v[102:103], v21 offset:18432
    s_waitcnt lgkmcnt(6)
    v_mfma_f32_16x16x32_bf16 v[168:171], v[120:123], v[216:219], v[168:171]
    ds_read_b64_tr_b16 v[104:105], v22 offset:16384
    v_mfma_f32_16x16x32_bf16 v[184:187], v[120:123], v[220:223], v[184:187]
    ds_read_b64_tr_b16 v[106:107], v22 offset:18432
    s_waitcnt lgkmcnt(6)
    v_mfma_f32_16x16x32_bf16 v[172:175], v[124:127], v[216:219], v[172:175]
    ds_read_b64_tr_b16 v[108:109], v23 offset:16384
    v_mfma_f32_16x16x32_bf16 v[188:191], v[124:127], v[220:223], v[188:191]
    ds_read_b64_tr_b16 v[110:111], v23 offset:18432
    buffer_load_dwordx4 v[216:219], v24, s[60:63], s76 offen
    buffer_load_dwordx4 v[220:223], v25, s[60:63], s76 offen
    s_add_u32 s76, s76, 1024
    s_and_b32 s76, s76, 0x7fff
    s_waitcnt vmcnt(14) lgkmcnt(6)
    v_mfma_f32_16x16x32_bf16 v[160:163], v[96:99], v[224:227], v[160:163]
    ds_read_b64_tr_b16 v[112:113], v20 offset:20480
    v_mfma_f32_16x16x32_bf16 v[176:179], v[96:99], v[228:231], v[176:179]
    ds_read_b64_tr_b16 v[114:115], v20 offset:22528
    s_waitcnt lgkmcnt(6)
    v_mfma_f32_16x16x32_bf16 v[164:167], v[100:103], v[224:227], v[164:167]
    ds_read_b64_tr_b16 v[116:117], v21 offset:20480
    v_mfma_f32_16x16x32_bf16 v[180:183], v[100:103], v[228:231], v[180:183]
    ds_read_b64_tr_b16 v[118:119], v21 offset:22528
    s_waitcnt lgkmcnt(6)
    v_mfma_f32_16x16x32_bf16 v[168:171], v[104:107], v[224:227], v[168:171]
    ds_read_b64_tr_b16 v[120:121], v22 offset:20480
    v_mfma_f32_16x16x32_bf16 v[184:187], v[104:107], v[228:231], v[184:187]
    ds_read_b64_tr_b16 v[122:123], v22 offset:22528
    s_waitcnt lgkmcnt(6)
    v_mfma_f32_16x16x32_bf16 v[172:175], v[108:111], v[224:227], v[172:175]
    ds_read_b64_tr_b16 v[124:125], v23 offset:20480
    v_mfma_f32_16x16x32_bf16 v[188:191], v[108:111], v[228:231], v[188:191]
    ds_read_b64_tr_b16 v[126:127], v23 offset:22528
    buffer_load_dwordx4 v[224:227], v24, s[60:63], s76 offen
    buffer_load_dwordx4 v[228:231], v25, s[60:63], s76 offen
    s_add_u32 s76, s76, 1024
    s_and_b32 s76, s76, 0x7fff
    s_waitcnt vmcnt(14) lgkmcnt(6)
    v_mfma_f32_16x16x32_bf16 v[160:163], v[112:115], v[232:235], v[160:163]
    ds_read_b64_tr_b16 v[96:97], v20 offset:24576
    v_mfma_f32_16x16x32_bf16 v[176:179], v[112:115], v[236:239], v[176:179]
    ds_read_b64_tr_b16 v[98:99], v20 offset:26624
    s_waitcnt lgkmcnt(6)
    v_mfma_f32_16x16x32_bf16 v[164:167], v[116:119], v[232:235], v[164:167]
    ds_read_b64_tr_b16 v[100:101], v21 offset:24576
    v_mfma_f32_16x16x32_bf16 v[180:183], v[116:119], v[236:239], v[180:183]
    ds_read_b64_tr_b16 v[102:103], v21 offset:26624
    s_waitcnt lgkmcnt(6)
    v_mfma_f32_16x16x32_bf16 v[168:171], v[120:123], v[232:235], v[168:171]
    ds_read_b64_tr_b16 v[104:105], v22 offset:24576
    v_mfma_f32_16x16x32_bf16 v[184:187], v[120:123], v[236:239], v[184:187]
    ds_read_b64_tr_b16 v[106:107], v22 offset:26624
    s_waitcnt lgkmcnt(6)
    v_mfma_f32_16x16x32_bf16 v[172:175], v[124:127], v[232:235], v[172:175]
    ds_read_b64_tr_b16 v[108:109], v23 offset:24576
    v_mfma_f32_16x16x32_bf16 v[188:191], v[124:127], v[236:239], v[188:191]
    ds_read_b64_tr_b16 v[110:111], v23 offset:26624
    buffer_load_dwordx4 v[232:235], v24, s[60:63], s76 offen
    buffer_load_dwordx4 v[236:239], v25, s[60:63], s76 offen
    s_add_u32 s76, s76, 1024
    s_and_b32 s76, s76, 0x7fff
    s_waitcnt vmcnt(14) lgkmcnt(6)
    v_mfma_f32_16x16x32_bf16 v[160:163], v[96:99], v[240:243], v[160:163]
    ds_read_b64_tr_b16 v[112:113], v20 offset:28672
    v_mfma_f32_16x16x32_bf16 v[176:179], v[96:99], v[244:247], v[176:179]
    ds_read_b64_tr_b16 v[114:115], v20 offset:30720
    s_waitcnt lgkmcnt(6)
    v_mfma_f32_16x16x32_bf16 v[164:167], v[100:103], v[240:243], v[164:167]
    ds_read_b64_tr_b16 v[116:117], v21 offset:28672
    v_mfma_f32_16x16x32_bf16 v[180:183], v[100:103], v[244:247], v[180:183]
    ds_read_b64_tr_b16 v[118:119], v21 offset:30720
    s_waitcnt lgkmcnt(6)
    v_mfma_f32_16x16x32_bf16 v[168:171], v[104:107], v[240:243], v[168:171]
    ds_read_b64_tr_b16 v[120:121], v22 offset:28672
    v_mfma_f32_16x16x32_bf16 v[184:187], v[104:107], v[244:247], v[184:187]
    ds_read_b64_tr_b16 v[122:123], v22 offset:30720
    s_waitcnt lgkmcnt(6)
    v_mfma_f32_16x16x32_bf16 v[172:175], v[108:111], v[240:243], v[172:175]
    ds_read_b64_tr_b16 v[124:125], v23 offset:28672
    v_mfma_f32_16x16x32_bf16 v[188:191], v[108:111], v[244:247], v[188:191]
    ds_read_b64_tr_b16 v[126:127], v23 offset:30720
    buffer_load_dwordx4 v[240:243], v24, s[60:63], s76 offen
    buffer_load_dwordx4 v[244:247], v25, s[60:63], s76 offen
    s_add_u32 s76, s76, 1024
    s_and_b32 s76, s76, 0x7fff
    v_add_u32 v20, s3, v20
    v_add_u32 v21, s3, v21
    v_add_u32 v22, s3, v22
    v_add_u32 v23, s3, v23
    s_waitcnt vmcnt(14) lgkmcnt(6)
    v_mfma_f32_16x16x32_bf16 v[160:163], v[112:115], v[248:251], v[160:163]
    ds_read_b64_tr_b16 v[96:97], v20 offset:0
    v_mfma_f32_16x16x32_bf16 v[176:179], v[112:115], v[252:255], v[176:179]
    ds_read_b64_tr_b16 v[98:99], v20 offset:2048
    s_waitcnt lgkmcnt(6)
    v_mfma_f32_16x16x32_bf16 v[164:167], v[116:119], v[248:251], v[164:167]
    ds_read_b64_tr_b16 v[100:101], v21 offset:0
    v_mfma_f32_16x16x32_bf16 v[180:183], v[116:119], v[252:255], v[180:183]
    ds_read_b64_tr_b16 v[102:103], v21 offset:2048
    s_waitcnt lgkmcnt(6)
    v_mfma_f32_16x16x32_bf16 v[168:171], v[120:123], v[248:251], v[168:171]
    ds_read_b64_tr_b16 v[104:105], v22 offset:0
    v_mfma_f32_16x16x32_bf16 v[184:187], v[120:123], v[252:255], v[184:187]
    ds_read_b64_tr_b16 v[106:107], v22 offset:2048
    s_waitcnt lgkmcnt(6)
    v_mfma_f32_16x16x32_bf16 v[172:175], v[124:127], v[248:251], v[172:175]
    ds_read_b64_tr_b16 v[108:109], v23 offset:0
    v_mfma_f32_16x16x32_bf16 v[188:191], v[124:127], v[252:255], v[188:191]
    ds_read_b64_tr_b16 v[110:111], v23 offset:2048
    buffer_load_dwordx4 v[248:251], v24, s[60:63], s76 offen
    buffer_load_dwordx4 v[252:255], v25, s[60:63], s76 offen
    s_add_u32 s76, s76, 1024
    s_and_b32 s76, s76, 0x7fff
    s_add_u32 s66, s66, 1
    s_cmp_lt_u32 s66, 4
    s_cbranch_scc1 L_p5
    s_waitcnt lgkmcnt(0)
    s_and_b32 s77, s77, 2047
    s_sub_u32 s77, 2047, s77
    s_lshr_b32 s19, s77, 5
    s_cmp_eq_u32 s19, s68
    s_cbranch_scc1 L_own
L_ownret:
    v_cvt_pk_bf16_f32 v160, v160, v161
    v_cvt_pk_bf16_f32 v161, v162, v163
    v_cvt_pk_bf16_f32 v168, v168, v169
    v_cvt_pk_bf16_f32 v162, v164, v165
    v_cvt_pk_bf16_f32 v163, v166, v167
    v_cvt_pk_bf16_f32 v169, v170, v171
    v_cvt_pk_bf16_f32 v176, v176, v177
    v_cvt_pk_bf16_f32 v170, v172, v173
    v_cvt_pk_bf16_f32 v171, v174, v175
    v_cvt_pk_bf16_f32 v177, v178, v179
    v_cvt_pk_bf16_f32 v184, v184, v185
    v_cvt_pk_bf16_f32 v178, v180, v181
    v_cvt_pk_bf16_f32 v179, v182, v183
    v_cvt_pk_bf16_f32 v185, v186, v187
    v_permlane16_swap_b32 v160, v162
    v_permlane16_swap_b32 v161, v163
    v_cvt_pk_bf16_f32 v186, v188, v189
    v_cvt_pk_bf16_f32 v187, v190, v191
    v_permlane16_swap_b32 v168, v170
    v_permlane16_swap_b32 v169, v171
    v_dot2_f32_bf16 v96, v160, v80, 0
    v_dot2_f32_bf16 v97, v160, v82, 0
    v_dot2_f32_bf16 v98, v161, v80, 0
    v_dot2_f32_bf16 v99, v161, v82, 0
    v_dot2_f32_bf16 v100, v162, v80, 0
    v_dot2_f32_bf16 v101, v162, v82, 0
    v_dot2_f32_bf16 v102, v163, v80, 0
    v_dot2_f32_bf16 v103, v163, v82, 0
    v_permlane16_swap_b32 v176, v178
    v_permlane16_swap_b32 v177, v179
    v_dot2_f32_bf16 v104, v168, v80, 0
    v_dot2_f32_bf16 v105, v168, v82, 0
    v_dot2_f32_bf16 v106, v169, v80, 0
    v_dot2_f32_bf16 v107, v169, v82, 0
    v_dot2_f32_bf16 v108, v170, v80, 0
    v_dot2_f32_bf16 v109, v170, v82, 0
    v_dot2_f32_bf16 v110, v171, v80, 0
    v_dot2_f32_bf16 v111, v171, v82, 0
    v_permlane16_swap_b32 v184, v186
    v_permlane16_swap_b32 v185, v187
    v_dot2_f32_bf16 v112, v176, v81, 0
    v_dot2_f32_bf16 v113, v176, v83, 0
    v_dot2_f32_bf16 v114, v177, v81, 0
    v_dot2_f32_bf16 v115, v177, v83, 0
    v_dot2_f32_bf16 v116, v178, v81, 0
    v_dot2_f32_bf16 v117, v178, v83, 0
    v_dot2_f32_bf16 v118, v179, v81, 0
    v_dot2_f32_bf16 v119, v179, v83, 0
    v_dot2_f32_bf16 v120, v184, v81, 0
    v_dot2_f32_bf16 v121, v184, v83, 0
    v_dot2_f32_bf16 v122, v185, v81, 0
    v_dot2_f32_bf16 v123, v185, v83, 0
    v_dot2_f32_bf16 v124, v186, v81, 0
    v_dot2_f32_bf16 v125, v186, v83, 0
    v_dot2_f32_bf16 v126, v187, v81, 0
    v_dot2_f32_bf16 v127, v187, v83, 0
    v_cvt_pk_bf16_f32 v160, v96, v97
    v_cvt_pk_bf16_f32 v161, v98, v99
    v_cvt_pk_bf16_f32 v162, v100, v101
    v_cvt_pk_bf16_f32 v163, v102, v103
    s_mov_b32 s74, 0x3f80
    s_mov_b32 s75, 0x3f800000
    v_cvt_pk_bf16_f32 v168, v104, v105
    v_cvt_pk_bf16_f32 v169, v106, v107
    v_cvt_pk_bf16_f32 v170, v108, v109
    v_cvt_pk_bf16_f32 v171, v110, v111
    v_dot2_f32_bf16 v96, v160, s74, v128
    v_dot2_f32_bf16 v97, v160, s75, v129
    v_dot2_f32_bf16 v98, v161, s74, v130
    v_dot2_f32_bf16 v99, v161, s75, v131
    v_dot2_f32_bf16 v100, v162, s74, v132
    v_dot2_f32_bf16 v101, v162, s75, v133
    v_dot2_f32_bf16 v102, v163, s74, v134
    v_dot2_f32_bf16 v103, v163, s75, v135
    v_cvt_pk_bf16_f32 v176, v112, v113
    v_cvt_pk_bf16_f32 v177, v114, v115
    v_cvt_pk_bf16_f32 v178, v116, v117
    v_cvt_pk_bf16_f32 v179, v118, v119
    v_dot2_f32_bf16 v104, v168, s74, v136
    v_dot2_f32_bf16 v105, v168, s75, v137
    v_dot2_f32_bf16 v106, v169, s74, v138
    v_dot2_f32_bf16 v107, v169, s75, v139
    v_dot2_f32_bf16 v108, v170, s74, v140
    v_dot2_f32_bf16 v109, v170, s75, v141
    v_dot2_f32_bf16 v110, v171, s74, v142
    v_dot2_f32_bf16 v111, v171, s75, v143
    v_cvt_pk_bf16_f32 v184, v120, v121
    v_cvt_pk_bf16_f32 v185, v122, v123
    v_cvt_pk_bf16_f32 v186, v124, v125
    v_cvt_pk_bf16_f32 v187, v126, v127
    v_dot2_f32_bf16 v112, v176, s74, v144
    v_dot2_f32_bf16 v113, v176, s75, v145
    v_dot2_f32_bf16 v114, v177, s74, v146
    v_dot2_f32_bf16 v115, v177, s75, v147
    v_dot2_f32_bf16 v116, v178, s74, v148
    v_dot2_f32_bf16 v117, v178, s75, v149
    v_dot2_f32_bf16 v118, v179, s74, v150
    v_dot2_f32_bf16 v119, v179, s75, v151
    v_dot2_f32_bf16 v120, v184, s74, v152
    v_dot2_f32_bf16 v121, v184, s75, v153
    v_dot2_f32_bf16 v122, v185, s74, v154
    v_dot2_f32_bf16 v123, v185, s75, v155
    v_dot2_f32_bf16 v124, v186, s74, v156
    v_dot2_f32_bf16 v125, v186, s75, v157
    v_dot2_f32_bf16 v126, v187, s74, v158
    v_dot2_f32_bf16 v127, v187, s75, v159
    v_cvt_pk_bf16_f32 v160, v96, v97
    v_cvt_pk_bf16_f32 v161, v98, v99
    v_cvt_pk_bf16_f32 v162, v100, v101
    v_cvt_pk_bf16_f32 v163, v102, v103
    v_cvt_pk_bf16_f32 v168, v104, v105
    v_cvt_pk_bf16_f32 v169, v106, v107
    v_cvt_pk_bf16_f32 v170, v108, v109
    v_cvt_pk_bf16_f32 v171, v110, v111
    buffer_store_dwordx4 v[160:163], v26, s[44:47], s70 offen offset:0 sc1
    v_cvt_pk_bf16_f32 v176, v112, v113
    v_cvt_pk_bf16_f32 v177, v114, v115
    v_cvt_pk_bf16_f32 v178, v116, v117
    v_cvt_pk_bf16_f32 v179, v118, v119
    buffer_store_dwordx4 v[168:171], v26, s[44:47], s70 offen offset:64 sc1
    v_cvt_pk_bf16_f32 v184, v120, v121
    v_cvt_pk_bf16_f32 v185, v122, v123
    v_cvt_pk_bf16_f32 v186, v124, v125
    v_cvt_pk_bf16_f32 v187, v126, v127
    buffer_store_dwordx4 v[176:179], v26, s[44:47], s73 offen offset:0 sc1
    buffer_store_dwordx4 v[184:187], v26, s[44:47], s73 offen offset:64 sc1
    s_endpgm
L_own:
    v_and_b32 v54, 16, v2
    v_lshlrev_b32 v54, 2, v54
    v_and_b32 v55, 32, v2
    v_add_u32 v54, v54, v55
L_xo37:
    ds_read_b32 v88, v13 offset:224
    ds_read_b128 v[96:99], v54 offset:512
    ds_read_b128 v[100:103], v54 offset:528
    ds_read_b128 v[104:107], v54 offset:640
    ds_read_b128 v[108:111], v54 offset:656
    s_waitcnt lgkmcnt(0)
    v_cmp_ne_u32 vcc, v88, v18
    s_cbranch_vccz L_xk38
    s_add_u32 s79, s79, 1
    s_cmp_lt_u32 s79, 32768
    s_cbranch_scc1 L_xo37
L_xk38:
    s_and_b32 s77, s77, 31
    v_and_b32 v54, 15, v2
    v_cmp_eq_u32 vcc, s77, v54
    s_nop 1
    v_cndmask_b32 v128, v128, v96, vcc
    v_cndmask_b32 v129, v129, v97, vcc
    v_cndmask_b32 v130, v130, v98, vcc
    v_cndmask_b32 v131, v131, v99, vcc
    v_cndmask_b32 v132, v132, v100, vcc
    v_cndmask_b32 v133, v133, v101, vcc
    v_cndmask_b32 v134, v134, v102, vcc
    v_cndmask_b32 v135, v135, v103, vcc
    v_cndmask_b32 v136, v136, v104, vcc
    v_cndmask_b32 v137, v137, v105, vcc
    v_cndmask_b32 v138, v138, v106, vcc
    v_cndmask_b32 v139, v139, v107, vcc
    v_cndmask_b32 v140, v140, v108, vcc
    v_cndmask_b32 v141, v141, v109, vcc
    v_cndmask_b32 v142, v142, v110, vcc
    v_cndmask_b32 v143, v143, v111, vcc
    v_add_u32 v54, 16, v54
    v_cmp_eq_u32 vcc, s77, v54
    s_nop 1
    v_cndmask_b32 v144, v144, v96, vcc
    v_cndmask_b32 v145, v145, v97, vcc
    v_cndmask_b32 v146, v146, v98, vcc
    v_cndmask_b32 v147, v147, v99, vcc
    v_cndmask_b32 v148, v148, v100, vcc
    v_cndmask_b32 v149, v149, v101, vcc
    v_cndmask_b32 v150, v150, v102, vcc
    v_cndmask_b32 v151, v151, v103, vcc
    v_cndmask_b32 v152, v152, v104, vcc
    v_cndmask_b32 v153, v153, v105, vcc
    v_cndmask_b32 v154, v154, v106, vcc
    v_cndmask_b32 v155, v155, v107, vcc
    v_cndmask_b32 v156, v156, v108, vcc
    v_cndmask_b32 v157, v157, v109, vcc
    v_cndmask_b32 v158, v158, v110, vcc
    v_cndmask_b32 v159, v159, v111, vcc
    s_branch L_ownret
L_end:
    s_endpgm
.section .rodata,"a"
.p2align 6
.amdhsa_kernel fk_kernel
  .amdhsa_next_free_vgpr 256
  .amdhsa_next_free_sgpr 102
  .amdhsa_accum_offset 256
  .amdhsa_group_segment_fixed_size 0
  .amdhsa_kernarg_size 104
  .amdhsa_user_sgpr_count 2
  .amdhsa_user_sgpr_kernarg_segment_ptr 1
  .amdhsa_system_sgpr_workgroup_id_x 1
.end_amdhsa_kernel
```

```asm
; @launch kernel=fk_kernel grid=(256,1,1) block=(512,1,1) lds=163840
.amdgcn_target "amdgcn-amd-amdhsa--gfx950"
.text
.globl fk_kernel
.p2align 8
.type fk_kernel,@function
fk_kernel:
    s_load_dwordx4 s[4:7], s[0:1], 0
    s_load_dwordx4 s[8:11], s[0:1], 16
    s_load_dwordx16 s[84:99], s[0:1], 40
    s_cmp_ge_u32 s2, 256
    s_cbranch_scc1 L_end
    v_lshrrev_b32 v1, 6, v0
    v_and_b32 v2, 63, v0
    v_readfirstlane_b32 s16, v1
    v_lshrrev_b32 v4, 3, v2
    v_lshlrev_b32 v5, 11, v4
    v_and_b32 v6, 7, v2
    v_lshrrev_b32 v7, 4, v2
    v_xor_b32 v8, v6, v7
    v_lshl_add_u32 v10, v8, 4, v5
    v_xor_b32 v8, 4, v8
    v_lshl_add_u32 v11, v8, 4, v5
    v_mul_u32_u24 v5, 6144, v4
    v_and_b32 v7, 1, v7
    v_lshlrev_b32 v7, 2, v7
    v_xor_b32 v8, v6, v7
    s_and_b32 s12, s2, 7
    s_lshr_b32 s13, s2, 3
    s_and_b32 s14, s13, 15
    s_lshl_b32 s15, s12, 1
    s_lshr_b32 s19, s13, 4
    s_add_u32 s15, s15, s19
    s_and_b32 s17, s16, 3
    s_and_b32 s19, s16, 1
    s_lshl_b32 s19, s19, 1
    v_xor_b32 v8, s19, v8
    v_lshl_add_u32 v12, v8, 4, v5
    s_lshl_b32 s19, s14, 18
    v_add_u32 v10, s19, v10
    v_add_u32 v11, s19, v11
    s_lshl_b32 s19, s15, 7
    v_add_u32 v12, s19, v12
    s_add_u32 s64, s14, s15
    s_and_b32 s64, s64, 3
    s_add_u32 s65, s12, 0
    s_and_b32 s65, s65, 3
    s_lshl_b32 s65, s65, 2
    s_and_b32 s72, s64, 3
    s_add_u32 s72, s72, s65
    s_mul_i32 s73, s72, 393216
    s_lshl_b32 s72, s72, 7
    s_lshl_b32 s74, s16, 15
    s_add_u32 s72, s72, s74
    s_mul_i32 s74, s16, 49152
    s_add_u32 s73, s73, s74
    s_lshl_b32 s75, s16, 10
    s_lshl_b32 m0, s16, 11
    s_add_u32 s74, s72, 16384
    s_waitcnt lgkmcnt(0)
    s_mov_b64 s[24:25], s[4:5]
    s_mov_b32 s26, 4194304
    s_mov_b32 s27, 0x00020000
    buffer_load_dwordx4 v10, s[24:27], s72 offen lds
    s_addk_i32 m0, 1024
    s_mov_b64 s[28:29], s[6:7]
    s_mov_b32 s30, 6291456
    s_mov_b32 s31, 0x00020000
    buffer_load_dwordx4 v11, s[24:27], s74 offen lds
    s_add_u32 m0, s75, 16384
    s_nop 0
    buffer_load_dwordx4 v12, s[28:31], s73 offen lds
    s_add_u32 m0, s75, 24576
    s_addk_i32 s73, 2048
    buffer_load_dwordx4 v12, s[28:31], s73 offen lds
    s_add_u32 m0, s75, 32768
    s_addk_i32 s73, 2048
    buffer_load_dwordx4 v12, s[28:31], s73 offen lds
    s_cmp_lt_u32 s16, 4
    s_cbranch_scc1 L_compute
    s_bfe_u32 s19, s14, 0x10002
    s_lshl_b32 s19, s19, 2
    s_add_u32 s19, s19, s17
    s_xor_b32 s3, s19, 4
    s_mul_i32 s66, s19, 49152
    s_mul_i32 s67, s3, 49152
    s_lshl_b32 s68, s19, 10
    s_add_u32 s68, s68, 16384
    s_lshl_b32 s69, s3, 10
    s_add_u32 s69, s69, 16384
    s_lshl_b32 s70, s17, 16
    s_lshl_b32 s71, s17, 12
    s_add_u32 s72, s64, 1
    s_and_b32 s72, s72, 3
    s_add_u32 s73, s65, 0
    s_and_b32 s73, s73, 15
    s_add_u32 s72, s72, s73
    s_mul_i32 s73, s72, 393216
    s_lshl_b32 s72, s72, 7
    s_add_u32 s74, s72, s70
    s_add_u32 s75, s73, s66
    s_add_u32 s76, s73, s67
    s_add_u32 m0, s71, 40960
    s_add_u32 s77, s74, 0
    buffer_load_dwordx4 v10, s[24:27], s77 offen lds
    s_add_u32 m0, s71, 41984
    s_add_u32 s77, s74, 16384
    buffer_load_dwordx4 v11, s[24:27], s77 offen lds
    s_add_u32 m0, s71, 43008
    s_add_u32 s77, s74, 32768
    buffer_load_dwordx4 v10, s[24:27], s77 offen lds
    s_add_u32 m0, s71, 44032
    s_add_u32 s77, s74, 49152
    buffer_load_dwordx4 v11, s[24:27], s77 offen lds
    s_add_u32 m0, s68, 40960
    s_add_u32 s77, s75, 0
    buffer_load_dwordx4 v12, s[28:31], s77 offen lds
    s_add_u32 m0, s68, 49152
    s_add_u32 s77, s75, 2048
    buffer_load_dwordx4 v12, s[28:31], s77 offen lds
    s_add_u32 m0, s68, 57344
    s_add_u32 s77, s75, 4096
    buffer_load_dwordx4 v12, s[28:31], s77 offen lds
    s_add_u32 m0, s69, 40960
    s_add_u32 s77, s76, 0
    buffer_load_dwordx4 v12, s[28:31], s77 offen lds
    s_mov_b64 s[32:33], s[98:99]
    s_mov_b32 s34, 16777216
    s_mov_b32 s35, 0x00020000
    s_mov_b64 s[36:37], s[96:97]
    s_mov_b32 s38, 256
    s_mov_b32 s39, 0x00020000
    s_mov_b64 s[40:41], s[84:85]
    s_mov_b32 s42, 2048
    s_mov_b32 s43, 0x00020000
    s_mov_b64 s[44:45], s[92:93]
    s_mov_b32 s46, 2048
    s_mov_b32 s47, 0x00020000
    s_mov_b64 s[48:49], s[86:87]
    s_mov_b32 s50, 7340032
    s_mov_b32 s51, 0x00020000
    s_mov_b64 s[52:53], s[88:89]
    s_mov_b32 s54, 7340032
    s_mov_b32 s55, 0x00020000
    s_mov_b64 s[56:57], s[90:91]
    s_mov_b32 s58, 7340032
    s_mov_b32 s59, 0x00020000
    s_mov_b64 s[60:61], s[10:11]
    s_mov_b32 s62, 2097152
    s_mov_b32 s63, 0x00020000
    s_mov_b32 s79, 0
    v_mov_b32 v13, 0
    v_lshlrev_b32 v3, 4, v2
    v_lshrrev_b32 v9, 4, v2
    v_and_b32 v8, 15, v2
    v_mul_u32_u24 v15, 7168, v9
    v_lshl_add_u32 v15, v8, 4, v15
    v_lshlrev_b32 v16, 11, v9
    v_lshl_add_u32 v16, v8, 4, v16
    v_lshrrev_b32 v19, 3, v2
    v_and_b32 v20, 7, v2
    v_lshlrev_b32 v17, 11, v19
    v_lshl_add_u32 v17, v20, 4, v17
    v_lshlrev_b32 v21, 1, v9
    v_xor_b32 v21, v20, v21
    v_lshlrev_b32 v18, 7, v19
    v_lshl_add_u32 v18, v21, 4, v18
    s_lshl_b32 s19, s17, 10
    s_add_u32 s19, s19, 32768
    v_add_u32 v18, s19, v18
    v_add_u32 v22, 65536, v18
    v_mov_b32 v23, 0xffff
    v_mov_b32 v24, 0xffff0000
    v_cmp_eq_u32 vcc, 0, v8
    s_nop 1
    v_cndmask_b32 v25, 0, v23, vcc
    v_cmp_eq_u32 vcc, 1, v8
    s_nop 1
    v_cndmask_b32 v4, v25, v24, vcc
    v_cmp_eq_u32 vcc, 2, v8
    s_nop 1
    v_cndmask_b32 v25, 0, v23, vcc
    v_cmp_eq_u32 vcc, 3, v8
    s_nop 1
    v_cndmask_b32 v5, v25, v24, vcc
    v_cmp_eq_u32 vcc, 4, v8
    s_nop 1
    v_cndmask_b32 v25, 0, v23, vcc
    v_cmp_eq_u32 vcc, 5, v8
    s_nop 1
    v_cndmask_b32 v6, v25, v24, vcc
    v_cmp_eq_u32 vcc, 6, v8
    s_nop 1
    v_cndmask_b32 v25, 0, v23, vcc
    v_cmp_eq_u32 vcc, 7, v8
    s_nop 1
    v_cndmask_b32 v7, v25, v24, vcc
    v_mov_b32 v23, 0x3ff
    s_getreg_b32 s23, hwreg(HW_REG_XCC_ID, 0, 4)
    v_and_b32 v36, 3, v2
    v_lshlrev_b32 v36, 2, v36
    v_mov_b32 v37, 0x7fc17fc1
    s_cmp_lt_u32 s2, 224
    s_cselect_b32 s50, s50, 0
    s_cselect_b32 s54, s54, 0
    s_lshl_b32 s0, s12, 7
    s_lshl_b32 s19, s17, 5
    s_add_u32 s0, s0, s19
    s_mul_i32 s1, s0, 7168
    s_lshl_b32 s19, s13, 8
    s_add_u32 s1, s1, s19
    s_waitcnt vmcnt(8)
    s_barrier
    s_add_u32 m0, s69, 49152
    s_add_u32 s77, s76, 2048
    buffer_load_dwordx4 v12, s[28:31], s77 offen lds
    s_add_u32 m0, s69, 57344
    s_add_u32 s77, s76, 4096
    buffer_load_dwordx4 v12, s[28:31], s77 offen lds
    s_add_u32 s72, s64, 2
    s_and_b32 s72, s72, 3
    s_add_u32 s73, s65, 0
    s_and_b32 s73, s73, 15
    s_add_u32 s72, s72, s73
    s_mul_i32 s73, s72, 393216
    s_lshl_b32 s72, s72, 7
    s_add_u32 s74, s72, s70
    s_add_u32 s75, s73, s66
    s_add_u32 s76, s73, s67
    s_add_u32 m0, s71, 81920
    s_add_u32 s77, s74, 0
    buffer_load_dwordx4 v10, s[24:27], s77 offen lds
    s_add_u32 m0, s71, 82944
    s_add_u32 s77, s74, 16384
    buffer_load_dwordx4 v11, s[24:27], s77 offen lds
    s_add_u32 m0, s71, 83968
    s_add_u32 s77, s74, 32768
    buffer_load_dwordx4 v10, s[24:27], s77 offen lds
    s_add_u32 m0, s71, 84992
    s_add_u32 s77, s74, 49152
    buffer_load_dwordx4 v11, s[24:27], s77 offen lds
    s_add_u32 m0, s68, 81920
    s_add_u32 s77, s75, 0
    buffer_load_dwordx4 v12, s[28:31], s77 offen lds
    s_add_u32 m0, s68, 90112
    s_add_u32 s77, s75, 2048
    buffer_load_dwordx4 v12, s[28:31], s77 offen lds
    s_add_u32 m0, s68, 98304
    s_add_u32 s77, s75, 4096
    buffer_load_dwordx4 v12, s[28:31], s77 offen lds
    s_add_u32 m0, s69, 81920
    s_add_u32 s77, s76, 0
    buffer_load_dwordx4 v12, s[28:31], s77 offen lds
    s_add_u32 m0, s69, 90112
    s_add_u32 s77, s76, 2048
    buffer_load_dwordx4 v12, s[28:31], s77 offen lds
    s_lshl_b32 s18, s14, 7
    s_lshl_b32 s19, s15, 3
    s_add_u32 s18, s18, s19
    s_lshl_b32 s19, s17, 1
    s_add_u32 s18, s18, s19
    s_lshl_b32 s19, s18, 11
    buffer_load_dwordx4 v[40:43], v3, s[24:27], s19 offen offset:0
    buffer_load_dwordx4 v[44:47], v3, s[24:27], s19 offen offset:1024
    buffer_load_dwordx4 v[48:51], v3, s[24:27], s19 offen offset:2048
    buffer_load_dwordx4 v[52:55], v3, s[24:27], s19 offen offset:3072
    buffer_load_dwordx4 v[56:59], v3, s[40:43], 0 offen offset:0
    buffer_load_dwordx4 v[60:63], v3, s[40:43], 0 offen offset:1024
    buffer_load_dwordx4 v[64:67], v3, s[44:47], 0 offen offset:0
    buffer_load_dwordx4 v[68:71], v3, s[44:47], 0 offen offset:1024
    s_waitcnt vmcnt(17)
    s_barrier
    s_add_u32 m0, s69, 98304
    s_add_u32 s77, s76, 4096
    buffer_load_dwordx4 v12, s[28:31], s77 offen lds
    s_add_u32 s72, s64, 3
    s_and_b32 s72, s72, 3
    s_add_u32 s73, s65, 0
    s_and_b32 s73, s73, 15
    s_add_u32 s72, s72, s73
    s_mul_i32 s73, s72, 393216
    s_lshl_b32 s72, s72, 7
    s_add_u32 s74, s72, s70
    s_add_u32 s75, s73, s66
    s_add_u32 s76, s73, s67
    s_add_u32 m0, s71, 122880
    s_add_u32 s77, s74, 0
    buffer_load_dwordx4 v10, s[24:27], s77 offen lds
    s_add_u32 m0, s71, 123904
    s_add_u32 s77, s74, 16384
    buffer_load_dwordx4 v11, s[24:27], s77 offen lds
    s_add_u32 m0, s71, 124928
    s_add_u32 s77, s74, 32768
    buffer_load_dwordx4 v10, s[24:27], s77 offen lds
    s_add_u32 m0, s71, 125952
    s_add_u32 s77, s74, 49152
    buffer_load_dwordx4 v11, s[24:27], s77 offen lds
    s_add_u32 m0, s68, 122880
    s_add_u32 s77, s75, 0
    buffer_load_dwordx4 v12, s[28:31], s77 offen lds
    s_add_u32 m0, s68, 131072
    s_add_u32 s77, s75, 2048
    buffer_load_dwordx4 v12, s[28:31], s77 offen lds
    s_add_u32 m0, s68, 139264
    s_add_u32 s77, s75, 4096
    buffer_load_dwordx4 v12, s[28:31], s77 offen lds
    s_add_u32 m0, s69, 122880
    s_add_u32 s77, s76, 0
    buffer_load_dwordx4 v12, s[28:31], s77 offen lds
    s_add_u32 m0, s69, 131072
    s_add_u32 s77, s76, 2048
    buffer_load_dwordx4 v12, s[28:31], s77 offen lds
    s_add_u32 m0, s69, 139264
    s_add_u32 s77, s76, 4096
    buffer_load_dwordx4 v12, s[28:31], s77 offen lds
    buffer_load_dword v14, v13, s[36:39], 0 offen offset:4 sc1
    s_waitcnt vmcnt(11)
    s_barrier
    s_add_u32 s72, s64, 0
    s_and_b32 s72, s72, 3
    s_add_u32 s73, s65, 4
    s_and_b32 s73, s73, 15
    s_add_u32 s72, s72, s73
    s_mul_i32 s73, s72, 393216
    s_lshl_b32 s72, s72, 7
    s_add_u32 s74, s72, s70
    s_add_u32 s75, s73, s66
    s_add_u32 s76, s73, s67
    s_add_u32 m0, s71, 0
    s_add_u32 s77, s74, 0
    buffer_load_dwordx4 v10, s[24:27], s77 offen lds
    s_add_u32 m0, s71, 1024
    s_add_u32 s77, s74, 16384
    buffer_load_dwordx4 v11, s[24:27], s77 offen lds
    s_add_u32 m0, s71, 2048
    s_add_u32 s77, s74, 32768
    buffer_load_dwordx4 v10, s[24:27], s77 offen lds
    s_add_u32 m0, s71, 3072
    s_add_u32 s77, s74, 49152
    buffer_load_dwordx4 v11, s[24:27], s77 offen lds
    s_add_u32 m0, s68, 0
    s_add_u32 s77, s75, 0
    buffer_load_dwordx4 v12, s[28:31], s77 offen lds
    s_add_u32 m0, s68, 8192
    s_add_u32 s77, s75, 2048
    buffer_load_dwordx4 v12, s[28:31], s77 offen lds
    s_add_u32 m0, s68, 16384
    s_add_u32 s77, s75, 4096
    buffer_load_dwordx4 v12, s[28:31], s77 offen lds
    s_add_u32 m0, s69, 0
    s_add_u32 s77, s76, 0
    buffer_load_dwordx4 v12, s[28:31], s77 offen lds
    s_add_u32 m0, s69, 8192
    s_add_u32 s77, s76, 2048
    buffer_load_dwordx4 v12, s[28:31], s77 offen lds
    s_add_u32 m0, s69, 16384
    s_add_u32 s77, s76, 4096
    buffer_load_dwordx4 v12, s[28:31], s77 offen lds
    s_add_u32 s72, s64, 1
    s_and_b32 s72, s72, 3
    s_add_u32 s73, s65, 4
    s_and_b32 s73, s73, 15
    s_add_u32 s72, s72, s73
    s_mul_i32 s73, s72, 393216
    s_lshl_b32 s72, s72, 7
    s_add_u32 s74, s72, s70
    s_add_u32 s75, s73, s66
    s_add_u32 s76, s73, s67
    s_add_u32 m0, s71, 40960
    s_add_u32 s77, s74, 0
    buffer_load_dwordx4 v10, s[24:27], s77 offen lds
    s_add_u32 m0, s71, 41984
    s_add_u32 s77, s74, 16384
    buffer_load_dwordx4 v11, s[24:27], s77 offen lds
    s_add_u32 m0, s71, 43008
    s_add_u32 s77, s74, 32768
    buffer_load_dwordx4 v10, s[24:27], s77 offen lds
    s_add_u32 m0, s71, 44032
    s_add_u32 s77, s74, 49152
    buffer_load_dwordx4 v11, s[24:27], s77 offen lds
    s_add_u32 m0, s68, 40960
    s_add_u32 s77, s75, 0
    buffer_load_dwordx4 v12, s[28:31], s77 offen lds
    s_add_u32 m0, s68, 49152
    s_add_u32 s77, s75, 2048
    buffer_load_dwordx4 v12, s[28:31], s77 offen lds
    s_add_u32 m0, s68, 57344
    s_add_u32 s77, s75, 4096
    buffer_load_dwordx4 v12, s[28:31], s77 offen lds
    s_add_u32 m0, s69, 40960
    s_add_u32 s77, s76, 0
    buffer_load_dwordx4 v12, s[28:31], s77 offen lds
    s_add_u32 m0, s69, 49152
    s_add_u32 s77, s76, 2048
    buffer_load_dwordx4 v12, s[28:31], s77 offen lds
    s_add_u32 m0, s69, 57344
    s_add_u32 s77, s76, 4096
    buffer_load_dwordx4 v12, s[28:31], s77 offen lds
    s_waitcnt vmcnt(21)
    s_barrier
    s_add_u32 s72, s64, 2
    s_and_b32 s72, s72, 3
    s_add_u32 s73, s65, 4
    s_and_b32 s73, s73, 15
    s_add_u32 s72, s72, s73
    s_mul_i32 s73, s72, 393216
    s_lshl_b32 s72, s72, 7
    s_add_u32 s74, s72, s70
    s_add_u32 s75, s73, s66
    s_add_u32 s76, s73, s67
    s_add_u32 m0, s71, 81920
    s_add_u32 s77, s74, 0
    buffer_load_dwordx4 v10, s[24:27], s77 offen lds
    s_add_u32 m0, s71, 82944
    s_add_u32 s77, s74, 16384
    buffer_load_dwordx4 v11, s[24:27], s77 offen lds
    s_add_u32 m0, s71, 83968
    s_add_u32 s77, s74, 32768
    buffer_load_dwordx4 v10, s[24:27], s77 offen lds
    s_add_u32 m0, s71, 84992
    s_add_u32 s77, s74, 49152
    buffer_load_dwordx4 v11, s[24:27], s77 offen lds
    s_add_u32 m0, s68, 81920
    s_add_u32 s77, s75, 0
    buffer_load_dwordx4 v12, s[28:31], s77 offen lds
    s_add_u32 m0, s68, 90112
    s_add_u32 s77, s75, 2048
    buffer_load_dwordx4 v12, s[28:31], s77 offen lds
    s_add_u32 m0, s68, 98304
    s_add_u32 s77, s75, 4096
    buffer_load_dwordx4 v12, s[28:31], s77 offen lds
    s_add_u32 m0, s69, 81920
    s_add_u32 s77, s76, 0
    buffer_load_dwordx4 v12, s[28:31], s77 offen lds
    s_add_u32 m0, s69, 90112
    s_add_u32 s77, s76, 2048
    buffer_load_dwordx4 v12, s[28:31], s77 offen lds
    s_add_u32 m0, s69, 98304
    s_add_u32 s77, s76, 4096
    buffer_load_dwordx4 v12, s[28:31], s77 offen lds
    s_waitcnt vmcnt(20)
    s_barrier
    s_add_u32 s72, s64, 3
    s_and_b32 s72, s72, 3
    s_add_u32 s73, s65, 4
    s_and_b32 s73, s73, 15
    s_add_u32 s72, s72, s73
    s_mul_i32 s73, s72, 393216
    s_lshl_b32 s72, s72, 7
    s_add_u32 s74, s72, s70
    s_add_u32 s75, s73, s66
    s_add_u32 s76, s73, s67
    s_add_u32 m0, s71, 122880
    s_add_u32 s77, s74, 0
    buffer_load_dwordx4 v10, s[24:27], s77 offen lds
    s_add_u32 m0, s71, 123904
    s_add_u32 s77, s74, 16384
    buffer_load_dwordx4 v11, s[24:27], s77 offen lds
    s_add_u32 m0, s71, 124928
    s_add_u32 s77, s74, 32768
    buffer_load_dwordx4 v10, s[24:27], s77 offen lds
    s_add_u32 m0, s71, 125952
    s_add_u32 s77, s74, 49152
    buffer_load_dwordx4 v11, s[24:27], s77 offen lds
    s_add_u32 m0, s68, 122880
    s_add_u32 s77, s75, 0
    buffer_load_dwordx4 v12, s[28:31], s77 offen lds
    s_add_u32 m0, s68, 131072
    s_add_u32 s77, s75, 2048
    buffer_load_dwordx4 v12, s[28:31], s77 offen lds
    s_add_u32 m0, s68, 139264
    s_add_u32 s77, s75, 4096
    buffer_load_dwordx4 v12, s[28:31], s77 offen lds
    s_add_u32 m0, s69, 122880
    s_add_u32 s77, s76, 0
    buffer_load_dwordx4 v12, s[28:31], s77 offen lds
    s_add_u32 m0, s69, 131072
    s_add_u32 s77, s76, 2048
    buffer_load_dwordx4 v12, s[28:31], s77 offen lds
    s_add_u32 m0, s69, 139264
    s_add_u32 s77, s76, 4096
    buffer_load_dwordx4 v12, s[28:31], s77 offen lds
    s_waitcnt vmcnt(52)
    s_waitcnt vmcnt(40)
    v_readfirstlane_b32 s78, v14
L_tg1:
    s_nop 1
    s_cmp_lg_u32 s78, 0
    s_cbranch_scc1 L_tk2
    buffer_load_dword v14, v13, s[36:39], 0 offen offset:4 sc1
    s_waitcnt vmcnt(0)
    v_readfirstlane_b32 s78, v14
    s_add_u32 s79, s79, 1
    s_cmp_lt_u32 s79, 32768
    s_cbranch_scc1 L_tg1
L_tk2:
    s_mul_i32 s80, s78, 0x9e3779b1
    s_lshr_b32 s80, s80, 22
    s_mul_i32 s81, s78, 0x85ebca77
    s_lshr_b32 s81, s81, 22
    s_mul_i32 s82, s78, 0xc2b2ae3d
    s_lshr_b32 s82, s82, 22
    s_mul_i32 s83, s78, 0x27d4eb2f
    s_lshr_b32 s83, s83, 22
    v_and_b32 v72, 0xffff, v64
    v_and_b32 v80, 0xffff0000, v64
    v_and_b32 v73, 0xffff, v65
    v_and_b32 v81, 0xffff0000, v65
    v_dot2_f32_bf16 v92, v40, v72, 0
    v_dot2_f32_bf16 v93, v40, v80, 0
    v_and_b32 v74, 0xffff, v66
    v_and_b32 v82, 0xffff0000, v66
    v_dot2_f32_bf16 v94, v41, v73, 0
    v_dot2_f32_bf16 v95, v41, v81, 0
    v_and_b32 v75, 0xffff, v67
    v_and_b32 v83, 0xffff0000, v67
    v_cvt_pk_bf16_f32 v92, v92, v93
    v_dot2_f32_bf16 v96, v42, v74, 0
    v_dot2_f32_bf16 v97, v42, v82, 0
    s_mov_b32 s19, 0x3f803f80
    v_and_b32 v76, 0xffff, v68
    v_and_b32 v84, 0xffff0000, v68
    v_dot2_f32_bf16 v89, v92, s19, 0
    v_cvt_pk_bf16_f32 v94, v94, v95
    v_dot2_f32_bf16 v98, v43, v75, 0
    v_dot2_f32_bf16 v99, v43, v83, 0
    v_and_b32 v77, 0xffff, v69
    v_and_b32 v85, 0xffff0000, v69
    v_dot2_f32_bf16 v89, v94, s19, v89
    v_cvt_pk_bf16_f32 v96, v96, v97
    v_dot2_f32_bf16 v92, v44, v76, 0
    v_dot2_f32_bf16 v93, v44, v84, 0
    v_and_b32 v78, 0xffff, v70
    v_and_b32 v86, 0xffff0000, v70
    v_dot2_f32_bf16 v89, v96, s19, v89
    v_cvt_pk_bf16_f32 v98, v98, v99
    v_dot2_f32_bf16 v94, v45, v77, 0
    v_dot2_f32_bf16 v95, v45, v85, 0
    v_and_b32 v79, 0xffff, v71
    v_and_b32 v87, 0xffff0000, v71
    v_dot2_f32_bf16 v89, v98, s19, v89
    v_cvt_pk_bf16_f32 v92, v92, v93
    v_dot2_f32_bf16 v96, v46, v78, 0
    v_dot2_f32_bf16 v97, v46, v86, 0
    v_dot2_f32_bf16 v89, v92, s19, v89
    v_cvt_pk_bf16_f32 v94, v94, v95
    v_dot2_f32_bf16 v98, v47, v79, 0
    v_dot2_f32_bf16 v99, v47, v87, 0
    v_dot2_f32_bf16 v92, v48, v72, 0
    v_dot2_f32_bf16 v93, v48, v80, 0
    v_dot2_f32_bf16 v89, v94, s19, v89
    v_cvt_pk_bf16_f32 v96, v96, v97
    v_dot2_f32_bf16 v94, v49, v73, 0
    v_dot2_f32_bf16 v95, v49, v81, 0
    v_dot2_f32_bf16 v89, v96, s19, v89
    v_cvt_pk_bf16_f32 v98, v98, v99
    v_cvt_pk_bf16_f32 v92, v92, v93
    v_dot2_f32_bf16 v96, v50, v74, 0
    v_dot2_f32_bf16 v97, v50, v82, 0
    v_dot2_f32_bf16 v89, v98, s19, v89
    v_dot2_f32_bf16 v88, v40, v56, 0
    v_dot2_f32_bf16 v90, v48, v56, 0
    v_dot2_f32_bf16 v91, v92, s19, 0
    v_cvt_pk_bf16_f32 v94, v94, v95
    v_dot2_f32_bf16 v98, v51, v75, 0
    v_dot2_f32_bf16 v99, v51, v83, 0
    v_dot2_f32_bf16 v88, v41, v57, v88
    v_dot2_f32_bf16 v90, v49, v57, v90
    v_dot2_f32_bf16 v91, v94, s19, v91
    v_cvt_pk_bf16_f32 v96, v96, v97
    v_dot2_f32_bf16 v92, v52, v76, 0
    v_dot2_f32_bf16 v93, v52, v84, 0
    v_dot2_f32_bf16 v88, v42, v58, v88
    v_dot2_f32_bf16 v90, v50, v58, v90
    v_dot2_f32_bf16 v91, v96, s19, v91
    v_cvt_pk_bf16_f32 v98, v98, v99
    v_dot2_f32_bf16 v94, v53, v77, 0
    v_dot2_f32_bf16 v95, v53, v85, 0
    v_dot2_f32_bf16 v88, v43, v59, v88
    v_dot2_f32_bf16 v90, v51, v59, v90
    v_dot2_f32_bf16 v91, v98, s19, v91
    v_cvt_pk_bf16_f32 v92, v92, v93
    v_dot2_f32_bf16 v96, v54, v78, 0
    v_dot2_f32_bf16 v97, v54, v86, 0
    v_dot2_f32_bf16 v88, v44, v60, v88
    v_dot2_f32_bf16 v90, v52, v60, v90
    v_dot2_f32_bf16 v91, v92, s19, v91
    v_cvt_pk_bf16_f32 v94, v94, v95
    v_dot2_f32_bf16 v98, v55, v79, 0
    v_dot2_f32_bf16 v99, v55, v87, 0
    v_dot2_f32_bf16 v88, v45, v61, v88
    v_dot2_f32_bf16 v90, v53, v61, v90
    v_dot2_f32_bf16 v91, v94, s19, v91
    v_cvt_pk_bf16_f32 v96, v96, v97
    v_dot2_f32_bf16 v88, v46, v62, v88
    v_dot2_f32_bf16 v90, v54, v62, v90
    v_dot2_f32_bf16 v91, v96, s19, v91
    v_cvt_pk_bf16_f32 v98, v98, v99
    v_dot2_f32_bf16 v88, v47, v63, v88
    v_dot2_f32_bf16 v90, v55, v63, v90
    v_dot2_f32_bf16 v91, v98, s19, v91
    s_nop 1
    v_permlane32_swap_b32 v88, v90
    v_permlane32_swap_b32 v89, v91
    v_add_f32 v88, v88, v90
    v_add_f32 v89, v89, v91
    v_mov_b32 v91, s78
    s_nop 0
    v_permlane16_swap_b32 v88, v89
    v_add_f32 v88, v88, v89
    s_nop 1
    v_add_f32_dpp v88, v88, v88 row_ror:8 row_mask:0xf bank_mask:0xf
    s_nop 1
    v_add_f32_dpp v88, v88, v88 row_ror:4 row_mask:0xf bank_mask:0xf
    s_nop 1
    v_add_f32_dpp v88, v88, v88 row_ror:2 row_mask:0xf bank_mask:0xf
    s_nop 1
    v_add_f32_dpp v88, v88, v88 row_ror:1 row_mask:0xf bank_mask:0xf
    v_cvt_pk_bf16_f32 v88, v88, v88
    v_ashrrev_i32 v90, 31, v88
    v_and_b32 v89, 0xffff0000, v88
    v_or_b32 v90, 0x80000000, v90
    v_mul_f32 v89, 0xbfb8aa3b, v89
    v_xor_b32 v90, v90, v88
    v_exp_f32 v89, v89
    v_lshrrev_b32 v90, 16, v90
    v_add_f32 v89, 1.0, v89
    v_readlane_b32 s84, v90, 0
    v_readlane_b32 s85, v90, 32
    v_rcp_f32 v89, v89
    s_lshl_b32 s84, s84, 11
    s_lshl_b32 s85, s85, 11
    s_sub_u32 s3, 2047, s18
    v_cvt_pk_bf16_f32 v89, v89, v89
    s_or_b32 s84, s84, s3
    s_sub_u32 s3, s3, 1
    s_or_b32 s85, s85, s3
    v_readlane_b32 s20, v89, 16
    s_max_u32 s84, s84, s85
    v_readlane_b32 s21, v89, 48
    s_lshl_b32 s84, s84, 4
    s_or_b32 s84, s84, s23
    s_and_b32 s20, s20, 0xffff
    s_and_b32 s21, s21, 0xffff0000
    s_or_b32 s20, s20, s21
    s_lshl_b32 s3, s18, 2
    s_add_u32 s21, s3, 4472832
    s_add_u32 s3, s3, 4464640
    v_mov_b32 v88, s84
    v_mov_b32 v89, s78
    v_mov_b32 v90, s20
    s_mov_b64 exec, 1
    buffer_store_dwordx2 v[88:89], v13, s[32:35], s3 offen sc1
    buffer_store_dwordx2 v[90:91], v13, s[32:35], s21 offen sc1
    s_mov_b64 exec, -1
    s_waitcnt vmcnt(22)
    s_barrier
    s_add_u32 s72, s64, 0
    s_and_b32 s72, s72, 3
    s_add_u32 s73, s65, 8
    s_and_b32 s73, s73, 15
    s_add_u32 s72, s72, s73
    s_mul_i32 s73, s72, 393216
    s_lshl_b32 s72, s72, 7
    s_add_u32 s74, s72, s70
    s_add_u32 s75, s73, s66
    s_add_u32 s76, s73, s67
    s_add_u32 m0, s71, 0
    s_add_u32 s77, s74, 0
    buffer_load_dwordx4 v10, s[24:27], s77 offen lds
    s_add_u32 m0, s71, 1024
    s_add_u32 s77, s74, 16384
    buffer_load_dwordx4 v11, s[24:27], s77 offen lds
    s_add_u32 m0, s71, 2048
    s_add_u32 s77, s74, 32768
    buffer_load_dwordx4 v10, s[24:27], s77 offen lds
    s_add_u32 m0, s71, 3072
    s_add_u32 s77, s74, 49152
    buffer_load_dwordx4 v11, s[24:27], s77 offen lds
    s_add_u32 m0, s68, 0
    s_add_u32 s77, s75, 0
    buffer_load_dwordx4 v12, s[28:31], s77 offen lds
    s_add_u32 m0, s68, 8192
    s_add_u32 s77, s75, 2048
    buffer_load_dwordx4 v12, s[28:31], s77 offen lds
    s_add_u32 m0, s68, 16384
    s_add_u32 s77, s75, 4096
    buffer_load_dwordx4 v12, s[28:31], s77 offen lds
    s_add_u32 m0, s69, 0
    s_add_u32 s77, s76, 0
    buffer_load_dwordx4 v12, s[28:31], s77 offen lds
    s_add_u32 m0, s69, 8192
    s_add_u32 s77, s76, 2048
    buffer_load_dwordx4 v12, s[28:31], s77 offen lds
    s_add_u32 m0, s69, 16384
    s_add_u32 s77, s76, 4096
    buffer_load_dwordx4 v12, s[28:31], s77 offen lds
    s_waitcnt vmcnt(22)
    s_barrier
    s_add_u32 s72, s64, 1
    s_and_b32 s72, s72, 3
    s_add_u32 s73, s65, 8
    s_and_b32 s73, s73, 15
    s_add_u32 s72, s72, s73
    s_mul_i32 s73, s72, 393216
    s_lshl_b32 s72, s72, 7
    s_add_u32 s74, s72, s70
    s_add_u32 s75, s73, s66
    s_add_u32 s76, s73, s67
    s_add_u32 m0, s71, 40960
    s_add_u32 s77, s74, 0
    buffer_load_dwordx4 v10, s[24:27], s77 offen lds
    s_add_u32 m0, s71, 41984
    s_add_u32 s77, s74, 16384
    buffer_load_dwordx4 v11, s[24:27], s77 offen lds
    s_add_u32 m0, s71, 43008
    s_add_u32 s77, s74, 32768
    buffer_load_dwordx4 v10, s[24:27], s77 offen lds
    s_add_u32 m0, s71, 44032
    s_add_u32 s77, s74, 49152
    buffer_load_dwordx4 v11, s[24:27], s77 offen lds
    s_add_u32 m0, s68, 40960
    s_add_u32 s77, s75, 0
    buffer_load_dwordx4 v12, s[28:31], s77 offen lds
    s_add_u32 m0, s68, 49152
    s_add_u32 s77, s75, 2048
    buffer_load_dwordx4 v12, s[28:31], s77 offen lds
    s_add_u32 m0, s68, 57344
    s_add_u32 s77, s75, 4096
    buffer_load_dwordx4 v12, s[28:31], s77 offen lds
    s_add_u32 m0, s69, 40960
    s_add_u32 s77, s76, 0
    buffer_load_dwordx4 v12, s[28:31], s77 offen lds
    s_add_u32 m0, s69, 49152
    s_add_u32 s77, s76, 2048
    buffer_load_dwordx4 v12, s[28:31], s77 offen lds
    s_add_u32 m0, s69, 57344
    s_add_u32 s77, s76, 4096
    buffer_load_dwordx4 v12, s[28:31], s77 offen lds
    s_waitcnt vmcnt(22)
    s_barrier
    s_add_u32 s72, s64, 2
    s_and_b32 s72, s72, 3
    s_add_u32 s73, s65, 8
    s_and_b32 s73, s73, 15
    s_add_u32 s72, s72, s73
    s_mul_i32 s73, s72, 393216
    s_lshl_b32 s72, s72, 7
    s_add_u32 s74, s72, s70
    s_add_u32 s75, s73, s66
    s_add_u32 s76, s73, s67
    s_add_u32 m0, s71, 81920
    s_add_u32 s77, s74, 0
    buffer_load_dwordx4 v10, s[24:27], s77 offen lds
    s_add_u32 m0, s71, 82944
    s_add_u32 s77, s74, 16384
    buffer_load_dwordx4 v11, s[24:27], s77 offen lds
    s_add_u32 m0, s71, 83968
    s_add_u32 s77, s74, 32768
    buffer_load_dwordx4 v10, s[24:27], s77 offen lds
    s_add_u32 m0, s71, 84992
    s_add_u32 s77, s74, 49152
    buffer_load_dwordx4 v11, s[24:27], s77 offen lds
    s_add_u32 m0, s68, 81920
    s_add_u32 s77, s75, 0
    buffer_load_dwordx4 v12, s[28:31], s77 offen lds
    s_add_u32 m0, s68, 90112
    s_add_u32 s77, s75, 2048
    buffer_load_dwordx4 v12, s[28:31], s77 offen lds
    s_add_u32 m0, s68, 98304
    s_add_u32 s77, s75, 4096
    buffer_load_dwordx4 v12, s[28:31], s77 offen lds
    s_add_u32 m0, s69, 81920
    s_add_u32 s77, s76, 0
    buffer_load_dwordx4 v12, s[28:31], s77 offen lds
    s_add_u32 m0, s69, 90112
    s_add_u32 s77, s76, 2048
    buffer_load_dwordx4 v12, s[28:31], s77 offen lds
    s_add_u32 m0, s69, 98304
    s_add_u32 s77, s76, 4096
    buffer_load_dwordx4 v12, s[28:31], s77 offen lds
    s_waitcnt vmcnt(20)
    s_barrier
    s_add_u32 s72, s64, 3
    s_and_b32 s72, s72, 3
    s_add_u32 s73, s65, 8
    s_and_b32 s73, s73, 15
    s_add_u32 s72, s72, s73
    s_mul_i32 s73, s72, 393216
    s_lshl_b32 s72, s72, 7
    s_add_u32 s74, s72, s70
    s_add_u32 s75, s73, s66
    s_add_u32 s76, s73, s67
    s_add_u32 m0, s71, 122880
    s_add_u32 s77, s74, 0
    buffer_load_dwordx4 v10, s[24:27], s77 offen lds
    s_add_u32 m0, s71, 123904
    s_add_u32 s77, s74, 16384
    buffer_load_dwordx4 v11, s[24:27], s77 offen lds
    s_add_u32 m0, s71, 124928
    s_add_u32 s77, s74, 32768
    buffer_load_dwordx4 v10, s[24:27], s77 offen lds
    s_add_u32 m0, s71, 125952
    s_add_u32 s77, s74, 49152
    buffer_load_dwordx4 v11, s[24:27], s77 offen lds
    s_add_u32 m0, s68, 122880
    s_add_u32 s77, s75, 0
    buffer_load_dwordx4 v12, s[28:31], s77 offen lds
    s_add_u32 m0, s68, 131072
    s_add_u32 s77, s75, 2048
    buffer_load_dwordx4 v12, s[28:31], s77 offen lds
    s_add_u32 m0, s68, 139264
    s_add_u32 s77, s75, 4096
    buffer_load_dwordx4 v12, s[28:31], s77 offen lds
    s_add_u32 m0, s69, 122880
    s_add_u32 s77, s76, 0
    buffer_load_dwordx4 v12, s[28:31], s77 offen lds
    s_add_u32 m0, s69, 131072
    s_add_u32 s77, s76, 2048
    buffer_load_dwordx4 v12, s[28:31], s77 offen lds
    s_add_u32 m0, s69, 139264
    s_add_u32 s77, s76, 4096
    buffer_load_dwordx4 v12, s[28:31], s77 offen lds
    s_waitcnt vmcnt(20)
    s_barrier
    s_add_u32 s72, s64, 0
    s_and_b32 s72, s72, 3
    s_add_u32 s73, s65, 12
    s_and_b32 s73, s73, 15
    s_add_u32 s72, s72, s73
    s_mul_i32 s73, s72, 393216
    s_lshl_b32 s72, s72, 7
    s_add_u32 s74, s72, s70
    s_add_u32 s75, s73, s66
    s_add_u32 s76, s73, s67
    s_add_u32 m0, s71, 0
    s_add_u32 s77, s74, 0
    buffer_load_dwordx4 v10, s[24:27], s77 offen lds
    s_add_u32 m0, s71, 1024
    s_add_u32 s77, s74, 16384
    buffer_load_dwordx4 v11, s[24:27], s77 offen lds
    s_add_u32 m0, s71, 2048
    s_add_u32 s77, s74, 32768
    buffer_load_dwordx4 v10, s[24:27], s77 offen lds
    s_add_u32 m0, s71, 3072
    s_add_u32 s77, s74, 49152
    buffer_load_dwordx4 v11, s[24:27], s77 offen lds
    s_add_u32 m0, s68, 0
    s_add_u32 s77, s75, 0
    buffer_load_dwordx4 v12, s[28:31], s77 offen lds
    s_add_u32 m0, s68, 8192
    s_add_u32 s77, s75, 2048
    buffer_load_dwordx4 v12, s[28:31], s77 offen lds
    s_add_u32 m0, s68, 16384
    s_add_u32 s77, s75, 4096
    buffer_load_dwordx4 v12, s[28:31], s77 offen lds
    s_add_u32 m0, s69, 0
    s_add_u32 s77, s76, 0
    buffer_load_dwordx4 v12, s[28:31], s77 offen lds
    s_add_u32 m0, s69, 8192
    s_add_u32 s77, s76, 2048
    buffer_load_dwordx4 v12, s[28:31], s77 offen lds
    s_add_u32 m0, s69, 16384
    s_add_u32 s77, s76, 4096
    buffer_load_dwordx4 v12, s[28:31], s77 offen lds
    s_waitcnt vmcnt(20)
    s_barrier
    s_add_u32 s72, s64, 1
    s_and_b32 s72, s72, 3
    s_add_u32 s73, s65, 12
    s_and_b32 s73, s73, 15
    s_add_u32 s72, s72, s73
    s_mul_i32 s73, s72, 393216
    s_lshl_b32 s72, s72, 7
    s_add_u32 s74, s72, s70
    s_add_u32 s75, s73, s66
    s_add_u32 s76, s73, s67
    s_add_u32 m0, s71, 40960
    s_add_u32 s77, s74, 0
    buffer_load_dwordx4 v10, s[24:27], s77 offen lds
    s_add_u32 m0, s71, 41984
    s_add_u32 s77, s74, 16384
    buffer_load_dwordx4 v11, s[24:27], s77 offen lds
    s_add_u32 m0, s71, 43008
    s_add_u32 s77, s74, 32768
    buffer_load_dwordx4 v10, s[24:27], s77 offen lds
    s_add_u32 m0, s71, 44032
    s_add_u32 s77, s74, 49152
    buffer_load_dwordx4 v11, s[24:27], s77 offen lds
    s_add_u32 m0, s68, 40960
    s_add_u32 s77, s75, 0
    buffer_load_dwordx4 v12, s[28:31], s77 offen lds
    s_add_u32 m0, s68, 49152
    s_add_u32 s77, s75, 2048
    buffer_load_dwordx4 v12, s[28:31], s77 offen lds
    s_add_u32 m0, s68, 57344
    s_add_u32 s77, s75, 4096
    buffer_load_dwordx4 v12, s[28:31], s77 offen lds
    s_add_u32 m0, s69, 40960
    s_add_u32 s77, s76, 0
    buffer_load_dwordx4 v12, s[28:31], s77 offen lds
    s_add_u32 m0, s69, 49152
    s_add_u32 s77, s76, 2048
    buffer_load_dwordx4 v12, s[28:31], s77 offen lds
    s_add_u32 m0, s69, 57344
    s_add_u32 s77, s76, 4096
    buffer_load_dwordx4 v12, s[28:31], s77 offen lds
    s_waitcnt vmcnt(20)
    s_barrier
    s_add_u32 s72, s64, 2
    s_and_b32 s72, s72, 3
    s_add_u32 s73, s65, 12
    s_and_b32 s73, s73, 15
    s_add_u32 s72, s72, s73
    s_mul_i32 s73, s72, 393216
    s_lshl_b32 s72, s72, 7
    s_add_u32 s74, s72, s70
    s_add_u32 s75, s73, s66
    s_add_u32 s76, s73, s67
    s_add_u32 m0, s71, 81920
    s_add_u32 s77, s74, 0
    buffer_load_dwordx4 v10, s[24:27], s77 offen lds
    s_add_u32 m0, s71, 82944
    s_add_u32 s77, s74, 16384
    buffer_load_dwordx4 v11, s[24:27], s77 offen lds
    s_add_u32 m0, s71, 83968
    s_add_u32 s77, s74, 32768
    buffer_load_dwordx4 v10, s[24:27], s77 offen lds
    s_add_u32 m0, s71, 84992
    s_add_u32 s77, s74, 49152
    buffer_load_dwordx4 v11, s[24:27], s77 offen lds
    s_add_u32 m0, s68, 81920
    s_add_u32 s77, s75, 0
    buffer_load_dwordx4 v12, s[28:31], s77 offen lds
    s_add_u32 m0, s68, 90112
    s_add_u32 s77, s75, 2048
    buffer_load_dwordx4 v12, s[28:31], s77 offen lds
    s_add_u32 m0, s68, 98304
    s_add_u32 s77, s75, 4096
    buffer_load_dwordx4 v12, s[28:31], s77 offen lds
    s_add_u32 m0, s69, 81920
    s_add_u32 s77, s76, 0
    buffer_load_dwordx4 v12, s[28:31], s77 offen lds
    s_add_u32 m0, s69, 90112
    s_add_u32 s77, s76, 2048
    buffer_load_dwordx4 v12, s[28:31], s77 offen lds
    s_add_u32 m0, s69, 98304
    s_add_u32 s77, s76, 4096
    buffer_load_dwordx4 v12, s[28:31], s77 offen lds
    s_lshl_b32 s19, s17, 11
    s_add_u32 s19, s19, 4464640
    buffer_load_dwordx4 v[28:31], v3, s[32:35], s19 offen offset:0 sc1
    buffer_load_dwordx4 v[32:35], v3, s[32:35], s19 offen offset:1024 sc1
    s_waitcnt vmcnt(22)
    s_barrier
    s_add_u32 s72, s64, 3
    s_and_b32 s72, s72, 3
    s_add_u32 s73, s65, 12
    s_and_b32 s73, s73, 15
    s_add_u32 s72, s72, s73
    s_mul_i32 s73, s72, 393216
    s_lshl_b32 s72, s72, 7
    s_add_u32 s74, s72, s70
    s_add_u32 s75, s73, s66
    s_add_u32 s76, s73, s67
    s_add_u32 m0, s71, 122880
    s_add_u32 s77, s74, 0
    buffer_load_dwordx4 v10, s[24:27], s77 offen lds
    s_add_u32 m0, s71, 123904
    s_add_u32 s77, s74, 16384
    buffer_load_dwordx4 v11, s[24:27], s77 offen lds
    s_add_u32 m0, s71, 124928
    s_add_u32 s77, s74, 32768
    buffer_load_dwordx4 v10, s[24:27], s77 offen lds
    s_add_u32 m0, s71, 125952
    s_add_u32 s77, s74, 49152
    buffer_load_dwordx4 v11, s[24:27], s77 offen lds
    s_add_u32 m0, s68, 122880
    s_add_u32 s77, s75, 0
    buffer_load_dwordx4 v12, s[28:31], s77 offen lds
    s_add_u32 m0, s68, 131072
    s_add_u32 s77, s75, 2048
    buffer_load_dwordx4 v12, s[28:31], s77 offen lds
    s_add_u32 m0, s68, 139264
    s_add_u32 s77, s75, 4096
    buffer_load_dwordx4 v12, s[28:31], s77 offen lds
    s_add_u32 m0, s69, 122880
    s_add_u32 s77, s76, 0
    buffer_load_dwordx4 v12, s[28:31], s77 offen lds
    s_add_u32 m0, s69, 131072
    s_add_u32 s77, s76, 2048
    buffer_load_dwordx4 v12, s[28:31], s77 offen lds
    s_add_u32 m0, s69, 139264
    s_add_u32 s77, s76, 4096
    buffer_load_dwordx4 v12, s[28:31], s77 offen lds
    s_waitcnt vmcnt(22)
    s_barrier
    buffer_load_dwordx4 v[100:103], v15, s[48:51], s1 offen nt
    buffer_load_dwordx4 v[132:135], v15, s[52:55], s1 offen nt
    s_add_u32 s1, s1, 28672
    buffer_load_dwordx4 v[104:107], v15, s[48:51], s1 offen nt
    buffer_load_dwordx4 v[136:139], v15, s[52:55], s1 offen nt
    s_add_u32 s1, s1, 28672
    buffer_load_dwordx4 v[108:111], v15, s[48:51], s1 offen nt
    buffer_load_dwordx4 v[140:143], v15, s[52:55], s1 offen nt
    s_add_u32 s1, s1, 28672
    s_mul_i32 s73, s13, 112
    s_mul_i32 s19, s17, 28
    s_add_u32 s73, s73, s19
    s_lshl_b32 s74, s73, 11
    s_lshl_b32 s19, s12, 8
    s_add_u32 s74, s74, s19
    s_lshr_b32 s67, s12, 2
    s_lshl_b32 s67, s67, 3
    s_lshr_b32 s19, s13, 2
    s_add_u32 s67, s67, s19
    s_lshl_b32 s68, s19, 2
    s_lshl_b32 s69, s67, 7
    s_lshl_b32 s19, s17, 14
    s_add_u32 s69, s69, s19
    s_waitcnt vmcnt(6)
    s_barrier
    s_cmp_lg_u32 s17, 0
    s_cbranch_scc1 L_z3
    v_mov_b32 v40, 0
    v_mov_b32 v41, 0
    v_mov_b32 v42, 0
    v_mov_b32 v43, 0
    s_mov_b64 exec, 15
    ds_write_b128 v3, v[40:43] offset:0
    ds_write_b32 v13, v37 offset:128
    s_mov_b64 exec, -1
L_z3:
    buffer_load_dwordx4 v[112:115], v15, s[48:51], s1 offen nt
    buffer_load_dwordx4 v[144:147], v15, s[52:55], s1 offen nt
    s_add_u32 s1, s1, 28672
    buffer_load_dwordx4 v[116:119], v15, s[48:51], s1 offen nt
    buffer_load_dwordx4 v[148:151], v15, s[52:55], s1 offen nt
    s_add_u32 s1, s1, 28672
    buffer_load_dwordx4 v[120:123], v15, s[48:51], s1 offen nt
    buffer_load_dwordx4 v[152:155], v15, s[52:55], s1 offen nt
    s_add_u32 s1, s1, 28672
    buffer_load_dwordx4 v[124:127], v15, s[48:51], s1 offen nt
    buffer_load_dwordx4 v[156:159], v15, s[52:55], s1 offen nt
    s_add_u32 s1, s1, 28672
    buffer_load_dwordx4 v[128:131], v15, s[48:51], s1 offen nt
    buffer_load_dwordx4 v[160:163], v15, s[52:55], s1 offen nt
    s_add_u32 s1, s1, 28672
    s_waitcnt vmcnt(26)
L_kp4:
    v_xor_b32 v29, s78, v29
    v_mov_b32 v80, v28
    v_xor_b32 v31, s78, v31
    v_mov_b32 v81, v30
    v_xor_b32 v33, s78, v33
    v_mov_b32 v82, v32
    v_xor_b32 v35, s78, v35
    v_mov_b32 v83, v34
    v_or3_b32 v29, v29, v31, v33
    v_max3_u32 v28, v28, v30, v32
    v_or_b32 v29, v29, v35
    v_max_u32 v28, v28, v34
    v_cmp_ne_u32 vcc, 0, v29
    s_cbranch_vccz L_kk5
    s_lshl_b32 s19, s17, 11
    s_add_u32 s19, s19, 4464640
    buffer_load_dwordx4 v[28:31], v3, s[32:35], s19 offen offset:0 sc1
    buffer_load_dwordx4 v[32:35], v3, s[32:35], s19 offen offset:1024 sc1
    s_waitcnt vmcnt(0)
    s_add_u32 s79, s79, 1
    s_cmp_lt_u32 s79, 32768
    s_cbranch_scc1 L_kp4
L_kk5:
    v_xor_b32 v72, s23, v80
    v_xor_b32 v73, s23, v81
    v_xor_b32 v74, s23, v82
    v_xor_b32 v75, s23, v83
    v_or3_b32 v72, v72, v73, v74
    v_or_b32 v72, v72, v75
    v_and_b32 v72, 15, v72
    v_cmp_ne_u32 vcc, 0, v72
    s_lshl_b32 s19, s15, 1
    s_lshl_b32 s19, 3, s19
    s_or_b32 s3, vcc_lo, vcc_hi
    s_and_b32 s3, s3, s19
    s_cselect_b32 s3, 1, 0
    v_xor_b32 v72, s3, v37
    s_lshl_b64 exec, 1, s17
    ds_write_b32 v36, v72 offset:240
    s_mov_b64 exec, -1
L_fw6:
    ds_read_b32 v29, v13 offset:128
    s_waitcnt lgkmcnt(0)
    v_cmp_ne_u32 vcc, v29, v37
    s_cbranch_vccz L_fk7
    s_add_u32 s79, s79, 1
    s_cmp_lt_u32 s79, 32768
    s_cbranch_scc1 L_fw6
L_fk7:
    ds_max_u32 v13, v28 offset:16
    v_mov_b32 v26, 1
    s_mov_b64 exec, 1
    ds_add_u32 v13, v26 offset:0
    s_mov_b64 exec, -1
L_kc8:
    ds_read_b32 v26, v13 offset:0
    ds_read_b32 v27, v13 offset:16
    s_waitcnt lgkmcnt(0)
    v_readfirstlane_b32 s19, v26
    v_readfirstlane_b32 s71, v27
    s_nop 0
    s_cmp_ge_u32 s19, 4
    s_cbranch_scc1 L_kd9
    s_add_u32 s79, s79, 1
    s_cmp_lt_u32 s79, 32768
    s_cbranch_scc1 L_kc8
L_kd9:
    s_lshr_b32 s71, s71, 4
    s_and_b32 s72, s71, 2047
    s_sub_u32 s72, 2047, s72
    s_lshl_b32 s19, s72, 11
    s_lshl_b32 s3, s0, 1
    s_add_u32 s19, s19, s3
    v_lshlrev_b32 v26, 3, v20
    v_lshl_add_u32 v26, v9, 1, v26
    buffer_load_ushort v27, v26, s[24:27], s19 offen
    s_lshl_b32 s19, s68, 16
    s_add_u32 s19, s19, s69
    buffer_load_dwordx4 v[192:195], v17, s[60:63], s19 offen
    s_add_u32 s68, s68, 1
    s_and_b32 s68, s68, 31
    s_lshl_b32 s19, s68, 16
    s_add_u32 s19, s19, s69
    buffer_load_dwordx4 v[196:199], v17, s[60:63], s19 offen
    s_add_u32 s68, s68, 1
    s_and_b32 s68, s68, 31
    s_lshl_b32 s19, s68, 16
    s_add_u32 s19, s19, s69
    buffer_load_dwordx4 v[200:203], v17, s[60:63], s19 offen
    s_add_u32 s68, s68, 1
    s_and_b32 s68, s68, 31
    s_lshl_b32 s19, s68, 16
    s_add_u32 s19, s19, s69
    buffer_load_dwordx4 v[204:207], v17, s[60:63], s19 offen
    s_add_u32 s68, s68, 1
    s_and_b32 s68, s68, 31
    s_lshl_b32 s19, s68, 16
    s_add_u32 s19, s19, s69
    buffer_load_dwordx4 v[208:211], v17, s[60:63], s19 offen
    s_add_u32 s68, s68, 1
    s_and_b32 s68, s68, 31
    s_lshl_b32 s19, s68, 16
    s_add_u32 s19, s19, s69
    buffer_load_dwordx4 v[212:215], v17, s[60:63], s19 offen
    s_add_u32 s68, s68, 1
    s_and_b32 s68, s68, 31
    s_lshl_b32 s19, s68, 16
    s_add_u32 s19, s19, s69
    buffer_load_dwordx4 v[216:219], v17, s[60:63], s19 offen
    s_add_u32 s68, s68, 1
    s_and_b32 s68, s68, 31
    s_lshl_b32 s19, s68, 16
    s_add_u32 s19, s19, s69
    buffer_load_dwordx4 v[220:223], v17, s[60:63], s19 offen
    s_add_u32 s68, s68, 1
    s_and_b32 s68, s68, 31
    s_lshl_b32 s19, s68, 16
    s_add_u32 s19, s19, s69
    buffer_load_dwordx4 v[224:227], v17, s[60:63], s19 offen
    s_add_u32 s68, s68, 1
    s_and_b32 s68, s68, 31
    s_lshl_b32 s19, s68, 16
    s_add_u32 s19, s19, s69
    buffer_load_dwordx4 v[228:231], v17, s[60:63], s19 offen
    s_add_u32 s68, s68, 1
    s_and_b32 s68, s68, 31
    s_lshl_b32 s19, s68, 16
    s_add_u32 s19, s19, s69
    buffer_load_dwordx4 v[232:235], v17, s[60:63], s19 offen
    s_add_u32 s68, s68, 1
    s_and_b32 s68, s68, 31
    s_lshl_b32 s19, s68, 16
    s_add_u32 s19, s19, s69
    buffer_load_dwordx4 v[236:239], v17, s[60:63], s19 offen
    s_add_u32 s68, s68, 1
    s_and_b32 s68, s68, 31
    s_lshl_b32 s19, s68, 16
    s_add_u32 s19, s19, s69
    buffer_load_dwordx4 v[240:243], v17, s[60:63], s19 offen
    s_add_u32 s68, s68, 1
    s_and_b32 s68, s68, 31
    s_lshl_b32 s19, s68, 16
    s_add_u32 s19, s19, s69
    buffer_load_dwordx4 v[244:247], v17, s[60:63], s19 offen
    s_add_u32 s68, s68, 1
    s_and_b32 s68, s68, 31
    s_lshl_b32 s19, s68, 16
    s_add_u32 s19, s19, s69
    buffer_load_dwordx4 v[248:251], v17, s[60:63], s19 offen
    s_add_u32 s68, s68, 1
    s_and_b32 s68, s68, 31
    s_lshl_b32 s19, s68, 16
    s_add_u32 s19, s19, s69
    buffer_load_dwordx4 v[252:255], v17, s[60:63], s19 offen
    s_add_u32 s68, s68, 1
    s_and_b32 s68, s68, 31
    s_waitcnt vmcnt(16)
    v_lshl_or_b32 v27, v27, 16, v27
    s_lshl_b32 s19, s17, 10
    s_add_u32 s19, s19, 26624
    v_and_b32_dpp v72, v27, v4 row_newbcast:0 row_mask:0xf bank_mask:0xf
    v_and_b32_dpp v73, v27, v5 row_newbcast:0 row_mask:0xf bank_mask:0xf
    v_and_b32_dpp v74, v27, v6 row_newbcast:0 row_mask:0xf bank_mask:0xf
    v_and_b32_dpp v75, v27, v7 row_newbcast:0 row_mask:0xf bank_mask:0xf
    v_and_b32_dpp v76, v27, v4 row_newbcast:1 row_mask:0xf bank_mask:0xf
    v_and_b32_dpp v77, v27, v5 row_newbcast:1 row_mask:0xf bank_mask:0xf
    v_mfma_f32_16x16x32_bf16 v[88:91], v[72:75], v[100:103], 0
    v_and_b32_dpp v78, v27, v6 row_newbcast:1 row_mask:0xf bank_mask:0xf
    v_and_b32_dpp v79, v27, v7 row_newbcast:1 row_mask:0xf bank_mask:0xf
    v_mfma_f32_16x16x32_bf16 v[92:95], v[72:75], v[132:135], 0
    v_and_b32_dpp v80, v27, v4 row_newbcast:2 row_mask:0xf bank_mask:0xf
    v_and_b32_dpp v81, v27, v5 row_newbcast:2 row_mask:0xf bank_mask:0xf
    v_mfma_f32_16x16x32_bf16 v[88:91], v[76:79], v[104:107], v[88:91]
    v_and_b32_dpp v82, v27, v6 row_newbcast:2 row_mask:0xf bank_mask:0xf
    v_and_b32_dpp v83, v27, v7 row_newbcast:2 row_mask:0xf bank_mask:0xf
    v_mfma_f32_16x16x32_bf16 v[92:95], v[76:79], v[136:139], v[92:95]
    v_and_b32_dpp v84, v27, v4 row_newbcast:3 row_mask:0xf bank_mask:0xf
    v_and_b32_dpp v85, v27, v5 row_newbcast:3 row_mask:0xf bank_mask:0xf
    v_mfma_f32_16x16x32_bf16 v[88:91], v[80:83], v[108:111], v[88:91]
    v_and_b32_dpp v86, v27, v6 row_newbcast:3 row_mask:0xf bank_mask:0xf
    v_and_b32_dpp v87, v27, v7 row_newbcast:3 row_mask:0xf bank_mask:0xf
    v_mfma_f32_16x16x32_bf16 v[92:95], v[80:83], v[140:143], v[92:95]
    v_and_b32_dpp v72, v27, v4 row_newbcast:4 row_mask:0xf bank_mask:0xf
    v_and_b32_dpp v73, v27, v5 row_newbcast:4 row_mask:0xf bank_mask:0xf
    v_mfma_f32_16x16x32_bf16 v[88:91], v[84:87], v[112:115], v[88:91]
    v_and_b32_dpp v74, v27, v6 row_newbcast:4 row_mask:0xf bank_mask:0xf
    v_and_b32_dpp v75, v27, v7 row_newbcast:4 row_mask:0xf bank_mask:0xf
    v_mfma_f32_16x16x32_bf16 v[92:95], v[84:87], v[144:147], v[92:95]
    v_and_b32_dpp v76, v27, v4 row_newbcast:5 row_mask:0xf bank_mask:0xf
    v_and_b32_dpp v77, v27, v5 row_newbcast:5 row_mask:0xf bank_mask:0xf
    v_mfma_f32_16x16x32_bf16 v[88:91], v[72:75], v[116:119], v[88:91]
    v_and_b32_dpp v78, v27, v6 row_newbcast:5 row_mask:0xf bank_mask:0xf
    v_and_b32_dpp v79, v27, v7 row_newbcast:5 row_mask:0xf bank_mask:0xf
    v_mfma_f32_16x16x32_bf16 v[92:95], v[72:75], v[148:151], v[92:95]
    v_and_b32_dpp v80, v27, v4 row_newbcast:6 row_mask:0xf bank_mask:0xf
    v_and_b32_dpp v81, v27, v5 row_newbcast:6 row_mask:0xf bank_mask:0xf
    v_mfma_f32_16x16x32_bf16 v[88:91], v[76:79], v[120:123], v[88:91]
    v_and_b32_dpp v82, v27, v6 row_newbcast:6 row_mask:0xf bank_mask:0xf
    v_and_b32_dpp v83, v27, v7 row_newbcast:6 row_mask:0xf bank_mask:0xf
    v_mfma_f32_16x16x32_bf16 v[92:95], v[76:79], v[152:155], v[92:95]
    v_and_b32_dpp v84, v27, v4 row_newbcast:7 row_mask:0xf bank_mask:0xf
    v_and_b32_dpp v85, v27, v5 row_newbcast:7 row_mask:0xf bank_mask:0xf
    v_mfma_f32_16x16x32_bf16 v[88:91], v[80:83], v[124:127], v[88:91]
    v_and_b32_dpp v86, v27, v6 row_newbcast:7 row_mask:0xf bank_mask:0xf
    v_and_b32_dpp v87, v27, v7 row_newbcast:7 row_mask:0xf bank_mask:0xf
    v_mfma_f32_16x16x32_bf16 v[92:95], v[80:83], v[156:159], v[92:95]
    v_add_u32 v26, s19, v3
    v_mov_b32 v28, 1
    v_mfma_f32_16x16x32_bf16 v[88:91], v[84:87], v[128:131], v[88:91]
    v_mfma_f32_16x16x32_bf16 v[92:95], v[84:87], v[160:163], v[92:95]
    s_nop 7
    v_permlane32_swap_b32 v88, v92
    v_permlane32_swap_b32 v89, v93
    v_permlane32_swap_b32 v90, v94
    v_permlane32_swap_b32 v91, v95
    ds_write_b128 v26, v[88:91]
    s_mov_b64 exec, 1
    ds_add_rtn_u32 v29, v13, v28 offset:32
    s_mov_b64 exec, -1
    s_waitcnt lgkmcnt(0)
    v_readfirstlane_b32 s19, v29
    s_nop 1
    s_cmp_lg_u32 s19, 3
    s_cbranch_scc1 L_gs10
    ds_read_b128 v[72:75], v3 offset:26624
    ds_read_b128 v[76:79], v3 offset:27648
    ds_read_b128 v[80:83], v3 offset:28672
    ds_read_b128 v[84:87], v3 offset:29696
    s_waitcnt lgkmcnt(0)
    v_pk_add_f32 v[72:73], v[72:73], v[76:77]
    v_pk_add_f32 v[74:75], v[74:75], v[78:79]
    v_pk_add_f32 v[80:81], v[80:81], v[84:85]
    v_pk_add_f32 v[82:83], v[82:83], v[86:87]
    v_pk_add_f32 v[72:73], v[72:73], v[80:81]
    v_pk_add_f32 v[74:75], v[74:75], v[82:83]
    v_bfi_b32 v72, v23, s80, v72
    v_bfi_b32 v73, v23, s81, v73
    v_bfi_b32 v74, v23, s82, v74
    v_bfi_b32 v75, v23, s83, v75
    s_cmp_ge_u32 s2, 224
    s_cbranch_scc1 L_gs10
    v_lshrrev_b32 v26, 5, v2
    v_mul_u32_u24 v26, 14336, v26
    v_lshl_add_u32 v26, v8, 5, v26
    v_and_b32 v29, 1, v9
    v_lshl_add_u32 v26, v29, 4, v26
    s_mul_i32 s19, s12, 28672
    s_lshl_b32 s3, s13, 9
    s_add_u32 s19, s19, s3
    s_add_u32 s19, s19, 4489216
    buffer_store_dwordx4 v[72:75], v26, s[32:35], s19 offen sc1
L_gs10:
    s_waitcnt vmcnt(8)
L_fw11:
    ds_read_b32 v29, v36 offset:144
    s_waitcnt lgkmcnt(0)
    v_cmp_ne_u32 vcc, v29, v37
    s_cbranch_vccz L_fk12
    s_add_u32 s79, s79, 1
    s_cmp_lt_u32 s79, 32768
    s_cbranch_scc1 L_fw11
L_fk12:
    ds_write_b128 v18, v[192:195] offset:0
    ds_write_b128 v18, v[196:199] offset:4096
    ds_write_b128 v18, v[200:203] offset:8192
    ds_write_b128 v18, v[204:207] offset:12288
    ds_write_b128 v18, v[208:211] offset:16384
    ds_write_b128 v18, v[212:215] offset:20480
    ds_write_b128 v18, v[216:219] offset:24576
    ds_write_b128 v18, v[220:223] offset:28672
    s_waitcnt vmcnt(0)
    ds_write_b128 v18, v[224:227] offset:32768
    ds_write_b128 v18, v[228:231] offset:36864
    ds_write_b128 v18, v[232:235] offset:40960
    ds_write_b128 v18, v[236:239] offset:45056
    ds_write_b128 v18, v[240:243] offset:49152
    ds_write_b128 v18, v[244:247] offset:53248
    ds_write_b128 v18, v[248:251] offset:57344
    ds_write_b128 v18, v[252:255] offset:61440
L_fw13:
    ds_read_b32 v29, v36 offset:176
    s_waitcnt lgkmcnt(0)
    v_cmp_ne_u32 vcc, v29, v37
    s_cbranch_vccz L_fk14
    s_add_u32 s79, s79, 1
    s_cmp_lt_u32 s79, 32768
    s_cbranch_scc1 L_fw13
L_fk14:
    v_min_u32 v26, 6, v20
    v_mul_u32_u24 v27, 28672, v19
    v_lshl_add_u32 v26, v26, 4, v27
    s_lshl_b32 s75, s73, 2
    s_add_u32 s75, s75, 4489216
    s_add_u32 s76, s75, 14336
    buffer_load_dwordx4 v[72:75], v26, s[32:35], s75 offen sc1
    buffer_load_dwordx4 v[76:79], v26, s[32:35], s76 offen sc1
    s_lshl_b32 s19, s68, 16
    s_add_u32 s19, s19, s69
    buffer_load_dwordx4 v[192:195], v17, s[60:63], s19 offen
    s_add_u32 s68, s68, 1
    s_and_b32 s68, s68, 31
    s_lshl_b32 s19, s68, 16
    s_add_u32 s19, s19, s69
    buffer_load_dwordx4 v[196:199], v17, s[60:63], s19 offen
    s_add_u32 s68, s68, 1
    s_and_b32 s68, s68, 31
    s_lshl_b32 s19, s68, 16
    s_add_u32 s19, s19, s69
    buffer_load_dwordx4 v[200:203], v17, s[60:63], s19 offen
    s_add_u32 s68, s68, 1
    s_and_b32 s68, s68, 31
    s_lshl_b32 s19, s68, 16
    s_add_u32 s19, s19, s69
    buffer_load_dwordx4 v[204:207], v17, s[60:63], s19 offen
    s_add_u32 s68, s68, 1
    s_and_b32 s68, s68, 31
    s_lshl_b32 s19, s68, 16
    s_add_u32 s19, s19, s69
    buffer_load_dwordx4 v[208:211], v17, s[60:63], s19 offen
    s_add_u32 s68, s68, 1
    s_and_b32 s68, s68, 31
    s_lshl_b32 s19, s68, 16
    s_add_u32 s19, s19, s69
    buffer_load_dwordx4 v[212:215], v17, s[60:63], s19 offen
    s_add_u32 s68, s68, 1
    s_and_b32 s68, s68, 31
    s_lshl_b32 s19, s68, 16
    s_add_u32 s19, s19, s69
    buffer_load_dwordx4 v[216:219], v17, s[60:63], s19 offen
    s_add_u32 s68, s68, 1
    s_and_b32 s68, s68, 31
    s_lshl_b32 s19, s68, 16
    s_add_u32 s19, s19, s69
    buffer_load_dwordx4 v[220:223], v17, s[60:63], s19 offen
    s_add_u32 s68, s68, 1
    s_and_b32 s68, s68, 31
    s_lshl_b32 s19, s68, 16
    s_add_u32 s19, s19, s69
    buffer_load_dwordx4 v[224:227], v17, s[60:63], s19 offen
    s_add_u32 s68, s68, 1
    s_and_b32 s68, s68, 31
    s_lshl_b32 s19, s68, 16
    s_add_u32 s19, s19, s69
    buffer_load_dwordx4 v[228:231], v17, s[60:63], s19 offen
    s_add_u32 s68, s68, 1
    s_and_b32 s68, s68, 31
    s_lshl_b32 s19, s68, 16
    s_add_u32 s19, s19, s69
    buffer_load_dwordx4 v[232:235], v17, s[60:63], s19 offen
    s_add_u32 s68, s68, 1
    s_and_b32 s68, s68, 31
    s_lshl_b32 s19, s68, 16
    s_add_u32 s19, s19, s69
    buffer_load_dwordx4 v[236:239], v17, s[60:63], s19 offen
    s_add_u32 s68, s68, 1
    s_and_b32 s68, s68, 31
    s_lshl_b32 s19, s68, 16
    s_add_u32 s19, s19, s69
    buffer_load_dwordx4 v[240:243], v17, s[60:63], s19 offen
    s_add_u32 s68, s68, 1
    s_and_b32 s68, s68, 31
    s_lshl_b32 s19, s68, 16
    s_add_u32 s19, s19, s69
    buffer_load_dwordx4 v[244:247], v17, s[60:63], s19 offen
    s_add_u32 s68, s68, 1
    s_and_b32 s68, s68, 31
    s_lshl_b32 s19, s68, 16
    s_add_u32 s19, s19, s69
    buffer_load_dwordx4 v[248:251], v17, s[60:63], s19 offen
    s_add_u32 s68, s68, 1
    s_and_b32 s68, s68, 31
    s_lshl_b32 s19, s68, 16
    s_add_u32 s19, s19, s69
    buffer_load_dwordx4 v[252:255], v17, s[60:63], s19 offen
    s_add_u32 s68, s68, 1
    s_and_b32 s68, s68, 31
    s_waitcnt vmcnt(8)
L_fw15:
    ds_read_b32 v29, v36 offset:160
    s_waitcnt lgkmcnt(0)
    v_cmp_ne_u32 vcc, v29, v37
    s_cbranch_vccz L_fk16
    s_add_u32 s79, s79, 1
    s_cmp_lt_u32 s79, 32768
    s_cbranch_scc1 L_fw15
L_fk16:
    ds_write_b128 v22, v[192:195] offset:0
    ds_write_b128 v22, v[196:199] offset:4096
    ds_write_b128 v22, v[200:203] offset:8192
    ds_write_b128 v22, v[204:207] offset:12288
    ds_write_b128 v22, v[208:211] offset:16384
    ds_write_b128 v22, v[212:215] offset:20480
    ds_write_b128 v22, v[216:219] offset:24576
    ds_write_b128 v22, v[220:223] offset:28672
    s_waitcnt vmcnt(0)
    ds_write_b128 v22, v[224:227] offset:32768
    ds_write_b128 v22, v[228:231] offset:36864
    ds_write_b128 v22, v[232:235] offset:40960
    ds_write_b128 v22, v[236:239] offset:45056
    ds_write_b128 v22, v[240:243] offset:49152
    ds_write_b128 v22, v[244:247] offset:53248
    ds_write_b128 v22, v[248:251] offset:57344
    ds_write_b128 v22, v[252:255] offset:61440
    s_lshl_b64 exec, 1, s17
    ds_write_b32 v36, v37 offset:208
    s_mov_b64 exec, -1
L_fw17:
    ds_read_b32 v29, v36 offset:192
    s_waitcnt lgkmcnt(0)
    v_cmp_ne_u32 vcc, v29, v37
    s_cbranch_vccz L_fk18
    s_add_u32 s79, s79, 1
    s_cmp_lt_u32 s79, 32768
    s_cbranch_scc1 L_fw17
L_fk18:
    buffer_load_dwordx4 v[164:167], v16, s[56:59], s74 offen nt
    s_add_u32 s74, s74, 8192
    buffer_load_dwordx4 v[168:171], v16, s[56:59], s74 offen nt
    s_add_u32 s74, s74, 8192
    buffer_load_dwordx4 v[172:175], v16, s[56:59], s74 offen nt
    s_add_u32 s74, s74, 8192
    buffer_load_dwordx4 v[176:179], v16, s[56:59], s74 offen nt
    s_add_u32 s74, s74, 8192
    buffer_load_dwordx4 v[180:183], v16, s[56:59], s74 offen nt
    s_add_u32 s74, s74, 8192
    buffer_load_dwordx4 v[184:187], v16, s[56:59], s74 offen nt
    s_add_u32 s74, s74, 8192
    buffer_load_dwordx4 v[188:191], v16, s[56:59], s74 offen nt
    s_add_u32 s74, s74, 8192
    s_waitcnt vmcnt(23)
L_gp19:
    v_xor_b32 v72, s80, v72
    v_xor_b32 v73, s81, v73
    v_xor_b32 v74, s82, v74
    v_xor_b32 v75, s83, v75
    v_xor_b32 v76, s80, v76
    v_xor_b32 v77, s81, v77
    v_xor_b32 v78, s82, v78
    v_xor_b32 v79, s83, v79
    v_or3_b32 v80, v72, v73, v74
    v_or3_b32 v81, v75, v76, v77
    v_or3_b32 v80, v80, v78, v79
    v_or_b32 v80, v80, v81
    v_and_b32 v80, v80, v23
    v_cmp_ne_u32 vcc, 0, v80
    s_cbranch_vccz L_gk20
    buffer_load_dwordx4 v[72:75], v26, s[32:35], s75 offen sc1
    buffer_load_dwordx4 v[76:79], v26, s[32:35], s76 offen sc1
    s_waitcnt vmcnt(0)
    s_add_u32 s79, s79, 1
    s_cmp_lt_u32 s79, 32768
    s_cbranch_scc1 L_gp19
L_gk20:
    s_waitcnt vmcnt(0)
    v_permlane32_swap_b32 v72, v74
    v_permlane32_swap_b32 v73, v75
    v_permlane32_swap_b32 v76, v78
    v_permlane32_swap_b32 v77, v79
    v_add_f32 v72, v72, v74
    v_add_f32 v73, v73, v75
    v_add_f32 v76, v76, v78
    v_add_f32 v77, v77, v79
    v_permlane16_swap_b32 v72, v73
    s_lshl_b32 s19, s17, 9
    v_permlane16_swap_b32 v76, v77
    v_add_f32 v72, v72, v73
    v_add_f32 v76, v76, v77
    s_add_u32 s19, s19, 30720
    v_add_f32_dpp v72, v72, v72 row_ror:8 row_mask:0xf bank_mask:0xf
    v_add_f32_dpp v76, v76, v76 row_ror:8 row_mask:0xf bank_mask:0xf
    v_add_u32 v26, s19, v3
    v_cvt_pk_bf16_f32 v72, v72, v76
    v_and_b32 v76, 0xffff0000, v72
    v_lshlrev_b32 v72, 16, v72
    v_mul_f32 v73, 0xbfb8aa3b, v72
    v_exp_f32 v73, v73
    s_nop 0
    v_add_f32 v73, 1.0, v73
    v_rcp_f32 v73, v73
    s_nop 0
    v_mul_f32 v73, v73, v72
    v_cvt_pk_bf16_f32 v73, v73, v73
    v_lshlrev_b32 v73, 16, v73
    v_mul_f32 v73, v73, v76
    v_cvt_pk_bf16_f32 v27, v73, v73
    s_nop 1
    v_and_b32_dpp v76, v27, v4 row_newbcast:0 row_mask:0xf bank_mask:0xf
    v_and_b32_dpp v77, v27, v5 row_newbcast:0 row_mask:0xf bank_mask:0xf
    v_and_b32_dpp v78, v27, v6 row_newbcast:0 row_mask:0xf bank_mask:0xf
    v_and_b32_dpp v79, v27, v7 row_newbcast:0 row_mask:0xf bank_mask:0xf
    v_and_b32_dpp v80, v27, v4 row_newbcast:1 row_mask:0xf bank_mask:0xf
    v_and_b32_dpp v81, v27, v5 row_newbcast:1 row_mask:0xf bank_mask:0xf
    v_mfma_f32_16x16x32_bf16 v[88:91], v[76:79], v[164:167], 0
    v_and_b32_dpp v82, v27, v6 row_newbcast:1 row_mask:0xf bank_mask:0xf
    v_and_b32_dpp v83, v27, v7 row_newbcast:1 row_mask:0xf bank_mask:0xf
    v_and_b32_dpp v84, v27, v4 row_newbcast:2 row_mask:0xf bank_mask:0xf
    v_and_b32_dpp v85, v27, v5 row_newbcast:2 row_mask:0xf bank_mask:0xf
    v_mfma_f32_16x16x32_bf16 v[88:91], v[80:83], v[168:171], v[88:91]
    v_and_b32_dpp v86, v27, v6 row_newbcast:2 row_mask:0xf bank_mask:0xf
    v_and_b32_dpp v87, v27, v7 row_newbcast:2 row_mask:0xf bank_mask:0xf
    v_and_b32_dpp v92, v27, v4 row_newbcast:3 row_mask:0xf bank_mask:0xf
    v_and_b32_dpp v93, v27, v5 row_newbcast:3 row_mask:0xf bank_mask:0xf
    v_mfma_f32_16x16x32_bf16 v[88:91], v[84:87], v[172:175], v[88:91]
    v_and_b32_dpp v94, v27, v6 row_newbcast:3 row_mask:0xf bank_mask:0xf
    v_and_b32_dpp v95, v27, v7 row_newbcast:3 row_mask:0xf bank_mask:0xf
    v_and_b32_dpp v76, v27, v4 row_newbcast:4 row_mask:0xf bank_mask:0xf
    v_and_b32_dpp v77, v27, v5 row_newbcast:4 row_mask:0xf bank_mask:0xf
    v_mfma_f32_16x16x32_bf16 v[88:91], v[92:95], v[176:179], v[88:91]
    v_and_b32_dpp v78, v27, v6 row_newbcast:4 row_mask:0xf bank_mask:0xf
    v_and_b32_dpp v79, v27, v7 row_newbcast:4 row_mask:0xf bank_mask:0xf
    v_and_b32_dpp v80, v27, v4 row_newbcast:5 row_mask:0xf bank_mask:0xf
    v_and_b32_dpp v81, v27, v5 row_newbcast:5 row_mask:0xf bank_mask:0xf
    v_mfma_f32_16x16x32_bf16 v[88:91], v[76:79], v[180:183], v[88:91]
    v_and_b32_dpp v82, v27, v6 row_newbcast:5 row_mask:0xf bank_mask:0xf
    v_and_b32_dpp v83, v27, v7 row_newbcast:5 row_mask:0xf bank_mask:0xf
    v_and_b32_dpp v84, v27, v4 row_newbcast:6 row_mask:0xf bank_mask:0xf
    v_and_b32_dpp v85, v27, v5 row_newbcast:6 row_mask:0xf bank_mask:0xf
    v_mfma_f32_16x16x32_bf16 v[88:91], v[80:83], v[184:187], v[88:91]
    v_and_b32_dpp v86, v27, v6 row_newbcast:6 row_mask:0xf bank_mask:0xf
    v_and_b32_dpp v87, v27, v7 row_newbcast:6 row_mask:0xf bank_mask:0xf
    s_nop 1
    v_mfma_f32_16x16x32_bf16 v[88:91], v[84:87], v[188:191], v[88:91]
    s_mov_b32 exec_hi, 0
    s_nop 6
    ds_write_b128 v26, v[88:91]
    s_mov_b64 exec, 1
    ds_add_rtn_u32 v29, v13, v28 offset:48
    s_mov_b64 exec, -1
    s_waitcnt lgkmcnt(0)
    v_readfirstlane_b32 s19, v29
    s_nop 1
    s_cmp_lg_u32 s19, 3
    s_cbranch_scc1 L_ys21
    ds_read_b128 v[72:75], v3 offset:30720
    ds_read_b128 v[76:79], v3 offset:31232
    ds_read_b128 v[80:83], v3 offset:31744
    ds_read_b128 v[84:87], v3 offset:32256
    s_waitcnt lgkmcnt(0)
    v_pk_add_f32 v[72:73], v[72:73], v[76:77]
    v_pk_add_f32 v[74:75], v[74:75], v[78:79]
    v_pk_add_f32 v[80:81], v[80:81], v[84:85]
    v_pk_add_f32 v[82:83], v[82:83], v[86:87]
    v_pk_add_f32 v[72:73], v[72:73], v[80:81]
    v_pk_add_f32 v[74:75], v[74:75], v[82:83]
    v_bfi_b32 v72, v23, s80, v72
    v_bfi_b32 v73, v23, s81, v73
    v_bfi_b32 v74, v23, s82, v74
    v_bfi_b32 v75, v23, s83, v75
    v_lshlrev_b32 v26, 5, v8
    v_lshl_add_u32 v26, v9, 4, v26
    s_lshl_b32 s19, s13, 12
    s_lshl_b32 s3, s12, 9
    s_add_u32 s19, s19, s3
    s_add_u32 s19, s19, 4718592
    s_mov_b32 exec_hi, 0
    buffer_store_dwordx4 v[72:75], v26, s[32:35], s19 offen sc1
    s_mov_b64 exec, -1
L_ys21:
    s_and_b32 s19, s12, 1
    s_lshl_b32 s19, s19, 1
    s_bfe_u32 s3, s12, 0x10001
    s_add_u32 s19, s19, s3
    s_lshl_b32 s19, s19, 2
    s_and_b32 s3, s13, 3
    s_add_u32 s19, s19, s3
    s_lshr_b32 s3, s72, 7
    s_xor_b32 s19, s19, s3
    s_or_b32 s19, s19, s17
    s_cmp_lg_u32 s19, 0
    s_cbranch_scc1 L_ldone
    v_lshlrev_b32 v26, 12, v9
    v_lshl_add_u32 v26, v8, 4, v26
    v_lshl_add_u32 v29, v8, 2, v9
    v_lshlrev_b32 v30, 1, v29
    v_lshlrev_b32 v29, 2, v29
    s_lshl_b32 s75, s67, 8
    s_add_u32 s75, s75, 4718592
    s_lshl_b32 s19, s72, 11
    s_lshl_b32 s3, s67, 7
    s_add_u32 s19, s19, s3
    s_lshr_b32 s76, s72, 1
    s_lshl_b32 s76, s76, 3
    s_add_u32 s76, s76, 4472832
    buffer_load_ushort v31, v30, s[24:27], s19 offen
L_yp22:
    buffer_load_dwordx2 v[32:33], v13, s[32:35], s76 offen sc1
    s_mov_b32 s19, s75
    buffer_load_dwordx4 v[100:103], v26, s[32:35], s19 offen sc1
    s_add_u32 s19, s19, 16384
    buffer_load_dwordx4 v[104:107], v26, s[32:35], s19 offen sc1
    s_add_u32 s19, s19, 16384
    buffer_load_dwordx4 v[108:111], v26, s[32:35], s19 offen sc1
    s_add_u32 s19, s19, 16384
    buffer_load_dwordx4 v[112:115], v26, s[32:35], s19 offen sc1
    s_add_u32 s19, s19, 16384
    buffer_load_dwordx4 v[116:119], v26, s[32:35], s19 offen sc1
    s_add_u32 s19, s19, 16384
    buffer_load_dwordx4 v[120:123], v26, s[32:35], s19 offen sc1
    s_add_u32 s19, s19, 16384
    buffer_load_dwordx4 v[124:127], v26, s[32:35], s19 offen sc1
    s_add_u32 s19, s19, 16384
    buffer_load_dwordx4 v[128:131], v26, s[32:35], s19 offen sc1
    s_add_u32 s19, s19, 16384
    s_waitcnt vmcnt(0)
    v_xor_b32 v33, s78, v33
    v_xor_b32 v100, s80, v100
    v_xor_b32 v101, s81, v101
    v_xor_b32 v102, s82, v102
    v_xor_b32 v103, s83, v103
    v_xor_b32 v104, s80, v104
    v_xor_b32 v105, s81, v105
    v_xor_b32 v106, s82, v106
    v_xor_b32 v107, s83, v107
    v_xor_b32 v108, s80, v108
    v_xor_b32 v109, s81, v109
    v_xor_b32 v110, s82, v110
    v_xor_b32 v111, s83, v111
    v_xor_b32 v112, s80, v112
    v_xor_b32 v113, s81, v113
    v_xor_b32 v114, s82, v114
    v_xor_b32 v115, s83, v115
    v_xor_b32 v116, s80, v116
    v_xor_b32 v117, s81, v117
    v_xor_b32 v118, s82, v118
    v_xor_b32 v119, s83, v119
    v_xor_b32 v120, s80, v120
    v_xor_b32 v121, s81, v121
    v_xor_b32 v122, s82, v122
    v_xor_b32 v123, s83, v123
    v_xor_b32 v124, s80, v124
    v_xor_b32 v125, s81, v125
    v_xor_b32 v126, s82, v126
    v_xor_b32 v127, s83, v127
    v_xor_b32 v128, s80, v128
    v_xor_b32 v129, s81, v129
    v_xor_b32 v130, s82, v130
    v_xor_b32 v131, s83, v131
    v_or_b32 v34, v100, v101
    v_or3_b32 v34, v34, v102, v103
    v_or3_b32 v34, v34, v104, v105
    v_or3_b32 v34, v34, v106, v107
    v_or3_b32 v34, v34, v108, v109
    v_or3_b32 v34, v34, v110, v111
    v_or3_b32 v34, v34, v112, v113
    v_or3_b32 v34, v34, v114, v115
    v_or3_b32 v34, v34, v116, v117
    v_or3_b32 v34, v34, v118, v119
    v_or3_b32 v34, v34, v120, v121
    v_or3_b32 v34, v34, v122, v123
    v_or3_b32 v34, v34, v124, v125
    v_or3_b32 v34, v34, v126, v127
    v_or3_b32 v34, v34, v128, v129
    v_or3_b32 v34, v34, v130, v131
    v_and_b32 v34, v34, v23
    v_or_b32 v34, v34, v33
    v_cmp_ne_u32 vcc, 0, v34
    s_cbranch_vccz L_yk23
    s_add_u32 s79, s79, 1
    s_cmp_lt_u32 s79, 32768
    s_cbranch_scc1 L_yp22
L_yk23:
    v_pk_add_f32 v[100:101], v[100:101], v[116:117]
    v_pk_add_f32 v[102:103], v[102:103], v[118:119]
    v_pk_add_f32 v[104:105], v[104:105], v[120:121]
    v_pk_add_f32 v[106:107], v[106:107], v[122:123]
    v_pk_add_f32 v[108:109], v[108:109], v[124:125]
    v_pk_add_f32 v[110:111], v[110:111], v[126:127]
    v_pk_add_f32 v[112:113], v[112:113], v[128:129]
    v_pk_add_f32 v[114:115], v[114:115], v[130:131]
    v_pk_add_f32 v[100:101], v[100:101], v[108:109]
    v_pk_add_f32 v[102:103], v[102:103], v[110:111]
    v_pk_add_f32 v[104:105], v[104:105], v[112:113]
    v_pk_add_f32 v[106:107], v[106:107], v[114:115]
    v_pk_add_f32 v[100:101], v[100:101], v[104:105]
    v_pk_add_f32 v[102:103], v[102:103], v[106:107]
    s_nop 1
    v_permlane32_swap_b32 v100, v102
    v_permlane32_swap_b32 v101, v103
    v_add_f32 v100, v100, v102
    v_add_f32 v101, v101, v103
    s_nop 1
    v_permlane16_swap_b32 v100, v101
    v_add_f32 v100, v100, v101
    s_lshr_b32 s19, s71, 11
    s_lshl_b32 s19, s19, 16
    s_not_b32 s3, s19
    s_ashr_i32 s3, s3, 31
    s_or_b32 s3, s3, 0x80000000
    s_xor_b32 s19, s19, s3
    s_and_b32 s19, s19, 0xffff0000
    v_mov_b32 v34, s19
    v_mul_f32 v34, 0xbfb8aa3b, v34
    v_exp_f32 v34, v34
    s_nop 0
    v_add_f32 v34, 1.0, v34
    v_rcp_f32 v34, v34
    s_nop 0
    v_cvt_pk_bf16_f32 v34, v34, v100
    v_and_b32 v35, 0xffff0000, v34
    v_lshlrev_b32 v34, 16, v34
    v_mul_f32 v34, v34, v35
    v_cvt_pk_bf16_f32 v34, v34, v34
    v_lshlrev_b32 v34, 16, v34
    v_lshlrev_b32 v31, 16, v31
    v_add_f32 v34, v34, v31
    s_and_b32 s3, s72, 1
    s_lshl_b32 s3, s3, 4
    v_lshrrev_b32 v32, s3, v32
    v_lshlrev_b32 v32, 16, v32
    v_sub_f32 v32, 1.0, v32
    v_cvt_pk_bf16_f32 v34, v34, v32
    v_and_b32 v35, 0xffff0000, v34
    v_lshlrev_b32 v34, 16, v34
    v_mul_f32 v34, v34, v35
    v_cvt_pk_bf16_f32 v34, v34, v34
    v_lshlrev_b32 v34, 16, v34
    v_mov_b32 v28, 1
    ds_write_b32 v29, v34 offset:512
    ds_write_b32 v13, v37 offset:224
    s_waitcnt lgkmcnt(0)
L_ldone:
    s_endpgm
L_compute:
    s_mov_b64 s[32:33], s[98:99]
    s_mov_b32 s34, 16777216
    s_mov_b32 s35, 0x00020000
    s_mov_b64 s[36:37], s[96:97]
    s_mov_b32 s38, 256
    s_mov_b32 s39, 0x00020000
    s_mov_b64 s[40:41], s[8:9]
    s_mov_b32 s42, 65536
    s_mov_b32 s43, 0x00020000
    s_mov_b64 s[44:45], s[94:95]
    s_mov_b32 s46, 4194304
    s_mov_b32 s47, 0x00020000
    s_mov_b64 s[60:61], s[98:99]
    s_mov_b32 s62, 16777216
    s_mov_b32 s63, 0x00020000
    s_mov_b32 s79, 0
    s_lshr_b32 s17, s16, 1
    s_and_b32 s18, s16, 1
    v_mov_b32 v13, 0
    v_and_b32 v4, 15, v2
    v_lshrrev_b32 v9, 4, v2
    s_or_b32 s19, s2, s16
    s_cmp_lg_u32 s19, 0
    s_cbranch_scc1 L_tp24
    s_memrealtime s[20:21]
    s_waitcnt lgkmcnt(0)
    s_or_b32 s20, s20, 1
    v_mov_b32 v3, s20
    s_mov_b64 exec, 1
    buffer_store_dword v3, v13, s[36:39], 0 offen offset:4 sc1
    s_mov_b64 exec, -1
L_tp24:
    s_lshl_b32 s67, s15, 1
    s_add_u32 s67, s67, s18
    s_lshl_b32 s19, s67, 11
    v_lshlrev_b32 v5, 6, v4
    v_lshl_add_u32 v5, v9, 3, v5
    buffer_load_dwordx2 v[60:61], v5, s[40:43], s19 offen offset:0
    buffer_load_dwordx2 v[62:63], v5, s[40:43], s19 offen offset:32
    buffer_load_dwordx2 v[64:65], v5, s[40:43], s19 offen offset:1024
    buffer_load_dwordx2 v[66:67], v5, s[40:43], s19 offen offset:1056
    s_lshl_b32 s19, s17, 13
    v_lshlrev_b32 v6, 7, v4
    v_add_u32 v6, s19, v6
    v_bfe_u32 v7, v2, 1, 3
    v_add_u32 v8, 0, v9
    v_xor_b32 v8, v8, v7
    v_lshl_add_u32 v20, v8, 4, v6
    v_add_u32 v8, 4, v9
    v_xor_b32 v8, v8, v7
    v_lshl_add_u32 v21, v8, 4, v6
    v_add_u32 v22, 40960, v20
    v_add_u32 v23, 40960, v21
    v_add_u32 v24, 81920, v20
    v_add_u32 v25, 81920, v21
    v_add_u32 v26, 122880, v20
    v_add_u32 v27, 122880, v21
    v_lshlrev_b32 v6, 10, v9
    v_bfe_u32 v7, v2, 2, 2
    v_lshl_add_u32 v6, v7, 7, v6
    v_bfe_u32 v7, v2, 3, 1
    v_xor_b32 v7, s18, v7
    v_lshl_add_u32 v6, v7, 6, v6
    v_bfe_u32 v7, v2, 4, 1
    v_lshl_add_u32 v6, v7, 5, v6
    v_and_b32 v7, 3, v2
    v_lshl_add_u32 v6, v7, 3, v6
    v_add_u32 v36, 16384, v6
    v_xor_b32 v37, 32, v36
    v_add_u32 v38, 57344, v6
    v_xor_b32 v39, 32, v38
    v_add_u32 v40, 98304, v6
    v_xor_b32 v41, 32, v40
    v_add_u32 v42, 139264, v6
    v_xor_b32 v43, 32, v42
    v_lshrrev_b32 v5, 2, v4
    v_and_b32 v6, 1, v4
    v_lshlrev_b32 v6, 4, v6
    v_mov_b32 v7, 0x3f80
    v_lshlrev_b32 v7, v6, v7
    v_cmp_eq_u32 vcc, v5, v9
    s_nop 1
    v_cndmask_b32 v7, 0, v7, vcc
    v_and_b32 v6, 2, v4
    v_cmp_eq_u32 vcc, 0, v6
    s_nop 1
    v_cndmask_b32 v52, 0, v7, vcc
    v_cndmask_b32 v53, v7, v13, vcc
    v_mov_b32 v56, 0x3f803f80
    v_mov_b32 v57, 0x3f803f80
    v_mov_b32 v58, 0x3f803f80
    v_mov_b32 v59, 0x3f803f80
    v_lshlrev_b32 v3, 4, v2
    v_lshlrev_b32 v12, 4, v9
    v_lshrrev_b32 v11, 5, v2
    v_lshlrev_b32 v8, 9, v11
    v_and_b32 v19, 16, v12
    v_add_u32 v8, v8, v19
    v_lshlrev_b32 v11, 2, v11
    v_lshl_add_u32 v11, v4, 4, v11
    v_lshlrev_b32 v9, 10, v9
    v_lshl_add_u32 v9, v4, 4, v9
    v_lshlrev_b32 v10, 3, v2
    s_xor_b32 s3, s16, 2
    s_mul_i32 s19, s3, 6144
    s_add_u32 s19, s19, 2048
    v_add_u32 v4, s19, v3
    s_mul_i32 s19, s16, 6144
    s_add_u32 s19, s19, 2048
    v_add_u32 v5, s19, v3
    v_lshlrev_b32 v7, 2, v2
    s_lshl_b32 s19, s3, 8
    s_add_u32 s19, s19, 1024
    v_add_u32 v6, s19, v7
    s_lshl_b32 s19, s16, 8
    s_add_u32 s19, s19, 1024
    v_add_u32 v7, s19, v7
    v_mov_b32 v15, 0x3ff
    v_mov_b32 v18, 0x7fc17fc1
    s_lshl_b32 s19, s16, 2
    v_mov_b32 v1, s19
    v_mov_b32 v19, -1
    s_lshl_b32 s19, s15, 2
    s_lshr_b32 s3, s14, 2
    s_add_u32 s19, s19, s3
    s_and_b32 s3, s14, 1
    s_bfe_u32 s20, s14, 0x10001
    s_lshl_b32 s20, s20, 3
    s_lshl_b32 s64, s19, 1
    s_add_u32 s64, s64, s3
    s_lshl_b32 s64, s64, 2
    s_add_u32 s64, s64, s16
    s_lshl_b32 s64, s64, 8
    s_add_u32 s64, s64, s20
    s_add_u32 s64, s64, 4325376
    s_lshl_b32 s65, s19, 1
    s_add_u32 s65, s65, s3
    s_lshl_b32 s65, s65, 1
    s_add_u32 s65, s65, s17
    s_lshl_b32 s65, s65, 4
    s_add_u32 s65, s65, s20
    s_lshl_b32 s3, s18, 2
    s_add_u32 s65, s65, s3
    s_add_u32 s65, s65, 4456448
    s_mov_b32 s74, 0x3fb8aa3b
    s_mov_b32 s76, 0xbfb8aa3b
    s_mov_b32 s75, 0
    s_mov_b32 s77, 0
    s_mov_b32 s69, 0
    s_mov_b32 s71, 0
    s_cmp_lg_u32 s17, 0
    s_cselect_b32 s68, s74, s76
    s_cselect_b32 s70, s76, s74
    s_cselect_b64 s[72:73], -1, 0
    s_mov_b32 s66, 0
    s_lshl_b32 s19, s15, 4
    s_lshl_b32 s3, s18, 3
    s_add_u32 s19, s19, s3
    s_lshl_b32 s3, s17, 2
    s_add_u32 s19, s19, s3
    s_lshl_b32 s19, s19, 4
    s_add_u32 s19, s19, s14
    s_lshl_b32 s48, s19, 10
    s_lshl_b32 s49, s19, 5
    s_add_u32 s49, s49, 4194304
    s_lshl_b32 s19, s15, 4
    s_add_u32 s19, s19, s14
    s_lshl_b32 s50, s19, 6
    s_add_u32 s50, s50, s16
    s_lshl_b32 s50, s50, 8
    s_lshl_b32 s51, s19, 9
    s_add_u32 s51, s51, 4194304
    s_lshl_b32 s19, s14, 1
    s_add_u32 s19, s19, s17
    s_lshl_b32 s52, s19, 17
    s_lshl_b32 s3, s67, 10
    s_add_u32 s52, s52, s3
    s_add_u32 s52, s52, 8388608
    s_lshl_b32 s53, s19, 5
    s_add_u32 s53, s53, s67
    s_lshl_b32 s53, s53, 2
    s_add_u32 s53, s53, 4481024
    s_and_b32 s19, s12, 1
    s_lshl_b32 s19, s19, 1
    s_bfe_u32 s3, s12, 0x10001
    s_add_u32 s19, s19, s3
    s_lshl_b32 s19, s19, 2
    s_and_b32 s3, s13, 3
    s_add_u32 s19, s19, s3
    s_lshl_b32 s58, s19, 2
    s_add_u32 s58, s58, s16
    s_lshr_b32 s19, s12, 2
    s_lshl_b32 s19, s19, 3
    s_lshr_b32 s3, s13, 2
    s_add_u32 s19, s19, s3
    s_lshl_b32 s54, s58, 16
    s_lshl_b32 s3, s19, 7
    s_add_u32 s54, s54, s3
    s_add_u32 s55, s54, 32768
    s_lshr_b32 s56, s58, 1
    s_lshl_b32 s56, s56, 7
    s_add_u32 s56, s56, 4481024
    s_lshl_b32 s57, s58, 7
    s_add_u32 s57, s57, 4472832
    s_lshl_b32 s59, s67, 12
    s_add_u32 s59, s59, 4325376
    s_lshl_b32 s28, s67, 7
    s_add_u32 s28, s28, 4456448
    s_mov_b32 s29, 0
    v_lshrrev_b32 v19, 4, v2
    v_and_b32 v54, 15, v2
    v_lshlrev_b32 v54, 6, v54
    v_lshl_add_u32 v76, v19, 14, v54
    v_lshl_add_u32 v77, v19, 15, v54
    v_lshrrev_b32 v19, 1, v2
    v_and_b32 v54, 1, v2
    v_lshlrev_b32 v54, 6, v54
    v_lshl_add_u32 v78, v19, 11, v54
    v_lshlrev_b32 v79, 9, v2
    v_lshrrev_b32 v54, 1, v2
    v_lshlrev_b32 v54, 10, v54
    v_and_b32 v19, 1, v2
    v_lshl_add_u32 v54, v19, 7, v54
    v_add_u32 v54, s50, v54
    v_lshlrev_b32 v19, 7, v2
    v_add_u32 v55, s51, v19
    s_sub_u32 s3, s59, 4096
    v_add_u32 v19, s3, v19
    v_cmp_gt_u32 vcc, 32, v2
    s_nop 1
    v_cndmask_b32 v54, v19, v54, vcc
    v_mov_b32 v19, s28
    v_cmp_gt_u32 vcc, 4, v2
    s_nop 1
    v_cndmask_b32 v55, v19, v55, vcc
    v_mov_b32 v19, -1
    v_mov_b64 v[160:161], 0
    v_mov_b64 v[162:163], 0
    v_mov_b64 v[164:165], 0
    v_mov_b64 v[166:167], 0
    v_mov_b64 v[168:169], 0
    v_mov_b64 v[170:171], 0
    v_mov_b64 v[172:173], 0
    v_mov_b64 v[174:175], 0
    v_mov_b64 v[176:177], 0
    v_mov_b64 v[178:179], 0
    v_mov_b64 v[180:181], 0
    v_mov_b64 v[182:183], 0
    v_mov_b64 v[184:185], 0
    v_mov_b64 v[186:187], 0
    v_mov_b64 v[188:189], 0
    v_mov_b64 v[190:191], 0
    v_mov_b64 v[192:193], 0
    v_mov_b64 v[194:195], 0
    v_mov_b64 v[196:197], 0
    v_mov_b64 v[198:199], 0
    v_mov_b64 v[200:201], 0
    v_mov_b64 v[202:203], 0
    v_mov_b64 v[204:205], 0
    v_mov_b64 v[206:207], 0
    v_mov_b64 v[208:209], 0
    v_mov_b64 v[210:211], 0
    v_mov_b64 v[212:213], 0
    v_mov_b64 v[214:215], 0
    v_mov_b64 v[216:217], 0
    v_mov_b64 v[218:219], 0
    v_mov_b64 v[220:221], 0
    v_mov_b64 v[222:223], 0
    v_mov_b64 v[224:225], 0
    v_mov_b64 v[226:227], 0
    v_mov_b64 v[228:229], 0
    v_mov_b64 v[230:231], 0
    v_mov_b64 v[232:233], 0
    v_mov_b64 v[234:235], 0
    v_mov_b64 v[236:237], 0
    v_mov_b64 v[238:239], 0
    v_mov_b64 v[240:241], 0
    v_mov_b64 v[242:243], 0
    v_mov_b64 v[244:245], 0
    v_mov_b64 v[246:247], 0
    v_mov_b64 v[248:249], 0
    v_mov_b64 v[250:251], 0
    v_mov_b64 v[252:253], 0
    v_mov_b64 v[254:255], 0
    s_waitcnt vmcnt(4)
    s_barrier
    ds_read_b128 v[80:83], v20 offset:0
    ds_read_b64_tr_b16 v[96:97], v36 offset:0
    ds_read_b64_tr_b16 v[98:99], v36 offset:512
    ds_read_b128 v[84:87], v20 offset:2048
    ds_read_b128 v[88:91], v20 offset:4096
    ds_read_b128 v[92:95], v20 offset:6144
    ds_read_b64_tr_b16 v[100:101], v37 offset:0
    ds_read_b64_tr_b16 v[102:103], v37 offset:512
    ds_read_b64_tr_b16 v[104:105], v36 offset:8192
    ds_read_b64_tr_b16 v[106:107], v36 offset:8704
    ds_read_b64_tr_b16 v[108:109], v37 offset:8192
    ds_read_b64_tr_b16 v[110:111], v37 offset:8704
    ds_read_b64_tr_b16 v[112:113], v36 offset:16384
    ds_read_b64_tr_b16 v[114:115], v36 offset:16896
    ds_read_b64_tr_b16 v[116:117], v37 offset:16384
    ds_read_b64_tr_b16 v[118:119], v37 offset:16896
    s_mov_b32 exec_lo, 0xffff
    s_mov_b32 exec_hi, 0xffff
    buffer_store_dword v19, v11, s[32:35], s64 offen sc1
    s_lshl_b64 exec, 1, s16
    buffer_store_dword v19, v13, s[32:35], s65 offen sc1
    s_mov_b64 exec, -1
.p2align 7
L_loop:
    s_waitcnt lgkmcnt(10)
    v_mfma_f32_16x16x32_bf16 v[160:163], v[96:99], v[80:83], v[160:163]
    ds_read_b128 v[120:123], v21 offset:0
    v_mfma_f32_16x16x32_bf16 v[164:167], v[96:99], v[84:87], v[164:167]
    ds_read_b64_tr_b16 v[136:137], v36 offset:4096
    v_mfma_f32_16x16x32_bf16 v[168:171], v[96:99], v[88:91], v[168:171]
    ds_read_b64_tr_b16 v[138:139], v36 offset:4608
    v_mfma_f32_16x16x32_bf16 v[172:175], v[96:99], v[92:95], v[172:175]
    s_waitcnt lgkmcnt(11)
    v_mfma_f32_16x16x32_bf16 v[188:191], v[100:103], v[92:95], v[188:191]
    ds_read_b128 v[124:127], v21 offset:2048
    v_mfma_f32_16x16x32_bf16 v[184:187], v[100:103], v[88:91], v[184:187]
    ds_read_b128 v[128:131], v21 offset:4096
    v_mfma_f32_16x16x32_bf16 v[180:183], v[100:103], v[84:87], v[180:183]
    ds_read_b128 v[132:135], v21 offset:6144
    v_mfma_f32_16x16x32_bf16 v[176:179], v[100:103], v[80:83], v[176:179]
    s_waitcnt lgkmcnt(12)
    v_mfma_f32_16x16x32_bf16 v[192:195], v[104:107], v[80:83], v[192:195]
    ds_read_b64_tr_b16 v[140:141], v37 offset:4096
    v_mfma_f32_16x16x32_bf16 v[196:199], v[104:107], v[84:87], v[196:199]
    ds_read_b64_tr_b16 v[142:143], v37 offset:4608
    v_mfma_f32_16x16x32_bf16 v[200:203], v[104:107], v[88:91], v[200:203]
    ds_read_b64_tr_b16 v[144:145], v36 offset:12288
    v_mfma_f32_16x16x32_bf16 v[204:207], v[104:107], v[92:95], v[204:207]
    s_waitcnt lgkmcnt(13)
    v_mfma_f32_16x16x32_bf16 v[220:223], v[108:111], v[92:95], v[220:223]
    ds_read_b64_tr_b16 v[146:147], v36 offset:12800
    v_mfma_f32_16x16x32_bf16 v[216:219], v[108:111], v[88:91], v[216:219]
    ds_read_b64_tr_b16 v[148:149], v37 offset:12288
    v_mfma_f32_16x16x32_bf16 v[212:215], v[108:111], v[84:87], v[212:215]
    ds_read_b64_tr_b16 v[150:151], v37 offset:12800
    v_mfma_f32_16x16x32_bf16 v[208:211], v[108:111], v[80:83], v[208:211]
    s_waitcnt lgkmcnt(14)
    v_mfma_f32_16x16x32_bf16 v[224:227], v[80:83], v[112:115], v[224:227]
    ds_read_b64_tr_b16 v[152:153], v36 offset:20480
    v_mfma_f32_16x16x32_bf16 v[228:231], v[84:87], v[112:115], v[228:231]
    ds_read_b64_tr_b16 v[154:155], v36 offset:20992
    v_mfma_f32_16x16x32_bf16 v[232:235], v[88:91], v[112:115], v[232:235]
    ds_read_b64_tr_b16 v[156:157], v37 offset:20480
    v_mfma_f32_16x16x32_bf16 v[236:239], v[92:95], v[112:115], v[236:239]
    s_waitcnt lgkmcnt(15)
    v_mfma_f32_16x16x32_bf16 v[252:255], v[92:95], v[116:119], v[252:255]
    ds_read_b64_tr_b16 v[158:159], v37 offset:20992
    v_mfma_f32_16x16x32_bf16 v[248:251], v[88:91], v[116:119], v[248:251]
    v_mfma_f32_16x16x32_bf16 v[244:247], v[84:87], v[116:119], v[244:247]
    v_mfma_f32_16x16x32_bf16 v[240:243], v[80:83], v[116:119], v[240:243]
    s_waitcnt lgkmcnt(10)
    v_mfma_f32_16x16x32_bf16 v[160:163], v[136:139], v[120:123], v[160:163]
    v_mfma_f32_16x16x32_bf16 v[164:167], v[136:139], v[124:127], v[164:167]
    v_mfma_f32_16x16x32_bf16 v[168:171], v[136:139], v[128:131], v[168:171]
    v_mfma_f32_16x16x32_bf16 v[172:175], v[136:139], v[132:135], v[172:175]
    s_waitcnt lgkmcnt(0)
    s_barrier
    ds_read_b128 v[80:83], v22 offset:0
    v_mfma_f32_16x16x32_bf16 v[188:191], v[140:143], v[132:135], v[188:191]
    ds_read_b64_tr_b16 v[96:97], v38 offset:0
    v_mfma_f32_16x16x32_bf16 v[184:187], v[140:143], v[128:131], v[184:187]
    ds_read_b64_tr_b16 v[98:99], v38 offset:512
    v_mfma_f32_16x16x32_bf16 v[180:183], v[140:143], v[124:127], v[180:183]
    ds_read_b128 v[84:87], v22 offset:2048
    v_mfma_f32_16x16x32_bf16 v[176:179], v[140:143], v[120:123], v[176:179]
    ds_read_b128 v[88:91], v22 offset:4096
    v_mfma_f32_16x16x32_bf16 v[192:195], v[144:147], v[120:123], v[192:195]
    ds_read_b128 v[92:95], v22 offset:6144
    v_mfma_f32_16x16x32_bf16 v[196:199], v[144:147], v[124:127], v[196:199]
    ds_read_b64_tr_b16 v[100:101], v39 offset:0
    v_mfma_f32_16x16x32_bf16 v[200:203], v[144:147], v[128:131], v[200:203]
    ds_read_b64_tr_b16 v[102:103], v39 offset:512
    v_mfma_f32_16x16x32_bf16 v[204:207], v[144:147], v[132:135], v[204:207]
    ds_read_b64_tr_b16 v[104:105], v38 offset:8192
    v_mfma_f32_16x16x32_bf16 v[220:223], v[148:151], v[132:135], v[220:223]
    ds_read_b64_tr_b16 v[106:107], v38 offset:8704
    v_mfma_f32_16x16x32_bf16 v[216:219], v[148:151], v[128:131], v[216:219]
    ds_read_b64_tr_b16 v[108:109], v39 offset:8192
    v_mfma_f32_16x16x32_bf16 v[212:215], v[148:151], v[124:127], v[212:215]
    ds_read_b64_tr_b16 v[110:111], v39 offset:8704
    v_mfma_f32_16x16x32_bf16 v[208:211], v[148:151], v[120:123], v[208:211]
    ds_read_b64_tr_b16 v[112:113], v38 offset:16384
    v_mfma_f32_16x16x32_bf16 v[224:227], v[120:123], v[152:155], v[224:227]
    ds_read_b64_tr_b16 v[114:115], v38 offset:16896
    v_mfma_f32_16x16x32_bf16 v[228:231], v[124:127], v[152:155], v[228:231]
    ds_read_b64_tr_b16 v[116:117], v39 offset:16384
    v_mfma_f32_16x16x32_bf16 v[232:235], v[128:131], v[152:155], v[232:235]
    ds_read_b64_tr_b16 v[118:119], v39 offset:16896
    v_mfma_f32_16x16x32_bf16 v[236:239], v[132:135], v[152:155], v[236:239]
    v_mfma_f32_16x16x32_bf16 v[252:255], v[132:135], v[156:159], v[252:255]
    v_mfma_f32_16x16x32_bf16 v[248:251], v[128:131], v[156:159], v[248:251]
    v_mfma_f32_16x16x32_bf16 v[244:247], v[124:127], v[156:159], v[244:247]
    v_mfma_f32_16x16x32_bf16 v[240:243], v[120:123], v[156:159], v[240:243]
    s_cmp_eq_u32 s66, 2
    s_cbranch_scc1 L_mid
L_midret:
    s_waitcnt lgkmcnt(10)
    v_mfma_f32_16x16x32_bf16 v[160:163], v[96:99], v[80:83], v[160:163]
    ds_read_b128 v[120:123], v23 offset:0
    v_mfma_f32_16x16x32_bf16 v[164:167], v[96:99], v[84:87], v[164:167]
    ds_read_b64_tr_b16 v[136:137], v38 offset:4096
    v_mfma_f32_16x16x32_bf16 v[168:171], v[96:99], v[88:91], v[168:171]
    ds_read_b64_tr_b16 v[138:139], v38 offset:4608
    v_mfma_f32_16x16x32_bf16 v[172:175], v[96:99], v[92:95], v[172:175]
    s_waitcnt lgkmcnt(11)
    v_mfma_f32_16x16x32_bf16 v[188:191], v[100:103], v[92:95], v[188:191]
    ds_read_b128 v[124:127], v23 offset:2048
    v_mfma_f32_16x16x32_bf16 v[184:187], v[100:103], v[88:91], v[184:187]
    ds_read_b128 v[128:131], v23 offset:4096
    v_mfma_f32_16x16x32_bf16 v[180:183], v[100:103], v[84:87], v[180:183]
    ds_read_b128 v[132:135], v23 offset:6144
    v_mfma_f32_16x16x32_bf16 v[176:179], v[100:103], v[80:83], v[176:179]
    s_waitcnt lgkmcnt(12)
    v_mfma_f32_16x16x32_bf16 v[192:195], v[104:107], v[80:83], v[192:195]
    ds_read_b64_tr_b16 v[140:141], v39 offset:4096
    v_mfma_f32_16x16x32_bf16 v[196:199], v[104:107], v[84:87], v[196:199]
    ds_read_b64_tr_b16 v[142:143], v39 offset:4608
    v_mfma_f32_16x16x32_bf16 v[200:203], v[104:107], v[88:91], v[200:203]
    ds_read_b64_tr_b16 v[144:145], v38 offset:12288
    v_mfma_f32_16x16x32_bf16 v[204:207], v[104:107], v[92:95], v[204:207]
    s_waitcnt lgkmcnt(13)
    v_mfma_f32_16x16x32_bf16 v[220:223], v[108:111], v[92:95], v[220:223]
    ds_read_b64_tr_b16 v[146:147], v38 offset:12800
    v_mfma_f32_16x16x32_bf16 v[216:219], v[108:111], v[88:91], v[216:219]
    ds_read_b64_tr_b16 v[148:149], v39 offset:12288
    v_mfma_f32_16x16x32_bf16 v[212:215], v[108:111], v[84:87], v[212:215]
    ds_read_b64_tr_b16 v[150:151], v39 offset:12800
    v_mfma_f32_16x16x32_bf16 v[208:211], v[108:111], v[80:83], v[208:211]
    s_waitcnt lgkmcnt(14)
    v_mfma_f32_16x16x32_bf16 v[224:227], v[80:83], v[112:115], v[224:227]
    ds_read_b64_tr_b16 v[152:153], v38 offset:20480
    v_mfma_f32_16x16x32_bf16 v[228:231], v[84:87], v[112:115], v[228:231]
    ds_read_b64_tr_b16 v[154:155], v38 offset:20992
    v_mfma_f32_16x16x32_bf16 v[232:235], v[88:91], v[112:115], v[232:235]
    ds_read_b64_tr_b16 v[156:157], v39 offset:20480
    v_mfma_f32_16x16x32_bf16 v[236:239], v[92:95], v[112:115], v[236:239]
    s_waitcnt lgkmcnt(15)
    v_mfma_f32_16x16x32_bf16 v[252:255], v[92:95], v[116:119], v[252:255]
    ds_read_b64_tr_b16 v[158:159], v39 offset:20992
    v_mfma_f32_16x16x32_bf16 v[248:251], v[88:91], v[116:119], v[248:251]
    v_mfma_f32_16x16x32_bf16 v[244:247], v[84:87], v[116:119], v[244:247]
    v_mfma_f32_16x16x32_bf16 v[240:243], v[80:83], v[116:119], v[240:243]
    s_waitcnt lgkmcnt(10)
    v_mfma_f32_16x16x32_bf16 v[160:163], v[136:139], v[120:123], v[160:163]
    v_mfma_f32_16x16x32_bf16 v[164:167], v[136:139], v[124:127], v[164:167]
    v_mfma_f32_16x16x32_bf16 v[168:171], v[136:139], v[128:131], v[168:171]
    v_mfma_f32_16x16x32_bf16 v[172:175], v[136:139], v[132:135], v[172:175]
    s_cmp_eq_u32 s66, 3
    s_waitcnt lgkmcnt(0)
    s_barrier
L_nob:
    ds_read_b128 v[80:83], v24 offset:0
    v_mfma_f32_16x16x32_bf16 v[188:191], v[140:143], v[132:135], v[188:191]
    ds_read_b64_tr_b16 v[96:97], v40 offset:0
    v_mfma_f32_16x16x32_bf16 v[184:187], v[140:143], v[128:131], v[184:187]
    ds_read_b64_tr_b16 v[98:99], v40 offset:512
    v_mfma_f32_16x16x32_bf16 v[180:183], v[140:143], v[124:127], v[180:183]
    ds_read_b128 v[84:87], v24 offset:2048
    v_mfma_f32_16x16x32_bf16 v[176:179], v[140:143], v[120:123], v[176:179]
    ds_read_b128 v[88:91], v24 offset:4096
    v_mfma_f32_16x16x32_bf16 v[192:195], v[144:147], v[120:123], v[192:195]
    ds_read_b128 v[92:95], v24 offset:6144
    v_mfma_f32_16x16x32_bf16 v[196:199], v[144:147], v[124:127], v[196:199]
    ds_read_b64_tr_b16 v[100:101], v41 offset:0
    v_mfma_f32_16x16x32_bf16 v[200:203], v[144:147], v[128:131], v[200:203]
    ds_read_b64_tr_b16 v[102:103], v41 offset:512
    v_mfma_f32_16x16x32_bf16 v[204:207], v[144:147], v[132:135], v[204:207]
    ds_read_b64_tr_b16 v[104:105], v40 offset:8192
    v_mfma_f32_16x16x32_bf16 v[220:223], v[148:151], v[132:135], v[220:223]
    ds_read_b64_tr_b16 v[106:107], v40 offset:8704
    v_mfma_f32_16x16x32_bf16 v[216:219], v[148:151], v[128:131], v[216:219]
    ds_read_b64_tr_b16 v[108:109], v41 offset:8192
    v_mfma_f32_16x16x32_bf16 v[212:215], v[148:151], v[124:127], v[212:215]
    ds_read_b64_tr_b16 v[110:111], v41 offset:8704
    v_mfma_f32_16x16x32_bf16 v[208:211], v[148:151], v[120:123], v[208:211]
    ds_read_b64_tr_b16 v[112:113], v40 offset:16384
    v_mfma_f32_16x16x32_bf16 v[224:227], v[120:123], v[152:155], v[224:227]
    ds_read_b64_tr_b16 v[114:115], v40 offset:16896
    v_mfma_f32_16x16x32_bf16 v[228:231], v[124:127], v[152:155], v[228:231]
    ds_read_b64_tr_b16 v[116:117], v41 offset:16384
    v_mfma_f32_16x16x32_bf16 v[232:235], v[128:131], v[152:155], v[232:235]
    ds_read_b64_tr_b16 v[118:119], v41 offset:16896
    v_mfma_f32_16x16x32_bf16 v[236:239], v[132:135], v[152:155], v[236:239]
    v_mfma_f32_16x16x32_bf16 v[252:255], v[132:135], v[156:159], v[252:255]
    v_mfma_f32_16x16x32_bf16 v[248:251], v[128:131], v[156:159], v[248:251]
    v_mfma_f32_16x16x32_bf16 v[244:247], v[124:127], v[156:159], v[244:247]
    v_mfma_f32_16x16x32_bf16 v[240:243], v[120:123], v[156:159], v[240:243]
    s_waitcnt lgkmcnt(10)
    v_mfma_f32_16x16x32_bf16 v[160:163], v[96:99], v[80:83], v[160:163]
    ds_read_b128 v[120:123], v25 offset:0
    v_mfma_f32_16x16x32_bf16 v[164:167], v[96:99], v[84:87], v[164:167]
    ds_read_b64_tr_b16 v[136:137], v40 offset:4096
    v_mfma_f32_16x16x32_bf16 v[168:171], v[96:99], v[88:91], v[168:171]
    ds_read_b64_tr_b16 v[138:139], v40 offset:4608
    v_mfma_f32_16x16x32_bf16 v[172:175], v[96:99], v[92:95], v[172:175]
    s_waitcnt lgkmcnt(11)
    v_mfma_f32_16x16x32_bf16 v[188:191], v[100:103], v[92:95], v[188:191]
    ds_read_b128 v[124:127], v25 offset:2048
    v_mfma_f32_16x16x32_bf16 v[184:187], v[100:103], v[88:91], v[184:187]
    ds_read_b128 v[128:131], v25 offset:4096
    v_mfma_f32_16x16x32_bf16 v[180:183], v[100:103], v[84:87], v[180:183]
    ds_read_b128 v[132:135], v25 offset:6144
    v_mfma_f32_16x16x32_bf16 v[176:179], v[100:103], v[80:83], v[176:179]
    s_waitcnt lgkmcnt(12)
    v_mfma_f32_16x16x32_bf16 v[192:195], v[104:107], v[80:83], v[192:195]
    ds_read_b64_tr_b16 v[140:141], v41 offset:4096
    v_mfma_f32_16x16x32_bf16 v[196:199], v[104:107], v[84:87], v[196:199]
    ds_read_b64_tr_b16 v[142:143], v41 offset:4608
    v_mfma_f32_16x16x32_bf16 v[200:203], v[104:107], v[88:91], v[200:203]
    ds_read_b64_tr_b16 v[144:145], v40 offset:12288
    v_mfma_f32_16x16x32_bf16 v[204:207], v[104:107], v[92:95], v[204:207]
    s_waitcnt lgkmcnt(13)
    v_mfma_f32_16x16x32_bf16 v[220:223], v[108:111], v[92:95], v[220:223]
    ds_read_b64_tr_b16 v[146:147], v40 offset:12800
    v_mfma_f32_16x16x32_bf16 v[216:219], v[108:111], v[88:91], v[216:219]
    ds_read_b64_tr_b16 v[148:149], v41 offset:12288
    v_mfma_f32_16x16x32_bf16 v[212:215], v[108:111], v[84:87], v[212:215]
    ds_read_b64_tr_b16 v[150:151], v41 offset:12800
    v_mfma_f32_16x16x32_bf16 v[208:211], v[108:111], v[80:83], v[208:211]
    s_waitcnt lgkmcnt(14)
    v_mfma_f32_16x16x32_bf16 v[224:227], v[80:83], v[112:115], v[224:227]
    ds_read_b64_tr_b16 v[152:153], v40 offset:20480
    v_mfma_f32_16x16x32_bf16 v[228:231], v[84:87], v[112:115], v[228:231]
    ds_read_b64_tr_b16 v[154:155], v40 offset:20992
    v_mfma_f32_16x16x32_bf16 v[232:235], v[88:91], v[112:115], v[232:235]
    ds_read_b64_tr_b16 v[156:157], v41 offset:20480
    v_mfma_f32_16x16x32_bf16 v[236:239], v[92:95], v[112:115], v[236:239]
    s_waitcnt lgkmcnt(15)
    v_mfma_f32_16x16x32_bf16 v[252:255], v[92:95], v[116:119], v[252:255]
    ds_read_b64_tr_b16 v[158:159], v41 offset:20992
    v_mfma_f32_16x16x32_bf16 v[248:251], v[88:91], v[116:119], v[248:251]
    v_mfma_f32_16x16x32_bf16 v[244:247], v[84:87], v[116:119], v[244:247]
    v_mfma_f32_16x16x32_bf16 v[240:243], v[80:83], v[116:119], v[240:243]
    s_waitcnt lgkmcnt(10)
    v_mfma_f32_16x16x32_bf16 v[160:163], v[136:139], v[120:123], v[160:163]
    v_mfma_f32_16x16x32_bf16 v[164:167], v[136:139], v[124:127], v[164:167]
    v_mfma_f32_16x16x32_bf16 v[168:171], v[136:139], v[128:131], v[168:171]
    v_mfma_f32_16x16x32_bf16 v[172:175], v[136:139], v[132:135], v[172:175]
    s_cmp_eq_u32 s66, 3
    s_waitcnt lgkmcnt(0)
    s_cbranch_scc1 L_last
    s_barrier
    ds_read_b128 v[80:83], v26 offset:0
    v_mfma_f32_16x16x32_bf16 v[188:191], v[140:143], v[132:135], v[188:191]
    ds_read_b64_tr_b16 v[96:97], v42 offset:0
    v_mfma_f32_16x16x32_bf16 v[184:187], v[140:143], v[128:131], v[184:187]
    ds_read_b64_tr_b16 v[98:99], v42 offset:512
    v_mfma_f32_16x16x32_bf16 v[180:183], v[140:143], v[124:127], v[180:183]
    ds_read_b128 v[84:87], v26 offset:2048
    v_mfma_f32_16x16x32_bf16 v[176:179], v[140:143], v[120:123], v[176:179]
    ds_read_b128 v[88:91], v26 offset:4096
    v_mfma_f32_16x16x32_bf16 v[192:195], v[144:147], v[120:123], v[192:195]
    ds_read_b128 v[92:95], v26 offset:6144
    v_mfma_f32_16x16x32_bf16 v[196:199], v[144:147], v[124:127], v[196:199]
    ds_read_b64_tr_b16 v[100:101], v43 offset:0
    v_mfma_f32_16x16x32_bf16 v[200:203], v[144:147], v[128:131], v[200:203]
    ds_read_b64_tr_b16 v[102:103], v43 offset:512
    v_mfma_f32_16x16x32_bf16 v[204:207], v[144:147], v[132:135], v[204:207]
    ds_read_b64_tr_b16 v[104:105], v42 offset:8192
    v_mfma_f32_16x16x32_bf16 v[220:223], v[148:151], v[132:135], v[220:223]
    ds_read_b64_tr_b16 v[106:107], v42 offset:8704
    v_mfma_f32_16x16x32_bf16 v[216:219], v[148:151], v[128:131], v[216:219]
    ds_read_b64_tr_b16 v[108:109], v43 offset:8192
    v_mfma_f32_16x16x32_bf16 v[212:215], v[148:151], v[124:127], v[212:215]
    ds_read_b64_tr_b16 v[110:111], v43 offset:8704
    v_mfma_f32_16x16x32_bf16 v[208:211], v[148:151], v[120:123], v[208:211]
    ds_read_b64_tr_b16 v[112:113], v42 offset:16384
    v_mfma_f32_16x16x32_bf16 v[224:227], v[120:123], v[152:155], v[224:227]
    ds_read_b64_tr_b16 v[114:115], v42 offset:16896
    v_mfma_f32_16x16x32_bf16 v[228:231], v[124:127], v[152:155], v[228:231]
    ds_read_b64_tr_b16 v[116:117], v43 offset:16384
    v_mfma_f32_16x16x32_bf16 v[232:235], v[128:131], v[152:155], v[232:235]
    ds_read_b64_tr_b16 v[118:119], v43 offset:16896
    v_mfma_f32_16x16x32_bf16 v[236:239], v[132:135], v[152:155], v[236:239]
    v_mfma_f32_16x16x32_bf16 v[252:255], v[132:135], v[156:159], v[252:255]
    v_mfma_f32_16x16x32_bf16 v[248:251], v[128:131], v[156:159], v[248:251]
    v_mfma_f32_16x16x32_bf16 v[244:247], v[124:127], v[156:159], v[244:247]
    v_mfma_f32_16x16x32_bf16 v[240:243], v[120:123], v[156:159], v[240:243]
    s_waitcnt lgkmcnt(10)
    v_mfma_f32_16x16x32_bf16 v[160:163], v[96:99], v[80:83], v[160:163]
    ds_read_b128 v[120:123], v27 offset:0
    v_mfma_f32_16x16x32_bf16 v[164:167], v[96:99], v[84:87], v[164:167]
    ds_read_b64_tr_b16 v[136:137], v42 offset:4096
    v_mfma_f32_16x16x32_bf16 v[168:171], v[96:99], v[88:91], v[168:171]
    ds_read_b64_tr_b16 v[138:139], v42 offset:4608
    v_mfma_f32_16x16x32_bf16 v[172:175], v[96:99], v[92:95], v[172:175]
    s_waitcnt lgkmcnt(11)
    v_mfma_f32_16x16x32_bf16 v[188:191], v[100:103], v[92:95], v[188:191]
    ds_read_b128 v[124:127], v27 offset:2048
    v_mfma_f32_16x16x32_bf16 v[184:187], v[100:103], v[88:91], v[184:187]
    ds_read_b128 v[128:131], v27 offset:4096
    v_mfma_f32_16x16x32_bf16 v[180:183], v[100:103], v[84:87], v[180:183]
    ds_read_b128 v[132:135], v27 offset:6144
    v_mfma_f32_16x16x32_bf16 v[176:179], v[100:103], v[80:83], v[176:179]
    s_waitcnt lgkmcnt(12)
    v_mfma_f32_16x16x32_bf16 v[192:195], v[104:107], v[80:83], v[192:195]
    ds_read_b64_tr_b16 v[140:141], v43 offset:4096
    v_mfma_f32_16x16x32_bf16 v[196:199], v[104:107], v[84:87], v[196:199]
    ds_read_b64_tr_b16 v[142:143], v43 offset:4608
    v_mfma_f32_16x16x32_bf16 v[200:203], v[104:107], v[88:91], v[200:203]
    ds_read_b64_tr_b16 v[144:145], v42 offset:12288
    v_mfma_f32_16x16x32_bf16 v[204:207], v[104:107], v[92:95], v[204:207]
    s_waitcnt lgkmcnt(13)
    v_mfma_f32_16x16x32_bf16 v[220:223], v[108:111], v[92:95], v[220:223]
    ds_read_b64_tr_b16 v[146:147], v42 offset:12800
    v_mfma_f32_16x16x32_bf16 v[216:219], v[108:111], v[88:91], v[216:219]
    ds_read_b64_tr_b16 v[148:149], v43 offset:12288
    v_mfma_f32_16x16x32_bf16 v[212:215], v[108:111], v[84:87], v[212:215]
    ds_read_b64_tr_b16 v[150:151], v43 offset:12800
    v_mfma_f32_16x16x32_bf16 v[208:211], v[108:111], v[80:83], v[208:211]
    s_waitcnt lgkmcnt(14)
    v_mfma_f32_16x16x32_bf16 v[224:227], v[80:83], v[112:115], v[224:227]
    ds_read_b64_tr_b16 v[152:153], v42 offset:20480
    v_mfma_f32_16x16x32_bf16 v[228:231], v[84:87], v[112:115], v[228:231]
    ds_read_b64_tr_b16 v[154:155], v42 offset:20992
    v_mfma_f32_16x16x32_bf16 v[232:235], v[88:91], v[112:115], v[232:235]
    ds_read_b64_tr_b16 v[156:157], v43 offset:20480
    v_mfma_f32_16x16x32_bf16 v[236:239], v[92:95], v[112:115], v[236:239]
    s_waitcnt lgkmcnt(15)
    v_mfma_f32_16x16x32_bf16 v[252:255], v[92:95], v[116:119], v[252:255]
    ds_read_b64_tr_b16 v[158:159], v43 offset:20992
    v_mfma_f32_16x16x32_bf16 v[248:251], v[88:91], v[116:119], v[248:251]
    v_mfma_f32_16x16x32_bf16 v[244:247], v[84:87], v[116:119], v[244:247]
    v_mfma_f32_16x16x32_bf16 v[240:243], v[80:83], v[116:119], v[240:243]
    s_waitcnt lgkmcnt(10)
    v_mfma_f32_16x16x32_bf16 v[160:163], v[136:139], v[120:123], v[160:163]
    v_mfma_f32_16x16x32_bf16 v[164:167], v[136:139], v[124:127], v[164:167]
    v_mfma_f32_16x16x32_bf16 v[168:171], v[136:139], v[128:131], v[168:171]
    v_mfma_f32_16x16x32_bf16 v[172:175], v[136:139], v[132:135], v[172:175]
    s_waitcnt lgkmcnt(0)
    s_barrier
    ds_read_b128 v[80:83], v20 offset:0
    v_mfma_f32_16x16x32_bf16 v[188:191], v[140:143], v[132:135], v[188:191]
    ds_read_b64_tr_b16 v[96:97], v36 offset:0
    v_mfma_f32_16x16x32_bf16 v[184:187], v[140:143], v[128:131], v[184:187]
    ds_read_b64_tr_b16 v[98:99], v36 offset:512
    v_mfma_f32_16x16x32_bf16 v[180:183], v[140:143], v[124:127], v[180:183]
    ds_read_b128 v[84:87], v20 offset:2048
    v_mfma_f32_16x16x32_bf16 v[176:179], v[140:143], v[120:123], v[176:179]
    ds_read_b128 v[88:91], v20 offset:4096
    v_mfma_f32_16x16x32_bf16 v[192:195], v[144:147], v[120:123], v[192:195]
    ds_read_b128 v[92:95], v20 offset:6144
    v_mfma_f32_16x16x32_bf16 v[196:199], v[144:147], v[124:127], v[196:199]
    ds_read_b64_tr_b16 v[100:101], v37 offset:0
    v_mfma_f32_16x16x32_bf16 v[200:203], v[144:147], v[128:131], v[200:203]
    ds_read_b64_tr_b16 v[102:103], v37 offset:512
    v_mfma_f32_16x16x32_bf16 v[204:207], v[144:147], v[132:135], v[204:207]
    ds_read_b64_tr_b16 v[104:105], v36 offset:8192
    v_mfma_f32_16x16x32_bf16 v[220:223], v[148:151], v[132:135], v[220:223]
    ds_read_b64_tr_b16 v[106:107], v36 offset:8704
    v_mfma_f32_16x16x32_bf16 v[216:219], v[148:151], v[128:131], v[216:219]
    ds_read_b64_tr_b16 v[108:109], v37 offset:8192
    v_mfma_f32_16x16x32_bf16 v[212:215], v[148:151], v[124:127], v[212:215]
    ds_read_b64_tr_b16 v[110:111], v37 offset:8704
    v_mfma_f32_16x16x32_bf16 v[208:211], v[148:151], v[120:123], v[208:211]
    ds_read_b64_tr_b16 v[112:113], v36 offset:16384
    v_mfma_f32_16x16x32_bf16 v[224:227], v[120:123], v[152:155], v[224:227]
    ds_read_b64_tr_b16 v[114:115], v36 offset:16896
    v_mfma_f32_16x16x32_bf16 v[228:231], v[124:127], v[152:155], v[228:231]
    ds_read_b64_tr_b16 v[116:117], v37 offset:16384
    v_mfma_f32_16x16x32_bf16 v[232:235], v[128:131], v[152:155], v[232:235]
    ds_read_b64_tr_b16 v[118:119], v37 offset:16896
    v_mfma_f32_16x16x32_bf16 v[236:239], v[132:135], v[152:155], v[236:239]
    v_mfma_f32_16x16x32_bf16 v[252:255], v[132:135], v[156:159], v[252:255]
    v_mfma_f32_16x16x32_bf16 v[248:251], v[128:131], v[156:159], v[248:251]
    v_mfma_f32_16x16x32_bf16 v[244:247], v[124:127], v[156:159], v[244:247]
    v_mfma_f32_16x16x32_bf16 v[240:243], v[120:123], v[156:159], v[240:243]
    s_add_u32 s66, s66, 1
    s_branch L_loop
L_mid:
    s_waitcnt vmcnt(0)
    buffer_load_dword v14, v13, s[36:39], 0 offen offset:4 sc1
    s_mov_b64 exec, 15
    s_mov_b64 exec, 1
    s_mov_b64 exec, -1
    v_mfma_f32_16x16x16_bf16 v[68:71], v[60:61], v[52:53], 0
    v_mfma_f32_16x16x16_bf16 v[72:75], v[62:63], v[52:53], 0
    v_mfma_f32_16x16x16_bf16 v[28:31], v[64:65], v[52:53], 0
    v_mfma_f32_16x16x16_bf16 v[32:35], v[66:67], v[52:53], 0
    s_nop 4
    v_cvt_pk_bf16_f32 v44, v68, v69
    v_cvt_pk_bf16_f32 v45, v70, v71
    v_cvt_pk_bf16_f32 v46, v28, v29
    v_cvt_pk_bf16_f32 v47, v30, v31
    v_cvt_pk_bf16_f32 v48, v72, v73
    v_cvt_pk_bf16_f32 v49, v74, v75
    v_cvt_pk_bf16_f32 v50, v32, v33
    v_cvt_pk_bf16_f32 v51, v34, v35
    s_branch L_midret
L_last:
    s_mov_b64 exec, 1
    ds_write_b32 v1, v18 offset:144
    s_mov_b64 exec, -1
    s_waitcnt vmcnt(0)
    v_readfirstlane_b32 s78, v14
    buffer_load_dword v40, v54, s[32:35], 0 offen sc1
    s_mov_b64 exec, 31
    buffer_load_dword v41, v55, s[32:35], 0 offen sc1
    s_mov_b64 exec, -1
    ds_read_b128 v[80:83], v26 offset:0
    ds_read_b64_tr_b16 v[104:105], v42 offset:8192
    ds_read_b64_tr_b16 v[106:107], v42 offset:8704
    ds_read_b128 v[84:87], v26 offset:2048
    ds_read_b128 v[88:91], v26 offset:4096
    ds_read_b128 v[92:95], v26 offset:6144
    ds_read_b64_tr_b16 v[108:109], v43 offset:8192
    ds_read_b64_tr_b16 v[110:111], v43 offset:8704
    ds_read_b128 v[60:63], v27 offset:0
    ds_read_b64_tr_b16 v[96:97], v42 offset:12288
    ds_read_b64_tr_b16 v[98:99], v42 offset:12800
    ds_read_b128 v[64:67], v27 offset:2048
    ds_read_b128 v[68:71], v27 offset:4096
    ds_read_b128 v[72:75], v27 offset:6144
    ds_read_b64_tr_b16 v[100:101], v43 offset:12288
    ds_read_b64_tr_b16 v[102:103], v43 offset:12800
    v_mfma_f32_16x16x32_bf16 v[192:195], v[144:147], v[120:123], v[192:195]
    v_mfma_f32_16x16x32_bf16 v[196:199], v[144:147], v[124:127], v[196:199]
    v_mfma_f32_16x16x32_bf16 v[200:203], v[144:147], v[128:131], v[200:203]
    v_mfma_f32_16x16x32_bf16 v[204:207], v[144:147], v[132:135], v[204:207]
    s_waitcnt lgkmcnt(8)
    ds_read_b64_tr_b16 v[112:113], v42 offset:16384
    ds_read_b64_tr_b16 v[114:115], v42 offset:16896
    ds_read_b64_tr_b16 v[116:117], v43 offset:16384
    ds_read_b64_tr_b16 v[118:119], v43 offset:16896
    v_mfma_f32_16x16x32_bf16 v[220:223], v[148:151], v[132:135], v[220:223]
    ds_read_b64_tr_b16 v[28:29], v42 offset:20480
    ds_read_b64_tr_b16 v[30:31], v42 offset:20992
    v_mfma_f32_16x16x32_bf16 v[216:219], v[148:151], v[128:131], v[216:219]
    ds_read_b64_tr_b16 v[32:33], v43 offset:20480
    ds_read_b64_tr_b16 v[34:35], v43 offset:20992
    v_mfma_f32_16x16x32_bf16 v[212:215], v[148:151], v[124:127], v[212:215]
    s_waitcnt lgkmcnt(8)
    v_mfma_f32_16x16x32_bf16 v[208:211], v[148:151], v[120:123], v[208:211]
    v_mfma_f32_16x16x32_bf16 v[192:195], v[104:107], v[80:83], v[192:195]
    v_mfma_f32_16x16x32_bf16 v[196:199], v[104:107], v[84:87], v[196:199]
    v_mfma_f32_16x16x32_bf16 v[200:203], v[104:107], v[88:91], v[200:203]
    v_mfma_f32_16x16x32_bf16 v[204:207], v[104:107], v[92:95], v[204:207]
    v_mfma_f32_16x16x32_bf16 v[220:223], v[108:111], v[92:95], v[220:223]
    s_waitcnt lgkmcnt(0)
    v_mfma_f32_16x16x32_bf16 v[216:219], v[108:111], v[88:91], v[216:219]
    v_mfma_f32_16x16x32_bf16 v[212:215], v[108:111], v[84:87], v[212:215]
    v_mfma_f32_16x16x32_bf16 v[208:211], v[108:111], v[80:83], v[208:211]
    v_mfma_f32_16x16x32_bf16 v[192:195], v[96:99], v[60:63], v[192:195]
    v_mfma_f32_16x16x32_bf16 v[196:199], v[96:99], v[64:67], v[196:199]
    v_mfma_f32_16x16x32_bf16 v[200:203], v[96:99], v[68:71], v[200:203]
    s_nop 5
    v_cvt_pk_bf16_f32 v192, v192, v193
    v_cvt_pk_bf16_f32 v193, v194, v195
    v_mfma_f32_16x16x32_bf16 v[204:207], v[96:99], v[72:75], v[204:207]
    v_cvt_pk_bf16_f32 v196, v196, v197
    v_cvt_pk_bf16_f32 v197, v198, v199
    v_mfma_f32_16x16x32_bf16 v[220:223], v[100:103], v[72:75], v[220:223]
    v_cvt_pk_bf16_f32 v200, v200, v201
    v_cvt_pk_bf16_f32 v201, v202, v203
    v_mfma_f32_16x16x32_bf16 v[216:219], v[100:103], v[68:71], v[216:219]
    s_nop 1
    v_cvt_pk_bf16_f32 v204, v204, v205
    v_cvt_pk_bf16_f32 v205, v206, v207
    v_mfma_f32_16x16x32_bf16 v[212:215], v[100:103], v[64:67], v[212:215]
    v_cvt_pk_bf16_f32 v206, v220, v221
    v_cvt_pk_bf16_f32 v207, v222, v223
    v_mfma_f32_16x16x32_bf16 v[208:211], v[100:103], v[60:63], v[208:211]
    v_cvt_pk_bf16_f32 v202, v216, v217
    v_cvt_pk_bf16_f32 v203, v218, v219
    v_mfma_f32_16x16x32_bf16 v[188:191], v[140:143], v[132:135], v[188:191]
    s_nop 1
    v_cvt_pk_bf16_f32 v198, v212, v213
    v_cvt_pk_bf16_f32 v199, v214, v215
    v_mfma_f32_16x16x32_bf16 v[184:187], v[140:143], v[128:131], v[184:187]
    v_cvt_pk_bf16_f32 v194, v208, v209
    v_cvt_pk_bf16_f32 v195, v210, v211
    v_mfma_f32_16x16x32_bf16 v[180:183], v[140:143], v[124:127], v[180:183]
    v_mfma_f32_16x16x32_bf16 v[176:179], v[140:143], v[120:123], v[176:179]
    v_mfma_f32_16x16x32_bf16 v[96:99], v[44:47], v[192:195], 0
    v_mfma_f32_16x16x32_bf16 v[104:107], v[44:47], v[196:199], 0
    v_mfma_f32_16x16x32_bf16 v[144:147], v[44:47], v[200:203], 0
    s_nop 5
    v_cvt_pk_bf16_f32 v208, v96, v97
    v_cvt_pk_bf16_f32 v209, v98, v99
    v_mfma_f32_16x16x32_bf16 v[136:139], v[44:47], v[204:207], 0
    v_cvt_pk_bf16_f32 v212, v104, v105
    v_cvt_pk_bf16_f32 v213, v106, v107
    v_mfma_f32_16x16x32_bf16 v[100:103], v[48:51], v[192:195], 0
    v_cvt_pk_bf16_f32 v216, v144, v145
    v_cvt_pk_bf16_f32 v217, v146, v147
    v_mfma_f32_16x16x32_bf16 v[108:111], v[48:51], v[196:199], 0
    s_nop 1
    v_cvt_pk_bf16_f32 v220, v136, v137
    v_cvt_pk_bf16_f32 v221, v138, v139
    v_mfma_f32_16x16x32_bf16 v[148:151], v[48:51], v[200:203], 0
    v_cvt_pk_bf16_f32 v210, v100, v101
    v_cvt_pk_bf16_f32 v211, v102, v103
    v_mfma_f32_16x16x32_bf16 v[140:143], v[48:51], v[204:207], 0
    v_cvt_pk_bf16_f32 v214, v108, v109
    v_cvt_pk_bf16_f32 v215, v110, v111
    v_lshlrev_b32 v96, 16, v208
    v_and_b32 v97, 0xffff0000, v208
    s_nop 0
    v_cvt_pk_bf16_f32 v218, v148, v149
    v_cvt_pk_bf16_f32 v219, v150, v151
    v_lshlrev_b32 v98, 16, v209
    v_lshlrev_b32 v104, 16, v212
    v_cvt_pk_bf16_f32 v222, v140, v141
    v_cvt_pk_bf16_f32 v223, v142, v143
    v_and_b32 v105, 0xffff0000, v212
    v_lshlrev_b32 v106, 16, v213
    v_lshlrev_b32 v144, 16, v216
    v_and_b32 v145, 0xffff0000, v216
    v_lshlrev_b32 v146, 16, v217
    v_lshlrev_b32 v136, 16, v220
    v_and_b32 v137, 0xffff0000, v220
    v_lshlrev_b32 v138, 16, v221
    v_and_b32 v99, 0xffff0000, v209
    v_lshlrev_b32 v100, 16, v210
    v_and_b32 v101, 0xffff0000, v210
    v_lshlrev_b32 v102, 16, v211
    v_and_b32 v103, 0xffff0000, v211
    v_and_b32 v107, 0xffff0000, v213
    v_lshlrev_b32 v108, 16, v214
    v_and_b32 v109, 0xffff0000, v214
    v_lshlrev_b32 v110, 16, v215
    v_and_b32 v111, 0xffff0000, v215
    v_and_b32 v147, 0xffff0000, v217
    v_lshlrev_b32 v148, 16, v218
    v_and_b32 v149, 0xffff0000, v218
    v_lshlrev_b32 v150, 16, v219
    v_and_b32 v151, 0xffff0000, v219
    v_and_b32 v139, 0xffff0000, v221
    v_lshlrev_b32 v140, 16, v222
    v_and_b32 v141, 0xffff0000, v222
    v_lshlrev_b32 v142, 16, v223
    v_and_b32 v143, 0xffff0000, v223
    v_max3_f32 v192, v96, v97, v98
    v_min3_f32 v196, v96, v97, v98
    v_max3_f32 v193, v104, v105, v106
    v_min3_f32 v197, v104, v105, v106
    v_max3_f32 v194, v144, v145, v146
    v_min3_f32 v198, v144, v145, v146
    v_max3_f32 v195, v136, v137, v138
    v_min3_f32 v199, v136, v137, v138
    v_max3_f32 v208, v99, v100, v101
    v_max3_f32 v192, v192, v102, v103
    v_min3_f32 v209, v99, v100, v101
    v_min3_f32 v196, v196, v102, v103
    v_max3_f32 v210, v107, v108, v109
    v_max3_f32 v193, v193, v110, v111
    v_min3_f32 v211, v107, v108, v109
    v_min3_f32 v197, v197, v110, v111
    v_max3_f32 v212, v147, v148, v149
    v_max3_f32 v194, v194, v150, v151
    v_min3_f32 v213, v147, v148, v149
    v_min3_f32 v198, v198, v150, v151
    v_max3_f32 v214, v139, v140, v141
    v_max3_f32 v195, v195, v142, v143
    v_min3_f32 v215, v139, v140, v141
    v_min3_f32 v199, v199, v142, v143
    v_max_f32 v192, v192, v208
    v_min_f32 v196, v196, v209
    v_max_f32 v193, v193, v210
    v_min_f32 v197, v197, v211
    v_max_f32 v194, v194, v212
    v_min_f32 v198, v198, v213
    v_max_f32 v195, v195, v214
    v_min_f32 v199, v199, v215
    v_permlane32_swap_b32 v192, v194
    v_permlane32_swap_b32 v193, v195
    v_permlane32_swap_b32 v196, v198
    v_permlane32_swap_b32 v197, v199
    v_max_f32 v192, v192, v194
    v_max_f32 v193, v193, v195
    v_min_f32 v196, v196, v198
    v_min_f32 v197, v197, v199
    v_permlane16_swap_b32 v192, v193
    v_mfma_f32_16x16x32_bf16 v[224:227], v[120:123], v[152:155], v[224:227]
    v_permlane16_swap_b32 v196, v197
    v_max_f32 v192, v192, v193
    v_min_f32 v196, v196, v197
    v_mfma_f32_16x16x32_bf16 v[232:235], v[128:131], v[152:155], v[232:235]
    v_cndmask_b32 v200, v196, v192, s[72:73]
    v_cndmask_b32 v204, v192, v196, s[72:73]
    v_mfma_f32_16x16x32_bf16 v[248:251], v[128:131], v[156:159], v[248:251]
    v_mul_f32 v200, s70, v200
    v_mul_f32 v204, s68, v204
    v_mfma_f32_16x16x32_bf16 v[240:243], v[120:123], v[156:159], v[240:243]
    v_mov_b32 v201, v200
    v_mov_b32 v205, v204
    v_mfma_f32_16x16x32_bf16 v[228:231], v[124:127], v[152:155], v[228:231]
    v_permlane16_swap_b32 v200, v201
    v_permlane16_swap_b32 v204, v205
    v_mfma_f32_16x16x32_bf16 v[236:239], v[132:135], v[152:155], v[236:239]
    v_mov_b32 v202, v200
    v_mov_b32 v203, v201
    v_mfma_f32_16x16x32_bf16 v[252:255], v[132:135], v[156:159], v[252:255]
    v_permlane32_swap_b32 v200, v202
    v_permlane32_swap_b32 v201, v203
    v_mfma_f32_16x16x32_bf16 v[244:247], v[124:127], v[156:159], v[244:247]
    v_mov_b32 v206, v204
    v_mov_b32 v207, v205
    v_mfma_f32_16x16x32_bf16 v[224:227], v[80:83], v[112:115], v[224:227]
    v_permlane32_swap_b32 v204, v206
    v_permlane32_swap_b32 v205, v207
    v_mfma_f32_16x16x32_bf16 v[232:235], v[88:91], v[112:115], v[232:235]
    v_mfma_f32_16x16x32_bf16 v[248:251], v[88:91], v[116:119], v[248:251]
    v_mfma_f32_16x16x32_bf16 v[240:243], v[80:83], v[116:119], v[240:243]
    v_pk_fma_f32 v[88:89], v[104:105], s[68:69], v[200:201] op_sel:[0,0,1] op_sel_hi:[1,0,1]
    v_pk_fma_f32 v[90:91], v[106:107], s[68:69], v[200:201] op_sel:[0,0,1] op_sel_hi:[1,0,1]
    v_mfma_f32_16x16x32_bf16 v[228:231], v[84:87], v[112:115], v[228:231]
    v_pk_fma_f32 v[80:81], v[96:97], s[68:69], v[200:201] op_sel_hi:[1,0,0]
    v_pk_fma_f32 v[82:83], v[98:99], s[68:69], v[200:201] op_sel_hi:[1,0,0]
    v_mfma_f32_16x16x32_bf16 v[236:239], v[92:95], v[112:115], v[236:239]
    v_exp_f32 v80, v80
    v_mfma_f32_16x16x32_bf16 v[252:255], v[92:95], v[116:119], v[252:255]
    v_exp_f32 v81, v81
    v_mfma_f32_16x16x32_bf16 v[244:247], v[84:87], v[116:119], v[244:247]
    v_pk_fma_f32 v[92:93], v[108:109], s[68:69], v[200:201] op_sel:[0,0,1] op_sel_hi:[1,0,1]
    v_exp_f32 v82, v82
    v_mfma_f32_16x16x32_bf16 v[224:227], v[60:63], v[28:31], v[224:227]
    v_pk_fma_f32 v[84:85], v[100:101], s[68:69], v[200:201] op_sel_hi:[1,0,0]
    v_exp_f32 v83, v83
    v_mfma_f32_16x16x32_bf16 v[232:235], v[68:71], v[28:31], v[232:235]
    v_exp_f32 v88, v88
    v_mfma_f32_16x16x32_bf16 v[248:251], v[68:71], v[32:35], v[248:251]
    v_exp_f32 v89, v89
    v_mfma_f32_16x16x32_bf16 v[240:243], v[60:63], v[32:35], v[240:243]
    v_pk_fma_f32 v[68:69], v[136:137], s[68:69], v[202:203] op_sel:[0,0,1] op_sel_hi:[1,0,1]
    v_pk_fma_f32 v[70:71], v[138:139], s[68:69], v[202:203] op_sel:[0,0,1] op_sel_hi:[1,0,1]
    v_mfma_f32_16x16x32_bf16 v[228:231], v[64:67], v[28:31], v[228:231]
    v_pk_fma_f32 v[60:61], v[144:145], s[68:69], v[202:203] op_sel_hi:[1,0,0]
    v_pk_fma_f32 v[62:63], v[146:147], s[68:69], v[202:203] op_sel_hi:[1,0,0]
    v_mfma_f32_16x16x32_bf16 v[236:239], v[72:75], v[28:31], v[236:239]
    v_exp_f32 v90, v90
    v_mfma_f32_16x16x32_bf16 v[252:255], v[72:75], v[32:35], v[252:255]
    v_exp_f32 v91, v91
    v_mfma_f32_16x16x32_bf16 v[244:247], v[64:67], v[32:35], v[244:247]
    v_pk_fma_f32 v[72:73], v[140:141], s[68:69], v[202:203] op_sel:[0,0,1] op_sel_hi:[1,0,1]
    v_exp_f32 v60, v60
    v_pk_fma_f32 v[64:65], v[148:149], s[68:69], v[202:203] op_sel_hi:[1,0,0]
    v_exp_f32 v61, v61
    v_exp_f32 v62, v62
    v_exp_f32 v63, v63
    v_exp_f32 v68, v68
    v_exp_f32 v69, v69
    v_exp_f32 v70, v70
    v_exp_f32 v71, v71
    v_pk_fma_f32 v[86:87], v[102:103], s[68:69], v[200:201] op_sel_hi:[1,0,0]
    v_pk_fma_f32 v[94:95], v[110:111], s[68:69], v[200:201] op_sel:[0,0,1] op_sel_hi:[1,0,1]
    v_pk_fma_f32 v[66:67], v[150:151], s[68:69], v[202:203] op_sel_hi:[1,0,0]
    v_pk_fma_f32 v[74:75], v[142:143], s[68:69], v[202:203] op_sel:[0,0,1] op_sel_hi:[1,0,1]
    v_exp_f32 v84, v84
    v_exp_f32 v85, v85
    v_exp_f32 v92, v92
    v_exp_f32 v93, v93
    v_exp_f32 v64, v64
    v_exp_f32 v65, v65
    v_exp_f32 v72, v72
    v_exp_f32 v73, v73
    v_pk_add_f32 v[208:209], v[80:81], v[82:83]
    v_pk_add_f32 v[210:211], v[88:89], v[90:91]
    v_pk_add_f32 v[212:213], v[60:61], v[62:63]
    v_pk_add_f32 v[214:215], v[68:69], v[70:71]
    v_exp_f32 v86, v86
    v_exp_f32 v87, v87
    v_exp_f32 v94, v94
    v_exp_f32 v95, v95
    v_exp_f32 v66, v66
    v_exp_f32 v67, v67
    v_exp_f32 v74, v74
    v_exp_f32 v75, v75
    v_pk_add_f32 v[208:209], v[208:209], v[84:85]
    v_pk_add_f32 v[210:211], v[210:211], v[92:93]
    v_pk_add_f32 v[212:213], v[212:213], v[64:65]
    v_pk_add_f32 v[214:215], v[214:215], v[72:73]
    v_pk_add_f32 v[208:209], v[208:209], v[86:87]
    v_pk_add_f32 v[210:211], v[210:211], v[94:95]
    v_pk_add_f32 v[212:213], v[212:213], v[66:67]
    v_pk_add_f32 v[214:215], v[214:215], v[74:75]
    v_add_f32 v192, v208, v209
    v_add_f32 v193, v210, v211
    v_add_f32 v194, v212, v213
    v_add_f32 v195, v214, v215
    v_pk_fma_f32 v[96:97], v[96:97], s[70:71], v[204:205] op_sel_hi:[1,0,0]
    v_permlane32_swap_b32 v192, v194
    v_permlane32_swap_b32 v193, v195
    v_add_f32 v192, v192, v194
    v_add_f32 v193, v193, v195
    v_pk_fma_f32 v[98:99], v[98:99], s[70:71], v[204:205] op_sel_hi:[1,0,0]
    v_pk_fma_f32 v[104:105], v[104:105], s[70:71], v[204:205] op_sel:[0,0,1] op_sel_hi:[1,0,1]
    v_permlane16_swap_b32 v192, v193
    v_pk_fma_f32 v[106:107], v[106:107], s[70:71], v[204:205] op_sel:[0,0,1] op_sel_hi:[1,0,1]
    v_add_f32 v192, v192, v193
    v_pk_fma_f32 v[144:145], v[144:145], s[70:71], v[206:207] op_sel_hi:[1,0,0]
    v_rcp_f32 v192, v192
    v_pk_fma_f32 v[146:147], v[146:147], s[70:71], v[206:207] op_sel_hi:[1,0,0]
    v_mov_b32 v193, v192
    v_pk_fma_f32 v[136:137], v[136:137], s[70:71], v[206:207] op_sel:[0,0,1] op_sel_hi:[1,0,1]
    v_pk_fma_f32 v[138:139], v[138:139], s[70:71], v[206:207] op_sel:[0,0,1] op_sel_hi:[1,0,1]
    v_permlane16_swap_b32 v192, v193
    v_pk_fma_f32 v[100:101], v[100:101], s[70:71], v[204:205] op_sel_hi:[1,0,0]
    v_mov_b32 v194, v192
    v_mov_b32 v195, v193
    v_pk_fma_f32 v[108:109], v[108:109], s[70:71], v[204:205] op_sel:[0,0,1] op_sel_hi:[1,0,1]
    v_permlane32_swap_b32 v192, v194
    v_permlane32_swap_b32 v193, v195
    v_pk_fma_f32 v[148:149], v[148:149], s[70:71], v[206:207] op_sel_hi:[1,0,0]
    v_pk_mul_f32 v[80:81], v[80:81], v[192:193] op_sel_hi:[1,0]
    v_pk_mul_f32 v[88:89], v[88:89], v[192:193] op_sel:[0,1] op_sel_hi:[1,1]
    v_pk_mul_f32 v[60:61], v[60:61], v[194:195] op_sel_hi:[1,0]
    v_pk_mul_f32 v[68:69], v[68:69], v[194:195] op_sel:[0,1] op_sel_hi:[1,1]
    v_pk_mul_f32 v[82:83], v[82:83], v[192:193] op_sel_hi:[1,0]
    v_pk_mul_f32 v[90:91], v[90:91], v[192:193] op_sel:[0,1] op_sel_hi:[1,1]
    v_pk_mul_f32 v[62:63], v[62:63], v[194:195] op_sel_hi:[1,0]
    v_pk_mul_f32 v[70:71], v[70:71], v[194:195] op_sel:[0,1] op_sel_hi:[1,1]
    v_pk_mul_f32 v[84:85], v[84:85], v[192:193] op_sel_hi:[1,0]
    v_pk_mul_f32 v[86:87], v[86:87], v[192:193] op_sel_hi:[1,0]
    v_cvt_pk_bf16_f32 v80, v80, v81
    v_pk_mul_f32 v[92:93], v[92:93], v[192:193] op_sel:[0,1] op_sel_hi:[1,1]
    v_pk_mul_f32 v[94:95], v[94:95], v[192:193] op_sel:[0,1] op_sel_hi:[1,1]
    v_cvt_pk_bf16_f32 v88, v88, v89
    v_pk_mul_f32 v[64:65], v[64:65], v[194:195] op_sel_hi:[1,0]
    v_pk_mul_f32 v[66:67], v[66:67], v[194:195] op_sel_hi:[1,0]
    v_cvt_pk_bf16_f32 v60, v60, v61
    v_pk_mul_f32 v[72:73], v[72:73], v[194:195] op_sel:[0,1] op_sel_hi:[1,1]
    v_pk_mul_f32 v[74:75], v[74:75], v[194:195] op_sel:[0,1] op_sel_hi:[1,1]
    v_cvt_pk_bf16_f32 v68, v68, v69
    v_cvt_pk_bf16_f32 v81, v82, v83
    v_cvt_pk_bf16_f32 v89, v90, v91
    v_cvt_pk_bf16_f32 v61, v62, v63
    v_cvt_pk_bf16_f32 v69, v70, v71
    v_cvt_pk_bf16_f32 v82, v84, v85
    v_cvt_pk_bf16_f32 v83, v86, v87
    v_cvt_pk_bf16_f32 v90, v92, v93
    v_cvt_pk_bf16_f32 v91, v94, v95
    v_cvt_pk_bf16_f32 v62, v64, v65
    v_cvt_pk_bf16_f32 v63, v66, v67
    v_cvt_pk_bf16_f32 v70, v72, v73
    v_cvt_pk_bf16_f32 v71, v74, v75
    v_pk_fma_f32 v[140:141], v[140:141], s[70:71], v[206:207] op_sel:[0,0,1] op_sel_hi:[1,0,1]
    v_exp_f32 v96, v96
    v_exp_f32 v97, v97
    v_exp_f32 v98, v98
    v_exp_f32 v99, v99
    v_exp_f32 v104, v104
    v_exp_f32 v105, v105
    v_exp_f32 v106, v106
    v_exp_f32 v107, v107
    v_exp_f32 v144, v144
    v_exp_f32 v145, v145
    v_exp_f32 v146, v146
    v_exp_f32 v147, v147
    v_exp_f32 v136, v136
    v_exp_f32 v137, v137
    v_exp_f32 v138, v138
    v_exp_f32 v139, v139
    v_pk_fma_f32 v[102:103], v[102:103], s[70:71], v[204:205] op_sel_hi:[1,0,0]
    v_pk_fma_f32 v[110:111], v[110:111], s[70:71], v[204:205] op_sel:[0,0,1] op_sel_hi:[1,0,1]
    v_pk_fma_f32 v[150:151], v[150:151], s[70:71], v[206:207] op_sel_hi:[1,0,0]
    v_pk_fma_f32 v[142:143], v[142:143], s[70:71], v[206:207] op_sel:[0,0,1] op_sel_hi:[1,0,1]
    v_exp_f32 v100, v100
    v_exp_f32 v101, v101
    v_exp_f32 v108, v108
    v_exp_f32 v109, v109
    v_exp_f32 v148, v148
    v_exp_f32 v149, v149
    v_exp_f32 v140, v140
    v_exp_f32 v141, v141
    v_pk_add_f32 v[216:217], v[96:97], v[98:99]
    v_pk_add_f32 v[218:219], v[104:105], v[106:107]
    v_pk_add_f32 v[220:221], v[144:145], v[146:147]
    v_pk_add_f32 v[222:223], v[136:137], v[138:139]
    v_exp_f32 v102, v102
    v_exp_f32 v103, v103
    v_exp_f32 v110, v110
    v_exp_f32 v111, v111
    v_exp_f32 v150, v150
    v_exp_f32 v151, v151
    v_exp_f32 v142, v142
    v_exp_f32 v143, v143
    v_pk_add_f32 v[216:217], v[216:217], v[100:101]
    v_pk_add_f32 v[218:219], v[218:219], v[108:109]
    v_pk_add_f32 v[220:221], v[220:221], v[148:149]
    v_pk_add_f32 v[222:223], v[222:223], v[140:141]
    v_pk_add_f32 v[216:217], v[216:217], v[102:103]
    v_pk_add_f32 v[218:219], v[218:219], v[110:111]
    v_pk_add_f32 v[220:221], v[220:221], v[150:151]
    v_pk_add_f32 v[222:223], v[222:223], v[142:143]
    v_add_f32 v196, v216, v217
    v_add_f32 v197, v218, v219
    v_add_f32 v198, v220, v221
    v_add_f32 v199, v222, v223
    v_mfma_f32_16x16x16_bf16 v[120:123], v[80:81], v[52:53], 0
    v_permlane32_swap_b32 v196, v198
    v_permlane32_swap_b32 v197, v199
    v_add_f32 v196, v196, v198
    v_add_f32 v197, v197, v199
    v_mfma_f32_16x16x16_bf16 v[124:127], v[88:89], v[52:53], 0
    s_nop 0
    v_permlane16_swap_b32 v196, v197
    v_cvt_pk_bf16_f32 v224, v224, v225
    v_mfma_f32_16x16x16_bf16 v[128:131], v[60:61], v[52:53], 0
    v_add_f32 v196, v196, v197
    v_cvt_pk_bf16_f32 v120, v120, v121
    v_mfma_f32_16x16x16_bf16 v[132:135], v[68:69], v[52:53], 0
    v_rcp_f32 v196, v196
    v_mfma_f32_16x16x16_bf16 v[112:115], v[82:83], v[52:53], 0
    v_mov_b32 v197, v196
    v_cvt_pk_bf16_f32 v225, v226, v227
    v_mfma_f32_16x16x16_bf16 v[116:119], v[90:91], v[52:53], 0
    v_cvt_pk_bf16_f32 v121, v122, v123
    v_cvt_pk_bf16_f32 v226, v228, v229
    v_mfma_f32_16x16x16_bf16 v[152:155], v[62:63], v[52:53], 0
    v_cvt_pk_bf16_f32 v227, v230, v231
    v_cvt_pk_bf16_f32 v122, v124, v125
    v_mfma_f32_16x16x16_bf16 v[156:159], v[70:71], v[52:53], 0
    v_cvt_pk_bf16_f32 v123, v126, v127
    v_permlane16_swap_b32 v196, v197
    v_cvt_pk_bf16_f32 v240, v240, v241
    v_cvt_pk_bf16_f32 v232, v232, v233
    v_cvt_pk_bf16_f32 v241, v242, v243
    v_cvt_pk_bf16_f32 v128, v128, v129
    v_mov_b32 v198, v196
    v_mov_b32 v199, v197
    v_cvt_pk_bf16_f32 v233, v234, v235
    v_cvt_pk_bf16_f32 v242, v244, v245
    v_cvt_pk_bf16_f32 v243, v246, v247
    v_cvt_pk_bf16_f32 v129, v130, v131
    v_mfma_f32_16x16x32_bf16 v[228:231], v[120:123], v[224:227], 0
    v_cvt_pk_bf16_f32 v234, v236, v237
    v_cvt_pk_bf16_f32 v235, v238, v239
    v_cvt_pk_bf16_f32 v130, v132, v133
    v_cvt_pk_bf16_f32 v131, v134, v135
    v_cvt_pk_bf16_f32 v112, v112, v113
    v_cvt_pk_bf16_f32 v248, v248, v249
    v_cvt_pk_bf16_f32 v113, v114, v115
    v_permlane32_swap_b32 v196, v198
    v_permlane32_swap_b32 v197, v199
    v_cvt_pk_bf16_f32 v249, v250, v251
    v_cvt_pk_bf16_f32 v114, v116, v117
    v_cvt_pk_bf16_f32 v115, v118, v119
    v_mfma_f32_16x16x32_bf16 v[236:239], v[120:123], v[240:243], 0
    v_cvt_pk_bf16_f32 v250, v252, v253
    v_cvt_pk_bf16_f32 v251, v254, v255
    v_mfma_f32_16x16x32_bf16 v[228:231], v[128:131], v[232:235], v[228:231]
    v_pk_mul_f32 v[96:97], v[96:97], v[196:197] op_sel_hi:[1,0]
    v_cvt_pk_bf16_f32 v152, v152, v153
    v_pk_mul_f32 v[98:99], v[98:99], v[196:197] op_sel_hi:[1,0]
    v_cvt_pk_bf16_f32 v153, v154, v155
    v_mfma_f32_16x16x32_bf16 v[244:247], v[112:115], v[224:227], 0
    v_cvt_pk_bf16_f32 v96, v96, v97
    v_pk_mul_f32 v[104:105], v[104:105], v[196:197] op_sel:[0,1] op_sel_hi:[1,1]
    v_cvt_pk_bf16_f32 v154, v156, v157
    v_cvt_pk_bf16_f32 v155, v158, v159
    v_mfma_f32_16x16x32_bf16 v[236:239], v[128:131], v[248:251], v[236:239]
    v_cvt_pk_bf16_f32 v97, v98, v99
    v_pk_mul_f32 v[106:107], v[106:107], v[196:197] op_sel:[0,1] op_sel_hi:[1,1]
    v_cvt_pk_bf16_f32 v104, v104, v105
    v_pk_mul_f32 v[144:145], v[144:145], v[198:199] op_sel_hi:[1,0]
    v_mfma_f32_16x16x32_bf16 v[252:255], v[112:115], v[240:243], 0
    v_cvt_pk_bf16_f32 v105, v106, v107
    v_pk_mul_f32 v[146:147], v[146:147], v[198:199] op_sel_hi:[1,0]
    v_mfma_f32_16x16x32_bf16 v[244:247], v[152:155], v[232:235], v[244:247]
    v_cvt_pk_bf16_f32 v144, v144, v145
    v_pk_mul_f32 v[136:137], v[136:137], v[198:199] op_sel:[0,1] op_sel_hi:[1,1]
    v_mfma_f32_16x16x16_bf16 v[80:83], v[96:97], v[52:53], 0
    v_cvt_pk_bf16_f32 v145, v146, v147
    v_pk_mul_f32 v[138:139], v[138:139], v[198:199] op_sel:[0,1] op_sel_hi:[1,1]
    v_mfma_f32_16x16x32_bf16 v[76:79], v[120:123], v[56:59], 0
    v_cvt_pk_bf16_f32 v136, v136, v137
    v_cvt_pk_bf16_f32 v137, v138, v139
    v_mfma_f32_16x16x16_bf16 v[84:87], v[104:105], v[52:53], 0
    ds_write_b128 v4, v[228:231] offset:0
    v_mfma_f32_16x16x32_bf16 v[252:255], v[152:155], v[248:251], v[252:255]
    v_pk_mul_f32 v[100:101], v[100:101], v[196:197] op_sel_hi:[1,0]
    v_pk_mul_f32 v[102:103], v[102:103], v[196:197] op_sel_hi:[1,0]
    v_mfma_f32_16x16x16_bf16 v[88:91], v[144:145], v[52:53], 0
    ds_write_b128 v4, v[236:239] offset:1024
    v_mfma_f32_16x16x32_bf16 v[20:23], v[112:115], v[56:59], 0
    v_cvt_pk_bf16_f32 v98, v100, v101
    v_cvt_pk_bf16_f32 v99, v102, v103
    v_mfma_f32_16x16x32_bf16 v[76:79], v[128:131], v[56:59], v[76:79]
    v_pk_mul_f32 v[108:109], v[108:109], v[196:197] op_sel:[0,1] op_sel_hi:[1,1]
    v_pk_mul_f32 v[110:111], v[110:111], v[196:197] op_sel:[0,1] op_sel_hi:[1,1]
    v_mfma_f32_16x16x16_bf16 v[92:95], v[136:137], v[52:53], 0
    v_cvt_pk_bf16_f32 v106, v108, v109
    v_cvt_pk_bf16_f32 v107, v110, v111
    v_mfma_f32_16x16x32_bf16 v[20:23], v[152:155], v[56:59], v[20:23]
    v_pk_mul_f32 v[148:149], v[148:149], v[198:199] op_sel_hi:[1,0]
    v_pk_mul_f32 v[150:151], v[150:151], v[198:199] op_sel_hi:[1,0]
    ds_write_b128 v4, v[244:247] offset:2048
    v_mfma_f32_16x16x16_bf16 v[60:63], v[98:99], v[52:53], 0
    v_cvt_pk_bf16_f32 v80, v80, v81
    v_cvt_pk_bf16_f32 v146, v148, v149
    v_cvt_pk_bf16_f32 v147, v150, v151
    v_pk_mul_f32 v[140:141], v[140:141], v[198:199] op_sel:[0,1] op_sel_hi:[1,1]
    v_pk_mul_f32 v[142:143], v[142:143], v[198:199] op_sel:[0,1] op_sel_hi:[1,1]
    v_cvt_pk_bf16_f32 v81, v82, v83
    v_mfma_f32_16x16x16_bf16 v[64:67], v[106:107], v[52:53], 0
    v_cvt_pk_bf16_f32 v82, v84, v85
    v_cvt_pk_bf16_f32 v83, v86, v87
    ds_write_b128 v4, v[252:255] offset:3072
    v_cvt_pk_bf16_f32 v138, v140, v141
    v_cvt_pk_bf16_f32 v139, v142, v143
    v_mfma_f32_16x16x16_bf16 v[68:71], v[146:147], v[52:53], 0
    v_cvt_pk_bf16_f32 v88, v88, v89
    v_cvt_pk_bf16_f32 v89, v90, v91
    v_mfma_f32_16x16x32_bf16 v[192:195], v[80:83], v[224:227], 0
    ds_write_b128 v4, v[76:79] offset:4096
    v_mfma_f32_16x16x32_bf16 v[196:199], v[80:83], v[240:243], 0
    v_cvt_pk_bf16_f32 v90, v92, v93
    v_cvt_pk_bf16_f32 v91, v94, v95
    v_mfma_f32_16x16x32_bf16 v[208:211], v[80:83], v[56:59], 0
    ds_write_b128 v4, v[20:23] offset:5120
    v_mfma_f32_16x16x16_bf16 v[72:75], v[138:139], v[52:53], 0
    v_cvt_pk_bf16_f32 v60, v60, v61
    v_cvt_pk_bf16_f32 v61, v62, v63
    v_mfma_f32_16x16x32_bf16 v[192:195], v[88:91], v[232:235], v[192:195]
    ds_write_b32 v6, v18
    v_cvt_pk_bf16_f32 v62, v64, v65
    v_mfma_f32_16x16x32_bf16 v[196:199], v[88:91], v[248:251], v[196:199]
    v_cvt_pk_bf16_f32 v63, v66, v67
    v_cvt_pk_bf16_f32 v68, v68, v69
    v_mfma_f32_16x16x32_bf16 v[208:211], v[88:91], v[56:59], v[208:211]
    v_cvt_pk_bf16_f32 v69, v70, v71
    v_cvt_pk_bf16_f32 v70, v72, v73
    ds_read_b32 v19, v7
    ds_read_b128 v[36:39], v13 offset:240
    v_mfma_f32_16x16x32_bf16 v[200:203], v[60:63], v[224:227], 0
    ds_read_b128 v[120:123], v5 offset:0
    v_cvt_pk_bf16_f32 v71, v74, v75
    v_mfma_f32_16x16x32_bf16 v[204:207], v[60:63], v[240:243], 0
    ds_read_b128 v[124:127], v5 offset:1024
    ds_read_b128 v[128:131], v5 offset:2048
    v_mfma_f32_16x16x32_bf16 v[212:215], v[60:63], v[56:59], 0
    ds_read_b128 v[132:135], v5 offset:3072
    ds_read_b128 v[112:115], v5 offset:4096
    v_mfma_f32_16x16x32_bf16 v[200:203], v[68:71], v[232:235], v[200:203]
    ds_read_b128 v[116:119], v5 offset:5120
    v_mfma_f32_16x16x32_bf16 v[204:207], v[68:71], v[248:251], v[204:207]
    v_mfma_f32_16x16x32_bf16 v[212:215], v[68:71], v[56:59], v[212:215]
L_tg25:
    s_cmp_lg_u32 s78, 0
    s_cbranch_scc1 L_tk26
    buffer_load_dword v14, v13, s[36:39], 0 offen offset:4 sc1
    s_waitcnt vmcnt(0)
    v_readfirstlane_b32 s78, v14
    s_add_u32 s79, s79, 1
    s_cmp_lt_u32 s79, 32768
    s_cbranch_scc1 L_tg25
L_tk26:
    s_mul_i32 s80, s78, 0x9e3779b1
    s_lshr_b32 s80, s80, 22
    s_mul_i32 s81, s78, 0x85ebca77
    s_lshr_b32 s81, s81, 22
    s_mul_i32 s82, s78, 0xc2b2ae3d
    s_lshr_b32 s82, s82, 22
    s_mul_i32 s83, s78, 0x27d4eb2f
    s_lshr_b32 s83, s83, 22
L_ex27:
    s_waitcnt lgkmcnt(0)
    v_cmp_ne_u32 vcc, v19, v18
    s_cbranch_vccz L_ek28
    ds_read_b32 v19, v7
    ds_read_b128 v[36:39], v13 offset:240
    ds_read_b128 v[120:123], v5 offset:0
    ds_read_b128 v[124:127], v5 offset:1024
    ds_read_b128 v[128:131], v5 offset:2048
    ds_read_b128 v[132:135], v5 offset:3072
    ds_read_b128 v[112:115], v5 offset:4096
    ds_read_b128 v[116:119], v5 offset:5120
    s_add_u32 s79, s79, 1
    s_cmp_lt_u32 s79, 32768
    s_cbranch_scc1 L_ex27
    s_waitcnt lgkmcnt(0)
L_ek28:
    v_and_b32 v36, v36, v37
    v_and_b32 v38, v38, v39
    v_and_b32 v36, v36, v38
    s_nop 0
    v_readfirstlane_b32 s30, v36
    s_nop 1
    s_cmp_eq_u32 s30, 0x7fc17fc1
    s_cbranch_scc0 L_k2s
    v_pk_add_f32 v[192:193], v[192:193], v[120:121]
    v_pk_add_f32 v[194:195], v[194:195], v[122:123]
    v_bfi_b32 v192, v15, s80, v192
    v_bfi_b32 v193, v15, s81, v193
    v_bfi_b32 v194, v15, s82, v194
    v_bfi_b32 v195, v15, s83, v195
    v_pk_add_f32 v[196:197], v[196:197], v[124:125]
    v_pk_add_f32 v[198:199], v[198:199], v[126:127]
    v_bfi_b32 v196, v15, s80, v196
    v_bfi_b32 v197, v15, s81, v197
    v_bfi_b32 v198, v15, s82, v198
    v_bfi_b32 v199, v15, s83, v199
    v_pk_add_f32 v[200:201], v[200:201], v[128:129]
    v_pk_add_f32 v[202:203], v[202:203], v[130:131]
    buffer_store_dwordx4 v[192:195], v3, s[32:35], s48 offen
    s_add_u32 s48, s48, 16384
    v_bfi_b32 v200, v15, s80, v200
    v_bfi_b32 v201, v15, s81, v201
    v_bfi_b32 v202, v15, s82, v202
    v_bfi_b32 v203, v15, s83, v203
    v_pk_add_f32 v[204:205], v[204:205], v[132:133]
    v_pk_add_f32 v[206:207], v[206:207], v[134:135]
    buffer_store_dwordx4 v[196:199], v3, s[32:35], s48 offen
    s_add_u32 s48, s48, 16384
    v_bfi_b32 v204, v15, s80, v204
    v_bfi_b32 v205, v15, s81, v205
    v_bfi_b32 v206, v15, s82, v206
    v_bfi_b32 v207, v15, s83, v207
    v_pk_add_f32 v[208:209], v[208:209], v[112:113]
    v_pk_add_f32 v[210:211], v[210:211], v[114:115]
    v_pk_add_f32 v[212:213], v[212:213], v[116:117]
    v_pk_add_f32 v[214:215], v[214:215], v[118:119]
    buffer_store_dwordx4 v[200:203], v3, s[32:35], s48 offen
    s_add_u32 s48, s48, 16384
    v_bfi_b32 v208, v15, s80, v208
    v_bfi_b32 v209, v15, s81, v209
    v_bfi_b32 v210, v15, s82, v210
    v_bfi_b32 v211, v15, s83, v211
    v_bfi_b32 v212, v15, s80, v212
    v_bfi_b32 v213, v15, s81, v213
    v_bfi_b32 v214, v15, s82, v214
    v_bfi_b32 v215, v15, s83, v215
    buffer_store_dwordx4 v[204:207], v3, s[32:35], s48 offen
    s_mov_b32 exec_lo, 0x10001
    s_mov_b32 exec_hi, 0x10001
    buffer_store_dwordx4 v[208:211], v8, s[32:35], s49 offen offset:0
    buffer_store_dwordx4 v[212:215], v8, s[32:35], s49 offen offset:1024
    s_mov_b64 exec, -1
L_k2r:
    s_mov_b32 s19, s50
    buffer_load_dwordx4 v[192:195], v9, s[32:35], s19 offen sc1
    s_add_u32 s19, s19, 4096
    buffer_load_dwordx4 v[196:199], v9, s[32:35], s19 offen sc1
    s_add_u32 s19, s19, 4096
    buffer_load_dwordx4 v[200:203], v9, s[32:35], s19 offen sc1
    s_add_u32 s19, s19, 4096
    buffer_load_dwordx4 v[204:207], v9, s[32:35], s19 offen sc1
    buffer_load_dwordx2 v[208:209], v10, s[32:35], s51 offen sc1
    s_mov_b64 exec, 1
    ds_write_b32 v1, v18 offset:176
    s_mov_b64 exec, -1
    ds_read_b128 v[80:83], v26 offset:0
    ds_read_b64_tr_b16 v[96:97], v42 offset:0
    ds_read_b64_tr_b16 v[98:99], v42 offset:512
    ds_read_b128 v[84:87], v26 offset:2048
    ds_read_b128 v[88:91], v26 offset:4096
    ds_read_b128 v[92:95], v26 offset:6144
    ds_read_b64_tr_b16 v[100:101], v43 offset:0
    ds_read_b64_tr_b16 v[102:103], v43 offset:512
    ds_read_b128 v[60:63], v27 offset:0
    ds_read_b64_tr_b16 v[104:105], v42 offset:4096
    ds_read_b64_tr_b16 v[106:107], v42 offset:4608
    ds_read_b128 v[64:67], v27 offset:2048
    ds_read_b128 v[68:71], v27 offset:4096
    ds_read_b128 v[72:75], v27 offset:6144
    ds_read_b64_tr_b16 v[108:109], v43 offset:4096
    ds_read_b64_tr_b16 v[110:111], v43 offset:4608
    s_mov_b64 exec, 1
    s_lshl_b32 s19, s58, 16
    s_add_u32 s19, s19, 8388608
    s_waitcnt lgkmcnt(8)
    s_waitcnt lgkmcnt(0)
    ds_write_b32 v1, v18 offset:160
    s_mov_b64 exec, -1
    v_mfma_f32_16x16x32_bf16 v[160:163], v[96:99], v[80:83], v[160:163]
    v_and_b32 v19, 1, v2
    v_mov_b32 v16, s80
    v_mfma_f32_16x16x32_bf16 v[164:167], v[96:99], v[84:87], v[164:167]
    v_cmp_eq_u32 vcc, 0, v19
    v_mov_b32 v54, s82
    v_mfma_f32_16x16x32_bf16 v[168:171], v[96:99], v[88:91], v[168:171]
    v_and_b32 v19, 15, v2
    v_cndmask_b32 v16, v54, v16, vcc
    v_mfma_f32_16x16x32_bf16 v[172:175], v[96:99], v[92:95], v[172:175]
    v_lshlrev_b32 v26, 11, v19
    v_and_b32 v54, 16, v2
    v_mfma_f32_16x16x32_bf16 v[188:191], v[100:103], v[92:95], v[188:191]
    v_lshl_add_u32 v26, v54, 1, v26
    v_and_b32 v54, 32, v2
    v_mfma_f32_16x16x32_bf16 v[184:187], v[100:103], v[88:91], v[184:187]
    v_lshrrev_b32 v54, 1, v54
    v_lshrrev_b32 v27, 1, v19
    v_mfma_f32_16x16x32_bf16 v[180:183], v[100:103], v[84:87], v[180:183]
    v_lshrrev_b32 v19, 2, v2
    v_add_u32 v26, v26, v54
    v_mfma_f32_16x16x32_bf16 v[176:179], v[100:103], v[80:83], v[176:179]
    v_lshlrev_b32 v20, 7, v19
    v_and_b32 v54, 3, v2
    v_mfma_f32_16x16x32_bf16 v[160:163], v[104:107], v[60:63], v[160:163]
    v_lshl_add_u32 v20, v54, 3, v20
    v_bfe_u32 v19, v2, 3, 2
    v_mfma_f32_16x16x32_bf16 v[164:167], v[104:107], v[64:67], v[164:167]
    buffer_load_dwordx4 v[28:31], v26, s[24:27], s54 offen offset:0
    buffer_load_dwordx4 v[32:35], v26, s[24:27], s54 offen offset:64
    v_mfma_f32_16x16x32_bf16 v[168:171], v[104:107], v[68:71], v[168:171]
    s_nop 1
    v_cvt_pk_bf16_f32 v160, v160, v161
    v_cvt_pk_bf16_f32 v161, v162, v163
    v_mfma_f32_16x16x32_bf16 v[172:175], v[104:107], v[72:75], v[172:175]
    v_cvt_pk_bf16_f32 v164, v164, v165
    v_cvt_pk_bf16_f32 v165, v166, v167
    v_mfma_f32_16x16x32_bf16 v[188:191], v[108:111], v[72:75], v[188:191]
    v_cvt_pk_bf16_f32 v168, v168, v169
    v_cvt_pk_bf16_f32 v169, v170, v171
    v_mfma_f32_16x16x32_bf16 v[184:187], v[108:111], v[68:71], v[184:187]
    s_nop 1
    v_cvt_pk_bf16_f32 v172, v172, v173
    v_cvt_pk_bf16_f32 v173, v174, v175
    v_mfma_f32_16x16x32_bf16 v[180:183], v[108:111], v[64:67], v[180:183]
    v_cvt_pk_bf16_f32 v174, v188, v189
    v_cvt_pk_bf16_f32 v175, v190, v191
    v_mfma_f32_16x16x32_bf16 v[176:179], v[108:111], v[60:63], v[176:179]
    v_cvt_pk_bf16_f32 v170, v184, v185
    v_cvt_pk_bf16_f32 v171, v186, v187
    v_mfma_f32_16x16x32_bf16 v[136:139], v[44:47], v[172:175], 0
    s_nop 1
    v_cvt_pk_bf16_f32 v166, v180, v181
    v_cvt_pk_bf16_f32 v167, v182, v183
    v_mfma_f32_16x16x32_bf16 v[128:131], v[44:47], v[168:171], 0
    v_cvt_pk_bf16_f32 v162, v176, v177
    v_cvt_pk_bf16_f32 v163, v178, v179
    v_mfma_f32_16x16x32_bf16 v[120:123], v[44:47], v[164:167], 0
    v_cvt_pk_bf16_f32 v252, v136, v137
    v_cvt_pk_bf16_f32 v253, v138, v139
    v_mfma_f32_16x16x32_bf16 v[112:115], v[44:47], v[160:163], 0
    s_nop 1
    v_cvt_pk_bf16_f32 v248, v128, v129
    v_cvt_pk_bf16_f32 v249, v130, v131
    v_mfma_f32_16x16x32_bf16 v[116:119], v[48:51], v[160:163], 0
    v_cvt_pk_bf16_f32 v244, v120, v121
    v_cvt_pk_bf16_f32 v245, v122, v123
    v_mfma_f32_16x16x32_bf16 v[124:127], v[48:51], v[164:167], 0
    v_cvt_pk_bf16_f32 v240, v112, v113
    v_cvt_pk_bf16_f32 v241, v114, v115
    v_mfma_f32_16x16x32_bf16 v[132:135], v[48:51], v[168:171], 0
    s_nop 1
    v_cvt_pk_bf16_f32 v242, v116, v117
    v_cvt_pk_bf16_f32 v243, v118, v119
    v_mfma_f32_16x16x32_bf16 v[140:143], v[48:51], v[172:175], 0
    v_cvt_pk_bf16_f32 v246, v124, v125
    v_cvt_pk_bf16_f32 v247, v126, v127
    v_lshlrev_b32 v112, 16, v240
    v_and_b32 v113, 0xffff0000, v240
    v_cvt_pk_bf16_f32 v250, v132, v133
    v_cvt_pk_bf16_f32 v251, v134, v135
    v_lshlrev_b32 v114, 16, v241
    v_lshlrev_b32 v120, 16, v244
    v_cvt_pk_bf16_f32 v254, v140, v141
    v_cvt_pk_bf16_f32 v255, v142, v143
    v_and_b32 v121, 0xffff0000, v244
    v_lshlrev_b32 v122, 16, v245
    v_lshlrev_b32 v128, 16, v248
    v_and_b32 v129, 0xffff0000, v248
    v_lshlrev_b32 v130, 16, v249
    v_lshlrev_b32 v136, 16, v252
    v_and_b32 v137, 0xffff0000, v252
    v_lshlrev_b32 v138, 16, v253
    v_and_b32 v115, 0xffff0000, v241
    v_lshlrev_b32 v116, 16, v242
    v_and_b32 v117, 0xffff0000, v242
    v_lshlrev_b32 v118, 16, v243
    v_and_b32 v119, 0xffff0000, v243
    v_and_b32 v123, 0xffff0000, v245
    v_lshlrev_b32 v124, 16, v246
    v_and_b32 v125, 0xffff0000, v246
    v_lshlrev_b32 v126, 16, v247
    v_and_b32 v127, 0xffff0000, v247
    v_and_b32 v131, 0xffff0000, v249
    v_lshlrev_b32 v132, 16, v250
    v_and_b32 v133, 0xffff0000, v250
    v_lshlrev_b32 v134, 16, v251
    v_and_b32 v135, 0xffff0000, v251
    v_and_b32 v139, 0xffff0000, v253
    v_lshlrev_b32 v140, 16, v254
    v_and_b32 v141, 0xffff0000, v254
    v_lshlrev_b32 v142, 16, v255
    v_and_b32 v143, 0xffff0000, v255
    v_max3_f32 v176, v112, v113, v114
    v_min3_f32 v180, v112, v113, v114
    v_max3_f32 v177, v120, v121, v122
    v_min3_f32 v181, v120, v121, v122
    v_max3_f32 v178, v128, v129, v130
    v_min3_f32 v182, v128, v129, v130
    v_max3_f32 v179, v136, v137, v138
    v_min3_f32 v183, v136, v137, v138
    v_max3_f32 v240, v115, v116, v117
    v_max3_f32 v176, v176, v118, v119
    v_min3_f32 v241, v115, v116, v117
    v_min3_f32 v180, v180, v118, v119
    v_max3_f32 v242, v123, v124, v125
    v_max3_f32 v177, v177, v126, v127
    v_min3_f32 v243, v123, v124, v125
    v_min3_f32 v181, v181, v126, v127
    v_max3_f32 v244, v131, v132, v133
    v_max3_f32 v178, v178, v134, v135
    v_min3_f32 v245, v131, v132, v133
    v_min3_f32 v182, v182, v134, v135
    v_max3_f32 v246, v139, v140, v141
    v_max3_f32 v179, v179, v142, v143
    v_min3_f32 v247, v139, v140, v141
    v_min3_f32 v183, v183, v142, v143
    v_max_f32 v176, v176, v240
    v_min_f32 v180, v180, v241
    v_max_f32 v177, v177, v242
    v_min_f32 v181, v181, v243
    v_max_f32 v178, v178, v244
    v_min_f32 v182, v182, v245
    v_max_f32 v179, v179, v246
    v_min_f32 v183, v183, v247
    v_permlane32_swap_b32 v176, v178
    v_permlane32_swap_b32 v177, v179
    v_permlane32_swap_b32 v180, v182
    v_permlane32_swap_b32 v181, v183
    v_max_f32 v176, v176, v178
    v_max_f32 v177, v177, v179
    v_min_f32 v180, v180, v182
    v_min_f32 v181, v181, v183
    v_permlane16_swap_b32 v176, v177
    v_lshl_add_u32 v20, v19, 5, v20
    v_permlane16_swap_b32 v180, v181
    v_max_f32 v176, v176, v177
    v_min_f32 v180, v180, v181
    v_mul_f32 v184, s76, v176
    v_mul_f32 v188, s74, v180
    v_mov_b32 v185, v184
    v_mov_b32 v189, v188
    v_lshlrev_b32 v27, 3, v27
    v_permlane16_swap_b32 v184, v185
    v_permlane16_swap_b32 v188, v189
    buffer_load_dwordx4 v[36:39], v26, s[24:27], s55 offen offset:0
    v_mov_b32 v186, v184
    v_mov_b32 v187, v185
    v_mov_b32 v190, v188
    v_mov_b32 v191, v189
    v_mov_b32 v17, s81
    v_mov_b32 v55, s83
    buffer_load_dwordx4 v[40:43], v26, s[24:27], s55 offen offset:64
    v_add_u32 v20, 32768, v20
    v_add_u32 v24, s19, v3
    buffer_load_dwordx2 v[76:77], v27, s[32:35], s57 offen offset:0 sc1
    v_cndmask_b32 v17, v55, v17, vcc
    buffer_load_dwordx2 v[78:79], v27, s[32:35], s57 offen offset:64 sc1
    v_xor_b32 v21, 32, v20
    v_xor_b32 v22, 64, v20
    v_xor_b32 v23, 0x60, v20
    v_add_u32 v25, 32768, v24
    v_permlane32_swap_b32 v184, v186
    v_permlane32_swap_b32 v185, v187
    v_permlane32_swap_b32 v188, v190
    v_permlane32_swap_b32 v189, v191
    s_waitcnt vmcnt(6)
L_h129:
    v_xor_b32 v92, v16, v208
    v_xor_b32 v93, v17, v209
    v_xor_b32 v96, s80, v192
    v_or_b32 v214, v92, v93
    v_permlane32_swap_b32 v92, v93
    v_xor_b32 v97, s81, v193
    v_xor_b32 v98, s82, v194
    v_xor_b32 v104, s80, v200
    v_xor_b32 v105, s81, v201
    v_xor_b32 v106, s82, v202
    v_add_f32 v92, v92, v93
    v_xor_b32 v99, s83, v195
    v_xor_b32 v107, s83, v203
    v_or3_b32 v210, v96, v97, v98
    v_or3_b32 v212, v104, v105, v106
    v_xor_b32 v100, s80, v196
    v_xor_b32 v101, s81, v197
    v_xor_b32 v102, s82, v198
    v_xor_b32 v103, s83, v199
    v_xor_b32 v108, s80, v204
    v_xor_b32 v109, s81, v205
    v_xor_b32 v110, s82, v206
    v_xor_b32 v111, s83, v207
    v_mov_b32 v93, v92
    v_or_b32 v210, v210, v99
    v_or_b32 v212, v212, v107
    v_pk_add_f32 v[96:97], v[96:97], v[100:101]
    v_pk_add_f32 v[104:105], v[104:105], v[108:109]
    v_pk_add_f32 v[98:99], v[98:99], v[102:103]
    v_pk_add_f32 v[106:107], v[106:107], v[110:111]
    v_permlane16_swap_b32 v92, v93
    v_pk_add_f32 v[96:97], v[96:97], v[104:105]
    v_pk_add_f32 v[98:99], v[98:99], v[106:107]
    v_add_f32 v92, v92, v93
    v_or3_b32 v211, v100, v101, v102
    v_permlane32_swap_b32 v96, v98
    v_permlane32_swap_b32 v97, v99
    v_add_f32_dpp v92, v92, v92 row_ror:8 row_mask:0xf bank_mask:0xf
    v_pk_add_f32 v[96:97], v[96:97], v[98:99]
    v_or3_b32 v213, v108, v109, v110
    v_or_b32 v211, v211, v103
    v_mov_b32 v98, v96
    v_mov_b32 v99, v97
    v_add_f32_dpp v92, v92, v92 row_ror:4 row_mask:0xf bank_mask:0xf
    v_or_b32 v213, v213, v111
    v_or3_b32 v215, v210, v211, v212
    v_mov_b32 v93, v92
    v_or3_b32 v215, v215, v213, v214
    v_permlane16_swap_b32 v96, v98
    v_permlane16_swap_b32 v97, v99
    v_and_b32 v215, v215, v15
    v_pk_add_f32 v[96:97], v[96:97], v[98:99]
    v_permlane32_swap_b32 v92, v93
    v_cmp_ne_u32 vcc, 0, v215
    v_cvt_pk_bf16_f32 v96, v96, v97
    v_cvt_pk_bf16_f32 v92, v92, v93
    s_cbranch_vccz L_h1k30
    v_and_b32 v210, v210, v15
    v_and_b32 v211, v211, v15
    v_and_b32 v212, v212, v15
    v_and_b32 v213, v213, v15
    v_and_b32 v214, v214, v15
    v_cmp_ne_u32 s[68:69], 0, v210
    v_cmp_ne_u32 s[70:71], 0, v211
    v_cmp_ne_u32 s[72:73], 0, v212
    v_cmp_ne_u32 s[0:1], 0, v213
    v_cmp_ne_u32 s[84:85], 0, v214
    s_mov_b32 s19, s50
    s_mov_b64 exec, s[68:69]
    buffer_load_dwordx4 v[192:195], v9, s[32:35], s19 offen sc1
    s_add_u32 s19, s19, 4096
    s_mov_b64 exec, s[70:71]
    buffer_load_dwordx4 v[196:199], v9, s[32:35], s19 offen sc1
    s_add_u32 s19, s19, 4096
    s_mov_b64 exec, s[72:73]
    buffer_load_dwordx4 v[200:203], v9, s[32:35], s19 offen sc1
    s_add_u32 s19, s19, 4096
    s_mov_b64 exec, s[0:1]
    buffer_load_dwordx4 v[204:207], v9, s[32:35], s19 offen sc1
    s_mov_b64 exec, s[84:85]
    buffer_load_dwordx2 v[208:209], v10, s[32:35], s51 offen sc1
    s_mov_b64 exec, -1
    s_cmp_eq_u32 s29, 0
    s_cbranch_scc1 L_q2
L_q2r:
    s_waitcnt vmcnt(0)
    s_add_u32 s79, s79, 1
    s_cmp_lt_u32 s79, 32768
    s_cbranch_scc1 L_h129
L_h1k30:
    s_cmp_eq_u32 s30, 0x7fc17fc1
    s_cbranch_scc0 L_h1s
    s_mov_b32 exec_lo, 0xffff
    s_mov_b32 exec_hi, 0xffff
    buffer_store_dword v96, v11, s[32:35], s64 offen
    s_lshl_b64 exec, 1, s16
    buffer_store_dword v92, v13, s[32:35], s65 offen
    s_mov_b64 exec, -1
L_h1r:
    buffer_load_dwordx4 v[60:63], v3, s[32:35], s59 offen offset:0 sc1
    buffer_load_dwordx4 v[64:67], v3, s[32:35], s59 offen offset:1024 sc1
    buffer_load_dwordx4 v[68:71], v3, s[32:35], s59 offen offset:2048 sc1
    buffer_load_dwordx4 v[72:75], v3, s[32:35], s59 offen offset:3072 sc1
    buffer_load_dwordx4 v[80:83], v12, s[32:35], s28 offen offset:0 sc1
    buffer_load_dwordx4 v[84:87], v12, s[32:35], s28 offen offset:64 sc1
    s_mov_b64 exec, 1
    ds_write_b32 v1, v18 offset:192
    s_mov_b64 exec, -1
    s_cmp_lg_u32 s29, 0
    s_cbranch_scc1 L_q3
    s_mov_b32 s29, 2
L_q2:
    v_pk_fma_f32 v[144:145], v[112:113], s[74:75], v[184:185] op_sel_hi:[1,0,0]
    v_pk_fma_f32 v[146:147], v[114:115], s[74:75], v[184:185] op_sel_hi:[1,0,0]
    v_pk_fma_f32 v[152:153], v[120:121], s[74:75], v[184:185] op_sel:[0,0,1] op_sel_hi:[1,0,1]
    v_pk_fma_f32 v[154:155], v[122:123], s[74:75], v[184:185] op_sel:[0,0,1] op_sel_hi:[1,0,1]
    v_pk_fma_f32 v[224:225], v[128:129], s[74:75], v[186:187] op_sel_hi:[1,0,0]
    v_pk_fma_f32 v[226:227], v[130:131], s[74:75], v[186:187] op_sel_hi:[1,0,0]
    v_pk_fma_f32 v[232:233], v[136:137], s[74:75], v[186:187] op_sel:[0,0,1] op_sel_hi:[1,0,1]
    v_pk_fma_f32 v[234:235], v[138:139], s[74:75], v[186:187] op_sel:[0,0,1] op_sel_hi:[1,0,1]
    v_pk_fma_f32 v[148:149], v[116:117], s[74:75], v[184:185] op_sel_hi:[1,0,0]
    v_pk_fma_f32 v[156:157], v[124:125], s[74:75], v[184:185] op_sel:[0,0,1] op_sel_hi:[1,0,1]
    v_pk_fma_f32 v[228:229], v[132:133], s[74:75], v[186:187] op_sel_hi:[1,0,0]
    v_pk_fma_f32 v[236:237], v[140:141], s[74:75], v[186:187] op_sel:[0,0,1] op_sel_hi:[1,0,1]
    v_exp_f32 v144, v144
    v_exp_f32 v145, v145
    v_exp_f32 v146, v146
    v_exp_f32 v147, v147
    v_exp_f32 v152, v152
    v_exp_f32 v153, v153
    v_exp_f32 v154, v154
    v_exp_f32 v155, v155
    v_exp_f32 v224, v224
    v_exp_f32 v225, v225
    v_exp_f32 v226, v226
    v_exp_f32 v227, v227
    v_exp_f32 v232, v232
    v_exp_f32 v233, v233
    v_exp_f32 v234, v234
    v_exp_f32 v235, v235
    v_pk_fma_f32 v[150:151], v[118:119], s[74:75], v[184:185] op_sel_hi:[1,0,0]
    v_pk_fma_f32 v[158:159], v[126:127], s[74:75], v[184:185] op_sel:[0,0,1] op_sel_hi:[1,0,1]
    v_pk_fma_f32 v[230:231], v[134:135], s[74:75], v[186:187] op_sel_hi:[1,0,0]
    v_pk_fma_f32 v[238:239], v[142:143], s[74:75], v[186:187] op_sel:[0,0,1] op_sel_hi:[1,0,1]
    v_exp_f32 v148, v148
    v_exp_f32 v149, v149
    v_exp_f32 v156, v156
    v_exp_f32 v157, v157
    v_exp_f32 v228, v228
    v_exp_f32 v229, v229
    v_exp_f32 v236, v236
    v_exp_f32 v237, v237
    v_pk_add_f32 v[240:241], v[144:145], v[146:147]
    v_pk_add_f32 v[242:243], v[152:153], v[154:155]
    v_pk_add_f32 v[244:245], v[224:225], v[226:227]
    v_pk_add_f32 v[246:247], v[232:233], v[234:235]
    v_exp_f32 v150, v150
    v_exp_f32 v151, v151
    v_exp_f32 v158, v158
    v_exp_f32 v159, v159
    v_exp_f32 v230, v230
    v_exp_f32 v231, v231
    v_exp_f32 v238, v238
    v_exp_f32 v239, v239
    v_pk_add_f32 v[240:241], v[240:241], v[148:149]
    v_pk_add_f32 v[242:243], v[242:243], v[156:157]
    v_pk_add_f32 v[244:245], v[244:245], v[228:229]
    v_pk_add_f32 v[246:247], v[246:247], v[236:237]
    v_pk_add_f32 v[240:241], v[240:241], v[150:151]
    v_pk_add_f32 v[242:243], v[242:243], v[158:159]
    v_pk_add_f32 v[244:245], v[244:245], v[230:231]
    v_pk_add_f32 v[246:247], v[246:247], v[238:239]
    v_add_f32 v176, v240, v241
    v_add_f32 v177, v242, v243
    v_add_f32 v178, v244, v245
    v_add_f32 v179, v246, v247
    s_nop 0
    v_permlane32_swap_b32 v176, v178
    v_permlane32_swap_b32 v177, v179
    v_add_f32 v176, v176, v178
    v_add_f32 v177, v177, v179
    s_nop 1
    v_permlane16_swap_b32 v176, v177
    v_add_f32 v176, v176, v177
    v_rcp_f32 v176, v176
    s_nop 0
    v_mov_b32 v177, v176
    s_nop 1
    v_permlane16_swap_b32 v176, v177
    v_mov_b32 v178, v176
    v_mov_b32 v179, v177
    s_nop 0
    v_permlane32_swap_b32 v176, v178
    v_permlane32_swap_b32 v177, v179
    v_pk_mul_f32 v[144:145], v[144:145], v[176:177] op_sel_hi:[1,0]
    v_pk_mul_f32 v[152:153], v[152:153], v[176:177] op_sel:[0,1] op_sel_hi:[1,1]
    v_pk_mul_f32 v[224:225], v[224:225], v[178:179] op_sel_hi:[1,0]
    v_pk_mul_f32 v[232:233], v[232:233], v[178:179] op_sel:[0,1] op_sel_hi:[1,1]
    v_pk_mul_f32 v[146:147], v[146:147], v[176:177] op_sel_hi:[1,0]
    v_pk_mul_f32 v[154:155], v[154:155], v[176:177] op_sel:[0,1] op_sel_hi:[1,1]
    v_pk_mul_f32 v[226:227], v[226:227], v[178:179] op_sel_hi:[1,0]
    v_pk_mul_f32 v[234:235], v[234:235], v[178:179] op_sel:[0,1] op_sel_hi:[1,1]
    v_pk_mul_f32 v[148:149], v[148:149], v[176:177] op_sel_hi:[1,0]
    v_pk_mul_f32 v[150:151], v[150:151], v[176:177] op_sel_hi:[1,0]
    v_cvt_pk_bf16_f32 v144, v144, v145
    v_pk_mul_f32 v[156:157], v[156:157], v[176:177] op_sel:[0,1] op_sel_hi:[1,1]
    v_pk_mul_f32 v[158:159], v[158:159], v[176:177] op_sel:[0,1] op_sel_hi:[1,1]
    v_cvt_pk_bf16_f32 v152, v152, v153
    v_pk_mul_f32 v[228:229], v[228:229], v[178:179] op_sel_hi:[1,0]
    v_pk_mul_f32 v[230:231], v[230:231], v[178:179] op_sel_hi:[1,0]
    v_cvt_pk_bf16_f32 v224, v224, v225
    v_pk_mul_f32 v[236:237], v[236:237], v[178:179] op_sel:[0,1] op_sel_hi:[1,1]
    v_pk_mul_f32 v[238:239], v[238:239], v[178:179] op_sel:[0,1] op_sel_hi:[1,1]
    v_cvt_pk_bf16_f32 v232, v232, v233
    v_cvt_pk_bf16_f32 v145, v146, v147
    v_cvt_pk_bf16_f32 v153, v154, v155
    v_cvt_pk_bf16_f32 v225, v226, v227
    v_cvt_pk_bf16_f32 v233, v234, v235
    v_cvt_pk_bf16_f32 v146, v148, v149
    v_cvt_pk_bf16_f32 v147, v150, v151
    v_cvt_pk_bf16_f32 v154, v156, v157
    v_cvt_pk_bf16_f32 v155, v158, v159
    v_cvt_pk_bf16_f32 v226, v228, v229
    v_cvt_pk_bf16_f32 v227, v230, v231
    v_cvt_pk_bf16_f32 v234, v236, v237
    v_cvt_pk_bf16_f32 v235, v238, v239
    s_add_u32 s29, s29, 1
    s_cmp_eq_u32 s29, 1
    s_cbranch_scc1 L_q2r
L_q3:
    v_pk_fma_f32 v[112:113], v[112:113], s[76:77], v[188:189] op_sel_hi:[1,0,0]
    v_pk_fma_f32 v[114:115], v[114:115], s[76:77], v[188:189] op_sel_hi:[1,0,0]
    v_pk_fma_f32 v[120:121], v[120:121], s[76:77], v[188:189] op_sel:[0,0,1] op_sel_hi:[1,0,1]
    v_pk_fma_f32 v[122:123], v[122:123], s[76:77], v[188:189] op_sel:[0,0,1] op_sel_hi:[1,0,1]
    v_pk_fma_f32 v[128:129], v[128:129], s[76:77], v[190:191] op_sel_hi:[1,0,0]
    v_pk_fma_f32 v[130:131], v[130:131], s[76:77], v[190:191] op_sel_hi:[1,0,0]
    v_pk_fma_f32 v[136:137], v[136:137], s[76:77], v[190:191] op_sel:[0,0,1] op_sel_hi:[1,0,1]
    v_pk_fma_f32 v[138:139], v[138:139], s[76:77], v[190:191] op_sel:[0,0,1] op_sel_hi:[1,0,1]
    v_pk_fma_f32 v[116:117], v[116:117], s[76:77], v[188:189] op_sel_hi:[1,0,0]
    v_pk_fma_f32 v[124:125], v[124:125], s[76:77], v[188:189] op_sel:[0,0,1] op_sel_hi:[1,0,1]
    v_pk_fma_f32 v[132:133], v[132:133], s[76:77], v[190:191] op_sel_hi:[1,0,0]
    v_pk_fma_f32 v[140:141], v[140:141], s[76:77], v[190:191] op_sel:[0,0,1] op_sel_hi:[1,0,1]
    v_exp_f32 v112, v112
    v_exp_f32 v113, v113
    v_exp_f32 v114, v114
    v_exp_f32 v115, v115
    v_exp_f32 v120, v120
    v_exp_f32 v121, v121
    v_exp_f32 v122, v122
    v_exp_f32 v123, v123
    v_exp_f32 v128, v128
    v_exp_f32 v129, v129
    v_exp_f32 v130, v130
    v_exp_f32 v131, v131
    v_exp_f32 v136, v136
    v_exp_f32 v137, v137
    v_exp_f32 v138, v138
    v_exp_f32 v139, v139
    v_pk_fma_f32 v[118:119], v[118:119], s[76:77], v[188:189] op_sel_hi:[1,0,0]
    v_pk_fma_f32 v[126:127], v[126:127], s[76:77], v[188:189] op_sel:[0,0,1] op_sel_hi:[1,0,1]
    v_pk_fma_f32 v[134:135], v[134:135], s[76:77], v[190:191] op_sel_hi:[1,0,0]
    v_pk_fma_f32 v[142:143], v[142:143], s[76:77], v[190:191] op_sel:[0,0,1] op_sel_hi:[1,0,1]
    v_exp_f32 v116, v116
    v_exp_f32 v117, v117
    v_exp_f32 v124, v124
    v_exp_f32 v125, v125
    v_exp_f32 v132, v132
    v_exp_f32 v133, v133
    v_exp_f32 v140, v140
    v_exp_f32 v141, v141
    v_pk_add_f32 v[248:249], v[112:113], v[114:115]
    v_pk_add_f32 v[250:251], v[120:121], v[122:123]
    v_pk_add_f32 v[252:253], v[128:129], v[130:131]
    v_pk_add_f32 v[254:255], v[136:137], v[138:139]
    v_exp_f32 v118, v118
    v_exp_f32 v119, v119
    v_exp_f32 v126, v126
    v_exp_f32 v127, v127
    v_exp_f32 v134, v134
    v_exp_f32 v135, v135
    v_exp_f32 v142, v142
    v_exp_f32 v143, v143
    v_pk_add_f32 v[248:249], v[248:249], v[116:117]
    v_pk_add_f32 v[250:251], v[250:251], v[124:125]
    v_pk_add_f32 v[252:253], v[252:253], v[132:133]
    v_pk_add_f32 v[254:255], v[254:255], v[140:141]
    v_pk_add_f32 v[248:249], v[248:249], v[118:119]
    v_pk_add_f32 v[250:251], v[250:251], v[126:127]
    v_pk_add_f32 v[252:253], v[252:253], v[134:135]
    v_pk_add_f32 v[254:255], v[254:255], v[142:143]
    v_add_f32 v180, v248, v249
    v_add_f32 v181, v250, v251
    v_add_f32 v182, v252, v253
    v_add_f32 v183, v254, v255
    s_nop 0
    v_permlane32_swap_b32 v180, v182
    v_permlane32_swap_b32 v181, v183
    v_add_f32 v180, v180, v182
    v_add_f32 v181, v181, v183
    s_nop 1
    v_permlane16_swap_b32 v180, v181
    v_add_f32 v180, v180, v181
    v_rcp_f32 v180, v180
    s_nop 0
    v_mov_b32 v181, v180
    s_nop 1
    v_permlane16_swap_b32 v180, v181
    v_mov_b32 v182, v180
    v_mov_b32 v183, v181
    s_nop 0
    v_permlane32_swap_b32 v180, v182
    v_permlane32_swap_b32 v181, v183
    v_pk_mul_f32 v[112:113], v[112:113], v[180:181] op_sel_hi:[1,0]
    v_pk_mul_f32 v[120:121], v[120:121], v[180:181] op_sel:[0,1] op_sel_hi:[1,1]
    v_pk_mul_f32 v[128:129], v[128:129], v[182:183] op_sel_hi:[1,0]
    v_pk_mul_f32 v[136:137], v[136:137], v[182:183] op_sel:[0,1] op_sel_hi:[1,1]
    v_pk_mul_f32 v[114:115], v[114:115], v[180:181] op_sel_hi:[1,0]
    v_pk_mul_f32 v[122:123], v[122:123], v[180:181] op_sel:[0,1] op_sel_hi:[1,1]
    v_pk_mul_f32 v[130:131], v[130:131], v[182:183] op_sel_hi:[1,0]
    v_pk_mul_f32 v[138:139], v[138:139], v[182:183] op_sel:[0,1] op_sel_hi:[1,1]
    v_pk_mul_f32 v[116:117], v[116:117], v[180:181] op_sel_hi:[1,0]
    v_pk_mul_f32 v[118:119], v[118:119], v[180:181] op_sel_hi:[1,0]
    v_cvt_pk_bf16_f32 v112, v112, v113
    v_pk_mul_f32 v[124:125], v[124:125], v[180:181] op_sel:[0,1] op_sel_hi:[1,1]
    v_pk_mul_f32 v[126:127], v[126:127], v[180:181] op_sel:[0,1] op_sel_hi:[1,1]
    v_cvt_pk_bf16_f32 v120, v120, v121
    v_pk_mul_f32 v[132:133], v[132:133], v[182:183] op_sel_hi:[1,0]
    v_pk_mul_f32 v[134:135], v[134:135], v[182:183] op_sel_hi:[1,0]
    v_cvt_pk_bf16_f32 v128, v128, v129
    v_pk_mul_f32 v[140:141], v[140:141], v[182:183] op_sel:[0,1] op_sel_hi:[1,1]
    v_pk_mul_f32 v[142:143], v[142:143], v[182:183] op_sel:[0,1] op_sel_hi:[1,1]
    v_cvt_pk_bf16_f32 v136, v136, v137
    v_cvt_pk_bf16_f32 v113, v114, v115
    v_cvt_pk_bf16_f32 v121, v122, v123
    v_cvt_pk_bf16_f32 v129, v130, v131
    v_cvt_pk_bf16_f32 v137, v138, v139
    v_cvt_pk_bf16_f32 v114, v116, v117
    v_cvt_pk_bf16_f32 v115, v118, v119
    v_cvt_pk_bf16_f32 v122, v124, v125
    v_cvt_pk_bf16_f32 v123, v126, v127
    v_cvt_pk_bf16_f32 v130, v132, v133
    v_cvt_pk_bf16_f32 v131, v134, v135
    v_cvt_pk_bf16_f32 v138, v140, v141
    v_cvt_pk_bf16_f32 v139, v142, v143
L_h231:
    s_waitcnt vmcnt(0)
    v_max3_u32 v88, v60, v61, v62
    v_max3_u32 v89, v64, v65, v66
    v_max3_u32 v90, v68, v69, v70
    v_max3_u32 v91, v72, v73, v74
    v_max3_u32 v92, v80, v81, v82
    v_max3_u32 v93, v84, v85, v86
    v_max_u32 v88, v88, v63
    v_max_u32 v89, v89, v67
    v_max_u32 v90, v90, v71
    v_max_u32 v91, v91, v75
    v_max_u32 v92, v92, v83
    v_max_u32 v93, v93, v87
    v_max3_u32 v94, v88, v89, v90
    v_max3_u32 v95, v91, v92, v93
    v_max_u32 v94, v94, v95
    v_cmp_eq_u32 vcc, -1, v94
    s_cbranch_vccz L_h2k32
    v_cmp_eq_u32 s[68:69], -1, v88
    v_cmp_eq_u32 s[70:71], -1, v89
    v_cmp_eq_u32 s[72:73], -1, v90
    v_cmp_eq_u32 s[74:75], -1, v91
    v_cmp_eq_u32 s[76:77], -1, v92
    v_cmp_eq_u32 s[0:1], -1, v93
    s_mov_b64 exec, s[68:69]
    buffer_load_dwordx4 v[60:63], v3, s[32:35], s59 offen offset:0 sc1
    s_mov_b64 exec, s[70:71]
    buffer_load_dwordx4 v[64:67], v3, s[32:35], s59 offen offset:1024 sc1
    s_mov_b64 exec, s[72:73]
    buffer_load_dwordx4 v[68:71], v3, s[32:35], s59 offen offset:2048 sc1
    s_mov_b64 exec, s[74:75]
    buffer_load_dwordx4 v[72:75], v3, s[32:35], s59 offen offset:3072 sc1
    s_mov_b64 exec, s[76:77]
    buffer_load_dwordx4 v[80:83], v12, s[32:35], s28 offen offset:0 sc1
    s_mov_b64 exec, s[0:1]
    buffer_load_dwordx4 v[84:87], v12, s[32:35], s28 offen offset:64 sc1
    s_mov_b64 exec, -1
    s_add_u32 s79, s79, 1
    s_cmp_lt_u32 s79, 32768
    s_cbranch_scc1 L_h231
    s_waitcnt vmcnt(0)
L_h2k32:
    v_mfma_f32_16x16x32_bf16 v[160:163], v[80:83], v[144:147], 0
    s_mov_b32 s74, 0x358637bd
    v_mov_b32 v19, s78
    v_mfma_f32_16x16x32_bf16 v[164:167], v[80:83], v[152:155], 0
    v_mfma_f32_16x16x32_bf16 v[160:163], v[84:87], v[112:115], v[160:163]
    v_mfma_f32_16x16x32_bf16 v[164:167], v[84:87], v[120:123], v[164:167]
    v_mfma_f32_16x16x32_bf16 v[168:171], v[80:83], v[224:227], 0
    v_mfma_f32_16x16x32_bf16 v[172:175], v[80:83], v[232:235], 0
    s_nop 5
    v_cvt_pk_bf16_f32 v88, v160, v164
    v_mfma_f32_16x16x32_bf16 v[168:171], v[84:87], v[128:131], v[168:171]
    v_and_b32 v89, 0xffff0000, v88
    v_lshlrev_b32 v88, 16, v88
    v_mfma_f32_16x16x32_bf16 v[172:175], v[84:87], v[136:139], v[172:175]
    v_pk_add_f32 v[88:89], v[88:89], s[74:75] op_sel_hi:[1,0]
    v_mfma_f32_16x16x32_bf16 v[192:195], v[60:63], v[144:147], 0
    v_cvt_pk_bf16_f32 v88, v88, v89
    v_mfma_f32_16x16x32_bf16 v[196:199], v[64:67], v[144:147], 0
    s_nop 3
    v_cvt_pk_bf16_f32 v90, v168, v172
    v_and_b32 v89, 0xffff0000, v88
    v_mfma_f32_16x16x32_bf16 v[200:203], v[60:63], v[152:155], 0
    v_and_b32 v91, 0xffff0000, v90
    v_lshlrev_b32 v90, 16, v90
    v_mfma_f32_16x16x32_bf16 v[192:195], v[68:71], v[112:115], v[192:195]
    v_pk_add_f32 v[90:91], v[90:91], s[74:75] op_sel_hi:[1,0]
    v_lshlrev_b32 v88, 16, v88
    v_mfma_f32_16x16x32_bf16 v[204:207], v[64:67], v[152:155], 0
    v_cvt_pk_bf16_f32 v90, v90, v91
    v_rcp_f32 v88, v88
    v_mfma_f32_16x16x32_bf16 v[208:211], v[60:63], v[224:227], 0
    s_nop 1
    v_cvt_pk_bf16_f32 v96, v192, v193
    v_rcp_f32 v89, v89
    v_mfma_f32_16x16x32_bf16 v[196:199], v[72:75], v[112:115], v[196:199]
    v_cvt_pk_bf16_f32 v97, v194, v195
    v_and_b32 v91, 0xffff0000, v90
    v_mfma_f32_16x16x32_bf16 v[200:203], v[68:71], v[120:123], v[200:203]
    v_lshlrev_b32 v192, 16, v96
    v_and_b32 v193, 0xffff0000, v96
    v_mfma_f32_16x16x32_bf16 v[212:215], v[64:67], v[224:227], 0
    s_nop 1
    v_cvt_pk_bf16_f32 v98, v196, v197
    v_cvt_pk_bf16_f32 v99, v198, v199
    v_mfma_f32_16x16x32_bf16 v[216:219], v[60:63], v[232:235], 0
    v_cvt_pk_bf16_f32 v100, v200, v201
    v_lshlrev_b32 v90, 16, v90
    v_mfma_f32_16x16x32_bf16 v[204:207], v[72:75], v[120:123], v[204:207]
    v_lshlrev_b32 v194, 16, v97
    v_and_b32 v195, 0xffff0000, v97
    v_mfma_f32_16x16x32_bf16 v[208:211], v[68:71], v[128:131], v[208:211]
    v_cvt_pk_bf16_f32 v101, v202, v203
    v_lshlrev_b32 v196, 16, v98
    v_mfma_f32_16x16x32_bf16 v[220:223], v[64:67], v[232:235], 0
    v_and_b32 v197, 0xffff0000, v98
    v_lshlrev_b32 v198, 16, v99
    v_mfma_f32_16x16x32_bf16 v[212:215], v[72:75], v[128:131], v[212:215]
    v_and_b32 v199, 0xffff0000, v99
    v_pk_mul_f32 v[192:193], v[192:193], v[88:89] op_sel_hi:[1,0]
    v_mfma_f32_16x16x32_bf16 v[216:219], v[68:71], v[136:139], v[216:219]
    v_cvt_pk_bf16_f32 v102, v204, v205
    v_cvt_pk_bf16_f32 v103, v206, v207
    v_mfma_f32_16x16x32_bf16 v[220:223], v[72:75], v[136:139], v[220:223]
    v_lshlrev_b32 v200, 16, v100
    v_and_b32 v201, 0xffff0000, v100
    v_cvt_pk_bf16_f32 v104, v208, v209
    v_rcp_f32 v90, v90
    v_rcp_f32 v91, v91
    v_pk_mul_f32 v[194:195], v[194:195], v[88:89] op_sel_hi:[1,0]
    v_lshlrev_b32 v202, 16, v101
    v_and_b32 v203, 0xffff0000, v101
    v_cvt_pk_bf16_f32 v105, v210, v211
    v_pk_mul_f32 v[196:197], v[196:197], v[88:89] op_sel_hi:[1,0]
    v_pk_mul_f32 v[198:199], v[198:199], v[88:89] op_sel_hi:[1,0]
    v_cvt_pk_bf16_f32 v192, v192, v193
    v_lshlrev_b32 v204, 16, v102
    v_and_b32 v205, 0xffff0000, v102
    v_lshlrev_b32 v206, 16, v103
    v_and_b32 v207, 0xffff0000, v103
    v_pk_mul_f32 v[200:201], v[200:201], v[88:89] op_sel:[0,1] op_sel_hi:[1,1]
    v_cvt_pk_bf16_f32 v106, v212, v213
    v_cvt_pk_bf16_f32 v107, v214, v215
    v_lshlrev_b32 v208, 16, v104
    v_and_b32 v209, 0xffff0000, v104
    v_cvt_pk_bf16_f32 v108, v216, v217
    v_cvt_pk_bf16_f32 v193, v194, v195
    v_pk_mul_f32 v[202:203], v[202:203], v[88:89] op_sel:[0,1] op_sel_hi:[1,1]
    v_lshlrev_b32 v210, 16, v105
    v_and_b32 v211, 0xffff0000, v105
    v_cvt_pk_bf16_f32 v109, v218, v219
    v_cvt_pk_bf16_f32 v194, v196, v197
    v_cvt_pk_bf16_f32 v195, v198, v199
    v_pk_mul_f32 v[204:205], v[204:205], v[88:89] op_sel:[0,1] op_sel_hi:[1,1]
    v_pk_mul_f32 v[206:207], v[206:207], v[88:89] op_sel:[0,1] op_sel_hi:[1,1]
    v_cvt_pk_bf16_f32 v200, v200, v201
    v_lshlrev_b32 v212, 16, v106
    v_and_b32 v213, 0xffff0000, v106
    v_lshlrev_b32 v214, 16, v107
    v_and_b32 v215, 0xffff0000, v107
    v_pk_mul_f32 v[208:209], v[208:209], v[90:91] op_sel_hi:[1,0]
    v_cvt_pk_bf16_f32 v110, v220, v221
    v_cvt_pk_bf16_f32 v111, v222, v223
    v_lshlrev_b32 v216, 16, v108
    v_and_b32 v217, 0xffff0000, v108
    v_cvt_pk_bf16_f32 v201, v202, v203
    v_pk_mul_f32 v[210:211], v[210:211], v[90:91] op_sel_hi:[1,0]
    v_lshlrev_b32 v218, 16, v109
    v_and_b32 v219, 0xffff0000, v109
    buffer_store_dwordx4 v[192:195], v3, s[32:35], s52 offen sc1
    v_cvt_pk_bf16_f32 v202, v204, v205
    v_cvt_pk_bf16_f32 v203, v206, v207
    v_pk_mul_f32 v[212:213], v[212:213], v[90:91] op_sel_hi:[1,0]
    v_pk_mul_f32 v[214:215], v[214:215], v[90:91] op_sel_hi:[1,0]
    v_cvt_pk_bf16_f32 v208, v208, v209
    v_lshlrev_b32 v220, 16, v110
    v_and_b32 v221, 0xffff0000, v110
    v_lshlrev_b32 v222, 16, v111
    v_and_b32 v223, 0xffff0000, v111
    v_pk_mul_f32 v[216:217], v[216:217], v[90:91] op_sel:[0,1] op_sel_hi:[1,1]
    s_add_u32 s52, s52, 32768
    v_cvt_pk_bf16_f32 v209, v210, v211
    v_pk_mul_f32 v[218:219], v[218:219], v[90:91] op_sel:[0,1] op_sel_hi:[1,1]
    buffer_store_dwordx4 v[200:203], v3, s[32:35], s52 offen sc1
    v_cvt_pk_bf16_f32 v210, v212, v213
    v_cvt_pk_bf16_f32 v211, v214, v215
    v_pk_mul_f32 v[220:221], v[220:221], v[90:91] op_sel:[0,1] op_sel_hi:[1,1]
    v_pk_mul_f32 v[222:223], v[222:223], v[90:91] op_sel:[0,1] op_sel_hi:[1,1]
    v_cvt_pk_bf16_f32 v216, v216, v217
    s_add_u32 s52, s52, 32768
    v_cvt_pk_bf16_f32 v217, v218, v219
    buffer_store_dwordx4 v[208:211], v3, s[32:35], s52 offen sc1
    v_cvt_pk_bf16_f32 v218, v220, v221
    v_cvt_pk_bf16_f32 v219, v222, v223
    s_add_u32 s52, s52, 32768
    buffer_store_dwordx4 v[216:219], v3, s[32:35], s52 offen sc1
L_gc33:
    v_cmp_ne_u32 vcc, s78, v77
    v_cmp_ne_u32 s[74:75], s78, v79
    s_nop 1
    s_or_b64 vcc, vcc, s[74:75]
    s_cbranch_vccz L_gk34
    buffer_load_dwordx2 v[76:77], v27, s[32:35], s57 offen offset:0 sc1
    buffer_load_dwordx2 v[78:79], v27, s[32:35], s57 offen offset:64 sc1
    s_waitcnt vmcnt(0)
    s_add_u32 s79, s79, 1
    s_cmp_lt_u32 s79, 32768
    s_cbranch_scc1 L_gc33
L_gk34:
    v_and_b32 v54, 1, v2
    v_and_b32 v55, 31, v2
    v_lshlrev_b32 v54, 4, v54
    v_lshlrev_b32 v55, 2, v55
    v_lshrrev_b32 v80, v54, v76
    v_lshrrev_b32 v81, v54, v78
    v_lshlrev_b32 v82, 16, v80
    v_lshlrev_b32 v83, 16, v81
    v_sub_f32 v84, 1.0, v82
    v_sub_f32 v85, 1.0, v83
    v_cvt_pk_bf16_f32 v86, v13, v84
    v_cvt_pk_bf16_f32 v87, v13, v85
    v_lshrrev_b32 v84, 16, v86
    v_lshrrev_b32 v85, 16, v87
    v_dot2_f32_bf16 v128, v28, v84, 0
    v_dot2_f32_bf16 v129, v28, v86, 0
    v_dot2_f32_bf16 v130, v29, v84, 0
    v_dot2_f32_bf16 v131, v29, v86, 0
    v_dot2_f32_bf16 v132, v30, v84, 0
    v_dot2_f32_bf16 v133, v30, v86, 0
    v_dot2_f32_bf16 v134, v31, v84, 0
    v_dot2_f32_bf16 v135, v31, v86, 0
    v_dot2_f32_bf16 v136, v32, v84, 0
    v_dot2_f32_bf16 v137, v32, v86, 0
    v_dot2_f32_bf16 v138, v33, v84, 0
    v_dot2_f32_bf16 v139, v33, v86, 0
    v_dot2_f32_bf16 v140, v34, v84, 0
    v_dot2_f32_bf16 v141, v34, v86, 0
    v_dot2_f32_bf16 v142, v35, v84, 0
    v_dot2_f32_bf16 v143, v35, v86, 0
    v_dot2_f32_bf16 v144, v36, v85, 0
    v_dot2_f32_bf16 v145, v36, v87, 0
    v_dot2_f32_bf16 v146, v37, v85, 0
    v_dot2_f32_bf16 v147, v37, v87, 0
    v_dot2_f32_bf16 v148, v38, v85, 0
    v_dot2_f32_bf16 v149, v38, v87, 0
    v_dot2_f32_bf16 v150, v39, v85, 0
    v_dot2_f32_bf16 v151, v39, v87, 0
    v_dot2_f32_bf16 v152, v40, v85, 0
    v_dot2_f32_bf16 v153, v40, v87, 0
    v_dot2_f32_bf16 v154, v41, v85, 0
    v_dot2_f32_bf16 v155, v41, v87, 0
    v_dot2_f32_bf16 v156, v42, v85, 0
    v_dot2_f32_bf16 v157, v42, v87, 0
    v_dot2_f32_bf16 v158, v43, v85, 0
    v_dot2_f32_bf16 v159, v43, v87, 0
    v_cvt_pk_bf16_f32 v28, v128, v129
    v_cvt_pk_bf16_f32 v29, v130, v131
    v_cvt_pk_bf16_f32 v30, v132, v133
    v_cvt_pk_bf16_f32 v31, v134, v135
    v_cvt_pk_bf16_f32 v32, v136, v137
    v_cvt_pk_bf16_f32 v33, v138, v139
    v_cvt_pk_bf16_f32 v34, v140, v141
    v_cvt_pk_bf16_f32 v35, v142, v143
    v_cvt_pk_bf16_f32 v36, v144, v145
    v_cvt_pk_bf16_f32 v37, v146, v147
    v_cvt_pk_bf16_f32 v38, v148, v149
    v_cvt_pk_bf16_f32 v39, v150, v151
    v_cvt_pk_bf16_f32 v40, v152, v153
    v_cvt_pk_bf16_f32 v41, v154, v155
    v_cvt_pk_bf16_f32 v42, v156, v157
    v_cvt_pk_bf16_f32 v43, v158, v159
    s_lshr_b32 s3, s13, 2
    v_and_b32 v80, 0xffff, v80
    v_and_b32 v81, 0xffff, v81
    v_lshlrev_b32 v128, 16, v28
    v_and_b32 v129, 0xffff0000, v28
    v_lshlrev_b32 v130, 16, v29
    v_and_b32 v131, 0xffff0000, v29
    v_lshlrev_b32 v132, 16, v30
    v_and_b32 v133, 0xffff0000, v30
    v_lshlrev_b32 v134, 16, v31
    v_and_b32 v135, 0xffff0000, v31
    v_lshlrev_b32 v136, 16, v32
    v_and_b32 v137, 0xffff0000, v32
    v_lshlrev_b32 v138, 16, v33
    v_and_b32 v139, 0xffff0000, v33
    v_lshlrev_b32 v140, 16, v34
    v_and_b32 v141, 0xffff0000, v34
    v_lshlrev_b32 v142, 16, v35
    v_and_b32 v143, 0xffff0000, v35
    v_lshlrev_b32 v144, 16, v36
    v_and_b32 v145, 0xffff0000, v36
    v_lshlrev_b32 v146, 16, v37
    v_and_b32 v147, 0xffff0000, v37
    v_lshlrev_b32 v148, 16, v38
    v_and_b32 v149, 0xffff0000, v38
    v_lshlrev_b32 v150, 16, v39
    v_and_b32 v151, 0xffff0000, v39
    v_lshlrev_b32 v152, 16, v40
    v_and_b32 v153, 0xffff0000, v40
    v_lshlrev_b32 v154, 16, v41
    v_and_b32 v155, 0xffff0000, v41
    v_lshlrev_b32 v156, 16, v42
    v_and_b32 v157, 0xffff0000, v42
    v_lshlrev_b32 v158, 16, v43
    v_and_b32 v159, 0xffff0000, v43
    v_mov_b32 v160, 0
    v_mov_b32 v161, 0
    v_mov_b32 v162, 0
    v_mov_b32 v163, 0
    v_mov_b32 v164, 0
    v_mov_b32 v165, 0
    v_mov_b32 v166, 0
    v_mov_b32 v167, 0
    v_mov_b32 v168, 0
    v_mov_b32 v169, 0
    v_mov_b32 v170, 0
    v_mov_b32 v171, 0
    v_mov_b32 v172, 0
    v_mov_b32 v173, 0
    v_mov_b32 v174, 0
    v_mov_b32 v175, 0
    v_mov_b32 v176, 0
    v_mov_b32 v177, 0
    v_mov_b32 v178, 0
    v_mov_b32 v179, 0
    v_mov_b32 v180, 0
    v_mov_b32 v181, 0
    v_mov_b32 v182, 0
    v_mov_b32 v183, 0
    v_mov_b32 v184, 0
    v_mov_b32 v185, 0
    v_mov_b32 v186, 0
    v_mov_b32 v187, 0
    v_mov_b32 v188, 0
    v_mov_b32 v189, 0
    v_mov_b32 v190, 0
    v_mov_b32 v191, 0
    v_and_b32 v90, 12, v55
    s_lshl_b32 s76, s3, 12
    s_waitcnt vmcnt(0)
    s_mov_b64 exec, 1
    buffer_store_dword v19, v13, s[32:35], s53 offen sc1
    s_mov_b64 exec, -1
L_of35:
    buffer_load_dword v54, v55, s[32:35], s56 offen sc1
    ds_read_b32 v88, v90 offset:208
    ds_read_b32 v89, v13 offset:16
    s_waitcnt vmcnt(0) lgkmcnt(0)
    v_cmp_ne_u32 vcc, s78, v54
    v_cmp_ne_u32 s[74:75], v88, v18
    s_nop 1
    s_or_b64 vcc, vcc, s[74:75]
    s_cbranch_vccz L_ofk36
    s_add_u32 s79, s79, 1
    s_cmp_lt_u32 s79, 32768
    s_cbranch_scc1 L_of35
L_ofk36:
    buffer_load_dwordx4 v[192:195], v24, s[60:63], s76 offen
    buffer_load_dwordx4 v[196:199], v25, s[60:63], s76 offen
    s_add_u32 s76, s76, 1024
    s_and_b32 s76, s76, 0x7fff
    buffer_load_dwordx4 v[200:203], v24, s[60:63], s76 offen
    buffer_load_dwordx4 v[204:207], v25, s[60:63], s76 offen
    s_add_u32 s76, s76, 1024
    s_and_b32 s76, s76, 0x7fff
    buffer_load_dwordx4 v[208:211], v24, s[60:63], s76 offen
    buffer_load_dwordx4 v[212:215], v25, s[60:63], s76 offen
    s_add_u32 s76, s76, 1024
    s_and_b32 s76, s76, 0x7fff
    buffer_load_dwordx4 v[216:219], v24, s[60:63], s76 offen
    buffer_load_dwordx4 v[220:223], v25, s[60:63], s76 offen
    s_add_u32 s76, s76, 1024
    s_and_b32 s76, s76, 0x7fff
    buffer_load_dwordx4 v[224:227], v24, s[60:63], s76 offen
    buffer_load_dwordx4 v[228:231], v25, s[60:63], s76 offen
    s_add_u32 s76, s76, 1024
    s_and_b32 s76, s76, 0x7fff
    buffer_load_dwordx4 v[232:235], v24, s[60:63], s76 offen
    buffer_load_dwordx4 v[236:239], v25, s[60:63], s76 offen
    s_add_u32 s76, s76, 1024
    s_and_b32 s76, s76, 0x7fff
    buffer_load_dwordx4 v[240:243], v24, s[60:63], s76 offen
    buffer_load_dwordx4 v[244:247], v25, s[60:63], s76 offen
    s_add_u32 s76, s76, 1024
    s_and_b32 s76, s76, 0x7fff
    buffer_load_dwordx4 v[248:251], v24, s[60:63], s76 offen
    buffer_load_dwordx4 v[252:255], v25, s[60:63], s76 offen
    s_add_u32 s76, s76, 1024
    s_and_b32 s76, s76, 0x7fff
    ds_read_b64_tr_b16 v[96:97], v20 offset:0
    ds_read_b64_tr_b16 v[98:99], v20 offset:2048
    ds_read_b64_tr_b16 v[100:101], v21 offset:0
    ds_read_b64_tr_b16 v[102:103], v21 offset:2048
    ds_read_b64_tr_b16 v[104:105], v22 offset:0
    ds_read_b64_tr_b16 v[106:107], v22 offset:2048
    ds_read_b64_tr_b16 v[108:109], v23 offset:0
    ds_read_b64_tr_b16 v[110:111], v23 offset:2048
    v_readfirstlane_b32 s77, v89
    s_mov_b32 s66, 0
    s_mov_b32 s3, 32768
.p2align 6
L_p5:
    s_cmp_eq_u32 s66, 3
    s_cselect_b32 s62, 0, s62
    s_cselect_b32 s3, 0, s3
    s_waitcnt vmcnt(14) lgkmcnt(6)
    v_mfma_f32_16x16x32_bf16 v[160:163], v[96:99], v[192:195], v[160:163]
    ds_read_b64_tr_b16 v[112:113], v20 offset:4096
    v_mfma_f32_16x16x32_bf16 v[176:179], v[96:99], v[196:199], v[176:179]
    ds_read_b64_tr_b16 v[114:115], v20 offset:6144
    s_waitcnt lgkmcnt(6)
    v_mfma_f32_16x16x32_bf16 v[164:167], v[100:103], v[192:195], v[164:167]
    ds_read_b64_tr_b16 v[116:117], v21 offset:4096
    v_mfma_f32_16x16x32_bf16 v[180:183], v[100:103], v[196:199], v[180:183]
    ds_read_b64_tr_b16 v[118:119], v21 offset:6144
    s_waitcnt lgkmcnt(6)
    v_mfma_f32_16x16x32_bf16 v[168:171], v[104:107], v[192:195], v[168:171]
    ds_read_b64_tr_b16 v[120:121], v22 offset:4096
    v_mfma_f32_16x16x32_bf16 v[184:187], v[104:107], v[196:199], v[184:187]
    ds_read_b64_tr_b16 v[122:123], v22 offset:6144
    s_waitcnt lgkmcnt(6)
    v_mfma_f32_16x16x32_bf16 v[172:175], v[108:111], v[192:195], v[172:175]
    ds_read_b64_tr_b16 v[124:125], v23 offset:4096
    v_mfma_f32_16x16x32_bf16 v[188:191], v[108:111], v[196:199], v[188:191]
    ds_read_b64_tr_b16 v[126:127], v23 offset:6144
    buffer_load_dwordx4 v[192:195], v24, s[60:63], s76 offen
    buffer_load_dwordx4 v[196:199], v25, s[60:63], s76 offen
    s_add_u32 s76, s76, 1024
    s_and_b32 s76, s76, 0x7fff
    s_waitcnt vmcnt(14) lgkmcnt(6)
    v_mfma_f32_16x16x32_bf16 v[160:163], v[112:115], v[200:203], v[160:163]
    ds_read_b64_tr_b16 v[96:97], v20 offset:8192
    v_mfma_f32_16x16x32_bf16 v[176:179], v[112:115], v[204:207], v[176:179]
    ds_read_b64_tr_b16 v[98:99], v20 offset:10240
    s_waitcnt lgkmcnt(6)
    v_mfma_f32_16x16x32_bf16 v[164:167], v[116:119], v[200:203], v[164:167]
    ds_read_b64_tr_b16 v[100:101], v21 offset:8192
    v_mfma_f32_16x16x32_bf16 v[180:183], v[116:119], v[204:207], v[180:183]
    ds_read_b64_tr_b16 v[102:103], v21 offset:10240
    s_waitcnt lgkmcnt(6)
    v_mfma_f32_16x16x32_bf16 v[168:171], v[120:123], v[200:203], v[168:171]
    ds_read_b64_tr_b16 v[104:105], v22 offset:8192
    v_mfma_f32_16x16x32_bf16 v[184:187], v[120:123], v[204:207], v[184:187]
    ds_read_b64_tr_b16 v[106:107], v22 offset:10240
    s_waitcnt lgkmcnt(6)
    v_mfma_f32_16x16x32_bf16 v[172:175], v[124:127], v[200:203], v[172:175]
    ds_read_b64_tr_b16 v[108:109], v23 offset:8192
    v_mfma_f32_16x16x32_bf16 v[188:191], v[124:127], v[204:207], v[188:191]
    ds_read_b64_tr_b16 v[110:111], v23 offset:10240
    buffer_load_dwordx4 v[200:203], v24, s[60:63], s76 offen
    buffer_load_dwordx4 v[204:207], v25, s[60:63], s76 offen
    s_add_u32 s76, s76, 1024
    s_and_b32 s76, s76, 0x7fff
    s_waitcnt vmcnt(14) lgkmcnt(6)
    v_mfma_f32_16x16x32_bf16 v[160:163], v[96:99], v[208:211], v[160:163]
    ds_read_b64_tr_b16 v[112:113], v20 offset:12288
    v_mfma_f32_16x16x32_bf16 v[176:179], v[96:99], v[212:215], v[176:179]
    ds_read_b64_tr_b16 v[114:115], v20 offset:14336
    s_waitcnt lgkmcnt(6)
    v_mfma_f32_16x16x32_bf16 v[164:167], v[100:103], v[208:211], v[164:167]
    ds_read_b64_tr_b16 v[116:117], v21 offset:12288
    v_mfma_f32_16x16x32_bf16 v[180:183], v[100:103], v[212:215], v[180:183]
    ds_read_b64_tr_b16 v[118:119], v21 offset:14336
    s_waitcnt lgkmcnt(6)
    v_mfma_f32_16x16x32_bf16 v[168:171], v[104:107], v[208:211], v[168:171]
    ds_read_b64_tr_b16 v[120:121], v22 offset:12288
    v_mfma_f32_16x16x32_bf16 v[184:187], v[104:107], v[212:215], v[184:187]
    ds_read_b64_tr_b16 v[122:123], v22 offset:14336
    s_waitcnt lgkmcnt(6)
    v_mfma_f32_16x16x32_bf16 v[172:175], v[108:111], v[208:211], v[172:175]
    ds_read_b64_tr_b16 v[124:125], v23 offset:12288
    v_mfma_f32_16x16x32_bf16 v[188:191], v[108:111], v[212:215], v[188:191]
    ds_read_b64_tr_b16 v[126:127], v23 offset:14336
    buffer_load_dwordx4 v[208:211], v24, s[60:63], s76 offen
    buffer_load_dwordx4 v[212:215], v25, s[60:63], s76 offen
    s_add_u32 s76, s76, 1024
    s_and_b32 s76, s76, 0x7fff
    s_waitcnt vmcnt(14) lgkmcnt(6)
    v_mfma_f32_16x16x32_bf16 v[160:163], v[112:115], v[216:219], v[160:163]
    ds_read_b64_tr_b16 v[96:97], v20 offset:16384
    v_mfma_f32_16x16x32_bf16 v[176:179], v[112:115], v[220:223], v[176:179]
    ds_read_b64_tr_b16 v[98:99], v20 offset:18432
    s_waitcnt lgkmcnt(6)
    v_mfma_f32_16x16x32_bf16 v[164:167], v[116:119], v[216:219], v[164:167]
    ds_read_b64_tr_b16 v[100:101], v21 offset:16384
    v_mfma_f32_16x16x32_bf16 v[180:183], v[116:119], v[220:223], v[180:183]
    ds_read_b64_tr_b16 v[102:103], v21 offset:18432
    s_waitcnt lgkmcnt(6)
    v_mfma_f32_16x16x32_bf16 v[168:171], v[120:123], v[216:219], v[168:171]
    ds_read_b64_tr_b16 v[104:105], v22 offset:16384
    v_mfma_f32_16x16x32_bf16 v[184:187], v[120:123], v[220:223], v[184:187]
    ds_read_b64_tr_b16 v[106:107], v22 offset:18432
    s_waitcnt lgkmcnt(6)
    v_mfma_f32_16x16x32_bf16 v[172:175], v[124:127], v[216:219], v[172:175]
    ds_read_b64_tr_b16 v[108:109], v23 offset:16384
    v_mfma_f32_16x16x32_bf16 v[188:191], v[124:127], v[220:223], v[188:191]
    ds_read_b64_tr_b16 v[110:111], v23 offset:18432
    buffer_load_dwordx4 v[216:219], v24, s[60:63], s76 offen
    buffer_load_dwordx4 v[220:223], v25, s[60:63], s76 offen
    s_add_u32 s76, s76, 1024
    s_and_b32 s76, s76, 0x7fff
    s_waitcnt vmcnt(14) lgkmcnt(6)
    v_mfma_f32_16x16x32_bf16 v[160:163], v[96:99], v[224:227], v[160:163]
    ds_read_b64_tr_b16 v[112:113], v20 offset:20480
    v_mfma_f32_16x16x32_bf16 v[176:179], v[96:99], v[228:231], v[176:179]
    ds_read_b64_tr_b16 v[114:115], v20 offset:22528
    s_waitcnt lgkmcnt(6)
    v_mfma_f32_16x16x32_bf16 v[164:167], v[100:103], v[224:227], v[164:167]
    ds_read_b64_tr_b16 v[116:117], v21 offset:20480
    v_mfma_f32_16x16x32_bf16 v[180:183], v[100:103], v[228:231], v[180:183]
    ds_read_b64_tr_b16 v[118:119], v21 offset:22528
    s_waitcnt lgkmcnt(6)
    v_mfma_f32_16x16x32_bf16 v[168:171], v[104:107], v[224:227], v[168:171]
    ds_read_b64_tr_b16 v[120:121], v22 offset:20480
    v_mfma_f32_16x16x32_bf16 v[184:187], v[104:107], v[228:231], v[184:187]
    ds_read_b64_tr_b16 v[122:123], v22 offset:22528
    s_waitcnt lgkmcnt(6)
    v_mfma_f32_16x16x32_bf16 v[172:175], v[108:111], v[224:227], v[172:175]
    ds_read_b64_tr_b16 v[124:125], v23 offset:20480
    v_mfma_f32_16x16x32_bf16 v[188:191], v[108:111], v[228:231], v[188:191]
    ds_read_b64_tr_b16 v[126:127], v23 offset:22528
    buffer_load_dwordx4 v[224:227], v24, s[60:63], s76 offen
    buffer_load_dwordx4 v[228:231], v25, s[60:63], s76 offen
    s_add_u32 s76, s76, 1024
    s_and_b32 s76, s76, 0x7fff
    s_waitcnt vmcnt(14) lgkmcnt(6)
    v_mfma_f32_16x16x32_bf16 v[160:163], v[112:115], v[232:235], v[160:163]
    ds_read_b64_tr_b16 v[96:97], v20 offset:24576
    v_mfma_f32_16x16x32_bf16 v[176:179], v[112:115], v[236:239], v[176:179]
    ds_read_b64_tr_b16 v[98:99], v20 offset:26624
    s_waitcnt lgkmcnt(6)
    v_mfma_f32_16x16x32_bf16 v[164:167], v[116:119], v[232:235], v[164:167]
    ds_read_b64_tr_b16 v[100:101], v21 offset:24576
    v_mfma_f32_16x16x32_bf16 v[180:183], v[116:119], v[236:239], v[180:183]
    ds_read_b64_tr_b16 v[102:103], v21 offset:26624
    s_waitcnt lgkmcnt(6)
    v_mfma_f32_16x16x32_bf16 v[168:171], v[120:123], v[232:235], v[168:171]
    ds_read_b64_tr_b16 v[104:105], v22 offset:24576
    v_mfma_f32_16x16x32_bf16 v[184:187], v[120:123], v[236:239], v[184:187]
    ds_read_b64_tr_b16 v[106:107], v22 offset:26624
    s_waitcnt lgkmcnt(6)
    v_mfma_f32_16x16x32_bf16 v[172:175], v[124:127], v[232:235], v[172:175]
    ds_read_b64_tr_b16 v[108:109], v23 offset:24576
    v_mfma_f32_16x16x32_bf16 v[188:191], v[124:127], v[236:239], v[188:191]
    ds_read_b64_tr_b16 v[110:111], v23 offset:26624
    buffer_load_dwordx4 v[232:235], v24, s[60:63], s76 offen
    buffer_load_dwordx4 v[236:239], v25, s[60:63], s76 offen
    s_add_u32 s76, s76, 1024
    s_and_b32 s76, s76, 0x7fff
    s_waitcnt vmcnt(14) lgkmcnt(6)
    v_mfma_f32_16x16x32_bf16 v[160:163], v[96:99], v[240:243], v[160:163]
    ds_read_b64_tr_b16 v[112:113], v20 offset:28672
    v_mfma_f32_16x16x32_bf16 v[176:179], v[96:99], v[244:247], v[176:179]
    ds_read_b64_tr_b16 v[114:115], v20 offset:30720
    s_waitcnt lgkmcnt(6)
    v_mfma_f32_16x16x32_bf16 v[164:167], v[100:103], v[240:243], v[164:167]
    ds_read_b64_tr_b16 v[116:117], v21 offset:28672
    v_mfma_f32_16x16x32_bf16 v[180:183], v[100:103], v[244:247], v[180:183]
    ds_read_b64_tr_b16 v[118:119], v21 offset:30720
    s_waitcnt lgkmcnt(6)
    v_mfma_f32_16x16x32_bf16 v[168:171], v[104:107], v[240:243], v[168:171]
    ds_read_b64_tr_b16 v[120:121], v22 offset:28672
    v_mfma_f32_16x16x32_bf16 v[184:187], v[104:107], v[244:247], v[184:187]
    ds_read_b64_tr_b16 v[122:123], v22 offset:30720
    s_waitcnt lgkmcnt(6)
    v_mfma_f32_16x16x32_bf16 v[172:175], v[108:111], v[240:243], v[172:175]
    ds_read_b64_tr_b16 v[124:125], v23 offset:28672
    v_mfma_f32_16x16x32_bf16 v[188:191], v[108:111], v[244:247], v[188:191]
    ds_read_b64_tr_b16 v[126:127], v23 offset:30720
    buffer_load_dwordx4 v[240:243], v24, s[60:63], s76 offen
    buffer_load_dwordx4 v[244:247], v25, s[60:63], s76 offen
    s_add_u32 s76, s76, 1024
    s_and_b32 s76, s76, 0x7fff
    v_add_u32 v20, s3, v20
    v_add_u32 v21, s3, v21
    v_add_u32 v22, s3, v22
    v_add_u32 v23, s3, v23
    s_waitcnt vmcnt(14) lgkmcnt(6)
    v_mfma_f32_16x16x32_bf16 v[160:163], v[112:115], v[248:251], v[160:163]
    ds_read_b64_tr_b16 v[96:97], v20 offset:0
    v_mfma_f32_16x16x32_bf16 v[176:179], v[112:115], v[252:255], v[176:179]
    ds_read_b64_tr_b16 v[98:99], v20 offset:2048
    s_waitcnt lgkmcnt(6)
    v_mfma_f32_16x16x32_bf16 v[164:167], v[116:119], v[248:251], v[164:167]
    ds_read_b64_tr_b16 v[100:101], v21 offset:0
    v_mfma_f32_16x16x32_bf16 v[180:183], v[116:119], v[252:255], v[180:183]
    ds_read_b64_tr_b16 v[102:103], v21 offset:2048
    s_waitcnt lgkmcnt(6)
    v_mfma_f32_16x16x32_bf16 v[168:171], v[120:123], v[248:251], v[168:171]
    ds_read_b64_tr_b16 v[104:105], v22 offset:0
    v_mfma_f32_16x16x32_bf16 v[184:187], v[120:123], v[252:255], v[184:187]
    ds_read_b64_tr_b16 v[106:107], v22 offset:2048
    s_waitcnt lgkmcnt(6)
    v_mfma_f32_16x16x32_bf16 v[172:175], v[124:127], v[248:251], v[172:175]
    ds_read_b64_tr_b16 v[108:109], v23 offset:0
    v_mfma_f32_16x16x32_bf16 v[188:191], v[124:127], v[252:255], v[188:191]
    ds_read_b64_tr_b16 v[110:111], v23 offset:2048
    buffer_load_dwordx4 v[248:251], v24, s[60:63], s76 offen
    buffer_load_dwordx4 v[252:255], v25, s[60:63], s76 offen
    s_add_u32 s76, s76, 1024
    s_and_b32 s76, s76, 0x7fff
    s_add_u32 s66, s66, 1
    s_cmp_lt_u32 s66, 4
    s_cbranch_scc1 L_p5
    s_waitcnt lgkmcnt(0)
    s_lshr_b32 s77, s77, 4
    s_and_b32 s77, s77, 2047
    s_sub_u32 s77, 2047, s77
    s_lshr_b32 s19, s77, 5
    s_cmp_eq_u32 s19, s58
    s_cbranch_scc1 L_own
L_ownret:
    v_cvt_pk_bf16_f32 v160, v160, v161
    v_cvt_pk_bf16_f32 v161, v162, v163
    v_cvt_pk_bf16_f32 v168, v168, v169
    v_cvt_pk_bf16_f32 v162, v164, v165
    v_cvt_pk_bf16_f32 v163, v166, v167
    v_cvt_pk_bf16_f32 v169, v170, v171
    v_cvt_pk_bf16_f32 v176, v176, v177
    v_cvt_pk_bf16_f32 v170, v172, v173
    v_cvt_pk_bf16_f32 v171, v174, v175
    v_cvt_pk_bf16_f32 v177, v178, v179
    v_cvt_pk_bf16_f32 v184, v184, v185
    v_cvt_pk_bf16_f32 v178, v180, v181
    v_cvt_pk_bf16_f32 v179, v182, v183
    v_cvt_pk_bf16_f32 v185, v186, v187
    v_permlane16_swap_b32 v160, v162
    v_permlane16_swap_b32 v161, v163
    v_cvt_pk_bf16_f32 v186, v188, v189
    v_cvt_pk_bf16_f32 v187, v190, v191
    v_permlane16_swap_b32 v168, v170
    v_permlane16_swap_b32 v169, v171
    v_dot2_f32_bf16 v96, v160, v80, 0
    v_dot2_f32_bf16 v97, v160, v82, 0
    v_dot2_f32_bf16 v98, v161, v80, 0
    v_dot2_f32_bf16 v99, v161, v82, 0
    v_dot2_f32_bf16 v100, v162, v80, 0
    v_dot2_f32_bf16 v101, v162, v82, 0
    v_dot2_f32_bf16 v102, v163, v80, 0
    v_dot2_f32_bf16 v103, v163, v82, 0
    v_permlane16_swap_b32 v176, v178
    v_permlane16_swap_b32 v177, v179
    v_dot2_f32_bf16 v104, v168, v80, 0
    v_dot2_f32_bf16 v105, v168, v82, 0
    v_dot2_f32_bf16 v106, v169, v80, 0
    v_dot2_f32_bf16 v107, v169, v82, 0
    v_dot2_f32_bf16 v108, v170, v80, 0
    v_dot2_f32_bf16 v109, v170, v82, 0
    v_dot2_f32_bf16 v110, v171, v80, 0
    v_dot2_f32_bf16 v111, v171, v82, 0
    v_permlane16_swap_b32 v184, v186
    v_permlane16_swap_b32 v185, v187
    v_dot2_f32_bf16 v112, v176, v81, 0
    v_dot2_f32_bf16 v113, v176, v83, 0
    v_dot2_f32_bf16 v114, v177, v81, 0
    v_dot2_f32_bf16 v115, v177, v83, 0
    v_dot2_f32_bf16 v116, v178, v81, 0
    v_dot2_f32_bf16 v117, v178, v83, 0
    v_dot2_f32_bf16 v118, v179, v81, 0
    v_dot2_f32_bf16 v119, v179, v83, 0
    v_dot2_f32_bf16 v120, v184, v81, 0
    v_dot2_f32_bf16 v121, v184, v83, 0
    v_dot2_f32_bf16 v122, v185, v81, 0
    v_dot2_f32_bf16 v123, v185, v83, 0
    v_dot2_f32_bf16 v124, v186, v81, 0
    v_dot2_f32_bf16 v125, v186, v83, 0
    v_dot2_f32_bf16 v126, v187, v81, 0
    v_dot2_f32_bf16 v127, v187, v83, 0
    v_cvt_pk_bf16_f32 v160, v96, v97
    v_cvt_pk_bf16_f32 v161, v98, v99
    v_cvt_pk_bf16_f32 v162, v100, v101
    v_cvt_pk_bf16_f32 v163, v102, v103
    s_mov_b32 s74, 0x3f80
    s_mov_b32 s75, 0x3f800000
    v_cvt_pk_bf16_f32 v168, v104, v105
    v_cvt_pk_bf16_f32 v169, v106, v107
    v_cvt_pk_bf16_f32 v170, v108, v109
    v_cvt_pk_bf16_f32 v171, v110, v111
    v_dot2_f32_bf16 v96, v160, s74, v128
    v_dot2_f32_bf16 v97, v160, s75, v129
    v_dot2_f32_bf16 v98, v161, s74, v130
    v_dot2_f32_bf16 v99, v161, s75, v131
    v_dot2_f32_bf16 v100, v162, s74, v132
    v_dot2_f32_bf16 v101, v162, s75, v133
    v_dot2_f32_bf16 v102, v163, s74, v134
    v_dot2_f32_bf16 v103, v163, s75, v135
    v_cvt_pk_bf16_f32 v176, v112, v113
    v_cvt_pk_bf16_f32 v177, v114, v115
    v_cvt_pk_bf16_f32 v178, v116, v117
    v_cvt_pk_bf16_f32 v179, v118, v119
    v_dot2_f32_bf16 v104, v168, s74, v136
    v_dot2_f32_bf16 v105, v168, s75, v137
    v_dot2_f32_bf16 v106, v169, s74, v138
    v_dot2_f32_bf16 v107, v169, s75, v139
    v_dot2_f32_bf16 v108, v170, s74, v140
    v_dot2_f32_bf16 v109, v170, s75, v141
    v_dot2_f32_bf16 v110, v171, s74, v142
    v_dot2_f32_bf16 v111, v171, s75, v143
    v_cvt_pk_bf16_f32 v184, v120, v121
    v_cvt_pk_bf16_f32 v185, v122, v123
    v_cvt_pk_bf16_f32 v186, v124, v125
    v_cvt_pk_bf16_f32 v187, v126, v127
    v_dot2_f32_bf16 v112, v176, s74, v144
    v_dot2_f32_bf16 v113, v176, s75, v145
    v_dot2_f32_bf16 v114, v177, s74, v146
    v_dot2_f32_bf16 v115, v177, s75, v147
    v_dot2_f32_bf16 v116, v178, s74, v148
    v_dot2_f32_bf16 v117, v178, s75, v149
    v_dot2_f32_bf16 v118, v179, s74, v150
    v_dot2_f32_bf16 v119, v179, s75, v151
    v_dot2_f32_bf16 v120, v184, s74, v152
    v_dot2_f32_bf16 v121, v184, s75, v153
    v_dot2_f32_bf16 v122, v185, s74, v154
    v_dot2_f32_bf16 v123, v185, s75, v155
    v_dot2_f32_bf16 v124, v186, s74, v156
    v_dot2_f32_bf16 v125, v186, s75, v157
    v_dot2_f32_bf16 v126, v187, s74, v158
    v_dot2_f32_bf16 v127, v187, s75, v159
    v_cvt_pk_bf16_f32 v160, v96, v97
    v_cvt_pk_bf16_f32 v161, v98, v99
    v_cvt_pk_bf16_f32 v162, v100, v101
    v_cvt_pk_bf16_f32 v163, v102, v103
    v_cvt_pk_bf16_f32 v168, v104, v105
    v_cvt_pk_bf16_f32 v169, v106, v107
    v_cvt_pk_bf16_f32 v170, v108, v109
    v_cvt_pk_bf16_f32 v171, v110, v111
    buffer_store_dwordx4 v[160:163], v26, s[44:47], s54 offen offset:0 sc1
    v_cvt_pk_bf16_f32 v176, v112, v113
    v_cvt_pk_bf16_f32 v177, v114, v115
    v_cvt_pk_bf16_f32 v178, v116, v117
    v_cvt_pk_bf16_f32 v179, v118, v119
    buffer_store_dwordx4 v[168:171], v26, s[44:47], s54 offen offset:64 sc1
    v_cvt_pk_bf16_f32 v184, v120, v121
    v_cvt_pk_bf16_f32 v185, v122, v123
    v_cvt_pk_bf16_f32 v186, v124, v125
    v_cvt_pk_bf16_f32 v187, v126, v127
    buffer_store_dwordx4 v[176:179], v26, s[44:47], s55 offen offset:0 sc1
    buffer_store_dwordx4 v[184:187], v26, s[44:47], s55 offen offset:64 sc1
    s_endpgm
L_own:
    v_and_b32 v54, 16, v2
    v_lshlrev_b32 v54, 2, v54
    v_and_b32 v55, 32, v2
    v_add_u32 v54, v54, v55
L_xo37:
    ds_read_b32 v88, v13 offset:224
    ds_read_b128 v[96:99], v54 offset:512
    ds_read_b128 v[100:103], v54 offset:528
    ds_read_b128 v[104:107], v54 offset:640
    ds_read_b128 v[108:111], v54 offset:656
    s_waitcnt lgkmcnt(0)
    v_cmp_ne_u32 vcc, v88, v18
    s_cbranch_vccz L_xk38
    s_add_u32 s79, s79, 1
    s_cmp_lt_u32 s79, 32768
    s_cbranch_scc1 L_xo37
L_xk38:
    s_and_b32 s77, s77, 31
    v_and_b32 v54, 15, v2
    v_cmp_eq_u32 vcc, s77, v54
    s_nop 1
    v_cndmask_b32 v128, v128, v96, vcc
    v_cndmask_b32 v129, v129, v97, vcc
    v_cndmask_b32 v130, v130, v98, vcc
    v_cndmask_b32 v131, v131, v99, vcc
    v_cndmask_b32 v132, v132, v100, vcc
    v_cndmask_b32 v133, v133, v101, vcc
    v_cndmask_b32 v134, v134, v102, vcc
    v_cndmask_b32 v135, v135, v103, vcc
    v_cndmask_b32 v136, v136, v104, vcc
    v_cndmask_b32 v137, v137, v105, vcc
    v_cndmask_b32 v138, v138, v106, vcc
    v_cndmask_b32 v139, v139, v107, vcc
    v_cndmask_b32 v140, v140, v108, vcc
    v_cndmask_b32 v141, v141, v109, vcc
    v_cndmask_b32 v142, v142, v110, vcc
    v_cndmask_b32 v143, v143, v111, vcc
    v_add_u32 v54, 16, v54
    v_cmp_eq_u32 vcc, s77, v54
    s_nop 1
    v_cndmask_b32 v144, v144, v96, vcc
    v_cndmask_b32 v145, v145, v97, vcc
    v_cndmask_b32 v146, v146, v98, vcc
    v_cndmask_b32 v147, v147, v99, vcc
    v_cndmask_b32 v148, v148, v100, vcc
    v_cndmask_b32 v149, v149, v101, vcc
    v_cndmask_b32 v150, v150, v102, vcc
    v_cndmask_b32 v151, v151, v103, vcc
    v_cndmask_b32 v152, v152, v104, vcc
    v_cndmask_b32 v153, v153, v105, vcc
    v_cndmask_b32 v154, v154, v106, vcc
    v_cndmask_b32 v155, v155, v107, vcc
    v_cndmask_b32 v156, v156, v108, vcc
    v_cndmask_b32 v157, v157, v109, vcc
    v_cndmask_b32 v158, v158, v110, vcc
    v_cndmask_b32 v159, v159, v111, vcc
    s_branch L_ownret
L_k2s:
    v_pk_add_f32 v[192:193], v[192:193], v[120:121]
    v_pk_add_f32 v[194:195], v[194:195], v[122:123]
    v_bfi_b32 v192, v15, s80, v192
    v_bfi_b32 v193, v15, s81, v193
    v_bfi_b32 v194, v15, s82, v194
    v_bfi_b32 v195, v15, s83, v195
    v_pk_add_f32 v[196:197], v[196:197], v[124:125]
    v_pk_add_f32 v[198:199], v[198:199], v[126:127]
    v_bfi_b32 v196, v15, s80, v196
    v_bfi_b32 v197, v15, s81, v197
    v_bfi_b32 v198, v15, s82, v198
    v_bfi_b32 v199, v15, s83, v199
    v_pk_add_f32 v[200:201], v[200:201], v[128:129]
    v_pk_add_f32 v[202:203], v[202:203], v[130:131]
    buffer_store_dwordx4 v[192:195], v3, s[32:35], s48 offen sc1
    s_add_u32 s48, s48, 16384
    v_bfi_b32 v200, v15, s80, v200
    v_bfi_b32 v201, v15, s81, v201
    v_bfi_b32 v202, v15, s82, v202
    v_bfi_b32 v203, v15, s83, v203
    v_pk_add_f32 v[204:205], v[204:205], v[132:133]
    v_pk_add_f32 v[206:207], v[206:207], v[134:135]
    buffer_store_dwordx4 v[196:199], v3, s[32:35], s48 offen sc1
    s_add_u32 s48, s48, 16384
    v_bfi_b32 v204, v15, s80, v204
    v_bfi_b32 v205, v15, s81, v205
    v_bfi_b32 v206, v15, s82, v206
    v_bfi_b32 v207, v15, s83, v207
    v_pk_add_f32 v[208:209], v[208:209], v[112:113]
    v_pk_add_f32 v[210:211], v[210:211], v[114:115]
    v_pk_add_f32 v[212:213], v[212:213], v[116:117]
    v_pk_add_f32 v[214:215], v[214:215], v[118:119]
    buffer_store_dwordx4 v[200:203], v3, s[32:35], s48 offen sc1
    s_add_u32 s48, s48, 16384
    v_bfi_b32 v208, v15, s80, v208
    v_bfi_b32 v209, v15, s81, v209
    v_bfi_b32 v210, v15, s82, v210
    v_bfi_b32 v211, v15, s83, v211
    v_bfi_b32 v212, v15, s80, v212
    v_bfi_b32 v213, v15, s81, v213
    v_bfi_b32 v214, v15, s82, v214
    v_bfi_b32 v215, v15, s83, v215
    buffer_store_dwordx4 v[204:207], v3, s[32:35], s48 offen sc1
    s_mov_b32 exec_lo, 0x10001
    s_mov_b32 exec_hi, 0x10001
    buffer_store_dwordx4 v[208:211], v8, s[32:35], s49 offen offset:0 sc1
    buffer_store_dwordx4 v[212:215], v8, s[32:35], s49 offen offset:1024 sc1
    s_mov_b64 exec, -1
    s_branch L_k2r
L_h1s:
    s_mov_b32 exec_lo, 0xffff
    s_mov_b32 exec_hi, 0xffff
    buffer_store_dword v96, v11, s[32:35], s64 offen sc1
    s_lshl_b64 exec, 1, s16
    buffer_store_dword v92, v13, s[32:35], s65 offen sc1
    s_mov_b64 exec, -1
    s_branch L_h1r
L_end:
    s_endpgm
.section .rodata,"a"
.p2align 6
.amdhsa_kernel fk_kernel
  .amdhsa_next_free_vgpr 256
  .amdhsa_next_free_sgpr 102
  .amdhsa_accum_offset 256
  .amdhsa_group_segment_fixed_size 0
  .amdhsa_kernarg_size 104
  .amdhsa_user_sgpr_count 2
  .amdhsa_user_sgpr_kernarg_segment_ptr 1
  .amdhsa_system_sgpr_workgroup_id_x 1
.end_amdhsa_kernel
```

```asm
; @launch kernel=fk_kernel grid=(256,1,1) block=(512,1,1) lds=163840
.amdgcn_target "amdgcn-amd-amdhsa--gfx950"
.text
.globl fk_kernel
.p2align 8
.type fk_kernel,@function
fk_kernel:
    s_load_dwordx4 s[4:7], s[0:1], 0
    s_load_dwordx4 s[8:11], s[0:1], 16
    s_load_dwordx16 s[84:99], s[0:1], 40
    s_cmp_ge_u32 s2, 256
    s_cbranch_scc1 L_end
    v_lshrrev_b32 v1, 6, v0
    v_and_b32 v2, 63, v0
    v_readfirstlane_b32 s16, v1
    v_lshrrev_b32 v4, 3, v2
    v_lshlrev_b32 v5, 11, v4
    v_and_b32 v6, 7, v2
    v_lshrrev_b32 v7, 4, v2
    v_xor_b32 v8, v6, v7
    v_lshl_add_u32 v10, v8, 4, v5
    v_xor_b32 v8, 4, v8
    v_lshl_add_u32 v11, v8, 4, v5
    v_mul_u32_u24 v5, 6144, v4
    v_and_b32 v7, 1, v7
    v_lshlrev_b32 v7, 2, v7
    v_xor_b32 v8, v6, v7
    s_and_b32 s12, s2, 7
    s_lshr_b32 s13, s2, 3
    s_and_b32 s14, s13, 15
    s_lshl_b32 s15, s12, 1
    s_lshr_b32 s19, s13, 4
    s_add_u32 s15, s15, s19
    s_and_b32 s17, s16, 3
    s_and_b32 s19, s16, 1
    s_lshl_b32 s19, s19, 1
    v_xor_b32 v8, s19, v8
    v_lshl_add_u32 v12, v8, 4, v5
    s_lshl_b32 s19, s14, 18
    v_add_u32 v10, s19, v10
    v_add_u32 v11, s19, v11
    s_lshl_b32 s19, s15, 7
    v_add_u32 v12, s19, v12
    s_add_u32 s64, s14, s15
    s_and_b32 s64, s64, 3
    s_add_u32 s65, s12, 0
    s_and_b32 s65, s65, 3
    s_lshl_b32 s65, s65, 2
    s_and_b32 s72, s64, 3
    s_add_u32 s72, s72, s65
    s_mul_i32 s73, s72, 393216
    s_lshl_b32 s72, s72, 7
    s_lshl_b32 s74, s16, 15
    s_add_u32 s72, s72, s74
    s_mul_i32 s74, s16, 49152
    s_add_u32 s73, s73, s74
    s_lshl_b32 s75, s16, 10
    s_lshl_b32 m0, s16, 11
    s_add_u32 s74, s72, 16384
    s_waitcnt lgkmcnt(0)
    s_mov_b64 s[24:25], s[4:5]
    s_mov_b32 s26, 4194304
    s_mov_b32 s27, 0x00020000
    buffer_load_dwordx4 v10, s[24:27], s72 offen lds
    s_addk_i32 m0, 1024
    s_mov_b64 s[28:29], s[6:7]
    s_mov_b32 s30, 6291456
    s_mov_b32 s31, 0x00020000
    buffer_load_dwordx4 v11, s[24:27], s74 offen lds
    s_add_u32 m0, s75, 16384
    s_nop 0
    buffer_load_dwordx4 v12, s[28:31], s73 offen lds
    s_add_u32 m0, s75, 24576
    s_addk_i32 s73, 2048
    buffer_load_dwordx4 v12, s[28:31], s73 offen lds
    s_add_u32 m0, s75, 32768
    s_addk_i32 s73, 2048
    buffer_load_dwordx4 v12, s[28:31], s73 offen lds
    s_cmp_lt_u32 s16, 4
    s_cbranch_scc1 L_compute
    s_bfe_u32 s19, s14, 0x10002
    s_lshl_b32 s19, s19, 2
    s_add_u32 s19, s19, s17
    s_xor_b32 s3, s19, 4
    s_mul_i32 s66, s19, 49152
    s_mul_i32 s67, s3, 49152
    s_lshl_b32 s68, s19, 10
    s_add_u32 s68, s68, 16384
    s_lshl_b32 s69, s3, 10
    s_add_u32 s69, s69, 16384
    s_lshl_b32 s70, s17, 16
    s_lshl_b32 s71, s17, 12
    s_add_u32 s72, s64, 1
    s_and_b32 s72, s72, 3
    s_add_u32 s73, s65, 0
    s_and_b32 s73, s73, 15
    s_add_u32 s72, s72, s73
    s_mul_i32 s73, s72, 393216
    s_lshl_b32 s72, s72, 7
    s_add_u32 s74, s72, s70
    s_add_u32 s75, s73, s66
    s_add_u32 s76, s73, s67
    s_add_u32 m0, s71, 40960
    s_add_u32 s77, s74, 0
    buffer_load_dwordx4 v10, s[24:27], s77 offen lds
    s_add_u32 m0, s71, 41984
    s_add_u32 s77, s74, 16384
    buffer_load_dwordx4 v11, s[24:27], s77 offen lds
    s_add_u32 m0, s71, 43008
    s_add_u32 s77, s74, 32768
    buffer_load_dwordx4 v10, s[24:27], s77 offen lds
    s_add_u32 m0, s71, 44032
    s_add_u32 s77, s74, 49152
    buffer_load_dwordx4 v11, s[24:27], s77 offen lds
    s_add_u32 m0, s68, 40960
    s_add_u32 s77, s75, 0
    buffer_load_dwordx4 v12, s[28:31], s77 offen lds
    s_add_u32 m0, s68, 49152
    s_add_u32 s77, s75, 2048
    buffer_load_dwordx4 v12, s[28:31], s77 offen lds
    s_add_u32 m0, s68, 57344
    s_add_u32 s77, s75, 4096
    buffer_load_dwordx4 v12, s[28:31], s77 offen lds
    s_add_u32 m0, s69, 40960
    s_add_u32 s77, s76, 0
    buffer_load_dwordx4 v12, s[28:31], s77 offen lds
    s_mov_b64 s[32:33], s[98:99]
    s_mov_b32 s34, 16777216
    s_mov_b32 s35, 0x00020000
    s_mov_b64 s[36:37], s[96:97]
    s_mov_b32 s38, 256
    s_mov_b32 s39, 0x00020000
    s_mov_b64 s[40:41], s[84:85]
    s_mov_b32 s42, 2048
    s_mov_b32 s43, 0x00020000
    s_mov_b64 s[44:45], s[92:93]
    s_mov_b32 s46, 2048
    s_mov_b32 s47, 0x00020000
    s_mov_b64 s[48:49], s[86:87]
    s_mov_b32 s50, 7340032
    s_mov_b32 s51, 0x00020000
    s_mov_b64 s[52:53], s[88:89]
    s_mov_b32 s54, 7340032
    s_mov_b32 s55, 0x00020000
    s_mov_b64 s[56:57], s[90:91]
    s_mov_b32 s58, 7340032
    s_mov_b32 s59, 0x00020000
    s_mov_b64 s[60:61], s[10:11]
    s_mov_b32 s62, 2097152
    s_mov_b32 s63, 0x00020000
    s_mov_b32 s79, 0
    v_mov_b32 v13, 0
    v_lshlrev_b32 v3, 4, v2
    v_lshrrev_b32 v9, 4, v2
    v_and_b32 v8, 15, v2
    v_mul_u32_u24 v15, 7168, v9
    v_lshl_add_u32 v15, v8, 4, v15
    v_lshlrev_b32 v16, 11, v9
    v_lshl_add_u32 v16, v8, 4, v16
    v_lshrrev_b32 v19, 3, v2
    v_and_b32 v20, 7, v2
    v_lshlrev_b32 v17, 11, v19
    v_lshl_add_u32 v17, v20, 4, v17
    v_lshlrev_b32 v21, 1, v9
    v_xor_b32 v21, v20, v21
    v_lshlrev_b32 v18, 7, v19
    v_lshl_add_u32 v18, v21, 4, v18
    s_lshl_b32 s19, s17, 10
    s_add_u32 s19, s19, 32768
    v_add_u32 v18, s19, v18
    v_add_u32 v22, 65536, v18
    v_mov_b32 v23, 0xffff
    v_mov_b32 v24, 0xffff0000
    v_cmp_eq_u32 vcc, 0, v8
    s_nop 1
    v_cndmask_b32 v25, 0, v23, vcc
    v_cmp_eq_u32 vcc, 1, v8
    s_nop 1
    v_cndmask_b32 v4, v25, v24, vcc
    v_cmp_eq_u32 vcc, 2, v8
    s_nop 1
    v_cndmask_b32 v25, 0, v23, vcc
    v_cmp_eq_u32 vcc, 3, v8
    s_nop 1
    v_cndmask_b32 v5, v25, v24, vcc
    v_cmp_eq_u32 vcc, 4, v8
    s_nop 1
    v_cndmask_b32 v25, 0, v23, vcc
    v_cmp_eq_u32 vcc, 5, v8
    s_nop 1
    v_cndmask_b32 v6, v25, v24, vcc
    v_cmp_eq_u32 vcc, 6, v8
    s_nop 1
    v_cndmask_b32 v25, 0, v23, vcc
    v_cmp_eq_u32 vcc, 7, v8
    s_nop 1
    v_cndmask_b32 v7, v25, v24, vcc
    v_mov_b32 v23, 0x3ff
    s_getreg_b32 s23, hwreg(HW_REG_XCC_ID, 0, 4)
    v_and_b32 v36, 3, v2
    v_lshlrev_b32 v36, 2, v36
    v_mov_b32 v37, 0x7fc17fc1
    s_cmp_lt_u32 s2, 224
    s_cselect_b32 s50, s50, 0
    s_cselect_b32 s54, s54, 0
    s_lshl_b32 s0, s12, 7
    s_lshl_b32 s19, s17, 5
    s_add_u32 s0, s0, s19
    s_mul_i32 s1, s0, 7168
    s_lshl_b32 s19, s13, 8
    s_add_u32 s1, s1, s19
    s_waitcnt vmcnt(8)
    s_barrier
    s_add_u32 m0, s69, 49152
    s_add_u32 s77, s76, 2048
    buffer_load_dwordx4 v12, s[28:31], s77 offen lds
    s_add_u32 m0, s69, 57344
    s_add_u32 s77, s76, 4096
    buffer_load_dwordx4 v12, s[28:31], s77 offen lds
    s_add_u32 s72, s64, 2
    s_and_b32 s72, s72, 3
    s_add_u32 s73, s65, 0
    s_and_b32 s73, s73, 15
    s_add_u32 s72, s72, s73
    s_mul_i32 s73, s72, 393216
    s_lshl_b32 s72, s72, 7
    s_add_u32 s74, s72, s70
    s_add_u32 s75, s73, s66
    s_add_u32 s76, s73, s67
    s_add_u32 m0, s71, 81920
    s_add_u32 s77, s74, 0
    buffer_load_dwordx4 v10, s[24:27], s77 offen lds
    s_add_u32 m0, s71, 82944
    s_add_u32 s77, s74, 16384
    buffer_load_dwordx4 v11, s[24:27], s77 offen lds
    s_add_u32 m0, s71, 83968
    s_add_u32 s77, s74, 32768
    buffer_load_dwordx4 v10, s[24:27], s77 offen lds
    s_add_u32 m0, s71, 84992
    s_add_u32 s77, s74, 49152
    buffer_load_dwordx4 v11, s[24:27], s77 offen lds
    s_add_u32 m0, s68, 81920
    s_add_u32 s77, s75, 0
    buffer_load_dwordx4 v12, s[28:31], s77 offen lds
    s_add_u32 m0, s68, 90112
    s_add_u32 s77, s75, 2048
    buffer_load_dwordx4 v12, s[28:31], s77 offen lds
    s_add_u32 m0, s68, 98304
    s_add_u32 s77, s75, 4096
    buffer_load_dwordx4 v12, s[28:31], s77 offen lds
    s_add_u32 m0, s69, 81920
    s_add_u32 s77, s76, 0
    buffer_load_dwordx4 v12, s[28:31], s77 offen lds
    s_add_u32 m0, s69, 90112
    s_add_u32 s77, s76, 2048
    buffer_load_dwordx4 v12, s[28:31], s77 offen lds
    s_lshl_b32 s18, s14, 7
    s_lshl_b32 s19, s15, 3
    s_add_u32 s18, s18, s19
    s_lshl_b32 s19, s17, 1
    s_add_u32 s18, s18, s19
    s_lshl_b32 s19, s18, 11
    buffer_load_dwordx4 v[40:43], v3, s[24:27], s19 offen offset:0
    buffer_load_dwordx4 v[44:47], v3, s[24:27], s19 offen offset:1024
    buffer_load_dwordx4 v[48:51], v3, s[24:27], s19 offen offset:2048
    buffer_load_dwordx4 v[52:55], v3, s[24:27], s19 offen offset:3072
    buffer_load_dwordx4 v[56:59], v3, s[40:43], 0 offen offset:0
    buffer_load_dwordx4 v[60:63], v3, s[40:43], 0 offen offset:1024
    buffer_load_dwordx4 v[64:67], v3, s[44:47], 0 offen offset:0
    buffer_load_dwordx4 v[68:71], v3, s[44:47], 0 offen offset:1024
    s_waitcnt vmcnt(17)
    s_barrier
    s_add_u32 m0, s69, 98304
    s_add_u32 s77, s76, 4096
    buffer_load_dwordx4 v12, s[28:31], s77 offen lds
    s_add_u32 s72, s64, 3
    s_and_b32 s72, s72, 3
    s_add_u32 s73, s65, 0
    s_and_b32 s73, s73, 15
    s_add_u32 s72, s72, s73
    s_mul_i32 s73, s72, 393216
    s_lshl_b32 s72, s72, 7
    s_add_u32 s74, s72, s70
    s_add_u32 s75, s73, s66
    s_add_u32 s76, s73, s67
    s_add_u32 m0, s71, 122880
    s_add_u32 s77, s74, 0
    buffer_load_dwordx4 v10, s[24:27], s77 offen lds
    s_add_u32 m0, s71, 123904
    s_add_u32 s77, s74, 16384
    buffer_load_dwordx4 v11, s[24:27], s77 offen lds
    s_add_u32 m0, s71, 124928
    s_add_u32 s77, s74, 32768
    buffer_load_dwordx4 v10, s[24:27], s77 offen lds
    s_add_u32 m0, s71, 125952
    s_add_u32 s77, s74, 49152
    buffer_load_dwordx4 v11, s[24:27], s77 offen lds
    s_add_u32 m0, s68, 122880
    s_add_u32 s77, s75, 0
    buffer_load_dwordx4 v12, s[28:31], s77 offen lds
    s_add_u32 m0, s68, 131072
    s_add_u32 s77, s75, 2048
    buffer_load_dwordx4 v12, s[28:31], s77 offen lds
    s_add_u32 m0, s68, 139264
    s_add_u32 s77, s75, 4096
    buffer_load_dwordx4 v12, s[28:31], s77 offen lds
    s_add_u32 m0, s69, 122880
    s_add_u32 s77, s76, 0
    buffer_load_dwordx4 v12, s[28:31], s77 offen lds
    s_add_u32 m0, s69, 131072
    s_add_u32 s77, s76, 2048
    buffer_load_dwordx4 v12, s[28:31], s77 offen lds
    s_add_u32 m0, s69, 139264
    s_add_u32 s77, s76, 4096
    buffer_load_dwordx4 v12, s[28:31], s77 offen lds
    buffer_load_dword v14, v13, s[36:39], 0 offen offset:4 sc1
    s_waitcnt vmcnt(11)
    s_barrier
    s_add_u32 s72, s64, 0
    s_and_b32 s72, s72, 3
    s_add_u32 s73, s65, 4
    s_and_b32 s73, s73, 15
    s_add_u32 s72, s72, s73
    s_mul_i32 s73, s72, 393216
    s_lshl_b32 s72, s72, 7
    s_add_u32 s74, s72, s70
    s_add_u32 s75, s73, s66
    s_add_u32 s76, s73, s67
    s_add_u32 m0, s71, 0
    s_add_u32 s77, s74, 0
    buffer_load_dwordx4 v10, s[24:27], s77 offen lds
    s_add_u32 m0, s71, 1024
    s_add_u32 s77, s74, 16384
    buffer_load_dwordx4 v11, s[24:27], s77 offen lds
    s_add_u32 m0, s71, 2048
    s_add_u32 s77, s74, 32768
    buffer_load_dwordx4 v10, s[24:27], s77 offen lds
    s_add_u32 m0, s71, 3072
    s_add_u32 s77, s74, 49152
    buffer_load_dwordx4 v11, s[24:27], s77 offen lds
    s_add_u32 m0, s68, 0
    s_add_u32 s77, s75, 0
    buffer_load_dwordx4 v12, s[28:31], s77 offen lds
    s_add_u32 m0, s68, 8192
    s_add_u32 s77, s75, 2048
    buffer_load_dwordx4 v12, s[28:31], s77 offen lds
    s_add_u32 m0, s68, 16384
    s_add_u32 s77, s75, 4096
    buffer_load_dwordx4 v12, s[28:31], s77 offen lds
    s_add_u32 m0, s69, 0
    s_add_u32 s77, s76, 0
    buffer_load_dwordx4 v12, s[28:31], s77 offen lds
    s_add_u32 m0, s69, 8192
    s_add_u32 s77, s76, 2048
    buffer_load_dwordx4 v12, s[28:31], s77 offen lds
    s_add_u32 m0, s69, 16384
    s_add_u32 s77, s76, 4096
    buffer_load_dwordx4 v12, s[28:31], s77 offen lds
    s_add_u32 s72, s64, 1
    s_and_b32 s72, s72, 3
    s_add_u32 s73, s65, 4
    s_and_b32 s73, s73, 15
    s_add_u32 s72, s72, s73
    s_mul_i32 s73, s72, 393216
    s_lshl_b32 s72, s72, 7
    s_add_u32 s74, s72, s70
    s_add_u32 s75, s73, s66
    s_add_u32 s76, s73, s67
    s_add_u32 m0, s71, 40960
    s_add_u32 s77, s74, 0
    buffer_load_dwordx4 v10, s[24:27], s77 offen lds
    s_add_u32 m0, s71, 41984
    s_add_u32 s77, s74, 16384
    buffer_load_dwordx4 v11, s[24:27], s77 offen lds
    s_add_u32 m0, s71, 43008
    s_add_u32 s77, s74, 32768
    buffer_load_dwordx4 v10, s[24:27], s77 offen lds
    s_add_u32 m0, s71, 44032
    s_add_u32 s77, s74, 49152
    buffer_load_dwordx4 v11, s[24:27], s77 offen lds
    s_add_u32 m0, s68, 40960
    s_add_u32 s77, s75, 0
    buffer_load_dwordx4 v12, s[28:31], s77 offen lds
    s_add_u32 m0, s68, 49152
    s_add_u32 s77, s75, 2048
    buffer_load_dwordx4 v12, s[28:31], s77 offen lds
    s_add_u32 m0, s68, 57344
    s_add_u32 s77, s75, 4096
    buffer_load_dwordx4 v12, s[28:31], s77 offen lds
    s_add_u32 m0, s69, 40960
    s_add_u32 s77, s76, 0
    buffer_load_dwordx4 v12, s[28:31], s77 offen lds
    s_add_u32 m0, s69, 49152
    s_add_u32 s77, s76, 2048
    buffer_load_dwordx4 v12, s[28:31], s77 offen lds
    s_add_u32 m0, s69, 57344
    s_add_u32 s77, s76, 4096
    buffer_load_dwordx4 v12, s[28:31], s77 offen lds
    s_waitcnt vmcnt(21)
    s_barrier
    s_add_u32 s72, s64, 2
    s_and_b32 s72, s72, 3
    s_add_u32 s73, s65, 4
    s_and_b32 s73, s73, 15
    s_add_u32 s72, s72, s73
    s_mul_i32 s73, s72, 393216
    s_lshl_b32 s72, s72, 7
    s_add_u32 s74, s72, s70
    s_add_u32 s75, s73, s66
    s_add_u32 s76, s73, s67
    s_add_u32 m0, s71, 81920
    s_add_u32 s77, s74, 0
    buffer_load_dwordx4 v10, s[24:27], s77 offen lds
    s_add_u32 m0, s71, 82944
    s_add_u32 s77, s74, 16384
    buffer_load_dwordx4 v11, s[24:27], s77 offen lds
    s_add_u32 m0, s71, 83968
    s_add_u32 s77, s74, 32768
    buffer_load_dwordx4 v10, s[24:27], s77 offen lds
    s_add_u32 m0, s71, 84992
    s_add_u32 s77, s74, 49152
    buffer_load_dwordx4 v11, s[24:27], s77 offen lds
    s_add_u32 m0, s68, 81920
    s_add_u32 s77, s75, 0
    buffer_load_dwordx4 v12, s[28:31], s77 offen lds
    s_add_u32 m0, s68, 90112
    s_add_u32 s77, s75, 2048
    buffer_load_dwordx4 v12, s[28:31], s77 offen lds
    s_add_u32 m0, s68, 98304
    s_add_u32 s77, s75, 4096
    buffer_load_dwordx4 v12, s[28:31], s77 offen lds
    s_add_u32 m0, s69, 81920
    s_add_u32 s77, s76, 0
    buffer_load_dwordx4 v12, s[28:31], s77 offen lds
    s_add_u32 m0, s69, 90112
    s_add_u32 s77, s76, 2048
    buffer_load_dwordx4 v12, s[28:31], s77 offen lds
    s_add_u32 m0, s69, 98304
    s_add_u32 s77, s76, 4096
    buffer_load_dwordx4 v12, s[28:31], s77 offen lds
    s_waitcnt vmcnt(20)
    s_barrier
    s_add_u32 s72, s64, 3
    s_and_b32 s72, s72, 3
    s_add_u32 s73, s65, 4
    s_and_b32 s73, s73, 15
    s_add_u32 s72, s72, s73
    s_mul_i32 s73, s72, 393216
    s_lshl_b32 s72, s72, 7
    s_add_u32 s74, s72, s70
    s_add_u32 s75, s73, s66
    s_add_u32 s76, s73, s67
    s_add_u32 m0, s71, 122880
    s_add_u32 s77, s74, 0
    buffer_load_dwordx4 v10, s[24:27], s77 offen lds
    s_add_u32 m0, s71, 123904
    s_add_u32 s77, s74, 16384
    buffer_load_dwordx4 v11, s[24:27], s77 offen lds
    s_add_u32 m0, s71, 124928
    s_add_u32 s77, s74, 32768
    buffer_load_dwordx4 v10, s[24:27], s77 offen lds
    s_add_u32 m0, s71, 125952
    s_add_u32 s77, s74, 49152
    buffer_load_dwordx4 v11, s[24:27], s77 offen lds
    s_add_u32 m0, s68, 122880
    s_add_u32 s77, s75, 0
    buffer_load_dwordx4 v12, s[28:31], s77 offen lds
    s_add_u32 m0, s68, 131072
    s_add_u32 s77, s75, 2048
    buffer_load_dwordx4 v12, s[28:31], s77 offen lds
    s_add_u32 m0, s68, 139264
    s_add_u32 s77, s75, 4096
    buffer_load_dwordx4 v12, s[28:31], s77 offen lds
    s_add_u32 m0, s69, 122880
    s_add_u32 s77, s76, 0
    buffer_load_dwordx4 v12, s[28:31], s77 offen lds
    s_add_u32 m0, s69, 131072
    s_add_u32 s77, s76, 2048
    buffer_load_dwordx4 v12, s[28:31], s77 offen lds
    s_add_u32 m0, s69, 139264
    s_add_u32 s77, s76, 4096
    buffer_load_dwordx4 v12, s[28:31], s77 offen lds
    s_waitcnt vmcnt(52)
    s_waitcnt vmcnt(40)
    v_readfirstlane_b32 s78, v14
L_tg1:
    s_nop 1
    s_cmp_lg_u32 s78, 0
    s_cbranch_scc1 L_tk2
    buffer_load_dword v14, v13, s[36:39], 0 offen offset:4 sc1
    s_waitcnt vmcnt(0)
    v_readfirstlane_b32 s78, v14
    s_add_u32 s79, s79, 1
    s_cmp_lt_u32 s79, 32768
    s_cbranch_scc1 L_tg1
L_tk2:
    s_mul_i32 s80, s78, 0x9e3779b1
    s_lshr_b32 s80, s80, 22
    s_mul_i32 s81, s78, 0x85ebca77
    s_lshr_b32 s81, s81, 22
    s_mul_i32 s82, s78, 0xc2b2ae3d
    s_lshr_b32 s82, s82, 22
    s_mul_i32 s83, s78, 0x27d4eb2f
    s_lshr_b32 s83, s83, 22
    v_and_b32 v72, 0xffff, v64
    v_and_b32 v80, 0xffff0000, v64
    v_and_b32 v73, 0xffff, v65
    v_and_b32 v81, 0xffff0000, v65
    v_dot2_f32_bf16 v92, v40, v72, 0
    v_dot2_f32_bf16 v93, v40, v80, 0
    v_and_b32 v74, 0xffff, v66
    v_and_b32 v82, 0xffff0000, v66
    v_dot2_f32_bf16 v94, v41, v73, 0
    v_dot2_f32_bf16 v95, v41, v81, 0
    v_and_b32 v75, 0xffff, v67
    v_and_b32 v83, 0xffff0000, v67
    v_cvt_pk_bf16_f32 v92, v92, v93
    v_dot2_f32_bf16 v96, v42, v74, 0
    v_dot2_f32_bf16 v97, v42, v82, 0
    s_mov_b32 s19, 0x3f803f80
    v_and_b32 v76, 0xffff, v68
    v_and_b32 v84, 0xffff0000, v68
    v_dot2_f32_bf16 v89, v92, s19, 0
    v_cvt_pk_bf16_f32 v94, v94, v95
    v_dot2_f32_bf16 v98, v43, v75, 0
    v_dot2_f32_bf16 v99, v43, v83, 0
    v_and_b32 v77, 0xffff, v69
    v_and_b32 v85, 0xffff0000, v69
    v_dot2_f32_bf16 v89, v94, s19, v89
    v_cvt_pk_bf16_f32 v96, v96, v97
    v_dot2_f32_bf16 v92, v44, v76, 0
    v_dot2_f32_bf16 v93, v44, v84, 0
    v_and_b32 v78, 0xffff, v70
    v_and_b32 v86, 0xffff0000, v70
    v_dot2_f32_bf16 v89, v96, s19, v89
    v_cvt_pk_bf16_f32 v98, v98, v99
    v_dot2_f32_bf16 v94, v45, v77, 0
    v_dot2_f32_bf16 v95, v45, v85, 0
    v_and_b32 v79, 0xffff, v71
    v_and_b32 v87, 0xffff0000, v71
    v_dot2_f32_bf16 v89, v98, s19, v89
    v_cvt_pk_bf16_f32 v92, v92, v93
    v_dot2_f32_bf16 v96, v46, v78, 0
    v_dot2_f32_bf16 v97, v46, v86, 0
    v_dot2_f32_bf16 v89, v92, s19, v89
    v_cvt_pk_bf16_f32 v94, v94, v95
    v_dot2_f32_bf16 v98, v47, v79, 0
    v_dot2_f32_bf16 v99, v47, v87, 0
    v_dot2_f32_bf16 v92, v48, v72, 0
    v_dot2_f32_bf16 v93, v48, v80, 0
    v_dot2_f32_bf16 v89, v94, s19, v89
    v_cvt_pk_bf16_f32 v96, v96, v97
    v_dot2_f32_bf16 v94, v49, v73, 0
    v_dot2_f32_bf16 v95, v49, v81, 0
    v_dot2_f32_bf16 v89, v96, s19, v89
    v_cvt_pk_bf16_f32 v98, v98, v99
    v_cvt_pk_bf16_f32 v92, v92, v93
    v_dot2_f32_bf16 v96, v50, v74, 0
    v_dot2_f32_bf16 v97, v50, v82, 0
    v_dot2_f32_bf16 v89, v98, s19, v89
    v_dot2_f32_bf16 v88, v40, v56, 0
    v_dot2_f32_bf16 v90, v48, v56, 0
    v_dot2_f32_bf16 v91, v92, s19, 0
    v_cvt_pk_bf16_f32 v94, v94, v95
    v_dot2_f32_bf16 v98, v51, v75, 0
    v_dot2_f32_bf16 v99, v51, v83, 0
    v_dot2_f32_bf16 v88, v41, v57, v88
    v_dot2_f32_bf16 v90, v49, v57, v90
    v_dot2_f32_bf16 v91, v94, s19, v91
    v_cvt_pk_bf16_f32 v96, v96, v97
    v_dot2_f32_bf16 v92, v52, v76, 0
    v_dot2_f32_bf16 v93, v52, v84, 0
    v_dot2_f32_bf16 v88, v42, v58, v88
    v_dot2_f32_bf16 v90, v50, v58, v90
    v_dot2_f32_bf16 v91, v96, s19, v91
    v_cvt_pk_bf16_f32 v98, v98, v99
    v_dot2_f32_bf16 v94, v53, v77, 0
    v_dot2_f32_bf16 v95, v53, v85, 0
    v_dot2_f32_bf16 v88, v43, v59, v88
    v_dot2_f32_bf16 v90, v51, v59, v90
    v_dot2_f32_bf16 v91, v98, s19, v91
    v_cvt_pk_bf16_f32 v92, v92, v93
    v_dot2_f32_bf16 v96, v54, v78, 0
    v_dot2_f32_bf16 v97, v54, v86, 0
    v_dot2_f32_bf16 v88, v44, v60, v88
    v_dot2_f32_bf16 v90, v52, v60, v90
    v_dot2_f32_bf16 v91, v92, s19, v91
    v_cvt_pk_bf16_f32 v94, v94, v95
    v_dot2_f32_bf16 v98, v55, v79, 0
    v_dot2_f32_bf16 v99, v55, v87, 0
    v_dot2_f32_bf16 v88, v45, v61, v88
    v_dot2_f32_bf16 v90, v53, v61, v90
    v_dot2_f32_bf16 v91, v94, s19, v91
    v_cvt_pk_bf16_f32 v96, v96, v97
    v_dot2_f32_bf16 v88, v46, v62, v88
    v_dot2_f32_bf16 v90, v54, v62, v90
    v_dot2_f32_bf16 v91, v96, s19, v91
    v_cvt_pk_bf16_f32 v98, v98, v99
    v_dot2_f32_bf16 v88, v47, v63, v88
    v_dot2_f32_bf16 v90, v55, v63, v90
    v_dot2_f32_bf16 v91, v98, s19, v91
    s_nop 1
    v_permlane32_swap_b32 v88, v90
    v_permlane32_swap_b32 v89, v91
    v_add_f32 v88, v88, v90
    v_add_f32 v89, v89, v91
    v_mov_b32 v91, s78
    s_nop 0
    v_permlane16_swap_b32 v88, v89
    v_add_f32 v88, v88, v89
    s_nop 1
    v_add_f32_dpp v88, v88, v88 row_ror:8 row_mask:0xf bank_mask:0xf
    s_nop 1
    v_add_f32_dpp v88, v88, v88 row_ror:4 row_mask:0xf bank_mask:0xf
    s_nop 1
    v_add_f32_dpp v88, v88, v88 row_ror:2 row_mask:0xf bank_mask:0xf
    s_nop 1
    v_add_f32_dpp v88, v88, v88 row_ror:1 row_mask:0xf bank_mask:0xf
    v_cvt_pk_bf16_f32 v88, v88, v88
    v_ashrrev_i32 v90, 31, v88
    v_and_b32 v89, 0xffff0000, v88
    v_or_b32 v90, 0x80000000, v90
    v_mul_f32 v89, 0xbfb8aa3b, v89
    v_xor_b32 v90, v90, v88
    v_exp_f32 v89, v89
    v_lshrrev_b32 v90, 16, v90
    v_add_f32 v89, 1.0, v89
    v_readlane_b32 s84, v90, 0
    v_readlane_b32 s85, v90, 32
    v_rcp_f32 v89, v89
    s_lshl_b32 s84, s84, 11
    s_lshl_b32 s85, s85, 11
    s_sub_u32 s3, 2047, s18
    v_cvt_pk_bf16_f32 v89, v89, v89
    s_or_b32 s84, s84, s3
    s_sub_u32 s3, s3, 1
    s_or_b32 s85, s85, s3
    v_readlane_b32 s20, v89, 16
    s_max_u32 s84, s84, s85
    v_readlane_b32 s21, v89, 48
    s_lshl_b32 s84, s84, 4
    s_or_b32 s84, s84, s23
    s_and_b32 s20, s20, 0xffff
    s_and_b32 s21, s21, 0xffff0000
    s_or_b32 s20, s20, s21
    s_lshl_b32 s3, s18, 2
    s_add_u32 s21, s3, 4472832
    s_add_u32 s3, s3, 4464640
    v_mov_b32 v88, s84
    v_mov_b32 v89, s78
    v_mov_b32 v90, s20
    s_mov_b64 exec, 1
    buffer_store_dwordx2 v[88:89], v13, s[32:35], s3 offen sc1
    buffer_store_dwordx2 v[90:91], v13, s[32:35], s21 offen sc1
    s_mov_b64 exec, -1
    s_waitcnt vmcnt(22)
    s_barrier
    s_add_u32 s72, s64, 0
    s_and_b32 s72, s72, 3
    s_add_u32 s73, s65, 8
    s_and_b32 s73, s73, 15
    s_add_u32 s72, s72, s73
    s_mul_i32 s73, s72, 393216
    s_lshl_b32 s72, s72, 7
    s_add_u32 s74, s72, s70
    s_add_u32 s75, s73, s66
    s_add_u32 s76, s73, s67
    s_add_u32 m0, s71, 0
    s_add_u32 s77, s74, 0
    buffer_load_dwordx4 v10, s[24:27], s77 offen lds
    s_add_u32 m0, s71, 1024
    s_add_u32 s77, s74, 16384
    buffer_load_dwordx4 v11, s[24:27], s77 offen lds
    s_add_u32 m0, s71, 2048
    s_add_u32 s77, s74, 32768
    buffer_load_dwordx4 v10, s[24:27], s77 offen lds
    s_add_u32 m0, s71, 3072
    s_add_u32 s77, s74, 49152
    buffer_load_dwordx4 v11, s[24:27], s77 offen lds
    s_add_u32 m0, s68, 0
    s_add_u32 s77, s75, 0
    buffer_load_dwordx4 v12, s[28:31], s77 offen lds
    s_add_u32 m0, s68, 8192
    s_add_u32 s77, s75, 2048
    buffer_load_dwordx4 v12, s[28:31], s77 offen lds
    s_add_u32 m0, s68, 16384
    s_add_u32 s77, s75, 4096
    buffer_load_dwordx4 v12, s[28:31], s77 offen lds
    s_add_u32 m0, s69, 0
    s_add_u32 s77, s76, 0
    buffer_load_dwordx4 v12, s[28:31], s77 offen lds
    s_add_u32 m0, s69, 8192
    s_add_u32 s77, s76, 2048
    buffer_load_dwordx4 v12, s[28:31], s77 offen lds
    s_add_u32 m0, s69, 16384
    s_add_u32 s77, s76, 4096
    buffer_load_dwordx4 v12, s[28:31], s77 offen lds
    s_waitcnt vmcnt(22)
    s_barrier
    s_add_u32 s72, s64, 1
    s_and_b32 s72, s72, 3
    s_add_u32 s73, s65, 8
    s_and_b32 s73, s73, 15
    s_add_u32 s72, s72, s73
    s_mul_i32 s73, s72, 393216
    s_lshl_b32 s72, s72, 7
    s_add_u32 s74, s72, s70
    s_add_u32 s75, s73, s66
    s_add_u32 s76, s73, s67
    s_add_u32 m0, s71, 40960
    s_add_u32 s77, s74, 0
    buffer_load_dwordx4 v10, s[24:27], s77 offen lds
    s_add_u32 m0, s71, 41984
    s_add_u32 s77, s74, 16384
    buffer_load_dwordx4 v11, s[24:27], s77 offen lds
    s_add_u32 m0, s71, 43008
    s_add_u32 s77, s74, 32768
    buffer_load_dwordx4 v10, s[24:27], s77 offen lds
    s_add_u32 m0, s71, 44032
    s_add_u32 s77, s74, 49152
    buffer_load_dwordx4 v11, s[24:27], s77 offen lds
    s_add_u32 m0, s68, 40960
    s_add_u32 s77, s75, 0
    buffer_load_dwordx4 v12, s[28:31], s77 offen lds
    s_add_u32 m0, s68, 49152
    s_add_u32 s77, s75, 2048
    buffer_load_dwordx4 v12, s[28:31], s77 offen lds
    s_add_u32 m0, s68, 57344
    s_add_u32 s77, s75, 4096
    buffer_load_dwordx4 v12, s[28:31], s77 offen lds
    s_add_u32 m0, s69, 40960
    s_add_u32 s77, s76, 0
    buffer_load_dwordx4 v12, s[28:31], s77 offen lds
    s_add_u32 m0, s69, 49152
    s_add_u32 s77, s76, 2048
    buffer_load_dwordx4 v12, s[28:31], s77 offen lds
    s_add_u32 m0, s69, 57344
    s_add_u32 s77, s76, 4096
    buffer_load_dwordx4 v12, s[28:31], s77 offen lds
    s_waitcnt vmcnt(22)
    s_barrier
    s_add_u32 s72, s64, 2
    s_and_b32 s72, s72, 3
    s_add_u32 s73, s65, 8
    s_and_b32 s73, s73, 15
    s_add_u32 s72, s72, s73
    s_mul_i32 s73, s72, 393216
    s_lshl_b32 s72, s72, 7
    s_add_u32 s74, s72, s70
    s_add_u32 s75, s73, s66
    s_add_u32 s76, s73, s67
    s_add_u32 m0, s71, 81920
    s_add_u32 s77, s74, 0
    buffer_load_dwordx4 v10, s[24:27], s77 offen lds
    s_add_u32 m0, s71, 82944
    s_add_u32 s77, s74, 16384
    buffer_load_dwordx4 v11, s[24:27], s77 offen lds
    s_add_u32 m0, s71, 83968
    s_add_u32 s77, s74, 32768
    buffer_load_dwordx4 v10, s[24:27], s77 offen lds
    s_add_u32 m0, s71, 84992
    s_add_u32 s77, s74, 49152
    buffer_load_dwordx4 v11, s[24:27], s77 offen lds
    s_add_u32 m0, s68, 81920
    s_add_u32 s77, s75, 0
    buffer_load_dwordx4 v12, s[28:31], s77 offen lds
    s_add_u32 m0, s68, 90112
    s_add_u32 s77, s75, 2048
    buffer_load_dwordx4 v12, s[28:31], s77 offen lds
    s_add_u32 m0, s68, 98304
    s_add_u32 s77, s75, 4096
    buffer_load_dwordx4 v12, s[28:31], s77 offen lds
    s_add_u32 m0, s69, 81920
    s_add_u32 s77, s76, 0
    buffer_load_dwordx4 v12, s[28:31], s77 offen lds
    s_add_u32 m0, s69, 90112
    s_add_u32 s77, s76, 2048
    buffer_load_dwordx4 v12, s[28:31], s77 offen lds
    s_add_u32 m0, s69, 98304
    s_add_u32 s77, s76, 4096
    buffer_load_dwordx4 v12, s[28:31], s77 offen lds
    s_waitcnt vmcnt(20)
    s_barrier
    s_add_u32 s72, s64, 3
    s_and_b32 s72, s72, 3
    s_add_u32 s73, s65, 8
    s_and_b32 s73, s73, 15
    s_add_u32 s72, s72, s73
    s_mul_i32 s73, s72, 393216
    s_lshl_b32 s72, s72, 7
    s_add_u32 s74, s72, s70
    s_add_u32 s75, s73, s66
    s_add_u32 s76, s73, s67
    s_add_u32 m0, s71, 122880
    s_add_u32 s77, s74, 0
    buffer_load_dwordx4 v10, s[24:27], s77 offen lds
    s_add_u32 m0, s71, 123904
    s_add_u32 s77, s74, 16384
    buffer_load_dwordx4 v11, s[24:27], s77 offen lds
    s_add_u32 m0, s71, 124928
    s_add_u32 s77, s74, 32768
    buffer_load_dwordx4 v10, s[24:27], s77 offen lds
    s_add_u32 m0, s71, 125952
    s_add_u32 s77, s74, 49152
    buffer_load_dwordx4 v11, s[24:27], s77 offen lds
    s_add_u32 m0, s68, 122880
    s_add_u32 s77, s75, 0
    buffer_load_dwordx4 v12, s[28:31], s77 offen lds
    s_add_u32 m0, s68, 131072
    s_add_u32 s77, s75, 2048
    buffer_load_dwordx4 v12, s[28:31], s77 offen lds
    s_add_u32 m0, s68, 139264
    s_add_u32 s77, s75, 4096
    buffer_load_dwordx4 v12, s[28:31], s77 offen lds
    s_add_u32 m0, s69, 122880
    s_add_u32 s77, s76, 0
    buffer_load_dwordx4 v12, s[28:31], s77 offen lds
    s_add_u32 m0, s69, 131072
    s_add_u32 s77, s76, 2048
    buffer_load_dwordx4 v12, s[28:31], s77 offen lds
    s_add_u32 m0, s69, 139264
    s_add_u32 s77, s76, 4096
    buffer_load_dwordx4 v12, s[28:31], s77 offen lds
    s_waitcnt vmcnt(20)
    s_barrier
    s_add_u32 s72, s64, 0
    s_and_b32 s72, s72, 3
    s_add_u32 s73, s65, 12
    s_and_b32 s73, s73, 15
    s_add_u32 s72, s72, s73
    s_mul_i32 s73, s72, 393216
    s_lshl_b32 s72, s72, 7
    s_add_u32 s74, s72, s70
    s_add_u32 s75, s73, s66
    s_add_u32 s76, s73, s67
    s_add_u32 m0, s71, 0
    s_add_u32 s77, s74, 0
    buffer_load_dwordx4 v10, s[24:27], s77 offen lds
    s_add_u32 m0, s71, 1024
    s_add_u32 s77, s74, 16384
    buffer_load_dwordx4 v11, s[24:27], s77 offen lds
    s_add_u32 m0, s71, 2048
    s_add_u32 s77, s74, 32768
    buffer_load_dwordx4 v10, s[24:27], s77 offen lds
    s_add_u32 m0, s71, 3072
    s_add_u32 s77, s74, 49152
    buffer_load_dwordx4 v11, s[24:27], s77 offen lds
    s_add_u32 m0, s68, 0
    s_add_u32 s77, s75, 0
    buffer_load_dwordx4 v12, s[28:31], s77 offen lds
    s_add_u32 m0, s68, 8192
    s_add_u32 s77, s75, 2048
    buffer_load_dwordx4 v12, s[28:31], s77 offen lds
    s_add_u32 m0, s68, 16384
    s_add_u32 s77, s75, 4096
    buffer_load_dwordx4 v12, s[28:31], s77 offen lds
    s_add_u32 m0, s69, 0
    s_add_u32 s77, s76, 0
    buffer_load_dwordx4 v12, s[28:31], s77 offen lds
    s_add_u32 m0, s69, 8192
    s_add_u32 s77, s76, 2048
    buffer_load_dwordx4 v12, s[28:31], s77 offen lds
    s_add_u32 m0, s69, 16384
    s_add_u32 s77, s76, 4096
    buffer_load_dwordx4 v12, s[28:31], s77 offen lds
    s_waitcnt vmcnt(20)
    s_barrier
    s_add_u32 s72, s64, 1
    s_and_b32 s72, s72, 3
    s_add_u32 s73, s65, 12
    s_and_b32 s73, s73, 15
    s_add_u32 s72, s72, s73
    s_mul_i32 s73, s72, 393216
    s_lshl_b32 s72, s72, 7
    s_add_u32 s74, s72, s70
    s_add_u32 s75, s73, s66
    s_add_u32 s76, s73, s67
    s_add_u32 m0, s71, 40960
    s_add_u32 s77, s74, 0
    buffer_load_dwordx4 v10, s[24:27], s77 offen lds
    s_add_u32 m0, s71, 41984
    s_add_u32 s77, s74, 16384
    buffer_load_dwordx4 v11, s[24:27], s77 offen lds
    s_add_u32 m0, s71, 43008
    s_add_u32 s77, s74, 32768
    buffer_load_dwordx4 v10, s[24:27], s77 offen lds
    s_add_u32 m0, s71, 44032
    s_add_u32 s77, s74, 49152
    buffer_load_dwordx4 v11, s[24:27], s77 offen lds
    s_add_u32 m0, s68, 40960
    s_add_u32 s77, s75, 0
    buffer_load_dwordx4 v12, s[28:31], s77 offen lds
    s_add_u32 m0, s68, 49152
    s_add_u32 s77, s75, 2048
    buffer_load_dwordx4 v12, s[28:31], s77 offen lds
    s_add_u32 m0, s68, 57344
    s_add_u32 s77, s75, 4096
    buffer_load_dwordx4 v12, s[28:31], s77 offen lds
    s_add_u32 m0, s69, 40960
    s_add_u32 s77, s76, 0
    buffer_load_dwordx4 v12, s[28:31], s77 offen lds
    s_add_u32 m0, s69, 49152
    s_add_u32 s77, s76, 2048
    buffer_load_dwordx4 v12, s[28:31], s77 offen lds
    s_add_u32 m0, s69, 57344
    s_add_u32 s77, s76, 4096
    buffer_load_dwordx4 v12, s[28:31], s77 offen lds
    s_waitcnt vmcnt(20)
    s_barrier
    s_add_u32 s72, s64, 2
    s_and_b32 s72, s72, 3
    s_add_u32 s73, s65, 12
    s_and_b32 s73, s73, 15
    s_add_u32 s72, s72, s73
    s_mul_i32 s73, s72, 393216
    s_lshl_b32 s72, s72, 7
    s_add_u32 s74, s72, s70
    s_add_u32 s75, s73, s66
    s_add_u32 s76, s73, s67
    s_add_u32 m0, s71, 81920
    s_add_u32 s77, s74, 0
    buffer_load_dwordx4 v10, s[24:27], s77 offen lds
    s_add_u32 m0, s71, 82944
    s_add_u32 s77, s74, 16384
    buffer_load_dwordx4 v11, s[24:27], s77 offen lds
    s_add_u32 m0, s71, 83968
    s_add_u32 s77, s74, 32768
    buffer_load_dwordx4 v10, s[24:27], s77 offen lds
    s_add_u32 m0, s71, 84992
    s_add_u32 s77, s74, 49152
    buffer_load_dwordx4 v11, s[24:27], s77 offen lds
    s_add_u32 m0, s68, 81920
    s_add_u32 s77, s75, 0
    buffer_load_dwordx4 v12, s[28:31], s77 offen lds
    s_add_u32 m0, s68, 90112
    s_add_u32 s77, s75, 2048
    buffer_load_dwordx4 v12, s[28:31], s77 offen lds
    s_add_u32 m0, s68, 98304
    s_add_u32 s77, s75, 4096
    buffer_load_dwordx4 v12, s[28:31], s77 offen lds
    s_add_u32 m0, s69, 81920
    s_add_u32 s77, s76, 0
    buffer_load_dwordx4 v12, s[28:31], s77 offen lds
    s_add_u32 m0, s69, 90112
    s_add_u32 s77, s76, 2048
    buffer_load_dwordx4 v12, s[28:31], s77 offen lds
    s_add_u32 m0, s69, 98304
    s_add_u32 s77, s76, 4096
    buffer_load_dwordx4 v12, s[28:31], s77 offen lds
    s_lshl_b32 s19, s17, 11
    s_add_u32 s19, s19, 4464640
    buffer_load_dwordx4 v[28:31], v3, s[32:35], s19 offen offset:0 sc1
    buffer_load_dwordx4 v[32:35], v3, s[32:35], s19 offen offset:1024 sc1
    s_waitcnt vmcnt(22)
    s_barrier
    s_add_u32 s72, s64, 3
    s_and_b32 s72, s72, 3
    s_add_u32 s73, s65, 12
    s_and_b32 s73, s73, 15
    s_add_u32 s72, s72, s73
    s_mul_i32 s73, s72, 393216
    s_lshl_b32 s72, s72, 7
    s_add_u32 s74, s72, s70
    s_add_u32 s75, s73, s66
    s_add_u32 s76, s73, s67
    s_add_u32 m0, s71, 122880
    s_add_u32 s77, s74, 0
    buffer_load_dwordx4 v10, s[24:27], s77 offen lds
    s_add_u32 m0, s71, 123904
    s_add_u32 s77, s74, 16384
    buffer_load_dwordx4 v11, s[24:27], s77 offen lds
    s_add_u32 m0, s71, 124928
    s_add_u32 s77, s74, 32768
    buffer_load_dwordx4 v10, s[24:27], s77 offen lds
    s_add_u32 m0, s71, 125952
    s_add_u32 s77, s74, 49152
    buffer_load_dwordx4 v11, s[24:27], s77 offen lds
    s_add_u32 m0, s68, 122880
    s_add_u32 s77, s75, 0
    buffer_load_dwordx4 v12, s[28:31], s77 offen lds
    s_add_u32 m0, s68, 131072
    s_add_u32 s77, s75, 2048
    buffer_load_dwordx4 v12, s[28:31], s77 offen lds
    s_add_u32 m0, s68, 139264
    s_add_u32 s77, s75, 4096
    buffer_load_dwordx4 v12, s[28:31], s77 offen lds
    s_add_u32 m0, s69, 122880
    s_add_u32 s77, s76, 0
    buffer_load_dwordx4 v12, s[28:31], s77 offen lds
    s_add_u32 m0, s69, 131072
    s_add_u32 s77, s76, 2048
    buffer_load_dwordx4 v12, s[28:31], s77 offen lds
    s_add_u32 m0, s69, 139264
    s_add_u32 s77, s76, 4096
    buffer_load_dwordx4 v12, s[28:31], s77 offen lds
    s_waitcnt vmcnt(22)
    s_barrier
    buffer_load_dwordx4 v[100:103], v15, s[48:51], s1 offen nt
    buffer_load_dwordx4 v[132:135], v15, s[52:55], s1 offen nt
    s_add_u32 s1, s1, 28672
    buffer_load_dwordx4 v[104:107], v15, s[48:51], s1 offen nt
    buffer_load_dwordx4 v[136:139], v15, s[52:55], s1 offen nt
    s_add_u32 s1, s1, 28672
    buffer_load_dwordx4 v[108:111], v15, s[48:51], s1 offen nt
    buffer_load_dwordx4 v[140:143], v15, s[52:55], s1 offen nt
    s_add_u32 s1, s1, 28672
    s_mul_i32 s73, s13, 112
    s_mul_i32 s19, s17, 28
    s_add_u32 s73, s73, s19
    s_lshl_b32 s74, s73, 11
    s_lshl_b32 s19, s12, 8
    s_add_u32 s74, s74, s19
    s_lshr_b32 s67, s12, 2
    s_lshl_b32 s67, s67, 3
    s_lshr_b32 s19, s13, 2
    s_add_u32 s67, s67, s19
    s_lshl_b32 s68, s19, 2
    s_lshl_b32 s69, s67, 7
    s_lshl_b32 s19, s17, 14
    s_add_u32 s69, s69, s19
    s_waitcnt vmcnt(6)
    s_barrier
    s_cmp_lg_u32 s17, 0
    s_cbranch_scc1 L_z3
    v_mov_b32 v40, 0
    v_mov_b32 v41, 0
    v_mov_b32 v42, 0
    v_mov_b32 v43, 0
    s_mov_b64 exec, 15
    ds_write_b128 v3, v[40:43] offset:0
    ds_write_b32 v13, v37 offset:128
    s_mov_b64 exec, -1
L_z3:
    s_waitcnt vmcnt(16)
L_kp4:
    v_xor_b32 v29, s78, v29
    v_mov_b32 v80, v28
    v_xor_b32 v31, s78, v31
    v_mov_b32 v81, v30
    v_xor_b32 v33, s78, v33
    v_mov_b32 v82, v32
    v_xor_b32 v35, s78, v35
    v_mov_b32 v83, v34
    v_or3_b32 v29, v29, v31, v33
    v_max3_u32 v28, v28, v30, v32
    v_or_b32 v29, v29, v35
    v_max_u32 v28, v28, v34
    v_cmp_ne_u32 vcc, 0, v29
    s_cbranch_vccz L_kk5
    s_lshl_b32 s19, s17, 11
    s_add_u32 s19, s19, 4464640
    buffer_load_dwordx4 v[28:31], v3, s[32:35], s19 offen offset:0 sc1
    buffer_load_dwordx4 v[32:35], v3, s[32:35], s19 offen offset:1024 sc1
    s_waitcnt vmcnt(0)
    s_add_u32 s79, s79, 1
    s_cmp_lt_u32 s79, 32768
    s_cbranch_scc1 L_kp4
L_kk5:
    v_xor_b32 v72, s23, v80
    v_xor_b32 v73, s23, v81
    v_xor_b32 v74, s23, v82
    v_xor_b32 v75, s23, v83
    v_or3_b32 v72, v72, v73, v74
    v_or_b32 v72, v72, v75
    v_and_b32 v72, 15, v72
    v_cmp_ne_u32 vcc, 0, v72
    s_lshl_b32 s19, s15, 1
    s_lshl_b32 s19, 3, s19
    s_or_b32 s3, vcc_lo, vcc_hi
    s_and_b32 s3, s3, s19
    s_cselect_b32 s3, 1, 0
    v_xor_b32 v72, s3, v37
    s_lshl_b64 exec, 1, s17
    ds_write_b32 v36, v72 offset:240
    s_mov_b64 exec, -1
    buffer_load_dwordx4 v[112:115], v15, s[48:51], s1 offen nt
    buffer_load_dwordx4 v[144:147], v15, s[52:55], s1 offen nt
    s_add_u32 s1, s1, 28672
    buffer_load_dwordx4 v[116:119], v15, s[48:51], s1 offen nt
    buffer_load_dwordx4 v[148:151], v15, s[52:55], s1 offen nt
    s_add_u32 s1, s1, 28672
    buffer_load_dwordx4 v[120:123], v15, s[48:51], s1 offen nt
    buffer_load_dwordx4 v[152:155], v15, s[52:55], s1 offen nt
    s_add_u32 s1, s1, 28672
    buffer_load_dwordx4 v[124:127], v15, s[48:51], s1 offen nt
    buffer_load_dwordx4 v[156:159], v15, s[52:55], s1 offen nt
    s_add_u32 s1, s1, 28672
    buffer_load_dwordx4 v[128:131], v15, s[48:51], s1 offen nt
    buffer_load_dwordx4 v[160:163], v15, s[52:55], s1 offen nt
    s_add_u32 s1, s1, 28672
L_fw6:
    ds_read_b32 v29, v13 offset:128
    s_waitcnt lgkmcnt(0)
    v_cmp_ne_u32 vcc, v29, v37
    s_cbranch_vccz L_fk7
    s_add_u32 s79, s79, 1
    s_cmp_lt_u32 s79, 32768
    s_cbranch_scc1 L_fw6
L_fk7:
    ds_max_u32 v13, v28 offset:16
    v_mov_b32 v26, 1
    s_mov_b64 exec, 1
    ds_add_u32 v13, v26 offset:0
    s_mov_b64 exec, -1
L_kc8:
    ds_read_b32 v26, v13 offset:0
    ds_read_b32 v27, v13 offset:16
    s_waitcnt lgkmcnt(0)
    v_readfirstlane_b32 s19, v26
    v_readfirstlane_b32 s71, v27
    s_nop 0
    s_cmp_ge_u32 s19, 4
    s_cbranch_scc1 L_kd9
    s_add_u32 s79, s79, 1
    s_cmp_lt_u32 s79, 32768
    s_cbranch_scc1 L_kc8
L_kd9:
    s_lshr_b32 s71, s71, 4
    s_and_b32 s72, s71, 2047
    s_sub_u32 s72, 2047, s72
    s_lshl_b32 s19, s72, 11
    s_lshl_b32 s3, s0, 1
    s_add_u32 s19, s19, s3
    v_lshlrev_b32 v26, 3, v20
    v_lshl_add_u32 v26, v9, 1, v26
    buffer_load_ushort v27, v26, s[24:27], s19 offen
    s_lshl_b32 s19, s68, 16
    s_add_u32 s19, s19, s69
    buffer_load_dwordx4 v[192:195], v17, s[60:63], s19 offen
    s_add_u32 s68, s68, 1
    s_and_b32 s68, s68, 31
    s_lshl_b32 s19, s68, 16
    s_add_u32 s19, s19, s69
    buffer_load_dwordx4 v[196:199], v17, s[60:63], s19 offen
    s_add_u32 s68, s68, 1
    s_and_b32 s68, s68, 31
    s_lshl_b32 s19, s68, 16
    s_add_u32 s19, s19, s69
    buffer_load_dwordx4 v[200:203], v17, s[60:63], s19 offen
    s_add_u32 s68, s68, 1
    s_and_b32 s68, s68, 31
    s_lshl_b32 s19, s68, 16
    s_add_u32 s19, s19, s69
    buffer_load_dwordx4 v[204:207], v17, s[60:63], s19 offen
    s_add_u32 s68, s68, 1
    s_and_b32 s68, s68, 31
    s_lshl_b32 s19, s68, 16
    s_add_u32 s19, s19, s69
    buffer_load_dwordx4 v[208:211], v17, s[60:63], s19 offen
    s_add_u32 s68, s68, 1
    s_and_b32 s68, s68, 31
    s_lshl_b32 s19, s68, 16
    s_add_u32 s19, s19, s69
    buffer_load_dwordx4 v[212:215], v17, s[60:63], s19 offen
    s_add_u32 s68, s68, 1
    s_and_b32 s68, s68, 31
    s_lshl_b32 s19, s68, 16
    s_add_u32 s19, s19, s69
    buffer_load_dwordx4 v[216:219], v17, s[60:63], s19 offen
    s_add_u32 s68, s68, 1
    s_and_b32 s68, s68, 31
    s_lshl_b32 s19, s68, 16
    s_add_u32 s19, s19, s69
    buffer_load_dwordx4 v[220:223], v17, s[60:63], s19 offen
    s_add_u32 s68, s68, 1
    s_and_b32 s68, s68, 31
    s_lshl_b32 s19, s68, 16
    s_add_u32 s19, s19, s69
    buffer_load_dwordx4 v[224:227], v17, s[60:63], s19 offen
    s_add_u32 s68, s68, 1
    s_and_b32 s68, s68, 31
    s_lshl_b32 s19, s68, 16
    s_add_u32 s19, s19, s69
    buffer_load_dwordx4 v[228:231], v17, s[60:63], s19 offen
    s_add_u32 s68, s68, 1
    s_and_b32 s68, s68, 31
    s_lshl_b32 s19, s68, 16
    s_add_u32 s19, s19, s69
    buffer_load_dwordx4 v[232:235], v17, s[60:63], s19 offen
    s_add_u32 s68, s68, 1
    s_and_b32 s68, s68, 31
    s_lshl_b32 s19, s68, 16
    s_add_u32 s19, s19, s69
    buffer_load_dwordx4 v[236:239], v17, s[60:63], s19 offen
    s_add_u32 s68, s68, 1
    s_and_b32 s68, s68, 31
    s_lshl_b32 s19, s68, 16
    s_add_u32 s19, s19, s69
    buffer_load_dwordx4 v[240:243], v17, s[60:63], s19 offen
    s_add_u32 s68, s68, 1
    s_and_b32 s68, s68, 31
    s_lshl_b32 s19, s68, 16
    s_add_u32 s19, s19, s69
    buffer_load_dwordx4 v[244:247], v17, s[60:63], s19 offen
    s_add_u32 s68, s68, 1
    s_and_b32 s68, s68, 31
    s_lshl_b32 s19, s68, 16
    s_add_u32 s19, s19, s69
    buffer_load_dwordx4 v[248:251], v17, s[60:63], s19 offen
    s_add_u32 s68, s68, 1
    s_and_b32 s68, s68, 31
    s_lshl_b32 s19, s68, 16
    s_add_u32 s19, s19, s69
    buffer_load_dwordx4 v[252:255], v17, s[60:63], s19 offen
    s_add_u32 s68, s68, 1
    s_and_b32 s68, s68, 31
    s_waitcnt vmcnt(16)
    s_waitcnt vmcnt(17)
    v_lshl_or_b32 v27, v27, 16, v27
    s_lshl_b32 s19, s17, 10
    s_add_u32 s19, s19, 26624
    v_and_b32_dpp v72, v27, v4 row_newbcast:0 row_mask:0xf bank_mask:0xf
    v_and_b32_dpp v73, v27, v5 row_newbcast:0 row_mask:0xf bank_mask:0xf
    v_and_b32_dpp v74, v27, v6 row_newbcast:0 row_mask:0xf bank_mask:0xf
    v_and_b32_dpp v75, v27, v7 row_newbcast:0 row_mask:0xf bank_mask:0xf
    v_and_b32_dpp v76, v27, v4 row_newbcast:1 row_mask:0xf bank_mask:0xf
    v_and_b32_dpp v77, v27, v5 row_newbcast:1 row_mask:0xf bank_mask:0xf
    v_mfma_f32_16x16x32_bf16 v[88:91], v[72:75], v[100:103], 0
    v_and_b32_dpp v78, v27, v6 row_newbcast:1 row_mask:0xf bank_mask:0xf
    v_and_b32_dpp v79, v27, v7 row_newbcast:1 row_mask:0xf bank_mask:0xf
    v_mfma_f32_16x16x32_bf16 v[92:95], v[72:75], v[132:135], 0
    v_and_b32_dpp v80, v27, v4 row_newbcast:2 row_mask:0xf bank_mask:0xf
    v_and_b32_dpp v81, v27, v5 row_newbcast:2 row_mask:0xf bank_mask:0xf
    v_mfma_f32_16x16x32_bf16 v[88:91], v[76:79], v[104:107], v[88:91]
    v_and_b32_dpp v82, v27, v6 row_newbcast:2 row_mask:0xf bank_mask:0xf
    v_and_b32_dpp v83, v27, v7 row_newbcast:2 row_mask:0xf bank_mask:0xf
    v_mfma_f32_16x16x32_bf16 v[92:95], v[76:79], v[136:139], v[92:95]
    v_and_b32_dpp v84, v27, v4 row_newbcast:3 row_mask:0xf bank_mask:0xf
    v_and_b32_dpp v85, v27, v5 row_newbcast:3 row_mask:0xf bank_mask:0xf
    v_mfma_f32_16x16x32_bf16 v[88:91], v[80:83], v[108:111], v[88:91]
    v_and_b32_dpp v86, v27, v6 row_newbcast:3 row_mask:0xf bank_mask:0xf
    v_and_b32_dpp v87, v27, v7 row_newbcast:3 row_mask:0xf bank_mask:0xf
    v_mfma_f32_16x16x32_bf16 v[92:95], v[80:83], v[140:143], v[92:95]
    v_and_b32_dpp v72, v27, v4 row_newbcast:4 row_mask:0xf bank_mask:0xf
    v_and_b32_dpp v73, v27, v5 row_newbcast:4 row_mask:0xf bank_mask:0xf
    v_mfma_f32_16x16x32_bf16 v[88:91], v[84:87], v[112:115], v[88:91]
    v_and_b32_dpp v74, v27, v6 row_newbcast:4 row_mask:0xf bank_mask:0xf
    v_and_b32_dpp v75, v27, v7 row_newbcast:4 row_mask:0xf bank_mask:0xf
    v_mfma_f32_16x16x32_bf16 v[92:95], v[84:87], v[144:147], v[92:95]
    v_and_b32_dpp v76, v27, v4 row_newbcast:5 row_mask:0xf bank_mask:0xf
    v_and_b32_dpp v77, v27, v5 row_newbcast:5 row_mask:0xf bank_mask:0xf
    v_mfma_f32_16x16x32_bf16 v[88:91], v[72:75], v[116:119], v[88:91]
    v_and_b32_dpp v78, v27, v6 row_newbcast:5 row_mask:0xf bank_mask:0xf
    v_and_b32_dpp v79, v27, v7 row_newbcast:5 row_mask:0xf bank_mask:0xf
    v_mfma_f32_16x16x32_bf16 v[92:95], v[72:75], v[148:151], v[92:95]
    v_and_b32_dpp v80, v27, v4 row_newbcast:6 row_mask:0xf bank_mask:0xf
    v_and_b32_dpp v81, v27, v5 row_newbcast:6 row_mask:0xf bank_mask:0xf
    v_mfma_f32_16x16x32_bf16 v[88:91], v[76:79], v[120:123], v[88:91]
    v_and_b32_dpp v82, v27, v6 row_newbcast:6 row_mask:0xf bank_mask:0xf
    v_and_b32_dpp v83, v27, v7 row_newbcast:6 row_mask:0xf bank_mask:0xf
    v_mfma_f32_16x16x32_bf16 v[92:95], v[76:79], v[152:155], v[92:95]
    v_and_b32_dpp v84, v27, v4 row_newbcast:7 row_mask:0xf bank_mask:0xf
    v_and_b32_dpp v85, v27, v5 row_newbcast:7 row_mask:0xf bank_mask:0xf
    v_mfma_f32_16x16x32_bf16 v[88:91], v[80:83], v[124:127], v[88:91]
    v_and_b32_dpp v86, v27, v6 row_newbcast:7 row_mask:0xf bank_mask:0xf
    v_and_b32_dpp v87, v27, v7 row_newbcast:7 row_mask:0xf bank_mask:0xf
    v_mfma_f32_16x16x32_bf16 v[92:95], v[80:83], v[156:159], v[92:95]
    v_add_u32 v26, s19, v3
    v_mov_b32 v28, 1
    v_mfma_f32_16x16x32_bf16 v[88:91], v[84:87], v[128:131], v[88:91]
    v_mfma_f32_16x16x32_bf16 v[92:95], v[84:87], v[160:163], v[92:95]
    s_nop 7
    v_permlane32_swap_b32 v88, v92
    v_permlane32_swap_b32 v89, v93
    v_permlane32_swap_b32 v90, v94
    v_permlane32_swap_b32 v91, v95
    ds_write_b128 v26, v[88:91]
    s_mov_b64 exec, 1
    ds_add_rtn_u32 v29, v13, v28 offset:32
    s_mov_b64 exec, -1
    s_waitcnt lgkmcnt(0)
    v_readfirstlane_b32 s19, v29
    s_nop 1
    s_cmp_lg_u32 s19, 3
    s_cbranch_scc1 L_gs10
    ds_read_b128 v[72:75], v3 offset:26624
    ds_read_b128 v[76:79], v3 offset:27648
    ds_read_b128 v[80:83], v3 offset:28672
    ds_read_b128 v[84:87], v3 offset:29696
    s_waitcnt lgkmcnt(0)
    v_pk_add_f32 v[72:73], v[72:73], v[76:77]
    v_pk_add_f32 v[74:75], v[74:75], v[78:79]
    v_pk_add_f32 v[80:81], v[80:81], v[84:85]
    v_pk_add_f32 v[82:83], v[82:83], v[86:87]
    v_pk_add_f32 v[72:73], v[72:73], v[80:81]
    v_pk_add_f32 v[74:75], v[74:75], v[82:83]
    v_bfi_b32 v72, v23, s80, v72
    v_bfi_b32 v73, v23, s81, v73
    v_bfi_b32 v74, v23, s82, v74
    v_bfi_b32 v75, v23, s83, v75
    s_cmp_ge_u32 s2, 224
    s_cbranch_scc1 L_gs10
    v_lshrrev_b32 v26, 5, v2
    v_mul_u32_u24 v26, 14336, v26
    v_lshl_add_u32 v26, v8, 5, v26
    v_and_b32 v29, 1, v9
    v_lshl_add_u32 v26, v29, 4, v26
    s_mul_i32 s19, s12, 28672
    s_lshl_b32 s3, s13, 9
    s_add_u32 s19, s19, s3
    s_add_u32 s19, s19, 4489216
    buffer_store_dwordx4 v[72:75], v26, s[32:35], s19 offen sc1
L_gs10:
    s_waitcnt vmcnt(8)
L_fw11:
    ds_read_b32 v29, v36 offset:144
    s_waitcnt lgkmcnt(0)
    v_cmp_ne_u32 vcc, v29, v37
    s_cbranch_vccz L_fk12
    s_add_u32 s79, s79, 1
    s_cmp_lt_u32 s79, 32768
    s_cbranch_scc1 L_fw11
L_fk12:
    ds_write_b128 v18, v[192:195] offset:0
    ds_write_b128 v18, v[196:199] offset:4096
    ds_write_b128 v18, v[200:203] offset:8192
    ds_write_b128 v18, v[204:207] offset:12288
    ds_write_b128 v18, v[208:211] offset:16384
    ds_write_b128 v18, v[212:215] offset:20480
    ds_write_b128 v18, v[216:219] offset:24576
    ds_write_b128 v18, v[220:223] offset:28672
    s_waitcnt vmcnt(0)
    ds_write_b128 v18, v[224:227] offset:32768
    ds_write_b128 v18, v[228:231] offset:36864
    ds_write_b128 v18, v[232:235] offset:40960
    ds_write_b128 v18, v[236:239] offset:45056
    ds_write_b128 v18, v[240:243] offset:49152
    ds_write_b128 v18, v[244:247] offset:53248
    ds_write_b128 v18, v[248:251] offset:57344
    ds_write_b128 v18, v[252:255] offset:61440
L_fw13:
    ds_read_b32 v29, v36 offset:176
    s_waitcnt lgkmcnt(0)
    v_cmp_ne_u32 vcc, v29, v37
    s_cbranch_vccz L_fk14
    s_add_u32 s79, s79, 1
    s_cmp_lt_u32 s79, 32768
    s_cbranch_scc1 L_fw13
L_fk14:
    v_min_u32 v26, 6, v20
    v_mul_u32_u24 v27, 28672, v19
    v_lshl_add_u32 v26, v26, 4, v27
    s_lshl_b32 s75, s73, 2
    s_add_u32 s75, s75, 4489216
    s_add_u32 s76, s75, 14336
    buffer_load_dwordx4 v[72:75], v26, s[32:35], s75 offen sc1
    buffer_load_dwordx4 v[76:79], v26, s[32:35], s76 offen sc1
    s_lshl_b32 s19, s68, 16
    s_add_u32 s19, s19, s69
    buffer_load_dwordx4 v[192:195], v17, s[60:63], s19 offen
    s_add_u32 s68, s68, 1
    s_and_b32 s68, s68, 31
    s_lshl_b32 s19, s68, 16
    s_add_u32 s19, s19, s69
    buffer_load_dwordx4 v[196:199], v17, s[60:63], s19 offen
    s_add_u32 s68, s68, 1
    s_and_b32 s68, s68, 31
    s_lshl_b32 s19, s68, 16
    s_add_u32 s19, s19, s69
    buffer_load_dwordx4 v[200:203], v17, s[60:63], s19 offen
    s_add_u32 s68, s68, 1
    s_and_b32 s68, s68, 31
    s_lshl_b32 s19, s68, 16
    s_add_u32 s19, s19, s69
    buffer_load_dwordx4 v[204:207], v17, s[60:63], s19 offen
    s_add_u32 s68, s68, 1
    s_and_b32 s68, s68, 31
    s_lshl_b32 s19, s68, 16
    s_add_u32 s19, s19, s69
    buffer_load_dwordx4 v[208:211], v17, s[60:63], s19 offen
    s_add_u32 s68, s68, 1
    s_and_b32 s68, s68, 31
    s_lshl_b32 s19, s68, 16
    s_add_u32 s19, s19, s69
    buffer_load_dwordx4 v[212:215], v17, s[60:63], s19 offen
    s_add_u32 s68, s68, 1
    s_and_b32 s68, s68, 31
    s_lshl_b32 s19, s68, 16
    s_add_u32 s19, s19, s69
    buffer_load_dwordx4 v[216:219], v17, s[60:63], s19 offen
    s_add_u32 s68, s68, 1
    s_and_b32 s68, s68, 31
    s_lshl_b32 s19, s68, 16
    s_add_u32 s19, s19, s69
    buffer_load_dwordx4 v[220:223], v17, s[60:63], s19 offen
    s_add_u32 s68, s68, 1
    s_and_b32 s68, s68, 31
    s_lshl_b32 s19, s68, 16
    s_add_u32 s19, s19, s69
    buffer_load_dwordx4 v[224:227], v17, s[60:63], s19 offen
    s_add_u32 s68, s68, 1
    s_and_b32 s68, s68, 31
    s_lshl_b32 s19, s68, 16
    s_add_u32 s19, s19, s69
    buffer_load_dwordx4 v[228:231], v17, s[60:63], s19 offen
    s_add_u32 s68, s68, 1
    s_and_b32 s68, s68, 31
    s_lshl_b32 s19, s68, 16
    s_add_u32 s19, s19, s69
    buffer_load_dwordx4 v[232:235], v17, s[60:63], s19 offen
    s_add_u32 s68, s68, 1
    s_and_b32 s68, s68, 31
    s_lshl_b32 s19, s68, 16
    s_add_u32 s19, s19, s69
    buffer_load_dwordx4 v[236:239], v17, s[60:63], s19 offen
    s_add_u32 s68, s68, 1
    s_and_b32 s68, s68, 31
    s_lshl_b32 s19, s68, 16
    s_add_u32 s19, s19, s69
    buffer_load_dwordx4 v[240:243], v17, s[60:63], s19 offen
    s_add_u32 s68, s68, 1
    s_and_b32 s68, s68, 31
    s_lshl_b32 s19, s68, 16
    s_add_u32 s19, s19, s69
    buffer_load_dwordx4 v[244:247], v17, s[60:63], s19 offen
    s_add_u32 s68, s68, 1
    s_and_b32 s68, s68, 31
    s_lshl_b32 s19, s68, 16
    s_add_u32 s19, s19, s69
    buffer_load_dwordx4 v[248:251], v17, s[60:63], s19 offen
    s_add_u32 s68, s68, 1
    s_and_b32 s68, s68, 31
    s_lshl_b32 s19, s68, 16
    s_add_u32 s19, s19, s69
    buffer_load_dwordx4 v[252:255], v17, s[60:63], s19 offen
    s_add_u32 s68, s68, 1
    s_and_b32 s68, s68, 31
    s_waitcnt vmcnt(8)
L_fw15:
    ds_read_b32 v29, v36 offset:160
    s_waitcnt lgkmcnt(0)
    v_cmp_ne_u32 vcc, v29, v37
    s_cbranch_vccz L_fk16
    s_add_u32 s79, s79, 1
    s_cmp_lt_u32 s79, 32768
    s_cbranch_scc1 L_fw15
L_fk16:
    ds_write_b128 v22, v[192:195] offset:0
    ds_write_b128 v22, v[196:199] offset:4096
    ds_write_b128 v22, v[200:203] offset:8192
    ds_write_b128 v22, v[204:207] offset:12288
    ds_write_b128 v22, v[208:211] offset:16384
    ds_write_b128 v22, v[212:215] offset:20480
    ds_write_b128 v22, v[216:219] offset:24576
    ds_write_b128 v22, v[220:223] offset:28672
    s_waitcnt vmcnt(0)
    ds_write_b128 v22, v[224:227] offset:32768
    ds_write_b128 v22, v[228:231] offset:36864
    ds_write_b128 v22, v[232:235] offset:40960
    ds_write_b128 v22, v[236:239] offset:45056
    ds_write_b128 v22, v[240:243] offset:49152
    ds_write_b128 v22, v[244:247] offset:53248
    ds_write_b128 v22, v[248:251] offset:57344
    ds_write_b128 v22, v[252:255] offset:61440
    s_lshl_b64 exec, 1, s17
    ds_write_b32 v36, v37 offset:208
    s_mov_b64 exec, -1
L_fw17:
    ds_read_b32 v29, v36 offset:192
    s_waitcnt lgkmcnt(0)
    v_cmp_ne_u32 vcc, v29, v37
    s_cbranch_vccz L_fk18
    s_add_u32 s79, s79, 1
    s_cmp_lt_u32 s79, 32768
    s_cbranch_scc1 L_fw17
L_fk18:
    buffer_load_dwordx4 v[164:167], v16, s[56:59], s74 offen nt
    s_add_u32 s74, s74, 8192
    buffer_load_dwordx4 v[168:171], v16, s[56:59], s74 offen nt
    s_add_u32 s74, s74, 8192
    buffer_load_dwordx4 v[172:175], v16, s[56:59], s74 offen nt
    s_add_u32 s74, s74, 8192
    buffer_load_dwordx4 v[176:179], v16, s[56:59], s74 offen nt
    s_add_u32 s74, s74, 8192
    buffer_load_dwordx4 v[180:183], v16, s[56:59], s74 offen nt
    s_add_u32 s74, s74, 8192
    buffer_load_dwordx4 v[184:187], v16, s[56:59], s74 offen nt
    s_add_u32 s74, s74, 8192
    buffer_load_dwordx4 v[188:191], v16, s[56:59], s74 offen nt
    s_add_u32 s74, s74, 8192
    s_waitcnt vmcnt(23)
L_gp19:
    v_xor_b32 v72, s80, v72
    v_xor_b32 v73, s81, v73
    v_xor_b32 v74, s82, v74
    v_xor_b32 v75, s83, v75
    v_xor_b32 v76, s80, v76
    v_xor_b32 v77, s81, v77
    v_xor_b32 v78, s82, v78
    v_xor_b32 v79, s83, v79
    v_or3_b32 v80, v72, v73, v74
    v_or3_b32 v81, v75, v76, v77
    v_or3_b32 v80, v80, v78, v79
    v_or_b32 v80, v80, v81
    v_and_b32 v80, v80, v23
    v_cmp_ne_u32 vcc, 0, v80
    s_cbranch_vccz L_gk20
    buffer_load_dwordx4 v[72:75], v26, s[32:35], s75 offen sc1
    buffer_load_dwordx4 v[76:79], v26, s[32:35], s76 offen sc1
    s_waitcnt vmcnt(0)
    s_add_u32 s79, s79, 1
    s_cmp_lt_u32 s79, 32768
    s_cbranch_scc1 L_gp19
L_gk20:
    s_waitcnt vmcnt(0)
    v_permlane32_swap_b32 v72, v74
    v_permlane32_swap_b32 v73, v75
    v_permlane32_swap_b32 v76, v78
    v_permlane32_swap_b32 v77, v79
    v_add_f32 v72, v72, v74
    v_add_f32 v73, v73, v75
    v_add_f32 v76, v76, v78
    v_add_f32 v77, v77, v79
    v_permlane16_swap_b32 v72, v73
    s_lshl_b32 s19, s17, 9
    v_permlane16_swap_b32 v76, v77
    v_add_f32 v72, v72, v73
    v_add_f32 v76, v76, v77
    s_add_u32 s19, s19, 30720
    v_add_f32_dpp v72, v72, v72 row_ror:8 row_mask:0xf bank_mask:0xf
    v_add_f32_dpp v76, v76, v76 row_ror:8 row_mask:0xf bank_mask:0xf
    v_add_u32 v26, s19, v3
    v_cvt_pk_bf16_f32 v72, v72, v76
    v_and_b32 v76, 0xffff0000, v72
    v_lshlrev_b32 v72, 16, v72
    v_mul_f32 v73, 0xbfb8aa3b, v72
    v_exp_f32 v73, v73
    s_nop 0
    v_add_f32 v73, 1.0, v73
    v_rcp_f32 v73, v73
    s_nop 0
    v_mul_f32 v73, v73, v72
    v_cvt_pk_bf16_f32 v73, v73, v73
    v_lshlrev_b32 v73, 16, v73
    v_mul_f32 v73, v73, v76
    v_cvt_pk_bf16_f32 v27, v73, v73
    s_nop 1
    v_and_b32_dpp v76, v27, v4 row_newbcast:0 row_mask:0xf bank_mask:0xf
    v_and_b32_dpp v77, v27, v5 row_newbcast:0 row_mask:0xf bank_mask:0xf
    v_and_b32_dpp v78, v27, v6 row_newbcast:0 row_mask:0xf bank_mask:0xf
    v_and_b32_dpp v79, v27, v7 row_newbcast:0 row_mask:0xf bank_mask:0xf
    v_and_b32_dpp v80, v27, v4 row_newbcast:1 row_mask:0xf bank_mask:0xf
    v_and_b32_dpp v81, v27, v5 row_newbcast:1 row_mask:0xf bank_mask:0xf
    v_mfma_f32_16x16x32_bf16 v[88:91], v[76:79], v[164:167], 0
    v_and_b32_dpp v82, v27, v6 row_newbcast:1 row_mask:0xf bank_mask:0xf
    v_and_b32_dpp v83, v27, v7 row_newbcast:1 row_mask:0xf bank_mask:0xf
    v_and_b32_dpp v84, v27, v4 row_newbcast:2 row_mask:0xf bank_mask:0xf
    v_and_b32_dpp v85, v27, v5 row_newbcast:2 row_mask:0xf bank_mask:0xf
    v_mfma_f32_16x16x32_bf16 v[88:91], v[80:83], v[168:171], v[88:91]
    v_and_b32_dpp v86, v27, v6 row_newbcast:2 row_mask:0xf bank_mask:0xf
    v_and_b32_dpp v87, v27, v7 row_newbcast:2 row_mask:0xf bank_mask:0xf
    v_and_b32_dpp v92, v27, v4 row_newbcast:3 row_mask:0xf bank_mask:0xf
    v_and_b32_dpp v93, v27, v5 row_newbcast:3 row_mask:0xf bank_mask:0xf
    v_mfma_f32_16x16x32_bf16 v[88:91], v[84:87], v[172:175], v[88:91]
    v_and_b32_dpp v94, v27, v6 row_newbcast:3 row_mask:0xf bank_mask:0xf
    v_and_b32_dpp v95, v27, v7 row_newbcast:3 row_mask:0xf bank_mask:0xf
    v_and_b32_dpp v76, v27, v4 row_newbcast:4 row_mask:0xf bank_mask:0xf
    v_and_b32_dpp v77, v27, v5 row_newbcast:4 row_mask:0xf bank_mask:0xf
    v_mfma_f32_16x16x32_bf16 v[88:91], v[92:95], v[176:179], v[88:91]
    v_and_b32_dpp v78, v27, v6 row_newbcast:4 row_mask:0xf bank_mask:0xf
    v_and_b32_dpp v79, v27, v7 row_newbcast:4 row_mask:0xf bank_mask:0xf
    v_and_b32_dpp v80, v27, v4 row_newbcast:5 row_mask:0xf bank_mask:0xf
    v_and_b32_dpp v81, v27, v5 row_newbcast:5 row_mask:0xf bank_mask:0xf
    v_mfma_f32_16x16x32_bf16 v[88:91], v[76:79], v[180:183], v[88:91]
    v_and_b32_dpp v82, v27, v6 row_newbcast:5 row_mask:0xf bank_mask:0xf
    v_and_b32_dpp v83, v27, v7 row_newbcast:5 row_mask:0xf bank_mask:0xf
    v_and_b32_dpp v84, v27, v4 row_newbcast:6 row_mask:0xf bank_mask:0xf
    v_and_b32_dpp v85, v27, v5 row_newbcast:6 row_mask:0xf bank_mask:0xf
    v_mfma_f32_16x16x32_bf16 v[88:91], v[80:83], v[184:187], v[88:91]
    v_and_b32_dpp v86, v27, v6 row_newbcast:6 row_mask:0xf bank_mask:0xf
    v_and_b32_dpp v87, v27, v7 row_newbcast:6 row_mask:0xf bank_mask:0xf
    s_nop 1
    v_mfma_f32_16x16x32_bf16 v[88:91], v[84:87], v[188:191], v[88:91]
    s_mov_b32 exec_hi, 0
    s_nop 6
    ds_write_b128 v26, v[88:91]
    s_mov_b64 exec, 1
    ds_add_rtn_u32 v29, v13, v28 offset:48
    s_mov_b64 exec, -1
    s_waitcnt lgkmcnt(0)
    v_readfirstlane_b32 s19, v29
    s_nop 1
    s_cmp_lg_u32 s19, 3
    s_cbranch_scc1 L_ys21
    ds_read_b128 v[72:75], v3 offset:30720
    ds_read_b128 v[76:79], v3 offset:31232
    ds_read_b128 v[80:83], v3 offset:31744
    ds_read_b128 v[84:87], v3 offset:32256
    s_waitcnt lgkmcnt(0)
    v_pk_add_f32 v[72:73], v[72:73], v[76:77]
    v_pk_add_f32 v[74:75], v[74:75], v[78:79]
    v_pk_add_f32 v[80:81], v[80:81], v[84:85]
    v_pk_add_f32 v[82:83], v[82:83], v[86:87]
    v_pk_add_f32 v[72:73], v[72:73], v[80:81]
    v_pk_add_f32 v[74:75], v[74:75], v[82:83]
    v_bfi_b32 v72, v23, s80, v72
    v_bfi_b32 v73, v23, s81, v73
    v_bfi_b32 v74, v23, s82, v74
    v_bfi_b32 v75, v23, s83, v75
    v_lshlrev_b32 v26, 5, v8
    v_lshl_add_u32 v26, v9, 4, v26
    s_lshl_b32 s19, s13, 12
    s_lshl_b32 s3, s12, 9
    s_add_u32 s19, s19, s3
    s_add_u32 s19, s19, 4718592
    s_mov_b32 exec_hi, 0
    buffer_store_dwordx4 v[72:75], v26, s[32:35], s19 offen sc1
    s_mov_b64 exec, -1
L_ys21:
    s_and_b32 s19, s12, 1
    s_lshl_b32 s19, s19, 1
    s_bfe_u32 s3, s12, 0x10001
    s_add_u32 s19, s19, s3
    s_lshl_b32 s19, s19, 2
    s_and_b32 s3, s13, 3
    s_add_u32 s19, s19, s3
    s_lshr_b32 s3, s72, 7
    s_xor_b32 s19, s19, s3
    s_or_b32 s19, s19, s17
    s_cmp_lg_u32 s19, 0
    s_cbranch_scc1 L_ldone
    v_lshlrev_b32 v26, 12, v9
    v_lshl_add_u32 v26, v8, 4, v26
    v_lshl_add_u32 v29, v8, 2, v9
    v_lshlrev_b32 v30, 1, v29
    v_lshlrev_b32 v29, 2, v29
    s_lshl_b32 s75, s67, 8
    s_add_u32 s75, s75, 4718592
    s_lshl_b32 s19, s72, 11
    s_lshl_b32 s3, s67, 7
    s_add_u32 s19, s19, s3
    s_lshr_b32 s76, s72, 1
    s_lshl_b32 s76, s76, 3
    s_add_u32 s76, s76, 4472832
    buffer_load_ushort v31, v30, s[24:27], s19 offen
L_yp22:
    buffer_load_dwordx2 v[32:33], v13, s[32:35], s76 offen sc1
    s_mov_b32 s19, s75
    buffer_load_dwordx4 v[100:103], v26, s[32:35], s19 offen sc1
    s_add_u32 s19, s19, 16384
    buffer_load_dwordx4 v[104:107], v26, s[32:35], s19 offen sc1
    s_add_u32 s19, s19, 16384
    buffer_load_dwordx4 v[108:111], v26, s[32:35], s19 offen sc1
    s_add_u32 s19, s19, 16384
    buffer_load_dwordx4 v[112:115], v26, s[32:35], s19 offen sc1
    s_add_u32 s19, s19, 16384
    buffer_load_dwordx4 v[116:119], v26, s[32:35], s19 offen sc1
    s_add_u32 s19, s19, 16384
    buffer_load_dwordx4 v[120:123], v26, s[32:35], s19 offen sc1
    s_add_u32 s19, s19, 16384
    buffer_load_dwordx4 v[124:127], v26, s[32:35], s19 offen sc1
    s_add_u32 s19, s19, 16384
    buffer_load_dwordx4 v[128:131], v26, s[32:35], s19 offen sc1
    s_add_u32 s19, s19, 16384
    s_waitcnt vmcnt(0)
    v_xor_b32 v33, s78, v33
    v_xor_b32 v100, s80, v100
    v_xor_b32 v101, s81, v101
    v_xor_b32 v102, s82, v102
    v_xor_b32 v103, s83, v103
    v_xor_b32 v104, s80, v104
    v_xor_b32 v105, s81, v105
    v_xor_b32 v106, s82, v106
    v_xor_b32 v107, s83, v107
    v_xor_b32 v108, s80, v108
    v_xor_b32 v109, s81, v109
    v_xor_b32 v110, s82, v110
    v_xor_b32 v111, s83, v111
    v_xor_b32 v112, s80, v112
    v_xor_b32 v113, s81, v113
    v_xor_b32 v114, s82, v114
    v_xor_b32 v115, s83, v115
    v_xor_b32 v116, s80, v116
    v_xor_b32 v117, s81, v117
    v_xor_b32 v118, s82, v118
    v_xor_b32 v119, s83, v119
    v_xor_b32 v120, s80, v120
    v_xor_b32 v121, s81, v121
    v_xor_b32 v122, s82, v122
    v_xor_b32 v123, s83, v123
    v_xor_b32 v124, s80, v124
    v_xor_b32 v125, s81, v125
    v_xor_b32 v126, s82, v126
    v_xor_b32 v127, s83, v127
    v_xor_b32 v128, s80, v128
    v_xor_b32 v129, s81, v129
    v_xor_b32 v130, s82, v130
    v_xor_b32 v131, s83, v131
    v_or_b32 v34, v100, v101
    v_or3_b32 v34, v34, v102, v103
    v_or3_b32 v34, v34, v104, v105
    v_or3_b32 v34, v34, v106, v107
    v_or3_b32 v34, v34, v108, v109
    v_or3_b32 v34, v34, v110, v111
    v_or3_b32 v34, v34, v112, v113
    v_or3_b32 v34, v34, v114, v115
    v_or3_b32 v34, v34, v116, v117
    v_or3_b32 v34, v34, v118, v119
    v_or3_b32 v34, v34, v120, v121
    v_or3_b32 v34, v34, v122, v123
    v_or3_b32 v34, v34, v124, v125
    v_or3_b32 v34, v34, v126, v127
    v_or3_b32 v34, v34, v128, v129
    v_or3_b32 v34, v34, v130, v131
    v_and_b32 v34, v34, v23
    v_or_b32 v34, v34, v33
    v_cmp_ne_u32 vcc, 0, v34
    s_cbranch_vccz L_yk23
    s_add_u32 s79, s79, 1
    s_cmp_lt_u32 s79, 32768
    s_cbranch_scc1 L_yp22
L_yk23:
    v_pk_add_f32 v[100:101], v[100:101], v[116:117]
    v_pk_add_f32 v[102:103], v[102:103], v[118:119]
    v_pk_add_f32 v[104:105], v[104:105], v[120:121]
    v_pk_add_f32 v[106:107], v[106:107], v[122:123]
    v_pk_add_f32 v[108:109], v[108:109], v[124:125]
    v_pk_add_f32 v[110:111], v[110:111], v[126:127]
    v_pk_add_f32 v[112:113], v[112:113], v[128:129]
    v_pk_add_f32 v[114:115], v[114:115], v[130:131]
    v_pk_add_f32 v[100:101], v[100:101], v[108:109]
    v_pk_add_f32 v[102:103], v[102:103], v[110:111]
    v_pk_add_f32 v[104:105], v[104:105], v[112:113]
    v_pk_add_f32 v[106:107], v[106:107], v[114:115]
    v_pk_add_f32 v[100:101], v[100:101], v[104:105]
    v_pk_add_f32 v[102:103], v[102:103], v[106:107]
    s_nop 1
    v_permlane32_swap_b32 v100, v102
    v_permlane32_swap_b32 v101, v103
    v_add_f32 v100, v100, v102
    v_add_f32 v101, v101, v103
    s_nop 1
    v_permlane16_swap_b32 v100, v101
    v_add_f32 v100, v100, v101
    s_lshr_b32 s19, s71, 11
    s_lshl_b32 s19, s19, 16
    s_not_b32 s3, s19
    s_ashr_i32 s3, s3, 31
    s_or_b32 s3, s3, 0x80000000
    s_xor_b32 s19, s19, s3
    s_and_b32 s19, s19, 0xffff0000
    v_mov_b32 v34, s19
    v_mul_f32 v34, 0xbfb8aa3b, v34
    v_exp_f32 v34, v34
    s_nop 0
    v_add_f32 v34, 1.0, v34
    v_rcp_f32 v34, v34
    s_nop 0
    v_cvt_pk_bf16_f32 v34, v34, v100
    v_and_b32 v35, 0xffff0000, v34
    v_lshlrev_b32 v34, 16, v34
    v_mul_f32 v34, v34, v35
    v_cvt_pk_bf16_f32 v34, v34, v34
    v_lshlrev_b32 v34, 16, v34
    v_lshlrev_b32 v31, 16, v31
    v_add_f32 v34, v34, v31
    s_and_b32 s3, s72, 1
    s_lshl_b32 s3, s3, 4
    v_lshrrev_b32 v32, s3, v32
    v_lshlrev_b32 v32, 16, v32
    v_sub_f32 v32, 1.0, v32
    v_cvt_pk_bf16_f32 v34, v34, v32
    v_and_b32 v35, 0xffff0000, v34
    v_lshlrev_b32 v34, 16, v34
    v_mul_f32 v34, v34, v35
    v_cvt_pk_bf16_f32 v34, v34, v34
    v_lshlrev_b32 v34, 16, v34
    v_mov_b32 v28, 1
    ds_write_b32 v29, v34 offset:512
    ds_write_b32 v13, v37 offset:224
    s_waitcnt lgkmcnt(0)
L_ldone:
    s_endpgm
L_compute:
    s_mov_b64 s[32:33], s[98:99]
    s_mov_b32 s34, 16777216
    s_mov_b32 s35, 0x00020000
    s_mov_b64 s[36:37], s[96:97]
    s_mov_b32 s38, 256
    s_mov_b32 s39, 0x00020000
    s_mov_b64 s[40:41], s[8:9]
    s_mov_b32 s42, 65536
    s_mov_b32 s43, 0x00020000
    s_mov_b64 s[44:45], s[94:95]
    s_mov_b32 s46, 4194304
    s_mov_b32 s47, 0x00020000
    s_mov_b64 s[60:61], s[98:99]
    s_mov_b32 s62, 16777216
    s_mov_b32 s63, 0x00020000
    s_mov_b32 s79, 0
    s_lshr_b32 s17, s16, 1
    s_and_b32 s18, s16, 1
    v_mov_b32 v13, 0
    v_and_b32 v4, 15, v2
    v_lshrrev_b32 v9, 4, v2
    s_or_b32 s19, s2, s16
    s_cmp_lg_u32 s19, 0
    s_cbranch_scc1 L_tp24
    s_memrealtime s[20:21]
    s_waitcnt lgkmcnt(0)
    s_or_b32 s20, s20, 1
    v_mov_b32 v3, s20
    s_mov_b64 exec, 1
    buffer_store_dword v3, v13, s[36:39], 0 offen offset:4 sc1
    s_mov_b64 exec, -1
L_tp24:
    s_lshl_b32 s67, s15, 1
    s_add_u32 s67, s67, s18
    s_lshl_b32 s19, s67, 11
    v_lshlrev_b32 v5, 6, v4
    v_lshl_add_u32 v5, v9, 3, v5
    buffer_load_dwordx2 v[60:61], v5, s[40:43], s19 offen offset:0
    buffer_load_dwordx2 v[62:63], v5, s[40:43], s19 offen offset:32
    buffer_load_dwordx2 v[64:65], v5, s[40:43], s19 offen offset:1024
    buffer_load_dwordx2 v[66:67], v5, s[40:43], s19 offen offset:1056
    s_lshl_b32 s19, s17, 13
    v_lshlrev_b32 v6, 7, v4
    v_add_u32 v6, s19, v6
    v_bfe_u32 v7, v2, 1, 3
    v_add_u32 v8, 0, v9
    v_xor_b32 v8, v8, v7
    v_lshl_add_u32 v20, v8, 4, v6
    v_add_u32 v8, 4, v9
    v_xor_b32 v8, v8, v7
    v_lshl_add_u32 v21, v8, 4, v6
    v_add_u32 v22, 40960, v20
    v_add_u32 v23, 40960, v21
    v_add_u32 v24, 81920, v20
    v_add_u32 v25, 81920, v21
    v_add_u32 v26, 122880, v20
    v_add_u32 v27, 122880, v21
    v_lshlrev_b32 v6, 10, v9
    v_bfe_u32 v7, v2, 2, 2
    v_lshl_add_u32 v6, v7, 7, v6
    v_bfe_u32 v7, v2, 3, 1
    v_xor_b32 v7, s18, v7
    v_lshl_add_u32 v6, v7, 6, v6
    v_bfe_u32 v7, v2, 4, 1
    v_lshl_add_u32 v6, v7, 5, v6
    v_and_b32 v7, 3, v2
    v_lshl_add_u32 v6, v7, 3, v6
    v_add_u32 v36, 16384, v6
    v_xor_b32 v37, 32, v36
    v_add_u32 v38, 57344, v6
    v_xor_b32 v39, 32, v38
    v_add_u32 v40, 98304, v6
    v_xor_b32 v41, 32, v40
    v_add_u32 v42, 139264, v6
    v_xor_b32 v43, 32, v42
    v_lshrrev_b32 v5, 2, v4
    v_and_b32 v6, 1, v4
    v_lshlrev_b32 v6, 4, v6
    v_mov_b32 v7, 0x3f80
    v_lshlrev_b32 v7, v6, v7
    v_cmp_eq_u32 vcc, v5, v9
    s_nop 1
    v_cndmask_b32 v7, 0, v7, vcc
    v_and_b32 v6, 2, v4
    v_cmp_eq_u32 vcc, 0, v6
    s_nop 1
    v_cndmask_b32 v52, 0, v7, vcc
    v_cndmask_b32 v53, v7, v13, vcc
    v_mov_b32 v56, 0x3f803f80
    v_mov_b32 v57, 0x3f803f80
    v_mov_b32 v58, 0x3f803f80
    v_mov_b32 v59, 0x3f803f80
    v_lshlrev_b32 v3, 4, v2
    v_lshlrev_b32 v12, 4, v9
    v_lshrrev_b32 v11, 5, v2
    v_lshlrev_b32 v8, 9, v11
    v_and_b32 v19, 16, v12
    v_add_u32 v8, v8, v19
    v_lshlrev_b32 v11, 2, v11
    v_lshl_add_u32 v11, v4, 4, v11
    v_lshlrev_b32 v9, 10, v9
    v_lshl_add_u32 v9, v4, 4, v9
    v_lshlrev_b32 v10, 3, v2
    s_xor_b32 s3, s16, 2
    s_mul_i32 s19, s3, 6144
    s_add_u32 s19, s19, 2048
    v_add_u32 v4, s19, v3
    s_mul_i32 s19, s16, 6144
    s_add_u32 s19, s19, 2048
    v_add_u32 v5, s19, v3
    v_lshlrev_b32 v7, 2, v2
    s_lshl_b32 s19, s3, 8
    s_add_u32 s19, s19, 1024
    v_add_u32 v6, s19, v7
    s_lshl_b32 s19, s16, 8
    s_add_u32 s19, s19, 1024
    v_add_u32 v7, s19, v7
    v_mov_b32 v15, 0x3ff
    v_mov_b32 v18, 0x7fc17fc1
    s_lshl_b32 s19, s16, 2
    v_mov_b32 v1, s19
    v_mov_b32 v19, -1
    s_lshl_b32 s19, s15, 2
    s_lshr_b32 s3, s14, 2
    s_add_u32 s19, s19, s3
    s_and_b32 s3, s14, 1
    s_bfe_u32 s20, s14, 0x10001
    s_lshl_b32 s20, s20, 3
    s_lshl_b32 s64, s19, 1
    s_add_u32 s64, s64, s3
    s_lshl_b32 s64, s64, 2
    s_add_u32 s64, s64, s16
    s_lshl_b32 s64, s64, 8
    s_add_u32 s64, s64, s20
    s_add_u32 s64, s64, 4325376
    s_lshl_b32 s65, s19, 1
    s_add_u32 s65, s65, s3
    s_lshl_b32 s65, s65, 1
    s_add_u32 s65, s65, s17
    s_lshl_b32 s65, s65, 4
    s_add_u32 s65, s65, s20
    s_lshl_b32 s3, s18, 2
    s_add_u32 s65, s65, s3
    s_add_u32 s65, s65, 4456448
    s_mov_b32 s74, 0x3fb8aa3b
    s_mov_b32 s76, 0xbfb8aa3b
    s_mov_b32 s75, 0
    s_mov_b32 s77, 0
    s_mov_b32 s69, 0
    s_mov_b32 s71, 0
    s_cmp_lg_u32 s17, 0
    s_cselect_b32 s68, s74, s76
    s_cselect_b32 s70, s76, s74
    s_cselect_b64 s[72:73], -1, 0
    s_mov_b32 s66, 0
    s_lshl_b32 s19, s15, 4
    s_lshl_b32 s3, s18, 3
    s_add_u32 s19, s19, s3
    s_lshl_b32 s3, s17, 2
    s_add_u32 s19, s19, s3
    s_lshl_b32 s19, s19, 4
    s_add_u32 s19, s19, s14
    s_lshl_b32 s48, s19, 10
    s_lshl_b32 s49, s19, 5
    s_add_u32 s49, s49, 4194304
    s_lshl_b32 s19, s15, 4
    s_add_u32 s19, s19, s14
    s_lshl_b32 s50, s19, 6
    s_add_u32 s50, s50, s16
    s_lshl_b32 s50, s50, 8
    s_lshl_b32 s51, s19, 9
    s_add_u32 s51, s51, 4194304
    s_lshl_b32 s19, s14, 1
    s_add_u32 s19, s19, s17
    s_lshl_b32 s52, s19, 17
    s_lshl_b32 s3, s67, 10
    s_add_u32 s52, s52, s3
    s_add_u32 s52, s52, 8388608
    s_lshl_b32 s53, s19, 5
    s_add_u32 s53, s53, s67
    s_lshl_b32 s53, s53, 2
    s_add_u32 s53, s53, 4481024
    s_and_b32 s19, s12, 1
    s_lshl_b32 s19, s19, 1
    s_bfe_u32 s3, s12, 0x10001
    s_add_u32 s19, s19, s3
    s_lshl_b32 s19, s19, 2
    s_and_b32 s3, s13, 3
    s_add_u32 s19, s19, s3
    s_lshl_b32 s58, s19, 2
    s_add_u32 s58, s58, s16
    s_lshr_b32 s19, s12, 2
    s_lshl_b32 s19, s19, 3
    s_lshr_b32 s3, s13, 2
    s_add_u32 s19, s19, s3
    s_lshl_b32 s54, s58, 16
    s_lshl_b32 s3, s19, 7
    s_add_u32 s54, s54, s3
    s_add_u32 s55, s54, 32768
    s_lshr_b32 s56, s58, 1
    s_lshl_b32 s56, s56, 7
    s_add_u32 s56, s56, 4481024
    s_lshl_b32 s57, s58, 7
    s_add_u32 s57, s57, 4472832
    s_lshl_b32 s59, s67, 12
    s_add_u32 s59, s59, 4325376
    s_lshl_b32 s28, s67, 7
    s_add_u32 s28, s28, 4456448
    s_mov_b32 s29, 0
    v_lshrrev_b32 v19, 4, v2
    v_and_b32 v54, 15, v2
    v_lshlrev_b32 v54, 6, v54
    v_lshl_add_u32 v76, v19, 14, v54
    v_lshl_add_u32 v77, v19, 15, v54
    v_lshrrev_b32 v19, 1, v2
    v_and_b32 v54, 1, v2
    v_lshlrev_b32 v54, 6, v54
    v_lshl_add_u32 v78, v19, 11, v54
    v_lshlrev_b32 v79, 9, v2
    v_lshrrev_b32 v54, 1, v2
    v_lshlrev_b32 v54, 10, v54
    v_and_b32 v19, 1, v2
    v_lshl_add_u32 v54, v19, 7, v54
    v_add_u32 v54, s50, v54
    v_lshlrev_b32 v19, 7, v2
    v_add_u32 v55, s51, v19
    s_sub_u32 s3, s59, 4096
    v_add_u32 v19, s3, v19
    v_cmp_gt_u32 vcc, 32, v2
    s_nop 1
    v_cndmask_b32 v54, v19, v54, vcc
    v_mov_b32 v19, s28
    v_cmp_gt_u32 vcc, 4, v2
    s_nop 1
    v_cndmask_b32 v55, v19, v55, vcc
    v_mov_b32 v19, -1
    v_mov_b64 v[160:161], 0
    v_mov_b64 v[162:163], 0
    v_mov_b64 v[164:165], 0
    v_mov_b64 v[166:167], 0
    v_mov_b64 v[168:169], 0
    v_mov_b64 v[170:171], 0
    v_mov_b64 v[172:173], 0
    v_mov_b64 v[174:175], 0
    v_mov_b64 v[176:177], 0
    v_mov_b64 v[178:179], 0
    v_mov_b64 v[180:181], 0
    v_mov_b64 v[182:183], 0
    v_mov_b64 v[184:185], 0
    v_mov_b64 v[186:187], 0
    v_mov_b64 v[188:189], 0
    v_mov_b64 v[190:191], 0
    v_mov_b64 v[192:193], 0
    v_mov_b64 v[194:195], 0
    v_mov_b64 v[196:197], 0
    v_mov_b64 v[198:199], 0
    v_mov_b64 v[200:201], 0
    v_mov_b64 v[202:203], 0
    v_mov_b64 v[204:205], 0
    v_mov_b64 v[206:207], 0
    v_mov_b64 v[208:209], 0
    v_mov_b64 v[210:211], 0
    v_mov_b64 v[212:213], 0
    v_mov_b64 v[214:215], 0
    v_mov_b64 v[216:217], 0
    v_mov_b64 v[218:219], 0
    v_mov_b64 v[220:221], 0
    v_mov_b64 v[222:223], 0
    v_mov_b64 v[224:225], 0
    v_mov_b64 v[226:227], 0
    v_mov_b64 v[228:229], 0
    v_mov_b64 v[230:231], 0
    v_mov_b64 v[232:233], 0
    v_mov_b64 v[234:235], 0
    v_mov_b64 v[236:237], 0
    v_mov_b64 v[238:239], 0
    v_mov_b64 v[240:241], 0
    v_mov_b64 v[242:243], 0
    v_mov_b64 v[244:245], 0
    v_mov_b64 v[246:247], 0
    v_mov_b64 v[248:249], 0
    v_mov_b64 v[250:251], 0
    v_mov_b64 v[252:253], 0
    v_mov_b64 v[254:255], 0
    s_waitcnt vmcnt(4)
    s_barrier
    ds_read_b128 v[80:83], v20 offset:0
    ds_read_b64_tr_b16 v[96:97], v36 offset:0
    ds_read_b64_tr_b16 v[98:99], v36 offset:512
    ds_read_b128 v[84:87], v20 offset:2048
    ds_read_b128 v[88:91], v20 offset:4096
    ds_read_b128 v[92:95], v20 offset:6144
    ds_read_b64_tr_b16 v[100:101], v37 offset:0
    ds_read_b64_tr_b16 v[102:103], v37 offset:512
    ds_read_b64_tr_b16 v[104:105], v36 offset:8192
    ds_read_b64_tr_b16 v[106:107], v36 offset:8704
    ds_read_b64_tr_b16 v[108:109], v37 offset:8192
    ds_read_b64_tr_b16 v[110:111], v37 offset:8704
    ds_read_b64_tr_b16 v[112:113], v36 offset:16384
    ds_read_b64_tr_b16 v[114:115], v36 offset:16896
    ds_read_b64_tr_b16 v[116:117], v37 offset:16384
    ds_read_b64_tr_b16 v[118:119], v37 offset:16896
    s_mov_b32 exec_lo, 0xffff
    s_mov_b32 exec_hi, 0xffff
    buffer_store_dword v19, v11, s[32:35], s64 offen sc1
    s_lshl_b64 exec, 1, s16
    buffer_store_dword v19, v13, s[32:35], s65 offen sc1
    s_mov_b64 exec, -1
.p2align 7
L_loop:
    s_waitcnt lgkmcnt(10)
    v_mfma_f32_16x16x32_bf16 v[160:163], v[96:99], v[80:83], v[160:163]
    ds_read_b128 v[120:123], v21 offset:0
    v_mfma_f32_16x16x32_bf16 v[164:167], v[96:99], v[84:87], v[164:167]
    ds_read_b64_tr_b16 v[136:137], v36 offset:4096
    v_mfma_f32_16x16x32_bf16 v[168:171], v[96:99], v[88:91], v[168:171]
    ds_read_b64_tr_b16 v[138:139], v36 offset:4608
    v_mfma_f32_16x16x32_bf16 v[172:175], v[96:99], v[92:95], v[172:175]
    s_waitcnt lgkmcnt(11)
    v_mfma_f32_16x16x32_bf16 v[188:191], v[100:103], v[92:95], v[188:191]
    ds_read_b128 v[124:127], v21 offset:2048
    v_mfma_f32_16x16x32_bf16 v[184:187], v[100:103], v[88:91], v[184:187]
    ds_read_b128 v[128:131], v21 offset:4096
    v_mfma_f32_16x16x32_bf16 v[180:183], v[100:103], v[84:87], v[180:183]
    ds_read_b128 v[132:135], v21 offset:6144
    v_mfma_f32_16x16x32_bf16 v[176:179], v[100:103], v[80:83], v[176:179]
    s_waitcnt lgkmcnt(12)
    v_mfma_f32_16x16x32_bf16 v[192:195], v[104:107], v[80:83], v[192:195]
    ds_read_b64_tr_b16 v[140:141], v37 offset:4096
    v_mfma_f32_16x16x32_bf16 v[196:199], v[104:107], v[84:87], v[196:199]
    ds_read_b64_tr_b16 v[142:143], v37 offset:4608
    v_mfma_f32_16x16x32_bf16 v[200:203], v[104:107], v[88:91], v[200:203]
    ds_read_b64_tr_b16 v[144:145], v36 offset:12288
    v_mfma_f32_16x16x32_bf16 v[204:207], v[104:107], v[92:95], v[204:207]
    s_waitcnt lgkmcnt(13)
    v_mfma_f32_16x16x32_bf16 v[220:223], v[108:111], v[92:95], v[220:223]
    ds_read_b64_tr_b16 v[146:147], v36 offset:12800
    v_mfma_f32_16x16x32_bf16 v[216:219], v[108:111], v[88:91], v[216:219]
    ds_read_b64_tr_b16 v[148:149], v37 offset:12288
    v_mfma_f32_16x16x32_bf16 v[212:215], v[108:111], v[84:87], v[212:215]
    ds_read_b64_tr_b16 v[150:151], v37 offset:12800
    v_mfma_f32_16x16x32_bf16 v[208:211], v[108:111], v[80:83], v[208:211]
    s_waitcnt lgkmcnt(14)
    v_mfma_f32_16x16x32_bf16 v[224:227], v[80:83], v[112:115], v[224:227]
    ds_read_b64_tr_b16 v[152:153], v36 offset:20480
    v_mfma_f32_16x16x32_bf16 v[228:231], v[84:87], v[112:115], v[228:231]
    ds_read_b64_tr_b16 v[154:155], v36 offset:20992
    v_mfma_f32_16x16x32_bf16 v[232:235], v[88:91], v[112:115], v[232:235]
    ds_read_b64_tr_b16 v[156:157], v37 offset:20480
    v_mfma_f32_16x16x32_bf16 v[236:239], v[92:95], v[112:115], v[236:239]
    s_waitcnt lgkmcnt(15)
    v_mfma_f32_16x16x32_bf16 v[252:255], v[92:95], v[116:119], v[252:255]
    ds_read_b64_tr_b16 v[158:159], v37 offset:20992
    v_mfma_f32_16x16x32_bf16 v[248:251], v[88:91], v[116:119], v[248:251]
    v_mfma_f32_16x16x32_bf16 v[244:247], v[84:87], v[116:119], v[244:247]
    v_mfma_f32_16x16x32_bf16 v[240:243], v[80:83], v[116:119], v[240:243]
    s_waitcnt lgkmcnt(10)
    v_mfma_f32_16x16x32_bf16 v[160:163], v[136:139], v[120:123], v[160:163]
    v_mfma_f32_16x16x32_bf16 v[164:167], v[136:139], v[124:127], v[164:167]
    v_mfma_f32_16x16x32_bf16 v[168:171], v[136:139], v[128:131], v[168:171]
    v_mfma_f32_16x16x32_bf16 v[172:175], v[136:139], v[132:135], v[172:175]
    s_waitcnt lgkmcnt(0)
    s_barrier
    ds_read_b128 v[80:83], v22 offset:0
    v_mfma_f32_16x16x32_bf16 v[188:191], v[140:143], v[132:135], v[188:191]
    ds_read_b64_tr_b16 v[96:97], v38 offset:0
    v_mfma_f32_16x16x32_bf16 v[184:187], v[140:143], v[128:131], v[184:187]
    ds_read_b64_tr_b16 v[98:99], v38 offset:512
    v_mfma_f32_16x16x32_bf16 v[180:183], v[140:143], v[124:127], v[180:183]
    ds_read_b128 v[84:87], v22 offset:2048
    v_mfma_f32_16x16x32_bf16 v[176:179], v[140:143], v[120:123], v[176:179]
    ds_read_b128 v[88:91], v22 offset:4096
    v_mfma_f32_16x16x32_bf16 v[192:195], v[144:147], v[120:123], v[192:195]
    ds_read_b128 v[92:95], v22 offset:6144
    v_mfma_f32_16x16x32_bf16 v[196:199], v[144:147], v[124:127], v[196:199]
    ds_read_b64_tr_b16 v[100:101], v39 offset:0
    v_mfma_f32_16x16x32_bf16 v[200:203], v[144:147], v[128:131], v[200:203]
    ds_read_b64_tr_b16 v[102:103], v39 offset:512
    v_mfma_f32_16x16x32_bf16 v[204:207], v[144:147], v[132:135], v[204:207]
    ds_read_b64_tr_b16 v[104:105], v38 offset:8192
    v_mfma_f32_16x16x32_bf16 v[220:223], v[148:151], v[132:135], v[220:223]
    ds_read_b64_tr_b16 v[106:107], v38 offset:8704
    v_mfma_f32_16x16x32_bf16 v[216:219], v[148:151], v[128:131], v[216:219]
    ds_read_b64_tr_b16 v[108:109], v39 offset:8192
    v_mfma_f32_16x16x32_bf16 v[212:215], v[148:151], v[124:127], v[212:215]
    ds_read_b64_tr_b16 v[110:111], v39 offset:8704
    v_mfma_f32_16x16x32_bf16 v[208:211], v[148:151], v[120:123], v[208:211]
    ds_read_b64_tr_b16 v[112:113], v38 offset:16384
    v_mfma_f32_16x16x32_bf16 v[224:227], v[120:123], v[152:155], v[224:227]
    ds_read_b64_tr_b16 v[114:115], v38 offset:16896
    v_mfma_f32_16x16x32_bf16 v[228:231], v[124:127], v[152:155], v[228:231]
    ds_read_b64_tr_b16 v[116:117], v39 offset:16384
    v_mfma_f32_16x16x32_bf16 v[232:235], v[128:131], v[152:155], v[232:235]
    ds_read_b64_tr_b16 v[118:119], v39 offset:16896
    v_mfma_f32_16x16x32_bf16 v[236:239], v[132:135], v[152:155], v[236:239]
    v_mfma_f32_16x16x32_bf16 v[252:255], v[132:135], v[156:159], v[252:255]
    v_mfma_f32_16x16x32_bf16 v[248:251], v[128:131], v[156:159], v[248:251]
    v_mfma_f32_16x16x32_bf16 v[244:247], v[124:127], v[156:159], v[244:247]
    v_mfma_f32_16x16x32_bf16 v[240:243], v[120:123], v[156:159], v[240:243]
    s_cmp_eq_u32 s66, 2
    s_cbranch_scc1 L_mid
L_midret:
    s_waitcnt lgkmcnt(10)
    v_mfma_f32_16x16x32_bf16 v[160:163], v[96:99], v[80:83], v[160:163]
    ds_read_b128 v[120:123], v23 offset:0
    v_mfma_f32_16x16x32_bf16 v[164:167], v[96:99], v[84:87], v[164:167]
    ds_read_b64_tr_b16 v[136:137], v38 offset:4096
    v_mfma_f32_16x16x32_bf16 v[168:171], v[96:99], v[88:91], v[168:171]
    ds_read_b64_tr_b16 v[138:139], v38 offset:4608
    v_mfma_f32_16x16x32_bf16 v[172:175], v[96:99], v[92:95], v[172:175]
    s_waitcnt lgkmcnt(11)
    v_mfma_f32_16x16x32_bf16 v[188:191], v[100:103], v[92:95], v[188:191]
    ds_read_b128 v[124:127], v23 offset:2048
    v_mfma_f32_16x16x32_bf16 v[184:187], v[100:103], v[88:91], v[184:187]
    ds_read_b128 v[128:131], v23 offset:4096
    v_mfma_f32_16x16x32_bf16 v[180:183], v[100:103], v[84:87], v[180:183]
    ds_read_b128 v[132:135], v23 offset:6144
    v_mfma_f32_16x16x32_bf16 v[176:179], v[100:103], v[80:83], v[176:179]
    s_waitcnt lgkmcnt(12)
    v_mfma_f32_16x16x32_bf16 v[192:195], v[104:107], v[80:83], v[192:195]
    ds_read_b64_tr_b16 v[140:141], v39 offset:4096
    v_mfma_f32_16x16x32_bf16 v[196:199], v[104:107], v[84:87], v[196:199]
    ds_read_b64_tr_b16 v[142:143], v39 offset:4608
    v_mfma_f32_16x16x32_bf16 v[200:203], v[104:107], v[88:91], v[200:203]
    ds_read_b64_tr_b16 v[144:145], v38 offset:12288
    v_mfma_f32_16x16x32_bf16 v[204:207], v[104:107], v[92:95], v[204:207]
    s_waitcnt lgkmcnt(13)
    v_mfma_f32_16x16x32_bf16 v[220:223], v[108:111], v[92:95], v[220:223]
    ds_read_b64_tr_b16 v[146:147], v38 offset:12800
    v_mfma_f32_16x16x32_bf16 v[216:219], v[108:111], v[88:91], v[216:219]
    ds_read_b64_tr_b16 v[148:149], v39 offset:12288
    v_mfma_f32_16x16x32_bf16 v[212:215], v[108:111], v[84:87], v[212:215]
    ds_read_b64_tr_b16 v[150:151], v39 offset:12800
    v_mfma_f32_16x16x32_bf16 v[208:211], v[108:111], v[80:83], v[208:211]
    s_waitcnt lgkmcnt(14)
    v_mfma_f32_16x16x32_bf16 v[224:227], v[80:83], v[112:115], v[224:227]
    ds_read_b64_tr_b16 v[152:153], v38 offset:20480
    v_mfma_f32_16x16x32_bf16 v[228:231], v[84:87], v[112:115], v[228:231]
    ds_read_b64_tr_b16 v[154:155], v38 offset:20992
    v_mfma_f32_16x16x32_bf16 v[232:235], v[88:91], v[112:115], v[232:235]
    ds_read_b64_tr_b16 v[156:157], v39 offset:20480
    v_mfma_f32_16x16x32_bf16 v[236:239], v[92:95], v[112:115], v[236:239]
    s_waitcnt lgkmcnt(15)
    v_mfma_f32_16x16x32_bf16 v[252:255], v[92:95], v[116:119], v[252:255]
    ds_read_b64_tr_b16 v[158:159], v39 offset:20992
    v_mfma_f32_16x16x32_bf16 v[248:251], v[88:91], v[116:119], v[248:251]
    v_mfma_f32_16x16x32_bf16 v[244:247], v[84:87], v[116:119], v[244:247]
    v_mfma_f32_16x16x32_bf16 v[240:243], v[80:83], v[116:119], v[240:243]
    s_waitcnt lgkmcnt(10)
    v_mfma_f32_16x16x32_bf16 v[160:163], v[136:139], v[120:123], v[160:163]
    v_mfma_f32_16x16x32_bf16 v[164:167], v[136:139], v[124:127], v[164:167]
    v_mfma_f32_16x16x32_bf16 v[168:171], v[136:139], v[128:131], v[168:171]
    v_mfma_f32_16x16x32_bf16 v[172:175], v[136:139], v[132:135], v[172:175]
    s_cmp_eq_u32 s66, 3
    s_waitcnt lgkmcnt(0)
    s_barrier
L_nob:
    ds_read_b128 v[80:83], v24 offset:0
    v_mfma_f32_16x16x32_bf16 v[188:191], v[140:143], v[132:135], v[188:191]
    ds_read_b64_tr_b16 v[96:97], v40 offset:0
    v_mfma_f32_16x16x32_bf16 v[184:187], v[140:143], v[128:131], v[184:187]
    ds_read_b64_tr_b16 v[98:99], v40 offset:512
    v_mfma_f32_16x16x32_bf16 v[180:183], v[140:143], v[124:127], v[180:183]
    ds_read_b128 v[84:87], v24 offset:2048
    v_mfma_f32_16x16x32_bf16 v[176:179], v[140:143], v[120:123], v[176:179]
    ds_read_b128 v[88:91], v24 offset:4096
    v_mfma_f32_16x16x32_bf16 v[192:195], v[144:147], v[120:123], v[192:195]
    ds_read_b128 v[92:95], v24 offset:6144
    v_mfma_f32_16x16x32_bf16 v[196:199], v[144:147], v[124:127], v[196:199]
    ds_read_b64_tr_b16 v[100:101], v41 offset:0
    v_mfma_f32_16x16x32_bf16 v[200:203], v[144:147], v[128:131], v[200:203]
    ds_read_b64_tr_b16 v[102:103], v41 offset:512
    v_mfma_f32_16x16x32_bf16 v[204:207], v[144:147], v[132:135], v[204:207]
    ds_read_b64_tr_b16 v[104:105], v40 offset:8192
    v_mfma_f32_16x16x32_bf16 v[220:223], v[148:151], v[132:135], v[220:223]
    ds_read_b64_tr_b16 v[106:107], v40 offset:8704
    v_mfma_f32_16x16x32_bf16 v[216:219], v[148:151], v[128:131], v[216:219]
    ds_read_b64_tr_b16 v[108:109], v41 offset:8192
    v_mfma_f32_16x16x32_bf16 v[212:215], v[148:151], v[124:127], v[212:215]
    ds_read_b64_tr_b16 v[110:111], v41 offset:8704
    v_mfma_f32_16x16x32_bf16 v[208:211], v[148:151], v[120:123], v[208:211]
    ds_read_b64_tr_b16 v[112:113], v40 offset:16384
    v_mfma_f32_16x16x32_bf16 v[224:227], v[120:123], v[152:155], v[224:227]
    ds_read_b64_tr_b16 v[114:115], v40 offset:16896
    v_mfma_f32_16x16x32_bf16 v[228:231], v[124:127], v[152:155], v[228:231]
    ds_read_b64_tr_b16 v[116:117], v41 offset:16384
    v_mfma_f32_16x16x32_bf16 v[232:235], v[128:131], v[152:155], v[232:235]
    ds_read_b64_tr_b16 v[118:119], v41 offset:16896
    v_mfma_f32_16x16x32_bf16 v[236:239], v[132:135], v[152:155], v[236:239]
    v_mfma_f32_16x16x32_bf16 v[252:255], v[132:135], v[156:159], v[252:255]
    v_mfma_f32_16x16x32_bf16 v[248:251], v[128:131], v[156:159], v[248:251]
    v_mfma_f32_16x16x32_bf16 v[244:247], v[124:127], v[156:159], v[244:247]
    v_mfma_f32_16x16x32_bf16 v[240:243], v[120:123], v[156:159], v[240:243]
    s_waitcnt lgkmcnt(10)
    v_mfma_f32_16x16x32_bf16 v[160:163], v[96:99], v[80:83], v[160:163]
    ds_read_b128 v[120:123], v25 offset:0
    v_mfma_f32_16x16x32_bf16 v[164:167], v[96:99], v[84:87], v[164:167]
    ds_read_b64_tr_b16 v[136:137], v40 offset:4096
    v_mfma_f32_16x16x32_bf16 v[168:171], v[96:99], v[88:91], v[168:171]
    ds_read_b64_tr_b16 v[138:139], v40 offset:4608
    v_mfma_f32_16x16x32_bf16 v[172:175], v[96:99], v[92:95], v[172:175]
    s_waitcnt lgkmcnt(11)
    v_mfma_f32_16x16x32_bf16 v[188:191], v[100:103], v[92:95], v[188:191]
    ds_read_b128 v[124:127], v25 offset:2048
    v_mfma_f32_16x16x32_bf16 v[184:187], v[100:103], v[88:91], v[184:187]
    ds_read_b128 v[128:131], v25 offset:4096
    v_mfma_f32_16x16x32_bf16 v[180:183], v[100:103], v[84:87], v[180:183]
    ds_read_b128 v[132:135], v25 offset:6144
    v_mfma_f32_16x16x32_bf16 v[176:179], v[100:103], v[80:83], v[176:179]
    s_waitcnt lgkmcnt(12)
    v_mfma_f32_16x16x32_bf16 v[192:195], v[104:107], v[80:83], v[192:195]
    ds_read_b64_tr_b16 v[140:141], v41 offset:4096
    v_mfma_f32_16x16x32_bf16 v[196:199], v[104:107], v[84:87], v[196:199]
    ds_read_b64_tr_b16 v[142:143], v41 offset:4608
    v_mfma_f32_16x16x32_bf16 v[200:203], v[104:107], v[88:91], v[200:203]
    ds_read_b64_tr_b16 v[144:145], v40 offset:12288
    v_mfma_f32_16x16x32_bf16 v[204:207], v[104:107], v[92:95], v[204:207]
    s_waitcnt lgkmcnt(13)
    v_mfma_f32_16x16x32_bf16 v[220:223], v[108:111], v[92:95], v[220:223]
    ds_read_b64_tr_b16 v[146:147], v40 offset:12800
    v_mfma_f32_16x16x32_bf16 v[216:219], v[108:111], v[88:91], v[216:219]
    ds_read_b64_tr_b16 v[148:149], v41 offset:12288
    v_mfma_f32_16x16x32_bf16 v[212:215], v[108:111], v[84:87], v[212:215]
    ds_read_b64_tr_b16 v[150:151], v41 offset:12800
    v_mfma_f32_16x16x32_bf16 v[208:211], v[108:111], v[80:83], v[208:211]
    s_waitcnt lgkmcnt(14)
    v_mfma_f32_16x16x32_bf16 v[224:227], v[80:83], v[112:115], v[224:227]
    ds_read_b64_tr_b16 v[152:153], v40 offset:20480
    v_mfma_f32_16x16x32_bf16 v[228:231], v[84:87], v[112:115], v[228:231]
    ds_read_b64_tr_b16 v[154:155], v40 offset:20992
    v_mfma_f32_16x16x32_bf16 v[232:235], v[88:91], v[112:115], v[232:235]
    ds_read_b64_tr_b16 v[156:157], v41 offset:20480
    v_mfma_f32_16x16x32_bf16 v[236:239], v[92:95], v[112:115], v[236:239]
    s_waitcnt lgkmcnt(15)
    v_mfma_f32_16x16x32_bf16 v[252:255], v[92:95], v[116:119], v[252:255]
    ds_read_b64_tr_b16 v[158:159], v41 offset:20992
    v_mfma_f32_16x16x32_bf16 v[248:251], v[88:91], v[116:119], v[248:251]
    v_mfma_f32_16x16x32_bf16 v[244:247], v[84:87], v[116:119], v[244:247]
    v_mfma_f32_16x16x32_bf16 v[240:243], v[80:83], v[116:119], v[240:243]
    s_waitcnt lgkmcnt(10)
    v_mfma_f32_16x16x32_bf16 v[160:163], v[136:139], v[120:123], v[160:163]
    v_mfma_f32_16x16x32_bf16 v[164:167], v[136:139], v[124:127], v[164:167]
    v_mfma_f32_16x16x32_bf16 v[168:171], v[136:139], v[128:131], v[168:171]
    v_mfma_f32_16x16x32_bf16 v[172:175], v[136:139], v[132:135], v[172:175]
    s_cmp_eq_u32 s66, 3
    s_waitcnt lgkmcnt(0)
    s_cbranch_scc1 L_last
    s_barrier
    ds_read_b128 v[80:83], v26 offset:0
    v_mfma_f32_16x16x32_bf16 v[188:191], v[140:143], v[132:135], v[188:191]
    ds_read_b64_tr_b16 v[96:97], v42 offset:0
    v_mfma_f32_16x16x32_bf16 v[184:187], v[140:143], v[128:131], v[184:187]
    ds_read_b64_tr_b16 v[98:99], v42 offset:512
    v_mfma_f32_16x16x32_bf16 v[180:183], v[140:143], v[124:127], v[180:183]
    ds_read_b128 v[84:87], v26 offset:2048
    v_mfma_f32_16x16x32_bf16 v[176:179], v[140:143], v[120:123], v[176:179]
    ds_read_b128 v[88:91], v26 offset:4096
    v_mfma_f32_16x16x32_bf16 v[192:195], v[144:147], v[120:123], v[192:195]
    ds_read_b128 v[92:95], v26 offset:6144
    v_mfma_f32_16x16x32_bf16 v[196:199], v[144:147], v[124:127], v[196:199]
    ds_read_b64_tr_b16 v[100:101], v43 offset:0
    v_mfma_f32_16x16x32_bf16 v[200:203], v[144:147], v[128:131], v[200:203]
    ds_read_b64_tr_b16 v[102:103], v43 offset:512
    v_mfma_f32_16x16x32_bf16 v[204:207], v[144:147], v[132:135], v[204:207]
    ds_read_b64_tr_b16 v[104:105], v42 offset:8192
    v_mfma_f32_16x16x32_bf16 v[220:223], v[148:151], v[132:135], v[220:223]
    ds_read_b64_tr_b16 v[106:107], v42 offset:8704
    v_mfma_f32_16x16x32_bf16 v[216:219], v[148:151], v[128:131], v[216:219]
    ds_read_b64_tr_b16 v[108:109], v43 offset:8192
    v_mfma_f32_16x16x32_bf16 v[212:215], v[148:151], v[124:127], v[212:215]
    ds_read_b64_tr_b16 v[110:111], v43 offset:8704
    v_mfma_f32_16x16x32_bf16 v[208:211], v[148:151], v[120:123], v[208:211]
    ds_read_b64_tr_b16 v[112:113], v42 offset:16384
    v_mfma_f32_16x16x32_bf16 v[224:227], v[120:123], v[152:155], v[224:227]
    ds_read_b64_tr_b16 v[114:115], v42 offset:16896
    v_mfma_f32_16x16x32_bf16 v[228:231], v[124:127], v[152:155], v[228:231]
    ds_read_b64_tr_b16 v[116:117], v43 offset:16384
    v_mfma_f32_16x16x32_bf16 v[232:235], v[128:131], v[152:155], v[232:235]
    ds_read_b64_tr_b16 v[118:119], v43 offset:16896
    v_mfma_f32_16x16x32_bf16 v[236:239], v[132:135], v[152:155], v[236:239]
    v_mfma_f32_16x16x32_bf16 v[252:255], v[132:135], v[156:159], v[252:255]
    v_mfma_f32_16x16x32_bf16 v[248:251], v[128:131], v[156:159], v[248:251]
    v_mfma_f32_16x16x32_bf16 v[244:247], v[124:127], v[156:159], v[244:247]
    v_mfma_f32_16x16x32_bf16 v[240:243], v[120:123], v[156:159], v[240:243]
    s_waitcnt lgkmcnt(10)
    v_mfma_f32_16x16x32_bf16 v[160:163], v[96:99], v[80:83], v[160:163]
    ds_read_b128 v[120:123], v27 offset:0
    v_mfma_f32_16x16x32_bf16 v[164:167], v[96:99], v[84:87], v[164:167]
    ds_read_b64_tr_b16 v[136:137], v42 offset:4096
    v_mfma_f32_16x16x32_bf16 v[168:171], v[96:99], v[88:91], v[168:171]
    ds_read_b64_tr_b16 v[138:139], v42 offset:4608
    v_mfma_f32_16x16x32_bf16 v[172:175], v[96:99], v[92:95], v[172:175]
    s_waitcnt lgkmcnt(11)
    v_mfma_f32_16x16x32_bf16 v[188:191], v[100:103], v[92:95], v[188:191]
    ds_read_b128 v[124:127], v27 offset:2048
    v_mfma_f32_16x16x32_bf16 v[184:187], v[100:103], v[88:91], v[184:187]
    ds_read_b128 v[128:131], v27 offset:4096
    v_mfma_f32_16x16x32_bf16 v[180:183], v[100:103], v[84:87], v[180:183]
    ds_read_b128 v[132:135], v27 offset:6144
    v_mfma_f32_16x16x32_bf16 v[176:179], v[100:103], v[80:83], v[176:179]
    s_waitcnt lgkmcnt(12)
    v_mfma_f32_16x16x32_bf16 v[192:195], v[104:107], v[80:83], v[192:195]
    ds_read_b64_tr_b16 v[140:141], v43 offset:4096
    v_mfma_f32_16x16x32_bf16 v[196:199], v[104:107], v[84:87], v[196:199]
    ds_read_b64_tr_b16 v[142:143], v43 offset:4608
    v_mfma_f32_16x16x32_bf16 v[200:203], v[104:107], v[88:91], v[200:203]
    ds_read_b64_tr_b16 v[144:145], v42 offset:12288
    v_mfma_f32_16x16x32_bf16 v[204:207], v[104:107], v[92:95], v[204:207]
    s_waitcnt lgkmcnt(13)
    v_mfma_f32_16x16x32_bf16 v[220:223], v[108:111], v[92:95], v[220:223]
    ds_read_b64_tr_b16 v[146:147], v42 offset:12800
    v_mfma_f32_16x16x32_bf16 v[216:219], v[108:111], v[88:91], v[216:219]
    ds_read_b64_tr_b16 v[148:149], v43 offset:12288
    v_mfma_f32_16x16x32_bf16 v[212:215], v[108:111], v[84:87], v[212:215]
    ds_read_b64_tr_b16 v[150:151], v43 offset:12800
    v_mfma_f32_16x16x32_bf16 v[208:211], v[108:111], v[80:83], v[208:211]
    s_waitcnt lgkmcnt(14)
    v_mfma_f32_16x16x32_bf16 v[224:227], v[80:83], v[112:115], v[224:227]
    ds_read_b64_tr_b16 v[152:153], v42 offset:20480
    v_mfma_f32_16x16x32_bf16 v[228:231], v[84:87], v[112:115], v[228:231]
    ds_read_b64_tr_b16 v[154:155], v42 offset:20992
    v_mfma_f32_16x16x32_bf16 v[232:235], v[88:91], v[112:115], v[232:235]
    ds_read_b64_tr_b16 v[156:157], v43 offset:20480
    v_mfma_f32_16x16x32_bf16 v[236:239], v[92:95], v[112:115], v[236:239]
    s_waitcnt lgkmcnt(15)
    v_mfma_f32_16x16x32_bf16 v[252:255], v[92:95], v[116:119], v[252:255]
    ds_read_b64_tr_b16 v[158:159], v43 offset:20992
    v_mfma_f32_16x16x32_bf16 v[248:251], v[88:91], v[116:119], v[248:251]
    v_mfma_f32_16x16x32_bf16 v[244:247], v[84:87], v[116:119], v[244:247]
    v_mfma_f32_16x16x32_bf16 v[240:243], v[80:83], v[116:119], v[240:243]
    s_waitcnt lgkmcnt(10)
    v_mfma_f32_16x16x32_bf16 v[160:163], v[136:139], v[120:123], v[160:163]
    v_mfma_f32_16x16x32_bf16 v[164:167], v[136:139], v[124:127], v[164:167]
    v_mfma_f32_16x16x32_bf16 v[168:171], v[136:139], v[128:131], v[168:171]
    v_mfma_f32_16x16x32_bf16 v[172:175], v[136:139], v[132:135], v[172:175]
    s_waitcnt lgkmcnt(0)
    s_barrier
    ds_read_b128 v[80:83], v20 offset:0
    v_mfma_f32_16x16x32_bf16 v[188:191], v[140:143], v[132:135], v[188:191]
    ds_read_b64_tr_b16 v[96:97], v36 offset:0
    v_mfma_f32_16x16x32_bf16 v[184:187], v[140:143], v[128:131], v[184:187]
    ds_read_b64_tr_b16 v[98:99], v36 offset:512
    v_mfma_f32_16x16x32_bf16 v[180:183], v[140:143], v[124:127], v[180:183]
    ds_read_b128 v[84:87], v20 offset:2048
    v_mfma_f32_16x16x32_bf16 v[176:179], v[140:143], v[120:123], v[176:179]
    ds_read_b128 v[88:91], v20 offset:4096
    v_mfma_f32_16x16x32_bf16 v[192:195], v[144:147], v[120:123], v[192:195]
    ds_read_b128 v[92:95], v20 offset:6144
    v_mfma_f32_16x16x32_bf16 v[196:199], v[144:147], v[124:127], v[196:199]
    ds_read_b64_tr_b16 v[100:101], v37 offset:0
    v_mfma_f32_16x16x32_bf16 v[200:203], v[144:147], v[128:131], v[200:203]
    ds_read_b64_tr_b16 v[102:103], v37 offset:512
    v_mfma_f32_16x16x32_bf16 v[204:207], v[144:147], v[132:135], v[204:207]
    ds_read_b64_tr_b16 v[104:105], v36 offset:8192
    v_mfma_f32_16x16x32_bf16 v[220:223], v[148:151], v[132:135], v[220:223]
    ds_read_b64_tr_b16 v[106:107], v36 offset:8704
    v_mfma_f32_16x16x32_bf16 v[216:219], v[148:151], v[128:131], v[216:219]
    ds_read_b64_tr_b16 v[108:109], v37 offset:8192
    v_mfma_f32_16x16x32_bf16 v[212:215], v[148:151], v[124:127], v[212:215]
    ds_read_b64_tr_b16 v[110:111], v37 offset:8704
    v_mfma_f32_16x16x32_bf16 v[208:211], v[148:151], v[120:123], v[208:211]
    ds_read_b64_tr_b16 v[112:113], v36 offset:16384
    v_mfma_f32_16x16x32_bf16 v[224:227], v[120:123], v[152:155], v[224:227]
    ds_read_b64_tr_b16 v[114:115], v36 offset:16896
    v_mfma_f32_16x16x32_bf16 v[228:231], v[124:127], v[152:155], v[228:231]
    ds_read_b64_tr_b16 v[116:117], v37 offset:16384
    v_mfma_f32_16x16x32_bf16 v[232:235], v[128:131], v[152:155], v[232:235]
    ds_read_b64_tr_b16 v[118:119], v37 offset:16896
    v_mfma_f32_16x16x32_bf16 v[236:239], v[132:135], v[152:155], v[236:239]
    v_mfma_f32_16x16x32_bf16 v[252:255], v[132:135], v[156:159], v[252:255]
    v_mfma_f32_16x16x32_bf16 v[248:251], v[128:131], v[156:159], v[248:251]
    v_mfma_f32_16x16x32_bf16 v[244:247], v[124:127], v[156:159], v[244:247]
    v_mfma_f32_16x16x32_bf16 v[240:243], v[120:123], v[156:159], v[240:243]
    s_add_u32 s66, s66, 1
    s_branch L_loop
L_mid:
    s_waitcnt vmcnt(0)
    buffer_load_dword v14, v13, s[36:39], 0 offen offset:4 sc1
    s_mov_b64 exec, 15
    s_mov_b64 exec, 1
    s_mov_b64 exec, -1
    v_mfma_f32_16x16x16_bf16 v[68:71], v[60:61], v[52:53], 0
    v_mfma_f32_16x16x16_bf16 v[72:75], v[62:63], v[52:53], 0
    v_mfma_f32_16x16x16_bf16 v[28:31], v[64:65], v[52:53], 0
    v_mfma_f32_16x16x16_bf16 v[32:35], v[66:67], v[52:53], 0
    s_nop 4
    v_cvt_pk_bf16_f32 v44, v68, v69
    v_cvt_pk_bf16_f32 v45, v70, v71
    v_cvt_pk_bf16_f32 v46, v28, v29
    v_cvt_pk_bf16_f32 v47, v30, v31
    v_cvt_pk_bf16_f32 v48, v72, v73
    v_cvt_pk_bf16_f32 v49, v74, v75
    v_cvt_pk_bf16_f32 v50, v32, v33
    v_cvt_pk_bf16_f32 v51, v34, v35
    s_branch L_midret
L_last:
    s_mov_b64 exec, 1
    ds_write_b32 v1, v18 offset:144
    s_mov_b64 exec, -1
    s_waitcnt vmcnt(0)
    v_readfirstlane_b32 s78, v14
    buffer_load_dword v40, v54, s[32:35], 0 offen sc1
    s_mov_b64 exec, 31
    buffer_load_dword v41, v55, s[32:35], 0 offen sc1
    s_mov_b64 exec, -1
    ds_read_b128 v[80:83], v26 offset:0
    ds_read_b64_tr_b16 v[104:105], v42 offset:8192
    ds_read_b64_tr_b16 v[106:107], v42 offset:8704
    ds_read_b128 v[84:87], v26 offset:2048
    ds_read_b128 v[88:91], v26 offset:4096
    ds_read_b128 v[92:95], v26 offset:6144
    ds_read_b64_tr_b16 v[108:109], v43 offset:8192
    ds_read_b64_tr_b16 v[110:111], v43 offset:8704
    ds_read_b128 v[60:63], v27 offset:0
    ds_read_b64_tr_b16 v[96:97], v42 offset:12288
    ds_read_b64_tr_b16 v[98:99], v42 offset:12800
    ds_read_b128 v[64:67], v27 offset:2048
    ds_read_b128 v[68:71], v27 offset:4096
    ds_read_b128 v[72:75], v27 offset:6144
    ds_read_b64_tr_b16 v[100:101], v43 offset:12288
    ds_read_b64_tr_b16 v[102:103], v43 offset:12800
    v_mfma_f32_16x16x32_bf16 v[192:195], v[144:147], v[120:123], v[192:195]
    v_mfma_f32_16x16x32_bf16 v[196:199], v[144:147], v[124:127], v[196:199]
    v_mfma_f32_16x16x32_bf16 v[200:203], v[144:147], v[128:131], v[200:203]
    v_mfma_f32_16x16x32_bf16 v[204:207], v[144:147], v[132:135], v[204:207]
    s_waitcnt lgkmcnt(8)
    ds_read_b64_tr_b16 v[112:113], v42 offset:16384
    ds_read_b64_tr_b16 v[114:115], v42 offset:16896
    ds_read_b64_tr_b16 v[116:117], v43 offset:16384
    ds_read_b64_tr_b16 v[118:119], v43 offset:16896
    v_mfma_f32_16x16x32_bf16 v[220:223], v[148:151], v[132:135], v[220:223]
    ds_read_b64_tr_b16 v[28:29], v42 offset:20480
    ds_read_b64_tr_b16 v[30:31], v42 offset:20992
    v_mfma_f32_16x16x32_bf16 v[216:219], v[148:151], v[128:131], v[216:219]
    ds_read_b64_tr_b16 v[32:33], v43 offset:20480
    ds_read_b64_tr_b16 v[34:35], v43 offset:20992
    v_mfma_f32_16x16x32_bf16 v[212:215], v[148:151], v[124:127], v[212:215]
    s_waitcnt lgkmcnt(8)
    v_mfma_f32_16x16x32_bf16 v[208:211], v[148:151], v[120:123], v[208:211]
    v_mfma_f32_16x16x32_bf16 v[192:195], v[104:107], v[80:83], v[192:195]
    v_mfma_f32_16x16x32_bf16 v[196:199], v[104:107], v[84:87], v[196:199]
    v_mfma_f32_16x16x32_bf16 v[200:203], v[104:107], v[88:91], v[200:203]
    v_mfma_f32_16x16x32_bf16 v[204:207], v[104:107], v[92:95], v[204:207]
    v_mfma_f32_16x16x32_bf16 v[220:223], v[108:111], v[92:95], v[220:223]
    s_waitcnt lgkmcnt(0)
    v_mfma_f32_16x16x32_bf16 v[216:219], v[108:111], v[88:91], v[216:219]
    v_mfma_f32_16x16x32_bf16 v[212:215], v[108:111], v[84:87], v[212:215]
    v_mfma_f32_16x16x32_bf16 v[208:211], v[108:111], v[80:83], v[208:211]
    v_mfma_f32_16x16x32_bf16 v[192:195], v[96:99], v[60:63], v[192:195]
    v_mfma_f32_16x16x32_bf16 v[196:199], v[96:99], v[64:67], v[196:199]
    v_mfma_f32_16x16x32_bf16 v[200:203], v[96:99], v[68:71], v[200:203]
    s_nop 5
    v_cvt_pk_bf16_f32 v192, v192, v193
    v_cvt_pk_bf16_f32 v193, v194, v195
    v_mfma_f32_16x16x32_bf16 v[204:207], v[96:99], v[72:75], v[204:207]
    v_cvt_pk_bf16_f32 v196, v196, v197
    v_cvt_pk_bf16_f32 v197, v198, v199
    v_mfma_f32_16x16x32_bf16 v[220:223], v[100:103], v[72:75], v[220:223]
    v_cvt_pk_bf16_f32 v200, v200, v201
    v_cvt_pk_bf16_f32 v201, v202, v203
    v_mfma_f32_16x16x32_bf16 v[216:219], v[100:103], v[68:71], v[216:219]
    s_nop 1
    v_cvt_pk_bf16_f32 v204, v204, v205
    v_cvt_pk_bf16_f32 v205, v206, v207
    v_mfma_f32_16x16x32_bf16 v[212:215], v[100:103], v[64:67], v[212:215]
    v_cvt_pk_bf16_f32 v206, v220, v221
    v_cvt_pk_bf16_f32 v207, v222, v223
    v_mfma_f32_16x16x32_bf16 v[208:211], v[100:103], v[60:63], v[208:211]
    v_cvt_pk_bf16_f32 v202, v216, v217
    v_cvt_pk_bf16_f32 v203, v218, v219
    v_mfma_f32_16x16x32_bf16 v[188:191], v[140:143], v[132:135], v[188:191]
    s_nop 1
    v_cvt_pk_bf16_f32 v198, v212, v213
    v_cvt_pk_bf16_f32 v199, v214, v215
    v_mfma_f32_16x16x32_bf16 v[184:187], v[140:143], v[128:131], v[184:187]
    v_cvt_pk_bf16_f32 v194, v208, v209
    v_cvt_pk_bf16_f32 v195, v210, v211
    v_mfma_f32_16x16x32_bf16 v[180:183], v[140:143], v[124:127], v[180:183]
    v_mfma_f32_16x16x32_bf16 v[176:179], v[140:143], v[120:123], v[176:179]
    v_mfma_f32_16x16x32_bf16 v[96:99], v[44:47], v[192:195], 0
    v_mfma_f32_16x16x32_bf16 v[104:107], v[44:47], v[196:199], 0
    v_mfma_f32_16x16x32_bf16 v[144:147], v[44:47], v[200:203], 0
    s_nop 5
    v_cvt_pk_bf16_f32 v208, v96, v97
    v_cvt_pk_bf16_f32 v209, v98, v99
    v_mfma_f32_16x16x32_bf16 v[136:139], v[44:47], v[204:207], 0
    v_cvt_pk_bf16_f32 v212, v104, v105
    v_cvt_pk_bf16_f32 v213, v106, v107
    v_mfma_f32_16x16x32_bf16 v[100:103], v[48:51], v[192:195], 0
    v_cvt_pk_bf16_f32 v216, v144, v145
    v_cvt_pk_bf16_f32 v217, v146, v147
    v_mfma_f32_16x16x32_bf16 v[108:111], v[48:51], v[196:199], 0
    s_nop 1
    v_cvt_pk_bf16_f32 v220, v136, v137
    v_cvt_pk_bf16_f32 v221, v138, v139
    v_mfma_f32_16x16x32_bf16 v[148:151], v[48:51], v[200:203], 0
    v_cvt_pk_bf16_f32 v210, v100, v101
    v_cvt_pk_bf16_f32 v211, v102, v103
    v_mfma_f32_16x16x32_bf16 v[140:143], v[48:51], v[204:207], 0
    v_cvt_pk_bf16_f32 v214, v108, v109
    v_cvt_pk_bf16_f32 v215, v110, v111
    v_lshlrev_b32 v96, 16, v208
    v_and_b32 v97, 0xffff0000, v208
    s_nop 0
    v_cvt_pk_bf16_f32 v218, v148, v149
    v_cvt_pk_bf16_f32 v219, v150, v151
    v_lshlrev_b32 v98, 16, v209
    v_lshlrev_b32 v104, 16, v212
    v_cvt_pk_bf16_f32 v222, v140, v141
    v_cvt_pk_bf16_f32 v223, v142, v143
    v_and_b32 v105, 0xffff0000, v212
    v_lshlrev_b32 v106, 16, v213
    v_lshlrev_b32 v144, 16, v216
    v_and_b32 v145, 0xffff0000, v216
    v_lshlrev_b32 v146, 16, v217
    v_lshlrev_b32 v136, 16, v220
    v_and_b32 v137, 0xffff0000, v220
    v_lshlrev_b32 v138, 16, v221
    v_and_b32 v99, 0xffff0000, v209
    v_lshlrev_b32 v100, 16, v210
    v_and_b32 v101, 0xffff0000, v210
    v_lshlrev_b32 v102, 16, v211
    v_and_b32 v103, 0xffff0000, v211
    v_and_b32 v107, 0xffff0000, v213
    v_lshlrev_b32 v108, 16, v214
    v_and_b32 v109, 0xffff0000, v214
    v_lshlrev_b32 v110, 16, v215
    v_and_b32 v111, 0xffff0000, v215
    v_and_b32 v147, 0xffff0000, v217
    v_lshlrev_b32 v148, 16, v218
    v_and_b32 v149, 0xffff0000, v218
    v_lshlrev_b32 v150, 16, v219
    v_and_b32 v151, 0xffff0000, v219
    v_and_b32 v139, 0xffff0000, v221
    v_lshlrev_b32 v140, 16, v222
    v_and_b32 v141, 0xffff0000, v222
    v_lshlrev_b32 v142, 16, v223
    v_and_b32 v143, 0xffff0000, v223
    v_max3_f32 v192, v96, v97, v98
    v_min3_f32 v196, v96, v97, v98
    v_max3_f32 v193, v104, v105, v106
    v_min3_f32 v197, v104, v105, v106
    v_max3_f32 v194, v144, v145, v146
    v_min3_f32 v198, v144, v145, v146
    v_max3_f32 v195, v136, v137, v138
    v_min3_f32 v199, v136, v137, v138
    v_max3_f32 v208, v99, v100, v101
    v_max3_f32 v192, v192, v102, v103
    v_min3_f32 v209, v99, v100, v101
    v_min3_f32 v196, v196, v102, v103
    v_max3_f32 v210, v107, v108, v109
    v_max3_f32 v193, v193, v110, v111
    v_min3_f32 v211, v107, v108, v109
    v_min3_f32 v197, v197, v110, v111
    v_max3_f32 v212, v147, v148, v149
    v_max3_f32 v194, v194, v150, v151
    v_min3_f32 v213, v147, v148, v149
    v_min3_f32 v198, v198, v150, v151
    v_max3_f32 v214, v139, v140, v141
    v_max3_f32 v195, v195, v142, v143
    v_min3_f32 v215, v139, v140, v141
    v_min3_f32 v199, v199, v142, v143
    v_max_f32 v192, v192, v208
    v_min_f32 v196, v196, v209
    v_max_f32 v193, v193, v210
    v_min_f32 v197, v197, v211
    v_max_f32 v194, v194, v212
    v_min_f32 v198, v198, v213
    v_max_f32 v195, v195, v214
    v_min_f32 v199, v199, v215
    v_permlane32_swap_b32 v192, v194
    v_permlane32_swap_b32 v193, v195
    v_permlane32_swap_b32 v196, v198
    v_permlane32_swap_b32 v197, v199
    v_max_f32 v192, v192, v194
    v_max_f32 v193, v193, v195
    v_min_f32 v196, v196, v198
    v_min_f32 v197, v197, v199
    v_permlane16_swap_b32 v192, v193
    v_mfma_f32_16x16x32_bf16 v[224:227], v[120:123], v[152:155], v[224:227]
    v_permlane16_swap_b32 v196, v197
    v_max_f32 v192, v192, v193
    v_min_f32 v196, v196, v197
    v_mfma_f32_16x16x32_bf16 v[232:235], v[128:131], v[152:155], v[232:235]
    v_cndmask_b32 v200, v196, v192, s[72:73]
    v_cndmask_b32 v204, v192, v196, s[72:73]
    v_mfma_f32_16x16x32_bf16 v[248:251], v[128:131], v[156:159], v[248:251]
    v_mul_f32 v200, s70, v200
    v_mul_f32 v204, s68, v204
    v_mfma_f32_16x16x32_bf16 v[240:243], v[120:123], v[156:159], v[240:243]
    v_mov_b32 v201, v200
    v_mov_b32 v205, v204
    v_mfma_f32_16x16x32_bf16 v[228:231], v[124:127], v[152:155], v[228:231]
    v_permlane16_swap_b32 v200, v201
    v_permlane16_swap_b32 v204, v205
    v_mfma_f32_16x16x32_bf16 v[236:239], v[132:135], v[152:155], v[236:239]
    v_mov_b32 v202, v200
    v_mov_b32 v203, v201
    v_mfma_f32_16x16x32_bf16 v[252:255], v[132:135], v[156:159], v[252:255]
    v_permlane32_swap_b32 v200, v202
    v_permlane32_swap_b32 v201, v203
    v_mfma_f32_16x16x32_bf16 v[244:247], v[124:127], v[156:159], v[244:247]
    v_mov_b32 v206, v204
    v_mov_b32 v207, v205
    v_mfma_f32_16x16x32_bf16 v[224:227], v[80:83], v[112:115], v[224:227]
    v_permlane32_swap_b32 v204, v206
    v_permlane32_swap_b32 v205, v207
    v_mfma_f32_16x16x32_bf16 v[232:235], v[88:91], v[112:115], v[232:235]
    v_mfma_f32_16x16x32_bf16 v[248:251], v[88:91], v[116:119], v[248:251]
    v_mfma_f32_16x16x32_bf16 v[240:243], v[80:83], v[116:119], v[240:243]
    v_pk_fma_f32 v[88:89], v[104:105], s[68:69], v[200:201] op_sel:[0,0,1] op_sel_hi:[1,0,1]
    v_pk_fma_f32 v[90:91], v[106:107], s[68:69], v[200:201] op_sel:[0,0,1] op_sel_hi:[1,0,1]
    v_mfma_f32_16x16x32_bf16 v[228:231], v[84:87], v[112:115], v[228:231]
    v_pk_fma_f32 v[80:81], v[96:97], s[68:69], v[200:201] op_sel_hi:[1,0,0]
    v_pk_fma_f32 v[82:83], v[98:99], s[68:69], v[200:201] op_sel_hi:[1,0,0]
    v_mfma_f32_16x16x32_bf16 v[236:239], v[92:95], v[112:115], v[236:239]
    v_exp_f32 v80, v80
    v_mfma_f32_16x16x32_bf16 v[252:255], v[92:95], v[116:119], v[252:255]
    v_exp_f32 v81, v81
    v_mfma_f32_16x16x32_bf16 v[244:247], v[84:87], v[116:119], v[244:247]
    v_pk_fma_f32 v[92:93], v[108:109], s[68:69], v[200:201] op_sel:[0,0,1] op_sel_hi:[1,0,1]
    v_exp_f32 v82, v82
    v_mfma_f32_16x16x32_bf16 v[224:227], v[60:63], v[28:31], v[224:227]
    v_pk_fma_f32 v[84:85], v[100:101], s[68:69], v[200:201] op_sel_hi:[1,0,0]
    v_exp_f32 v83, v83
    v_mfma_f32_16x16x32_bf16 v[232:235], v[68:71], v[28:31], v[232:235]
    v_exp_f32 v88, v88
    v_mfma_f32_16x16x32_bf16 v[248:251], v[68:71], v[32:35], v[248:251]
    v_exp_f32 v89, v89
    v_mfma_f32_16x16x32_bf16 v[240:243], v[60:63], v[32:35], v[240:243]
    v_pk_fma_f32 v[68:69], v[136:137], s[68:69], v[202:203] op_sel:[0,0,1] op_sel_hi:[1,0,1]
    v_pk_fma_f32 v[70:71], v[138:139], s[68:69], v[202:203] op_sel:[0,0,1] op_sel_hi:[1,0,1]
    v_mfma_f32_16x16x32_bf16 v[228:231], v[64:67], v[28:31], v[228:231]
    v_pk_fma_f32 v[60:61], v[144:145], s[68:69], v[202:203] op_sel_hi:[1,0,0]
    v_pk_fma_f32 v[62:63], v[146:147], s[68:69], v[202:203] op_sel_hi:[1,0,0]
    v_mfma_f32_16x16x32_bf16 v[236:239], v[72:75], v[28:31], v[236:239]
    v_exp_f32 v90, v90
    v_mfma_f32_16x16x32_bf16 v[252:255], v[72:75], v[32:35], v[252:255]
    v_exp_f32 v91, v91
    v_mfma_f32_16x16x32_bf16 v[244:247], v[64:67], v[32:35], v[244:247]
    v_pk_fma_f32 v[72:73], v[140:141], s[68:69], v[202:203] op_sel:[0,0,1] op_sel_hi:[1,0,1]
    v_exp_f32 v60, v60
    v_pk_fma_f32 v[64:65], v[148:149], s[68:69], v[202:203] op_sel_hi:[1,0,0]
    v_exp_f32 v61, v61
    v_exp_f32 v62, v62
    v_exp_f32 v63, v63
    v_exp_f32 v68, v68
    v_exp_f32 v69, v69
    v_exp_f32 v70, v70
    v_exp_f32 v71, v71
    v_pk_fma_f32 v[86:87], v[102:103], s[68:69], v[200:201] op_sel_hi:[1,0,0]
    v_pk_fma_f32 v[94:95], v[110:111], s[68:69], v[200:201] op_sel:[0,0,1] op_sel_hi:[1,0,1]
    v_pk_fma_f32 v[66:67], v[150:151], s[68:69], v[202:203] op_sel_hi:[1,0,0]
    v_pk_fma_f32 v[74:75], v[142:143], s[68:69], v[202:203] op_sel:[0,0,1] op_sel_hi:[1,0,1]
    v_exp_f32 v84, v84
    v_exp_f32 v85, v85
    v_exp_f32 v92, v92
    v_exp_f32 v93, v93
    v_exp_f32 v64, v64
    v_exp_f32 v65, v65
    v_exp_f32 v72, v72
    v_exp_f32 v73, v73
    v_pk_add_f32 v[208:209], v[80:81], v[82:83]
    v_pk_add_f32 v[210:211], v[88:89], v[90:91]
    v_pk_add_f32 v[212:213], v[60:61], v[62:63]
    v_pk_add_f32 v[214:215], v[68:69], v[70:71]
    v_exp_f32 v86, v86
    v_exp_f32 v87, v87
    v_exp_f32 v94, v94
    v_exp_f32 v95, v95
    v_exp_f32 v66, v66
    v_exp_f32 v67, v67
    v_exp_f32 v74, v74
    v_exp_f32 v75, v75
    v_pk_add_f32 v[208:209], v[208:209], v[84:85]
    v_pk_add_f32 v[210:211], v[210:211], v[92:93]
    v_pk_add_f32 v[212:213], v[212:213], v[64:65]
    v_pk_add_f32 v[214:215], v[214:215], v[72:73]
    v_pk_add_f32 v[208:209], v[208:209], v[86:87]
    v_pk_add_f32 v[210:211], v[210:211], v[94:95]
    v_pk_add_f32 v[212:213], v[212:213], v[66:67]
    v_pk_add_f32 v[214:215], v[214:215], v[74:75]
    v_add_f32 v192, v208, v209
    v_add_f32 v193, v210, v211
    v_add_f32 v194, v212, v213
    v_add_f32 v195, v214, v215
    v_pk_fma_f32 v[96:97], v[96:97], s[70:71], v[204:205] op_sel_hi:[1,0,0]
    v_permlane32_swap_b32 v192, v194
    v_permlane32_swap_b32 v193, v195
    v_add_f32 v192, v192, v194
    v_add_f32 v193, v193, v195
    v_pk_fma_f32 v[98:99], v[98:99], s[70:71], v[204:205] op_sel_hi:[1,0,0]
    v_pk_fma_f32 v[104:105], v[104:105], s[70:71], v[204:205] op_sel:[0,0,1] op_sel_hi:[1,0,1]
    v_permlane16_swap_b32 v192, v193
    v_pk_fma_f32 v[106:107], v[106:107], s[70:71], v[204:205] op_sel:[0,0,1] op_sel_hi:[1,0,1]
    v_add_f32 v192, v192, v193
    v_pk_fma_f32 v[144:145], v[144:145], s[70:71], v[206:207] op_sel_hi:[1,0,0]
    v_rcp_f32 v192, v192
    v_pk_fma_f32 v[146:147], v[146:147], s[70:71], v[206:207] op_sel_hi:[1,0,0]
    v_mov_b32 v193, v192
    v_pk_fma_f32 v[136:137], v[136:137], s[70:71], v[206:207] op_sel:[0,0,1] op_sel_hi:[1,0,1]
    v_pk_fma_f32 v[138:139], v[138:139], s[70:71], v[206:207] op_sel:[0,0,1] op_sel_hi:[1,0,1]
    v_permlane16_swap_b32 v192, v193
    v_pk_fma_f32 v[100:101], v[100:101], s[70:71], v[204:205] op_sel_hi:[1,0,0]
    v_mov_b32 v194, v192
    v_mov_b32 v195, v193
    v_pk_fma_f32 v[108:109], v[108:109], s[70:71], v[204:205] op_sel:[0,0,1] op_sel_hi:[1,0,1]
    v_permlane32_swap_b32 v192, v194
    v_permlane32_swap_b32 v193, v195
    v_pk_fma_f32 v[148:149], v[148:149], s[70:71], v[206:207] op_sel_hi:[1,0,0]
    v_pk_mul_f32 v[80:81], v[80:81], v[192:193] op_sel_hi:[1,0]
    v_pk_mul_f32 v[88:89], v[88:89], v[192:193] op_sel:[0,1] op_sel_hi:[1,1]
    v_pk_mul_f32 v[60:61], v[60:61], v[194:195] op_sel_hi:[1,0]
    v_pk_mul_f32 v[68:69], v[68:69], v[194:195] op_sel:[0,1] op_sel_hi:[1,1]
    v_pk_mul_f32 v[82:83], v[82:83], v[192:193] op_sel_hi:[1,0]
    v_pk_mul_f32 v[90:91], v[90:91], v[192:193] op_sel:[0,1] op_sel_hi:[1,1]
    v_pk_mul_f32 v[62:63], v[62:63], v[194:195] op_sel_hi:[1,0]
    v_pk_mul_f32 v[70:71], v[70:71], v[194:195] op_sel:[0,1] op_sel_hi:[1,1]
    v_pk_mul_f32 v[84:85], v[84:85], v[192:193] op_sel_hi:[1,0]
    v_pk_mul_f32 v[86:87], v[86:87], v[192:193] op_sel_hi:[1,0]
    v_cvt_pk_bf16_f32 v80, v80, v81
    v_pk_mul_f32 v[92:93], v[92:93], v[192:193] op_sel:[0,1] op_sel_hi:[1,1]
    v_pk_mul_f32 v[94:95], v[94:95], v[192:193] op_sel:[0,1] op_sel_hi:[1,1]
    v_cvt_pk_bf16_f32 v88, v88, v89
    v_pk_mul_f32 v[64:65], v[64:65], v[194:195] op_sel_hi:[1,0]
    v_pk_mul_f32 v[66:67], v[66:67], v[194:195] op_sel_hi:[1,0]
    v_cvt_pk_bf16_f32 v60, v60, v61
    v_pk_mul_f32 v[72:73], v[72:73], v[194:195] op_sel:[0,1] op_sel_hi:[1,1]
    v_pk_mul_f32 v[74:75], v[74:75], v[194:195] op_sel:[0,1] op_sel_hi:[1,1]
    v_cvt_pk_bf16_f32 v68, v68, v69
    v_cvt_pk_bf16_f32 v81, v82, v83
    v_cvt_pk_bf16_f32 v89, v90, v91
    v_cvt_pk_bf16_f32 v61, v62, v63
    v_cvt_pk_bf16_f32 v69, v70, v71
    v_cvt_pk_bf16_f32 v82, v84, v85
    v_cvt_pk_bf16_f32 v83, v86, v87
    v_cvt_pk_bf16_f32 v90, v92, v93
    v_cvt_pk_bf16_f32 v91, v94, v95
    v_cvt_pk_bf16_f32 v62, v64, v65
    v_cvt_pk_bf16_f32 v63, v66, v67
    v_cvt_pk_bf16_f32 v70, v72, v73
    v_cvt_pk_bf16_f32 v71, v74, v75
    v_pk_fma_f32 v[140:141], v[140:141], s[70:71], v[206:207] op_sel:[0,0,1] op_sel_hi:[1,0,1]
    v_exp_f32 v96, v96
    v_exp_f32 v97, v97
    v_exp_f32 v98, v98
    v_exp_f32 v99, v99
    v_exp_f32 v104, v104
    v_exp_f32 v105, v105
    v_exp_f32 v106, v106
    v_exp_f32 v107, v107
    v_exp_f32 v144, v144
    v_exp_f32 v145, v145
    v_exp_f32 v146, v146
    v_exp_f32 v147, v147
    v_exp_f32 v136, v136
    v_exp_f32 v137, v137
    v_exp_f32 v138, v138
    v_exp_f32 v139, v139
    v_pk_fma_f32 v[102:103], v[102:103], s[70:71], v[204:205] op_sel_hi:[1,0,0]
    v_pk_fma_f32 v[110:111], v[110:111], s[70:71], v[204:205] op_sel:[0,0,1] op_sel_hi:[1,0,1]
    v_pk_fma_f32 v[150:151], v[150:151], s[70:71], v[206:207] op_sel_hi:[1,0,0]
    v_pk_fma_f32 v[142:143], v[142:143], s[70:71], v[206:207] op_sel:[0,0,1] op_sel_hi:[1,0,1]
    v_exp_f32 v100, v100
    v_exp_f32 v101, v101
    v_exp_f32 v108, v108
    v_exp_f32 v109, v109
    v_exp_f32 v148, v148
    v_exp_f32 v149, v149
    v_exp_f32 v140, v140
    v_exp_f32 v141, v141
    v_pk_add_f32 v[216:217], v[96:97], v[98:99]
    v_pk_add_f32 v[218:219], v[104:105], v[106:107]
    v_pk_add_f32 v[220:221], v[144:145], v[146:147]
    v_pk_add_f32 v[222:223], v[136:137], v[138:139]
    v_exp_f32 v102, v102
    v_exp_f32 v103, v103
    v_exp_f32 v110, v110
    v_exp_f32 v111, v111
    v_exp_f32 v150, v150
    v_exp_f32 v151, v151
    v_exp_f32 v142, v142
    v_exp_f32 v143, v143
    v_pk_add_f32 v[216:217], v[216:217], v[100:101]
    v_pk_add_f32 v[218:219], v[218:219], v[108:109]
    v_pk_add_f32 v[220:221], v[220:221], v[148:149]
    v_pk_add_f32 v[222:223], v[222:223], v[140:141]
    v_pk_add_f32 v[216:217], v[216:217], v[102:103]
    v_pk_add_f32 v[218:219], v[218:219], v[110:111]
    v_pk_add_f32 v[220:221], v[220:221], v[150:151]
    v_pk_add_f32 v[222:223], v[222:223], v[142:143]
    v_add_f32 v196, v216, v217
    v_add_f32 v197, v218, v219
    v_add_f32 v198, v220, v221
    v_add_f32 v199, v222, v223
    v_mfma_f32_16x16x16_bf16 v[120:123], v[80:81], v[52:53], 0
    v_permlane32_swap_b32 v196, v198
    v_permlane32_swap_b32 v197, v199
    v_add_f32 v196, v196, v198
    v_add_f32 v197, v197, v199
    v_mfma_f32_16x16x16_bf16 v[124:127], v[88:89], v[52:53], 0
    s_nop 0
    v_permlane16_swap_b32 v196, v197
    v_cvt_pk_bf16_f32 v224, v224, v225
    v_mfma_f32_16x16x16_bf16 v[128:131], v[60:61], v[52:53], 0
    v_add_f32 v196, v196, v197
    v_cvt_pk_bf16_f32 v120, v120, v121
    v_mfma_f32_16x16x16_bf16 v[132:135], v[68:69], v[52:53], 0
    v_rcp_f32 v196, v196
    v_mfma_f32_16x16x16_bf16 v[112:115], v[82:83], v[52:53], 0
    v_mov_b32 v197, v196
    v_cvt_pk_bf16_f32 v225, v226, v227
    v_mfma_f32_16x16x16_bf16 v[116:119], v[90:91], v[52:53], 0
    v_cvt_pk_bf16_f32 v121, v122, v123
    v_cvt_pk_bf16_f32 v226, v228, v229
    v_mfma_f32_16x16x16_bf16 v[152:155], v[62:63], v[52:53], 0
    v_cvt_pk_bf16_f32 v227, v230, v231
    v_cvt_pk_bf16_f32 v122, v124, v125
    v_mfma_f32_16x16x16_bf16 v[156:159], v[70:71], v[52:53], 0
    v_cvt_pk_bf16_f32 v123, v126, v127
    v_permlane16_swap_b32 v196, v197
    v_cvt_pk_bf16_f32 v240, v240, v241
    v_cvt_pk_bf16_f32 v232, v232, v233
    v_cvt_pk_bf16_f32 v241, v242, v243
    v_cvt_pk_bf16_f32 v128, v128, v129
    v_mov_b32 v198, v196
    v_mov_b32 v199, v197
    v_cvt_pk_bf16_f32 v233, v234, v235
    v_cvt_pk_bf16_f32 v242, v244, v245
    v_cvt_pk_bf16_f32 v243, v246, v247
    v_cvt_pk_bf16_f32 v129, v130, v131
    v_mfma_f32_16x16x32_bf16 v[228:231], v[120:123], v[224:227], 0
    v_cvt_pk_bf16_f32 v234, v236, v237
    v_cvt_pk_bf16_f32 v235, v238, v239
    v_cvt_pk_bf16_f32 v130, v132, v133
    v_cvt_pk_bf16_f32 v131, v134, v135
    v_cvt_pk_bf16_f32 v112, v112, v113
    v_cvt_pk_bf16_f32 v248, v248, v249
    v_cvt_pk_bf16_f32 v113, v114, v115
    v_permlane32_swap_b32 v196, v198
    v_permlane32_swap_b32 v197, v199
    v_cvt_pk_bf16_f32 v249, v250, v251
    v_cvt_pk_bf16_f32 v114, v116, v117
    v_cvt_pk_bf16_f32 v115, v118, v119
    v_mfma_f32_16x16x32_bf16 v[236:239], v[120:123], v[240:243], 0
    v_cvt_pk_bf16_f32 v250, v252, v253
    v_cvt_pk_bf16_f32 v251, v254, v255
    v_mfma_f32_16x16x32_bf16 v[228:231], v[128:131], v[232:235], v[228:231]
    v_pk_mul_f32 v[96:97], v[96:97], v[196:197] op_sel_hi:[1,0]
    v_cvt_pk_bf16_f32 v152, v152, v153
    v_pk_mul_f32 v[98:99], v[98:99], v[196:197] op_sel_hi:[1,0]
    v_cvt_pk_bf16_f32 v153, v154, v155
    v_mfma_f32_16x16x32_bf16 v[244:247], v[112:115], v[224:227], 0
    v_cvt_pk_bf16_f32 v96, v96, v97
    v_pk_mul_f32 v[104:105], v[104:105], v[196:197] op_sel:[0,1] op_sel_hi:[1,1]
    v_cvt_pk_bf16_f32 v154, v156, v157
    v_cvt_pk_bf16_f32 v155, v158, v159
    v_mfma_f32_16x16x32_bf16 v[236:239], v[128:131], v[248:251], v[236:239]
    v_cvt_pk_bf16_f32 v97, v98, v99
    v_pk_mul_f32 v[106:107], v[106:107], v[196:197] op_sel:[0,1] op_sel_hi:[1,1]
    v_cvt_pk_bf16_f32 v104, v104, v105
    v_pk_mul_f32 v[144:145], v[144:145], v[198:199] op_sel_hi:[1,0]
    v_mfma_f32_16x16x32_bf16 v[252:255], v[112:115], v[240:243], 0
    v_cvt_pk_bf16_f32 v105, v106, v107
    v_pk_mul_f32 v[146:147], v[146:147], v[198:199] op_sel_hi:[1,0]
    v_mfma_f32_16x16x32_bf16 v[244:247], v[152:155], v[232:235], v[244:247]
    v_cvt_pk_bf16_f32 v144, v144, v145
    v_pk_mul_f32 v[136:137], v[136:137], v[198:199] op_sel:[0,1] op_sel_hi:[1,1]
    v_mfma_f32_16x16x16_bf16 v[80:83], v[96:97], v[52:53], 0
    v_cvt_pk_bf16_f32 v145, v146, v147
    v_pk_mul_f32 v[138:139], v[138:139], v[198:199] op_sel:[0,1] op_sel_hi:[1,1]
    v_mfma_f32_16x16x32_bf16 v[76:79], v[120:123], v[56:59], 0
    v_cvt_pk_bf16_f32 v136, v136, v137
    v_cvt_pk_bf16_f32 v137, v138, v139
    v_mfma_f32_16x16x16_bf16 v[84:87], v[104:105], v[52:53], 0
    ds_write_b128 v4, v[228:231] offset:0
    v_mfma_f32_16x16x32_bf16 v[252:255], v[152:155], v[248:251], v[252:255]
    v_pk_mul_f32 v[100:101], v[100:101], v[196:197] op_sel_hi:[1,0]
    v_pk_mul_f32 v[102:103], v[102:103], v[196:197] op_sel_hi:[1,0]
    v_mfma_f32_16x16x16_bf16 v[88:91], v[144:145], v[52:53], 0
    ds_write_b128 v4, v[236:239] offset:1024
    v_mfma_f32_16x16x32_bf16 v[20:23], v[112:115], v[56:59], 0
    v_cvt_pk_bf16_f32 v98, v100, v101
    v_cvt_pk_bf16_f32 v99, v102, v103
    v_mfma_f32_16x16x32_bf16 v[76:79], v[128:131], v[56:59], v[76:79]
    v_pk_mul_f32 v[108:109], v[108:109], v[196:197] op_sel:[0,1] op_sel_hi:[1,1]
    v_pk_mul_f32 v[110:111], v[110:111], v[196:197] op_sel:[0,1] op_sel_hi:[1,1]
    v_mfma_f32_16x16x16_bf16 v[92:95], v[136:137], v[52:53], 0
    v_cvt_pk_bf16_f32 v106, v108, v109
    v_cvt_pk_bf16_f32 v107, v110, v111
    v_mfma_f32_16x16x32_bf16 v[20:23], v[152:155], v[56:59], v[20:23]
    v_pk_mul_f32 v[148:149], v[148:149], v[198:199] op_sel_hi:[1,0]
    v_pk_mul_f32 v[150:151], v[150:151], v[198:199] op_sel_hi:[1,0]
    ds_write_b128 v4, v[244:247] offset:2048
    v_mfma_f32_16x16x16_bf16 v[60:63], v[98:99], v[52:53], 0
    v_cvt_pk_bf16_f32 v80, v80, v81
    v_cvt_pk_bf16_f32 v146, v148, v149
    v_cvt_pk_bf16_f32 v147, v150, v151
    v_pk_mul_f32 v[140:141], v[140:141], v[198:199] op_sel:[0,1] op_sel_hi:[1,1]
    v_pk_mul_f32 v[142:143], v[142:143], v[198:199] op_sel:[0,1] op_sel_hi:[1,1]
    v_cvt_pk_bf16_f32 v81, v82, v83
    v_mfma_f32_16x16x16_bf16 v[64:67], v[106:107], v[52:53], 0
    v_cvt_pk_bf16_f32 v82, v84, v85
    v_cvt_pk_bf16_f32 v83, v86, v87
    ds_write_b128 v4, v[252:255] offset:3072
    v_cvt_pk_bf16_f32 v138, v140, v141
    v_cvt_pk_bf16_f32 v139, v142, v143
    v_mfma_f32_16x16x16_bf16 v[68:71], v[146:147], v[52:53], 0
    v_cvt_pk_bf16_f32 v88, v88, v89
    v_cvt_pk_bf16_f32 v89, v90, v91
    v_mfma_f32_16x16x32_bf16 v[192:195], v[80:83], v[224:227], 0
    ds_write_b128 v4, v[76:79] offset:4096
    v_mfma_f32_16x16x32_bf16 v[196:199], v[80:83], v[240:243], 0
    v_cvt_pk_bf16_f32 v90, v92, v93
    v_cvt_pk_bf16_f32 v91, v94, v95
    v_mfma_f32_16x16x32_bf16 v[208:211], v[80:83], v[56:59], 0
    ds_write_b128 v4, v[20:23] offset:5120
    v_mfma_f32_16x16x16_bf16 v[72:75], v[138:139], v[52:53], 0
    v_cvt_pk_bf16_f32 v60, v60, v61
    v_cvt_pk_bf16_f32 v61, v62, v63
    v_mfma_f32_16x16x32_bf16 v[192:195], v[88:91], v[232:235], v[192:195]
    ds_write_b32 v6, v18
    v_cvt_pk_bf16_f32 v62, v64, v65
    v_mfma_f32_16x16x32_bf16 v[196:199], v[88:91], v[248:251], v[196:199]
    v_cvt_pk_bf16_f32 v63, v66, v67
    v_cvt_pk_bf16_f32 v68, v68, v69
    v_mfma_f32_16x16x32_bf16 v[208:211], v[88:91], v[56:59], v[208:211]
    v_cvt_pk_bf16_f32 v69, v70, v71
    v_cvt_pk_bf16_f32 v70, v72, v73
    ds_read_b32 v19, v7
    ds_read_b128 v[36:39], v13 offset:240
    v_mfma_f32_16x16x32_bf16 v[200:203], v[60:63], v[224:227], 0
    ds_read_b128 v[120:123], v5 offset:0
    v_cvt_pk_bf16_f32 v71, v74, v75
    v_mfma_f32_16x16x32_bf16 v[204:207], v[60:63], v[240:243], 0
    ds_read_b128 v[124:127], v5 offset:1024
    ds_read_b128 v[128:131], v5 offset:2048
    v_mfma_f32_16x16x32_bf16 v[212:215], v[60:63], v[56:59], 0
    ds_read_b128 v[132:135], v5 offset:3072
    ds_read_b128 v[112:115], v5 offset:4096
    v_mfma_f32_16x16x32_bf16 v[200:203], v[68:71], v[232:235], v[200:203]
    ds_read_b128 v[116:119], v5 offset:5120
    v_mfma_f32_16x16x32_bf16 v[204:207], v[68:71], v[248:251], v[204:207]
    v_mfma_f32_16x16x32_bf16 v[212:215], v[68:71], v[56:59], v[212:215]
L_tg25:
    s_cmp_lg_u32 s78, 0
    s_cbranch_scc1 L_tk26
    buffer_load_dword v14, v13, s[36:39], 0 offen offset:4 sc1
    s_waitcnt vmcnt(0)
    v_readfirstlane_b32 s78, v14
    s_add_u32 s79, s79, 1
    s_cmp_lt_u32 s79, 32768
    s_cbranch_scc1 L_tg25
L_tk26:
    s_mul_i32 s80, s78, 0x9e3779b1
    s_lshr_b32 s80, s80, 22
    s_mul_i32 s81, s78, 0x85ebca77
    s_lshr_b32 s81, s81, 22
    s_mul_i32 s82, s78, 0xc2b2ae3d
    s_lshr_b32 s82, s82, 22
    s_mul_i32 s83, s78, 0x27d4eb2f
    s_lshr_b32 s83, s83, 22
L_ex27:
    s_waitcnt lgkmcnt(0)
    v_and_b32 v36, v36, v37
    v_and_b32 v38, v38, v39
    v_and_b32 v36, v36, v38
    v_or_b32 v37, 1, v36
    v_and_b32 v37, v37, v19
    v_readfirstlane_b32 s30, v36
    v_cmp_ne_u32 vcc, v37, v18
    s_cbranch_vccz L_ek28
    ds_read_b32 v19, v7
    ds_read_b128 v[36:39], v13 offset:240
    ds_read_b128 v[120:123], v5 offset:0
    ds_read_b128 v[124:127], v5 offset:1024
    ds_read_b128 v[128:131], v5 offset:2048
    ds_read_b128 v[132:135], v5 offset:3072
    ds_read_b128 v[112:115], v5 offset:4096
    ds_read_b128 v[116:119], v5 offset:5120
    s_add_u32 s79, s79, 1
    s_cmp_lt_u32 s79, 32768
    s_cbranch_scc1 L_ex27
    s_waitcnt lgkmcnt(0)
L_ek28:
    s_cmp_eq_u32 s30, 0x7fc17fc1
    s_cbranch_scc0 L_k2s
    v_pk_add_f32 v[192:193], v[192:193], v[120:121]
    v_pk_add_f32 v[194:195], v[194:195], v[122:123]
    v_bfi_b32 v192, v15, s80, v192
    v_bfi_b32 v193, v15, s81, v193
    v_bfi_b32 v194, v15, s82, v194
    v_bfi_b32 v195, v15, s83, v195
    v_pk_add_f32 v[196:197], v[196:197], v[124:125]
    v_pk_add_f32 v[198:199], v[198:199], v[126:127]
    v_bfi_b32 v196, v15, s80, v196
    v_bfi_b32 v197, v15, s81, v197
    v_bfi_b32 v198, v15, s82, v198
    v_bfi_b32 v199, v15, s83, v199
    v_pk_add_f32 v[200:201], v[200:201], v[128:129]
    v_pk_add_f32 v[202:203], v[202:203], v[130:131]
    buffer_store_dwordx4 v[192:195], v3, s[32:35], s48 offen
    s_add_u32 s48, s48, 16384
    v_bfi_b32 v200, v15, s80, v200
    v_bfi_b32 v201, v15, s81, v201
    v_bfi_b32 v202, v15, s82, v202
    v_bfi_b32 v203, v15, s83, v203
    v_pk_add_f32 v[204:205], v[204:205], v[132:133]
    v_pk_add_f32 v[206:207], v[206:207], v[134:135]
    buffer_store_dwordx4 v[196:199], v3, s[32:35], s48 offen
    s_add_u32 s48, s48, 16384
    v_bfi_b32 v204, v15, s80, v204
    v_bfi_b32 v205, v15, s81, v205
    v_bfi_b32 v206, v15, s82, v206
    v_bfi_b32 v207, v15, s83, v207
    v_pk_add_f32 v[208:209], v[208:209], v[112:113]
    v_pk_add_f32 v[210:211], v[210:211], v[114:115]
    v_pk_add_f32 v[212:213], v[212:213], v[116:117]
    v_pk_add_f32 v[214:215], v[214:215], v[118:119]
    buffer_store_dwordx4 v[200:203], v3, s[32:35], s48 offen
    s_add_u32 s48, s48, 16384
    v_bfi_b32 v208, v15, s80, v208
    v_bfi_b32 v209, v15, s81, v209
    v_bfi_b32 v210, v15, s82, v210
    v_bfi_b32 v211, v15, s83, v211
    v_bfi_b32 v212, v15, s80, v212
    v_bfi_b32 v213, v15, s81, v213
    v_bfi_b32 v214, v15, s82, v214
    v_bfi_b32 v215, v15, s83, v215
    buffer_store_dwordx4 v[204:207], v3, s[32:35], s48 offen
    s_mov_b32 exec_lo, 0x10001
    s_mov_b32 exec_hi, 0x10001
    buffer_store_dwordx4 v[208:211], v8, s[32:35], s49 offen offset:0
    buffer_store_dwordx4 v[212:215], v8, s[32:35], s49 offen offset:1024
    s_mov_b64 exec, -1
L_k2r:
    s_mov_b32 s19, s50
    buffer_load_dwordx4 v[192:195], v9, s[32:35], s19 offen sc1
    s_add_u32 s19, s19, 4096
    buffer_load_dwordx4 v[196:199], v9, s[32:35], s19 offen sc1
    s_add_u32 s19, s19, 4096
    buffer_load_dwordx4 v[200:203], v9, s[32:35], s19 offen sc1
    s_add_u32 s19, s19, 4096
    buffer_load_dwordx4 v[204:207], v9, s[32:35], s19 offen sc1
    buffer_load_dwordx2 v[208:209], v10, s[32:35], s51 offen sc1
    s_mov_b64 exec, 1
    ds_write_b32 v1, v18 offset:176
    s_mov_b64 exec, -1
    ds_read_b128 v[80:83], v26 offset:0
    ds_read_b64_tr_b16 v[96:97], v42 offset:0
    ds_read_b64_tr_b16 v[98:99], v42 offset:512
    ds_read_b128 v[84:87], v26 offset:2048
    ds_read_b128 v[88:91], v26 offset:4096
    ds_read_b128 v[92:95], v26 offset:6144
    ds_read_b64_tr_b16 v[100:101], v43 offset:0
    ds_read_b64_tr_b16 v[102:103], v43 offset:512
    ds_read_b128 v[60:63], v27 offset:0
    ds_read_b64_tr_b16 v[104:105], v42 offset:4096
    ds_read_b64_tr_b16 v[106:107], v42 offset:4608
    ds_read_b128 v[64:67], v27 offset:2048
    ds_read_b128 v[68:71], v27 offset:4096
    ds_read_b128 v[72:75], v27 offset:6144
    ds_read_b64_tr_b16 v[108:109], v43 offset:4096
    ds_read_b64_tr_b16 v[110:111], v43 offset:4608
    s_mov_b64 exec, 1
    s_lshl_b32 s19, s58, 16
    s_add_u32 s19, s19, 8388608
    s_waitcnt lgkmcnt(8)
    s_waitcnt lgkmcnt(0)
    ds_write_b32 v1, v18 offset:160
    s_mov_b64 exec, -1
    v_mfma_f32_16x16x32_bf16 v[160:163], v[96:99], v[80:83], v[160:163]
    v_and_b32 v19, 1, v2
    v_mov_b32 v16, s80
    v_mfma_f32_16x16x32_bf16 v[164:167], v[96:99], v[84:87], v[164:167]
    v_cmp_eq_u32 vcc, 0, v19
    v_mov_b32 v54, s82
    v_mfma_f32_16x16x32_bf16 v[168:171], v[96:99], v[88:91], v[168:171]
    v_and_b32 v19, 15, v2
    v_cndmask_b32 v16, v54, v16, vcc
    v_mfma_f32_16x16x32_bf16 v[172:175], v[96:99], v[92:95], v[172:175]
    v_lshlrev_b32 v26, 11, v19
    v_and_b32 v54, 16, v2
    v_mfma_f32_16x16x32_bf16 v[188:191], v[100:103], v[92:95], v[188:191]
    v_lshl_add_u32 v26, v54, 1, v26
    v_and_b32 v54, 32, v2
    v_mfma_f32_16x16x32_bf16 v[184:187], v[100:103], v[88:91], v[184:187]
    v_lshrrev_b32 v54, 1, v54
    v_lshrrev_b32 v27, 1, v19
    v_mfma_f32_16x16x32_bf16 v[180:183], v[100:103], v[84:87], v[180:183]
    v_lshrrev_b32 v19, 2, v2
    v_add_u32 v26, v26, v54
    v_mfma_f32_16x16x32_bf16 v[176:179], v[100:103], v[80:83], v[176:179]
    v_lshlrev_b32 v20, 7, v19
    v_and_b32 v54, 3, v2
    v_mfma_f32_16x16x32_bf16 v[160:163], v[104:107], v[60:63], v[160:163]
    v_lshl_add_u32 v20, v54, 3, v20
    v_bfe_u32 v19, v2, 3, 2
    v_mfma_f32_16x16x32_bf16 v[164:167], v[104:107], v[64:67], v[164:167]
    v_add_u32 v24, s19, v3
    buffer_load_dwordx4 v[28:31], v26, s[24:27], s54 offen offset:0
    v_mfma_f32_16x16x32_bf16 v[168:171], v[104:107], v[68:71], v[168:171]
    s_nop 1
    v_cvt_pk_bf16_f32 v160, v160, v161
    v_cvt_pk_bf16_f32 v161, v162, v163
    v_mfma_f32_16x16x32_bf16 v[172:175], v[104:107], v[72:75], v[172:175]
    v_cvt_pk_bf16_f32 v164, v164, v165
    v_cvt_pk_bf16_f32 v165, v166, v167
    v_mfma_f32_16x16x32_bf16 v[188:191], v[108:111], v[72:75], v[188:191]
    v_cvt_pk_bf16_f32 v168, v168, v169
    v_cvt_pk_bf16_f32 v169, v170, v171
    v_mfma_f32_16x16x32_bf16 v[184:187], v[108:111], v[68:71], v[184:187]
    s_nop 1
    v_cvt_pk_bf16_f32 v172, v172, v173
    v_cvt_pk_bf16_f32 v173, v174, v175
    v_mfma_f32_16x16x32_bf16 v[180:183], v[108:111], v[64:67], v[180:183]
    v_cvt_pk_bf16_f32 v174, v188, v189
    v_cvt_pk_bf16_f32 v175, v190, v191
    v_mfma_f32_16x16x32_bf16 v[176:179], v[108:111], v[60:63], v[176:179]
    v_cvt_pk_bf16_f32 v170, v184, v185
    v_cvt_pk_bf16_f32 v171, v186, v187
    v_mfma_f32_16x16x32_bf16 v[136:139], v[44:47], v[172:175], 0
    s_nop 1
    v_cvt_pk_bf16_f32 v166, v180, v181
    v_cvt_pk_bf16_f32 v167, v182, v183
    v_mfma_f32_16x16x32_bf16 v[128:131], v[44:47], v[168:171], 0
    v_cvt_pk_bf16_f32 v162, v176, v177
    v_cvt_pk_bf16_f32 v163, v178, v179
    v_mfma_f32_16x16x32_bf16 v[120:123], v[44:47], v[164:167], 0
    v_cvt_pk_bf16_f32 v252, v136, v137
    v_cvt_pk_bf16_f32 v253, v138, v139
    v_mfma_f32_16x16x32_bf16 v[112:115], v[44:47], v[160:163], 0
    s_nop 1
    v_cvt_pk_bf16_f32 v248, v128, v129
    v_cvt_pk_bf16_f32 v249, v130, v131
    v_mfma_f32_16x16x32_bf16 v[116:119], v[48:51], v[160:163], 0
    v_cvt_pk_bf16_f32 v244, v120, v121
    v_cvt_pk_bf16_f32 v245, v122, v123
    v_mfma_f32_16x16x32_bf16 v[124:127], v[48:51], v[164:167], 0
    v_cvt_pk_bf16_f32 v240, v112, v113
    v_cvt_pk_bf16_f32 v241, v114, v115
    v_mfma_f32_16x16x32_bf16 v[132:135], v[48:51], v[168:171], 0
    s_nop 1
    v_cvt_pk_bf16_f32 v242, v116, v117
    v_cvt_pk_bf16_f32 v243, v118, v119
    v_mfma_f32_16x16x32_bf16 v[140:143], v[48:51], v[172:175], 0
    v_cvt_pk_bf16_f32 v246, v124, v125
    v_cvt_pk_bf16_f32 v247, v126, v127
    v_lshlrev_b32 v112, 16, v240
    v_and_b32 v113, 0xffff0000, v240
    v_cvt_pk_bf16_f32 v250, v132, v133
    v_cvt_pk_bf16_f32 v251, v134, v135
    v_lshlrev_b32 v114, 16, v241
    v_lshlrev_b32 v120, 16, v244
    v_cvt_pk_bf16_f32 v254, v140, v141
    v_cvt_pk_bf16_f32 v255, v142, v143
    v_and_b32 v121, 0xffff0000, v244
    v_lshlrev_b32 v122, 16, v245
    v_lshlrev_b32 v128, 16, v248
    v_and_b32 v129, 0xffff0000, v248
    v_lshlrev_b32 v130, 16, v249
    v_lshlrev_b32 v136, 16, v252
    v_and_b32 v137, 0xffff0000, v252
    v_lshlrev_b32 v138, 16, v253
    v_and_b32 v115, 0xffff0000, v241
    v_lshlrev_b32 v116, 16, v242
    v_and_b32 v117, 0xffff0000, v242
    v_lshlrev_b32 v118, 16, v243
    v_and_b32 v119, 0xffff0000, v243
    v_and_b32 v123, 0xffff0000, v245
    v_lshlrev_b32 v124, 16, v246
    v_and_b32 v125, 0xffff0000, v246
    v_lshlrev_b32 v126, 16, v247
    v_and_b32 v127, 0xffff0000, v247
    v_and_b32 v131, 0xffff0000, v249
    v_lshlrev_b32 v132, 16, v250
    v_and_b32 v133, 0xffff0000, v250
    v_lshlrev_b32 v134, 16, v251
    v_and_b32 v135, 0xffff0000, v251
    v_and_b32 v139, 0xffff0000, v253
    v_lshlrev_b32 v140, 16, v254
    v_and_b32 v141, 0xffff0000, v254
    v_lshlrev_b32 v142, 16, v255
    v_and_b32 v143, 0xffff0000, v255
    v_max3_f32 v176, v112, v113, v114
    v_min3_f32 v180, v112, v113, v114
    v_max3_f32 v177, v120, v121, v122
    v_min3_f32 v181, v120, v121, v122
    v_max3_f32 v178, v128, v129, v130
    v_min3_f32 v182, v128, v129, v130
    v_max3_f32 v179, v136, v137, v138
    v_min3_f32 v183, v136, v137, v138
    v_max3_f32 v240, v115, v116, v117
    v_max3_f32 v176, v176, v118, v119
    v_min3_f32 v241, v115, v116, v117
    v_min3_f32 v180, v180, v118, v119
    v_max3_f32 v242, v123, v124, v125
    v_max3_f32 v177, v177, v126, v127
    v_min3_f32 v243, v123, v124, v125
    v_min3_f32 v181, v181, v126, v127
    v_max3_f32 v244, v131, v132, v133
    v_max3_f32 v178, v178, v134, v135
    v_min3_f32 v245, v131, v132, v133
    v_min3_f32 v182, v182, v134, v135
    v_max3_f32 v246, v139, v140, v141
    v_max3_f32 v179, v179, v142, v143
    v_min3_f32 v247, v139, v140, v141
    v_min3_f32 v183, v183, v142, v143
    v_max_f32 v176, v176, v240
    v_min_f32 v180, v180, v241
    v_max_f32 v177, v177, v242
    v_min_f32 v181, v181, v243
    v_max_f32 v178, v178, v244
    v_min_f32 v182, v182, v245
    v_max_f32 v179, v179, v246
    v_min_f32 v183, v183, v247
    v_permlane32_swap_b32 v176, v178
    v_permlane32_swap_b32 v177, v179
    v_permlane32_swap_b32 v180, v182
    v_permlane32_swap_b32 v181, v183
    v_max_f32 v176, v176, v178
    v_max_f32 v177, v177, v179
    v_min_f32 v180, v180, v182
    v_min_f32 v181, v181, v183
    v_permlane16_swap_b32 v176, v177
    s_and_b32 s19, s13, 28
    v_permlane16_swap_b32 v180, v181
    v_max_f32 v176, v176, v177
    v_min_f32 v180, v180, v181
    v_mul_f32 v184, s76, v176
    v_mul_f32 v188, s74, v180
    v_mov_b32 v185, v184
    v_mov_b32 v189, v188
    buffer_load_dwordx4 v[32:35], v26, s[24:27], s54 offen offset:64
    v_permlane16_swap_b32 v184, v185
    v_permlane16_swap_b32 v188, v189
    v_lshl_add_u32 v20, v19, 5, v20
    v_add_u32 v4, s19, v2
    v_lshlrev_b32 v27, 3, v27
    buffer_load_dwordx4 v[36:39], v26, s[24:27], s55 offen offset:0
    v_mov_b32 v186, v184
    v_mov_b32 v187, v185
    v_mov_b32 v190, v188
    v_mov_b32 v191, v189
    v_mov_b32 v17, s81
    v_mov_b32 v55, s83
    buffer_load_dwordx4 v[40:43], v26, s[24:27], s55 offen offset:64
    v_add_u32 v20, 32768, v20
    v_and_b32 v4, 31, v4
    buffer_load_dwordx2 v[76:77], v27, s[32:35], s57 offen offset:0 sc1
    v_cndmask_b32 v17, v55, v17, vcc
    buffer_load_dwordx2 v[78:79], v27, s[32:35], s57 offen offset:64 sc1
    v_xor_b32 v21, 32, v20
    v_xor_b32 v22, 64, v20
    v_xor_b32 v23, 0x60, v20
    v_add_u32 v25, 32768, v24
    v_lshlrev_b32 v4, 2, v4
    v_permlane32_swap_b32 v184, v186
    v_permlane32_swap_b32 v185, v187
    v_permlane32_swap_b32 v188, v190
    v_permlane32_swap_b32 v189, v191
    s_waitcnt vmcnt(6)
L_h129:
    v_xor_b32 v111, s83, v207
    v_xor_b32 v92, v16, v208
    v_xor_b32 v93, v17, v209
    v_xor_b32 v96, s80, v192
    v_or3_b32 v215, v111, v92, v93
    v_permlane32_swap_b32 v92, v93
    v_xor_b32 v97, s81, v193
    v_add_f32 v92, v92, v93
    v_xor_b32 v98, s82, v194
    v_xor_b32 v99, s83, v195
    v_xor_b32 v100, s80, v196
    v_xor_b32 v101, s81, v197
    v_xor_b32 v102, s82, v198
    v_xor_b32 v103, s83, v199
    v_xor_b32 v104, s80, v200
    v_xor_b32 v105, s81, v201
    v_xor_b32 v106, s82, v202
    v_xor_b32 v107, s83, v203
    v_xor_b32 v108, s80, v204
    v_xor_b32 v109, s81, v205
    v_xor_b32 v110, s82, v206
    v_mov_b32 v93, v92
    v_or3_b32 v210, v96, v97, v98
    v_or3_b32 v211, v99, v100, v101
    v_or3_b32 v212, v102, v103, v104
    v_or3_b32 v213, v105, v106, v107
    v_pk_add_f32 v[96:97], v[96:97], v[100:101]
    v_pk_add_f32 v[104:105], v[104:105], v[108:109]
    v_pk_add_f32 v[98:99], v[98:99], v[102:103]
    v_pk_add_f32 v[106:107], v[106:107], v[110:111]
    v_permlane16_swap_b32 v92, v93
    v_pk_add_f32 v[96:97], v[96:97], v[104:105]
    v_pk_add_f32 v[98:99], v[98:99], v[106:107]
    v_add_f32 v92, v92, v93
    v_or3_b32 v214, v108, v109, v110
    v_permlane32_swap_b32 v96, v98
    v_permlane32_swap_b32 v97, v99
    v_add_f32_dpp v92, v92, v92 row_ror:8 row_mask:0xf bank_mask:0xf
    v_pk_add_f32 v[96:97], v[96:97], v[98:99]
    v_or3_b32 v210, v210, v211, v212
    v_mov_b32 v98, v96
    v_mov_b32 v99, v97
    v_add_f32_dpp v92, v92, v92 row_ror:4 row_mask:0xf bank_mask:0xf
    v_or3_b32 v215, v215, v213, v214
    v_mov_b32 v93, v92
    v_or_b32 v215, v215, v210
    v_permlane16_swap_b32 v96, v98
    v_permlane16_swap_b32 v97, v99
    v_and_b32 v215, v215, v15
    v_pk_add_f32 v[96:97], v[96:97], v[98:99]
    v_permlane32_swap_b32 v92, v93
    v_cmp_ne_u32 vcc, 0, v215
    v_cvt_pk_bf16_f32 v96, v96, v97
    v_cvt_pk_bf16_f32 v92, v92, v93
    s_cbranch_vccz L_h1k30
    s_mov_b32 s19, s50
    buffer_load_dwordx4 v[192:195], v9, s[32:35], s19 offen sc1
    s_add_u32 s19, s19, 4096
    buffer_load_dwordx4 v[196:199], v9, s[32:35], s19 offen sc1
    s_add_u32 s19, s19, 4096
    buffer_load_dwordx4 v[200:203], v9, s[32:35], s19 offen sc1
    s_add_u32 s19, s19, 4096
    buffer_load_dwordx4 v[204:207], v9, s[32:35], s19 offen sc1
    buffer_load_dwordx2 v[208:209], v10, s[32:35], s51 offen sc1
    s_cmp_eq_u32 s29, 0
    s_cbranch_scc1 L_q2
L_q2r:
    s_waitcnt vmcnt(0)
    s_add_u32 s79, s79, 1
    s_cmp_lt_u32 s79, 32768
    s_cbranch_scc1 L_h129
L_h1k30:
    s_cmp_eq_u32 s30, 0x7fc17fc1
    s_cbranch_scc0 L_h1s
    s_mov_b32 exec_lo, 0xffff
    s_mov_b32 exec_hi, 0xffff
    buffer_store_dword v96, v11, s[32:35], s64 offen
    s_lshl_b64 exec, 1, s16
    buffer_store_dword v92, v13, s[32:35], s65 offen
    s_mov_b64 exec, -1
L_h1r:
    buffer_load_dwordx4 v[60:63], v3, s[32:35], s59 offen offset:0 sc1
    buffer_load_dwordx4 v[64:67], v3, s[32:35], s59 offen offset:1024 sc1
    buffer_load_dwordx4 v[68:71], v3, s[32:35], s59 offen offset:2048 sc1
    buffer_load_dwordx4 v[72:75], v3, s[32:35], s59 offen offset:3072 sc1
    buffer_load_dwordx4 v[80:83], v12, s[32:35], s28 offen offset:0 sc1
    buffer_load_dwordx4 v[84:87], v12, s[32:35], s28 offen offset:64 sc1
    s_mov_b64 exec, 1
    ds_write_b32 v1, v18 offset:192
    s_mov_b64 exec, -1
    s_cmp_lg_u32 s29, 0
    s_cbranch_scc1 L_q3
    s_mov_b32 s29, 2
L_q2:
    v_pk_fma_f32 v[144:145], v[112:113], s[74:75], v[184:185] op_sel_hi:[1,0,0]
    v_pk_fma_f32 v[146:147], v[114:115], s[74:75], v[184:185] op_sel_hi:[1,0,0]
    v_pk_fma_f32 v[152:153], v[120:121], s[74:75], v[184:185] op_sel:[0,0,1] op_sel_hi:[1,0,1]
    v_pk_fma_f32 v[154:155], v[122:123], s[74:75], v[184:185] op_sel:[0,0,1] op_sel_hi:[1,0,1]
    v_pk_fma_f32 v[224:225], v[128:129], s[74:75], v[186:187] op_sel_hi:[1,0,0]
    v_pk_fma_f32 v[226:227], v[130:131], s[74:75], v[186:187] op_sel_hi:[1,0,0]
    v_pk_fma_f32 v[232:233], v[136:137], s[74:75], v[186:187] op_sel:[0,0,1] op_sel_hi:[1,0,1]
    v_pk_fma_f32 v[234:235], v[138:139], s[74:75], v[186:187] op_sel:[0,0,1] op_sel_hi:[1,0,1]
    v_pk_fma_f32 v[148:149], v[116:117], s[74:75], v[184:185] op_sel_hi:[1,0,0]
    v_pk_fma_f32 v[156:157], v[124:125], s[74:75], v[184:185] op_sel:[0,0,1] op_sel_hi:[1,0,1]
    v_pk_fma_f32 v[228:229], v[132:133], s[74:75], v[186:187] op_sel_hi:[1,0,0]
    v_pk_fma_f32 v[236:237], v[140:141], s[74:75], v[186:187] op_sel:[0,0,1] op_sel_hi:[1,0,1]
    v_exp_f32 v144, v144
    v_exp_f32 v145, v145
    v_exp_f32 v146, v146
    v_exp_f32 v147, v147
    v_exp_f32 v152, v152
    v_exp_f32 v153, v153
    v_exp_f32 v154, v154
    v_exp_f32 v155, v155
    v_exp_f32 v224, v224
    v_exp_f32 v225, v225
    v_exp_f32 v226, v226
    v_exp_f32 v227, v227
    v_exp_f32 v232, v232
    v_exp_f32 v233, v233
    v_exp_f32 v234, v234
    v_exp_f32 v235, v235
    v_pk_fma_f32 v[150:151], v[118:119], s[74:75], v[184:185] op_sel_hi:[1,0,0]
    v_pk_fma_f32 v[158:159], v[126:127], s[74:75], v[184:185] op_sel:[0,0,1] op_sel_hi:[1,0,1]
    v_pk_fma_f32 v[230:231], v[134:135], s[74:75], v[186:187] op_sel_hi:[1,0,0]
    v_pk_fma_f32 v[238:239], v[142:143], s[74:75], v[186:187] op_sel:[0,0,1] op_sel_hi:[1,0,1]
    v_exp_f32 v148, v148
    v_exp_f32 v149, v149
    v_exp_f32 v156, v156
    v_exp_f32 v157, v157
    v_exp_f32 v228, v228
    v_exp_f32 v229, v229
    v_exp_f32 v236, v236
    v_exp_f32 v237, v237
    v_pk_add_f32 v[240:241], v[144:145], v[146:147]
    v_pk_add_f32 v[242:243], v[152:153], v[154:155]
    v_pk_add_f32 v[244:245], v[224:225], v[226:227]
    v_pk_add_f32 v[246:247], v[232:233], v[234:235]
    v_exp_f32 v150, v150
    v_exp_f32 v151, v151
    v_exp_f32 v158, v158
    v_exp_f32 v159, v159
    v_exp_f32 v230, v230
    v_exp_f32 v231, v231
    v_exp_f32 v238, v238
    v_exp_f32 v239, v239
    v_pk_add_f32 v[240:241], v[240:241], v[148:149]
    v_pk_add_f32 v[242:243], v[242:243], v[156:157]
    v_pk_add_f32 v[244:245], v[244:245], v[228:229]
    v_pk_add_f32 v[246:247], v[246:247], v[236:237]
    v_pk_add_f32 v[240:241], v[240:241], v[150:151]
    v_pk_add_f32 v[242:243], v[242:243], v[158:159]
    v_pk_add_f32 v[244:245], v[244:245], v[230:231]
    v_pk_add_f32 v[246:247], v[246:247], v[238:239]
    v_add_f32 v176, v240, v241
    v_add_f32 v177, v242, v243
    v_add_f32 v178, v244, v245
    v_add_f32 v179, v246, v247
    s_nop 0
    v_permlane32_swap_b32 v176, v178
    v_permlane32_swap_b32 v177, v179
    v_add_f32 v176, v176, v178
    v_add_f32 v177, v177, v179
    s_nop 1
    v_permlane16_swap_b32 v176, v177
    v_add_f32 v176, v176, v177
    v_rcp_f32 v176, v176
    s_nop 0
    v_mov_b32 v177, v176
    s_nop 1
    v_permlane16_swap_b32 v176, v177
    v_mov_b32 v178, v176
    v_mov_b32 v179, v177
    s_nop 0
    v_permlane32_swap_b32 v176, v178
    v_permlane32_swap_b32 v177, v179
    v_pk_mul_f32 v[144:145], v[144:145], v[176:177] op_sel_hi:[1,0]
    v_pk_mul_f32 v[152:153], v[152:153], v[176:177] op_sel:[0,1] op_sel_hi:[1,1]
    v_pk_mul_f32 v[224:225], v[224:225], v[178:179] op_sel_hi:[1,0]
    v_pk_mul_f32 v[232:233], v[232:233], v[178:179] op_sel:[0,1] op_sel_hi:[1,1]
    v_pk_mul_f32 v[146:147], v[146:147], v[176:177] op_sel_hi:[1,0]
    v_pk_mul_f32 v[154:155], v[154:155], v[176:177] op_sel:[0,1] op_sel_hi:[1,1]
    v_pk_mul_f32 v[226:227], v[226:227], v[178:179] op_sel_hi:[1,0]
    v_pk_mul_f32 v[234:235], v[234:235], v[178:179] op_sel:[0,1] op_sel_hi:[1,1]
    v_pk_mul_f32 v[148:149], v[148:149], v[176:177] op_sel_hi:[1,0]
    v_pk_mul_f32 v[150:151], v[150:151], v[176:177] op_sel_hi:[1,0]
    v_cvt_pk_bf16_f32 v144, v144, v145
    v_pk_mul_f32 v[156:157], v[156:157], v[176:177] op_sel:[0,1] op_sel_hi:[1,1]
    v_pk_mul_f32 v[158:159], v[158:159], v[176:177] op_sel:[0,1] op_sel_hi:[1,1]
    v_cvt_pk_bf16_f32 v152, v152, v153
    v_pk_mul_f32 v[228:229], v[228:229], v[178:179] op_sel_hi:[1,0]
    v_pk_mul_f32 v[230:231], v[230:231], v[178:179] op_sel_hi:[1,0]
    v_cvt_pk_bf16_f32 v224, v224, v225
    v_pk_mul_f32 v[236:237], v[236:237], v[178:179] op_sel:[0,1] op_sel_hi:[1,1]
    v_pk_mul_f32 v[238:239], v[238:239], v[178:179] op_sel:[0,1] op_sel_hi:[1,1]
    v_cvt_pk_bf16_f32 v232, v232, v233
    v_cvt_pk_bf16_f32 v145, v146, v147
    v_cvt_pk_bf16_f32 v153, v154, v155
    v_cvt_pk_bf16_f32 v225, v226, v227
    v_cvt_pk_bf16_f32 v233, v234, v235
    v_cvt_pk_bf16_f32 v146, v148, v149
    v_cvt_pk_bf16_f32 v147, v150, v151
    v_cvt_pk_bf16_f32 v154, v156, v157
    v_cvt_pk_bf16_f32 v155, v158, v159
    v_cvt_pk_bf16_f32 v226, v228, v229
    v_cvt_pk_bf16_f32 v227, v230, v231
    v_cvt_pk_bf16_f32 v234, v236, v237
    v_cvt_pk_bf16_f32 v235, v238, v239
    s_add_u32 s29, s29, 1
    s_cmp_eq_u32 s29, 1
    s_cbranch_scc1 L_q2r
L_q3:
    v_pk_fma_f32 v[112:113], v[112:113], s[76:77], v[188:189] op_sel_hi:[1,0,0]
    v_pk_fma_f32 v[114:115], v[114:115], s[76:77], v[188:189] op_sel_hi:[1,0,0]
    v_pk_fma_f32 v[120:121], v[120:121], s[76:77], v[188:189] op_sel:[0,0,1] op_sel_hi:[1,0,1]
    v_pk_fma_f32 v[122:123], v[122:123], s[76:77], v[188:189] op_sel:[0,0,1] op_sel_hi:[1,0,1]
    v_pk_fma_f32 v[128:129], v[128:129], s[76:77], v[190:191] op_sel_hi:[1,0,0]
    v_pk_fma_f32 v[130:131], v[130:131], s[76:77], v[190:191] op_sel_hi:[1,0,0]
    v_pk_fma_f32 v[136:137], v[136:137], s[76:77], v[190:191] op_sel:[0,0,1] op_sel_hi:[1,0,1]
    v_pk_fma_f32 v[138:139], v[138:139], s[76:77], v[190:191] op_sel:[0,0,1] op_sel_hi:[1,0,1]
    v_pk_fma_f32 v[116:117], v[116:117], s[76:77], v[188:189] op_sel_hi:[1,0,0]
    v_pk_fma_f32 v[124:125], v[124:125], s[76:77], v[188:189] op_sel:[0,0,1] op_sel_hi:[1,0,1]
    v_pk_fma_f32 v[132:133], v[132:133], s[76:77], v[190:191] op_sel_hi:[1,0,0]
    v_pk_fma_f32 v[140:141], v[140:141], s[76:77], v[190:191] op_sel:[0,0,1] op_sel_hi:[1,0,1]
    v_exp_f32 v112, v112
    v_exp_f32 v113, v113
    v_exp_f32 v114, v114
    v_exp_f32 v115, v115
    v_exp_f32 v120, v120
    v_exp_f32 v121, v121
    v_exp_f32 v122, v122
    v_exp_f32 v123, v123
    v_exp_f32 v128, v128
    v_exp_f32 v129, v129
    v_exp_f32 v130, v130
    v_exp_f32 v131, v131
    v_exp_f32 v136, v136
    v_exp_f32 v137, v137
    v_exp_f32 v138, v138
    v_exp_f32 v139, v139
    v_pk_fma_f32 v[118:119], v[118:119], s[76:77], v[188:189] op_sel_hi:[1,0,0]
    v_pk_fma_f32 v[126:127], v[126:127], s[76:77], v[188:189] op_sel:[0,0,1] op_sel_hi:[1,0,1]
    v_pk_fma_f32 v[134:135], v[134:135], s[76:77], v[190:191] op_sel_hi:[1,0,0]
    v_pk_fma_f32 v[142:143], v[142:143], s[76:77], v[190:191] op_sel:[0,0,1] op_sel_hi:[1,0,1]
    v_exp_f32 v116, v116
    v_exp_f32 v117, v117
    v_exp_f32 v124, v124
    v_exp_f32 v125, v125
    v_exp_f32 v132, v132
    v_exp_f32 v133, v133
    v_exp_f32 v140, v140
    v_exp_f32 v141, v141
    v_pk_add_f32 v[248:249], v[112:113], v[114:115]
    v_pk_add_f32 v[250:251], v[120:121], v[122:123]
    v_pk_add_f32 v[252:253], v[128:129], v[130:131]
    v_pk_add_f32 v[254:255], v[136:137], v[138:139]
    v_exp_f32 v118, v118
    v_exp_f32 v119, v119
    v_exp_f32 v126, v126
    v_exp_f32 v127, v127
    v_exp_f32 v134, v134
    v_exp_f32 v135, v135
    v_exp_f32 v142, v142
    v_exp_f32 v143, v143
    v_pk_add_f32 v[248:249], v[248:249], v[116:117]
    v_pk_add_f32 v[250:251], v[250:251], v[124:125]
    v_pk_add_f32 v[252:253], v[252:253], v[132:133]
    v_pk_add_f32 v[254:255], v[254:255], v[140:141]
    v_pk_add_f32 v[248:249], v[248:249], v[118:119]
    v_pk_add_f32 v[250:251], v[250:251], v[126:127]
    v_pk_add_f32 v[252:253], v[252:253], v[134:135]
    v_pk_add_f32 v[254:255], v[254:255], v[142:143]
    v_add_f32 v180, v248, v249
    v_add_f32 v181, v250, v251
    v_add_f32 v182, v252, v253
    v_add_f32 v183, v254, v255
    s_nop 0
    v_permlane32_swap_b32 v180, v182
    v_permlane32_swap_b32 v181, v183
    v_add_f32 v180, v180, v182
    v_add_f32 v181, v181, v183
    s_nop 1
    v_permlane16_swap_b32 v180, v181
    v_add_f32 v180, v180, v181
    v_rcp_f32 v180, v180
    s_nop 0
    v_mov_b32 v181, v180
    s_nop 1
    v_permlane16_swap_b32 v180, v181
    v_mov_b32 v182, v180
    v_mov_b32 v183, v181
    s_nop 0
    v_permlane32_swap_b32 v180, v182
    v_permlane32_swap_b32 v181, v183
    v_pk_mul_f32 v[112:113], v[112:113], v[180:181] op_sel_hi:[1,0]
    v_pk_mul_f32 v[120:121], v[120:121], v[180:181] op_sel:[0,1] op_sel_hi:[1,1]
    v_pk_mul_f32 v[128:129], v[128:129], v[182:183] op_sel_hi:[1,0]
    v_pk_mul_f32 v[136:137], v[136:137], v[182:183] op_sel:[0,1] op_sel_hi:[1,1]
    v_pk_mul_f32 v[114:115], v[114:115], v[180:181] op_sel_hi:[1,0]
    v_pk_mul_f32 v[122:123], v[122:123], v[180:181] op_sel:[0,1] op_sel_hi:[1,1]
    v_pk_mul_f32 v[130:131], v[130:131], v[182:183] op_sel_hi:[1,0]
    v_pk_mul_f32 v[138:139], v[138:139], v[182:183] op_sel:[0,1] op_sel_hi:[1,1]
    v_pk_mul_f32 v[116:117], v[116:117], v[180:181] op_sel_hi:[1,0]
    v_pk_mul_f32 v[118:119], v[118:119], v[180:181] op_sel_hi:[1,0]
    v_cvt_pk_bf16_f32 v112, v112, v113
    v_pk_mul_f32 v[124:125], v[124:125], v[180:181] op_sel:[0,1] op_sel_hi:[1,1]
    v_pk_mul_f32 v[126:127], v[126:127], v[180:181] op_sel:[0,1] op_sel_hi:[1,1]
    v_cvt_pk_bf16_f32 v120, v120, v121
    v_pk_mul_f32 v[132:133], v[132:133], v[182:183] op_sel_hi:[1,0]
    v_pk_mul_f32 v[134:135], v[134:135], v[182:183] op_sel_hi:[1,0]
    v_cvt_pk_bf16_f32 v128, v128, v129
    v_pk_mul_f32 v[140:141], v[140:141], v[182:183] op_sel:[0,1] op_sel_hi:[1,1]
    v_pk_mul_f32 v[142:143], v[142:143], v[182:183] op_sel:[0,1] op_sel_hi:[1,1]
    v_cvt_pk_bf16_f32 v136, v136, v137
    v_cvt_pk_bf16_f32 v113, v114, v115
    v_cvt_pk_bf16_f32 v121, v122, v123
    v_cvt_pk_bf16_f32 v129, v130, v131
    v_cvt_pk_bf16_f32 v137, v138, v139
    v_cvt_pk_bf16_f32 v114, v116, v117
    v_cvt_pk_bf16_f32 v115, v118, v119
    v_cvt_pk_bf16_f32 v122, v124, v125
    v_cvt_pk_bf16_f32 v123, v126, v127
    v_cvt_pk_bf16_f32 v130, v132, v133
    v_cvt_pk_bf16_f32 v131, v134, v135
    v_cvt_pk_bf16_f32 v138, v140, v141
    v_cvt_pk_bf16_f32 v139, v142, v143
L_h231:
    s_waitcnt vmcnt(0)
    v_max3_u32 v88, v60, v61, v62
    v_max3_u32 v89, v64, v65, v66
    v_max3_u32 v90, v68, v69, v70
    v_max3_u32 v91, v72, v73, v74
    v_max3_u32 v92, v80, v81, v82
    v_max3_u32 v93, v84, v85, v86
    v_max_u32 v88, v88, v63
    v_max_u32 v89, v89, v67
    v_max_u32 v90, v90, v71
    v_max_u32 v91, v91, v75
    v_max_u32 v92, v92, v83
    v_max_u32 v93, v93, v87
    v_max3_u32 v94, v88, v89, v90
    v_max3_u32 v95, v91, v92, v93
    v_max_u32 v94, v94, v95
    v_cmp_eq_u32 vcc, -1, v94
    s_cbranch_vccz L_h2k32
    v_cmp_eq_u32 s[68:69], -1, v88
    v_cmp_eq_u32 s[70:71], -1, v89
    v_cmp_eq_u32 s[72:73], -1, v90
    v_cmp_eq_u32 s[74:75], -1, v91
    v_cmp_eq_u32 s[76:77], -1, v92
    v_cmp_eq_u32 s[0:1], -1, v93
    s_mov_b64 exec, s[68:69]
    buffer_load_dwordx4 v[60:63], v3, s[32:35], s59 offen offset:0 sc1
    s_mov_b64 exec, s[70:71]
    buffer_load_dwordx4 v[64:67], v3, s[32:35], s59 offen offset:1024 sc1
    s_mov_b64 exec, s[72:73]
    buffer_load_dwordx4 v[68:71], v3, s[32:35], s59 offen offset:2048 sc1
    s_mov_b64 exec, s[74:75]
    buffer_load_dwordx4 v[72:75], v3, s[32:35], s59 offen offset:3072 sc1
    s_mov_b64 exec, s[76:77]
    buffer_load_dwordx4 v[80:83], v12, s[32:35], s28 offen offset:0 sc1
    s_mov_b64 exec, s[0:1]
    buffer_load_dwordx4 v[84:87], v12, s[32:35], s28 offen offset:64 sc1
    s_mov_b64 exec, -1
    s_add_u32 s79, s79, 1
    s_cmp_lt_u32 s79, 32768
    s_cbranch_scc1 L_h231
    s_waitcnt vmcnt(0)
L_h2k32:
    v_mfma_f32_16x16x32_bf16 v[160:163], v[80:83], v[144:147], 0
    s_mov_b32 s74, 0x358637bd
    v_mov_b32 v19, s78
    v_mfma_f32_16x16x32_bf16 v[164:167], v[80:83], v[152:155], 0
    v_mfma_f32_16x16x32_bf16 v[160:163], v[84:87], v[112:115], v[160:163]
    v_mfma_f32_16x16x32_bf16 v[164:167], v[84:87], v[120:123], v[164:167]
    v_mfma_f32_16x16x32_bf16 v[168:171], v[80:83], v[224:227], 0
    v_mfma_f32_16x16x32_bf16 v[172:175], v[80:83], v[232:235], 0
    s_nop 5
    v_cvt_pk_bf16_f32 v88, v160, v164
    v_mfma_f32_16x16x32_bf16 v[168:171], v[84:87], v[128:131], v[168:171]
    v_and_b32 v89, 0xffff0000, v88
    v_lshlrev_b32 v88, 16, v88
    v_mfma_f32_16x16x32_bf16 v[172:175], v[84:87], v[136:139], v[172:175]
    v_pk_add_f32 v[88:89], v[88:89], s[74:75] op_sel_hi:[1,0]
    v_mfma_f32_16x16x32_bf16 v[192:195], v[60:63], v[144:147], 0
    v_cvt_pk_bf16_f32 v88, v88, v89
    v_mfma_f32_16x16x32_bf16 v[196:199], v[64:67], v[144:147], 0
    s_nop 3
    v_cvt_pk_bf16_f32 v90, v168, v172
    v_and_b32 v89, 0xffff0000, v88
    v_mfma_f32_16x16x32_bf16 v[200:203], v[60:63], v[152:155], 0
    v_and_b32 v91, 0xffff0000, v90
    v_lshlrev_b32 v90, 16, v90
    v_mfma_f32_16x16x32_bf16 v[192:195], v[68:71], v[112:115], v[192:195]
    v_pk_add_f32 v[90:91], v[90:91], s[74:75] op_sel_hi:[1,0]
    v_lshlrev_b32 v88, 16, v88
    v_mfma_f32_16x16x32_bf16 v[204:207], v[64:67], v[152:155], 0
    v_cvt_pk_bf16_f32 v90, v90, v91
    v_rcp_f32 v88, v88
    v_mfma_f32_16x16x32_bf16 v[208:211], v[60:63], v[224:227], 0
    s_nop 1
    v_cvt_pk_bf16_f32 v96, v192, v193
    v_rcp_f32 v89, v89
    v_mfma_f32_16x16x32_bf16 v[196:199], v[72:75], v[112:115], v[196:199]
    v_cvt_pk_bf16_f32 v97, v194, v195
    v_and_b32 v91, 0xffff0000, v90
    v_mfma_f32_16x16x32_bf16 v[200:203], v[68:71], v[120:123], v[200:203]
    v_lshlrev_b32 v192, 16, v96
    v_and_b32 v193, 0xffff0000, v96
    v_mfma_f32_16x16x32_bf16 v[212:215], v[64:67], v[224:227], 0
    s_nop 1
    v_cvt_pk_bf16_f32 v98, v196, v197
    v_cvt_pk_bf16_f32 v99, v198, v199
    v_mfma_f32_16x16x32_bf16 v[216:219], v[60:63], v[232:235], 0
    v_cvt_pk_bf16_f32 v100, v200, v201
    v_lshlrev_b32 v90, 16, v90
    v_mfma_f32_16x16x32_bf16 v[204:207], v[72:75], v[120:123], v[204:207]
    v_lshlrev_b32 v194, 16, v97
    v_and_b32 v195, 0xffff0000, v97
    v_mfma_f32_16x16x32_bf16 v[208:211], v[68:71], v[128:131], v[208:211]
    v_cvt_pk_bf16_f32 v101, v202, v203
    v_lshlrev_b32 v196, 16, v98
    v_mfma_f32_16x16x32_bf16 v[220:223], v[64:67], v[232:235], 0
    v_and_b32 v197, 0xffff0000, v98
    v_lshlrev_b32 v198, 16, v99
    v_mfma_f32_16x16x32_bf16 v[212:215], v[72:75], v[128:131], v[212:215]
    v_and_b32 v199, 0xffff0000, v99
    v_pk_mul_f32 v[192:193], v[192:193], v[88:89] op_sel_hi:[1,0]
    v_mfma_f32_16x16x32_bf16 v[216:219], v[68:71], v[136:139], v[216:219]
    v_cvt_pk_bf16_f32 v102, v204, v205
    v_cvt_pk_bf16_f32 v103, v206, v207
    v_mfma_f32_16x16x32_bf16 v[220:223], v[72:75], v[136:139], v[220:223]
    v_lshlrev_b32 v200, 16, v100
    v_and_b32 v201, 0xffff0000, v100
    v_cvt_pk_bf16_f32 v104, v208, v209
    v_rcp_f32 v90, v90
    v_rcp_f32 v91, v91
    v_pk_mul_f32 v[194:195], v[194:195], v[88:89] op_sel_hi:[1,0]
    v_lshlrev_b32 v202, 16, v101
    v_and_b32 v203, 0xffff0000, v101
    v_cvt_pk_bf16_f32 v105, v210, v211
    v_pk_mul_f32 v[196:197], v[196:197], v[88:89] op_sel_hi:[1,0]
    v_pk_mul_f32 v[198:199], v[198:199], v[88:89] op_sel_hi:[1,0]
    v_cvt_pk_bf16_f32 v192, v192, v193
    v_lshlrev_b32 v204, 16, v102
    v_and_b32 v205, 0xffff0000, v102
    v_lshlrev_b32 v206, 16, v103
    v_and_b32 v207, 0xffff0000, v103
    v_pk_mul_f32 v[200:201], v[200:201], v[88:89] op_sel:[0,1] op_sel_hi:[1,1]
    v_cvt_pk_bf16_f32 v106, v212, v213
    v_cvt_pk_bf16_f32 v107, v214, v215
    v_lshlrev_b32 v208, 16, v104
    v_and_b32 v209, 0xffff0000, v104
    v_cvt_pk_bf16_f32 v108, v216, v217
    v_cvt_pk_bf16_f32 v193, v194, v195
    v_pk_mul_f32 v[202:203], v[202:203], v[88:89] op_sel:[0,1] op_sel_hi:[1,1]
    v_lshlrev_b32 v210, 16, v105
    v_and_b32 v211, 0xffff0000, v105
    v_cvt_pk_bf16_f32 v109, v218, v219
    v_cvt_pk_bf16_f32 v194, v196, v197
    v_cvt_pk_bf16_f32 v195, v198, v199
    v_pk_mul_f32 v[204:205], v[204:205], v[88:89] op_sel:[0,1] op_sel_hi:[1,1]
    v_pk_mul_f32 v[206:207], v[206:207], v[88:89] op_sel:[0,1] op_sel_hi:[1,1]
    v_cvt_pk_bf16_f32 v200, v200, v201
    v_lshlrev_b32 v212, 16, v106
    v_and_b32 v213, 0xffff0000, v106
    v_lshlrev_b32 v214, 16, v107
    v_and_b32 v215, 0xffff0000, v107
    v_pk_mul_f32 v[208:209], v[208:209], v[90:91] op_sel_hi:[1,0]
    v_cvt_pk_bf16_f32 v110, v220, v221
    v_cvt_pk_bf16_f32 v111, v222, v223
    v_lshlrev_b32 v216, 16, v108
    v_and_b32 v217, 0xffff0000, v108
    v_cvt_pk_bf16_f32 v201, v202, v203
    v_pk_mul_f32 v[210:211], v[210:211], v[90:91] op_sel_hi:[1,0]
    v_lshlrev_b32 v218, 16, v109
    v_and_b32 v219, 0xffff0000, v109
    buffer_store_dwordx4 v[192:195], v3, s[32:35], s52 offen sc1
    v_cvt_pk_bf16_f32 v202, v204, v205
    v_cvt_pk_bf16_f32 v203, v206, v207
    v_pk_mul_f32 v[212:213], v[212:213], v[90:91] op_sel_hi:[1,0]
    v_pk_mul_f32 v[214:215], v[214:215], v[90:91] op_sel_hi:[1,0]
    v_cvt_pk_bf16_f32 v208, v208, v209
    v_lshlrev_b32 v220, 16, v110
    v_and_b32 v221, 0xffff0000, v110
    v_lshlrev_b32 v222, 16, v111
    v_and_b32 v223, 0xffff0000, v111
    v_pk_mul_f32 v[216:217], v[216:217], v[90:91] op_sel:[0,1] op_sel_hi:[1,1]
    s_add_u32 s52, s52, 32768
    v_cvt_pk_bf16_f32 v209, v210, v211
    v_pk_mul_f32 v[218:219], v[218:219], v[90:91] op_sel:[0,1] op_sel_hi:[1,1]
    buffer_store_dwordx4 v[200:203], v3, s[32:35], s52 offen sc1
    v_cvt_pk_bf16_f32 v210, v212, v213
    v_cvt_pk_bf16_f32 v211, v214, v215
    v_pk_mul_f32 v[220:221], v[220:221], v[90:91] op_sel:[0,1] op_sel_hi:[1,1]
    v_pk_mul_f32 v[222:223], v[222:223], v[90:91] op_sel:[0,1] op_sel_hi:[1,1]
    v_cvt_pk_bf16_f32 v216, v216, v217
    s_add_u32 s52, s52, 32768
    v_cvt_pk_bf16_f32 v217, v218, v219
    buffer_store_dwordx4 v[208:211], v3, s[32:35], s52 offen sc1
    v_cvt_pk_bf16_f32 v218, v220, v221
    v_cvt_pk_bf16_f32 v219, v222, v223
    s_add_u32 s52, s52, 32768
    buffer_store_dwordx4 v[216:219], v3, s[32:35], s52 offen sc1
L_gc33:
    v_cmp_ne_u32 vcc, s78, v77
    v_cmp_ne_u32 s[84:85], s78, v79
    s_nop 1
    s_or_b64 vcc, vcc, s[84:85]
    s_cbranch_vccz L_gk34
    buffer_load_dwordx2 v[76:77], v27, s[32:35], s57 offen offset:0 sc1
    buffer_load_dwordx2 v[78:79], v27, s[32:35], s57 offen offset:64 sc1
    s_waitcnt vmcnt(0)
    s_add_u32 s79, s79, 1
    s_cmp_lt_u32 s79, 32768
    s_cbranch_scc1 L_gc33
L_gk34:
    v_and_b32 v54, 1, v2
    v_and_b32 v55, 31, v2
    v_lshlrev_b32 v54, 4, v54
    v_lshlrev_b32 v55, 2, v55
    v_lshrrev_b32 v80, v54, v76
    v_lshrrev_b32 v81, v54, v78
    v_lshlrev_b32 v82, 16, v80
    v_lshlrev_b32 v83, 16, v81
    v_sub_f32 v84, 1.0, v82
    v_sub_f32 v85, 1.0, v83
    v_cvt_pk_bf16_f32 v86, v13, v84
    v_cvt_pk_bf16_f32 v87, v13, v85
    v_lshrrev_b32 v84, 16, v86
    v_lshrrev_b32 v85, 16, v87
    v_dot2_f32_bf16 v128, v28, v84, 0
    v_dot2_f32_bf16 v129, v28, v86, 0
    v_dot2_f32_bf16 v130, v29, v84, 0
    v_dot2_f32_bf16 v131, v29, v86, 0
    v_dot2_f32_bf16 v132, v30, v84, 0
    v_dot2_f32_bf16 v133, v30, v86, 0
    v_dot2_f32_bf16 v134, v31, v84, 0
    v_dot2_f32_bf16 v135, v31, v86, 0
    v_dot2_f32_bf16 v136, v32, v84, 0
    v_dot2_f32_bf16 v137, v32, v86, 0
    v_dot2_f32_bf16 v138, v33, v84, 0
    v_dot2_f32_bf16 v139, v33, v86, 0
    v_dot2_f32_bf16 v140, v34, v84, 0
    v_dot2_f32_bf16 v141, v34, v86, 0
    v_dot2_f32_bf16 v142, v35, v84, 0
    v_dot2_f32_bf16 v143, v35, v86, 0
    v_dot2_f32_bf16 v144, v36, v85, 0
    v_dot2_f32_bf16 v145, v36, v87, 0
    v_dot2_f32_bf16 v146, v37, v85, 0
    v_dot2_f32_bf16 v147, v37, v87, 0
    v_dot2_f32_bf16 v148, v38, v85, 0
    v_dot2_f32_bf16 v149, v38, v87, 0
    v_dot2_f32_bf16 v150, v39, v85, 0
    v_dot2_f32_bf16 v151, v39, v87, 0
    v_dot2_f32_bf16 v152, v40, v85, 0
    v_dot2_f32_bf16 v153, v40, v87, 0
    v_dot2_f32_bf16 v154, v41, v85, 0
    v_dot2_f32_bf16 v155, v41, v87, 0
    v_dot2_f32_bf16 v156, v42, v85, 0
    v_dot2_f32_bf16 v157, v42, v87, 0
    v_dot2_f32_bf16 v158, v43, v85, 0
    v_dot2_f32_bf16 v159, v43, v87, 0
    v_cvt_pk_bf16_f32 v28, v128, v129
    v_cvt_pk_bf16_f32 v29, v130, v131
    v_cvt_pk_bf16_f32 v30, v132, v133
    v_cvt_pk_bf16_f32 v31, v134, v135
    v_cvt_pk_bf16_f32 v32, v136, v137
    v_cvt_pk_bf16_f32 v33, v138, v139
    v_cvt_pk_bf16_f32 v34, v140, v141
    v_cvt_pk_bf16_f32 v35, v142, v143
    v_cvt_pk_bf16_f32 v36, v144, v145
    v_cvt_pk_bf16_f32 v37, v146, v147
    v_cvt_pk_bf16_f32 v38, v148, v149
    v_cvt_pk_bf16_f32 v39, v150, v151
    v_cvt_pk_bf16_f32 v40, v152, v153
    v_cvt_pk_bf16_f32 v41, v154, v155
    v_cvt_pk_bf16_f32 v42, v156, v157
    v_cvt_pk_bf16_f32 v43, v158, v159
    s_lshr_b32 s3, s13, 2
    v_and_b32 v80, 0xffff, v80
    v_and_b32 v81, 0xffff, v81
    v_lshlrev_b32 v128, 16, v28
    v_and_b32 v129, 0xffff0000, v28
    v_lshlrev_b32 v130, 16, v29
    v_and_b32 v131, 0xffff0000, v29
    v_lshlrev_b32 v132, 16, v30
    v_and_b32 v133, 0xffff0000, v30
    v_lshlrev_b32 v134, 16, v31
    v_and_b32 v135, 0xffff0000, v31
    v_lshlrev_b32 v136, 16, v32
    v_and_b32 v137, 0xffff0000, v32
    v_lshlrev_b32 v138, 16, v33
    v_and_b32 v139, 0xffff0000, v33
    v_lshlrev_b32 v140, 16, v34
    v_and_b32 v141, 0xffff0000, v34
    v_lshlrev_b32 v142, 16, v35
    v_and_b32 v143, 0xffff0000, v35
    v_lshlrev_b32 v144, 16, v36
    v_and_b32 v145, 0xffff0000, v36
    v_lshlrev_b32 v146, 16, v37
    v_and_b32 v147, 0xffff0000, v37
    v_lshlrev_b32 v148, 16, v38
    v_and_b32 v149, 0xffff0000, v38
    v_lshlrev_b32 v150, 16, v39
    v_and_b32 v151, 0xffff0000, v39
    v_lshlrev_b32 v152, 16, v40
    v_and_b32 v153, 0xffff0000, v40
    v_lshlrev_b32 v154, 16, v41
    v_and_b32 v155, 0xffff0000, v41
    v_lshlrev_b32 v156, 16, v42
    v_and_b32 v157, 0xffff0000, v42
    v_lshlrev_b32 v158, 16, v43
    v_and_b32 v159, 0xffff0000, v43
    v_mov_b32 v160, 0
    v_mov_b32 v161, 0
    v_mov_b32 v162, 0
    v_mov_b32 v163, 0
    v_mov_b32 v164, 0
    v_mov_b32 v165, 0
    v_mov_b32 v166, 0
    v_mov_b32 v167, 0
    v_mov_b32 v168, 0
    v_mov_b32 v169, 0
    v_mov_b32 v170, 0
    v_mov_b32 v171, 0
    v_mov_b32 v172, 0
    v_mov_b32 v173, 0
    v_mov_b32 v174, 0
    v_mov_b32 v175, 0
    v_mov_b32 v176, 0
    v_mov_b32 v177, 0
    v_mov_b32 v178, 0
    v_mov_b32 v179, 0
    v_mov_b32 v180, 0
    v_mov_b32 v181, 0
    v_mov_b32 v182, 0
    v_mov_b32 v183, 0
    v_mov_b32 v184, 0
    v_mov_b32 v185, 0
    v_mov_b32 v186, 0
    v_mov_b32 v187, 0
    v_mov_b32 v188, 0
    v_mov_b32 v189, 0
    v_mov_b32 v190, 0
    v_mov_b32 v191, 0
    v_and_b32 v90, 12, v55
    s_lshl_b32 s76, s3, 12
    s_waitcnt vmcnt(0)
    s_mov_b64 exec, 1
    buffer_store_dword v19, v13, s[32:35], s53 offen sc1
    s_mov_b64 exec, -1
L_of35:
    buffer_load_dword v54, v55, s[32:35], s56 offen sc1
    ds_read_b32 v88, v90 offset:208
    ds_read_b32 v89, v13 offset:16
    s_waitcnt vmcnt(0) lgkmcnt(0)
    v_cmp_ne_u32 vcc, s78, v54
    v_cmp_ne_u32 s[74:75], v88, v18
    s_nop 1
    s_or_b64 vcc, vcc, s[74:75]
    s_cbranch_vccz L_ofk36
    s_add_u32 s79, s79, 1
    s_cmp_lt_u32 s79, 32768
    s_cbranch_scc1 L_of35
L_ofk36:
    buffer_load_dwordx4 v[192:195], v24, s[60:63], s76 offen
    buffer_load_dwordx4 v[196:199], v25, s[60:63], s76 offen
    s_add_u32 s76, s76, 1024
    s_and_b32 s76, s76, 0x7fff
    buffer_load_dwordx4 v[200:203], v24, s[60:63], s76 offen
    buffer_load_dwordx4 v[204:207], v25, s[60:63], s76 offen
    s_add_u32 s76, s76, 1024
    s_and_b32 s76, s76, 0x7fff
    buffer_load_dwordx4 v[208:211], v24, s[60:63], s76 offen
    buffer_load_dwordx4 v[212:215], v25, s[60:63], s76 offen
    s_add_u32 s76, s76, 1024
    s_and_b32 s76, s76, 0x7fff
    buffer_load_dwordx4 v[216:219], v24, s[60:63], s76 offen
    buffer_load_dwordx4 v[220:223], v25, s[60:63], s76 offen
    s_add_u32 s76, s76, 1024
    s_and_b32 s76, s76, 0x7fff
    buffer_load_dwordx4 v[224:227], v24, s[60:63], s76 offen
    buffer_load_dwordx4 v[228:231], v25, s[60:63], s76 offen
    s_add_u32 s76, s76, 1024
    s_and_b32 s76, s76, 0x7fff
    buffer_load_dwordx4 v[232:235], v24, s[60:63], s76 offen
    buffer_load_dwordx4 v[236:239], v25, s[60:63], s76 offen
    s_add_u32 s76, s76, 1024
    s_and_b32 s76, s76, 0x7fff
    buffer_load_dwordx4 v[240:243], v24, s[60:63], s76 offen
    buffer_load_dwordx4 v[244:247], v25, s[60:63], s76 offen
    s_add_u32 s76, s76, 1024
    s_and_b32 s76, s76, 0x7fff
    buffer_load_dwordx4 v[248:251], v24, s[60:63], s76 offen
    buffer_load_dwordx4 v[252:255], v25, s[60:63], s76 offen
    s_add_u32 s76, s76, 1024
    s_and_b32 s76, s76, 0x7fff
    ds_read_b64_tr_b16 v[96:97], v20 offset:0
    ds_read_b64_tr_b16 v[98:99], v20 offset:2048
    ds_read_b64_tr_b16 v[100:101], v21 offset:0
    ds_read_b64_tr_b16 v[102:103], v21 offset:2048
    ds_read_b64_tr_b16 v[104:105], v22 offset:0
    ds_read_b64_tr_b16 v[106:107], v22 offset:2048
    ds_read_b64_tr_b16 v[108:109], v23 offset:0
    ds_read_b64_tr_b16 v[110:111], v23 offset:2048
    v_readfirstlane_b32 s77, v89
    s_mov_b32 s66, 0
    s_mov_b32 s3, 32768
.p2align 6
L_p5:
    s_cmp_eq_u32 s66, 3
    s_cselect_b32 s62, 0, s62
    s_cselect_b32 s3, 0, s3
    s_waitcnt vmcnt(14) lgkmcnt(6)
    v_mfma_f32_16x16x32_bf16 v[160:163], v[96:99], v[192:195], v[160:163]
    ds_read_b64_tr_b16 v[112:113], v20 offset:4096
    v_mfma_f32_16x16x32_bf16 v[176:179], v[96:99], v[196:199], v[176:179]
    ds_read_b64_tr_b16 v[114:115], v20 offset:6144
    s_waitcnt lgkmcnt(6)
    v_mfma_f32_16x16x32_bf16 v[164:167], v[100:103], v[192:195], v[164:167]
    ds_read_b64_tr_b16 v[116:117], v21 offset:4096
    v_mfma_f32_16x16x32_bf16 v[180:183], v[100:103], v[196:199], v[180:183]
    ds_read_b64_tr_b16 v[118:119], v21 offset:6144
    s_waitcnt lgkmcnt(6)
    v_mfma_f32_16x16x32_bf16 v[168:171], v[104:107], v[192:195], v[168:171]
    ds_read_b64_tr_b16 v[120:121], v22 offset:4096
    v_mfma_f32_16x16x32_bf16 v[184:187], v[104:107], v[196:199], v[184:187]
    ds_read_b64_tr_b16 v[122:123], v22 offset:6144
    s_waitcnt lgkmcnt(6)
    v_mfma_f32_16x16x32_bf16 v[172:175], v[108:111], v[192:195], v[172:175]
    ds_read_b64_tr_b16 v[124:125], v23 offset:4096
    v_mfma_f32_16x16x32_bf16 v[188:191], v[108:111], v[196:199], v[188:191]
    ds_read_b64_tr_b16 v[126:127], v23 offset:6144
    buffer_load_dwordx4 v[192:195], v24, s[60:63], s76 offen
    buffer_load_dwordx4 v[196:199], v25, s[60:63], s76 offen
    s_add_u32 s76, s76, 1024
    s_and_b32 s76, s76, 0x7fff
    s_waitcnt vmcnt(14) lgkmcnt(6)
    v_mfma_f32_16x16x32_bf16 v[160:163], v[112:115], v[200:203], v[160:163]
    ds_read_b64_tr_b16 v[96:97], v20 offset:8192
    v_mfma_f32_16x16x32_bf16 v[176:179], v[112:115], v[204:207], v[176:179]
    ds_read_b64_tr_b16 v[98:99], v20 offset:10240
    s_waitcnt lgkmcnt(6)
    v_mfma_f32_16x16x32_bf16 v[164:167], v[116:119], v[200:203], v[164:167]
    ds_read_b64_tr_b16 v[100:101], v21 offset:8192
    v_mfma_f32_16x16x32_bf16 v[180:183], v[116:119], v[204:207], v[180:183]
    ds_read_b64_tr_b16 v[102:103], v21 offset:10240
    s_waitcnt lgkmcnt(6)
    v_mfma_f32_16x16x32_bf16 v[168:171], v[120:123], v[200:203], v[168:171]
    ds_read_b64_tr_b16 v[104:105], v22 offset:8192
    v_mfma_f32_16x16x32_bf16 v[184:187], v[120:123], v[204:207], v[184:187]
    ds_read_b64_tr_b16 v[106:107], v22 offset:10240
    s_waitcnt lgkmcnt(6)
    v_mfma_f32_16x16x32_bf16 v[172:175], v[124:127], v[200:203], v[172:175]
    ds_read_b64_tr_b16 v[108:109], v23 offset:8192
    v_mfma_f32_16x16x32_bf16 v[188:191], v[124:127], v[204:207], v[188:191]
    ds_read_b64_tr_b16 v[110:111], v23 offset:10240
    buffer_load_dwordx4 v[200:203], v24, s[60:63], s76 offen
    buffer_load_dwordx4 v[204:207], v25, s[60:63], s76 offen
    s_add_u32 s76, s76, 1024
    s_and_b32 s76, s76, 0x7fff
    s_waitcnt vmcnt(14) lgkmcnt(6)
    v_mfma_f32_16x16x32_bf16 v[160:163], v[96:99], v[208:211], v[160:163]
    ds_read_b64_tr_b16 v[112:113], v20 offset:12288
    v_mfma_f32_16x16x32_bf16 v[176:179], v[96:99], v[212:215], v[176:179]
    ds_read_b64_tr_b16 v[114:115], v20 offset:14336
    s_waitcnt lgkmcnt(6)
    v_mfma_f32_16x16x32_bf16 v[164:167], v[100:103], v[208:211], v[164:167]
    ds_read_b64_tr_b16 v[116:117], v21 offset:12288
    v_mfma_f32_16x16x32_bf16 v[180:183], v[100:103], v[212:215], v[180:183]
    ds_read_b64_tr_b16 v[118:119], v21 offset:14336
    s_waitcnt lgkmcnt(6)
    v_mfma_f32_16x16x32_bf16 v[168:171], v[104:107], v[208:211], v[168:171]
    ds_read_b64_tr_b16 v[120:121], v22 offset:12288
    v_mfma_f32_16x16x32_bf16 v[184:187], v[104:107], v[212:215], v[184:187]
    ds_read_b64_tr_b16 v[122:123], v22 offset:14336
    s_waitcnt lgkmcnt(6)
    v_mfma_f32_16x16x32_bf16 v[172:175], v[108:111], v[208:211], v[172:175]
    ds_read_b64_tr_b16 v[124:125], v23 offset:12288
    v_mfma_f32_16x16x32_bf16 v[188:191], v[108:111], v[212:215], v[188:191]
    ds_read_b64_tr_b16 v[126:127], v23 offset:14336
    buffer_load_dwordx4 v[208:211], v24, s[60:63], s76 offen
    buffer_load_dwordx4 v[212:215], v25, s[60:63], s76 offen
    s_add_u32 s76, s76, 1024
    s_and_b32 s76, s76, 0x7fff
    s_waitcnt vmcnt(14) lgkmcnt(6)
    v_mfma_f32_16x16x32_bf16 v[160:163], v[112:115], v[216:219], v[160:163]
    ds_read_b64_tr_b16 v[96:97], v20 offset:16384
    v_mfma_f32_16x16x32_bf16 v[176:179], v[112:115], v[220:223], v[176:179]
    ds_read_b64_tr_b16 v[98:99], v20 offset:18432
    s_waitcnt lgkmcnt(6)
    v_mfma_f32_16x16x32_bf16 v[164:167], v[116:119], v[216:219], v[164:167]
    ds_read_b64_tr_b16 v[100:101], v21 offset:16384
    v_mfma_f32_16x16x32_bf16 v[180:183], v[116:119], v[220:223], v[180:183]
    ds_read_b64_tr_b16 v[102:103], v21 offset:18432
    s_waitcnt lgkmcnt(6)
    v_mfma_f32_16x16x32_bf16 v[168:171], v[120:123], v[216:219], v[168:171]
    ds_read_b64_tr_b16 v[104:105], v22 offset:16384
    v_mfma_f32_16x16x32_bf16 v[184:187], v[120:123], v[220:223], v[184:187]
    ds_read_b64_tr_b16 v[106:107], v22 offset:18432
    s_waitcnt lgkmcnt(6)
    v_mfma_f32_16x16x32_bf16 v[172:175], v[124:127], v[216:219], v[172:175]
    ds_read_b64_tr_b16 v[108:109], v23 offset:16384
    v_mfma_f32_16x16x32_bf16 v[188:191], v[124:127], v[220:223], v[188:191]
    ds_read_b64_tr_b16 v[110:111], v23 offset:18432
    buffer_load_dwordx4 v[216:219], v24, s[60:63], s76 offen
    buffer_load_dwordx4 v[220:223], v25, s[60:63], s76 offen
    s_add_u32 s76, s76, 1024
    s_and_b32 s76, s76, 0x7fff
    s_waitcnt vmcnt(14) lgkmcnt(6)
    v_mfma_f32_16x16x32_bf16 v[160:163], v[96:99], v[224:227], v[160:163]
    ds_read_b64_tr_b16 v[112:113], v20 offset:20480
    v_mfma_f32_16x16x32_bf16 v[176:179], v[96:99], v[228:231], v[176:179]
    ds_read_b64_tr_b16 v[114:115], v20 offset:22528
    s_waitcnt lgkmcnt(6)
    v_mfma_f32_16x16x32_bf16 v[164:167], v[100:103], v[224:227], v[164:167]
    ds_read_b64_tr_b16 v[116:117], v21 offset:20480
    v_mfma_f32_16x16x32_bf16 v[180:183], v[100:103], v[228:231], v[180:183]
    ds_read_b64_tr_b16 v[118:119], v21 offset:22528
    s_waitcnt lgkmcnt(6)
    v_mfma_f32_16x16x32_bf16 v[168:171], v[104:107], v[224:227], v[168:171]
    ds_read_b64_tr_b16 v[120:121], v22 offset:20480
    v_mfma_f32_16x16x32_bf16 v[184:187], v[104:107], v[228:231], v[184:187]
    ds_read_b64_tr_b16 v[122:123], v22 offset:22528
    s_waitcnt lgkmcnt(6)
    v_mfma_f32_16x16x32_bf16 v[172:175], v[108:111], v[224:227], v[172:175]
    ds_read_b64_tr_b16 v[124:125], v23 offset:20480
    v_mfma_f32_16x16x32_bf16 v[188:191], v[108:111], v[228:231], v[188:191]
    ds_read_b64_tr_b16 v[126:127], v23 offset:22528
    buffer_load_dwordx4 v[224:227], v24, s[60:63], s76 offen
    buffer_load_dwordx4 v[228:231], v25, s[60:63], s76 offen
    s_add_u32 s76, s76, 1024
    s_and_b32 s76, s76, 0x7fff
    s_waitcnt vmcnt(14) lgkmcnt(6)
    v_mfma_f32_16x16x32_bf16 v[160:163], v[112:115], v[232:235], v[160:163]
    ds_read_b64_tr_b16 v[96:97], v20 offset:24576
    v_mfma_f32_16x16x32_bf16 v[176:179], v[112:115], v[236:239], v[176:179]
    ds_read_b64_tr_b16 v[98:99], v20 offset:26624
    s_waitcnt lgkmcnt(6)
    v_mfma_f32_16x16x32_bf16 v[164:167], v[116:119], v[232:235], v[164:167]
    ds_read_b64_tr_b16 v[100:101], v21 offset:24576
    v_mfma_f32_16x16x32_bf16 v[180:183], v[116:119], v[236:239], v[180:183]
    ds_read_b64_tr_b16 v[102:103], v21 offset:26624
    s_waitcnt lgkmcnt(6)
    v_mfma_f32_16x16x32_bf16 v[168:171], v[120:123], v[232:235], v[168:171]
    ds_read_b64_tr_b16 v[104:105], v22 offset:24576
    v_mfma_f32_16x16x32_bf16 v[184:187], v[120:123], v[236:239], v[184:187]
    ds_read_b64_tr_b16 v[106:107], v22 offset:26624
    s_waitcnt lgkmcnt(6)
    v_mfma_f32_16x16x32_bf16 v[172:175], v[124:127], v[232:235], v[172:175]
    ds_read_b64_tr_b16 v[108:109], v23 offset:24576
    v_mfma_f32_16x16x32_bf16 v[188:191], v[124:127], v[236:239], v[188:191]
    ds_read_b64_tr_b16 v[110:111], v23 offset:26624
    buffer_load_dwordx4 v[232:235], v24, s[60:63], s76 offen
    buffer_load_dwordx4 v[236:239], v25, s[60:63], s76 offen
    s_add_u32 s76, s76, 1024
    s_and_b32 s76, s76, 0x7fff
    s_waitcnt vmcnt(14) lgkmcnt(6)
    v_mfma_f32_16x16x32_bf16 v[160:163], v[96:99], v[240:243], v[160:163]
    ds_read_b64_tr_b16 v[112:113], v20 offset:28672
    v_mfma_f32_16x16x32_bf16 v[176:179], v[96:99], v[244:247], v[176:179]
    ds_read_b64_tr_b16 v[114:115], v20 offset:30720
    s_waitcnt lgkmcnt(6)
    v_mfma_f32_16x16x32_bf16 v[164:167], v[100:103], v[240:243], v[164:167]
    ds_read_b64_tr_b16 v[116:117], v21 offset:28672
    v_mfma_f32_16x16x32_bf16 v[180:183], v[100:103], v[244:247], v[180:183]
    ds_read_b64_tr_b16 v[118:119], v21 offset:30720
    s_waitcnt lgkmcnt(6)
    v_mfma_f32_16x16x32_bf16 v[168:171], v[104:107], v[240:243], v[168:171]
    ds_read_b64_tr_b16 v[120:121], v22 offset:28672
    v_mfma_f32_16x16x32_bf16 v[184:187], v[104:107], v[244:247], v[184:187]
    ds_read_b64_tr_b16 v[122:123], v22 offset:30720
    s_waitcnt lgkmcnt(6)
    v_mfma_f32_16x16x32_bf16 v[172:175], v[108:111], v[240:243], v[172:175]
    ds_read_b64_tr_b16 v[124:125], v23 offset:28672
    v_mfma_f32_16x16x32_bf16 v[188:191], v[108:111], v[244:247], v[188:191]
    ds_read_b64_tr_b16 v[126:127], v23 offset:30720
    buffer_load_dwordx4 v[240:243], v24, s[60:63], s76 offen
    buffer_load_dwordx4 v[244:247], v25, s[60:63], s76 offen
    s_add_u32 s76, s76, 1024
    s_and_b32 s76, s76, 0x7fff
    v_add_u32 v20, s3, v20
    v_add_u32 v21, s3, v21
    v_add_u32 v22, s3, v22
    v_add_u32 v23, s3, v23
    s_waitcnt vmcnt(14) lgkmcnt(6)
    v_mfma_f32_16x16x32_bf16 v[160:163], v[112:115], v[248:251], v[160:163]
    ds_read_b64_tr_b16 v[96:97], v20 offset:0
    v_mfma_f32_16x16x32_bf16 v[176:179], v[112:115], v[252:255], v[176:179]
    ds_read_b64_tr_b16 v[98:99], v20 offset:2048
    s_waitcnt lgkmcnt(6)
    v_mfma_f32_16x16x32_bf16 v[164:167], v[116:119], v[248:251], v[164:167]
    ds_read_b64_tr_b16 v[100:101], v21 offset:0
    v_mfma_f32_16x16x32_bf16 v[180:183], v[116:119], v[252:255], v[180:183]
    ds_read_b64_tr_b16 v[102:103], v21 offset:2048
    s_waitcnt lgkmcnt(6)
    v_mfma_f32_16x16x32_bf16 v[168:171], v[120:123], v[248:251], v[168:171]
    ds_read_b64_tr_b16 v[104:105], v22 offset:0
    v_mfma_f32_16x16x32_bf16 v[184:187], v[120:123], v[252:255], v[184:187]
    ds_read_b64_tr_b16 v[106:107], v22 offset:2048
    s_waitcnt lgkmcnt(6)
    v_mfma_f32_16x16x32_bf16 v[172:175], v[124:127], v[248:251], v[172:175]
    ds_read_b64_tr_b16 v[108:109], v23 offset:0
    v_mfma_f32_16x16x32_bf16 v[188:191], v[124:127], v[252:255], v[188:191]
    ds_read_b64_tr_b16 v[110:111], v23 offset:2048
    buffer_load_dwordx4 v[248:251], v24, s[60:63], s76 offen
    buffer_load_dwordx4 v[252:255], v25, s[60:63], s76 offen
    s_add_u32 s76, s76, 1024
    s_and_b32 s76, s76, 0x7fff
    s_add_u32 s66, s66, 1
    s_cmp_lt_u32 s66, 4
    s_cbranch_scc1 L_p5
    s_waitcnt lgkmcnt(0)
    s_lshr_b32 s77, s77, 4
    s_and_b32 s77, s77, 2047
    s_sub_u32 s77, 2047, s77
    s_lshr_b32 s19, s77, 5
    s_cmp_eq_u32 s19, s58
    s_cbranch_scc1 L_own
L_ownret:
    v_cvt_pk_bf16_f32 v160, v160, v161
    v_cvt_pk_bf16_f32 v161, v162, v163
    v_cvt_pk_bf16_f32 v168, v168, v169
    v_cvt_pk_bf16_f32 v162, v164, v165
    v_cvt_pk_bf16_f32 v163, v166, v167
    v_cvt_pk_bf16_f32 v169, v170, v171
    v_cvt_pk_bf16_f32 v176, v176, v177
    v_cvt_pk_bf16_f32 v170, v172, v173
    v_cvt_pk_bf16_f32 v171, v174, v175
    v_cvt_pk_bf16_f32 v177, v178, v179
    v_cvt_pk_bf16_f32 v184, v184, v185
    v_cvt_pk_bf16_f32 v178, v180, v181
    v_cvt_pk_bf16_f32 v179, v182, v183
    v_cvt_pk_bf16_f32 v185, v186, v187
    v_permlane16_swap_b32 v160, v162
    v_permlane16_swap_b32 v161, v163
    v_cvt_pk_bf16_f32 v186, v188, v189
    v_cvt_pk_bf16_f32 v187, v190, v191
    v_permlane16_swap_b32 v168, v170
    v_permlane16_swap_b32 v169, v171
    v_dot2_f32_bf16 v96, v160, v80, 0
    v_dot2_f32_bf16 v97, v160, v82, 0
    v_dot2_f32_bf16 v98, v161, v80, 0
    v_dot2_f32_bf16 v99, v161, v82, 0
    v_dot2_f32_bf16 v100, v162, v80, 0
    v_dot2_f32_bf16 v101, v162, v82, 0
    v_dot2_f32_bf16 v102, v163, v80, 0
    v_dot2_f32_bf16 v103, v163, v82, 0
    v_permlane16_swap_b32 v176, v178
    v_permlane16_swap_b32 v177, v179
    v_dot2_f32_bf16 v104, v168, v80, 0
    v_dot2_f32_bf16 v105, v168, v82, 0
    v_dot2_f32_bf16 v106, v169, v80, 0
    v_dot2_f32_bf16 v107, v169, v82, 0
    v_dot2_f32_bf16 v108, v170, v80, 0
    v_dot2_f32_bf16 v109, v170, v82, 0
    v_dot2_f32_bf16 v110, v171, v80, 0
    v_dot2_f32_bf16 v111, v171, v82, 0
    v_permlane16_swap_b32 v184, v186
    v_permlane16_swap_b32 v185, v187
    v_dot2_f32_bf16 v112, v176, v81, 0
    v_dot2_f32_bf16 v113, v176, v83, 0
    v_dot2_f32_bf16 v114, v177, v81, 0
    v_dot2_f32_bf16 v115, v177, v83, 0
    v_dot2_f32_bf16 v116, v178, v81, 0
    v_dot2_f32_bf16 v117, v178, v83, 0
    v_dot2_f32_bf16 v118, v179, v81, 0
    v_dot2_f32_bf16 v119, v179, v83, 0
    v_dot2_f32_bf16 v120, v184, v81, 0
    v_dot2_f32_bf16 v121, v184, v83, 0
    v_dot2_f32_bf16 v122, v185, v81, 0
    v_dot2_f32_bf16 v123, v185, v83, 0
    v_dot2_f32_bf16 v124, v186, v81, 0
    v_dot2_f32_bf16 v125, v186, v83, 0
    v_dot2_f32_bf16 v126, v187, v81, 0
    v_dot2_f32_bf16 v127, v187, v83, 0
    v_cvt_pk_bf16_f32 v160, v96, v97
    v_cvt_pk_bf16_f32 v161, v98, v99
    v_cvt_pk_bf16_f32 v162, v100, v101
    v_cvt_pk_bf16_f32 v163, v102, v103
    s_mov_b32 s74, 0x3f80
    s_mov_b32 s75, 0x3f800000
    v_cvt_pk_bf16_f32 v168, v104, v105
    v_cvt_pk_bf16_f32 v169, v106, v107
    v_cvt_pk_bf16_f32 v170, v108, v109
    v_cvt_pk_bf16_f32 v171, v110, v111
    v_dot2_f32_bf16 v96, v160, s74, v128
    v_dot2_f32_bf16 v97, v160, s75, v129
    v_dot2_f32_bf16 v98, v161, s74, v130
    v_dot2_f32_bf16 v99, v161, s75, v131
    v_dot2_f32_bf16 v100, v162, s74, v132
    v_dot2_f32_bf16 v101, v162, s75, v133
    v_dot2_f32_bf16 v102, v163, s74, v134
    v_dot2_f32_bf16 v103, v163, s75, v135
    v_cvt_pk_bf16_f32 v176, v112, v113
    v_cvt_pk_bf16_f32 v177, v114, v115
    v_cvt_pk_bf16_f32 v178, v116, v117
    v_cvt_pk_bf16_f32 v179, v118, v119
    v_dot2_f32_bf16 v104, v168, s74, v136
    v_dot2_f32_bf16 v105, v168, s75, v137
    v_dot2_f32_bf16 v106, v169, s74, v138
    v_dot2_f32_bf16 v107, v169, s75, v139
    v_dot2_f32_bf16 v108, v170, s74, v140
    v_dot2_f32_bf16 v109, v170, s75, v141
    v_dot2_f32_bf16 v110, v171, s74, v142
    v_dot2_f32_bf16 v111, v171, s75, v143
    v_cvt_pk_bf16_f32 v184, v120, v121
    v_cvt_pk_bf16_f32 v185, v122, v123
    v_cvt_pk_bf16_f32 v186, v124, v125
    v_cvt_pk_bf16_f32 v187, v126, v127
    v_dot2_f32_bf16 v112, v176, s74, v144
    v_dot2_f32_bf16 v113, v176, s75, v145
    v_dot2_f32_bf16 v114, v177, s74, v146
    v_dot2_f32_bf16 v115, v177, s75, v147
    v_dot2_f32_bf16 v116, v178, s74, v148
    v_dot2_f32_bf16 v117, v178, s75, v149
    v_dot2_f32_bf16 v118, v179, s74, v150
    v_dot2_f32_bf16 v119, v179, s75, v151
    v_dot2_f32_bf16 v120, v184, s74, v152
    v_dot2_f32_bf16 v121, v184, s75, v153
    v_dot2_f32_bf16 v122, v185, s74, v154
    v_dot2_f32_bf16 v123, v185, s75, v155
    v_dot2_f32_bf16 v124, v186, s74, v156
    v_dot2_f32_bf16 v125, v186, s75, v157
    v_dot2_f32_bf16 v126, v187, s74, v158
    v_dot2_f32_bf16 v127, v187, s75, v159
    v_cvt_pk_bf16_f32 v160, v96, v97
    v_cvt_pk_bf16_f32 v161, v98, v99
    v_cvt_pk_bf16_f32 v162, v100, v101
    v_cvt_pk_bf16_f32 v163, v102, v103
    v_cvt_pk_bf16_f32 v168, v104, v105
    v_cvt_pk_bf16_f32 v169, v106, v107
    v_cvt_pk_bf16_f32 v170, v108, v109
    v_cvt_pk_bf16_f32 v171, v110, v111
    buffer_store_dwordx4 v[160:163], v26, s[44:47], s54 offen offset:0 sc1
    v_cvt_pk_bf16_f32 v176, v112, v113
    v_cvt_pk_bf16_f32 v177, v114, v115
    v_cvt_pk_bf16_f32 v178, v116, v117
    v_cvt_pk_bf16_f32 v179, v118, v119
    buffer_store_dwordx4 v[168:171], v26, s[44:47], s54 offen offset:64 sc1
    v_cvt_pk_bf16_f32 v184, v120, v121
    v_cvt_pk_bf16_f32 v185, v122, v123
    v_cvt_pk_bf16_f32 v186, v124, v125
    v_cvt_pk_bf16_f32 v187, v126, v127
    buffer_store_dwordx4 v[176:179], v26, s[44:47], s55 offen offset:0 sc1
    buffer_store_dwordx4 v[184:187], v26, s[44:47], s55 offen offset:64 sc1
    s_endpgm
L_own:
    v_and_b32 v54, 16, v2
    v_lshlrev_b32 v54, 2, v54
    v_and_b32 v55, 32, v2
    v_add_u32 v54, v54, v55
L_xo37:
    ds_read_b32 v88, v13 offset:224
    ds_read_b128 v[96:99], v54 offset:512
    ds_read_b128 v[100:103], v54 offset:528
    ds_read_b128 v[104:107], v54 offset:640
    ds_read_b128 v[108:111], v54 offset:656
    s_waitcnt lgkmcnt(0)
    v_cmp_ne_u32 vcc, v88, v18
    s_cbranch_vccz L_xk38
    s_add_u32 s79, s79, 1
    s_cmp_lt_u32 s79, 32768
    s_cbranch_scc1 L_xo37
L_xk38:
    s_and_b32 s77, s77, 31
    v_and_b32 v54, 15, v2
    v_cmp_eq_u32 vcc, s77, v54
    s_nop 1
    v_cndmask_b32 v128, v128, v96, vcc
    v_cndmask_b32 v129, v129, v97, vcc
    v_cndmask_b32 v130, v130, v98, vcc
    v_cndmask_b32 v131, v131, v99, vcc
    v_cndmask_b32 v132, v132, v100, vcc
    v_cndmask_b32 v133, v133, v101, vcc
    v_cndmask_b32 v134, v134, v102, vcc
    v_cndmask_b32 v135, v135, v103, vcc
    v_cndmask_b32 v136, v136, v104, vcc
    v_cndmask_b32 v137, v137, v105, vcc
    v_cndmask_b32 v138, v138, v106, vcc
    v_cndmask_b32 v139, v139, v107, vcc
    v_cndmask_b32 v140, v140, v108, vcc
    v_cndmask_b32 v141, v141, v109, vcc
    v_cndmask_b32 v142, v142, v110, vcc
    v_cndmask_b32 v143, v143, v111, vcc
    v_add_u32 v54, 16, v54
    v_cmp_eq_u32 vcc, s77, v54
    s_nop 1
    v_cndmask_b32 v144, v144, v96, vcc
    v_cndmask_b32 v145, v145, v97, vcc
    v_cndmask_b32 v146, v146, v98, vcc
    v_cndmask_b32 v147, v147, v99, vcc
    v_cndmask_b32 v148, v148, v100, vcc
    v_cndmask_b32 v149, v149, v101, vcc
    v_cndmask_b32 v150, v150, v102, vcc
    v_cndmask_b32 v151, v151, v103, vcc
    v_cndmask_b32 v152, v152, v104, vcc
    v_cndmask_b32 v153, v153, v105, vcc
    v_cndmask_b32 v154, v154, v106, vcc
    v_cndmask_b32 v155, v155, v107, vcc
    v_cndmask_b32 v156, v156, v108, vcc
    v_cndmask_b32 v157, v157, v109, vcc
    v_cndmask_b32 v158, v158, v110, vcc
    v_cndmask_b32 v159, v159, v111, vcc
    s_branch L_ownret
L_k2s:
    v_pk_add_f32 v[192:193], v[192:193], v[120:121]
    v_pk_add_f32 v[194:195], v[194:195], v[122:123]
    v_bfi_b32 v192, v15, s80, v192
    v_bfi_b32 v193, v15, s81, v193
    v_bfi_b32 v194, v15, s82, v194
    v_bfi_b32 v195, v15, s83, v195
    v_pk_add_f32 v[196:197], v[196:197], v[124:125]
    v_pk_add_f32 v[198:199], v[198:199], v[126:127]
    v_bfi_b32 v196, v15, s80, v196
    v_bfi_b32 v197, v15, s81, v197
    v_bfi_b32 v198, v15, s82, v198
    v_bfi_b32 v199, v15, s83, v199
    v_pk_add_f32 v[200:201], v[200:201], v[128:129]
    v_pk_add_f32 v[202:203], v[202:203], v[130:131]
    buffer_store_dwordx4 v[192:195], v3, s[32:35], s48 offen sc1
    s_add_u32 s48, s48, 16384
    v_bfi_b32 v200, v15, s80, v200
    v_bfi_b32 v201, v15, s81, v201
    v_bfi_b32 v202, v15, s82, v202
    v_bfi_b32 v203, v15, s83, v203
    v_pk_add_f32 v[204:205], v[204:205], v[132:133]
    v_pk_add_f32 v[206:207], v[206:207], v[134:135]
    buffer_store_dwordx4 v[196:199], v3, s[32:35], s48 offen sc1
    s_add_u32 s48, s48, 16384
    v_bfi_b32 v204, v15, s80, v204
    v_bfi_b32 v205, v15, s81, v205
    v_bfi_b32 v206, v15, s82, v206
    v_bfi_b32 v207, v15, s83, v207
    v_pk_add_f32 v[208:209], v[208:209], v[112:113]
    v_pk_add_f32 v[210:211], v[210:211], v[114:115]
    v_pk_add_f32 v[212:213], v[212:213], v[116:117]
    v_pk_add_f32 v[214:215], v[214:215], v[118:119]
    buffer_store_dwordx4 v[200:203], v3, s[32:35], s48 offen sc1
    s_add_u32 s48, s48, 16384
    v_bfi_b32 v208, v15, s80, v208
    v_bfi_b32 v209, v15, s81, v209
    v_bfi_b32 v210, v15, s82, v210
    v_bfi_b32 v211, v15, s83, v211
    v_bfi_b32 v212, v15, s80, v212
    v_bfi_b32 v213, v15, s81, v213
    v_bfi_b32 v214, v15, s82, v214
    v_bfi_b32 v215, v15, s83, v215
    buffer_store_dwordx4 v[204:207], v3, s[32:35], s48 offen sc1
    s_mov_b32 exec_lo, 0x10001
    s_mov_b32 exec_hi, 0x10001
    buffer_store_dwordx4 v[208:211], v8, s[32:35], s49 offen offset:0 sc1
    buffer_store_dwordx4 v[212:215], v8, s[32:35], s49 offen offset:1024 sc1
    s_mov_b64 exec, -1
    s_branch L_k2r
L_h1s:
    s_mov_b32 exec_lo, 0xffff
    s_mov_b32 exec_hi, 0xffff
    buffer_store_dword v96, v11, s[32:35], s64 offen sc1
    s_lshl_b64 exec, 1, s16
    buffer_store_dword v92, v13, s[32:35], s65 offen sc1
    s_mov_b64 exec, -1
    s_branch L_h1r
L_end:
    s_endpgm
.section .rodata,"a"
.p2align 6
.amdhsa_kernel fk_kernel
  .amdhsa_next_free_vgpr 256
  .amdhsa_next_free_sgpr 102
  .amdhsa_accum_offset 256
  .amdhsa_group_segment_fixed_size 0
  .amdhsa_kernarg_size 104
  .amdhsa_user_sgpr_count 2
  .amdhsa_user_sgpr_kernarg_segment_ptr 1
  .amdhsa_system_sgpr_workgroup_id_x 1
.end_amdhsa_kernel
```

```asm
; @launch kernel=fk_kernel grid=(256,1,1) block=(512,1,1) lds=163840
.amdgcn_target "amdgcn-amd-amdhsa--gfx950"
.text
.globl fk_kernel
.p2align 8
.type fk_kernel,@function
fk_kernel:
    s_load_dwordx4 s[4:7], s[0:1], 0
    s_load_dwordx4 s[8:11], s[0:1], 16
    s_load_dwordx16 s[84:99], s[0:1], 40
    s_cmp_ge_u32 s2, 256
    s_cbranch_scc1 L_end
    v_lshrrev_b32 v1, 6, v0
    v_and_b32 v2, 63, v0
    v_readfirstlane_b32 s16, v1
    v_lshrrev_b32 v4, 3, v2
    v_lshlrev_b32 v5, 11, v4
    v_and_b32 v6, 7, v2
    v_lshrrev_b32 v7, 4, v2
    v_xor_b32 v8, v6, v7
    v_lshl_add_u32 v10, v8, 4, v5
    v_xor_b32 v8, 4, v8
    v_lshl_add_u32 v11, v8, 4, v5
    v_mul_u32_u24 v5, 6144, v4
    v_and_b32 v7, 1, v7
    v_lshlrev_b32 v7, 2, v7
    v_xor_b32 v8, v6, v7
    s_and_b32 s12, s2, 7
    s_lshr_b32 s13, s2, 3
    s_and_b32 s14, s13, 15
    s_lshl_b32 s15, s12, 1
    s_lshr_b32 s19, s13, 4
    s_add_u32 s15, s15, s19
    s_and_b32 s17, s16, 3
    s_and_b32 s19, s16, 1
    s_lshl_b32 s19, s19, 1
    v_xor_b32 v8, s19, v8
    v_lshl_add_u32 v12, v8, 4, v5
    s_lshl_b32 s19, s14, 18
    v_add_u32 v10, s19, v10
    v_add_u32 v11, s19, v11
    s_lshl_b32 s19, s15, 7
    v_add_u32 v12, s19, v12
    s_lshl_b32 s64, s15, 1
    s_add_u32 s64, s64, s14
    s_and_b32 s64, s64, 3
    s_add_u32 s65, s12, 0
    s_and_b32 s65, s65, 3
    s_lshl_b32 s65, s65, 2
    s_and_b32 s72, s64, 3
    s_add_u32 s72, s72, s65
    s_mul_i32 s73, s72, 393216
    s_lshl_b32 s72, s72, 7
    s_lshl_b32 s74, s16, 15
    s_add_u32 s72, s72, s74
    s_mul_i32 s74, s16, 49152
    s_add_u32 s73, s73, s74
    s_lshl_b32 s75, s16, 10
    s_lshl_b32 m0, s16, 11
    s_add_u32 s74, s72, 16384
    s_waitcnt lgkmcnt(0)
    s_mov_b64 s[24:25], s[4:5]
    s_mov_b32 s26, 4194304
    s_mov_b32 s27, 0x00020000
    buffer_load_dwordx4 v10, s[24:27], s72 offen lds
    s_addk_i32 m0, 1024
    s_mov_b64 s[28:29], s[6:7]
    s_mov_b32 s30, 6291456
    s_mov_b32 s31, 0x00020000
    buffer_load_dwordx4 v11, s[24:27], s74 offen lds
    s_add_u32 m0, s75, 16384
    s_nop 0
    buffer_load_dwordx4 v12, s[28:31], s73 offen lds
    s_add_u32 m0, s75, 24576
    s_addk_i32 s73, 2048
    buffer_load_dwordx4 v12, s[28:31], s73 offen lds
    s_add_u32 m0, s75, 32768
    s_addk_i32 s73, 2048
    buffer_load_dwordx4 v12, s[28:31], s73 offen lds
    s_cmp_lt_u32 s16, 4
    s_cbranch_scc1 L_compute
    s_bfe_u32 s19, s14, 0x10002
    s_lshl_b32 s19, s19, 2
    s_add_u32 s19, s19, s17
    s_xor_b32 s3, s19, 4
    s_mul_i32 s66, s19, 49152
    s_mul_i32 s67, s3, 49152
    s_lshl_b32 s68, s19, 10
    s_add_u32 s68, s68, 16384
    s_lshl_b32 s69, s3, 10
    s_add_u32 s69, s69, 16384
    s_lshl_b32 s70, s17, 16
    s_lshl_b32 s71, s17, 12
    s_add_u32 s72, s64, 1
    s_and_b32 s72, s72, 3
    s_add_u32 s73, s65, 0
    s_and_b32 s73, s73, 15
    s_add_u32 s72, s72, s73
    s_mul_i32 s73, s72, 393216
    s_lshl_b32 s72, s72, 7
    s_add_u32 s74, s72, s70
    s_add_u32 s75, s73, s66
    s_add_u32 s76, s73, s67
    s_add_u32 m0, s71, 40960
    s_add_u32 s77, s74, 0
    buffer_load_dwordx4 v10, s[24:27], s77 offen lds
    s_add_u32 m0, s71, 41984
    s_add_u32 s77, s74, 16384
    buffer_load_dwordx4 v11, s[24:27], s77 offen lds
    s_add_u32 m0, s71, 43008
    s_add_u32 s77, s74, 32768
    buffer_load_dwordx4 v10, s[24:27], s77 offen lds
    s_add_u32 m0, s71, 44032
    s_add_u32 s77, s74, 49152
    buffer_load_dwordx4 v11, s[24:27], s77 offen lds
    s_add_u32 m0, s68, 40960
    s_add_u32 s77, s75, 0
    buffer_load_dwordx4 v12, s[28:31], s77 offen lds
    s_add_u32 m0, s68, 49152
    s_add_u32 s77, s75, 2048
    buffer_load_dwordx4 v12, s[28:31], s77 offen lds
    s_add_u32 m0, s68, 57344
    s_add_u32 s77, s75, 4096
    buffer_load_dwordx4 v12, s[28:31], s77 offen lds
    s_add_u32 m0, s69, 40960
    s_add_u32 s77, s76, 0
    buffer_load_dwordx4 v12, s[28:31], s77 offen lds
    s_mov_b64 s[32:33], s[98:99]
    s_mov_b32 s34, 16777216
    s_mov_b32 s35, 0x00020000
    s_mov_b64 s[36:37], s[96:97]
    s_mov_b32 s38, 256
    s_mov_b32 s39, 0x00020000
    s_mov_b64 s[40:41], s[84:85]
    s_mov_b32 s42, 2048
    s_mov_b32 s43, 0x00020000
    s_mov_b64 s[44:45], s[92:93]
    s_mov_b32 s46, 2048
    s_mov_b32 s47, 0x00020000
    s_mov_b64 s[48:49], s[86:87]
    s_mov_b32 s50, 7340032
    s_mov_b32 s51, 0x00020000
    s_mov_b64 s[52:53], s[88:89]
    s_mov_b32 s54, 7340032
    s_mov_b32 s55, 0x00020000
    s_mov_b64 s[56:57], s[90:91]
    s_mov_b32 s58, 7340032
    s_mov_b32 s59, 0x00020000
    s_mov_b64 s[60:61], s[10:11]
    s_mov_b32 s62, 2097152
    s_mov_b32 s63, 0x00020000
    s_mov_b32 s79, 0
    v_mov_b32 v13, 0
    v_lshlrev_b32 v3, 4, v2
    v_lshrrev_b32 v9, 4, v2
    v_and_b32 v8, 15, v2
    v_mul_u32_u24 v15, 7168, v9
    v_lshl_add_u32 v15, v8, 4, v15
    v_lshlrev_b32 v16, 11, v9
    v_lshl_add_u32 v16, v8, 4, v16
    v_lshrrev_b32 v19, 3, v2
    v_and_b32 v20, 7, v2
    v_lshlrev_b32 v17, 11, v19
    v_lshl_add_u32 v17, v20, 4, v17
    v_lshlrev_b32 v21, 1, v9
    v_xor_b32 v21, v20, v21
    v_lshlrev_b32 v18, 7, v19
    v_lshl_add_u32 v18, v21, 4, v18
    s_lshl_b32 s19, s17, 10
    s_add_u32 s19, s19, 32768
    v_add_u32 v18, s19, v18
    v_add_u32 v22, 65536, v18
    v_mov_b32 v23, 0xffff
    v_mov_b32 v24, 0xffff0000
    v_cmp_eq_u32 vcc, 0, v8
    s_nop 1
    v_cndmask_b32 v25, 0, v23, vcc
    v_cmp_eq_u32 vcc, 1, v8
    s_nop 1
    v_cndmask_b32 v4, v25, v24, vcc
    v_cmp_eq_u32 vcc, 2, v8
    s_nop 1
    v_cndmask_b32 v25, 0, v23, vcc
    v_cmp_eq_u32 vcc, 3, v8
    s_nop 1
    v_cndmask_b32 v5, v25, v24, vcc
    v_cmp_eq_u32 vcc, 4, v8
    s_nop 1
    v_cndmask_b32 v25, 0, v23, vcc
    v_cmp_eq_u32 vcc, 5, v8
    s_nop 1
    v_cndmask_b32 v6, v25, v24, vcc
    v_cmp_eq_u32 vcc, 6, v8
    s_nop 1
    v_cndmask_b32 v25, 0, v23, vcc
    v_cmp_eq_u32 vcc, 7, v8
    s_nop 1
    v_cndmask_b32 v7, v25, v24, vcc
    v_mov_b32 v23, 0x3ff
    s_getreg_b32 s23, hwreg(HW_REG_XCC_ID, 0, 4)
    v_and_b32 v36, 3, v2
    v_lshlrev_b32 v36, 2, v36
    v_mov_b32 v37, 0x7fc17fc1
    s_cmp_lt_u32 s2, 224
    s_cselect_b32 s50, s50, 0
    s_cselect_b32 s54, s54, 0
    s_lshl_b32 s0, s12, 7
    s_lshl_b32 s19, s17, 5
    s_add_u32 s0, s0, s19
    s_mul_i32 s1, s0, 7168
    s_lshl_b32 s19, s13, 8
    s_add_u32 s1, s1, s19
    s_waitcnt vmcnt(8)
    s_barrier
    s_add_u32 m0, s69, 49152
    s_add_u32 s77, s76, 2048
    buffer_load_dwordx4 v12, s[28:31], s77 offen lds
    s_add_u32 m0, s69, 57344
    s_add_u32 s77, s76, 4096
    buffer_load_dwordx4 v12, s[28:31], s77 offen lds
    s_add_u32 s72, s64, 2
    s_and_b32 s72, s72, 3
    s_add_u32 s73, s65, 0
    s_and_b32 s73, s73, 15
    s_add_u32 s72, s72, s73
    s_mul_i32 s73, s72, 393216
    s_lshl_b32 s72, s72, 7
    s_add_u32 s74, s72, s70
    s_add_u32 s75, s73, s66
    s_add_u32 s76, s73, s67
    s_add_u32 m0, s71, 81920
    s_add_u32 s77, s74, 0
    buffer_load_dwordx4 v10, s[24:27], s77 offen lds
    s_add_u32 m0, s71, 82944
    s_add_u32 s77, s74, 16384
    buffer_load_dwordx4 v11, s[24:27], s77 offen lds
    s_add_u32 m0, s71, 83968
    s_add_u32 s77, s74, 32768
    buffer_load_dwordx4 v10, s[24:27], s77 offen lds
    s_add_u32 m0, s71, 84992
    s_add_u32 s77, s74, 49152
    buffer_load_dwordx4 v11, s[24:27], s77 offen lds
    s_add_u32 m0, s68, 81920
    s_add_u32 s77, s75, 0
    buffer_load_dwordx4 v12, s[28:31], s77 offen lds
    s_add_u32 m0, s68, 90112
    s_add_u32 s77, s75, 2048
    buffer_load_dwordx4 v12, s[28:31], s77 offen lds
    s_add_u32 m0, s68, 98304
    s_add_u32 s77, s75, 4096
    buffer_load_dwordx4 v12, s[28:31], s77 offen lds
    s_add_u32 m0, s69, 81920
    s_add_u32 s77, s76, 0
    buffer_load_dwordx4 v12, s[28:31], s77 offen lds
    s_add_u32 m0, s69, 90112
    s_add_u32 s77, s76, 2048
    buffer_load_dwordx4 v12, s[28:31], s77 offen lds
    s_lshl_b32 s18, s14, 7
    s_lshl_b32 s19, s15, 3
    s_add_u32 s18, s18, s19
    s_lshl_b32 s19, s17, 1
    s_add_u32 s18, s18, s19
    s_lshl_b32 s19, s18, 11
    buffer_load_dwordx4 v[40:43], v3, s[24:27], s19 offen offset:0
    buffer_load_dwordx4 v[44:47], v3, s[24:27], s19 offen offset:1024
    buffer_load_dwordx4 v[48:51], v3, s[24:27], s19 offen offset:2048
    buffer_load_dwordx4 v[52:55], v3, s[24:27], s19 offen offset:3072
    buffer_load_dwordx4 v[56:59], v3, s[40:43], 0 offen offset:0
    buffer_load_dwordx4 v[60:63], v3, s[40:43], 0 offen offset:1024
    buffer_load_dwordx4 v[64:67], v3, s[44:47], 0 offen offset:0
    buffer_load_dwordx4 v[68:71], v3, s[44:47], 0 offen offset:1024
    s_waitcnt vmcnt(17)
    s_barrier
    s_add_u32 m0, s69, 98304
    s_add_u32 s77, s76, 4096
    buffer_load_dwordx4 v12, s[28:31], s77 offen lds
    s_add_u32 s72, s64, 3
    s_and_b32 s72, s72, 3
    s_add_u32 s73, s65, 0
    s_and_b32 s73, s73, 15
    s_add_u32 s72, s72, s73
    s_mul_i32 s73, s72, 393216
    s_lshl_b32 s72, s72, 7
    s_add_u32 s74, s72, s70
    s_add_u32 s75, s73, s66
    s_add_u32 s76, s73, s67
    s_add_u32 m0, s71, 122880
    s_add_u32 s77, s74, 0
    buffer_load_dwordx4 v10, s[24:27], s77 offen lds
    s_add_u32 m0, s71, 123904
    s_add_u32 s77, s74, 16384
    buffer_load_dwordx4 v11, s[24:27], s77 offen lds
    s_add_u32 m0, s71, 124928
    s_add_u32 s77, s74, 32768
    buffer_load_dwordx4 v10, s[24:27], s77 offen lds
    s_add_u32 m0, s71, 125952
    s_add_u32 s77, s74, 49152
    buffer_load_dwordx4 v11, s[24:27], s77 offen lds
    s_add_u32 m0, s68, 122880
    s_add_u32 s77, s75, 0
    buffer_load_dwordx4 v12, s[28:31], s77 offen lds
    s_add_u32 m0, s68, 131072
    s_add_u32 s77, s75, 2048
    buffer_load_dwordx4 v12, s[28:31], s77 offen lds
    s_add_u32 m0, s68, 139264
    s_add_u32 s77, s75, 4096
    buffer_load_dwordx4 v12, s[28:31], s77 offen lds
    s_add_u32 m0, s69, 122880
    s_add_u32 s77, s76, 0
    buffer_load_dwordx4 v12, s[28:31], s77 offen lds
    s_add_u32 m0, s69, 131072
    s_add_u32 s77, s76, 2048
    buffer_load_dwordx4 v12, s[28:31], s77 offen lds
    s_add_u32 m0, s69, 139264
    s_add_u32 s77, s76, 4096
    buffer_load_dwordx4 v12, s[28:31], s77 offen lds
    buffer_load_dword v14, v13, s[36:39], 0 offen offset:4 sc1
    s_waitcnt vmcnt(11)
    s_barrier
    s_add_u32 s72, s64, 0
    s_and_b32 s72, s72, 3
    s_add_u32 s73, s65, 4
    s_and_b32 s73, s73, 15
    s_add_u32 s72, s72, s73
    s_mul_i32 s73, s72, 393216
    s_lshl_b32 s72, s72, 7
    s_add_u32 s74, s72, s70
    s_add_u32 s75, s73, s66
    s_add_u32 s76, s73, s67
    s_add_u32 m0, s71, 0
    s_add_u32 s77, s74, 0
    buffer_load_dwordx4 v10, s[24:27], s77 offen lds
    s_add_u32 m0, s71, 1024
    s_add_u32 s77, s74, 16384
    buffer_load_dwordx4 v11, s[24:27], s77 offen lds
    s_add_u32 m0, s71, 2048
    s_add_u32 s77, s74, 32768
    buffer_load_dwordx4 v10, s[24:27], s77 offen lds
    s_add_u32 m0, s71, 3072
    s_add_u32 s77, s74, 49152
    buffer_load_dwordx4 v11, s[24:27], s77 offen lds
    s_add_u32 m0, s68, 0
    s_add_u32 s77, s75, 0
    buffer_load_dwordx4 v12, s[28:31], s77 offen lds
    s_add_u32 m0, s68, 8192
    s_add_u32 s77, s75, 2048
    buffer_load_dwordx4 v12, s[28:31], s77 offen lds
    s_add_u32 m0, s68, 16384
    s_add_u32 s77, s75, 4096
    buffer_load_dwordx4 v12, s[28:31], s77 offen lds
    s_add_u32 m0, s69, 0
    s_add_u32 s77, s76, 0
    buffer_load_dwordx4 v12, s[28:31], s77 offen lds
    s_add_u32 m0, s69, 8192
    s_add_u32 s77, s76, 2048
    buffer_load_dwordx4 v12, s[28:31], s77 offen lds
    s_add_u32 m0, s69, 16384
    s_add_u32 s77, s76, 4096
    buffer_load_dwordx4 v12, s[28:31], s77 offen lds
    s_waitcnt vmcnt(11)
    s_barrier
    s_add_u32 s72, s64, 1
    s_and_b32 s72, s72, 3
    s_add_u32 s73, s65, 4
    s_and_b32 s73, s73, 15
    s_add_u32 s72, s72, s73
    s_mul_i32 s73, s72, 393216
    s_lshl_b32 s72, s72, 7
    s_add_u32 s74, s72, s70
    s_add_u32 s75, s73, s66
    s_add_u32 s76, s73, s67
    s_add_u32 m0, s71, 40960
    s_add_u32 s77, s74, 0
    buffer_load_dwordx4 v10, s[24:27], s77 offen lds
    s_add_u32 m0, s71, 41984
    s_add_u32 s77, s74, 16384
    buffer_load_dwordx4 v11, s[24:27], s77 offen lds
    s_add_u32 m0, s71, 43008
    s_add_u32 s77, s74, 32768
    buffer_load_dwordx4 v10, s[24:27], s77 offen lds
    s_add_u32 m0, s71, 44032
    s_add_u32 s77, s74, 49152
    buffer_load_dwordx4 v11, s[24:27], s77 offen lds
    s_add_u32 m0, s68, 40960
    s_add_u32 s77, s75, 0
    buffer_load_dwordx4 v12, s[28:31], s77 offen lds
    s_add_u32 m0, s68, 49152
    s_add_u32 s77, s75, 2048
    buffer_load_dwordx4 v12, s[28:31], s77 offen lds
    s_add_u32 m0, s68, 57344
    s_add_u32 s77, s75, 4096
    buffer_load_dwordx4 v12, s[28:31], s77 offen lds
    s_add_u32 m0, s69, 40960
    s_add_u32 s77, s76, 0
    buffer_load_dwordx4 v12, s[28:31], s77 offen lds
    s_add_u32 m0, s69, 49152
    s_add_u32 s77, s76, 2048
    buffer_load_dwordx4 v12, s[28:31], s77 offen lds
    s_add_u32 m0, s69, 57344
    s_add_u32 s77, s76, 4096
    buffer_load_dwordx4 v12, s[28:31], s77 offen lds
    s_waitcnt vmcnt(10)
    s_barrier
    s_add_u32 s72, s64, 2
    s_and_b32 s72, s72, 3
    s_add_u32 s73, s65, 4
    s_and_b32 s73, s73, 15
    s_add_u32 s72, s72, s73
    s_mul_i32 s73, s72, 393216
    s_lshl_b32 s72, s72, 7
    s_add_u32 s74, s72, s70
    s_add_u32 s75, s73, s66
    s_add_u32 s76, s73, s67
    s_add_u32 m0, s71, 81920
    s_add_u32 s77, s74, 0
    buffer_load_dwordx4 v10, s[24:27], s77 offen lds
    s_add_u32 m0, s71, 82944
    s_add_u32 s77, s74, 16384
    buffer_load_dwordx4 v11, s[24:27], s77 offen lds
    s_add_u32 m0, s71, 83968
    s_add_u32 s77, s74, 32768
    buffer_load_dwordx4 v10, s[24:27], s77 offen lds
    s_add_u32 m0, s71, 84992
    s_add_u32 s77, s74, 49152
    buffer_load_dwordx4 v11, s[24:27], s77 offen lds
    s_add_u32 m0, s68, 81920
    s_add_u32 s77, s75, 0
    buffer_load_dwordx4 v12, s[28:31], s77 offen lds
    s_add_u32 m0, s68, 90112
    s_add_u32 s77, s75, 2048
    buffer_load_dwordx4 v12, s[28:31], s77 offen lds
    s_add_u32 m0, s68, 98304
    s_add_u32 s77, s75, 4096
    buffer_load_dwordx4 v12, s[28:31], s77 offen lds
    s_add_u32 m0, s69, 81920
    s_add_u32 s77, s76, 0
    buffer_load_dwordx4 v12, s[28:31], s77 offen lds
    s_add_u32 m0, s69, 90112
    s_add_u32 s77, s76, 2048
    buffer_load_dwordx4 v12, s[28:31], s77 offen lds
    s_add_u32 m0, s69, 98304
    s_add_u32 s77, s76, 4096
    buffer_load_dwordx4 v12, s[28:31], s77 offen lds
    s_add_u32 s72, s64, 3
    s_and_b32 s72, s72, 3
    s_add_u32 s73, s65, 4
    s_and_b32 s73, s73, 15
    s_add_u32 s72, s72, s73
    s_mul_i32 s73, s72, 393216
    s_lshl_b32 s72, s72, 7
    s_add_u32 s74, s72, s70
    s_add_u32 s75, s73, s66
    s_add_u32 s76, s73, s67
    s_add_u32 m0, s71, 122880
    s_add_u32 s77, s74, 0
    buffer_load_dwordx4 v10, s[24:27], s77 offen lds
    s_add_u32 m0, s71, 123904
    s_add_u32 s77, s74, 16384
    buffer_load_dwordx4 v11, s[24:27], s77 offen lds
    s_waitcnt vmcnt(44)
    s_waitcnt vmcnt(32)
    v_readfirstlane_b32 s78, v14
L_tg1:
    s_nop 1
    s_cmp_lg_u32 s78, 0
    s_cbranch_scc1 L_tk2
    buffer_load_dword v14, v13, s[36:39], 0 offen offset:4 sc1
    s_waitcnt vmcnt(0)
    v_readfirstlane_b32 s78, v14
    s_add_u32 s79, s79, 1
    s_cmp_lt_u32 s79, 32768
    s_cbranch_scc1 L_tg1
L_tk2:
    s_mul_i32 s80, s78, 0x9e3779b1
    s_lshr_b32 s80, s80, 22
    s_mul_i32 s81, s78, 0x85ebca77
    s_lshr_b32 s81, s81, 22
    s_mul_i32 s82, s78, 0xc2b2ae3d
    s_lshr_b32 s82, s82, 22
    s_mul_i32 s83, s78, 0x27d4eb2f
    s_lshr_b32 s83, s83, 22
    v_and_b32 v72, 0xffff, v64
    v_and_b32 v80, 0xffff0000, v64
    v_and_b32 v73, 0xffff, v65
    v_and_b32 v81, 0xffff0000, v65
    v_dot2_f32_bf16 v92, v40, v72, 0
    v_dot2_f32_bf16 v93, v40, v80, 0
    v_and_b32 v74, 0xffff, v66
    v_and_b32 v82, 0xffff0000, v66
    v_dot2_f32_bf16 v94, v41, v73, 0
    v_dot2_f32_bf16 v95, v41, v81, 0
    v_and_b32 v75, 0xffff, v67
    v_and_b32 v83, 0xffff0000, v67
    v_cvt_pk_bf16_f32 v92, v92, v93
    v_dot2_f32_bf16 v96, v42, v74, 0
    v_dot2_f32_bf16 v97, v42, v82, 0
    s_mov_b32 s19, 0x3f803f80
    v_and_b32 v76, 0xffff, v68
    v_and_b32 v84, 0xffff0000, v68
    v_dot2_f32_bf16 v89, v92, s19, 0
    v_cvt_pk_bf16_f32 v94, v94, v95
    v_dot2_f32_bf16 v98, v43, v75, 0
    v_dot2_f32_bf16 v99, v43, v83, 0
    v_and_b32 v77, 0xffff, v69
    v_and_b32 v85, 0xffff0000, v69
    v_dot2_f32_bf16 v89, v94, s19, v89
    v_cvt_pk_bf16_f32 v96, v96, v97
    v_dot2_f32_bf16 v92, v44, v76, 0
    v_dot2_f32_bf16 v93, v44, v84, 0
    v_and_b32 v78, 0xffff, v70
    v_and_b32 v86, 0xffff0000, v70
    v_dot2_f32_bf16 v89, v96, s19, v89
    v_cvt_pk_bf16_f32 v98, v98, v99
    v_dot2_f32_bf16 v94, v45, v77, 0
    v_dot2_f32_bf16 v95, v45, v85, 0
    v_and_b32 v79, 0xffff, v71
    v_and_b32 v87, 0xffff0000, v71
    v_dot2_f32_bf16 v89, v98, s19, v89
    v_cvt_pk_bf16_f32 v92, v92, v93
    v_dot2_f32_bf16 v96, v46, v78, 0
    v_dot2_f32_bf16 v97, v46, v86, 0
    v_dot2_f32_bf16 v89, v92, s19, v89
    v_cvt_pk_bf16_f32 v94, v94, v95
    v_dot2_f32_bf16 v98, v47, v79, 0
    v_dot2_f32_bf16 v99, v47, v87, 0
    v_dot2_f32_bf16 v92, v48, v72, 0
    v_dot2_f32_bf16 v93, v48, v80, 0
    v_dot2_f32_bf16 v89, v94, s19, v89
    v_cvt_pk_bf16_f32 v96, v96, v97
    v_dot2_f32_bf16 v94, v49, v73, 0
    v_dot2_f32_bf16 v95, v49, v81, 0
    v_dot2_f32_bf16 v89, v96, s19, v89
    v_cvt_pk_bf16_f32 v98, v98, v99
    v_cvt_pk_bf16_f32 v92, v92, v93
    v_dot2_f32_bf16 v96, v50, v74, 0
    v_dot2_f32_bf16 v97, v50, v82, 0
    v_dot2_f32_bf16 v89, v98, s19, v89
    v_dot2_f32_bf16 v88, v40, v56, 0
    v_dot2_f32_bf16 v90, v48, v56, 0
    v_dot2_f32_bf16 v91, v92, s19, 0
    v_cvt_pk_bf16_f32 v94, v94, v95
    v_dot2_f32_bf16 v98, v51, v75, 0
    v_dot2_f32_bf16 v99, v51, v83, 0
    v_dot2_f32_bf16 v88, v41, v57, v88
    v_dot2_f32_bf16 v90, v49, v57, v90
    v_dot2_f32_bf16 v91, v94, s19, v91
    v_cvt_pk_bf16_f32 v96, v96, v97
    v_dot2_f32_bf16 v92, v52, v76, 0
    v_dot2_f32_bf16 v93, v52, v84, 0
    v_dot2_f32_bf16 v88, v42, v58, v88
    v_dot2_f32_bf16 v90, v50, v58, v90
    v_dot2_f32_bf16 v91, v96, s19, v91
    v_cvt_pk_bf16_f32 v98, v98, v99
    v_dot2_f32_bf16 v94, v53, v77, 0
    v_dot2_f32_bf16 v95, v53, v85, 0
    v_dot2_f32_bf16 v88, v43, v59, v88
    v_dot2_f32_bf16 v90, v51, v59, v90
    v_dot2_f32_bf16 v91, v98, s19, v91
    v_cvt_pk_bf16_f32 v92, v92, v93
    v_dot2_f32_bf16 v96, v54, v78, 0
    v_dot2_f32_bf16 v97, v54, v86, 0
    v_dot2_f32_bf16 v88, v44, v60, v88
    v_dot2_f32_bf16 v90, v52, v60, v90
    v_dot2_f32_bf16 v91, v92, s19, v91
    v_cvt_pk_bf16_f32 v94, v94, v95
    v_dot2_f32_bf16 v98, v55, v79, 0
    v_dot2_f32_bf16 v99, v55, v87, 0
    v_dot2_f32_bf16 v88, v45, v61, v88
    v_dot2_f32_bf16 v90, v53, v61, v90
    v_dot2_f32_bf16 v91, v94, s19, v91
    v_cvt_pk_bf16_f32 v96, v96, v97
    v_dot2_f32_bf16 v88, v46, v62, v88
    v_dot2_f32_bf16 v90, v54, v62, v90
    v_dot2_f32_bf16 v91, v96, s19, v91
    v_cvt_pk_bf16_f32 v98, v98, v99
    v_dot2_f32_bf16 v88, v47, v63, v88
    v_dot2_f32_bf16 v90, v55, v63, v90
    v_dot2_f32_bf16 v91, v98, s19, v91
    s_nop 1
    v_permlane32_swap_b32 v88, v90
    v_permlane32_swap_b32 v89, v91
    v_add_f32 v88, v88, v90
    v_add_f32 v89, v89, v91
    v_mov_b32 v91, s78
    s_nop 0
    v_permlane16_swap_b32 v88, v89
    v_add_f32 v88, v88, v89
    s_nop 1
    v_add_f32_dpp v88, v88, v88 row_ror:8 row_mask:0xf bank_mask:0xf
    s_nop 1
    v_add_f32_dpp v88, v88, v88 row_ror:4 row_mask:0xf bank_mask:0xf
    s_nop 1
    v_add_f32_dpp v88, v88, v88 row_ror:2 row_mask:0xf bank_mask:0xf
    s_nop 1
    v_add_f32_dpp v88, v88, v88 row_ror:1 row_mask:0xf bank_mask:0xf
    v_cvt_pk_bf16_f32 v88, v88, v88
    v_ashrrev_i32 v90, 31, v88
    v_and_b32 v89, 0xffff0000, v88
    v_or_b32 v90, 0x80000000, v90
    v_mul_f32 v89, 0xbfb8aa3b, v89
    v_xor_b32 v90, v90, v88
    v_exp_f32 v89, v89
    v_lshrrev_b32 v90, 16, v90
    v_add_f32 v89, 1.0, v89
    v_readlane_b32 s84, v90, 0
    v_readlane_b32 s85, v90, 32
    v_rcp_f32 v89, v89
    s_lshl_b32 s84, s84, 11
    s_lshl_b32 s85, s85, 11
    s_sub_u32 s3, 2047, s18
    v_cvt_pk_bf16_f32 v89, v89, v89
    s_or_b32 s84, s84, s3
    s_sub_u32 s3, s3, 1
    s_or_b32 s85, s85, s3
    v_readlane_b32 s20, v89, 16
    s_max_u32 s84, s84, s85
    v_readlane_b32 s21, v89, 48
    s_lshl_b32 s84, s84, 4
    s_or_b32 s84, s84, s23
    s_and_b32 s20, s20, 0xffff
    s_and_b32 s21, s21, 0xffff0000
    s_or_b32 s20, s20, s21
    s_lshl_b32 s3, s18, 2
    s_add_u32 s21, s3, 4472832
    s_add_u32 s3, s3, 4464640
    v_mov_b32 v88, s84
    v_mov_b32 v89, s78
    v_mov_b32 v90, s20
    s_mov_b64 exec, 1
    buffer_store_dwordx2 v[88:89], v13, s[32:35], s3 offen sc1
    buffer_store_dwordx2 v[90:91], v13, s[32:35], s21 offen sc1
    s_mov_b64 exec, -1
    s_waitcnt vmcnt(14)
    s_barrier
    s_add_u32 m0, s71, 124928
    s_add_u32 s77, s74, 32768
    buffer_load_dwordx4 v10, s[24:27], s77 offen lds
    s_add_u32 m0, s71, 125952
    s_add_u32 s77, s74, 49152
    buffer_load_dwordx4 v11, s[24:27], s77 offen lds
    s_add_u32 m0, s68, 122880
    s_add_u32 s77, s75, 0
    buffer_load_dwordx4 v12, s[28:31], s77 offen lds
    s_add_u32 m0, s68, 131072
    s_add_u32 s77, s75, 2048
    buffer_load_dwordx4 v12, s[28:31], s77 offen lds
    s_add_u32 m0, s68, 139264
    s_add_u32 s77, s75, 4096
    buffer_load_dwordx4 v12, s[28:31], s77 offen lds
    s_add_u32 m0, s69, 122880
    s_add_u32 s77, s76, 0
    buffer_load_dwordx4 v12, s[28:31], s77 offen lds
    s_add_u32 m0, s69, 131072
    s_add_u32 s77, s76, 2048
    buffer_load_dwordx4 v12, s[28:31], s77 offen lds
    s_add_u32 m0, s69, 139264
    s_add_u32 s77, s76, 4096
    buffer_load_dwordx4 v12, s[28:31], s77 offen lds
    s_add_u32 s72, s64, 0
    s_and_b32 s72, s72, 3
    s_add_u32 s73, s65, 8
    s_and_b32 s73, s73, 15
    s_add_u32 s72, s72, s73
    s_mul_i32 s73, s72, 393216
    s_lshl_b32 s72, s72, 7
    s_add_u32 s74, s72, s70
    s_add_u32 s75, s73, s66
    s_add_u32 s76, s73, s67
    s_add_u32 m0, s71, 0
    s_add_u32 s77, s74, 0
    buffer_load_dwordx4 v10, s[24:27], s77 offen lds
    s_add_u32 m0, s71, 1024
    s_add_u32 s77, s74, 16384
    buffer_load_dwordx4 v11, s[24:27], s77 offen lds
    s_add_u32 m0, s71, 2048
    s_add_u32 s77, s74, 32768
    buffer_load_dwordx4 v10, s[24:27], s77 offen lds
    s_add_u32 m0, s71, 3072
    s_add_u32 s77, s74, 49152
    buffer_load_dwordx4 v11, s[24:27], s77 offen lds
    s_waitcnt vmcnt(16)
    s_barrier
    s_add_u32 m0, s68, 0
    s_add_u32 s77, s75, 0
    buffer_load_dwordx4 v12, s[28:31], s77 offen lds
    s_add_u32 m0, s68, 8192
    s_add_u32 s77, s75, 2048
    buffer_load_dwordx4 v12, s[28:31], s77 offen lds
    s_add_u32 m0, s68, 16384
    s_add_u32 s77, s75, 4096
    buffer_load_dwordx4 v12, s[28:31], s77 offen lds
    s_add_u32 m0, s69, 0
    s_add_u32 s77, s76, 0
    buffer_load_dwordx4 v12, s[28:31], s77 offen lds
    s_add_u32 m0, s69, 8192
    s_add_u32 s77, s76, 2048
    buffer_load_dwordx4 v12, s[28:31], s77 offen lds
    s_add_u32 m0, s69, 16384
    s_add_u32 s77, s76, 4096
    buffer_load_dwordx4 v12, s[28:31], s77 offen lds
    s_add_u32 s72, s64, 1
    s_and_b32 s72, s72, 3
    s_add_u32 s73, s65, 8
    s_and_b32 s73, s73, 15
    s_add_u32 s72, s72, s73
    s_mul_i32 s73, s72, 393216
    s_lshl_b32 s72, s72, 7
    s_add_u32 s74, s72, s70
    s_add_u32 s75, s73, s66
    s_add_u32 s76, s73, s67
    s_add_u32 m0, s71, 40960
    s_add_u32 s77, s74, 0
    buffer_load_dwordx4 v10, s[24:27], s77 offen lds
    s_add_u32 m0, s71, 41984
    s_add_u32 s77, s74, 16384
    buffer_load_dwordx4 v11, s[24:27], s77 offen lds
    s_add_u32 m0, s71, 43008
    s_add_u32 s77, s74, 32768
    buffer_load_dwordx4 v10, s[24:27], s77 offen lds
    s_add_u32 m0, s71, 44032
    s_add_u32 s77, s74, 49152
    buffer_load_dwordx4 v11, s[24:27], s77 offen lds
    s_waitcnt vmcnt(14)
    s_barrier
    s_add_u32 m0, s68, 40960
    s_add_u32 s77, s75, 0
    buffer_load_dwordx4 v12, s[28:31], s77 offen lds
    s_add_u32 m0, s68, 49152
    s_add_u32 s77, s75, 2048
    buffer_load_dwordx4 v12, s[28:31], s77 offen lds
    s_add_u32 m0, s68, 57344
    s_add_u32 s77, s75, 4096
    buffer_load_dwordx4 v12, s[28:31], s77 offen lds
    s_add_u32 m0, s69, 40960
    s_add_u32 s77, s76, 0
    buffer_load_dwordx4 v12, s[28:31], s77 offen lds
    s_add_u32 m0, s69, 49152
    s_add_u32 s77, s76, 2048
    buffer_load_dwordx4 v12, s[28:31], s77 offen lds
    s_add_u32 m0, s69, 57344
    s_add_u32 s77, s76, 4096
    buffer_load_dwordx4 v12, s[28:31], s77 offen lds
    s_add_u32 s72, s64, 2
    s_and_b32 s72, s72, 3
    s_add_u32 s73, s65, 8
    s_and_b32 s73, s73, 15
    s_add_u32 s72, s72, s73
    s_mul_i32 s73, s72, 393216
    s_lshl_b32 s72, s72, 7
    s_add_u32 s74, s72, s70
    s_add_u32 s75, s73, s66
    s_add_u32 s76, s73, s67
    s_add_u32 m0, s71, 81920
    s_add_u32 s77, s74, 0
    buffer_load_dwordx4 v10, s[24:27], s77 offen lds
    s_add_u32 m0, s71, 82944
    s_add_u32 s77, s74, 16384
    buffer_load_dwordx4 v11, s[24:27], s77 offen lds
    s_add_u32 m0, s71, 83968
    s_add_u32 s77, s74, 32768
    buffer_load_dwordx4 v10, s[24:27], s77 offen lds
    s_add_u32 m0, s71, 84992
    s_add_u32 s77, s74, 49152
    buffer_load_dwordx4 v11, s[24:27], s77 offen lds
    s_waitcnt vmcnt(14)
    s_barrier
    s_add_u32 m0, s68, 81920
    s_add_u32 s77, s75, 0
    buffer_load_dwordx4 v12, s[28:31], s77 offen lds
    s_add_u32 m0, s68, 90112
    s_add_u32 s77, s75, 2048
    buffer_load_dwordx4 v12, s[28:31], s77 offen lds
    s_add_u32 m0, s68, 98304
    s_add_u32 s77, s75, 4096
    buffer_load_dwordx4 v12, s[28:31], s77 offen lds
    s_add_u32 m0, s69, 81920
    s_add_u32 s77, s76, 0
    buffer_load_dwordx4 v12, s[28:31], s77 offen lds
    s_add_u32 m0, s69, 90112
    s_add_u32 s77, s76, 2048
    buffer_load_dwordx4 v12, s[28:31], s77 offen lds
    s_add_u32 m0, s69, 98304
    s_add_u32 s77, s76, 4096
    buffer_load_dwordx4 v12, s[28:31], s77 offen lds
    s_add_u32 s72, s64, 3
    s_and_b32 s72, s72, 3
    s_add_u32 s73, s65, 8
    s_and_b32 s73, s73, 15
    s_add_u32 s72, s72, s73
    s_mul_i32 s73, s72, 393216
    s_lshl_b32 s72, s72, 7
    s_add_u32 s74, s72, s70
    s_add_u32 s75, s73, s66
    s_add_u32 s76, s73, s67
    s_add_u32 m0, s71, 122880
    s_add_u32 s77, s74, 0
    buffer_load_dwordx4 v10, s[24:27], s77 offen lds
    s_add_u32 m0, s71, 123904
    s_add_u32 s77, s74, 16384
    buffer_load_dwordx4 v11, s[24:27], s77 offen lds
    s_add_u32 m0, s71, 124928
    s_add_u32 s77, s74, 32768
    buffer_load_dwordx4 v10, s[24:27], s77 offen lds
    s_add_u32 m0, s71, 125952
    s_add_u32 s77, s74, 49152
    buffer_load_dwordx4 v11, s[24:27], s77 offen lds
    s_add_u32 m0, s68, 122880
    s_add_u32 s77, s75, 0
    buffer_load_dwordx4 v12, s[28:31], s77 offen lds
    s_add_u32 m0, s68, 131072
    s_add_u32 s77, s75, 2048
    buffer_load_dwordx4 v12, s[28:31], s77 offen lds
    s_waitcnt vmcnt(16)
    s_barrier
    s_add_u32 m0, s68, 139264
    s_add_u32 s77, s75, 4096
    buffer_load_dwordx4 v12, s[28:31], s77 offen lds
    s_add_u32 m0, s69, 122880
    s_add_u32 s77, s76, 0
    buffer_load_dwordx4 v12, s[28:31], s77 offen lds
    s_add_u32 m0, s69, 131072
    s_add_u32 s77, s76, 2048
    buffer_load_dwordx4 v12, s[28:31], s77 offen lds
    s_add_u32 m0, s69, 139264
    s_add_u32 s77, s76, 4096
    buffer_load_dwordx4 v12, s[28:31], s77 offen lds
    s_add_u32 s72, s64, 0
    s_and_b32 s72, s72, 3
    s_add_u32 s73, s65, 12
    s_and_b32 s73, s73, 15
    s_add_u32 s72, s72, s73
    s_mul_i32 s73, s72, 393216
    s_lshl_b32 s72, s72, 7
    s_add_u32 s74, s72, s70
    s_add_u32 s75, s73, s66
    s_add_u32 s76, s73, s67
    s_add_u32 m0, s71, 0
    s_add_u32 s77, s74, 0
    buffer_load_dwordx4 v10, s[24:27], s77 offen lds
    s_add_u32 m0, s71, 1024
    s_add_u32 s77, s74, 16384
    buffer_load_dwordx4 v11, s[24:27], s77 offen lds
    s_add_u32 m0, s71, 2048
    s_add_u32 s77, s74, 32768
    buffer_load_dwordx4 v10, s[24:27], s77 offen lds
    s_add_u32 m0, s71, 3072
    s_add_u32 s77, s74, 49152
    buffer_load_dwordx4 v11, s[24:27], s77 offen lds
    s_add_u32 m0, s68, 0
    s_add_u32 s77, s75, 0
    buffer_load_dwordx4 v12, s[28:31], s77 offen lds
    s_add_u32 m0, s68, 8192
    s_add_u32 s77, s75, 2048
    buffer_load_dwordx4 v12, s[28:31], s77 offen lds
    s_add_u32 m0, s68, 16384
    s_add_u32 s77, s75, 4096
    buffer_load_dwordx4 v12, s[28:31], s77 offen lds
    s_add_u32 m0, s69, 0
    s_add_u32 s77, s76, 0
    buffer_load_dwordx4 v12, s[28:31], s77 offen lds
    s_waitcnt vmcnt(18)
    s_barrier
    s_add_u32 m0, s69, 8192
    s_add_u32 s77, s76, 2048
    buffer_load_dwordx4 v12, s[28:31], s77 offen lds
    s_add_u32 m0, s69, 16384
    s_add_u32 s77, s76, 4096
    buffer_load_dwordx4 v12, s[28:31], s77 offen lds
    s_add_u32 s72, s64, 1
    s_and_b32 s72, s72, 3
    s_add_u32 s73, s65, 12
    s_and_b32 s73, s73, 15
    s_add_u32 s72, s72, s73
    s_mul_i32 s73, s72, 393216
    s_lshl_b32 s72, s72, 7
    s_add_u32 s74, s72, s70
    s_add_u32 s75, s73, s66
    s_add_u32 s76, s73, s67
    s_add_u32 m0, s71, 40960
    s_add_u32 s77, s74, 0
    buffer_load_dwordx4 v10, s[24:27], s77 offen lds
    s_add_u32 m0, s71, 41984
    s_add_u32 s77, s74, 16384
    buffer_load_dwordx4 v11, s[24:27], s77 offen lds
    s_add_u32 m0, s71, 43008
    s_add_u32 s77, s74, 32768
    buffer_load_dwordx4 v10, s[24:27], s77 offen lds
    s_add_u32 m0, s71, 44032
    s_add_u32 s77, s74, 49152
    buffer_load_dwordx4 v11, s[24:27], s77 offen lds
    s_add_u32 m0, s68, 40960
    s_add_u32 s77, s75, 0
    buffer_load_dwordx4 v12, s[28:31], s77 offen lds
    s_add_u32 m0, s68, 49152
    s_add_u32 s77, s75, 2048
    buffer_load_dwordx4 v12, s[28:31], s77 offen lds
    s_add_u32 m0, s68, 57344
    s_add_u32 s77, s75, 4096
    buffer_load_dwordx4 v12, s[28:31], s77 offen lds
    s_add_u32 m0, s69, 40960
    s_add_u32 s77, s76, 0
    buffer_load_dwordx4 v12, s[28:31], s77 offen lds
    s_waitcnt vmcnt(18)
    s_barrier
    s_add_u32 m0, s69, 49152
    s_add_u32 s77, s76, 2048
    buffer_load_dwordx4 v12, s[28:31], s77 offen lds
    s_add_u32 m0, s69, 57344
    s_add_u32 s77, s76, 4096
    buffer_load_dwordx4 v12, s[28:31], s77 offen lds
    s_add_u32 s72, s64, 2
    s_and_b32 s72, s72, 3
    s_add_u32 s73, s65, 12
    s_and_b32 s73, s73, 15
    s_add_u32 s72, s72, s73
    s_mul_i32 s73, s72, 393216
    s_lshl_b32 s72, s72, 7
    s_add_u32 s74, s72, s70
    s_add_u32 s75, s73, s66
    s_add_u32 s76, s73, s67
    s_add_u32 m0, s71, 81920
    s_add_u32 s77, s74, 0
    buffer_load_dwordx4 v10, s[24:27], s77 offen lds
    s_add_u32 m0, s71, 82944
    s_add_u32 s77, s74, 16384
    buffer_load_dwordx4 v11, s[24:27], s77 offen lds
    s_add_u32 m0, s71, 83968
    s_add_u32 s77, s74, 32768
    buffer_load_dwordx4 v10, s[24:27], s77 offen lds
    s_add_u32 m0, s71, 84992
    s_add_u32 s77, s74, 49152
    buffer_load_dwordx4 v11, s[24:27], s77 offen lds
    s_add_u32 m0, s68, 81920
    s_add_u32 s77, s75, 0
    buffer_load_dwordx4 v12, s[28:31], s77 offen lds
    s_add_u32 m0, s68, 90112
    s_add_u32 s77, s75, 2048
    buffer_load_dwordx4 v12, s[28:31], s77 offen lds
    s_add_u32 m0, s68, 98304
    s_add_u32 s77, s75, 4096
    buffer_load_dwordx4 v12, s[28:31], s77 offen lds
    s_add_u32 m0, s69, 81920
    s_add_u32 s77, s76, 0
    buffer_load_dwordx4 v12, s[28:31], s77 offen lds
    s_lshl_b32 s19, s17, 11
    s_add_u32 s19, s19, 4464640
    buffer_load_dwordx4 v[28:31], v3, s[32:35], s19 offen offset:0 sc1
    buffer_load_dwordx4 v[32:35], v3, s[32:35], s19 offen offset:1024 sc1
    s_waitcnt vmcnt(20)
    s_barrier
    s_add_u32 m0, s69, 90112
    s_add_u32 s77, s76, 2048
    buffer_load_dwordx4 v12, s[28:31], s77 offen lds
    s_add_u32 m0, s69, 98304
    s_add_u32 s77, s76, 4096
    buffer_load_dwordx4 v12, s[28:31], s77 offen lds
    s_add_u32 s72, s64, 3
    s_and_b32 s72, s72, 3
    s_add_u32 s73, s65, 12
    s_and_b32 s73, s73, 15
    s_add_u32 s72, s72, s73
    s_mul_i32 s73, s72, 393216
    s_lshl_b32 s72, s72, 7
    s_add_u32 s74, s72, s70
    s_add_u32 s75, s73, s66
    s_add_u32 s76, s73, s67
    s_add_u32 m0, s71, 122880
    s_add_u32 s77, s74, 0
    buffer_load_dwordx4 v10, s[24:27], s77 offen lds
    s_add_u32 m0, s71, 123904
    s_add_u32 s77, s74, 16384
    buffer_load_dwordx4 v11, s[24:27], s77 offen lds
    s_add_u32 m0, s71, 124928
    s_add_u32 s77, s74, 32768
    buffer_load_dwordx4 v10, s[24:27], s77 offen lds
    s_add_u32 m0, s71, 125952
    s_add_u32 s77, s74, 49152
    buffer_load_dwordx4 v11, s[24:27], s77 offen lds
    s_add_u32 m0, s68, 122880
    s_add_u32 s77, s75, 0
    buffer_load_dwordx4 v12, s[28:31], s77 offen lds
    s_add_u32 m0, s68, 131072
    s_add_u32 s77, s75, 2048
    buffer_load_dwordx4 v12, s[28:31], s77 offen lds
    s_add_u32 m0, s68, 139264
    s_add_u32 s77, s75, 4096
    buffer_load_dwordx4 v12, s[28:31], s77 offen lds
    s_add_u32 m0, s69, 122880
    s_add_u32 s77, s76, 0
    buffer_load_dwordx4 v12, s[28:31], s77 offen lds
    s_add_u32 m0, s69, 131072
    s_add_u32 s77, s76, 2048
    buffer_load_dwordx4 v12, s[28:31], s77 offen lds
    s_add_u32 m0, s69, 139264
    s_add_u32 s77, s76, 4096
    buffer_load_dwordx4 v12, s[28:31], s77 offen lds
    s_waitcnt vmcnt(22)
    s_barrier
    buffer_load_dwordx4 v[100:103], v15, s[48:51], s1 offen nt
    buffer_load_dwordx4 v[132:135], v15, s[52:55], s1 offen nt
    s_add_u32 s1, s1, 28672
    buffer_load_dwordx4 v[104:107], v15, s[48:51], s1 offen nt
    buffer_load_dwordx4 v[136:139], v15, s[52:55], s1 offen nt
    s_add_u32 s1, s1, 28672
    buffer_load_dwordx4 v[108:111], v15, s[48:51], s1 offen nt
    buffer_load_dwordx4 v[140:143], v15, s[52:55], s1 offen nt
    s_add_u32 s1, s1, 28672
    s_mul_i32 s73, s13, 112
    s_mul_i32 s19, s17, 28
    s_add_u32 s73, s73, s19
    s_lshl_b32 s74, s73, 11
    s_lshl_b32 s19, s12, 8
    s_add_u32 s74, s74, s19
    s_lshr_b32 s67, s12, 2
    s_lshl_b32 s67, s67, 3
    s_lshr_b32 s19, s13, 2
    s_add_u32 s67, s67, s19
    s_lshl_b32 s68, s19, 2
    s_lshl_b32 s69, s67, 7
    s_lshl_b32 s19, s17, 14
    s_add_u32 s69, s69, s19
    s_and_b32 s19, s13, 3
    s_lshl_b32 s19, s19, 3
    s_add_u32 s68, s68, s19
    s_and_b32 s68, s68, 31
    s_waitcnt vmcnt(6)
    s_barrier
    s_cmp_lg_u32 s17, 0
    s_cbranch_scc1 L_z3
    v_mov_b32 v40, 0
    v_mov_b32 v41, 0
    v_mov_b32 v42, 0
    v_mov_b32 v43, 0
    s_mov_b64 exec, 31
    ds_write_b128 v3, v[40:43] offset:0
    ds_write_b32 v13, v37 offset:128
    s_mov_b64 exec, -1
L_z3:
    s_waitcnt vmcnt(18)
L_kp4:
    v_xor_b32 v29, s78, v29
    v_mov_b32 v80, v28
    v_xor_b32 v31, s78, v31
    v_mov_b32 v81, v30
    v_xor_b32 v33, s78, v33
    v_mov_b32 v82, v32
    v_xor_b32 v35, s78, v35
    v_mov_b32 v83, v34
    v_or3_b32 v29, v29, v31, v33
    v_max3_u32 v28, v28, v30, v32
    v_or_b32 v29, v29, v35
    v_max_u32 v28, v28, v34
    v_cmp_ne_u32 vcc, 0, v29
    s_cbranch_vccz L_kk5
    s_lshl_b32 s19, s17, 11
    s_add_u32 s19, s19, 4464640
    buffer_load_dwordx4 v[28:31], v3, s[32:35], s19 offen offset:0 sc1
    buffer_load_dwordx4 v[32:35], v3, s[32:35], s19 offen offset:1024 sc1
    s_waitcnt vmcnt(0)
    s_add_u32 s79, s79, 1
    s_cmp_lt_u32 s79, 32768
    s_cbranch_scc1 L_kp4
L_kk5:
    v_xor_b32 v72, s23, v80
    v_xor_b32 v73, s23, v81
    v_xor_b32 v74, s23, v82
    v_xor_b32 v75, s23, v83
    v_or3_b32 v72, v72, v73, v74
    v_or_b32 v72, v72, v75
    v_and_b32 v72, 15, v72
    v_cmp_ne_u32 vcc, 0, v72
    s_lshl_b32 s19, s15, 1
    s_lshl_b32 s19, 3, s19
    s_or_b32 s3, vcc_lo, vcc_hi
    s_and_b32 s3, s3, s19
    s_cselect_b32 s3, 1, 0
    v_xor_b32 v72, s3, v37
    s_lshl_b64 exec, 1, s17
    ds_write_b32 v36, v72 offset:240
    s_mov_b64 exec, -1
    buffer_load_dwordx4 v[112:115], v15, s[48:51], s1 offen nt
    buffer_load_dwordx4 v[144:147], v15, s[52:55], s1 offen nt
    s_add_u32 s1, s1, 28672
    buffer_load_dwordx4 v[116:119], v15, s[48:51], s1 offen nt
    buffer_load_dwordx4 v[148:151], v15, s[52:55], s1 offen nt
    s_add_u32 s1, s1, 28672
    buffer_load_dwordx4 v[120:123], v15, s[48:51], s1 offen nt
    buffer_load_dwordx4 v[152:155], v15, s[52:55], s1 offen nt
    s_add_u32 s1, s1, 28672
    buffer_load_dwordx4 v[124:127], v15, s[48:51], s1 offen nt
    buffer_load_dwordx4 v[156:159], v15, s[52:55], s1 offen nt
    s_add_u32 s1, s1, 28672
    buffer_load_dwordx4 v[128:131], v15, s[48:51], s1 offen nt
    buffer_load_dwordx4 v[160:163], v15, s[52:55], s1 offen nt
    s_add_u32 s1, s1, 28672
L_fw6:
    ds_read_b32 v29, v13 offset:128
    s_waitcnt lgkmcnt(0)
    v_cmp_ne_u32 vcc, v29, v37
    s_cbranch_vccz L_fk7
    s_add_u32 s79, s79, 1
    s_cmp_lt_u32 s79, 32768
    s_cbranch_scc1 L_fw6
L_fk7:
    ds_max_u32 v13, v28 offset:16
    v_mov_b32 v26, 1
    s_mov_b64 exec, 1
    ds_add_u32 v13, v26 offset:0
    s_mov_b64 exec, -1
L_kc8:
    ds_read_b32 v26, v13 offset:0
    ds_read_b32 v27, v13 offset:16
    s_waitcnt lgkmcnt(0)
    v_readfirstlane_b32 s19, v26
    v_readfirstlane_b32 s71, v27
    s_nop 0
    s_cmp_ge_u32 s19, 4
    s_cbranch_scc1 L_kd9
    s_add_u32 s79, s79, 1
    s_cmp_lt_u32 s79, 32768
    s_cbranch_scc1 L_kc8
L_kd9:
    s_lshr_b32 s71, s71, 4
    s_and_b32 s72, s71, 2047
    s_sub_u32 s72, 2047, s72
    s_lshl_b32 s19, s72, 11
    s_lshl_b32 s3, s0, 1
    s_add_u32 s19, s19, s3
    v_lshlrev_b32 v26, 3, v20
    v_lshl_add_u32 v26, v9, 1, v26
    buffer_load_ushort v27, v26, s[24:27], s19 offen
    s_lshl_b32 s19, s68, 16
    s_add_u32 s19, s19, s69
    buffer_load_dwordx4 v[192:195], v17, s[60:63], s19 offen
    s_add_u32 s68, s68, 1
    s_and_b32 s68, s68, 31
    s_lshl_b32 s19, s68, 16
    s_add_u32 s19, s19, s69
    buffer_load_dwordx4 v[196:199], v17, s[60:63], s19 offen
    s_add_u32 s68, s68, 1
    s_and_b32 s68, s68, 31
    s_lshl_b32 s19, s68, 16
    s_add_u32 s19, s19, s69
    buffer_load_dwordx4 v[200:203], v17, s[60:63], s19 offen
    s_add_u32 s68, s68, 1
    s_and_b32 s68, s68, 31
    s_lshl_b32 s19, s68, 16
    s_add_u32 s19, s19, s69
    buffer_load_dwordx4 v[204:207], v17, s[60:63], s19 offen
    s_add_u32 s68, s68, 1
    s_and_b32 s68, s68, 31
    s_lshl_b32 s19, s68, 16
    s_add_u32 s19, s19, s69
    buffer_load_dwordx4 v[208:211], v17, s[60:63], s19 offen
    s_add_u32 s68, s68, 1
    s_and_b32 s68, s68, 31
    s_lshl_b32 s19, s68, 16
    s_add_u32 s19, s19, s69
    buffer_load_dwordx4 v[212:215], v17, s[60:63], s19 offen
    s_add_u32 s68, s68, 1
    s_and_b32 s68, s68, 31
    s_lshl_b32 s19, s68, 16
    s_add_u32 s19, s19, s69
    buffer_load_dwordx4 v[216:219], v17, s[60:63], s19 offen
    s_add_u32 s68, s68, 1
    s_and_b32 s68, s68, 31
    s_lshl_b32 s19, s68, 16
    s_add_u32 s19, s19, s69
    buffer_load_dwordx4 v[220:223], v17, s[60:63], s19 offen
    s_add_u32 s68, s68, 1
    s_and_b32 s68, s68, 31
    s_lshl_b32 s19, s68, 16
    s_add_u32 s19, s19, s69
    buffer_load_dwordx4 v[224:227], v17, s[60:63], s19 offen
    s_add_u32 s68, s68, 1
    s_and_b32 s68, s68, 31
    s_lshl_b32 s19, s68, 16
    s_add_u32 s19, s19, s69
    buffer_load_dwordx4 v[228:231], v17, s[60:63], s19 offen
    s_add_u32 s68, s68, 1
    s_and_b32 s68, s68, 31
    s_lshl_b32 s19, s68, 16
    s_add_u32 s19, s19, s69
    buffer_load_dwordx4 v[232:235], v17, s[60:63], s19 offen
    s_add_u32 s68, s68, 1
    s_and_b32 s68, s68, 31
    s_lshl_b32 s19, s68, 16
    s_add_u32 s19, s19, s69
    buffer_load_dwordx4 v[236:239], v17, s[60:63], s19 offen
    s_add_u32 s68, s68, 1
    s_and_b32 s68, s68, 31
    s_lshl_b32 s19, s68, 16
    s_add_u32 s19, s19, s69
    buffer_load_dwordx4 v[240:243], v17, s[60:63], s19 offen
    s_add_u32 s68, s68, 1
    s_and_b32 s68, s68, 31
    s_lshl_b32 s19, s68, 16
    s_add_u32 s19, s19, s69
    buffer_load_dwordx4 v[244:247], v17, s[60:63], s19 offen
    s_add_u32 s68, s68, 1
    s_and_b32 s68, s68, 31
    s_lshl_b32 s19, s68, 16
    s_add_u32 s19, s19, s69
    buffer_load_dwordx4 v[248:251], v17, s[60:63], s19 offen
    s_add_u32 s68, s68, 1
    s_and_b32 s68, s68, 31
    s_lshl_b32 s19, s68, 16
    s_add_u32 s19, s19, s69
    buffer_load_dwordx4 v[252:255], v17, s[60:63], s19 offen
    s_add_u32 s68, s68, 1
    s_and_b32 s68, s68, 31
    s_waitcnt vmcnt(16)
    s_waitcnt vmcnt(17)
    v_lshl_or_b32 v27, v27, 16, v27
    s_lshl_b32 s19, s17, 10
    s_add_u32 s19, s19, 26624
    v_and_b32_dpp v72, v27, v4 row_newbcast:0 row_mask:0xf bank_mask:0xf
    v_and_b32_dpp v73, v27, v5 row_newbcast:0 row_mask:0xf bank_mask:0xf
    v_and_b32_dpp v74, v27, v6 row_newbcast:0 row_mask:0xf bank_mask:0xf
    v_and_b32_dpp v75, v27, v7 row_newbcast:0 row_mask:0xf bank_mask:0xf
    v_and_b32_dpp v76, v27, v4 row_newbcast:1 row_mask:0xf bank_mask:0xf
    v_and_b32_dpp v77, v27, v5 row_newbcast:1 row_mask:0xf bank_mask:0xf
    v_mfma_f32_16x16x32_bf16 v[88:91], v[72:75], v[100:103], 0
    v_and_b32_dpp v78, v27, v6 row_newbcast:1 row_mask:0xf bank_mask:0xf
    v_and_b32_dpp v79, v27, v7 row_newbcast:1 row_mask:0xf bank_mask:0xf
    v_mfma_f32_16x16x32_bf16 v[92:95], v[72:75], v[132:135], 0
    v_and_b32_dpp v80, v27, v4 row_newbcast:2 row_mask:0xf bank_mask:0xf
    v_and_b32_dpp v81, v27, v5 row_newbcast:2 row_mask:0xf bank_mask:0xf
    v_mfma_f32_16x16x32_bf16 v[88:91], v[76:79], v[104:107], v[88:91]
    v_and_b32_dpp v82, v27, v6 row_newbcast:2 row_mask:0xf bank_mask:0xf
    v_and_b32_dpp v83, v27, v7 row_newbcast:2 row_mask:0xf bank_mask:0xf
    v_mfma_f32_16x16x32_bf16 v[92:95], v[76:79], v[136:139], v[92:95]
    v_and_b32_dpp v84, v27, v4 row_newbcast:3 row_mask:0xf bank_mask:0xf
    v_and_b32_dpp v85, v27, v5 row_newbcast:3 row_mask:0xf bank_mask:0xf
    v_mfma_f32_16x16x32_bf16 v[88:91], v[80:83], v[108:111], v[88:91]
    v_and_b32_dpp v86, v27, v6 row_newbcast:3 row_mask:0xf bank_mask:0xf
    v_and_b32_dpp v87, v27, v7 row_newbcast:3 row_mask:0xf bank_mask:0xf
    v_mfma_f32_16x16x32_bf16 v[92:95], v[80:83], v[140:143], v[92:95]
    v_and_b32_dpp v72, v27, v4 row_newbcast:4 row_mask:0xf bank_mask:0xf
    v_and_b32_dpp v73, v27, v5 row_newbcast:4 row_mask:0xf bank_mask:0xf
    v_mfma_f32_16x16x32_bf16 v[88:91], v[84:87], v[112:115], v[88:91]
    v_and_b32_dpp v74, v27, v6 row_newbcast:4 row_mask:0xf bank_mask:0xf
    v_and_b32_dpp v75, v27, v7 row_newbcast:4 row_mask:0xf bank_mask:0xf
    v_mfma_f32_16x16x32_bf16 v[92:95], v[84:87], v[144:147], v[92:95]
    v_and_b32_dpp v76, v27, v4 row_newbcast:5 row_mask:0xf bank_mask:0xf
    v_and_b32_dpp v77, v27, v5 row_newbcast:5 row_mask:0xf bank_mask:0xf
    v_mfma_f32_16x16x32_bf16 v[88:91], v[72:75], v[116:119], v[88:91]
    v_and_b32_dpp v78, v27, v6 row_newbcast:5 row_mask:0xf bank_mask:0xf
    v_and_b32_dpp v79, v27, v7 row_newbcast:5 row_mask:0xf bank_mask:0xf
    v_mfma_f32_16x16x32_bf16 v[92:95], v[72:75], v[148:151], v[92:95]
    v_and_b32_dpp v80, v27, v4 row_newbcast:6 row_mask:0xf bank_mask:0xf
    v_and_b32_dpp v81, v27, v5 row_newbcast:6 row_mask:0xf bank_mask:0xf
    v_mfma_f32_16x16x32_bf16 v[88:91], v[76:79], v[120:123], v[88:91]
    v_and_b32_dpp v82, v27, v6 row_newbcast:6 row_mask:0xf bank_mask:0xf
    v_and_b32_dpp v83, v27, v7 row_newbcast:6 row_mask:0xf bank_mask:0xf
    v_mfma_f32_16x16x32_bf16 v[92:95], v[76:79], v[152:155], v[92:95]
    v_and_b32_dpp v84, v27, v4 row_newbcast:7 row_mask:0xf bank_mask:0xf
    v_and_b32_dpp v85, v27, v5 row_newbcast:7 row_mask:0xf bank_mask:0xf
    v_mfma_f32_16x16x32_bf16 v[88:91], v[80:83], v[124:127], v[88:91]
    v_and_b32_dpp v86, v27, v6 row_newbcast:7 row_mask:0xf bank_mask:0xf
    v_and_b32_dpp v87, v27, v7 row_newbcast:7 row_mask:0xf bank_mask:0xf
    v_mfma_f32_16x16x32_bf16 v[92:95], v[80:83], v[156:159], v[92:95]
    v_add_u32 v26, s19, v3
    v_mov_b32 v28, 1
    v_mfma_f32_16x16x32_bf16 v[88:91], v[84:87], v[128:131], v[88:91]
    v_mfma_f32_16x16x32_bf16 v[92:95], v[84:87], v[160:163], v[92:95]
    s_nop 7
    v_permlane32_swap_b32 v88, v92
    v_permlane32_swap_b32 v89, v93
    v_permlane32_swap_b32 v90, v94
    v_permlane32_swap_b32 v91, v95
    ds_write_b128 v26, v[88:91]
    s_mov_b64 exec, 1
    ds_add_rtn_u32 v29, v13, v28 offset:32
    s_mov_b64 exec, -1
    s_waitcnt lgkmcnt(0)
    v_readfirstlane_b32 s19, v29
    s_nop 1
    s_cmp_lg_u32 s19, 3
    s_cbranch_scc1 L_gs10
    ds_read_b128 v[72:75], v3 offset:26624
    ds_read_b128 v[76:79], v3 offset:27648
    ds_read_b128 v[80:83], v3 offset:28672
    ds_read_b128 v[84:87], v3 offset:29696
    s_waitcnt lgkmcnt(0)
    v_pk_add_f32 v[72:73], v[72:73], v[76:77]
    v_pk_add_f32 v[74:75], v[74:75], v[78:79]
    v_pk_add_f32 v[80:81], v[80:81], v[84:85]
    v_pk_add_f32 v[82:83], v[82:83], v[86:87]
    v_pk_add_f32 v[72:73], v[72:73], v[80:81]
    v_pk_add_f32 v[74:75], v[74:75], v[82:83]
    v_bfi_b32 v72, v23, s80, v72
    v_bfi_b32 v73, v23, s81, v73
    v_bfi_b32 v74, v23, s82, v74
    v_bfi_b32 v75, v23, s83, v75
    s_cmp_ge_u32 s2, 224
    s_cbranch_scc1 L_gs10
    v_lshrrev_b32 v26, 5, v2
    v_mul_u32_u24 v26, 14336, v26
    v_lshl_add_u32 v26, v8, 5, v26
    v_and_b32 v29, 1, v9
    v_lshl_add_u32 v26, v29, 4, v26
    s_mul_i32 s19, s12, 28672
    s_lshl_b32 s3, s13, 9
    s_add_u32 s19, s19, s3
    s_add_u32 s19, s19, 4489216
    buffer_store_dwordx4 v[72:75], v26, s[32:35], s19 offen sc1
L_gs10:
    s_waitcnt vmcnt(8)
L_fw11:
    ds_read_b32 v29, v36 offset:144
    s_waitcnt lgkmcnt(0)
    v_cmp_ne_u32 vcc, v29, v37
    s_cbranch_vccz L_fk12
    s_add_u32 s79, s79, 1
    s_cmp_lt_u32 s79, 32768
    s_cbranch_scc1 L_fw11
L_fk12:
    ds_write_b128 v18, v[192:195] offset:0
    ds_write_b128 v18, v[196:199] offset:4096
    ds_write_b128 v18, v[200:203] offset:8192
    ds_write_b128 v18, v[204:207] offset:12288
    ds_write_b128 v18, v[208:211] offset:16384
    ds_write_b128 v18, v[212:215] offset:20480
    ds_write_b128 v18, v[216:219] offset:24576
    ds_write_b128 v18, v[220:223] offset:28672
    s_waitcnt vmcnt(0)
    ds_write_b128 v18, v[224:227] offset:32768
    ds_write_b128 v18, v[228:231] offset:36864
    ds_write_b128 v18, v[232:235] offset:40960
    ds_write_b128 v18, v[236:239] offset:45056
    ds_write_b128 v18, v[240:243] offset:49152
    ds_write_b128 v18, v[244:247] offset:53248
    ds_write_b128 v18, v[248:251] offset:57344
    ds_write_b128 v18, v[252:255] offset:61440
L_fw13:
    ds_read_b32 v29, v36 offset:176
    s_waitcnt lgkmcnt(0)
    v_cmp_ne_u32 vcc, v29, v37
    s_cbranch_vccz L_fk14
    s_add_u32 s79, s79, 1
    s_cmp_lt_u32 s79, 32768
    s_cbranch_scc1 L_fw13
L_fk14:
    v_min_u32 v26, 6, v20
    v_mul_u32_u24 v27, 28672, v19
    v_lshl_add_u32 v26, v26, 4, v27
    s_lshl_b32 s75, s73, 2
    s_add_u32 s75, s75, 4489216
    s_add_u32 s76, s75, 14336
    buffer_load_dwordx4 v[72:75], v26, s[32:35], s75 offen sc1
    buffer_load_dwordx4 v[76:79], v26, s[32:35], s76 offen sc1
    s_lshl_b32 s19, s68, 16
    s_add_u32 s19, s19, s69
    buffer_load_dwordx4 v[192:195], v17, s[60:63], s19 offen
    s_add_u32 s68, s68, 1
    s_and_b32 s68, s68, 31
    s_lshl_b32 s19, s68, 16
    s_add_u32 s19, s19, s69
    buffer_load_dwordx4 v[196:199], v17, s[60:63], s19 offen
    s_add_u32 s68, s68, 1
    s_and_b32 s68, s68, 31
    s_lshl_b32 s19, s68, 16
    s_add_u32 s19, s19, s69
    buffer_load_dwordx4 v[200:203], v17, s[60:63], s19 offen
    s_add_u32 s68, s68, 1
    s_and_b32 s68, s68, 31
    s_lshl_b32 s19, s68, 16
    s_add_u32 s19, s19, s69
    buffer_load_dwordx4 v[204:207], v17, s[60:63], s19 offen
    s_add_u32 s68, s68, 1
    s_and_b32 s68, s68, 31
    s_lshl_b32 s19, s68, 16
    s_add_u32 s19, s19, s69
    buffer_load_dwordx4 v[208:211], v17, s[60:63], s19 offen
    s_add_u32 s68, s68, 1
    s_and_b32 s68, s68, 31
    s_lshl_b32 s19, s68, 16
    s_add_u32 s19, s19, s69
    buffer_load_dwordx4 v[212:215], v17, s[60:63], s19 offen
    s_add_u32 s68, s68, 1
    s_and_b32 s68, s68, 31
    s_lshl_b32 s19, s68, 16
    s_add_u32 s19, s19, s69
    buffer_load_dwordx4 v[216:219], v17, s[60:63], s19 offen
    s_add_u32 s68, s68, 1
    s_and_b32 s68, s68, 31
    s_lshl_b32 s19, s68, 16
    s_add_u32 s19, s19, s69
    buffer_load_dwordx4 v[220:223], v17, s[60:63], s19 offen
    s_add_u32 s68, s68, 1
    s_and_b32 s68, s68, 31
    s_lshl_b32 s19, s68, 16
    s_add_u32 s19, s19, s69
    buffer_load_dwordx4 v[224:227], v17, s[60:63], s19 offen
    s_add_u32 s68, s68, 1
    s_and_b32 s68, s68, 31
    s_lshl_b32 s19, s68, 16
    s_add_u32 s19, s19, s69
    buffer_load_dwordx4 v[228:231], v17, s[60:63], s19 offen
    s_add_u32 s68, s68, 1
    s_and_b32 s68, s68, 31
    s_lshl_b32 s19, s68, 16
    s_add_u32 s19, s19, s69
    buffer_load_dwordx4 v[232:235], v17, s[60:63], s19 offen
    s_add_u32 s68, s68, 1
    s_and_b32 s68, s68, 31
    s_lshl_b32 s19, s68, 16
    s_add_u32 s19, s19, s69
    buffer_load_dwordx4 v[236:239], v17, s[60:63], s19 offen
    s_add_u32 s68, s68, 1
    s_and_b32 s68, s68, 31
    s_lshl_b32 s19, s68, 16
    s_add_u32 s19, s19, s69
    buffer_load_dwordx4 v[240:243], v17, s[60:63], s19 offen
    s_add_u32 s68, s68, 1
    s_and_b32 s68, s68, 31
    s_lshl_b32 s19, s68, 16
    s_add_u32 s19, s19, s69
    buffer_load_dwordx4 v[244:247], v17, s[60:63], s19 offen
    s_add_u32 s68, s68, 1
    s_and_b32 s68, s68, 31
    s_lshl_b32 s19, s68, 16
    s_add_u32 s19, s19, s69
    buffer_load_dwordx4 v[248:251], v17, s[60:63], s19 offen
    s_add_u32 s68, s68, 1
    s_and_b32 s68, s68, 31
    s_lshl_b32 s19, s68, 16
    s_add_u32 s19, s19, s69
    buffer_load_dwordx4 v[252:255], v17, s[60:63], s19 offen
    s_add_u32 s68, s68, 1
    s_and_b32 s68, s68, 31
    s_waitcnt vmcnt(8)
L_fw15:
    ds_read_b32 v29, v36 offset:160
    s_waitcnt lgkmcnt(0)
    v_cmp_ne_u32 vcc, v29, v37
    s_cbranch_vccz L_fk16
    s_add_u32 s79, s79, 1
    s_cmp_lt_u32 s79, 32768
    s_cbranch_scc1 L_fw15
L_fk16:
    ds_write_b128 v22, v[192:195] offset:0
    ds_write_b128 v22, v[196:199] offset:4096
    ds_write_b128 v22, v[200:203] offset:8192
    ds_write_b128 v22, v[204:207] offset:12288
    ds_write_b128 v22, v[208:211] offset:16384
    ds_write_b128 v22, v[212:215] offset:20480
    ds_write_b128 v22, v[216:219] offset:24576
    ds_write_b128 v22, v[220:223] offset:28672
    s_waitcnt vmcnt(0)
    ds_write_b128 v22, v[224:227] offset:32768
    ds_write_b128 v22, v[228:231] offset:36864
    ds_write_b128 v22, v[232:235] offset:40960
    ds_write_b128 v22, v[236:239] offset:45056
    ds_write_b128 v22, v[240:243] offset:49152
    ds_write_b128 v22, v[244:247] offset:53248
    ds_write_b128 v22, v[248:251] offset:57344
    ds_write_b128 v22, v[252:255] offset:61440
    s_lshl_b64 exec, 1, s17
    ds_write_b32 v36, v37 offset:208
    s_mov_b64 exec, -1
L_fw17:
    ds_read_b32 v29, v36 offset:192
    s_waitcnt lgkmcnt(0)
    v_cmp_ne_u32 vcc, v29, v37
    s_cbranch_vccz L_fk18
    s_add_u32 s79, s79, 1
    s_cmp_lt_u32 s79, 32768
    s_cbranch_scc1 L_fw17
L_fk18:
    buffer_load_dwordx4 v[164:167], v16, s[56:59], s74 offen nt
    s_add_u32 s74, s74, 8192
    buffer_load_dwordx4 v[168:171], v16, s[56:59], s74 offen nt
    s_add_u32 s74, s74, 8192
    buffer_load_dwordx4 v[172:175], v16, s[56:59], s74 offen nt
    s_add_u32 s74, s74, 8192
    buffer_load_dwordx4 v[176:179], v16, s[56:59], s74 offen nt
    s_add_u32 s74, s74, 8192
    buffer_load_dwordx4 v[180:183], v16, s[56:59], s74 offen nt
    s_add_u32 s74, s74, 8192
    buffer_load_dwordx4 v[184:187], v16, s[56:59], s74 offen nt
    s_add_u32 s74, s74, 8192
    buffer_load_dwordx4 v[188:191], v16, s[56:59], s74 offen nt
    s_add_u32 s74, s74, 8192
    s_waitcnt vmcnt(23)
L_gp19:
    v_xor_b32 v72, s80, v72
    v_xor_b32 v73, s81, v73
    v_xor_b32 v74, s82, v74
    v_xor_b32 v75, s83, v75
    v_xor_b32 v76, s80, v76
    v_xor_b32 v77, s81, v77
    v_xor_b32 v78, s82, v78
    v_xor_b32 v79, s83, v79
    v_or3_b32 v80, v72, v73, v74
    v_or3_b32 v81, v75, v76, v77
    v_or3_b32 v80, v80, v78, v79
    v_or_b32 v80, v80, v81
    v_and_b32 v80, v80, v23
    v_cmp_ne_u32 vcc, 0, v80
    s_cbranch_vccz L_gk20
    buffer_load_dwordx4 v[72:75], v26, s[32:35], s75 offen sc1
    buffer_load_dwordx4 v[76:79], v26, s[32:35], s76 offen sc1
    s_waitcnt vmcnt(0)
    s_add_u32 s79, s79, 1
    s_cmp_lt_u32 s79, 32768
    s_cbranch_scc1 L_gp19
L_gk20:
    s_waitcnt vmcnt(0)
    v_permlane32_swap_b32 v72, v74
    v_permlane32_swap_b32 v73, v75
    v_permlane32_swap_b32 v76, v78
    v_permlane32_swap_b32 v77, v79
    v_add_f32 v72, v72, v74
    v_add_f32 v73, v73, v75
    v_add_f32 v76, v76, v78
    v_add_f32 v77, v77, v79
    v_permlane16_swap_b32 v72, v73
    s_lshl_b32 s19, s17, 9
    v_permlane16_swap_b32 v76, v77
    v_add_f32 v72, v72, v73
    v_add_f32 v76, v76, v77
    s_add_u32 s19, s19, 30720
    v_add_f32_dpp v72, v72, v72 row_ror:8 row_mask:0xf bank_mask:0xf
    v_add_f32_dpp v76, v76, v76 row_ror:8 row_mask:0xf bank_mask:0xf
    v_add_u32 v26, s19, v3
    v_cvt_pk_bf16_f32 v72, v72, v76
    v_and_b32 v76, 0xffff0000, v72
    v_lshlrev_b32 v72, 16, v72
    v_mul_f32 v73, 0xbfb8aa3b, v72
    v_exp_f32 v73, v73
    s_nop 0
    v_add_f32 v73, 1.0, v73
    v_rcp_f32 v73, v73
    s_nop 0
    v_mul_f32 v73, v73, v72
    v_cvt_pk_bf16_f32 v73, v73, v73
    v_lshlrev_b32 v73, 16, v73
    v_mul_f32 v73, v73, v76
    v_cvt_pk_bf16_f32 v27, v73, v73
    s_nop 1
    v_and_b32_dpp v76, v27, v4 row_newbcast:0 row_mask:0xf bank_mask:0xf
    v_and_b32_dpp v77, v27, v5 row_newbcast:0 row_mask:0xf bank_mask:0xf
    v_and_b32_dpp v78, v27, v6 row_newbcast:0 row_mask:0xf bank_mask:0xf
    v_and_b32_dpp v79, v27, v7 row_newbcast:0 row_mask:0xf bank_mask:0xf
    v_and_b32_dpp v80, v27, v4 row_newbcast:1 row_mask:0xf bank_mask:0xf
    v_and_b32_dpp v81, v27, v5 row_newbcast:1 row_mask:0xf bank_mask:0xf
    v_mfma_f32_16x16x32_bf16 v[88:91], v[76:79], v[164:167], 0
    v_and_b32_dpp v82, v27, v6 row_newbcast:1 row_mask:0xf bank_mask:0xf
    v_and_b32_dpp v83, v27, v7 row_newbcast:1 row_mask:0xf bank_mask:0xf
    v_and_b32_dpp v84, v27, v4 row_newbcast:2 row_mask:0xf bank_mask:0xf
    v_and_b32_dpp v85, v27, v5 row_newbcast:2 row_mask:0xf bank_mask:0xf
    v_mfma_f32_16x16x32_bf16 v[88:91], v[80:83], v[168:171], v[88:91]
    v_and_b32_dpp v86, v27, v6 row_newbcast:2 row_mask:0xf bank_mask:0xf
    v_and_b32_dpp v87, v27, v7 row_newbcast:2 row_mask:0xf bank_mask:0xf
    v_and_b32_dpp v92, v27, v4 row_newbcast:3 row_mask:0xf bank_mask:0xf
    v_and_b32_dpp v93, v27, v5 row_newbcast:3 row_mask:0xf bank_mask:0xf
    v_mfma_f32_16x16x32_bf16 v[88:91], v[84:87], v[172:175], v[88:91]
    v_and_b32_dpp v94, v27, v6 row_newbcast:3 row_mask:0xf bank_mask:0xf
    v_and_b32_dpp v95, v27, v7 row_newbcast:3 row_mask:0xf bank_mask:0xf
    v_and_b32_dpp v76, v27, v4 row_newbcast:4 row_mask:0xf bank_mask:0xf
    v_and_b32_dpp v77, v27, v5 row_newbcast:4 row_mask:0xf bank_mask:0xf
    v_mfma_f32_16x16x32_bf16 v[88:91], v[92:95], v[176:179], v[88:91]
    v_and_b32_dpp v78, v27, v6 row_newbcast:4 row_mask:0xf bank_mask:0xf
    v_and_b32_dpp v79, v27, v7 row_newbcast:4 row_mask:0xf bank_mask:0xf
    v_and_b32_dpp v80, v27, v4 row_newbcast:5 row_mask:0xf bank_mask:0xf
    v_and_b32_dpp v81, v27, v5 row_newbcast:5 row_mask:0xf bank_mask:0xf
    v_mfma_f32_16x16x32_bf16 v[88:91], v[76:79], v[180:183], v[88:91]
    v_and_b32_dpp v82, v27, v6 row_newbcast:5 row_mask:0xf bank_mask:0xf
    v_and_b32_dpp v83, v27, v7 row_newbcast:5 row_mask:0xf bank_mask:0xf
    v_and_b32_dpp v84, v27, v4 row_newbcast:6 row_mask:0xf bank_mask:0xf
    v_and_b32_dpp v85, v27, v5 row_newbcast:6 row_mask:0xf bank_mask:0xf
    v_mfma_f32_16x16x32_bf16 v[88:91], v[80:83], v[184:187], v[88:91]
    v_and_b32_dpp v86, v27, v6 row_newbcast:6 row_mask:0xf bank_mask:0xf
    v_and_b32_dpp v87, v27, v7 row_newbcast:6 row_mask:0xf bank_mask:0xf
    s_nop 1
    v_mfma_f32_16x16x32_bf16 v[88:91], v[84:87], v[188:191], v[88:91]
    s_mov_b32 exec_hi, 0
    s_nop 6
    ds_write_b128 v26, v[88:91]
    s_mov_b64 exec, 1
    ds_add_rtn_u32 v29, v13, v28 offset:48
    s_mov_b64 exec, -1
    s_waitcnt lgkmcnt(0)
    v_readfirstlane_b32 s19, v29
    s_nop 1
    s_cmp_lg_u32 s19, 3
    s_cbranch_scc1 L_ys21
    ds_read_b128 v[72:75], v3 offset:30720
    ds_read_b128 v[76:79], v3 offset:31232
    ds_read_b128 v[80:83], v3 offset:31744
    ds_read_b128 v[84:87], v3 offset:32256
    s_waitcnt lgkmcnt(0)
    v_pk_add_f32 v[72:73], v[72:73], v[76:77]
    v_pk_add_f32 v[74:75], v[74:75], v[78:79]
    v_pk_add_f32 v[80:81], v[80:81], v[84:85]
    v_pk_add_f32 v[82:83], v[82:83], v[86:87]
    v_pk_add_f32 v[72:73], v[72:73], v[80:81]
    v_pk_add_f32 v[74:75], v[74:75], v[82:83]
    v_bfi_b32 v72, v23, s80, v72
    v_bfi_b32 v73, v23, s81, v73
    v_bfi_b32 v74, v23, s82, v74
    v_bfi_b32 v75, v23, s83, v75
    v_lshlrev_b32 v26, 5, v8
    v_lshl_add_u32 v26, v9, 4, v26
    s_lshl_b32 s19, s13, 12
    s_lshl_b32 s3, s12, 9
    s_add_u32 s19, s19, s3
    s_add_u32 s19, s19, 4718592
    s_mov_b32 exec_hi, 0
    buffer_store_dwordx4 v[72:75], v26, s[32:35], s19 offen sc1
    s_mov_b64 exec, -1
L_ys21:
    s_and_b32 s19, s12, 1
    s_lshl_b32 s19, s19, 1
    s_bfe_u32 s3, s12, 0x10001
    s_add_u32 s19, s19, s3
    s_lshl_b32 s19, s19, 2
    s_and_b32 s3, s13, 3
    s_add_u32 s19, s19, s3
    s_lshr_b32 s3, s72, 7
    s_xor_b32 s19, s19, s3
    s_or_b32 s19, s19, s17
    s_cmp_lg_u32 s19, 0
    s_cbranch_scc1 L_ldone
    v_lshlrev_b32 v26, 12, v9
    v_lshl_add_u32 v26, v8, 4, v26
    v_lshl_add_u32 v29, v8, 2, v9
    v_lshlrev_b32 v30, 1, v29
    v_lshlrev_b32 v29, 2, v29
    s_lshl_b32 s75, s67, 8
    s_add_u32 s75, s75, 4718592
    s_lshl_b32 s19, s72, 11
    s_lshl_b32 s3, s67, 7
    s_add_u32 s19, s19, s3
    s_lshr_b32 s76, s72, 1
    s_lshl_b32 s76, s76, 3
    s_add_u32 s76, s76, 4472832
    buffer_load_ushort v31, v30, s[24:27], s19 offen
L_yp22:
    buffer_load_dwordx2 v[32:33], v13, s[32:35], s76 offen sc1
    s_mov_b32 s19, s75
    buffer_load_dwordx4 v[100:103], v26, s[32:35], s19 offen sc1
    s_add_u32 s19, s19, 16384
    buffer_load_dwordx4 v[104:107], v26, s[32:35], s19 offen sc1
    s_add_u32 s19, s19, 16384
    buffer_load_dwordx4 v[108:111], v26, s[32:35], s19 offen sc1
    s_add_u32 s19, s19, 16384
    buffer_load_dwordx4 v[112:115], v26, s[32:35], s19 offen sc1
    s_add_u32 s19, s19, 16384
    buffer_load_dwordx4 v[116:119], v26, s[32:35], s19 offen sc1
    s_add_u32 s19, s19, 16384
    buffer_load_dwordx4 v[120:123], v26, s[32:35], s19 offen sc1
    s_add_u32 s19, s19, 16384
    buffer_load_dwordx4 v[124:127], v26, s[32:35], s19 offen sc1
    s_add_u32 s19, s19, 16384
    buffer_load_dwordx4 v[128:131], v26, s[32:35], s19 offen sc1
    s_add_u32 s19, s19, 16384
    s_waitcnt vmcnt(0)
    v_xor_b32 v33, s78, v33
    v_xor_b32 v100, s80, v100
    v_xor_b32 v101, s81, v101
    v_xor_b32 v102, s82, v102
    v_xor_b32 v103, s83, v103
    v_xor_b32 v104, s80, v104
    v_xor_b32 v105, s81, v105
    v_xor_b32 v106, s82, v106
    v_xor_b32 v107, s83, v107
    v_xor_b32 v108, s80, v108
    v_xor_b32 v109, s81, v109
    v_xor_b32 v110, s82, v110
    v_xor_b32 v111, s83, v111
    v_xor_b32 v112, s80, v112
    v_xor_b32 v113, s81, v113
    v_xor_b32 v114, s82, v114
    v_xor_b32 v115, s83, v115
    v_xor_b32 v116, s80, v116
    v_xor_b32 v117, s81, v117
    v_xor_b32 v118, s82, v118
    v_xor_b32 v119, s83, v119
    v_xor_b32 v120, s80, v120
    v_xor_b32 v121, s81, v121
    v_xor_b32 v122, s82, v122
    v_xor_b32 v123, s83, v123
    v_xor_b32 v124, s80, v124
    v_xor_b32 v125, s81, v125
    v_xor_b32 v126, s82, v126
    v_xor_b32 v127, s83, v127
    v_xor_b32 v128, s80, v128
    v_xor_b32 v129, s81, v129
    v_xor_b32 v130, s82, v130
    v_xor_b32 v131, s83, v131
    v_or_b32 v34, v100, v101
    v_or3_b32 v34, v34, v102, v103
    v_or3_b32 v34, v34, v104, v105
    v_or3_b32 v34, v34, v106, v107
    v_or3_b32 v34, v34, v108, v109
    v_or3_b32 v34, v34, v110, v111
    v_or3_b32 v34, v34, v112, v113
    v_or3_b32 v34, v34, v114, v115
    v_or3_b32 v34, v34, v116, v117
    v_or3_b32 v34, v34, v118, v119
    v_or3_b32 v34, v34, v120, v121
    v_or3_b32 v34, v34, v122, v123
    v_or3_b32 v34, v34, v124, v125
    v_or3_b32 v34, v34, v126, v127
    v_or3_b32 v34, v34, v128, v129
    v_or3_b32 v34, v34, v130, v131
    v_and_b32 v34, v34, v23
    v_or_b32 v34, v34, v33
    v_cmp_ne_u32 vcc, 0, v34
    s_cbranch_vccz L_yk23
    s_add_u32 s79, s79, 1
    s_cmp_lt_u32 s79, 32768
    s_cbranch_scc1 L_yp22
L_yk23:
    v_pk_add_f32 v[100:101], v[100:101], v[116:117]
    v_pk_add_f32 v[102:103], v[102:103], v[118:119]
    v_pk_add_f32 v[104:105], v[104:105], v[120:121]
    v_pk_add_f32 v[106:107], v[106:107], v[122:123]
    v_pk_add_f32 v[108:109], v[108:109], v[124:125]
    v_pk_add_f32 v[110:111], v[110:111], v[126:127]
    v_pk_add_f32 v[112:113], v[112:113], v[128:129]
    v_pk_add_f32 v[114:115], v[114:115], v[130:131]
    v_pk_add_f32 v[100:101], v[100:101], v[108:109]
    v_pk_add_f32 v[102:103], v[102:103], v[110:111]
    v_pk_add_f32 v[104:105], v[104:105], v[112:113]
    v_pk_add_f32 v[106:107], v[106:107], v[114:115]
    v_pk_add_f32 v[100:101], v[100:101], v[104:105]
    v_pk_add_f32 v[102:103], v[102:103], v[106:107]
    s_nop 1
    v_permlane32_swap_b32 v100, v102
    v_permlane32_swap_b32 v101, v103
    v_add_f32 v100, v100, v102
    v_add_f32 v101, v101, v103
    s_nop 1
    v_permlane16_swap_b32 v100, v101
    v_add_f32 v100, v100, v101
    s_lshr_b32 s19, s71, 11
    s_lshl_b32 s19, s19, 16
    s_not_b32 s3, s19
    s_ashr_i32 s3, s3, 31
    s_or_b32 s3, s3, 0x80000000
    s_xor_b32 s19, s19, s3
    s_and_b32 s19, s19, 0xffff0000
    v_mov_b32 v34, s19
    v_mul_f32 v34, 0xbfb8aa3b, v34
    v_exp_f32 v34, v34
    s_nop 0
    v_add_f32 v34, 1.0, v34
    v_rcp_f32 v34, v34
    s_nop 0
    v_cvt_pk_bf16_f32 v34, v34, v100
    v_and_b32 v35, 0xffff0000, v34
    v_lshlrev_b32 v34, 16, v34
    v_mul_f32 v34, v34, v35
    v_cvt_pk_bf16_f32 v34, v34, v34
    v_lshlrev_b32 v34, 16, v34
    v_lshlrev_b32 v31, 16, v31
    v_add_f32 v34, v34, v31
    s_and_b32 s3, s72, 1
    s_lshl_b32 s3, s3, 4
    v_lshrrev_b32 v32, s3, v32
    v_lshlrev_b32 v32, 16, v32
    v_sub_f32 v32, 1.0, v32
    v_cvt_pk_bf16_f32 v34, v34, v32
    v_and_b32 v35, 0xffff0000, v34
    v_lshlrev_b32 v34, 16, v34
    v_mul_f32 v34, v34, v35
    v_cvt_pk_bf16_f32 v34, v34, v34
    v_lshlrev_b32 v34, 16, v34
    v_mov_b32 v28, 1
    ds_write_b32 v29, v34 offset:512
    ds_write_b32 v13, v37 offset:224
    s_waitcnt lgkmcnt(0)
L_ldone:
    s_endpgm
L_compute:
    s_mov_b64 s[32:33], s[98:99]
    s_mov_b32 s34, 16777216
    s_mov_b32 s35, 0x00020000
    s_mov_b64 s[36:37], s[96:97]
    s_mov_b32 s38, 256
    s_mov_b32 s39, 0x00020000
    s_mov_b64 s[40:41], s[8:9]
    s_mov_b32 s42, 65536
    s_mov_b32 s43, 0x00020000
    s_mov_b64 s[44:45], s[94:95]
    s_mov_b32 s46, 4194304
    s_mov_b32 s47, 0x00020000
    s_mov_b64 s[60:61], s[98:99]
    s_mov_b32 s62, 16777216
    s_mov_b32 s63, 0x00020000
    s_mov_b32 s79, 0
    s_lshr_b32 s17, s16, 1
    s_and_b32 s18, s16, 1
    v_mov_b32 v13, 0
    v_and_b32 v4, 15, v2
    v_lshrrev_b32 v9, 4, v2
    s_or_b32 s19, s2, s16
    s_cmp_lg_u32 s19, 0
    s_cbranch_scc1 L_tp24
    s_memrealtime s[20:21]
    s_waitcnt lgkmcnt(0)
    s_or_b32 s20, s20, 1
    v_mov_b32 v3, s20
    s_mov_b64 exec, 1
    buffer_store_dword v3, v13, s[36:39], 0 offen offset:4 sc1
    s_mov_b64 exec, -1
L_tp24:
    s_lshl_b32 s67, s15, 1
    s_add_u32 s67, s67, s18
    s_lshl_b32 s19, s67, 11
    v_lshlrev_b32 v5, 6, v4
    v_lshl_add_u32 v5, v9, 3, v5
    buffer_load_dwordx2 v[60:61], v5, s[40:43], s19 offen offset:0
    buffer_load_dwordx2 v[62:63], v5, s[40:43], s19 offen offset:32
    buffer_load_dwordx2 v[64:65], v5, s[40:43], s19 offen offset:1024
    buffer_load_dwordx2 v[66:67], v5, s[40:43], s19 offen offset:1056
    s_lshl_b32 s19, s17, 13
    v_lshlrev_b32 v6, 7, v4
    v_add_u32 v6, s19, v6
    v_bfe_u32 v7, v2, 1, 3
    v_add_u32 v8, 0, v9
    v_xor_b32 v8, v8, v7
    v_lshl_add_u32 v20, v8, 4, v6
    v_add_u32 v8, 4, v9
    v_xor_b32 v8, v8, v7
    v_lshl_add_u32 v21, v8, 4, v6
    v_add_u32 v22, 40960, v20
    v_add_u32 v23, 40960, v21
    v_add_u32 v24, 81920, v20
    v_add_u32 v25, 81920, v21
    v_add_u32 v26, 122880, v20
    v_add_u32 v27, 122880, v21
    v_lshlrev_b32 v6, 10, v9
    v_bfe_u32 v7, v2, 2, 2
    v_lshl_add_u32 v6, v7, 7, v6
    v_bfe_u32 v7, v2, 3, 1
    v_xor_b32 v7, s18, v7
    v_lshl_add_u32 v6, v7, 6, v6
    v_bfe_u32 v7, v2, 4, 1
    v_lshl_add_u32 v6, v7, 5, v6
    v_and_b32 v7, 3, v2
    v_lshl_add_u32 v6, v7, 3, v6
    v_add_u32 v36, 16384, v6
    v_xor_b32 v37, 32, v36
    v_add_u32 v38, 57344, v6
    v_xor_b32 v39, 32, v38
    v_add_u32 v40, 98304, v6
    v_xor_b32 v41, 32, v40
    v_add_u32 v42, 139264, v6
    v_xor_b32 v43, 32, v42
    v_lshrrev_b32 v5, 2, v4
    v_and_b32 v6, 1, v4
    v_lshlrev_b32 v6, 4, v6
    v_mov_b32 v7, 0x3f80
    v_lshlrev_b32 v7, v6, v7
    v_cmp_eq_u32 vcc, v5, v9
    s_nop 1
    v_cndmask_b32 v7, 0, v7, vcc
    v_and_b32 v6, 2, v4
    v_cmp_eq_u32 vcc, 0, v6
    s_nop 1
    v_cndmask_b32 v52, 0, v7, vcc
    v_cndmask_b32 v53, v7, v13, vcc
    v_mov_b32 v56, 0x3f803f80
    v_mov_b32 v57, 0x3f803f80
    v_mov_b32 v58, 0x3f803f80
    v_mov_b32 v59, 0x3f803f80
    v_lshlrev_b32 v3, 4, v2
    v_lshlrev_b32 v12, 4, v9
    v_lshrrev_b32 v11, 5, v2
    v_lshlrev_b32 v8, 9, v11
    v_and_b32 v19, 16, v12
    v_add_u32 v8, v8, v19
    v_lshlrev_b32 v11, 2, v11
    v_lshl_add_u32 v11, v4, 4, v11
    v_lshlrev_b32 v9, 10, v9
    v_lshl_add_u32 v9, v4, 4, v9
    v_lshlrev_b32 v10, 3, v2
    s_xor_b32 s3, s16, 2
    s_mul_i32 s19, s3, 6144
    s_add_u32 s19, s19, 2048
    v_add_u32 v4, s19, v3
    s_mul_i32 s19, s16, 6144
    s_add_u32 s19, s19, 2048
    v_add_u32 v5, s19, v3
    v_lshlrev_b32 v7, 2, v2
    s_lshl_b32 s19, s3, 8
    s_add_u32 s19, s19, 1024
    v_add_u32 v6, s19, v7
    s_lshl_b32 s19, s16, 8
    s_add_u32 s19, s19, 1024
    v_add_u32 v7, s19, v7
    v_mov_b32 v15, 0x3ff
    v_mov_b32 v18, 0x7fc17fc1
    s_lshl_b32 s19, s16, 2
    v_mov_b32 v1, s19
    v_mov_b32 v19, -1
    s_lshl_b32 s19, s15, 2
    s_lshr_b32 s3, s14, 2
    s_add_u32 s19, s19, s3
    s_and_b32 s3, s14, 1
    s_bfe_u32 s20, s14, 0x10001
    s_lshl_b32 s20, s20, 3
    s_lshl_b32 s64, s19, 1
    s_add_u32 s64, s64, s3
    s_lshl_b32 s64, s64, 2
    s_add_u32 s64, s64, s16
    s_lshl_b32 s64, s64, 8
    s_add_u32 s64, s64, s20
    s_add_u32 s64, s64, 4325376
    s_lshl_b32 s65, s19, 1
    s_add_u32 s65, s65, s3
    s_lshl_b32 s65, s65, 1
    s_add_u32 s65, s65, s17
    s_lshl_b32 s65, s65, 4
    s_add_u32 s65, s65, s20
    s_lshl_b32 s3, s18, 2
    s_add_u32 s65, s65, s3
    s_add_u32 s65, s65, 4456448
    s_mov_b32 s74, 0x3fb8aa3b
    s_mov_b32 s76, 0xbfb8aa3b
    s_mov_b32 s75, 0
    s_mov_b32 s77, 0
    s_mov_b32 s69, 0
    s_mov_b32 s71, 0
    s_cmp_lg_u32 s17, 0
    s_cselect_b32 s68, s74, s76
    s_cselect_b32 s70, s76, s74
    s_cselect_b64 s[72:73], -1, 0
    s_mov_b32 s66, 0
    s_lshl_b32 s19, s15, 4
    s_lshl_b32 s3, s18, 3
    s_add_u32 s19, s19, s3
    s_lshl_b32 s3, s17, 2
    s_add_u32 s19, s19, s3
    s_lshl_b32 s19, s19, 4
    s_add_u32 s19, s19, s14
    s_lshl_b32 s48, s19, 10
    s_lshl_b32 s49, s19, 5
    s_add_u32 s49, s49, 4194304
    s_lshl_b32 s19, s15, 4
    s_add_u32 s19, s19, s14
    s_lshl_b32 s50, s19, 6
    s_add_u32 s50, s50, s16
    s_lshl_b32 s50, s50, 8
    s_lshl_b32 s51, s19, 9
    s_add_u32 s51, s51, 4194304
    s_lshl_b32 s19, s14, 1
    s_add_u32 s19, s19, s17
    s_lshl_b32 s52, s19, 17
    s_lshl_b32 s3, s67, 10
    s_add_u32 s52, s52, s3
    s_add_u32 s52, s52, 8388608
    s_lshl_b32 s53, s19, 5
    s_add_u32 s53, s53, s67
    s_lshl_b32 s53, s53, 2
    s_add_u32 s53, s53, 4481024
    s_and_b32 s19, s12, 1
    s_lshl_b32 s19, s19, 1
    s_bfe_u32 s3, s12, 0x10001
    s_add_u32 s19, s19, s3
    s_lshl_b32 s19, s19, 2
    s_and_b32 s3, s13, 3
    s_add_u32 s19, s19, s3
    s_lshl_b32 s58, s19, 2
    s_add_u32 s58, s58, s16
    s_lshr_b32 s19, s12, 2
    s_lshl_b32 s19, s19, 3
    s_lshr_b32 s3, s13, 2
    s_add_u32 s19, s19, s3
    s_lshl_b32 s54, s58, 16
    s_lshl_b32 s3, s19, 7
    s_add_u32 s54, s54, s3
    s_add_u32 s55, s54, 32768
    s_lshr_b32 s56, s58, 1
    s_lshl_b32 s56, s56, 7
    s_add_u32 s56, s56, 4481024
    s_lshl_b32 s57, s58, 7
    s_add_u32 s57, s57, 4472832
    s_lshl_b32 s59, s67, 12
    s_add_u32 s59, s59, 4325376
    s_lshl_b32 s28, s67, 7
    s_add_u32 s28, s28, 4456448
    s_mov_b32 s29, 0
    v_lshrrev_b32 v19, 4, v2
    v_and_b32 v54, 15, v2
    v_lshlrev_b32 v54, 6, v54
    v_lshl_add_u32 v76, v19, 14, v54
    v_lshl_add_u32 v77, v19, 15, v54
    v_lshrrev_b32 v19, 1, v2
    v_and_b32 v54, 1, v2
    v_lshlrev_b32 v54, 6, v54
    v_lshl_add_u32 v78, v19, 11, v54
    v_lshlrev_b32 v79, 9, v2
    v_lshrrev_b32 v54, 1, v2
    v_lshlrev_b32 v54, 10, v54
    v_and_b32 v19, 1, v2
    v_lshl_add_u32 v54, v19, 7, v54
    v_add_u32 v54, s50, v54
    v_lshlrev_b32 v19, 7, v2
    v_add_u32 v55, s51, v19
    s_sub_u32 s3, s59, 4096
    v_add_u32 v19, s3, v19
    v_cmp_gt_u32 vcc, 32, v2
    s_nop 1
    v_cndmask_b32 v54, v19, v54, vcc
    v_mov_b32 v19, s28
    v_cmp_gt_u32 vcc, 4, v2
    s_nop 1
    v_cndmask_b32 v55, v19, v55, vcc
    v_mov_b32 v19, -1
    s_lshl_b32 s19, s14, 4
    s_add_u32 s19, s19, s15
    s_lshl_b32 s53, s19, 7
    s_add_u32 s53, s53, 4849664
    s_lshr_b32 s19, s58, 2
    s_lshl_b32 s56, s19, 11
    s_add_u32 s56, s56, 4849664
    v_mov_b64 v[160:161], 0
    v_mov_b64 v[162:163], 0
    v_mov_b64 v[164:165], 0
    v_mov_b64 v[166:167], 0
    v_mov_b64 v[168:169], 0
    v_mov_b64 v[170:171], 0
    v_mov_b64 v[172:173], 0
    v_mov_b64 v[174:175], 0
    v_mov_b64 v[176:177], 0
    v_mov_b64 v[178:179], 0
    v_mov_b64 v[180:181], 0
    v_mov_b64 v[182:183], 0
    v_mov_b64 v[184:185], 0
    v_mov_b64 v[186:187], 0
    v_mov_b64 v[188:189], 0
    v_mov_b64 v[190:191], 0
    v_mov_b64 v[192:193], 0
    v_mov_b64 v[194:195], 0
    v_mov_b64 v[196:197], 0
    v_mov_b64 v[198:199], 0
    v_mov_b64 v[200:201], 0
    v_mov_b64 v[202:203], 0
    v_mov_b64 v[204:205], 0
    v_mov_b64 v[206:207], 0
    v_mov_b64 v[208:209], 0
    v_mov_b64 v[210:211], 0
    v_mov_b64 v[212:213], 0
    v_mov_b64 v[214:215], 0
    v_mov_b64 v[216:217], 0
    v_mov_b64 v[218:219], 0
    v_mov_b64 v[220:221], 0
    v_mov_b64 v[222:223], 0
    v_mov_b64 v[224:225], 0
    v_mov_b64 v[226:227], 0
    v_mov_b64 v[228:229], 0
    v_mov_b64 v[230:231], 0
    v_mov_b64 v[232:233], 0
    v_mov_b64 v[234:235], 0
    v_mov_b64 v[236:237], 0
    v_mov_b64 v[238:239], 0
    v_mov_b64 v[240:241], 0
    v_mov_b64 v[242:243], 0
    v_mov_b64 v[244:245], 0
    v_mov_b64 v[246:247], 0
    v_mov_b64 v[248:249], 0
    v_mov_b64 v[250:251], 0
    v_mov_b64 v[252:253], 0
    v_mov_b64 v[254:255], 0
    s_waitcnt vmcnt(4)
    s_barrier
    ds_read_b128 v[80:83], v20 offset:0
    ds_read_b64_tr_b16 v[96:97], v36 offset:0
    ds_read_b64_tr_b16 v[98:99], v36 offset:512
    ds_read_b128 v[84:87], v20 offset:2048
    ds_read_b128 v[88:91], v20 offset:4096
    ds_read_b128 v[92:95], v20 offset:6144
    ds_read_b64_tr_b16 v[100:101], v37 offset:0
    ds_read_b64_tr_b16 v[102:103], v37 offset:512
    ds_read_b64_tr_b16 v[104:105], v36 offset:8192
    ds_read_b64_tr_b16 v[106:107], v36 offset:8704
    ds_read_b64_tr_b16 v[108:109], v37 offset:8192
    ds_read_b64_tr_b16 v[110:111], v37 offset:8704
    ds_read_b64_tr_b16 v[112:113], v36 offset:16384
    ds_read_b64_tr_b16 v[114:115], v36 offset:16896
    ds_read_b64_tr_b16 v[116:117], v37 offset:16384
    ds_read_b64_tr_b16 v[118:119], v37 offset:16896
    s_mov_b32 exec_lo, 0xffff
    s_mov_b32 exec_hi, 0xffff
    buffer_store_dword v19, v11, s[32:35], s64 offen sc1
    s_lshl_b64 exec, 1, s16
    buffer_store_dword v19, v13, s[32:35], s65 offen sc1
    s_mov_b64 exec, -1
.p2align 7
L_loop:
    s_waitcnt lgkmcnt(10)
    v_mfma_f32_16x16x32_bf16 v[160:163], v[96:99], v[80:83], v[160:163]
    ds_read_b128 v[120:123], v21 offset:0
    v_mfma_f32_16x16x32_bf16 v[164:167], v[96:99], v[84:87], v[164:167]
    ds_read_b64_tr_b16 v[136:137], v36 offset:4096
    v_mfma_f32_16x16x32_bf16 v[168:171], v[96:99], v[88:91], v[168:171]
    ds_read_b64_tr_b16 v[138:139], v36 offset:4608
    v_mfma_f32_16x16x32_bf16 v[172:175], v[96:99], v[92:95], v[172:175]
    s_waitcnt lgkmcnt(11)
    v_mfma_f32_16x16x32_bf16 v[188:191], v[100:103], v[92:95], v[188:191]
    ds_read_b128 v[124:127], v21 offset:2048
    v_mfma_f32_16x16x32_bf16 v[184:187], v[100:103], v[88:91], v[184:187]
    ds_read_b128 v[128:131], v21 offset:4096
    v_mfma_f32_16x16x32_bf16 v[180:183], v[100:103], v[84:87], v[180:183]
    ds_read_b128 v[132:135], v21 offset:6144
    v_mfma_f32_16x16x32_bf16 v[176:179], v[100:103], v[80:83], v[176:179]
    s_waitcnt lgkmcnt(12)
    v_mfma_f32_16x16x32_bf16 v[192:195], v[104:107], v[80:83], v[192:195]
    ds_read_b64_tr_b16 v[140:141], v37 offset:4096
    v_mfma_f32_16x16x32_bf16 v[196:199], v[104:107], v[84:87], v[196:199]
    ds_read_b64_tr_b16 v[142:143], v37 offset:4608
    v_mfma_f32_16x16x32_bf16 v[200:203], v[104:107], v[88:91], v[200:203]
    ds_read_b64_tr_b16 v[144:145], v36 offset:12288
    v_mfma_f32_16x16x32_bf16 v[204:207], v[104:107], v[92:95], v[204:207]
    s_waitcnt lgkmcnt(13)
    v_mfma_f32_16x16x32_bf16 v[220:223], v[108:111], v[92:95], v[220:223]
    ds_read_b64_tr_b16 v[146:147], v36 offset:12800
    v_mfma_f32_16x16x32_bf16 v[216:219], v[108:111], v[88:91], v[216:219]
    ds_read_b64_tr_b16 v[148:149], v37 offset:12288
    v_mfma_f32_16x16x32_bf16 v[212:215], v[108:111], v[84:87], v[212:215]
    ds_read_b64_tr_b16 v[150:151], v37 offset:12800
    v_mfma_f32_16x16x32_bf16 v[208:211], v[108:111], v[80:83], v[208:211]
    s_waitcnt lgkmcnt(14)
    v_mfma_f32_16x16x32_bf16 v[224:227], v[80:83], v[112:115], v[224:227]
    ds_read_b64_tr_b16 v[152:153], v36 offset:20480
    v_mfma_f32_16x16x32_bf16 v[228:231], v[84:87], v[112:115], v[228:231]
    ds_read_b64_tr_b16 v[154:155], v36 offset:20992
    v_mfma_f32_16x16x32_bf16 v[232:235], v[88:91], v[112:115], v[232:235]
    ds_read_b64_tr_b16 v[156:157], v37 offset:20480
    v_mfma_f32_16x16x32_bf16 v[236:239], v[92:95], v[112:115], v[236:239]
    s_waitcnt lgkmcnt(15)
    v_mfma_f32_16x16x32_bf16 v[252:255], v[92:95], v[116:119], v[252:255]
    ds_read_b64_tr_b16 v[158:159], v37 offset:20992
    v_mfma_f32_16x16x32_bf16 v[248:251], v[88:91], v[116:119], v[248:251]
    v_mfma_f32_16x16x32_bf16 v[244:247], v[84:87], v[116:119], v[244:247]
    v_mfma_f32_16x16x32_bf16 v[240:243], v[80:83], v[116:119], v[240:243]
    s_waitcnt lgkmcnt(10)
    v_mfma_f32_16x16x32_bf16 v[160:163], v[136:139], v[120:123], v[160:163]
    v_mfma_f32_16x16x32_bf16 v[164:167], v[136:139], v[124:127], v[164:167]
    v_mfma_f32_16x16x32_bf16 v[168:171], v[136:139], v[128:131], v[168:171]
    v_mfma_f32_16x16x32_bf16 v[172:175], v[136:139], v[132:135], v[172:175]
    s_waitcnt lgkmcnt(0)
    s_barrier
    ds_read_b128 v[80:83], v22 offset:0
    v_mfma_f32_16x16x32_bf16 v[188:191], v[140:143], v[132:135], v[188:191]
    ds_read_b64_tr_b16 v[96:97], v38 offset:0
    v_mfma_f32_16x16x32_bf16 v[184:187], v[140:143], v[128:131], v[184:187]
    ds_read_b64_tr_b16 v[98:99], v38 offset:512
    v_mfma_f32_16x16x32_bf16 v[180:183], v[140:143], v[124:127], v[180:183]
    ds_read_b128 v[84:87], v22 offset:2048
    v_mfma_f32_16x16x32_bf16 v[176:179], v[140:143], v[120:123], v[176:179]
    ds_read_b128 v[88:91], v22 offset:4096
    v_mfma_f32_16x16x32_bf16 v[192:195], v[144:147], v[120:123], v[192:195]
    ds_read_b128 v[92:95], v22 offset:6144
    v_mfma_f32_16x16x32_bf16 v[196:199], v[144:147], v[124:127], v[196:199]
    ds_read_b64_tr_b16 v[100:101], v39 offset:0
    v_mfma_f32_16x16x32_bf16 v[200:203], v[144:147], v[128:131], v[200:203]
    ds_read_b64_tr_b16 v[102:103], v39 offset:512
    v_mfma_f32_16x16x32_bf16 v[204:207], v[144:147], v[132:135], v[204:207]
    ds_read_b64_tr_b16 v[104:105], v38 offset:8192
    v_mfma_f32_16x16x32_bf16 v[220:223], v[148:151], v[132:135], v[220:223]
    ds_read_b64_tr_b16 v[106:107], v38 offset:8704
    v_mfma_f32_16x16x32_bf16 v[216:219], v[148:151], v[128:131], v[216:219]
    ds_read_b64_tr_b16 v[108:109], v39 offset:8192
    v_mfma_f32_16x16x32_bf16 v[212:215], v[148:151], v[124:127], v[212:215]
    ds_read_b64_tr_b16 v[110:111], v39 offset:8704
    v_mfma_f32_16x16x32_bf16 v[208:211], v[148:151], v[120:123], v[208:211]
    ds_read_b64_tr_b16 v[112:113], v38 offset:16384
    v_mfma_f32_16x16x32_bf16 v[224:227], v[120:123], v[152:155], v[224:227]
    ds_read_b64_tr_b16 v[114:115], v38 offset:16896
    v_mfma_f32_16x16x32_bf16 v[228:231], v[124:127], v[152:155], v[228:231]
    ds_read_b64_tr_b16 v[116:117], v39 offset:16384
    v_mfma_f32_16x16x32_bf16 v[232:235], v[128:131], v[152:155], v[232:235]
    ds_read_b64_tr_b16 v[118:119], v39 offset:16896
    v_mfma_f32_16x16x32_bf16 v[236:239], v[132:135], v[152:155], v[236:239]
    v_mfma_f32_16x16x32_bf16 v[252:255], v[132:135], v[156:159], v[252:255]
    v_mfma_f32_16x16x32_bf16 v[248:251], v[128:131], v[156:159], v[248:251]
    v_mfma_f32_16x16x32_bf16 v[244:247], v[124:127], v[156:159], v[244:247]
    v_mfma_f32_16x16x32_bf16 v[240:243], v[120:123], v[156:159], v[240:243]
    s_cmp_eq_u32 s66, 2
    s_cbranch_scc1 L_mid
L_midret:
    s_waitcnt lgkmcnt(10)
    v_mfma_f32_16x16x32_bf16 v[160:163], v[96:99], v[80:83], v[160:163]
    ds_read_b128 v[120:123], v23 offset:0
    v_mfma_f32_16x16x32_bf16 v[164:167], v[96:99], v[84:87], v[164:167]
    ds_read_b64_tr_b16 v[136:137], v38 offset:4096
    v_mfma_f32_16x16x32_bf16 v[168:171], v[96:99], v[88:91], v[168:171]
    ds_read_b64_tr_b16 v[138:139], v38 offset:4608
    v_mfma_f32_16x16x32_bf16 v[172:175], v[96:99], v[92:95], v[172:175]
    s_waitcnt lgkmcnt(11)
    v_mfma_f32_16x16x32_bf16 v[188:191], v[100:103], v[92:95], v[188:191]
    ds_read_b128 v[124:127], v23 offset:2048
    v_mfma_f32_16x16x32_bf16 v[184:187], v[100:103], v[88:91], v[184:187]
    ds_read_b128 v[128:131], v23 offset:4096
    v_mfma_f32_16x16x32_bf16 v[180:183], v[100:103], v[84:87], v[180:183]
    ds_read_b128 v[132:135], v23 offset:6144
    v_mfma_f32_16x16x32_bf16 v[176:179], v[100:103], v[80:83], v[176:179]
    s_waitcnt lgkmcnt(12)
    v_mfma_f32_16x16x32_bf16 v[192:195], v[104:107], v[80:83], v[192:195]
    ds_read_b64_tr_b16 v[140:141], v39 offset:4096
    v_mfma_f32_16x16x32_bf16 v[196:199], v[104:107], v[84:87], v[196:199]
    ds_read_b64_tr_b16 v[142:143], v39 offset:4608
    v_mfma_f32_16x16x32_bf16 v[200:203], v[104:107], v[88:91], v[200:203]
    ds_read_b64_tr_b16 v[144:145], v38 offset:12288
    v_mfma_f32_16x16x32_bf16 v[204:207], v[104:107], v[92:95], v[204:207]
    s_waitcnt lgkmcnt(13)
    v_mfma_f32_16x16x32_bf16 v[220:223], v[108:111], v[92:95], v[220:223]
    ds_read_b64_tr_b16 v[146:147], v38 offset:12800
    v_mfma_f32_16x16x32_bf16 v[216:219], v[108:111], v[88:91], v[216:219]
    ds_read_b64_tr_b16 v[148:149], v39 offset:12288
    v_mfma_f32_16x16x32_bf16 v[212:215], v[108:111], v[84:87], v[212:215]
    ds_read_b64_tr_b16 v[150:151], v39 offset:12800
    v_mfma_f32_16x16x32_bf16 v[208:211], v[108:111], v[80:83], v[208:211]
    s_waitcnt lgkmcnt(14)
    v_mfma_f32_16x16x32_bf16 v[224:227], v[80:83], v[112:115], v[224:227]
    ds_read_b64_tr_b16 v[152:153], v38 offset:20480
    v_mfma_f32_16x16x32_bf16 v[228:231], v[84:87], v[112:115], v[228:231]
    ds_read_b64_tr_b16 v[154:155], v38 offset:20992
    v_mfma_f32_16x16x32_bf16 v[232:235], v[88:91], v[112:115], v[232:235]
    ds_read_b64_tr_b16 v[156:157], v39 offset:20480
    v_mfma_f32_16x16x32_bf16 v[236:239], v[92:95], v[112:115], v[236:239]
    s_waitcnt lgkmcnt(15)
    v_mfma_f32_16x16x32_bf16 v[252:255], v[92:95], v[116:119], v[252:255]
    ds_read_b64_tr_b16 v[158:159], v39 offset:20992
    v_mfma_f32_16x16x32_bf16 v[248:251], v[88:91], v[116:119], v[248:251]
    v_mfma_f32_16x16x32_bf16 v[244:247], v[84:87], v[116:119], v[244:247]
    v_mfma_f32_16x16x32_bf16 v[240:243], v[80:83], v[116:119], v[240:243]
    s_waitcnt lgkmcnt(10)
    v_mfma_f32_16x16x32_bf16 v[160:163], v[136:139], v[120:123], v[160:163]
    v_mfma_f32_16x16x32_bf16 v[164:167], v[136:139], v[124:127], v[164:167]
    v_mfma_f32_16x16x32_bf16 v[168:171], v[136:139], v[128:131], v[168:171]
    v_mfma_f32_16x16x32_bf16 v[172:175], v[136:139], v[132:135], v[172:175]
    s_cmp_eq_u32 s66, 3
    s_waitcnt lgkmcnt(0)
    s_barrier
L_nob:
    ds_read_b128 v[80:83], v24 offset:0
    v_mfma_f32_16x16x32_bf16 v[188:191], v[140:143], v[132:135], v[188:191]
    ds_read_b64_tr_b16 v[96:97], v40 offset:0
    v_mfma_f32_16x16x32_bf16 v[184:187], v[140:143], v[128:131], v[184:187]
    ds_read_b64_tr_b16 v[98:99], v40 offset:512
    v_mfma_f32_16x16x32_bf16 v[180:183], v[140:143], v[124:127], v[180:183]
    ds_read_b128 v[84:87], v24 offset:2048
    v_mfma_f32_16x16x32_bf16 v[176:179], v[140:143], v[120:123], v[176:179]
    ds_read_b128 v[88:91], v24 offset:4096
    v_mfma_f32_16x16x32_bf16 v[192:195], v[144:147], v[120:123], v[192:195]
    ds_read_b128 v[92:95], v24 offset:6144
    v_mfma_f32_16x16x32_bf16 v[196:199], v[144:147], v[124:127], v[196:199]
    ds_read_b64_tr_b16 v[100:101], v41 offset:0
    v_mfma_f32_16x16x32_bf16 v[200:203], v[144:147], v[128:131], v[200:203]
    ds_read_b64_tr_b16 v[102:103], v41 offset:512
    v_mfma_f32_16x16x32_bf16 v[204:207], v[144:147], v[132:135], v[204:207]
    ds_read_b64_tr_b16 v[104:105], v40 offset:8192
    v_mfma_f32_16x16x32_bf16 v[220:223], v[148:151], v[132:135], v[220:223]
    ds_read_b64_tr_b16 v[106:107], v40 offset:8704
    v_mfma_f32_16x16x32_bf16 v[216:219], v[148:151], v[128:131], v[216:219]
    ds_read_b64_tr_b16 v[108:109], v41 offset:8192
    v_mfma_f32_16x16x32_bf16 v[212:215], v[148:151], v[124:127], v[212:215]
    ds_read_b64_tr_b16 v[110:111], v41 offset:8704
    v_mfma_f32_16x16x32_bf16 v[208:211], v[148:151], v[120:123], v[208:211]
    ds_read_b64_tr_b16 v[112:113], v40 offset:16384
    v_mfma_f32_16x16x32_bf16 v[224:227], v[120:123], v[152:155], v[224:227]
    ds_read_b64_tr_b16 v[114:115], v40 offset:16896
    v_mfma_f32_16x16x32_bf16 v[228:231], v[124:127], v[152:155], v[228:231]
    ds_read_b64_tr_b16 v[116:117], v41 offset:16384
    v_mfma_f32_16x16x32_bf16 v[232:235], v[128:131], v[152:155], v[232:235]
    ds_read_b64_tr_b16 v[118:119], v41 offset:16896
    v_mfma_f32_16x16x32_bf16 v[236:239], v[132:135], v[152:155], v[236:239]
    v_mfma_f32_16x16x32_bf16 v[252:255], v[132:135], v[156:159], v[252:255]
    v_mfma_f32_16x16x32_bf16 v[248:251], v[128:131], v[156:159], v[248:251]
    v_mfma_f32_16x16x32_bf16 v[244:247], v[124:127], v[156:159], v[244:247]
    v_mfma_f32_16x16x32_bf16 v[240:243], v[120:123], v[156:159], v[240:243]
    s_waitcnt lgkmcnt(10)
    v_mfma_f32_16x16x32_bf16 v[160:163], v[96:99], v[80:83], v[160:163]
    ds_read_b128 v[120:123], v25 offset:0
    v_mfma_f32_16x16x32_bf16 v[164:167], v[96:99], v[84:87], v[164:167]
    ds_read_b64_tr_b16 v[136:137], v40 offset:4096
    v_mfma_f32_16x16x32_bf16 v[168:171], v[96:99], v[88:91], v[168:171]
    ds_read_b64_tr_b16 v[138:139], v40 offset:4608
    v_mfma_f32_16x16x32_bf16 v[172:175], v[96:99], v[92:95], v[172:175]
    s_waitcnt lgkmcnt(11)
    v_mfma_f32_16x16x32_bf16 v[188:191], v[100:103], v[92:95], v[188:191]
    ds_read_b128 v[124:127], v25 offset:2048
    v_mfma_f32_16x16x32_bf16 v[184:187], v[100:103], v[88:91], v[184:187]
    ds_read_b128 v[128:131], v25 offset:4096
    v_mfma_f32_16x16x32_bf16 v[180:183], v[100:103], v[84:87], v[180:183]
    ds_read_b128 v[132:135], v25 offset:6144
    v_mfma_f32_16x16x32_bf16 v[176:179], v[100:103], v[80:83], v[176:179]
    s_waitcnt lgkmcnt(12)
    v_mfma_f32_16x16x32_bf16 v[192:195], v[104:107], v[80:83], v[192:195]
    ds_read_b64_tr_b16 v[140:141], v41 offset:4096
    v_mfma_f32_16x16x32_bf16 v[196:199], v[104:107], v[84:87], v[196:199]
    ds_read_b64_tr_b16 v[142:143], v41 offset:4608
    v_mfma_f32_16x16x32_bf16 v[200:203], v[104:107], v[88:91], v[200:203]
    ds_read_b64_tr_b16 v[144:145], v40 offset:12288
    v_mfma_f32_16x16x32_bf16 v[204:207], v[104:107], v[92:95], v[204:207]
    s_waitcnt lgkmcnt(13)
    v_mfma_f32_16x16x32_bf16 v[220:223], v[108:111], v[92:95], v[220:223]
    ds_read_b64_tr_b16 v[146:147], v40 offset:12800
    v_mfma_f32_16x16x32_bf16 v[216:219], v[108:111], v[88:91], v[216:219]
    ds_read_b64_tr_b16 v[148:149], v41 offset:12288
    v_mfma_f32_16x16x32_bf16 v[212:215], v[108:111], v[84:87], v[212:215]
    ds_read_b64_tr_b16 v[150:151], v41 offset:12800
    v_mfma_f32_16x16x32_bf16 v[208:211], v[108:111], v[80:83], v[208:211]
    s_waitcnt lgkmcnt(14)
    v_mfma_f32_16x16x32_bf16 v[224:227], v[80:83], v[112:115], v[224:227]
    ds_read_b64_tr_b16 v[152:153], v40 offset:20480
    v_mfma_f32_16x16x32_bf16 v[228:231], v[84:87], v[112:115], v[228:231]
    ds_read_b64_tr_b16 v[154:155], v40 offset:20992
    v_mfma_f32_16x16x32_bf16 v[232:235], v[88:91], v[112:115], v[232:235]
    ds_read_b64_tr_b16 v[156:157], v41 offset:20480
    v_mfma_f32_16x16x32_bf16 v[236:239], v[92:95], v[112:115], v[236:239]
    s_waitcnt lgkmcnt(15)
    v_mfma_f32_16x16x32_bf16 v[252:255], v[92:95], v[116:119], v[252:255]
    ds_read_b64_tr_b16 v[158:159], v41 offset:20992
    v_mfma_f32_16x16x32_bf16 v[248:251], v[88:91], v[116:119], v[248:251]
    v_mfma_f32_16x16x32_bf16 v[244:247], v[84:87], v[116:119], v[244:247]
    v_mfma_f32_16x16x32_bf16 v[240:243], v[80:83], v[116:119], v[240:243]
    s_waitcnt lgkmcnt(10)
    v_mfma_f32_16x16x32_bf16 v[160:163], v[136:139], v[120:123], v[160:163]
    v_mfma_f32_16x16x32_bf16 v[164:167], v[136:139], v[124:127], v[164:167]
    v_mfma_f32_16x16x32_bf16 v[168:171], v[136:139], v[128:131], v[168:171]
    v_mfma_f32_16x16x32_bf16 v[172:175], v[136:139], v[132:135], v[172:175]
    s_cmp_eq_u32 s66, 3
    s_waitcnt lgkmcnt(0)
    s_cbranch_scc1 L_last
    s_barrier
    ds_read_b128 v[80:83], v26 offset:0
    v_mfma_f32_16x16x32_bf16 v[188:191], v[140:143], v[132:135], v[188:191]
    ds_read_b64_tr_b16 v[96:97], v42 offset:0
    v_mfma_f32_16x16x32_bf16 v[184:187], v[140:143], v[128:131], v[184:187]
    ds_read_b64_tr_b16 v[98:99], v42 offset:512
    v_mfma_f32_16x16x32_bf16 v[180:183], v[140:143], v[124:127], v[180:183]
    ds_read_b128 v[84:87], v26 offset:2048
    v_mfma_f32_16x16x32_bf16 v[176:179], v[140:143], v[120:123], v[176:179]
    ds_read_b128 v[88:91], v26 offset:4096
    v_mfma_f32_16x16x32_bf16 v[192:195], v[144:147], v[120:123], v[192:195]
    ds_read_b128 v[92:95], v26 offset:6144
    v_mfma_f32_16x16x32_bf16 v[196:199], v[144:147], v[124:127], v[196:199]
    ds_read_b64_tr_b16 v[100:101], v43 offset:0
    v_mfma_f32_16x16x32_bf16 v[200:203], v[144:147], v[128:131], v[200:203]
    ds_read_b64_tr_b16 v[102:103], v43 offset:512
    v_mfma_f32_16x16x32_bf16 v[204:207], v[144:147], v[132:135], v[204:207]
    ds_read_b64_tr_b16 v[104:105], v42 offset:8192
    v_mfma_f32_16x16x32_bf16 v[220:223], v[148:151], v[132:135], v[220:223]
    ds_read_b64_tr_b16 v[106:107], v42 offset:8704
    v_mfma_f32_16x16x32_bf16 v[216:219], v[148:151], v[128:131], v[216:219]
    ds_read_b64_tr_b16 v[108:109], v43 offset:8192
    v_mfma_f32_16x16x32_bf16 v[212:215], v[148:151], v[124:127], v[212:215]
    ds_read_b64_tr_b16 v[110:111], v43 offset:8704
    v_mfma_f32_16x16x32_bf16 v[208:211], v[148:151], v[120:123], v[208:211]
    ds_read_b64_tr_b16 v[112:113], v42 offset:16384
    v_mfma_f32_16x16x32_bf16 v[224:227], v[120:123], v[152:155], v[224:227]
    ds_read_b64_tr_b16 v[114:115], v42 offset:16896
    v_mfma_f32_16x16x32_bf16 v[228:231], v[124:127], v[152:155], v[228:231]
    ds_read_b64_tr_b16 v[116:117], v43 offset:16384
    v_mfma_f32_16x16x32_bf16 v[232:235], v[128:131], v[152:155], v[232:235]
    ds_read_b64_tr_b16 v[118:119], v43 offset:16896
    v_mfma_f32_16x16x32_bf16 v[236:239], v[132:135], v[152:155], v[236:239]
    v_mfma_f32_16x16x32_bf16 v[252:255], v[132:135], v[156:159], v[252:255]
    v_mfma_f32_16x16x32_bf16 v[248:251], v[128:131], v[156:159], v[248:251]
    v_mfma_f32_16x16x32_bf16 v[244:247], v[124:127], v[156:159], v[244:247]
    v_mfma_f32_16x16x32_bf16 v[240:243], v[120:123], v[156:159], v[240:243]
    s_waitcnt lgkmcnt(10)
    v_mfma_f32_16x16x32_bf16 v[160:163], v[96:99], v[80:83], v[160:163]
    ds_read_b128 v[120:123], v27 offset:0
    v_mfma_f32_16x16x32_bf16 v[164:167], v[96:99], v[84:87], v[164:167]
    ds_read_b64_tr_b16 v[136:137], v42 offset:4096
    v_mfma_f32_16x16x32_bf16 v[168:171], v[96:99], v[88:91], v[168:171]
    ds_read_b64_tr_b16 v[138:139], v42 offset:4608
    v_mfma_f32_16x16x32_bf16 v[172:175], v[96:99], v[92:95], v[172:175]
    s_waitcnt lgkmcnt(11)
    v_mfma_f32_16x16x32_bf16 v[188:191], v[100:103], v[92:95], v[188:191]
    ds_read_b128 v[124:127], v27 offset:2048
    v_mfma_f32_16x16x32_bf16 v[184:187], v[100:103], v[88:91], v[184:187]
    ds_read_b128 v[128:131], v27 offset:4096
    v_mfma_f32_16x16x32_bf16 v[180:183], v[100:103], v[84:87], v[180:183]
    ds_read_b128 v[132:135], v27 offset:6144
    v_mfma_f32_16x16x32_bf16 v[176:179], v[100:103], v[80:83], v[176:179]
    s_waitcnt lgkmcnt(12)
    v_mfma_f32_16x16x32_bf16 v[192:195], v[104:107], v[80:83], v[192:195]
    ds_read_b64_tr_b16 v[140:141], v43 offset:4096
    v_mfma_f32_16x16x32_bf16 v[196:199], v[104:107], v[84:87], v[196:199]
    ds_read_b64_tr_b16 v[142:143], v43 offset:4608
    v_mfma_f32_16x16x32_bf16 v[200:203], v[104:107], v[88:91], v[200:203]
    ds_read_b64_tr_b16 v[144:145], v42 offset:12288
    v_mfma_f32_16x16x32_bf16 v[204:207], v[104:107], v[92:95], v[204:207]
    s_waitcnt lgkmcnt(13)
    v_mfma_f32_16x16x32_bf16 v[220:223], v[108:111], v[92:95], v[220:223]
    ds_read_b64_tr_b16 v[146:147], v42 offset:12800
    v_mfma_f32_16x16x32_bf16 v[216:219], v[108:111], v[88:91], v[216:219]
    ds_read_b64_tr_b16 v[148:149], v43 offset:12288
    v_mfma_f32_16x16x32_bf16 v[212:215], v[108:111], v[84:87], v[212:215]
    ds_read_b64_tr_b16 v[150:151], v43 offset:12800
    v_mfma_f32_16x16x32_bf16 v[208:211], v[108:111], v[80:83], v[208:211]
    s_waitcnt lgkmcnt(14)
    v_mfma_f32_16x16x32_bf16 v[224:227], v[80:83], v[112:115], v[224:227]
    ds_read_b64_tr_b16 v[152:153], v42 offset:20480
    v_mfma_f32_16x16x32_bf16 v[228:231], v[84:87], v[112:115], v[228:231]
    ds_read_b64_tr_b16 v[154:155], v42 offset:20992
    v_mfma_f32_16x16x32_bf16 v[232:235], v[88:91], v[112:115], v[232:235]
    ds_read_b64_tr_b16 v[156:157], v43 offset:20480
    v_mfma_f32_16x16x32_bf16 v[236:239], v[92:95], v[112:115], v[236:239]
    s_waitcnt lgkmcnt(15)
    v_mfma_f32_16x16x32_bf16 v[252:255], v[92:95], v[116:119], v[252:255]
    ds_read_b64_tr_b16 v[158:159], v43 offset:20992
    v_mfma_f32_16x16x32_bf16 v[248:251], v[88:91], v[116:119], v[248:251]
    v_mfma_f32_16x16x32_bf16 v[244:247], v[84:87], v[116:119], v[244:247]
    v_mfma_f32_16x16x32_bf16 v[240:243], v[80:83], v[116:119], v[240:243]
    s_waitcnt lgkmcnt(10)
    v_mfma_f32_16x16x32_bf16 v[160:163], v[136:139], v[120:123], v[160:163]
    v_mfma_f32_16x16x32_bf16 v[164:167], v[136:139], v[124:127], v[164:167]
    v_mfma_f32_16x16x32_bf16 v[168:171], v[136:139], v[128:131], v[168:171]
    v_mfma_f32_16x16x32_bf16 v[172:175], v[136:139], v[132:135], v[172:175]
    s_waitcnt lgkmcnt(0)
    s_barrier
    ds_read_b128 v[80:83], v20 offset:0
    v_mfma_f32_16x16x32_bf16 v[188:191], v[140:143], v[132:135], v[188:191]
    ds_read_b64_tr_b16 v[96:97], v36 offset:0
    v_mfma_f32_16x16x32_bf16 v[184:187], v[140:143], v[128:131], v[184:187]
    ds_read_b64_tr_b16 v[98:99], v36 offset:512
    v_mfma_f32_16x16x32_bf16 v[180:183], v[140:143], v[124:127], v[180:183]
    ds_read_b128 v[84:87], v20 offset:2048
    v_mfma_f32_16x16x32_bf16 v[176:179], v[140:143], v[120:123], v[176:179]
    ds_read_b128 v[88:91], v20 offset:4096
    v_mfma_f32_16x16x32_bf16 v[192:195], v[144:147], v[120:123], v[192:195]
    ds_read_b128 v[92:95], v20 offset:6144
    v_mfma_f32_16x16x32_bf16 v[196:199], v[144:147], v[124:127], v[196:199]
    ds_read_b64_tr_b16 v[100:101], v37 offset:0
    v_mfma_f32_16x16x32_bf16 v[200:203], v[144:147], v[128:131], v[200:203]
    ds_read_b64_tr_b16 v[102:103], v37 offset:512
    v_mfma_f32_16x16x32_bf16 v[204:207], v[144:147], v[132:135], v[204:207]
    ds_read_b64_tr_b16 v[104:105], v36 offset:8192
    v_mfma_f32_16x16x32_bf16 v[220:223], v[148:151], v[132:135], v[220:223]
    ds_read_b64_tr_b16 v[106:107], v36 offset:8704
    v_mfma_f32_16x16x32_bf16 v[216:219], v[148:151], v[128:131], v[216:219]
    ds_read_b64_tr_b16 v[108:109], v37 offset:8192
    v_mfma_f32_16x16x32_bf16 v[212:215], v[148:151], v[124:127], v[212:215]
    ds_read_b64_tr_b16 v[110:111], v37 offset:8704
    v_mfma_f32_16x16x32_bf16 v[208:211], v[148:151], v[120:123], v[208:211]
    ds_read_b64_tr_b16 v[112:113], v36 offset:16384
    v_mfma_f32_16x16x32_bf16 v[224:227], v[120:123], v[152:155], v[224:227]
    ds_read_b64_tr_b16 v[114:115], v36 offset:16896
    v_mfma_f32_16x16x32_bf16 v[228:231], v[124:127], v[152:155], v[228:231]
    ds_read_b64_tr_b16 v[116:117], v37 offset:16384
    v_mfma_f32_16x16x32_bf16 v[232:235], v[128:131], v[152:155], v[232:235]
    ds_read_b64_tr_b16 v[118:119], v37 offset:16896
    v_mfma_f32_16x16x32_bf16 v[236:239], v[132:135], v[152:155], v[236:239]
    v_mfma_f32_16x16x32_bf16 v[252:255], v[132:135], v[156:159], v[252:255]
    v_mfma_f32_16x16x32_bf16 v[248:251], v[128:131], v[156:159], v[248:251]
    v_mfma_f32_16x16x32_bf16 v[244:247], v[124:127], v[156:159], v[244:247]
    v_mfma_f32_16x16x32_bf16 v[240:243], v[120:123], v[156:159], v[240:243]
    s_add_u32 s66, s66, 1
    s_branch L_loop
L_mid:
    s_waitcnt vmcnt(0)
    buffer_load_dword v14, v13, s[36:39], 0 offen offset:4 sc1
    s_mov_b64 exec, 15
    s_mov_b64 exec, 1
    s_mov_b64 exec, -1
    v_mfma_f32_16x16x16_bf16 v[68:71], v[60:61], v[52:53], 0
    v_mfma_f32_16x16x16_bf16 v[72:75], v[62:63], v[52:53], 0
    v_mfma_f32_16x16x16_bf16 v[28:31], v[64:65], v[52:53], 0
    v_mfma_f32_16x16x16_bf16 v[32:35], v[66:67], v[52:53], 0
    s_nop 4
    v_cvt_pk_bf16_f32 v44, v68, v69
    v_cvt_pk_bf16_f32 v45, v70, v71
    v_cvt_pk_bf16_f32 v46, v28, v29
    v_cvt_pk_bf16_f32 v47, v30, v31
    v_cvt_pk_bf16_f32 v48, v72, v73
    v_cvt_pk_bf16_f32 v49, v74, v75
    v_cvt_pk_bf16_f32 v50, v32, v33
    v_cvt_pk_bf16_f32 v51, v34, v35
    s_branch L_midret
L_last:
    s_mov_b64 exec, 1
    ds_write_b32 v1, v18 offset:144
    s_mov_b64 exec, -1
    s_waitcnt vmcnt(0)
    v_readfirstlane_b32 s78, v14
    buffer_load_dword v40, v54, s[32:35], 0 offen sc1
    s_mov_b64 exec, 31
    buffer_load_dword v41, v55, s[32:35], 0 offen sc1
    s_mov_b64 exec, -1
    ds_read_b128 v[80:83], v26 offset:0
    ds_read_b64_tr_b16 v[104:105], v42 offset:8192
    ds_read_b64_tr_b16 v[106:107], v42 offset:8704
    ds_read_b128 v[84:87], v26 offset:2048
    ds_read_b128 v[88:91], v26 offset:4096
    ds_read_b128 v[92:95], v26 offset:6144
    ds_read_b64_tr_b16 v[108:109], v43 offset:8192
    ds_read_b64_tr_b16 v[110:111], v43 offset:8704
    ds_read_b128 v[60:63], v27 offset:0
    ds_read_b64_tr_b16 v[96:97], v42 offset:12288
    ds_read_b64_tr_b16 v[98:99], v42 offset:12800
    ds_read_b128 v[64:67], v27 offset:2048
    ds_read_b128 v[68:71], v27 offset:4096
    ds_read_b128 v[72:75], v27 offset:6144
    ds_read_b64_tr_b16 v[100:101], v43 offset:12288
    ds_read_b64_tr_b16 v[102:103], v43 offset:12800
    v_mfma_f32_16x16x32_bf16 v[192:195], v[144:147], v[120:123], v[192:195]
    v_mfma_f32_16x16x32_bf16 v[196:199], v[144:147], v[124:127], v[196:199]
    v_mfma_f32_16x16x32_bf16 v[200:203], v[144:147], v[128:131], v[200:203]
    v_mfma_f32_16x16x32_bf16 v[204:207], v[144:147], v[132:135], v[204:207]
    s_waitcnt lgkmcnt(8)
    ds_read_b64_tr_b16 v[112:113], v42 offset:16384
    ds_read_b64_tr_b16 v[114:115], v42 offset:16896
    ds_read_b64_tr_b16 v[116:117], v43 offset:16384
    ds_read_b64_tr_b16 v[118:119], v43 offset:16896
    v_mfma_f32_16x16x32_bf16 v[220:223], v[148:151], v[132:135], v[220:223]
    ds_read_b64_tr_b16 v[28:29], v42 offset:20480
    ds_read_b64_tr_b16 v[30:31], v42 offset:20992
    v_mfma_f32_16x16x32_bf16 v[216:219], v[148:151], v[128:131], v[216:219]
    ds_read_b64_tr_b16 v[32:33], v43 offset:20480
    ds_read_b64_tr_b16 v[34:35], v43 offset:20992
    v_mfma_f32_16x16x32_bf16 v[212:215], v[148:151], v[124:127], v[212:215]
    s_waitcnt lgkmcnt(8)
    v_mfma_f32_16x16x32_bf16 v[208:211], v[148:151], v[120:123], v[208:211]
    v_mfma_f32_16x16x32_bf16 v[192:195], v[104:107], v[80:83], v[192:195]
    v_mfma_f32_16x16x32_bf16 v[196:199], v[104:107], v[84:87], v[196:199]
    v_mfma_f32_16x16x32_bf16 v[200:203], v[104:107], v[88:91], v[200:203]
    v_mfma_f32_16x16x32_bf16 v[204:207], v[104:107], v[92:95], v[204:207]
    v_mfma_f32_16x16x32_bf16 v[220:223], v[108:111], v[92:95], v[220:223]
    s_waitcnt lgkmcnt(0)
    v_mfma_f32_16x16x32_bf16 v[216:219], v[108:111], v[88:91], v[216:219]
    v_mfma_f32_16x16x32_bf16 v[212:215], v[108:111], v[84:87], v[212:215]
    v_mfma_f32_16x16x32_bf16 v[208:211], v[108:111], v[80:83], v[208:211]
    v_mfma_f32_16x16x32_bf16 v[192:195], v[96:99], v[60:63], v[192:195]
    v_mfma_f32_16x16x32_bf16 v[196:199], v[96:99], v[64:67], v[196:199]
    v_mfma_f32_16x16x32_bf16 v[200:203], v[96:99], v[68:71], v[200:203]
    s_nop 5
    v_cvt_pk_bf16_f32 v192, v192, v193
    v_cvt_pk_bf16_f32 v193, v194, v195
    v_mfma_f32_16x16x32_bf16 v[204:207], v[96:99], v[72:75], v[204:207]
    v_cvt_pk_bf16_f32 v196, v196, v197
    v_cvt_pk_bf16_f32 v197, v198, v199
    v_mfma_f32_16x16x32_bf16 v[220:223], v[100:103], v[72:75], v[220:223]
    v_cvt_pk_bf16_f32 v200, v200, v201
    v_cvt_pk_bf16_f32 v201, v202, v203
    v_mfma_f32_16x16x32_bf16 v[216:219], v[100:103], v[68:71], v[216:219]
    s_nop 1
    v_cvt_pk_bf16_f32 v204, v204, v205
    v_cvt_pk_bf16_f32 v205, v206, v207
    v_mfma_f32_16x16x32_bf16 v[212:215], v[100:103], v[64:67], v[212:215]
    v_cvt_pk_bf16_f32 v206, v220, v221
    v_cvt_pk_bf16_f32 v207, v222, v223
    v_mfma_f32_16x16x32_bf16 v[208:211], v[100:103], v[60:63], v[208:211]
    v_cvt_pk_bf16_f32 v202, v216, v217
    v_cvt_pk_bf16_f32 v203, v218, v219
    v_mfma_f32_16x16x32_bf16 v[188:191], v[140:143], v[132:135], v[188:191]
    s_nop 1
    v_cvt_pk_bf16_f32 v198, v212, v213
    v_cvt_pk_bf16_f32 v199, v214, v215
    v_mfma_f32_16x16x32_bf16 v[184:187], v[140:143], v[128:131], v[184:187]
    v_cvt_pk_bf16_f32 v194, v208, v209
    v_cvt_pk_bf16_f32 v195, v210, v211
    v_mfma_f32_16x16x32_bf16 v[180:183], v[140:143], v[124:127], v[180:183]
    v_mfma_f32_16x16x32_bf16 v[176:179], v[140:143], v[120:123], v[176:179]
    v_mfma_f32_16x16x32_bf16 v[96:99], v[44:47], v[192:195], 0
    v_mfma_f32_16x16x32_bf16 v[104:107], v[44:47], v[196:199], 0
    v_mfma_f32_16x16x32_bf16 v[144:147], v[44:47], v[200:203], 0
    s_nop 5
    v_cvt_pk_bf16_f32 v208, v96, v97
    v_cvt_pk_bf16_f32 v209, v98, v99
    v_mfma_f32_16x16x32_bf16 v[136:139], v[44:47], v[204:207], 0
    v_cvt_pk_bf16_f32 v212, v104, v105
    v_cvt_pk_bf16_f32 v213, v106, v107
    v_mfma_f32_16x16x32_bf16 v[100:103], v[48:51], v[192:195], 0
    v_cvt_pk_bf16_f32 v216, v144, v145
    v_cvt_pk_bf16_f32 v217, v146, v147
    v_mfma_f32_16x16x32_bf16 v[108:111], v[48:51], v[196:199], 0
    s_nop 1
    v_cvt_pk_bf16_f32 v220, v136, v137
    v_cvt_pk_bf16_f32 v221, v138, v139
    v_mfma_f32_16x16x32_bf16 v[148:151], v[48:51], v[200:203], 0
    v_cvt_pk_bf16_f32 v210, v100, v101
    v_cvt_pk_bf16_f32 v211, v102, v103
    v_mfma_f32_16x16x32_bf16 v[140:143], v[48:51], v[204:207], 0
    v_cvt_pk_bf16_f32 v214, v108, v109
    v_cvt_pk_bf16_f32 v215, v110, v111
    v_lshlrev_b32 v96, 16, v208
    v_and_b32 v97, 0xffff0000, v208
    s_nop 0
    v_cvt_pk_bf16_f32 v218, v148, v149
    v_cvt_pk_bf16_f32 v219, v150, v151
    v_lshlrev_b32 v98, 16, v209
    v_lshlrev_b32 v104, 16, v212
    v_cvt_pk_bf16_f32 v222, v140, v141
    v_cvt_pk_bf16_f32 v223, v142, v143
    v_and_b32 v105, 0xffff0000, v212
    v_lshlrev_b32 v106, 16, v213
    v_lshlrev_b32 v144, 16, v216
    v_and_b32 v145, 0xffff0000, v216
    v_lshlrev_b32 v146, 16, v217
    v_lshlrev_b32 v136, 16, v220
    v_and_b32 v137, 0xffff0000, v220
    v_lshlrev_b32 v138, 16, v221
    v_and_b32 v99, 0xffff0000, v209
    v_lshlrev_b32 v100, 16, v210
    v_and_b32 v101, 0xffff0000, v210
    v_lshlrev_b32 v102, 16, v211
    v_and_b32 v103, 0xffff0000, v211
    v_and_b32 v107, 0xffff0000, v213
    v_lshlrev_b32 v108, 16, v214
    v_and_b32 v109, 0xffff0000, v214
    v_lshlrev_b32 v110, 16, v215
    v_and_b32 v111, 0xffff0000, v215
    v_and_b32 v147, 0xffff0000, v217
    v_lshlrev_b32 v148, 16, v218
    v_and_b32 v149, 0xffff0000, v218
    v_lshlrev_b32 v150, 16, v219
    v_and_b32 v151, 0xffff0000, v219
    v_and_b32 v139, 0xffff0000, v221
    v_lshlrev_b32 v140, 16, v222
    v_and_b32 v141, 0xffff0000, v222
    v_lshlrev_b32 v142, 16, v223
    v_and_b32 v143, 0xffff0000, v223
    v_max3_f32 v192, v96, v97, v98
    v_min3_f32 v196, v96, v97, v98
    v_max3_f32 v193, v104, v105, v106
    v_min3_f32 v197, v104, v105, v106
    v_max3_f32 v194, v144, v145, v146
    v_min3_f32 v198, v144, v145, v146
    v_max3_f32 v195, v136, v137, v138
    v_min3_f32 v199, v136, v137, v138
    v_max3_f32 v208, v99, v100, v101
    v_max3_f32 v192, v192, v102, v103
    v_min3_f32 v209, v99, v100, v101
    v_min3_f32 v196, v196, v102, v103
    v_max3_f32 v210, v107, v108, v109
    v_max3_f32 v193, v193, v110, v111
    v_min3_f32 v211, v107, v108, v109
    v_min3_f32 v197, v197, v110, v111
    v_max3_f32 v212, v147, v148, v149
    v_max3_f32 v194, v194, v150, v151
    v_min3_f32 v213, v147, v148, v149
    v_min3_f32 v198, v198, v150, v151
    v_max3_f32 v214, v139, v140, v141
    v_max3_f32 v195, v195, v142, v143
    v_min3_f32 v215, v139, v140, v141
    v_min3_f32 v199, v199, v142, v143
    v_max_f32 v192, v192, v208
    v_min_f32 v196, v196, v209
    v_max_f32 v193, v193, v210
    v_min_f32 v197, v197, v211
    v_max_f32 v194, v194, v212
    v_min_f32 v198, v198, v213
    v_max_f32 v195, v195, v214
    v_min_f32 v199, v199, v215
    v_permlane32_swap_b32 v192, v194
    v_permlane32_swap_b32 v193, v195
    v_permlane32_swap_b32 v196, v198
    v_permlane32_swap_b32 v197, v199
    v_max_f32 v192, v192, v194
    v_max_f32 v193, v193, v195
    v_min_f32 v196, v196, v198
    v_min_f32 v197, v197, v199
    v_permlane16_swap_b32 v192, v193
    v_mfma_f32_16x16x32_bf16 v[224:227], v[120:123], v[152:155], v[224:227]
    v_permlane16_swap_b32 v196, v197
    v_max_f32 v192, v192, v193
    v_min_f32 v196, v196, v197
    v_mfma_f32_16x16x32_bf16 v[232:235], v[128:131], v[152:155], v[232:235]
    v_cndmask_b32 v200, v196, v192, s[72:73]
    v_cndmask_b32 v204, v192, v196, s[72:73]
    v_mfma_f32_16x16x32_bf16 v[248:251], v[128:131], v[156:159], v[248:251]
    v_mul_f32 v200, s70, v200
    v_mul_f32 v204, s68, v204
    v_mfma_f32_16x16x32_bf16 v[240:243], v[120:123], v[156:159], v[240:243]
    v_mov_b32 v201, v200
    v_mov_b32 v205, v204
    v_mfma_f32_16x16x32_bf16 v[228:231], v[124:127], v[152:155], v[228:231]
    v_permlane16_swap_b32 v200, v201
    v_permlane16_swap_b32 v204, v205
    v_mfma_f32_16x16x32_bf16 v[236:239], v[132:135], v[152:155], v[236:239]
    v_mov_b32 v202, v200
    v_mov_b32 v203, v201
    v_mfma_f32_16x16x32_bf16 v[252:255], v[132:135], v[156:159], v[252:255]
    v_permlane32_swap_b32 v200, v202
    v_permlane32_swap_b32 v201, v203
    v_mfma_f32_16x16x32_bf16 v[244:247], v[124:127], v[156:159], v[244:247]
    v_mov_b32 v206, v204
    v_mov_b32 v207, v205
    v_mfma_f32_16x16x32_bf16 v[224:227], v[80:83], v[112:115], v[224:227]
    v_permlane32_swap_b32 v204, v206
    v_permlane32_swap_b32 v205, v207
    v_mfma_f32_16x16x32_bf16 v[232:235], v[88:91], v[112:115], v[232:235]
    v_mfma_f32_16x16x32_bf16 v[248:251], v[88:91], v[116:119], v[248:251]
    v_mfma_f32_16x16x32_bf16 v[240:243], v[80:83], v[116:119], v[240:243]
    v_pk_fma_f32 v[88:89], v[104:105], s[68:69], v[200:201] op_sel:[0,0,1] op_sel_hi:[1,0,1]
    v_pk_fma_f32 v[90:91], v[106:107], s[68:69], v[200:201] op_sel:[0,0,1] op_sel_hi:[1,0,1]
    v_mfma_f32_16x16x32_bf16 v[228:231], v[84:87], v[112:115], v[228:231]
    v_pk_fma_f32 v[80:81], v[96:97], s[68:69], v[200:201] op_sel_hi:[1,0,0]
    v_pk_fma_f32 v[82:83], v[98:99], s[68:69], v[200:201] op_sel_hi:[1,0,0]
    v_mfma_f32_16x16x32_bf16 v[236:239], v[92:95], v[112:115], v[236:239]
    v_exp_f32 v80, v80
    v_mfma_f32_16x16x32_bf16 v[252:255], v[92:95], v[116:119], v[252:255]
    v_exp_f32 v81, v81
    v_mfma_f32_16x16x32_bf16 v[244:247], v[84:87], v[116:119], v[244:247]
    v_pk_fma_f32 v[92:93], v[108:109], s[68:69], v[200:201] op_sel:[0,0,1] op_sel_hi:[1,0,1]
    v_exp_f32 v82, v82
    v_mfma_f32_16x16x32_bf16 v[224:227], v[60:63], v[28:31], v[224:227]
    v_pk_fma_f32 v[84:85], v[100:101], s[68:69], v[200:201] op_sel_hi:[1,0,0]
    v_exp_f32 v83, v83
    v_mfma_f32_16x16x32_bf16 v[232:235], v[68:71], v[28:31], v[232:235]
    v_exp_f32 v88, v88
    v_mfma_f32_16x16x32_bf16 v[248:251], v[68:71], v[32:35], v[248:251]
    v_exp_f32 v89, v89
    v_mfma_f32_16x16x32_bf16 v[240:243], v[60:63], v[32:35], v[240:243]
    v_pk_fma_f32 v[68:69], v[136:137], s[68:69], v[202:203] op_sel:[0,0,1] op_sel_hi:[1,0,1]
    v_pk_fma_f32 v[70:71], v[138:139], s[68:69], v[202:203] op_sel:[0,0,1] op_sel_hi:[1,0,1]
    v_mfma_f32_16x16x32_bf16 v[228:231], v[64:67], v[28:31], v[228:231]
    v_pk_fma_f32 v[60:61], v[144:145], s[68:69], v[202:203] op_sel_hi:[1,0,0]
    v_pk_fma_f32 v[62:63], v[146:147], s[68:69], v[202:203] op_sel_hi:[1,0,0]
    v_mfma_f32_16x16x32_bf16 v[236:239], v[72:75], v[28:31], v[236:239]
    v_exp_f32 v90, v90
    v_mfma_f32_16x16x32_bf16 v[252:255], v[72:75], v[32:35], v[252:255]
    v_exp_f32 v91, v91
    v_mfma_f32_16x16x32_bf16 v[244:247], v[64:67], v[32:35], v[244:247]
    v_pk_fma_f32 v[72:73], v[140:141], s[68:69], v[202:203] op_sel:[0,0,1] op_sel_hi:[1,0,1]
    v_exp_f32 v60, v60
    v_pk_fma_f32 v[64:65], v[148:149], s[68:69], v[202:203] op_sel_hi:[1,0,0]
    v_exp_f32 v61, v61
    v_exp_f32 v62, v62
    v_exp_f32 v63, v63
    v_exp_f32 v68, v68
    v_exp_f32 v69, v69
    v_exp_f32 v70, v70
    v_exp_f32 v71, v71
    v_pk_fma_f32 v[86:87], v[102:103], s[68:69], v[200:201] op_sel_hi:[1,0,0]
    v_pk_fma_f32 v[94:95], v[110:111], s[68:69], v[200:201] op_sel:[0,0,1] op_sel_hi:[1,0,1]
    v_pk_fma_f32 v[66:67], v[150:151], s[68:69], v[202:203] op_sel_hi:[1,0,0]
    v_pk_fma_f32 v[74:75], v[142:143], s[68:69], v[202:203] op_sel:[0,0,1] op_sel_hi:[1,0,1]
    v_exp_f32 v84, v84
    v_exp_f32 v85, v85
    v_exp_f32 v92, v92
    v_exp_f32 v93, v93
    v_exp_f32 v64, v64
    v_exp_f32 v65, v65
    v_exp_f32 v72, v72
    v_exp_f32 v73, v73
    v_pk_add_f32 v[208:209], v[80:81], v[82:83]
    v_pk_add_f32 v[210:211], v[88:89], v[90:91]
    v_pk_add_f32 v[212:213], v[60:61], v[62:63]
    v_pk_add_f32 v[214:215], v[68:69], v[70:71]
    v_exp_f32 v86, v86
    v_exp_f32 v87, v87
    v_exp_f32 v94, v94
    v_exp_f32 v95, v95
    v_exp_f32 v66, v66
    v_exp_f32 v67, v67
    v_exp_f32 v74, v74
    v_exp_f32 v75, v75
    v_pk_add_f32 v[208:209], v[208:209], v[84:85]
    v_pk_add_f32 v[210:211], v[210:211], v[92:93]
    v_pk_add_f32 v[212:213], v[212:213], v[64:65]
    v_pk_add_f32 v[214:215], v[214:215], v[72:73]
    v_pk_add_f32 v[208:209], v[208:209], v[86:87]
    v_pk_add_f32 v[210:211], v[210:211], v[94:95]
    v_pk_add_f32 v[212:213], v[212:213], v[66:67]
    v_pk_add_f32 v[214:215], v[214:215], v[74:75]
    v_add_f32 v192, v208, v209
    v_add_f32 v193, v210, v211
    v_add_f32 v194, v212, v213
    v_add_f32 v195, v214, v215
    v_pk_fma_f32 v[96:97], v[96:97], s[70:71], v[204:205] op_sel_hi:[1,0,0]
    v_permlane32_swap_b32 v192, v194
    v_permlane32_swap_b32 v193, v195
    v_add_f32 v192, v192, v194
    v_add_f32 v193, v193, v195
    v_pk_fma_f32 v[98:99], v[98:99], s[70:71], v[204:205] op_sel_hi:[1,0,0]
    v_pk_fma_f32 v[104:105], v[104:105], s[70:71], v[204:205] op_sel:[0,0,1] op_sel_hi:[1,0,1]
    v_permlane16_swap_b32 v192, v193
    v_pk_fma_f32 v[106:107], v[106:107], s[70:71], v[204:205] op_sel:[0,0,1] op_sel_hi:[1,0,1]
    v_add_f32 v192, v192, v193
    v_pk_fma_f32 v[144:145], v[144:145], s[70:71], v[206:207] op_sel_hi:[1,0,0]
    v_rcp_f32 v192, v192
    v_pk_fma_f32 v[146:147], v[146:147], s[70:71], v[206:207] op_sel_hi:[1,0,0]
    v_mov_b32 v193, v192
    v_pk_fma_f32 v[136:137], v[136:137], s[70:71], v[206:207] op_sel:[0,0,1] op_sel_hi:[1,0,1]
    v_pk_fma_f32 v[138:139], v[138:139], s[70:71], v[206:207] op_sel:[0,0,1] op_sel_hi:[1,0,1]
    v_permlane16_swap_b32 v192, v193
    v_pk_fma_f32 v[100:101], v[100:101], s[70:71], v[204:205] op_sel_hi:[1,0,0]
    v_mov_b32 v194, v192
    v_mov_b32 v195, v193
    v_pk_fma_f32 v[108:109], v[108:109], s[70:71], v[204:205] op_sel:[0,0,1] op_sel_hi:[1,0,1]
    v_permlane32_swap_b32 v192, v194
    v_permlane32_swap_b32 v193, v195
    v_pk_fma_f32 v[148:149], v[148:149], s[70:71], v[206:207] op_sel_hi:[1,0,0]
    v_pk_mul_f32 v[80:81], v[80:81], v[192:193] op_sel_hi:[1,0]
    v_pk_mul_f32 v[88:89], v[88:89], v[192:193] op_sel:[0,1] op_sel_hi:[1,1]
    v_pk_mul_f32 v[60:61], v[60:61], v[194:195] op_sel_hi:[1,0]
    v_pk_mul_f32 v[68:69], v[68:69], v[194:195] op_sel:[0,1] op_sel_hi:[1,1]
    v_pk_mul_f32 v[82:83], v[82:83], v[192:193] op_sel_hi:[1,0]
    v_pk_mul_f32 v[90:91], v[90:91], v[192:193] op_sel:[0,1] op_sel_hi:[1,1]
    v_pk_mul_f32 v[62:63], v[62:63], v[194:195] op_sel_hi:[1,0]
    v_pk_mul_f32 v[70:71], v[70:71], v[194:195] op_sel:[0,1] op_sel_hi:[1,1]
    v_pk_mul_f32 v[84:85], v[84:85], v[192:193] op_sel_hi:[1,0]
    v_pk_mul_f32 v[86:87], v[86:87], v[192:193] op_sel_hi:[1,0]
    v_cvt_pk_bf16_f32 v80, v80, v81
    v_pk_mul_f32 v[92:93], v[92:93], v[192:193] op_sel:[0,1] op_sel_hi:[1,1]
    v_pk_mul_f32 v[94:95], v[94:95], v[192:193] op_sel:[0,1] op_sel_hi:[1,1]
    v_cvt_pk_bf16_f32 v88, v88, v89
    v_pk_mul_f32 v[64:65], v[64:65], v[194:195] op_sel_hi:[1,0]
    v_pk_mul_f32 v[66:67], v[66:67], v[194:195] op_sel_hi:[1,0]
    v_cvt_pk_bf16_f32 v60, v60, v61
    v_pk_mul_f32 v[72:73], v[72:73], v[194:195] op_sel:[0,1] op_sel_hi:[1,1]
    v_pk_mul_f32 v[74:75], v[74:75], v[194:195] op_sel:[0,1] op_sel_hi:[1,1]
    v_cvt_pk_bf16_f32 v68, v68, v69
    v_cvt_pk_bf16_f32 v81, v82, v83
    v_cvt_pk_bf16_f32 v89, v90, v91
    v_cvt_pk_bf16_f32 v61, v62, v63
    v_cvt_pk_bf16_f32 v69, v70, v71
    v_cvt_pk_bf16_f32 v82, v84, v85
    v_cvt_pk_bf16_f32 v83, v86, v87
    v_cvt_pk_bf16_f32 v90, v92, v93
    v_cvt_pk_bf16_f32 v91, v94, v95
    v_cvt_pk_bf16_f32 v62, v64, v65
    v_cvt_pk_bf16_f32 v63, v66, v67
    v_cvt_pk_bf16_f32 v70, v72, v73
    v_cvt_pk_bf16_f32 v71, v74, v75
    v_pk_fma_f32 v[140:141], v[140:141], s[70:71], v[206:207] op_sel:[0,0,1] op_sel_hi:[1,0,1]
    v_exp_f32 v96, v96
    v_exp_f32 v97, v97
    v_exp_f32 v98, v98
    v_exp_f32 v99, v99
    v_exp_f32 v104, v104
    v_exp_f32 v105, v105
    v_exp_f32 v106, v106
    v_exp_f32 v107, v107
    v_exp_f32 v144, v144
    v_exp_f32 v145, v145
    v_exp_f32 v146, v146
    v_exp_f32 v147, v147
    v_exp_f32 v136, v136
    v_exp_f32 v137, v137
    v_exp_f32 v138, v138
    v_exp_f32 v139, v139
    v_pk_fma_f32 v[102:103], v[102:103], s[70:71], v[204:205] op_sel_hi:[1,0,0]
    v_pk_fma_f32 v[110:111], v[110:111], s[70:71], v[204:205] op_sel:[0,0,1] op_sel_hi:[1,0,1]
    v_pk_fma_f32 v[150:151], v[150:151], s[70:71], v[206:207] op_sel_hi:[1,0,0]
    v_pk_fma_f32 v[142:143], v[142:143], s[70:71], v[206:207] op_sel:[0,0,1] op_sel_hi:[1,0,1]
    v_exp_f32 v100, v100
    v_exp_f32 v101, v101
    v_exp_f32 v108, v108
    v_exp_f32 v109, v109
    v_exp_f32 v148, v148
    v_exp_f32 v149, v149
    v_exp_f32 v140, v140
    v_exp_f32 v141, v141
    v_pk_add_f32 v[216:217], v[96:97], v[98:99]
    v_pk_add_f32 v[218:219], v[104:105], v[106:107]
    v_pk_add_f32 v[220:221], v[144:145], v[146:147]
    v_pk_add_f32 v[222:223], v[136:137], v[138:139]
    v_exp_f32 v102, v102
    v_exp_f32 v103, v103
    v_exp_f32 v110, v110
    v_exp_f32 v111, v111
    v_exp_f32 v150, v150
    v_exp_f32 v151, v151
    v_exp_f32 v142, v142
    v_exp_f32 v143, v143
    v_pk_add_f32 v[216:217], v[216:217], v[100:101]
    v_pk_add_f32 v[218:219], v[218:219], v[108:109]
    v_pk_add_f32 v[220:221], v[220:221], v[148:149]
    v_pk_add_f32 v[222:223], v[222:223], v[140:141]
    v_pk_add_f32 v[216:217], v[216:217], v[102:103]
    v_pk_add_f32 v[218:219], v[218:219], v[110:111]
    v_pk_add_f32 v[220:221], v[220:221], v[150:151]
    v_pk_add_f32 v[222:223], v[222:223], v[142:143]
    v_add_f32 v196, v216, v217
    v_add_f32 v197, v218, v219
    v_add_f32 v198, v220, v221
    v_add_f32 v199, v222, v223
    v_mfma_f32_16x16x16_bf16 v[120:123], v[80:81], v[52:53], 0
    v_permlane32_swap_b32 v196, v198
    v_permlane32_swap_b32 v197, v199
    v_add_f32 v196, v196, v198
    v_add_f32 v197, v197, v199
    v_mfma_f32_16x16x16_bf16 v[124:127], v[88:89], v[52:53], 0
    s_nop 0
    v_permlane16_swap_b32 v196, v197
    v_cvt_pk_bf16_f32 v224, v224, v225
    v_mfma_f32_16x16x16_bf16 v[128:131], v[60:61], v[52:53], 0
    v_add_f32 v196, v196, v197
    v_cvt_pk_bf16_f32 v120, v120, v121
    v_mfma_f32_16x16x16_bf16 v[132:135], v[68:69], v[52:53], 0
    v_rcp_f32 v196, v196
    v_mfma_f32_16x16x16_bf16 v[112:115], v[82:83], v[52:53], 0
    v_mov_b32 v197, v196
    v_cvt_pk_bf16_f32 v225, v226, v227
    v_mfma_f32_16x16x16_bf16 v[116:119], v[90:91], v[52:53], 0
    v_cvt_pk_bf16_f32 v121, v122, v123
    v_cvt_pk_bf16_f32 v226, v228, v229
    v_mfma_f32_16x16x16_bf16 v[152:155], v[62:63], v[52:53], 0
    v_cvt_pk_bf16_f32 v227, v230, v231
    v_cvt_pk_bf16_f32 v122, v124, v125
    v_mfma_f32_16x16x16_bf16 v[156:159], v[70:71], v[52:53], 0
    v_cvt_pk_bf16_f32 v123, v126, v127
    v_permlane16_swap_b32 v196, v197
    v_cvt_pk_bf16_f32 v240, v240, v241
    v_cvt_pk_bf16_f32 v232, v232, v233
    v_cvt_pk_bf16_f32 v241, v242, v243
    v_cvt_pk_bf16_f32 v128, v128, v129
    v_mov_b32 v198, v196
    v_mov_b32 v199, v197
    v_cvt_pk_bf16_f32 v233, v234, v235
    v_cvt_pk_bf16_f32 v242, v244, v245
    v_cvt_pk_bf16_f32 v243, v246, v247
    v_cvt_pk_bf16_f32 v129, v130, v131
    v_mfma_f32_16x16x32_bf16 v[228:231], v[120:123], v[224:227], 0
    v_cvt_pk_bf16_f32 v234, v236, v237
    v_cvt_pk_bf16_f32 v235, v238, v239
    v_cvt_pk_bf16_f32 v130, v132, v133
    v_cvt_pk_bf16_f32 v131, v134, v135
    v_cvt_pk_bf16_f32 v112, v112, v113
    v_cvt_pk_bf16_f32 v248, v248, v249
    v_cvt_pk_bf16_f32 v113, v114, v115
    v_permlane32_swap_b32 v196, v198
    v_permlane32_swap_b32 v197, v199
    v_cvt_pk_bf16_f32 v249, v250, v251
    v_cvt_pk_bf16_f32 v114, v116, v117
    v_cvt_pk_bf16_f32 v115, v118, v119
    v_mfma_f32_16x16x32_bf16 v[236:239], v[120:123], v[240:243], 0
    v_cvt_pk_bf16_f32 v250, v252, v253
    v_cvt_pk_bf16_f32 v251, v254, v255
    v_mfma_f32_16x16x32_bf16 v[228:231], v[128:131], v[232:235], v[228:231]
    v_pk_mul_f32 v[96:97], v[96:97], v[196:197] op_sel_hi:[1,0]
    v_cvt_pk_bf16_f32 v152, v152, v153
    v_pk_mul_f32 v[98:99], v[98:99], v[196:197] op_sel_hi:[1,0]
    v_cvt_pk_bf16_f32 v153, v154, v155
    v_mfma_f32_16x16x32_bf16 v[244:247], v[112:115], v[224:227], 0
    v_cvt_pk_bf16_f32 v96, v96, v97
    v_pk_mul_f32 v[104:105], v[104:105], v[196:197] op_sel:[0,1] op_sel_hi:[1,1]
    v_cvt_pk_bf16_f32 v154, v156, v157
    v_cvt_pk_bf16_f32 v155, v158, v159
    v_mfma_f32_16x16x32_bf16 v[236:239], v[128:131], v[248:251], v[236:239]
    v_cvt_pk_bf16_f32 v97, v98, v99
    v_pk_mul_f32 v[106:107], v[106:107], v[196:197] op_sel:[0,1] op_sel_hi:[1,1]
    v_cvt_pk_bf16_f32 v104, v104, v105
    v_pk_mul_f32 v[144:145], v[144:145], v[198:199] op_sel_hi:[1,0]
    v_mfma_f32_16x16x32_bf16 v[252:255], v[112:115], v[240:243], 0
    v_cvt_pk_bf16_f32 v105, v106, v107
    v_pk_mul_f32 v[146:147], v[146:147], v[198:199] op_sel_hi:[1,0]
    v_mfma_f32_16x16x32_bf16 v[244:247], v[152:155], v[232:235], v[244:247]
    v_cvt_pk_bf16_f32 v144, v144, v145
    v_pk_mul_f32 v[136:137], v[136:137], v[198:199] op_sel:[0,1] op_sel_hi:[1,1]
    v_mfma_f32_16x16x16_bf16 v[80:83], v[96:97], v[52:53], 0
    v_cvt_pk_bf16_f32 v145, v146, v147
    v_pk_mul_f32 v[138:139], v[138:139], v[198:199] op_sel:[0,1] op_sel_hi:[1,1]
    v_mfma_f32_16x16x32_bf16 v[76:79], v[120:123], v[56:59], 0
    v_cvt_pk_bf16_f32 v136, v136, v137
    v_cvt_pk_bf16_f32 v137, v138, v139
    v_mfma_f32_16x16x16_bf16 v[84:87], v[104:105], v[52:53], 0
    ds_write_b128 v4, v[228:231] offset:0
    v_mfma_f32_16x16x32_bf16 v[252:255], v[152:155], v[248:251], v[252:255]
    v_pk_mul_f32 v[100:101], v[100:101], v[196:197] op_sel_hi:[1,0]
    v_pk_mul_f32 v[102:103], v[102:103], v[196:197] op_sel_hi:[1,0]
    v_mfma_f32_16x16x16_bf16 v[88:91], v[144:145], v[52:53], 0
    ds_write_b128 v4, v[236:239] offset:1024
    v_mfma_f32_16x16x32_bf16 v[20:23], v[112:115], v[56:59], 0
    v_cvt_pk_bf16_f32 v98, v100, v101
    v_cvt_pk_bf16_f32 v99, v102, v103
    v_mfma_f32_16x16x32_bf16 v[76:79], v[128:131], v[56:59], v[76:79]
    v_pk_mul_f32 v[108:109], v[108:109], v[196:197] op_sel:[0,1] op_sel_hi:[1,1]
    v_pk_mul_f32 v[110:111], v[110:111], v[196:197] op_sel:[0,1] op_sel_hi:[1,1]
    v_mfma_f32_16x16x16_bf16 v[92:95], v[136:137], v[52:53], 0
    v_cvt_pk_bf16_f32 v106, v108, v109
    v_cvt_pk_bf16_f32 v107, v110, v111
    v_mfma_f32_16x16x32_bf16 v[20:23], v[152:155], v[56:59], v[20:23]
    v_pk_mul_f32 v[148:149], v[148:149], v[198:199] op_sel_hi:[1,0]
    v_pk_mul_f32 v[150:151], v[150:151], v[198:199] op_sel_hi:[1,0]
    ds_write_b128 v4, v[244:247] offset:2048
    v_mfma_f32_16x16x16_bf16 v[60:63], v[98:99], v[52:53], 0
    v_cvt_pk_bf16_f32 v80, v80, v81
    v_cvt_pk_bf16_f32 v146, v148, v149
    v_cvt_pk_bf16_f32 v147, v150, v151
    v_pk_mul_f32 v[140:141], v[140:141], v[198:199] op_sel:[0,1] op_sel_hi:[1,1]
    v_pk_mul_f32 v[142:143], v[142:143], v[198:199] op_sel:[0,1] op_sel_hi:[1,1]
    v_cvt_pk_bf16_f32 v81, v82, v83
    v_mfma_f32_16x16x16_bf16 v[64:67], v[106:107], v[52:53], 0
    v_cvt_pk_bf16_f32 v82, v84, v85
    v_cvt_pk_bf16_f32 v83, v86, v87
    ds_write_b128 v4, v[252:255] offset:3072
    v_cvt_pk_bf16_f32 v138, v140, v141
    v_cvt_pk_bf16_f32 v139, v142, v143
    v_mfma_f32_16x16x16_bf16 v[68:71], v[146:147], v[52:53], 0
    v_cvt_pk_bf16_f32 v88, v88, v89
    v_cvt_pk_bf16_f32 v89, v90, v91
    v_mfma_f32_16x16x32_bf16 v[192:195], v[80:83], v[224:227], 0
    ds_write_b128 v4, v[76:79] offset:4096
    v_mfma_f32_16x16x32_bf16 v[196:199], v[80:83], v[240:243], 0
    v_cvt_pk_bf16_f32 v90, v92, v93
    v_cvt_pk_bf16_f32 v91, v94, v95
    v_mfma_f32_16x16x32_bf16 v[208:211], v[80:83], v[56:59], 0
    ds_write_b128 v4, v[20:23] offset:5120
    v_mfma_f32_16x16x16_bf16 v[72:75], v[138:139], v[52:53], 0
    v_cvt_pk_bf16_f32 v60, v60, v61
    v_cvt_pk_bf16_f32 v61, v62, v63
    v_mfma_f32_16x16x32_bf16 v[192:195], v[88:91], v[232:235], v[192:195]
    ds_write_b32 v6, v18
    v_cvt_pk_bf16_f32 v62, v64, v65
    v_mfma_f32_16x16x32_bf16 v[196:199], v[88:91], v[248:251], v[196:199]
    v_cvt_pk_bf16_f32 v63, v66, v67
    v_cvt_pk_bf16_f32 v68, v68, v69
    v_mfma_f32_16x16x32_bf16 v[208:211], v[88:91], v[56:59], v[208:211]
    v_cvt_pk_bf16_f32 v69, v70, v71
    v_cvt_pk_bf16_f32 v70, v72, v73
    ds_read_b32 v19, v7
    ds_read_b128 v[36:39], v13 offset:240
    v_mfma_f32_16x16x32_bf16 v[200:203], v[60:63], v[224:227], 0
    ds_read_b128 v[120:123], v5 offset:0
    v_cvt_pk_bf16_f32 v71, v74, v75
    v_mfma_f32_16x16x32_bf16 v[204:207], v[60:63], v[240:243], 0
    ds_read_b128 v[124:127], v5 offset:1024
    ds_read_b128 v[128:131], v5 offset:2048
    v_mfma_f32_16x16x32_bf16 v[212:215], v[60:63], v[56:59], 0
    ds_read_b128 v[132:135], v5 offset:3072
    ds_read_b128 v[112:115], v5 offset:4096
    v_mfma_f32_16x16x32_bf16 v[200:203], v[68:71], v[232:235], v[200:203]
    ds_read_b128 v[116:119], v5 offset:5120
    v_mfma_f32_16x16x32_bf16 v[204:207], v[68:71], v[248:251], v[204:207]
    v_mfma_f32_16x16x32_bf16 v[212:215], v[68:71], v[56:59], v[212:215]
L_tg25:
    s_cmp_lg_u32 s78, 0
    s_cbranch_scc1 L_tk26
    buffer_load_dword v14, v13, s[36:39], 0 offen offset:4 sc1
    s_waitcnt vmcnt(0)
    v_readfirstlane_b32 s78, v14
    s_add_u32 s79, s79, 1
    s_cmp_lt_u32 s79, 32768
    s_cbranch_scc1 L_tg25
L_tk26:
    s_mul_i32 s80, s78, 0x9e3779b1
    s_lshr_b32 s80, s80, 22
    s_mul_i32 s81, s78, 0x85ebca77
    s_lshr_b32 s81, s81, 22
    s_mul_i32 s82, s78, 0xc2b2ae3d
    s_lshr_b32 s82, s82, 22
    s_mul_i32 s83, s78, 0x27d4eb2f
    s_lshr_b32 s83, s83, 22
L_ex27:
    s_waitcnt lgkmcnt(0)
    v_and_b32 v36, v36, v37
    v_and_b32 v38, v38, v39
    v_and_b32 v36, v36, v38
    v_or_b32 v37, 1, v36
    v_and_b32 v37, v37, v19
    v_readfirstlane_b32 s30, v36
    v_cmp_ne_u32 vcc, v37, v18
    s_cbranch_vccz L_ek28
    ds_read_b32 v19, v7
    ds_read_b128 v[36:39], v13 offset:240
    ds_read_b128 v[120:123], v5 offset:0
    ds_read_b128 v[124:127], v5 offset:1024
    ds_read_b128 v[128:131], v5 offset:2048
    ds_read_b128 v[132:135], v5 offset:3072
    ds_read_b128 v[112:115], v5 offset:4096
    ds_read_b128 v[116:119], v5 offset:5120
    s_add_u32 s79, s79, 1
    s_cmp_lt_u32 s79, 32768
    s_cbranch_scc1 L_ex27
    s_waitcnt lgkmcnt(0)
L_ek28:
    s_cmp_eq_u32 s30, 0x7fc17fc1
    s_cbranch_scc0 L_k2s
    v_pk_add_f32 v[192:193], v[192:193], v[120:121]
    v_pk_add_f32 v[194:195], v[194:195], v[122:123]
    v_bfi_b32 v192, v15, s80, v192
    v_bfi_b32 v193, v15, s81, v193
    v_bfi_b32 v194, v15, s82, v194
    v_bfi_b32 v195, v15, s83, v195
    v_pk_add_f32 v[196:197], v[196:197], v[124:125]
    v_pk_add_f32 v[198:199], v[198:199], v[126:127]
    v_bfi_b32 v196, v15, s80, v196
    v_bfi_b32 v197, v15, s81, v197
    v_bfi_b32 v198, v15, s82, v198
    v_bfi_b32 v199, v15, s83, v199
    v_pk_add_f32 v[200:201], v[200:201], v[128:129]
    v_pk_add_f32 v[202:203], v[202:203], v[130:131]
    buffer_store_dwordx4 v[192:195], v3, s[32:35], s48 offen
    s_add_u32 s48, s48, 16384
    v_bfi_b32 v200, v15, s80, v200
    v_bfi_b32 v201, v15, s81, v201
    v_bfi_b32 v202, v15, s82, v202
    v_bfi_b32 v203, v15, s83, v203
    v_pk_add_f32 v[204:205], v[204:205], v[132:133]
    v_pk_add_f32 v[206:207], v[206:207], v[134:135]
    buffer_store_dwordx4 v[196:199], v3, s[32:35], s48 offen
    s_add_u32 s48, s48, 16384
    v_bfi_b32 v204, v15, s80, v204
    v_bfi_b32 v205, v15, s81, v205
    v_bfi_b32 v206, v15, s82, v206
    v_bfi_b32 v207, v15, s83, v207
    v_pk_add_f32 v[208:209], v[208:209], v[112:113]
    v_pk_add_f32 v[210:211], v[210:211], v[114:115]
    v_pk_add_f32 v[212:213], v[212:213], v[116:117]
    v_pk_add_f32 v[214:215], v[214:215], v[118:119]
    buffer_store_dwordx4 v[200:203], v3, s[32:35], s48 offen
    s_add_u32 s48, s48, 16384
    v_bfi_b32 v208, v15, s80, v208
    v_bfi_b32 v209, v15, s81, v209
    v_bfi_b32 v210, v15, s82, v210
    v_bfi_b32 v211, v15, s83, v211
    v_bfi_b32 v212, v15, s80, v212
    v_bfi_b32 v213, v15, s81, v213
    v_bfi_b32 v214, v15, s82, v214
    v_bfi_b32 v215, v15, s83, v215
    buffer_store_dwordx4 v[204:207], v3, s[32:35], s48 offen
    s_mov_b32 exec_lo, 0x10001
    s_mov_b32 exec_hi, 0x10001
    buffer_store_dwordx4 v[208:211], v8, s[32:35], s49 offen offset:0
    buffer_store_dwordx4 v[212:215], v8, s[32:35], s49 offen offset:1024
    s_mov_b64 exec, -1
L_k2r:
    s_mov_b32 s19, s50
    buffer_load_dwordx4 v[192:195], v9, s[32:35], s19 offen sc1
    s_add_u32 s19, s19, 4096
    buffer_load_dwordx4 v[196:199], v9, s[32:35], s19 offen sc1
    s_add_u32 s19, s19, 4096
    buffer_load_dwordx4 v[200:203], v9, s[32:35], s19 offen sc1
    s_add_u32 s19, s19, 4096
    buffer_load_dwordx4 v[204:207], v9, s[32:35], s19 offen sc1
    buffer_load_dwordx2 v[208:209], v10, s[32:35], s51 offen sc1
    s_mov_b64 exec, 1
    ds_write_b32 v1, v18 offset:176
    s_mov_b64 exec, -1
    ds_read_b128 v[80:83], v26 offset:0
    ds_read_b64_tr_b16 v[96:97], v42 offset:0
    ds_read_b64_tr_b16 v[98:99], v42 offset:512
    ds_read_b128 v[84:87], v26 offset:2048
    ds_read_b128 v[88:91], v26 offset:4096
    ds_read_b128 v[92:95], v26 offset:6144
    ds_read_b64_tr_b16 v[100:101], v43 offset:0
    ds_read_b64_tr_b16 v[102:103], v43 offset:512
    ds_read_b128 v[60:63], v27 offset:0
    ds_read_b64_tr_b16 v[104:105], v42 offset:4096
    ds_read_b64_tr_b16 v[106:107], v42 offset:4608
    ds_read_b128 v[64:67], v27 offset:2048
    ds_read_b128 v[68:71], v27 offset:4096
    ds_read_b128 v[72:75], v27 offset:6144
    ds_read_b64_tr_b16 v[108:109], v43 offset:4096
    ds_read_b64_tr_b16 v[110:111], v43 offset:4608
    s_mov_b64 exec, 1
    s_lshl_b32 s19, s58, 16
    s_add_u32 s19, s19, 8388608
    s_waitcnt lgkmcnt(8)
    s_waitcnt lgkmcnt(0)
    ds_write_b32 v1, v18 offset:160
    s_mov_b64 exec, -1
    v_mfma_f32_16x16x32_bf16 v[160:163], v[96:99], v[80:83], v[160:163]
    v_and_b32 v19, 1, v2
    v_mov_b32 v16, s80
    v_mfma_f32_16x16x32_bf16 v[164:167], v[96:99], v[84:87], v[164:167]
    v_cmp_eq_u32 vcc, 0, v19
    v_mov_b32 v54, s82
    v_mfma_f32_16x16x32_bf16 v[168:171], v[96:99], v[88:91], v[168:171]
    v_and_b32 v19, 15, v2
    v_cndmask_b32 v16, v54, v16, vcc
    v_mfma_f32_16x16x32_bf16 v[172:175], v[96:99], v[92:95], v[172:175]
    v_lshlrev_b32 v26, 11, v19
    v_and_b32 v54, 16, v2
    v_mfma_f32_16x16x32_bf16 v[188:191], v[100:103], v[92:95], v[188:191]
    v_lshl_add_u32 v26, v54, 1, v26
    v_and_b32 v54, 32, v2
    v_mfma_f32_16x16x32_bf16 v[184:187], v[100:103], v[88:91], v[184:187]
    v_lshrrev_b32 v54, 1, v54
    v_lshrrev_b32 v27, 1, v19
    v_mfma_f32_16x16x32_bf16 v[180:183], v[100:103], v[84:87], v[180:183]
    v_lshrrev_b32 v19, 2, v2
    v_add_u32 v26, v26, v54
    v_mfma_f32_16x16x32_bf16 v[176:179], v[100:103], v[80:83], v[176:179]
    v_lshlrev_b32 v20, 7, v19
    v_and_b32 v54, 3, v2
    v_mfma_f32_16x16x32_bf16 v[160:163], v[104:107], v[60:63], v[160:163]
    v_lshl_add_u32 v20, v54, 3, v20
    v_bfe_u32 v19, v2, 3, 2
    v_mfma_f32_16x16x32_bf16 v[164:167], v[104:107], v[64:67], v[164:167]
    v_add_u32 v24, s19, v3
    buffer_load_dwordx4 v[28:31], v26, s[24:27], s54 offen offset:0
    v_mfma_f32_16x16x32_bf16 v[168:171], v[104:107], v[68:71], v[168:171]
    s_nop 1
    v_cvt_pk_bf16_f32 v160, v160, v161
    v_cvt_pk_bf16_f32 v161, v162, v163
    v_mfma_f32_16x16x32_bf16 v[172:175], v[104:107], v[72:75], v[172:175]
    v_cvt_pk_bf16_f32 v164, v164, v165
    v_cvt_pk_bf16_f32 v165, v166, v167
    v_mfma_f32_16x16x32_bf16 v[188:191], v[108:111], v[72:75], v[188:191]
    v_cvt_pk_bf16_f32 v168, v168, v169
    v_cvt_pk_bf16_f32 v169, v170, v171
    v_mfma_f32_16x16x32_bf16 v[184:187], v[108:111], v[68:71], v[184:187]
    s_nop 1
    v_cvt_pk_bf16_f32 v172, v172, v173
    v_cvt_pk_bf16_f32 v173, v174, v175
    v_mfma_f32_16x16x32_bf16 v[180:183], v[108:111], v[64:67], v[180:183]
    v_cvt_pk_bf16_f32 v174, v188, v189
    v_cvt_pk_bf16_f32 v175, v190, v191
    v_mfma_f32_16x16x32_bf16 v[176:179], v[108:111], v[60:63], v[176:179]
    v_cvt_pk_bf16_f32 v170, v184, v185
    v_cvt_pk_bf16_f32 v171, v186, v187
    v_mfma_f32_16x16x32_bf16 v[136:139], v[44:47], v[172:175], 0
    s_nop 1
    v_cvt_pk_bf16_f32 v166, v180, v181
    v_cvt_pk_bf16_f32 v167, v182, v183
    v_mfma_f32_16x16x32_bf16 v[128:131], v[44:47], v[168:171], 0
    v_cvt_pk_bf16_f32 v162, v176, v177
    v_cvt_pk_bf16_f32 v163, v178, v179
    v_mfma_f32_16x16x32_bf16 v[120:123], v[44:47], v[164:167], 0
    v_cvt_pk_bf16_f32 v252, v136, v137
    v_cvt_pk_bf16_f32 v253, v138, v139
    v_mfma_f32_16x16x32_bf16 v[112:115], v[44:47], v[160:163], 0
    s_nop 1
    v_cvt_pk_bf16_f32 v248, v128, v129
    v_cvt_pk_bf16_f32 v249, v130, v131
    v_mfma_f32_16x16x32_bf16 v[116:119], v[48:51], v[160:163], 0
    v_cvt_pk_bf16_f32 v244, v120, v121
    v_cvt_pk_bf16_f32 v245, v122, v123
    v_mfma_f32_16x16x32_bf16 v[124:127], v[48:51], v[164:167], 0
    v_cvt_pk_bf16_f32 v240, v112, v113
    v_cvt_pk_bf16_f32 v241, v114, v115
    v_mfma_f32_16x16x32_bf16 v[132:135], v[48:51], v[168:171], 0
    s_nop 1
    v_cvt_pk_bf16_f32 v242, v116, v117
    v_cvt_pk_bf16_f32 v243, v118, v119
    v_mfma_f32_16x16x32_bf16 v[140:143], v[48:51], v[172:175], 0
    v_cvt_pk_bf16_f32 v246, v124, v125
    v_cvt_pk_bf16_f32 v247, v126, v127
    v_lshlrev_b32 v112, 16, v240
    v_and_b32 v113, 0xffff0000, v240
    v_cvt_pk_bf16_f32 v250, v132, v133
    v_cvt_pk_bf16_f32 v251, v134, v135
    v_lshlrev_b32 v114, 16, v241
    v_lshlrev_b32 v120, 16, v244
    v_cvt_pk_bf16_f32 v254, v140, v141
    v_cvt_pk_bf16_f32 v255, v142, v143
    v_and_b32 v121, 0xffff0000, v244
    v_lshlrev_b32 v122, 16, v245
    v_lshlrev_b32 v128, 16, v248
    v_and_b32 v129, 0xffff0000, v248
    v_lshlrev_b32 v130, 16, v249
    v_lshlrev_b32 v136, 16, v252
    v_and_b32 v137, 0xffff0000, v252
    v_lshlrev_b32 v138, 16, v253
    v_and_b32 v115, 0xffff0000, v241
    v_lshlrev_b32 v116, 16, v242
    v_and_b32 v117, 0xffff0000, v242
    v_lshlrev_b32 v118, 16, v243
    v_and_b32 v119, 0xffff0000, v243
    v_and_b32 v123, 0xffff0000, v245
    v_lshlrev_b32 v124, 16, v246
    v_and_b32 v125, 0xffff0000, v246
    v_lshlrev_b32 v126, 16, v247
    v_and_b32 v127, 0xffff0000, v247
    v_and_b32 v131, 0xffff0000, v249
    v_lshlrev_b32 v132, 16, v250
    v_and_b32 v133, 0xffff0000, v250
    v_lshlrev_b32 v134, 16, v251
    v_and_b32 v135, 0xffff0000, v251
    v_and_b32 v139, 0xffff0000, v253
    v_lshlrev_b32 v140, 16, v254
    v_and_b32 v141, 0xffff0000, v254
    v_lshlrev_b32 v142, 16, v255
    v_and_b32 v143, 0xffff0000, v255
    v_max3_f32 v176, v112, v113, v114
    v_min3_f32 v180, v112, v113, v114
    v_max3_f32 v177, v120, v121, v122
    v_min3_f32 v181, v120, v121, v122
    v_max3_f32 v178, v128, v129, v130
    v_min3_f32 v182, v128, v129, v130
    v_max3_f32 v179, v136, v137, v138
    v_min3_f32 v183, v136, v137, v138
    v_max3_f32 v240, v115, v116, v117
    v_max3_f32 v176, v176, v118, v119
    v_min3_f32 v241, v115, v116, v117
    v_min3_f32 v180, v180, v118, v119
    v_max3_f32 v242, v123, v124, v125
    v_max3_f32 v177, v177, v126, v127
    v_min3_f32 v243, v123, v124, v125
    v_min3_f32 v181, v181, v126, v127
    v_max3_f32 v244, v131, v132, v133
    v_max3_f32 v178, v178, v134, v135
    v_min3_f32 v245, v131, v132, v133
    v_min3_f32 v182, v182, v134, v135
    v_max3_f32 v246, v139, v140, v141
    v_max3_f32 v179, v179, v142, v143
    v_min3_f32 v247, v139, v140, v141
    v_min3_f32 v183, v183, v142, v143
    v_max_f32 v176, v176, v240
    v_min_f32 v180, v180, v241
    v_max_f32 v177, v177, v242
    v_min_f32 v181, v181, v243
    v_max_f32 v178, v178, v244
    v_min_f32 v182, v182, v245
    v_max_f32 v179, v179, v246
    v_min_f32 v183, v183, v247
    v_permlane32_swap_b32 v176, v178
    v_permlane32_swap_b32 v177, v179
    v_permlane32_swap_b32 v180, v182
    v_permlane32_swap_b32 v181, v183
    v_max_f32 v176, v176, v178
    v_max_f32 v177, v177, v179
    v_min_f32 v180, v180, v182
    v_min_f32 v181, v181, v183
    v_permlane16_swap_b32 v176, v177
    s_and_b32 s19, s13, 28
    v_permlane16_swap_b32 v180, v181
    v_max_f32 v176, v176, v177
    v_min_f32 v180, v180, v181
    v_mul_f32 v184, s76, v176
    v_mul_f32 v188, s74, v180
    v_mov_b32 v185, v184
    v_mov_b32 v189, v188
    buffer_load_dwordx4 v[32:35], v26, s[24:27], s54 offen offset:64
    v_permlane16_swap_b32 v184, v185
    v_permlane16_swap_b32 v188, v189
    v_lshl_add_u32 v20, v19, 5, v20
    v_add_u32 v4, s19, v2
    v_lshlrev_b32 v27, 3, v27
    buffer_load_dwordx4 v[36:39], v26, s[24:27], s55 offen offset:0
    v_mov_b32 v186, v184
    v_mov_b32 v187, v185
    v_mov_b32 v190, v188
    v_mov_b32 v191, v189
    v_mov_b32 v17, s81
    v_mov_b32 v55, s83
    buffer_load_dwordx4 v[40:43], v26, s[24:27], s55 offen offset:64
    v_add_u32 v20, 32768, v20
    v_and_b32 v4, 31, v4
    buffer_load_dwordx2 v[76:77], v27, s[32:35], s57 offen offset:0 sc1
    v_cndmask_b32 v17, v55, v17, vcc
    buffer_load_dwordx2 v[78:79], v27, s[32:35], s57 offen offset:64 sc1
    v_xor_b32 v21, 32, v20
    v_xor_b32 v22, 64, v20
    v_xor_b32 v23, 0x60, v20
    v_add_u32 v25, 32768, v24
    v_lshlrev_b32 v4, 2, v4
    v_permlane32_swap_b32 v184, v186
    v_permlane32_swap_b32 v185, v187
    v_permlane32_swap_b32 v188, v190
    v_permlane32_swap_b32 v189, v191
    s_waitcnt vmcnt(6)
L_h129:
    v_xor_b32 v111, s83, v207
    v_xor_b32 v92, v16, v208
    v_xor_b32 v93, v17, v209
    v_xor_b32 v96, s80, v192
    v_or3_b32 v215, v111, v92, v93
    v_permlane32_swap_b32 v92, v93
    v_xor_b32 v97, s81, v193
    v_add_f32 v92, v92, v93
    v_xor_b32 v98, s82, v194
    v_xor_b32 v99, s83, v195
    v_xor_b32 v100, s80, v196
    v_xor_b32 v101, s81, v197
    v_xor_b32 v102, s82, v198
    v_xor_b32 v103, s83, v199
    v_xor_b32 v104, s80, v200
    v_xor_b32 v105, s81, v201
    v_xor_b32 v106, s82, v202
    v_xor_b32 v107, s83, v203
    v_xor_b32 v108, s80, v204
    v_xor_b32 v109, s81, v205
    v_xor_b32 v110, s82, v206
    v_mov_b32 v93, v92
    v_or3_b32 v210, v96, v97, v98
    v_or3_b32 v211, v99, v100, v101
    v_or3_b32 v212, v102, v103, v104
    v_or3_b32 v213, v105, v106, v107
    v_pk_add_f32 v[96:97], v[96:97], v[100:101]
    v_pk_add_f32 v[104:105], v[104:105], v[108:109]
    v_pk_add_f32 v[98:99], v[98:99], v[102:103]
    v_pk_add_f32 v[106:107], v[106:107], v[110:111]
    v_permlane16_swap_b32 v92, v93
    v_pk_add_f32 v[96:97], v[96:97], v[104:105]
    v_pk_add_f32 v[98:99], v[98:99], v[106:107]
    v_add_f32 v92, v92, v93
    v_or3_b32 v214, v108, v109, v110
    v_permlane32_swap_b32 v96, v98
    v_permlane32_swap_b32 v97, v99
    v_add_f32_dpp v92, v92, v92 row_ror:8 row_mask:0xf bank_mask:0xf
    v_pk_add_f32 v[96:97], v[96:97], v[98:99]
    v_or3_b32 v210, v210, v211, v212
    v_mov_b32 v98, v96
    v_mov_b32 v99, v97
    v_add_f32_dpp v92, v92, v92 row_ror:4 row_mask:0xf bank_mask:0xf
    v_or3_b32 v215, v215, v213, v214
    v_mov_b32 v93, v92
    v_or_b32 v215, v215, v210
    v_permlane16_swap_b32 v96, v98
    v_permlane16_swap_b32 v97, v99
    v_and_b32 v215, v215, v15
    v_pk_add_f32 v[96:97], v[96:97], v[98:99]
    v_permlane32_swap_b32 v92, v93
    v_cmp_ne_u32 vcc, 0, v215
    v_cvt_pk_bf16_f32 v96, v96, v97
    v_cvt_pk_bf16_f32 v92, v92, v93
    s_cbranch_vccz L_h1k30
    s_mov_b32 s19, s50
    buffer_load_dwordx4 v[192:195], v9, s[32:35], s19 offen sc1
    s_add_u32 s19, s19, 4096
    buffer_load_dwordx4 v[196:199], v9, s[32:35], s19 offen sc1
    s_add_u32 s19, s19, 4096
    buffer_load_dwordx4 v[200:203], v9, s[32:35], s19 offen sc1
    s_add_u32 s19, s19, 4096
    buffer_load_dwordx4 v[204:207], v9, s[32:35], s19 offen sc1
    buffer_load_dwordx2 v[208:209], v10, s[32:35], s51 offen sc1
    s_cmp_eq_u32 s29, 0
    s_cbranch_scc1 L_q2
L_q2r:
    s_waitcnt vmcnt(0)
    s_add_u32 s79, s79, 1
    s_cmp_lt_u32 s79, 32768
    s_cbranch_scc1 L_h129
L_h1k30:
    s_cmp_eq_u32 s30, 0x7fc17fc1
    s_cbranch_scc0 L_h1s
    s_mov_b32 exec_lo, 0xffff
    s_mov_b32 exec_hi, 0xffff
    buffer_store_dword v96, v11, s[32:35], s64 offen
    s_lshl_b64 exec, 1, s16
    buffer_store_dword v92, v13, s[32:35], s65 offen
    s_mov_b64 exec, -1
L_h1r:
    buffer_load_dwordx4 v[60:63], v3, s[32:35], s59 offen offset:0 sc1
    buffer_load_dwordx4 v[64:67], v3, s[32:35], s59 offen offset:1024 sc1
    buffer_load_dwordx4 v[68:71], v3, s[32:35], s59 offen offset:2048 sc1
    buffer_load_dwordx4 v[72:75], v3, s[32:35], s59 offen offset:3072 sc1
    buffer_load_dwordx4 v[80:83], v12, s[32:35], s28 offen offset:0 sc1
    buffer_load_dwordx4 v[84:87], v12, s[32:35], s28 offen offset:64 sc1
    s_mov_b64 exec, 1
    ds_write_b32 v1, v18 offset:192
    s_mov_b64 exec, -1
    s_cmp_lg_u32 s29, 0
    s_cbranch_scc1 L_q3
    s_mov_b32 s29, 2
L_q2:
    v_pk_fma_f32 v[144:145], v[112:113], s[74:75], v[184:185] op_sel_hi:[1,0,0]
    v_pk_fma_f32 v[146:147], v[114:115], s[74:75], v[184:185] op_sel_hi:[1,0,0]
    v_pk_fma_f32 v[152:153], v[120:121], s[74:75], v[184:185] op_sel:[0,0,1] op_sel_hi:[1,0,1]
    v_pk_fma_f32 v[154:155], v[122:123], s[74:75], v[184:185] op_sel:[0,0,1] op_sel_hi:[1,0,1]
    v_pk_fma_f32 v[224:225], v[128:129], s[74:75], v[186:187] op_sel_hi:[1,0,0]
    v_pk_fma_f32 v[226:227], v[130:131], s[74:75], v[186:187] op_sel_hi:[1,0,0]
    v_pk_fma_f32 v[232:233], v[136:137], s[74:75], v[186:187] op_sel:[0,0,1] op_sel_hi:[1,0,1]
    v_pk_fma_f32 v[234:235], v[138:139], s[74:75], v[186:187] op_sel:[0,0,1] op_sel_hi:[1,0,1]
    v_pk_fma_f32 v[148:149], v[116:117], s[74:75], v[184:185] op_sel_hi:[1,0,0]
    v_pk_fma_f32 v[156:157], v[124:125], s[74:75], v[184:185] op_sel:[0,0,1] op_sel_hi:[1,0,1]
    v_pk_fma_f32 v[228:229], v[132:133], s[74:75], v[186:187] op_sel_hi:[1,0,0]
    v_pk_fma_f32 v[236:237], v[140:141], s[74:75], v[186:187] op_sel:[0,0,1] op_sel_hi:[1,0,1]
    v_exp_f32 v144, v144
    v_exp_f32 v145, v145
    v_exp_f32 v146, v146
    v_exp_f32 v147, v147
    v_exp_f32 v152, v152
    v_exp_f32 v153, v153
    v_exp_f32 v154, v154
    v_exp_f32 v155, v155
    v_exp_f32 v224, v224
    v_exp_f32 v225, v225
    v_exp_f32 v226, v226
    v_exp_f32 v227, v227
    v_exp_f32 v232, v232
    v_exp_f32 v233, v233
    v_exp_f32 v234, v234
    v_exp_f32 v235, v235
    v_pk_fma_f32 v[150:151], v[118:119], s[74:75], v[184:185] op_sel_hi:[1,0,0]
    v_pk_fma_f32 v[158:159], v[126:127], s[74:75], v[184:185] op_sel:[0,0,1] op_sel_hi:[1,0,1]
    v_pk_fma_f32 v[230:231], v[134:135], s[74:75], v[186:187] op_sel_hi:[1,0,0]
    v_pk_fma_f32 v[238:239], v[142:143], s[74:75], v[186:187] op_sel:[0,0,1] op_sel_hi:[1,0,1]
    v_exp_f32 v148, v148
    v_exp_f32 v149, v149
    v_exp_f32 v156, v156
    v_exp_f32 v157, v157
    v_exp_f32 v228, v228
    v_exp_f32 v229, v229
    v_exp_f32 v236, v236
    v_exp_f32 v237, v237
    v_pk_add_f32 v[240:241], v[144:145], v[146:147]
    v_pk_add_f32 v[242:243], v[152:153], v[154:155]
    v_pk_add_f32 v[244:245], v[224:225], v[226:227]
    v_pk_add_f32 v[246:247], v[232:233], v[234:235]
    v_exp_f32 v150, v150
    v_exp_f32 v151, v151
    v_exp_f32 v158, v158
    v_exp_f32 v159, v159
    v_exp_f32 v230, v230
    v_exp_f32 v231, v231
    v_exp_f32 v238, v238
    v_exp_f32 v239, v239
    v_pk_add_f32 v[240:241], v[240:241], v[148:149]
    v_pk_add_f32 v[242:243], v[242:243], v[156:157]
    v_pk_add_f32 v[244:245], v[244:245], v[228:229]
    v_pk_add_f32 v[246:247], v[246:247], v[236:237]
    v_pk_add_f32 v[240:241], v[240:241], v[150:151]
    v_pk_add_f32 v[242:243], v[242:243], v[158:159]
    v_pk_add_f32 v[244:245], v[244:245], v[230:231]
    v_pk_add_f32 v[246:247], v[246:247], v[238:239]
    v_add_f32 v176, v240, v241
    v_add_f32 v177, v242, v243
    v_add_f32 v178, v244, v245
    v_add_f32 v179, v246, v247
    s_nop 0
    v_permlane32_swap_b32 v176, v178
    v_permlane32_swap_b32 v177, v179
    v_add_f32 v176, v176, v178
    v_add_f32 v177, v177, v179
    s_nop 1
    v_permlane16_swap_b32 v176, v177
    v_add_f32 v176, v176, v177
    v_rcp_f32 v176, v176
    s_nop 0
    v_mov_b32 v177, v176
    s_nop 1
    v_permlane16_swap_b32 v176, v177
    v_mov_b32 v178, v176
    v_mov_b32 v179, v177
    s_nop 0
    v_permlane32_swap_b32 v176, v178
    v_permlane32_swap_b32 v177, v179
    v_pk_mul_f32 v[144:145], v[144:145], v[176:177] op_sel_hi:[1,0]
    v_pk_mul_f32 v[152:153], v[152:153], v[176:177] op_sel:[0,1] op_sel_hi:[1,1]
    v_pk_mul_f32 v[224:225], v[224:225], v[178:179] op_sel_hi:[1,0]
    v_pk_mul_f32 v[232:233], v[232:233], v[178:179] op_sel:[0,1] op_sel_hi:[1,1]
    v_pk_mul_f32 v[146:147], v[146:147], v[176:177] op_sel_hi:[1,0]
    v_pk_mul_f32 v[154:155], v[154:155], v[176:177] op_sel:[0,1] op_sel_hi:[1,1]
    v_pk_mul_f32 v[226:227], v[226:227], v[178:179] op_sel_hi:[1,0]
    v_pk_mul_f32 v[234:235], v[234:235], v[178:179] op_sel:[0,1] op_sel_hi:[1,1]
    v_pk_mul_f32 v[148:149], v[148:149], v[176:177] op_sel_hi:[1,0]
    v_pk_mul_f32 v[150:151], v[150:151], v[176:177] op_sel_hi:[1,0]
    v_cvt_pk_bf16_f32 v144, v144, v145
    v_pk_mul_f32 v[156:157], v[156:157], v[176:177] op_sel:[0,1] op_sel_hi:[1,1]
    v_pk_mul_f32 v[158:159], v[158:159], v[176:177] op_sel:[0,1] op_sel_hi:[1,1]
    v_cvt_pk_bf16_f32 v152, v152, v153
    v_pk_mul_f32 v[228:229], v[228:229], v[178:179] op_sel_hi:[1,0]
    v_pk_mul_f32 v[230:231], v[230:231], v[178:179] op_sel_hi:[1,0]
    v_cvt_pk_bf16_f32 v224, v224, v225
    v_pk_mul_f32 v[236:237], v[236:237], v[178:179] op_sel:[0,1] op_sel_hi:[1,1]
    v_pk_mul_f32 v[238:239], v[238:239], v[178:179] op_sel:[0,1] op_sel_hi:[1,1]
    v_cvt_pk_bf16_f32 v232, v232, v233
    v_cvt_pk_bf16_f32 v145, v146, v147
    v_cvt_pk_bf16_f32 v153, v154, v155
    v_cvt_pk_bf16_f32 v225, v226, v227
    v_cvt_pk_bf16_f32 v233, v234, v235
    v_cvt_pk_bf16_f32 v146, v148, v149
    v_cvt_pk_bf16_f32 v147, v150, v151
    v_cvt_pk_bf16_f32 v154, v156, v157
    v_cvt_pk_bf16_f32 v155, v158, v159
    v_cvt_pk_bf16_f32 v226, v228, v229
    v_cvt_pk_bf16_f32 v227, v230, v231
    v_cvt_pk_bf16_f32 v234, v236, v237
    v_cvt_pk_bf16_f32 v235, v238, v239
    s_add_u32 s29, s29, 1
    s_cmp_eq_u32 s29, 1
    s_cbranch_scc1 L_q2r
L_q3:
    v_pk_fma_f32 v[112:113], v[112:113], s[76:77], v[188:189] op_sel_hi:[1,0,0]
    v_pk_fma_f32 v[114:115], v[114:115], s[76:77], v[188:189] op_sel_hi:[1,0,0]
    v_pk_fma_f32 v[120:121], v[120:121], s[76:77], v[188:189] op_sel:[0,0,1] op_sel_hi:[1,0,1]
    v_pk_fma_f32 v[122:123], v[122:123], s[76:77], v[188:189] op_sel:[0,0,1] op_sel_hi:[1,0,1]
    v_pk_fma_f32 v[128:129], v[128:129], s[76:77], v[190:191] op_sel_hi:[1,0,0]
    v_pk_fma_f32 v[130:131], v[130:131], s[76:77], v[190:191] op_sel_hi:[1,0,0]
    v_pk_fma_f32 v[136:137], v[136:137], s[76:77], v[190:191] op_sel:[0,0,1] op_sel_hi:[1,0,1]
    v_pk_fma_f32 v[138:139], v[138:139], s[76:77], v[190:191] op_sel:[0,0,1] op_sel_hi:[1,0,1]
    v_pk_fma_f32 v[116:117], v[116:117], s[76:77], v[188:189] op_sel_hi:[1,0,0]
    v_pk_fma_f32 v[124:125], v[124:125], s[76:77], v[188:189] op_sel:[0,0,1] op_sel_hi:[1,0,1]
    v_pk_fma_f32 v[132:133], v[132:133], s[76:77], v[190:191] op_sel_hi:[1,0,0]
    v_pk_fma_f32 v[140:141], v[140:141], s[76:77], v[190:191] op_sel:[0,0,1] op_sel_hi:[1,0,1]
    v_exp_f32 v112, v112
    v_exp_f32 v113, v113
    v_exp_f32 v114, v114
    v_exp_f32 v115, v115
    v_exp_f32 v120, v120
    v_exp_f32 v121, v121
    v_exp_f32 v122, v122
    v_exp_f32 v123, v123
    v_exp_f32 v128, v128
    v_exp_f32 v129, v129
    v_exp_f32 v130, v130
    v_exp_f32 v131, v131
    v_exp_f32 v136, v136
    v_exp_f32 v137, v137
    v_exp_f32 v138, v138
    v_exp_f32 v139, v139
    v_pk_fma_f32 v[118:119], v[118:119], s[76:77], v[188:189] op_sel_hi:[1,0,0]
    v_pk_fma_f32 v[126:127], v[126:127], s[76:77], v[188:189] op_sel:[0,0,1] op_sel_hi:[1,0,1]
    v_pk_fma_f32 v[134:135], v[134:135], s[76:77], v[190:191] op_sel_hi:[1,0,0]
    v_pk_fma_f32 v[142:143], v[142:143], s[76:77], v[190:191] op_sel:[0,0,1] op_sel_hi:[1,0,1]
    v_exp_f32 v116, v116
    v_exp_f32 v117, v117
    v_exp_f32 v124, v124
    v_exp_f32 v125, v125
    v_exp_f32 v132, v132
    v_exp_f32 v133, v133
    v_exp_f32 v140, v140
    v_exp_f32 v141, v141
    v_pk_add_f32 v[248:249], v[112:113], v[114:115]
    v_pk_add_f32 v[250:251], v[120:121], v[122:123]
    v_pk_add_f32 v[252:253], v[128:129], v[130:131]
    v_pk_add_f32 v[254:255], v[136:137], v[138:139]
    v_exp_f32 v118, v118
    v_exp_f32 v119, v119
    v_exp_f32 v126, v126
    v_exp_f32 v127, v127
    v_exp_f32 v134, v134
    v_exp_f32 v135, v135
    v_exp_f32 v142, v142
    v_exp_f32 v143, v143
    v_pk_add_f32 v[248:249], v[248:249], v[116:117]
    v_pk_add_f32 v[250:251], v[250:251], v[124:125]
    v_pk_add_f32 v[252:253], v[252:253], v[132:133]
    v_pk_add_f32 v[254:255], v[254:255], v[140:141]
    v_pk_add_f32 v[248:249], v[248:249], v[118:119]
    v_pk_add_f32 v[250:251], v[250:251], v[126:127]
    v_pk_add_f32 v[252:253], v[252:253], v[134:135]
    v_pk_add_f32 v[254:255], v[254:255], v[142:143]
    v_add_f32 v180, v248, v249
    v_add_f32 v181, v250, v251
    v_add_f32 v182, v252, v253
    v_add_f32 v183, v254, v255
    s_nop 0
    v_permlane32_swap_b32 v180, v182
    v_permlane32_swap_b32 v181, v183
    v_add_f32 v180, v180, v182
    v_add_f32 v181, v181, v183
    s_nop 1
    v_permlane16_swap_b32 v180, v181
    v_add_f32 v180, v180, v181
    v_rcp_f32 v180, v180
    s_nop 0
    v_mov_b32 v181, v180
    s_nop 1
    v_permlane16_swap_b32 v180, v181
    v_mov_b32 v182, v180
    v_mov_b32 v183, v181
    s_nop 0
    v_permlane32_swap_b32 v180, v182
    v_permlane32_swap_b32 v181, v183
    v_pk_mul_f32 v[112:113], v[112:113], v[180:181] op_sel_hi:[1,0]
    v_pk_mul_f32 v[120:121], v[120:121], v[180:181] op_sel:[0,1] op_sel_hi:[1,1]
    v_pk_mul_f32 v[128:129], v[128:129], v[182:183] op_sel_hi:[1,0]
    v_pk_mul_f32 v[136:137], v[136:137], v[182:183] op_sel:[0,1] op_sel_hi:[1,1]
    v_pk_mul_f32 v[114:115], v[114:115], v[180:181] op_sel_hi:[1,0]
    v_pk_mul_f32 v[122:123], v[122:123], v[180:181] op_sel:[0,1] op_sel_hi:[1,1]
    v_pk_mul_f32 v[130:131], v[130:131], v[182:183] op_sel_hi:[1,0]
    v_pk_mul_f32 v[138:139], v[138:139], v[182:183] op_sel:[0,1] op_sel_hi:[1,1]
    v_pk_mul_f32 v[116:117], v[116:117], v[180:181] op_sel_hi:[1,0]
    v_pk_mul_f32 v[118:119], v[118:119], v[180:181] op_sel_hi:[1,0]
    v_cvt_pk_bf16_f32 v112, v112, v113
    v_pk_mul_f32 v[124:125], v[124:125], v[180:181] op_sel:[0,1] op_sel_hi:[1,1]
    v_pk_mul_f32 v[126:127], v[126:127], v[180:181] op_sel:[0,1] op_sel_hi:[1,1]
    v_cvt_pk_bf16_f32 v120, v120, v121
    v_pk_mul_f32 v[132:133], v[132:133], v[182:183] op_sel_hi:[1,0]
    v_pk_mul_f32 v[134:135], v[134:135], v[182:183] op_sel_hi:[1,0]
    v_cvt_pk_bf16_f32 v128, v128, v129
    v_pk_mul_f32 v[140:141], v[140:141], v[182:183] op_sel:[0,1] op_sel_hi:[1,1]
    v_pk_mul_f32 v[142:143], v[142:143], v[182:183] op_sel:[0,1] op_sel_hi:[1,1]
    v_cvt_pk_bf16_f32 v136, v136, v137
    v_cvt_pk_bf16_f32 v113, v114, v115
    v_cvt_pk_bf16_f32 v121, v122, v123
    v_cvt_pk_bf16_f32 v129, v130, v131
    v_cvt_pk_bf16_f32 v137, v138, v139
    v_cvt_pk_bf16_f32 v114, v116, v117
    v_cvt_pk_bf16_f32 v115, v118, v119
    v_cvt_pk_bf16_f32 v122, v124, v125
    v_cvt_pk_bf16_f32 v123, v126, v127
    v_cvt_pk_bf16_f32 v130, v132, v133
    v_cvt_pk_bf16_f32 v131, v134, v135
    v_cvt_pk_bf16_f32 v138, v140, v141
    v_cvt_pk_bf16_f32 v139, v142, v143
L_h231:
    s_waitcnt vmcnt(0)
    v_max3_u32 v88, v60, v61, v62
    v_max3_u32 v89, v64, v65, v66
    v_max3_u32 v90, v68, v69, v70
    v_max3_u32 v91, v72, v73, v74
    v_max3_u32 v92, v80, v81, v82
    v_max3_u32 v93, v84, v85, v86
    v_max_u32 v88, v88, v63
    v_max_u32 v89, v89, v67
    v_max_u32 v90, v90, v71
    v_max_u32 v91, v91, v75
    v_max_u32 v92, v92, v83
    v_max_u32 v93, v93, v87
    v_max3_u32 v94, v88, v89, v90
    v_max3_u32 v95, v91, v92, v93
    v_max_u32 v94, v94, v95
    v_cmp_eq_u32 vcc, -1, v94
    s_cbranch_vccz L_h2k32
    v_cmp_eq_u32 s[68:69], -1, v88
    v_cmp_eq_u32 s[70:71], -1, v89
    v_cmp_eq_u32 s[72:73], -1, v90
    v_cmp_eq_u32 s[74:75], -1, v91
    v_cmp_eq_u32 s[76:77], -1, v92
    v_cmp_eq_u32 s[0:1], -1, v93
    s_mov_b64 exec, s[68:69]
    buffer_load_dwordx4 v[60:63], v3, s[32:35], s59 offen offset:0 sc1
    s_mov_b64 exec, s[70:71]
    buffer_load_dwordx4 v[64:67], v3, s[32:35], s59 offen offset:1024 sc1
    s_mov_b64 exec, s[72:73]
    buffer_load_dwordx4 v[68:71], v3, s[32:35], s59 offen offset:2048 sc1
    s_mov_b64 exec, s[74:75]
    buffer_load_dwordx4 v[72:75], v3, s[32:35], s59 offen offset:3072 sc1
    s_mov_b64 exec, s[76:77]
    buffer_load_dwordx4 v[80:83], v12, s[32:35], s28 offen offset:0 sc1
    s_mov_b64 exec, s[0:1]
    buffer_load_dwordx4 v[84:87], v12, s[32:35], s28 offen offset:64 sc1
    s_mov_b64 exec, -1
    s_add_u32 s79, s79, 1
    s_cmp_lt_u32 s79, 32768
    s_cbranch_scc1 L_h231
    s_waitcnt vmcnt(0)
L_h2k32:
    v_mfma_f32_16x16x32_bf16 v[160:163], v[80:83], v[144:147], 0
    s_mov_b32 s74, 0x358637bd
    v_mov_b32 v19, s78
    v_mfma_f32_16x16x32_bf16 v[164:167], v[80:83], v[152:155], 0
    v_mfma_f32_16x16x32_bf16 v[160:163], v[84:87], v[112:115], v[160:163]
    v_mfma_f32_16x16x32_bf16 v[164:167], v[84:87], v[120:123], v[164:167]
    v_mfma_f32_16x16x32_bf16 v[168:171], v[80:83], v[224:227], 0
    v_mfma_f32_16x16x32_bf16 v[172:175], v[80:83], v[232:235], 0
    s_nop 5
    v_cvt_pk_bf16_f32 v88, v160, v164
    v_mfma_f32_16x16x32_bf16 v[168:171], v[84:87], v[128:131], v[168:171]
    v_and_b32 v89, 0xffff0000, v88
    v_lshlrev_b32 v88, 16, v88
    v_mfma_f32_16x16x32_bf16 v[172:175], v[84:87], v[136:139], v[172:175]
    v_pk_add_f32 v[88:89], v[88:89], s[74:75] op_sel_hi:[1,0]
    v_mfma_f32_16x16x32_bf16 v[192:195], v[60:63], v[144:147], 0
    v_cvt_pk_bf16_f32 v88, v88, v89
    v_mfma_f32_16x16x32_bf16 v[196:199], v[64:67], v[144:147], 0
    s_nop 3
    v_cvt_pk_bf16_f32 v90, v168, v172
    v_and_b32 v89, 0xffff0000, v88
    v_mfma_f32_16x16x32_bf16 v[200:203], v[60:63], v[152:155], 0
    v_and_b32 v91, 0xffff0000, v90
    v_lshlrev_b32 v90, 16, v90
    v_mfma_f32_16x16x32_bf16 v[192:195], v[68:71], v[112:115], v[192:195]
    v_pk_add_f32 v[90:91], v[90:91], s[74:75] op_sel_hi:[1,0]
    v_lshlrev_b32 v88, 16, v88
    v_mfma_f32_16x16x32_bf16 v[204:207], v[64:67], v[152:155], 0
    v_cvt_pk_bf16_f32 v90, v90, v91
    v_rcp_f32 v88, v88
    v_mfma_f32_16x16x32_bf16 v[208:211], v[60:63], v[224:227], 0
    s_nop 1
    v_cvt_pk_bf16_f32 v96, v192, v193
    v_rcp_f32 v89, v89
    v_mfma_f32_16x16x32_bf16 v[196:199], v[72:75], v[112:115], v[196:199]
    v_cvt_pk_bf16_f32 v97, v194, v195
    v_and_b32 v91, 0xffff0000, v90
    v_mfma_f32_16x16x32_bf16 v[200:203], v[68:71], v[120:123], v[200:203]
    v_lshlrev_b32 v192, 16, v96
    v_and_b32 v193, 0xffff0000, v96
    v_mfma_f32_16x16x32_bf16 v[212:215], v[64:67], v[224:227], 0
    s_nop 1
    v_cvt_pk_bf16_f32 v98, v196, v197
    v_cvt_pk_bf16_f32 v99, v198, v199
    v_mfma_f32_16x16x32_bf16 v[216:219], v[60:63], v[232:235], 0
    v_cvt_pk_bf16_f32 v100, v200, v201
    v_lshlrev_b32 v90, 16, v90
    v_mfma_f32_16x16x32_bf16 v[204:207], v[72:75], v[120:123], v[204:207]
    v_lshlrev_b32 v194, 16, v97
    v_and_b32 v195, 0xffff0000, v97
    v_mfma_f32_16x16x32_bf16 v[208:211], v[68:71], v[128:131], v[208:211]
    v_cvt_pk_bf16_f32 v101, v202, v203
    v_lshlrev_b32 v196, 16, v98
    v_mfma_f32_16x16x32_bf16 v[220:223], v[64:67], v[232:235], 0
    v_and_b32 v197, 0xffff0000, v98
    v_lshlrev_b32 v198, 16, v99
    v_mfma_f32_16x16x32_bf16 v[212:215], v[72:75], v[128:131], v[212:215]
    v_and_b32 v199, 0xffff0000, v99
    v_pk_mul_f32 v[192:193], v[192:193], v[88:89] op_sel_hi:[1,0]
    v_mfma_f32_16x16x32_bf16 v[216:219], v[68:71], v[136:139], v[216:219]
    v_cvt_pk_bf16_f32 v102, v204, v205
    v_cvt_pk_bf16_f32 v103, v206, v207
    v_mfma_f32_16x16x32_bf16 v[220:223], v[72:75], v[136:139], v[220:223]
    v_lshlrev_b32 v200, 16, v100
    v_and_b32 v201, 0xffff0000, v100
    v_cvt_pk_bf16_f32 v104, v208, v209
    v_rcp_f32 v90, v90
    v_rcp_f32 v91, v91
    v_pk_mul_f32 v[194:195], v[194:195], v[88:89] op_sel_hi:[1,0]
    v_lshlrev_b32 v202, 16, v101
    v_and_b32 v203, 0xffff0000, v101
    v_cvt_pk_bf16_f32 v105, v210, v211
    v_pk_mul_f32 v[196:197], v[196:197], v[88:89] op_sel_hi:[1,0]
    v_pk_mul_f32 v[198:199], v[198:199], v[88:89] op_sel_hi:[1,0]
    v_cvt_pk_bf16_f32 v192, v192, v193
    v_lshlrev_b32 v204, 16, v102
    v_and_b32 v205, 0xffff0000, v102
    v_lshlrev_b32 v206, 16, v103
    v_and_b32 v207, 0xffff0000, v103
    v_pk_mul_f32 v[200:201], v[200:201], v[88:89] op_sel:[0,1] op_sel_hi:[1,1]
    v_cvt_pk_bf16_f32 v106, v212, v213
    v_cvt_pk_bf16_f32 v107, v214, v215
    v_lshlrev_b32 v208, 16, v104
    v_and_b32 v209, 0xffff0000, v104
    v_cvt_pk_bf16_f32 v108, v216, v217
    v_cvt_pk_bf16_f32 v193, v194, v195
    v_pk_mul_f32 v[202:203], v[202:203], v[88:89] op_sel:[0,1] op_sel_hi:[1,1]
    v_lshlrev_b32 v210, 16, v105
    v_and_b32 v211, 0xffff0000, v105
    v_cvt_pk_bf16_f32 v109, v218, v219
    v_cvt_pk_bf16_f32 v194, v196, v197
    v_cvt_pk_bf16_f32 v195, v198, v199
    v_pk_mul_f32 v[204:205], v[204:205], v[88:89] op_sel:[0,1] op_sel_hi:[1,1]
    v_pk_mul_f32 v[206:207], v[206:207], v[88:89] op_sel:[0,1] op_sel_hi:[1,1]
    v_cvt_pk_bf16_f32 v200, v200, v201
    v_lshlrev_b32 v212, 16, v106
    v_and_b32 v213, 0xffff0000, v106
    v_lshlrev_b32 v214, 16, v107
    v_and_b32 v215, 0xffff0000, v107
    v_pk_mul_f32 v[208:209], v[208:209], v[90:91] op_sel_hi:[1,0]
    v_cvt_pk_bf16_f32 v110, v220, v221
    v_cvt_pk_bf16_f32 v111, v222, v223
    v_lshlrev_b32 v216, 16, v108
    v_and_b32 v217, 0xffff0000, v108
    v_cvt_pk_bf16_f32 v201, v202, v203
    v_pk_mul_f32 v[210:211], v[210:211], v[90:91] op_sel_hi:[1,0]
    v_lshlrev_b32 v218, 16, v109
    v_and_b32 v219, 0xffff0000, v109
    buffer_store_dwordx4 v[192:195], v3, s[32:35], s52 offen sc1
    v_cvt_pk_bf16_f32 v202, v204, v205
    v_cvt_pk_bf16_f32 v203, v206, v207
    v_pk_mul_f32 v[212:213], v[212:213], v[90:91] op_sel_hi:[1,0]
    v_pk_mul_f32 v[214:215], v[214:215], v[90:91] op_sel_hi:[1,0]
    v_cvt_pk_bf16_f32 v208, v208, v209
    v_lshlrev_b32 v220, 16, v110
    v_and_b32 v221, 0xffff0000, v110
    v_lshlrev_b32 v222, 16, v111
    v_and_b32 v223, 0xffff0000, v111
    v_pk_mul_f32 v[216:217], v[216:217], v[90:91] op_sel:[0,1] op_sel_hi:[1,1]
    s_add_u32 s52, s52, 32768
    v_cvt_pk_bf16_f32 v209, v210, v211
    v_pk_mul_f32 v[218:219], v[218:219], v[90:91] op_sel:[0,1] op_sel_hi:[1,1]
    buffer_store_dwordx4 v[200:203], v3, s[32:35], s52 offen sc1
    v_cvt_pk_bf16_f32 v210, v212, v213
    v_cvt_pk_bf16_f32 v211, v214, v215
    v_pk_mul_f32 v[220:221], v[220:221], v[90:91] op_sel:[0,1] op_sel_hi:[1,1]
    v_pk_mul_f32 v[222:223], v[222:223], v[90:91] op_sel:[0,1] op_sel_hi:[1,1]
    v_cvt_pk_bf16_f32 v216, v216, v217
    s_add_u32 s52, s52, 32768
    v_cvt_pk_bf16_f32 v217, v218, v219
    buffer_store_dwordx4 v[208:211], v3, s[32:35], s52 offen sc1
    v_cvt_pk_bf16_f32 v218, v220, v221
    v_cvt_pk_bf16_f32 v219, v222, v223
    s_add_u32 s52, s52, 32768
    buffer_store_dwordx4 v[216:219], v3, s[32:35], s52 offen sc1
L_gc33:
    v_cmp_ne_u32 vcc, s78, v77
    v_cmp_ne_u32 s[84:85], s78, v79
    s_nop 1
    s_or_b64 vcc, vcc, s[84:85]
    s_cbranch_vccz L_gk34
    buffer_load_dwordx2 v[76:77], v27, s[32:35], s57 offen offset:0 sc1
    buffer_load_dwordx2 v[78:79], v27, s[32:35], s57 offen offset:64 sc1
    s_waitcnt vmcnt(0)
    s_add_u32 s79, s79, 1
    s_cmp_lt_u32 s79, 32768
    s_cbranch_scc1 L_gc33
L_gk34:
    v_and_b32 v54, 1, v2
    s_lshr_b32 s3, s13, 2
    v_lshlrev_b32 v54, 4, v54
    s_lshl_b32 s76, s3, 12
    v_lshrrev_b32 v80, v54, v76
    v_lshrrev_b32 v81, v54, v78
    v_lshlrev_b32 v82, 16, v80
    v_lshlrev_b32 v83, 16, v81
    v_sub_f32 v84, 1.0, v82
    v_sub_f32 v85, 1.0, v83
    v_cvt_pk_bf16_f32 v86, v13, v84
    v_cvt_pk_bf16_f32 v87, v13, v85
    v_lshrrev_b32 v84, 16, v86
    v_lshrrev_b32 v85, 16, v87
    v_dot2_f32_bf16 v128, v28, v84, 0
    v_dot2_f32_bf16 v129, v28, v86, 0
    v_dot2_f32_bf16 v130, v29, v84, 0
    v_dot2_f32_bf16 v131, v29, v86, 0
    v_dot2_f32_bf16 v132, v30, v84, 0
    v_dot2_f32_bf16 v133, v30, v86, 0
    v_dot2_f32_bf16 v134, v31, v84, 0
    v_dot2_f32_bf16 v135, v31, v86, 0
    v_dot2_f32_bf16 v136, v32, v84, 0
    v_dot2_f32_bf16 v137, v32, v86, 0
    v_dot2_f32_bf16 v138, v33, v84, 0
    v_dot2_f32_bf16 v139, v33, v86, 0
    v_dot2_f32_bf16 v140, v34, v84, 0
    v_dot2_f32_bf16 v141, v34, v86, 0
    v_dot2_f32_bf16 v142, v35, v84, 0
    v_dot2_f32_bf16 v143, v35, v86, 0
    v_dot2_f32_bf16 v144, v36, v85, 0
    v_dot2_f32_bf16 v145, v36, v87, 0
    v_dot2_f32_bf16 v146, v37, v85, 0
    v_dot2_f32_bf16 v147, v37, v87, 0
    v_dot2_f32_bf16 v148, v38, v85, 0
    v_dot2_f32_bf16 v149, v38, v87, 0
    v_dot2_f32_bf16 v150, v39, v85, 0
    v_dot2_f32_bf16 v151, v39, v87, 0
    v_dot2_f32_bf16 v152, v40, v85, 0
    v_dot2_f32_bf16 v153, v40, v87, 0
    v_dot2_f32_bf16 v154, v41, v85, 0
    v_dot2_f32_bf16 v155, v41, v87, 0
    v_dot2_f32_bf16 v156, v42, v85, 0
    v_dot2_f32_bf16 v157, v42, v87, 0
    v_dot2_f32_bf16 v158, v43, v85, 0
    v_dot2_f32_bf16 v159, v43, v87, 0
    s_and_b32 s3, s13, 3
    v_cvt_pk_bf16_f32 v28, v128, v129
    v_cvt_pk_bf16_f32 v29, v130, v131
    v_cvt_pk_bf16_f32 v30, v132, v133
    v_cvt_pk_bf16_f32 v31, v134, v135
    v_cvt_pk_bf16_f32 v32, v136, v137
    v_cvt_pk_bf16_f32 v33, v138, v139
    v_cvt_pk_bf16_f32 v34, v140, v141
    v_cvt_pk_bf16_f32 v35, v142, v143
    v_cvt_pk_bf16_f32 v36, v144, v145
    v_cvt_pk_bf16_f32 v37, v146, v147
    v_cvt_pk_bf16_f32 v38, v148, v149
    v_cvt_pk_bf16_f32 v39, v150, v151
    v_cvt_pk_bf16_f32 v40, v152, v153
    v_cvt_pk_bf16_f32 v41, v154, v155
    v_cvt_pk_bf16_f32 v42, v156, v157
    v_cvt_pk_bf16_f32 v43, v158, v159
    v_and_b32 v55, 15, v2
    v_lshlrev_b32 v90, 2, v2
    s_lshl_b32 s3, s3, 13
    s_add_u32 s76, s76, s3
    v_and_b32 v80, 0xffff, v80
    v_and_b32 v81, 0xffff, v81
    v_lshlrev_b32 v128, 16, v28
    v_and_b32 v129, 0xffff0000, v28
    v_lshlrev_b32 v130, 16, v29
    v_and_b32 v131, 0xffff0000, v29
    v_lshlrev_b32 v132, 16, v30
    v_and_b32 v133, 0xffff0000, v30
    v_lshlrev_b32 v134, 16, v31
    v_and_b32 v135, 0xffff0000, v31
    v_lshlrev_b32 v136, 16, v32
    v_and_b32 v137, 0xffff0000, v32
    v_lshlrev_b32 v138, 16, v33
    v_and_b32 v139, 0xffff0000, v33
    v_lshlrev_b32 v140, 16, v34
    v_and_b32 v141, 0xffff0000, v34
    v_lshlrev_b32 v142, 16, v35
    v_and_b32 v143, 0xffff0000, v35
    v_lshlrev_b32 v144, 16, v36
    v_and_b32 v145, 0xffff0000, v36
    v_lshlrev_b32 v146, 16, v37
    v_and_b32 v147, 0xffff0000, v37
    v_lshlrev_b32 v148, 16, v38
    v_and_b32 v149, 0xffff0000, v38
    v_lshlrev_b32 v150, 16, v39
    v_and_b32 v151, 0xffff0000, v39
    v_lshlrev_b32 v152, 16, v40
    v_and_b32 v153, 0xffff0000, v40
    v_lshlrev_b32 v154, 16, v41
    v_and_b32 v155, 0xffff0000, v41
    v_lshlrev_b32 v156, 16, v42
    v_and_b32 v157, 0xffff0000, v42
    v_lshlrev_b32 v158, 16, v43
    v_and_b32 v159, 0xffff0000, v43
    v_mov_b32 v160, 0
    v_mov_b32 v161, 0
    v_mov_b32 v162, 0
    v_mov_b32 v163, 0
    v_mov_b32 v164, 0
    v_mov_b32 v165, 0
    v_mov_b32 v166, 0
    v_mov_b32 v167, 0
    v_mov_b32 v168, 0
    v_mov_b32 v169, 0
    v_mov_b32 v170, 0
    v_mov_b32 v171, 0
    v_mov_b32 v172, 0
    v_mov_b32 v173, 0
    v_mov_b32 v174, 0
    v_mov_b32 v175, 0
    v_mov_b32 v176, 0
    v_mov_b32 v177, 0
    v_mov_b32 v178, 0
    v_mov_b32 v179, 0
    v_mov_b32 v180, 0
    v_mov_b32 v181, 0
    v_mov_b32 v182, 0
    v_mov_b32 v183, 0
    v_mov_b32 v184, 0
    v_mov_b32 v185, 0
    v_mov_b32 v186, 0
    v_mov_b32 v187, 0
    v_mov_b32 v188, 0
    v_mov_b32 v189, 0
    v_mov_b32 v190, 0
    v_mov_b32 v191, 0
    v_lshlrev_b32 v55, 7, v55
    v_and_b32 v90, 12, v90
    v_mov_b32 v91, 1
    s_and_b32 s76, s76, 0x7fff
    s_waitcnt vmcnt(0)
    s_mov_b64 exec, 1
    ds_add_rtn_u32 v88, v13, v91 offset:64
    s_mov_b64 exec, -1
    s_waitcnt lgkmcnt(0)
    v_readfirstlane_b32 s3, v88
    s_nop 1
    s_cmp_lg_u32 s3, 3
    s_cbranch_scc1 L_ow
    s_mov_b64 exec, 1
    buffer_store_dword v19, v13, s[32:35], s53 offen sc1
    s_mov_b64 exec, -1
L_of35:
    buffer_load_dword v54, v55, s[32:35], s56 offen sc1
    ds_read_b32 v88, v90 offset:208
    s_waitcnt vmcnt(0) lgkmcnt(0)
    v_cmp_ne_u32 vcc, s78, v54
    v_cmp_ne_u32 s[74:75], v88, v18
    s_nop 1
    s_or_b64 vcc, vcc, s[74:75]
    s_cbranch_vccz L_ofk36
    s_add_u32 s79, s79, 1
    s_cmp_lt_u32 s79, 32768
    s_cbranch_scc1 L_of35
L_ofk36:
    ds_write_b32 v13, v18 offset:112
L_ow:
    ds_read_b32 v88, v13 offset:112
    ds_read_b32 v89, v13 offset:16
    s_waitcnt lgkmcnt(0)
    v_cmp_ne_u32 vcc, v88, v18
    s_cbranch_vccz L_owk
    s_add_u32 s79, s79, 1
    s_cmp_lt_u32 s79, 262144
    s_cbranch_scc1 L_ow
L_owk:
    buffer_load_dwordx4 v[192:195], v24, s[60:63], s76 offen
    buffer_load_dwordx4 v[196:199], v25, s[60:63], s76 offen
    s_add_u32 s76, s76, 1024
    s_and_b32 s76, s76, 0x7fff
    buffer_load_dwordx4 v[200:203], v24, s[60:63], s76 offen
    buffer_load_dwordx4 v[204:207], v25, s[60:63], s76 offen
    s_add_u32 s76, s76, 1024
    s_and_b32 s76, s76, 0x7fff
    buffer_load_dwordx4 v[208:211], v24, s[60:63], s76 offen
    buffer_load_dwordx4 v[212:215], v25, s[60:63], s76 offen
    s_add_u32 s76, s76, 1024
    s_and_b32 s76, s76, 0x7fff
    buffer_load_dwordx4 v[216:219], v24, s[60:63], s76 offen
    buffer_load_dwordx4 v[220:223], v25, s[60:63], s76 offen
    s_add_u32 s76, s76, 1024
    s_and_b32 s76, s76, 0x7fff
    buffer_load_dwordx4 v[224:227], v24, s[60:63], s76 offen
    buffer_load_dwordx4 v[228:231], v25, s[60:63], s76 offen
    s_add_u32 s76, s76, 1024
    s_and_b32 s76, s76, 0x7fff
    buffer_load_dwordx4 v[232:235], v24, s[60:63], s76 offen
    buffer_load_dwordx4 v[236:239], v25, s[60:63], s76 offen
    s_add_u32 s76, s76, 1024
    s_and_b32 s76, s76, 0x7fff
    buffer_load_dwordx4 v[240:243], v24, s[60:63], s76 offen
    buffer_load_dwordx4 v[244:247], v25, s[60:63], s76 offen
    s_add_u32 s76, s76, 1024
    s_and_b32 s76, s76, 0x7fff
    buffer_load_dwordx4 v[248:251], v24, s[60:63], s76 offen
    buffer_load_dwordx4 v[252:255], v25, s[60:63], s76 offen
    s_add_u32 s76, s76, 1024
    s_and_b32 s76, s76, 0x7fff
    ds_read_b64_tr_b16 v[96:97], v20 offset:0
    ds_read_b64_tr_b16 v[98:99], v20 offset:2048
    ds_read_b64_tr_b16 v[100:101], v21 offset:0
    ds_read_b64_tr_b16 v[102:103], v21 offset:2048
    ds_read_b64_tr_b16 v[104:105], v22 offset:0
    ds_read_b64_tr_b16 v[106:107], v22 offset:2048
    ds_read_b64_tr_b16 v[108:109], v23 offset:0
    ds_read_b64_tr_b16 v[110:111], v23 offset:2048
    v_readfirstlane_b32 s77, v89
    s_mov_b32 s66, 0
    s_mov_b32 s3, 32768
.p2align 6
L_p5:
    s_cmp_eq_u32 s66, 3
    s_cselect_b32 s62, 0, s62
    s_cselect_b32 s3, 0, s3
    s_waitcnt vmcnt(14) lgkmcnt(6)
    v_mfma_f32_16x16x32_bf16 v[160:163], v[96:99], v[192:195], v[160:163]
    ds_read_b64_tr_b16 v[112:113], v20 offset:4096
    v_mfma_f32_16x16x32_bf16 v[176:179], v[96:99], v[196:199], v[176:179]
    ds_read_b64_tr_b16 v[114:115], v20 offset:6144
    s_waitcnt lgkmcnt(6)
    v_mfma_f32_16x16x32_bf16 v[164:167], v[100:103], v[192:195], v[164:167]
    ds_read_b64_tr_b16 v[116:117], v21 offset:4096
    v_mfma_f32_16x16x32_bf16 v[180:183], v[100:103], v[196:199], v[180:183]
    ds_read_b64_tr_b16 v[118:119], v21 offset:6144
    s_waitcnt lgkmcnt(6)
    v_mfma_f32_16x16x32_bf16 v[168:171], v[104:107], v[192:195], v[168:171]
    ds_read_b64_tr_b16 v[120:121], v22 offset:4096
    v_mfma_f32_16x16x32_bf16 v[184:187], v[104:107], v[196:199], v[184:187]
    ds_read_b64_tr_b16 v[122:123], v22 offset:6144
    s_waitcnt lgkmcnt(6)
    v_mfma_f32_16x16x32_bf16 v[172:175], v[108:111], v[192:195], v[172:175]
    ds_read_b64_tr_b16 v[124:125], v23 offset:4096
    v_mfma_f32_16x16x32_bf16 v[188:191], v[108:111], v[196:199], v[188:191]
    ds_read_b64_tr_b16 v[126:127], v23 offset:6144
    buffer_load_dwordx4 v[192:195], v24, s[60:63], s76 offen
    buffer_load_dwordx4 v[196:199], v25, s[60:63], s76 offen
    s_add_u32 s76, s76, 1024
    s_and_b32 s76, s76, 0x7fff
    s_waitcnt vmcnt(14) lgkmcnt(6)
    v_mfma_f32_16x16x32_bf16 v[160:163], v[112:115], v[200:203], v[160:163]
    ds_read_b64_tr_b16 v[96:97], v20 offset:8192
    v_mfma_f32_16x16x32_bf16 v[176:179], v[112:115], v[204:207], v[176:179]
    ds_read_b64_tr_b16 v[98:99], v20 offset:10240
    s_waitcnt lgkmcnt(6)
    v_mfma_f32_16x16x32_bf16 v[164:167], v[116:119], v[200:203], v[164:167]
    ds_read_b64_tr_b16 v[100:101], v21 offset:8192
    v_mfma_f32_16x16x32_bf16 v[180:183], v[116:119], v[204:207], v[180:183]
    ds_read_b64_tr_b16 v[102:103], v21 offset:10240
    s_waitcnt lgkmcnt(6)
    v_mfma_f32_16x16x32_bf16 v[168:171], v[120:123], v[200:203], v[168:171]
    ds_read_b64_tr_b16 v[104:105], v22 offset:8192
    v_mfma_f32_16x16x32_bf16 v[184:187], v[120:123], v[204:207], v[184:187]
    ds_read_b64_tr_b16 v[106:107], v22 offset:10240
    s_waitcnt lgkmcnt(6)
    v_mfma_f32_16x16x32_bf16 v[172:175], v[124:127], v[200:203], v[172:175]
    ds_read_b64_tr_b16 v[108:109], v23 offset:8192
    v_mfma_f32_16x16x32_bf16 v[188:191], v[124:127], v[204:207], v[188:191]
    ds_read_b64_tr_b16 v[110:111], v23 offset:10240
    buffer_load_dwordx4 v[200:203], v24, s[60:63], s76 offen
    buffer_load_dwordx4 v[204:207], v25, s[60:63], s76 offen
    s_add_u32 s76, s76, 1024
    s_and_b32 s76, s76, 0x7fff
    s_waitcnt vmcnt(14) lgkmcnt(6)
    v_mfma_f32_16x16x32_bf16 v[160:163], v[96:99], v[208:211], v[160:163]
    ds_read_b64_tr_b16 v[112:113], v20 offset:12288
    v_mfma_f32_16x16x32_bf16 v[176:179], v[96:99], v[212:215], v[176:179]
    ds_read_b64_tr_b16 v[114:115], v20 offset:14336
    s_waitcnt lgkmcnt(6)
    v_mfma_f32_16x16x32_bf16 v[164:167], v[100:103], v[208:211], v[164:167]
    ds_read_b64_tr_b16 v[116:117], v21 offset:12288
    v_mfma_f32_16x16x32_bf16 v[180:183], v[100:103], v[212:215], v[180:183]
    ds_read_b64_tr_b16 v[118:119], v21 offset:14336
    s_waitcnt lgkmcnt(6)
    v_mfma_f32_16x16x32_bf16 v[168:171], v[104:107], v[208:211], v[168:171]
    ds_read_b64_tr_b16 v[120:121], v22 offset:12288
    v_mfma_f32_16x16x32_bf16 v[184:187], v[104:107], v[212:215], v[184:187]
    ds_read_b64_tr_b16 v[122:123], v22 offset:14336
    s_waitcnt lgkmcnt(6)
    v_mfma_f32_16x16x32_bf16 v[172:175], v[108:111], v[208:211], v[172:175]
    ds_read_b64_tr_b16 v[124:125], v23 offset:12288
    v_mfma_f32_16x16x32_bf16 v[188:191], v[108:111], v[212:215], v[188:191]
    ds_read_b64_tr_b16 v[126:127], v23 offset:14336
    buffer_load_dwordx4 v[208:211], v24, s[60:63], s76 offen
    buffer_load_dwordx4 v[212:215], v25, s[60:63], s76 offen
    s_add_u32 s76, s76, 1024
    s_and_b32 s76, s76, 0x7fff
    s_waitcnt vmcnt(14) lgkmcnt(6)
    v_mfma_f32_16x16x32_bf16 v[160:163], v[112:115], v[216:219], v[160:163]
    ds_read_b64_tr_b16 v[96:97], v20 offset:16384
    v_mfma_f32_16x16x32_bf16 v[176:179], v[112:115], v[220:223], v[176:179]
    ds_read_b64_tr_b16 v[98:99], v20 offset:18432
    s_waitcnt lgkmcnt(6)
    v_mfma_f32_16x16x32_bf16 v[164:167], v[116:119], v[216:219], v[164:167]
    ds_read_b64_tr_b16 v[100:101], v21 offset:16384
    v_mfma_f32_16x16x32_bf16 v[180:183], v[116:119], v[220:223], v[180:183]
    ds_read_b64_tr_b16 v[102:103], v21 offset:18432
    s_waitcnt lgkmcnt(6)
    v_mfma_f32_16x16x32_bf16 v[168:171], v[120:123], v[216:219], v[168:171]
    ds_read_b64_tr_b16 v[104:105], v22 offset:16384
    v_mfma_f32_16x16x32_bf16 v[184:187], v[120:123], v[220:223], v[184:187]
    ds_read_b64_tr_b16 v[106:107], v22 offset:18432
    s_waitcnt lgkmcnt(6)
    v_mfma_f32_16x16x32_bf16 v[172:175], v[124:127], v[216:219], v[172:175]
    ds_read_b64_tr_b16 v[108:109], v23 offset:16384
    v_mfma_f32_16x16x32_bf16 v[188:191], v[124:127], v[220:223], v[188:191]
    ds_read_b64_tr_b16 v[110:111], v23 offset:18432
    buffer_load_dwordx4 v[216:219], v24, s[60:63], s76 offen
    buffer_load_dwordx4 v[220:223], v25, s[60:63], s76 offen
    s_add_u32 s76, s76, 1024
    s_and_b32 s76, s76, 0x7fff
    s_waitcnt vmcnt(14) lgkmcnt(6)
    v_mfma_f32_16x16x32_bf16 v[160:163], v[96:99], v[224:227], v[160:163]
    ds_read_b64_tr_b16 v[112:113], v20 offset:20480
    v_mfma_f32_16x16x32_bf16 v[176:179], v[96:99], v[228:231], v[176:179]
    ds_read_b64_tr_b16 v[114:115], v20 offset:22528
    s_waitcnt lgkmcnt(6)
    v_mfma_f32_16x16x32_bf16 v[164:167], v[100:103], v[224:227], v[164:167]
    ds_read_b64_tr_b16 v[116:117], v21 offset:20480
    v_mfma_f32_16x16x32_bf16 v[180:183], v[100:103], v[228:231], v[180:183]
    ds_read_b64_tr_b16 v[118:119], v21 offset:22528
    s_waitcnt lgkmcnt(6)
    v_mfma_f32_16x16x32_bf16 v[168:171], v[104:107], v[224:227], v[168:171]
    ds_read_b64_tr_b16 v[120:121], v22 offset:20480
    v_mfma_f32_16x16x32_bf16 v[184:187], v[104:107], v[228:231], v[184:187]
    ds_read_b64_tr_b16 v[122:123], v22 offset:22528
    s_waitcnt lgkmcnt(6)
    v_mfma_f32_16x16x32_bf16 v[172:175], v[108:111], v[224:227], v[172:175]
    ds_read_b64_tr_b16 v[124:125], v23 offset:20480
    v_mfma_f32_16x16x32_bf16 v[188:191], v[108:111], v[228:231], v[188:191]
    ds_read_b64_tr_b16 v[126:127], v23 offset:22528
    buffer_load_dwordx4 v[224:227], v24, s[60:63], s76 offen
    buffer_load_dwordx4 v[228:231], v25, s[60:63], s76 offen
    s_add_u32 s76, s76, 1024
    s_and_b32 s76, s76, 0x7fff
    s_waitcnt vmcnt(14) lgkmcnt(6)
    v_mfma_f32_16x16x32_bf16 v[160:163], v[112:115], v[232:235], v[160:163]
    ds_read_b64_tr_b16 v[96:97], v20 offset:24576
    v_mfma_f32_16x16x32_bf16 v[176:179], v[112:115], v[236:239], v[176:179]
    ds_read_b64_tr_b16 v[98:99], v20 offset:26624
    s_waitcnt lgkmcnt(6)
    v_mfma_f32_16x16x32_bf16 v[164:167], v[116:119], v[232:235], v[164:167]
    ds_read_b64_tr_b16 v[100:101], v21 offset:24576
    v_mfma_f32_16x16x32_bf16 v[180:183], v[116:119], v[236:239], v[180:183]
    ds_read_b64_tr_b16 v[102:103], v21 offset:26624
    s_waitcnt lgkmcnt(6)
    v_mfma_f32_16x16x32_bf16 v[168:171], v[120:123], v[232:235], v[168:171]
    ds_read_b64_tr_b16 v[104:105], v22 offset:24576
    v_mfma_f32_16x16x32_bf16 v[184:187], v[120:123], v[236:239], v[184:187]
    ds_read_b64_tr_b16 v[106:107], v22 offset:26624
    s_waitcnt lgkmcnt(6)
    v_mfma_f32_16x16x32_bf16 v[172:175], v[124:127], v[232:235], v[172:175]
    ds_read_b64_tr_b16 v[108:109], v23 offset:24576
    v_mfma_f32_16x16x32_bf16 v[188:191], v[124:127], v[236:239], v[188:191]
    ds_read_b64_tr_b16 v[110:111], v23 offset:26624
    buffer_load_dwordx4 v[232:235], v24, s[60:63], s76 offen
    buffer_load_dwordx4 v[236:239], v25, s[60:63], s76 offen
    s_add_u32 s76, s76, 1024
    s_and_b32 s76, s76, 0x7fff
    s_waitcnt vmcnt(14) lgkmcnt(6)
    v_mfma_f32_16x16x32_bf16 v[160:163], v[96:99], v[240:243], v[160:163]
    ds_read_b64_tr_b16 v[112:113], v20 offset:28672
    v_mfma_f32_16x16x32_bf16 v[176:179], v[96:99], v[244:247], v[176:179]
    ds_read_b64_tr_b16 v[114:115], v20 offset:30720
    s_waitcnt lgkmcnt(6)
    v_mfma_f32_16x16x32_bf16 v[164:167], v[100:103], v[240:243], v[164:167]
    ds_read_b64_tr_b16 v[116:117], v21 offset:28672
    v_mfma_f32_16x16x32_bf16 v[180:183], v[100:103], v[244:247], v[180:183]
    ds_read_b64_tr_b16 v[118:119], v21 offset:30720
    s_waitcnt lgkmcnt(6)
    v_mfma_f32_16x16x32_bf16 v[168:171], v[104:107], v[240:243], v[168:171]
    ds_read_b64_tr_b16 v[120:121], v22 offset:28672
    v_mfma_f32_16x16x32_bf16 v[184:187], v[104:107], v[244:247], v[184:187]
    ds_read_b64_tr_b16 v[122:123], v22 offset:30720
    s_waitcnt lgkmcnt(6)
    v_mfma_f32_16x16x32_bf16 v[172:175], v[108:111], v[240:243], v[172:175]
    ds_read_b64_tr_b16 v[124:125], v23 offset:28672
    v_mfma_f32_16x16x32_bf16 v[188:191], v[108:111], v[244:247], v[188:191]
    ds_read_b64_tr_b16 v[126:127], v23 offset:30720
    buffer_load_dwordx4 v[240:243], v24, s[60:63], s76 offen
    buffer_load_dwordx4 v[244:247], v25, s[60:63], s76 offen
    s_add_u32 s76, s76, 1024
    s_and_b32 s76, s76, 0x7fff
    v_add_u32 v20, s3, v20
    v_add_u32 v21, s3, v21
    v_add_u32 v22, s3, v22
    v_add_u32 v23, s3, v23
    s_waitcnt vmcnt(14) lgkmcnt(6)
    v_mfma_f32_16x16x32_bf16 v[160:163], v[112:115], v[248:251], v[160:163]
    ds_read_b64_tr_b16 v[96:97], v20 offset:0
    v_mfma_f32_16x16x32_bf16 v[176:179], v[112:115], v[252:255], v[176:179]
    ds_read_b64_tr_b16 v[98:99], v20 offset:2048
    s_waitcnt lgkmcnt(6)
    v_mfma_f32_16x16x32_bf16 v[164:167], v[116:119], v[248:251], v[164:167]
    ds_read_b64_tr_b16 v[100:101], v21 offset:0
    v_mfma_f32_16x16x32_bf16 v[180:183], v[116:119], v[252:255], v[180:183]
    ds_read_b64_tr_b16 v[102:103], v21 offset:2048
    s_waitcnt lgkmcnt(6)
    v_mfma_f32_16x16x32_bf16 v[168:171], v[120:123], v[248:251], v[168:171]
    ds_read_b64_tr_b16 v[104:105], v22 offset:0
    v_mfma_f32_16x16x32_bf16 v[184:187], v[120:123], v[252:255], v[184:187]
    ds_read_b64_tr_b16 v[106:107], v22 offset:2048
    s_waitcnt lgkmcnt(6)
    v_mfma_f32_16x16x32_bf16 v[172:175], v[124:127], v[248:251], v[172:175]
    ds_read_b64_tr_b16 v[108:109], v23 offset:0
    v_mfma_f32_16x16x32_bf16 v[188:191], v[124:127], v[252:255], v[188:191]
    ds_read_b64_tr_b16 v[110:111], v23 offset:2048
    buffer_load_dwordx4 v[248:251], v24, s[60:63], s76 offen
    buffer_load_dwordx4 v[252:255], v25, s[60:63], s76 offen
    s_add_u32 s76, s76, 1024
    s_and_b32 s76, s76, 0x7fff
    s_add_u32 s66, s66, 1
    s_cmp_lt_u32 s66, 4
    s_cbranch_scc1 L_p5
    s_waitcnt lgkmcnt(0)
    s_lshr_b32 s77, s77, 4
    s_and_b32 s77, s77, 2047
    s_sub_u32 s77, 2047, s77
    s_lshr_b32 s19, s77, 5
    s_cmp_eq_u32 s19, s58
    s_cbranch_scc1 L_own
L_ownret:
    v_cvt_pk_bf16_f32 v160, v160, v161
    v_cvt_pk_bf16_f32 v161, v162, v163
    v_cvt_pk_bf16_f32 v168, v168, v169
    v_cvt_pk_bf16_f32 v162, v164, v165
    v_cvt_pk_bf16_f32 v163, v166, v167
    v_cvt_pk_bf16_f32 v169, v170, v171
    v_cvt_pk_bf16_f32 v176, v176, v177
    v_cvt_pk_bf16_f32 v170, v172, v173
    v_cvt_pk_bf16_f32 v171, v174, v175
    v_cvt_pk_bf16_f32 v177, v178, v179
    v_cvt_pk_bf16_f32 v184, v184, v185
    v_cvt_pk_bf16_f32 v178, v180, v181
    v_cvt_pk_bf16_f32 v179, v182, v183
    v_cvt_pk_bf16_f32 v185, v186, v187
    v_permlane16_swap_b32 v160, v162
    v_permlane16_swap_b32 v161, v163
    v_cvt_pk_bf16_f32 v186, v188, v189
    v_cvt_pk_bf16_f32 v187, v190, v191
    v_permlane16_swap_b32 v168, v170
    v_permlane16_swap_b32 v169, v171
    v_dot2_f32_bf16 v96, v160, v80, 0
    v_dot2_f32_bf16 v97, v160, v82, 0
    v_dot2_f32_bf16 v98, v161, v80, 0
    v_dot2_f32_bf16 v99, v161, v82, 0
    v_dot2_f32_bf16 v100, v162, v80, 0
    v_dot2_f32_bf16 v101, v162, v82, 0
    v_dot2_f32_bf16 v102, v163, v80, 0
    v_dot2_f32_bf16 v103, v163, v82, 0
    v_permlane16_swap_b32 v176, v178
    v_permlane16_swap_b32 v177, v179
    v_dot2_f32_bf16 v104, v168, v80, 0
    v_dot2_f32_bf16 v105, v168, v82, 0
    v_dot2_f32_bf16 v106, v169, v80, 0
    v_dot2_f32_bf16 v107, v169, v82, 0
    v_dot2_f32_bf16 v108, v170, v80, 0
    v_dot2_f32_bf16 v109, v170, v82, 0
    v_dot2_f32_bf16 v110, v171, v80, 0
    v_dot2_f32_bf16 v111, v171, v82, 0
    v_permlane16_swap_b32 v184, v186
    v_permlane16_swap_b32 v185, v187
    v_dot2_f32_bf16 v112, v176, v81, 0
    v_dot2_f32_bf16 v113, v176, v83, 0
    v_dot2_f32_bf16 v114, v177, v81, 0
    v_dot2_f32_bf16 v115, v177, v83, 0
    v_dot2_f32_bf16 v116, v178, v81, 0
    v_dot2_f32_bf16 v117, v178, v83, 0
    v_dot2_f32_bf16 v118, v179, v81, 0
    v_dot2_f32_bf16 v119, v179, v83, 0
    v_dot2_f32_bf16 v120, v184, v81, 0
    v_dot2_f32_bf16 v121, v184, v83, 0
    v_dot2_f32_bf16 v122, v185, v81, 0
    v_dot2_f32_bf16 v123, v185, v83, 0
    v_dot2_f32_bf16 v124, v186, v81, 0
    v_dot2_f32_bf16 v125, v186, v83, 0
    v_dot2_f32_bf16 v126, v187, v81, 0
    v_dot2_f32_bf16 v127, v187, v83, 0
    v_cvt_pk_bf16_f32 v160, v96, v97
    v_cvt_pk_bf16_f32 v161, v98, v99
    v_cvt_pk_bf16_f32 v162, v100, v101
    v_cvt_pk_bf16_f32 v163, v102, v103
    s_mov_b32 s74, 0x3f80
    s_mov_b32 s75, 0x3f800000
    v_cvt_pk_bf16_f32 v168, v104, v105
    v_cvt_pk_bf16_f32 v169, v106, v107
    v_cvt_pk_bf16_f32 v170, v108, v109
    v_cvt_pk_bf16_f32 v171, v110, v111
    v_dot2_f32_bf16 v96, v160, s74, v128
    v_dot2_f32_bf16 v97, v160, s75, v129
    v_dot2_f32_bf16 v98, v161, s74, v130
    v_dot2_f32_bf16 v99, v161, s75, v131
    v_dot2_f32_bf16 v100, v162, s74, v132
    v_dot2_f32_bf16 v101, v162, s75, v133
    v_dot2_f32_bf16 v102, v163, s74, v134
    v_dot2_f32_bf16 v103, v163, s75, v135
    v_cvt_pk_bf16_f32 v176, v112, v113
    v_cvt_pk_bf16_f32 v177, v114, v115
    v_cvt_pk_bf16_f32 v178, v116, v117
    v_cvt_pk_bf16_f32 v179, v118, v119
    v_dot2_f32_bf16 v104, v168, s74, v136
    v_dot2_f32_bf16 v105, v168, s75, v137
    v_dot2_f32_bf16 v106, v169, s74, v138
    v_dot2_f32_bf16 v107, v169, s75, v139
    v_dot2_f32_bf16 v108, v170, s74, v140
    v_dot2_f32_bf16 v109, v170, s75, v141
    v_dot2_f32_bf16 v110, v171, s74, v142
    v_dot2_f32_bf16 v111, v171, s75, v143
    v_cvt_pk_bf16_f32 v184, v120, v121
    v_cvt_pk_bf16_f32 v185, v122, v123
    v_cvt_pk_bf16_f32 v186, v124, v125
    v_cvt_pk_bf16_f32 v187, v126, v127
    v_dot2_f32_bf16 v112, v176, s74, v144
    v_dot2_f32_bf16 v113, v176, s75, v145
    v_dot2_f32_bf16 v114, v177, s74, v146
    v_dot2_f32_bf16 v115, v177, s75, v147
    v_dot2_f32_bf16 v116, v178, s74, v148
    v_dot2_f32_bf16 v117, v178, s75, v149
    v_dot2_f32_bf16 v118, v179, s74, v150
    v_dot2_f32_bf16 v119, v179, s75, v151
    v_dot2_f32_bf16 v120, v184, s74, v152
    v_dot2_f32_bf16 v121, v184, s75, v153
    v_dot2_f32_bf16 v122, v185, s74, v154
    v_dot2_f32_bf16 v123, v185, s75, v155
    v_dot2_f32_bf16 v124, v186, s74, v156
    v_dot2_f32_bf16 v125, v186, s75, v157
    v_dot2_f32_bf16 v126, v187, s74, v158
    v_dot2_f32_bf16 v127, v187, s75, v159
    v_cvt_pk_bf16_f32 v160, v96, v97
    v_cvt_pk_bf16_f32 v161, v98, v99
    v_cvt_pk_bf16_f32 v162, v100, v101
    v_cvt_pk_bf16_f32 v163, v102, v103
    v_cvt_pk_bf16_f32 v168, v104, v105
    v_cvt_pk_bf16_f32 v169, v106, v107
    v_cvt_pk_bf16_f32 v170, v108, v109
    v_cvt_pk_bf16_f32 v171, v110, v111
    buffer_store_dwordx4 v[160:163], v26, s[44:47], s54 offen offset:0 sc1
    v_cvt_pk_bf16_f32 v176, v112, v113
    v_cvt_pk_bf16_f32 v177, v114, v115
    v_cvt_pk_bf16_f32 v178, v116, v117
    v_cvt_pk_bf16_f32 v179, v118, v119
    buffer_store_dwordx4 v[168:171], v26, s[44:47], s54 offen offset:64 sc1
    v_cvt_pk_bf16_f32 v184, v120, v121
    v_cvt_pk_bf16_f32 v185, v122, v123
    v_cvt_pk_bf16_f32 v186, v124, v125
    v_cvt_pk_bf16_f32 v187, v126, v127
    buffer_store_dwordx4 v[176:179], v26, s[44:47], s55 offen offset:0 sc1
    buffer_store_dwordx4 v[184:187], v26, s[44:47], s55 offen offset:64 sc1
    s_endpgm
L_own:
    v_and_b32 v54, 16, v2
    v_lshlrev_b32 v54, 2, v54
    v_and_b32 v55, 32, v2
    v_add_u32 v54, v54, v55
L_xo37:
    ds_read_b32 v88, v13 offset:224
    ds_read_b128 v[96:99], v54 offset:512
    ds_read_b128 v[100:103], v54 offset:528
    ds_read_b128 v[104:107], v54 offset:640
    ds_read_b128 v[108:111], v54 offset:656
    s_waitcnt lgkmcnt(0)
    v_cmp_ne_u32 vcc, v88, v18
    s_cbranch_vccz L_xk38
    s_add_u32 s79, s79, 1
    s_cmp_lt_u32 s79, 32768
    s_cbranch_scc1 L_xo37
L_xk38:
    s_and_b32 s77, s77, 31
    v_and_b32 v54, 15, v2
    v_cmp_eq_u32 vcc, s77, v54
    s_nop 1
    v_cndmask_b32 v128, v128, v96, vcc
    v_cndmask_b32 v129, v129, v97, vcc
    v_cndmask_b32 v130, v130, v98, vcc
    v_cndmask_b32 v131, v131, v99, vcc
    v_cndmask_b32 v132, v132, v100, vcc
    v_cndmask_b32 v133, v133, v101, vcc
    v_cndmask_b32 v134, v134, v102, vcc
    v_cndmask_b32 v135, v135, v103, vcc
    v_cndmask_b32 v136, v136, v104, vcc
    v_cndmask_b32 v137, v137, v105, vcc
    v_cndmask_b32 v138, v138, v106, vcc
    v_cndmask_b32 v139, v139, v107, vcc
    v_cndmask_b32 v140, v140, v108, vcc
    v_cndmask_b32 v141, v141, v109, vcc
    v_cndmask_b32 v142, v142, v110, vcc
    v_cndmask_b32 v143, v143, v111, vcc
    v_add_u32 v54, 16, v54
    v_cmp_eq_u32 vcc, s77, v54
    s_nop 1
    v_cndmask_b32 v144, v144, v96, vcc
    v_cndmask_b32 v145, v145, v97, vcc
    v_cndmask_b32 v146, v146, v98, vcc
    v_cndmask_b32 v147, v147, v99, vcc
    v_cndmask_b32 v148, v148, v100, vcc
    v_cndmask_b32 v149, v149, v101, vcc
    v_cndmask_b32 v150, v150, v102, vcc
    v_cndmask_b32 v151, v151, v103, vcc
    v_cndmask_b32 v152, v152, v104, vcc
    v_cndmask_b32 v153, v153, v105, vcc
    v_cndmask_b32 v154, v154, v106, vcc
    v_cndmask_b32 v155, v155, v107, vcc
    v_cndmask_b32 v156, v156, v108, vcc
    v_cndmask_b32 v157, v157, v109, vcc
    v_cndmask_b32 v158, v158, v110, vcc
    v_cndmask_b32 v159, v159, v111, vcc
    s_branch L_ownret
L_k2s:
    v_pk_add_f32 v[192:193], v[192:193], v[120:121]
    v_pk_add_f32 v[194:195], v[194:195], v[122:123]
    v_bfi_b32 v192, v15, s80, v192
    v_bfi_b32 v193, v15, s81, v193
    v_bfi_b32 v194, v15, s82, v194
    v_bfi_b32 v195, v15, s83, v195
    v_pk_add_f32 v[196:197], v[196:197], v[124:125]
    v_pk_add_f32 v[198:199], v[198:199], v[126:127]
    v_bfi_b32 v196, v15, s80, v196
    v_bfi_b32 v197, v15, s81, v197
    v_bfi_b32 v198, v15, s82, v198
    v_bfi_b32 v199, v15, s83, v199
    v_pk_add_f32 v[200:201], v[200:201], v[128:129]
    v_pk_add_f32 v[202:203], v[202:203], v[130:131]
    buffer_store_dwordx4 v[192:195], v3, s[32:35], s48 offen sc1
    s_add_u32 s48, s48, 16384
    v_bfi_b32 v200, v15, s80, v200
    v_bfi_b32 v201, v15, s81, v201
    v_bfi_b32 v202, v15, s82, v202
    v_bfi_b32 v203, v15, s83, v203
    v_pk_add_f32 v[204:205], v[204:205], v[132:133]
    v_pk_add_f32 v[206:207], v[206:207], v[134:135]
    buffer_store_dwordx4 v[196:199], v3, s[32:35], s48 offen sc1
    s_add_u32 s48, s48, 16384
    v_bfi_b32 v204, v15, s80, v204
    v_bfi_b32 v205, v15, s81, v205
    v_bfi_b32 v206, v15, s82, v206
    v_bfi_b32 v207, v15, s83, v207
    v_pk_add_f32 v[208:209], v[208:209], v[112:113]
    v_pk_add_f32 v[210:211], v[210:211], v[114:115]
    v_pk_add_f32 v[212:213], v[212:213], v[116:117]
    v_pk_add_f32 v[214:215], v[214:215], v[118:119]
    buffer_store_dwordx4 v[200:203], v3, s[32:35], s48 offen sc1
    s_add_u32 s48, s48, 16384
    v_bfi_b32 v208, v15, s80, v208
    v_bfi_b32 v209, v15, s81, v209
    v_bfi_b32 v210, v15, s82, v210
    v_bfi_b32 v211, v15, s83, v211
    v_bfi_b32 v212, v15, s80, v212
    v_bfi_b32 v213, v15, s81, v213
    v_bfi_b32 v214, v15, s82, v214
    v_bfi_b32 v215, v15, s83, v215
    buffer_store_dwordx4 v[204:207], v3, s[32:35], s48 offen sc1
    s_mov_b32 exec_lo, 0x10001
    s_mov_b32 exec_hi, 0x10001
    buffer_store_dwordx4 v[208:211], v8, s[32:35], s49 offen offset:0 sc1
    buffer_store_dwordx4 v[212:215], v8, s[32:35], s49 offen offset:1024 sc1
    s_mov_b64 exec, -1
    s_branch L_k2r
L_h1s:
    s_mov_b32 exec_lo, 0xffff
    s_mov_b32 exec_hi, 0xffff
    buffer_store_dword v96, v11, s[32:35], s64 offen sc1
    s_lshl_b64 exec, 1, s16
    buffer_store_dword v92, v13, s[32:35], s65 offen sc1
    s_mov_b64 exec, -1
    s_branch L_h1r
L_end:
    s_endpgm
.section .rodata,"a"
.p2align 6
.amdhsa_kernel fk_kernel
  .amdhsa_next_free_vgpr 256
  .amdhsa_next_free_sgpr 102
  .amdhsa_accum_offset 256
  .amdhsa_group_segment_fixed_size 0
  .amdhsa_kernarg_size 104
  .amdhsa_user_sgpr_count 2
  .amdhsa_user_sgpr_kernarg_segment_ptr 1
  .amdhsa_system_sgpr_workgroup_id_x 1
.end_amdhsa_kernel
```

```asm
; @launch kernel=fk_kernel grid=(256,1,1) block=(512,1,1) lds=163840
.amdgcn_target "amdgcn-amd-amdhsa--gfx950"
.text
.globl fk_kernel
.p2align 8
.type fk_kernel,@function
fk_kernel:
    s_load_dwordx4 s[4:7], s[0:1], 0
    s_load_dwordx4 s[8:11], s[0:1], 16
    s_load_dwordx16 s[84:99], s[0:1], 40
    s_getpc_b64 s[66:67]
L_cep:
    v_lshrrev_b32 v1, 6, v0
    s_and_b32 s3, s2, -8
    v_readfirstlane_b32 s16, v1
    s_nop 1
    s_add_u32 s3, s3, s16
    s_lshl_b32 s3, s3, 6
    s_min_u32 s3, s3, L_end-L_cep-4
    s_load_dword s68, s[66:67], s3
    s_cmp_ge_u32 s2, 256
    s_cbranch_scc1 L_end
    v_lshrrev_b32 v1, 6, v0
    v_and_b32 v2, 63, v0
    v_readfirstlane_b32 s16, v1
    v_lshrrev_b32 v4, 3, v2
    v_lshlrev_b32 v5, 11, v4
    v_and_b32 v6, 7, v2
    v_lshrrev_b32 v7, 4, v2
    v_xor_b32 v8, v6, v7
    v_lshl_add_u32 v10, v8, 4, v5
    v_xor_b32 v8, 4, v8
    v_lshl_add_u32 v11, v8, 4, v5
    v_mul_u32_u24 v5, 6144, v4
    v_and_b32 v7, 1, v7
    v_lshlrev_b32 v7, 2, v7
    v_xor_b32 v8, v6, v7
    s_and_b32 s12, s2, 7
    s_lshr_b32 s13, s2, 3
    s_and_b32 s14, s13, 15
    s_lshl_b32 s15, s12, 1
    s_lshr_b32 s19, s13, 4
    s_add_u32 s15, s15, s19
    s_and_b32 s17, s16, 3
    s_and_b32 s19, s16, 1
    s_lshl_b32 s19, s19, 1
    v_xor_b32 v8, s19, v8
    v_lshl_add_u32 v12, v8, 4, v5
    s_lshl_b32 s19, s14, 18
    v_add_u32 v10, s19, v10
    v_add_u32 v11, s19, v11
    s_lshl_b32 s19, s15, 7
    v_add_u32 v12, s19, v12
    s_lshl_b32 s64, s15, 1
    s_add_u32 s64, s64, s14
    s_and_b32 s64, s64, 3
    s_add_u32 s65, s12, 0
    s_and_b32 s65, s65, 3
    s_lshl_b32 s65, s65, 2
    s_and_b32 s72, s64, 3
    s_add_u32 s72, s72, s65
    s_mul_i32 s73, s72, 393216
    s_lshl_b32 s72, s72, 7
    s_lshl_b32 s74, s16, 15
    s_add_u32 s72, s72, s74
    s_mul_i32 s74, s16, 49152
    s_add_u32 s73, s73, s74
    s_lshl_b32 s75, s16, 10
    s_lshl_b32 m0, s16, 11
    s_add_u32 s74, s72, 16384
    s_waitcnt lgkmcnt(0)
    s_mov_b64 s[24:25], s[4:5]
    s_mov_b32 s26, 4194304
    s_mov_b32 s27, 0x00020000
    buffer_load_dwordx4 v10, s[24:27], s72 offen lds
    s_addk_i32 m0, 1024
    s_mov_b64 s[28:29], s[6:7]
    s_mov_b32 s30, 6291456
    s_mov_b32 s31, 0x00020000
    buffer_load_dwordx4 v11, s[24:27], s74 offen lds
    s_add_u32 m0, s75, 16384
    s_nop 0
    buffer_load_dwordx4 v12, s[28:31], s73 offen lds
    s_add_u32 m0, s75, 24576
    s_addk_i32 s73, 2048
    buffer_load_dwordx4 v12, s[28:31], s73 offen lds
    s_add_u32 m0, s75, 32768
    s_addk_i32 s73, 2048
    buffer_load_dwordx4 v12, s[28:31], s73 offen lds
    s_cmp_lt_u32 s16, 4
    s_cbranch_scc1 L_compute
    s_bfe_u32 s19, s14, 0x10002
    s_lshl_b32 s19, s19, 2
    s_add_u32 s19, s19, s17
    s_xor_b32 s3, s19, 4
    s_mul_i32 s66, s19, 49152
    s_mul_i32 s67, s3, 49152
    s_lshl_b32 s68, s19, 10
    s_add_u32 s68, s68, 16384
    s_lshl_b32 s69, s3, 10
    s_add_u32 s69, s69, 16384
    s_lshl_b32 s70, s17, 16
    s_lshl_b32 s71, s17, 12
    s_add_u32 s72, s64, 1
    s_and_b32 s72, s72, 3
    s_add_u32 s73, s65, 0
    s_and_b32 s73, s73, 15
    s_add_u32 s72, s72, s73
    s_mul_i32 s73, s72, 393216
    s_lshl_b32 s72, s72, 7
    s_add_u32 s74, s72, s70
    s_add_u32 s75, s73, s66
    s_add_u32 s76, s73, s67
    s_add_u32 m0, s71, 40960
    s_add_u32 s77, s74, 0
    buffer_load_dwordx4 v10, s[24:27], s77 offen lds
    s_add_u32 m0, s71, 41984
    s_add_u32 s77, s74, 16384
    buffer_load_dwordx4 v11, s[24:27], s77 offen lds
    s_add_u32 m0, s71, 43008
    s_add_u32 s77, s74, 32768
    buffer_load_dwordx4 v10, s[24:27], s77 offen lds
    s_add_u32 m0, s71, 44032
    s_add_u32 s77, s74, 49152
    buffer_load_dwordx4 v11, s[24:27], s77 offen lds
    s_add_u32 m0, s68, 40960
    s_add_u32 s77, s75, 0
    buffer_load_dwordx4 v12, s[28:31], s77 offen lds
    s_add_u32 m0, s68, 49152
    s_add_u32 s77, s75, 2048
    buffer_load_dwordx4 v12, s[28:31], s77 offen lds
    s_add_u32 m0, s68, 57344
    s_add_u32 s77, s75, 4096
    buffer_load_dwordx4 v12, s[28:31], s77 offen lds
    s_add_u32 m0, s69, 40960
    s_add_u32 s77, s76, 0
    buffer_load_dwordx4 v12, s[28:31], s77 offen lds
    s_mov_b64 s[32:33], s[98:99]
    s_mov_b32 s34, 16777216
    s_mov_b32 s35, 0x00020000
    s_mov_b64 s[36:37], s[96:97]
    s_mov_b32 s38, 256
    s_mov_b32 s39, 0x00020000
    s_mov_b64 s[40:41], s[84:85]
    s_mov_b32 s42, 2048
    s_mov_b32 s43, 0x00020000
    s_mov_b64 s[44:45], s[92:93]
    s_mov_b32 s46, 2048
    s_mov_b32 s47, 0x00020000
    s_mov_b64 s[48:49], s[86:87]
    s_mov_b32 s50, 7340032
    s_mov_b32 s51, 0x00020000
    s_mov_b64 s[52:53], s[88:89]
    s_mov_b32 s54, 7340032
    s_mov_b32 s55, 0x00020000
    s_mov_b64 s[56:57], s[90:91]
    s_mov_b32 s58, 7340032
    s_mov_b32 s59, 0x00020000
    s_mov_b64 s[60:61], s[10:11]
    s_mov_b32 s62, 2097152
    s_mov_b32 s63, 0x00020000
    s_mov_b32 s79, 0
    v_mov_b32 v13, 0
    v_lshlrev_b32 v3, 4, v2
    v_lshrrev_b32 v9, 4, v2
    v_and_b32 v8, 15, v2
    v_mul_u32_u24 v15, 7168, v9
    v_lshl_add_u32 v15, v8, 4, v15
    v_lshlrev_b32 v16, 11, v9
    v_lshl_add_u32 v16, v8, 4, v16
    v_lshrrev_b32 v19, 3, v2
    v_and_b32 v20, 7, v2
    v_lshlrev_b32 v17, 11, v19
    v_lshl_add_u32 v17, v20, 4, v17
    v_lshlrev_b32 v21, 1, v9
    v_xor_b32 v21, v20, v21
    v_lshlrev_b32 v18, 7, v19
    v_lshl_add_u32 v18, v21, 4, v18
    s_lshl_b32 s19, s17, 10
    s_add_u32 s19, s19, 32768
    v_add_u32 v18, s19, v18
    v_add_u32 v22, 65536, v18
    v_mov_b32 v23, 0xffff
    v_mov_b32 v24, 0xffff0000
    v_cmp_eq_u32 vcc, 0, v8
    s_nop 1
    v_cndmask_b32 v25, 0, v23, vcc
    v_cmp_eq_u32 vcc, 1, v8
    s_nop 1
    v_cndmask_b32 v4, v25, v24, vcc
    v_cmp_eq_u32 vcc, 2, v8
    s_nop 1
    v_cndmask_b32 v25, 0, v23, vcc
    v_cmp_eq_u32 vcc, 3, v8
    s_nop 1
    v_cndmask_b32 v5, v25, v24, vcc
    v_cmp_eq_u32 vcc, 4, v8
    s_nop 1
    v_cndmask_b32 v25, 0, v23, vcc
    v_cmp_eq_u32 vcc, 5, v8
    s_nop 1
    v_cndmask_b32 v6, v25, v24, vcc
    v_cmp_eq_u32 vcc, 6, v8
    s_nop 1
    v_cndmask_b32 v25, 0, v23, vcc
    v_cmp_eq_u32 vcc, 7, v8
    s_nop 1
    v_cndmask_b32 v7, v25, v24, vcc
    v_mov_b32 v23, 0x3ff
    s_getreg_b32 s23, hwreg(HW_REG_XCC_ID, 0, 4)
    v_and_b32 v36, 3, v2
    v_lshlrev_b32 v36, 2, v36
    v_mov_b32 v37, 0x7fc17fc1
    s_cmp_lt_u32 s2, 224
    s_cselect_b32 s50, s50, 0
    s_cselect_b32 s54, s54, 0
    s_lshl_b32 s0, s12, 7
    s_lshl_b32 s19, s17, 5
    s_add_u32 s0, s0, s19
    s_mul_i32 s1, s0, 7168
    s_lshl_b32 s19, s13, 8
    s_add_u32 s1, s1, s19
    s_waitcnt vmcnt(8)
    s_barrier
    s_add_u32 m0, s69, 49152
    s_add_u32 s77, s76, 2048
    buffer_load_dwordx4 v12, s[28:31], s77 offen lds
    s_add_u32 m0, s69, 57344
    s_add_u32 s77, s76, 4096
    buffer_load_dwordx4 v12, s[28:31], s77 offen lds
    s_add_u32 s72, s64, 2
    s_and_b32 s72, s72, 3
    s_add_u32 s73, s65, 0
    s_and_b32 s73, s73, 15
    s_add_u32 s72, s72, s73
    s_mul_i32 s73, s72, 393216
    s_lshl_b32 s72, s72, 7
    s_add_u32 s74, s72, s70
    s_add_u32 s75, s73, s66
    s_add_u32 s76, s73, s67
    s_add_u32 m0, s71, 81920
    s_add_u32 s77, s74, 0
    buffer_load_dwordx4 v10, s[24:27], s77 offen lds
    s_add_u32 m0, s71, 82944
    s_add_u32 s77, s74, 16384
    buffer_load_dwordx4 v11, s[24:27], s77 offen lds
    s_add_u32 m0, s71, 83968
    s_add_u32 s77, s74, 32768
    buffer_load_dwordx4 v10, s[24:27], s77 offen lds
    s_add_u32 m0, s71, 84992
    s_add_u32 s77, s74, 49152
    buffer_load_dwordx4 v11, s[24:27], s77 offen lds
    s_add_u32 m0, s68, 81920
    s_add_u32 s77, s75, 0
    buffer_load_dwordx4 v12, s[28:31], s77 offen lds
    s_add_u32 m0, s68, 90112
    s_add_u32 s77, s75, 2048
    buffer_load_dwordx4 v12, s[28:31], s77 offen lds
    s_add_u32 m0, s68, 98304
    s_add_u32 s77, s75, 4096
    buffer_load_dwordx4 v12, s[28:31], s77 offen lds
    s_add_u32 m0, s69, 81920
    s_add_u32 s77, s76, 0
    buffer_load_dwordx4 v12, s[28:31], s77 offen lds
    s_add_u32 m0, s69, 90112
    s_add_u32 s77, s76, 2048
    buffer_load_dwordx4 v12, s[28:31], s77 offen lds
    s_lshl_b32 s18, s14, 7
    s_lshl_b32 s19, s15, 3
    s_add_u32 s18, s18, s19
    s_lshl_b32 s19, s17, 1
    s_add_u32 s18, s18, s19
    s_lshl_b32 s19, s18, 11
    buffer_load_dwordx4 v[40:43], v3, s[24:27], s19 offen offset:0
    buffer_load_dwordx4 v[44:47], v3, s[24:27], s19 offen offset:1024
    buffer_load_dwordx4 v[48:51], v3, s[24:27], s19 offen offset:2048
    buffer_load_dwordx4 v[52:55], v3, s[24:27], s19 offen offset:3072
    buffer_load_dwordx4 v[56:59], v3, s[40:43], 0 offen offset:0
    buffer_load_dwordx4 v[60:63], v3, s[40:43], 0 offen offset:1024
    buffer_load_dwordx4 v[64:67], v3, s[44:47], 0 offen offset:0
    buffer_load_dwordx4 v[68:71], v3, s[44:47], 0 offen offset:1024
    s_waitcnt vmcnt(17)
    s_barrier
    s_add_u32 m0, s69, 98304
    s_add_u32 s77, s76, 4096
    buffer_load_dwordx4 v12, s[28:31], s77 offen lds
    s_add_u32 s72, s64, 3
    s_and_b32 s72, s72, 3
    s_add_u32 s73, s65, 0
    s_and_b32 s73, s73, 15
    s_add_u32 s72, s72, s73
    s_mul_i32 s73, s72, 393216
    s_lshl_b32 s72, s72, 7
    s_add_u32 s74, s72, s70
    s_add_u32 s75, s73, s66
    s_add_u32 s76, s73, s67
    s_add_u32 m0, s71, 122880
    s_add_u32 s77, s74, 0
    buffer_load_dwordx4 v10, s[24:27], s77 offen lds
    s_add_u32 m0, s71, 123904
    s_add_u32 s77, s74, 16384
    buffer_load_dwordx4 v11, s[24:27], s77 offen lds
    s_add_u32 m0, s71, 124928
    s_add_u32 s77, s74, 32768
    buffer_load_dwordx4 v10, s[24:27], s77 offen lds
    s_add_u32 m0, s71, 125952
    s_add_u32 s77, s74, 49152
    buffer_load_dwordx4 v11, s[24:27], s77 offen lds
    s_add_u32 m0, s68, 122880
    s_add_u32 s77, s75, 0
    buffer_load_dwordx4 v12, s[28:31], s77 offen lds
    s_add_u32 m0, s68, 131072
    s_add_u32 s77, s75, 2048
    buffer_load_dwordx4 v12, s[28:31], s77 offen lds
    s_add_u32 m0, s68, 139264
    s_add_u32 s77, s75, 4096
    buffer_load_dwordx4 v12, s[28:31], s77 offen lds
    s_add_u32 m0, s69, 122880
    s_add_u32 s77, s76, 0
    buffer_load_dwordx4 v12, s[28:31], s77 offen lds
    s_add_u32 m0, s69, 131072
    s_add_u32 s77, s76, 2048
    buffer_load_dwordx4 v12, s[28:31], s77 offen lds
    s_add_u32 m0, s69, 139264
    s_add_u32 s77, s76, 4096
    buffer_load_dwordx4 v12, s[28:31], s77 offen lds
    buffer_load_dword v14, v13, s[36:39], 0 offen offset:4 sc1
    s_waitcnt vmcnt(11)
    s_barrier
    s_add_u32 s72, s64, 0
    s_and_b32 s72, s72, 3
    s_add_u32 s73, s65, 4
    s_and_b32 s73, s73, 15
    s_add_u32 s72, s72, s73
    s_mul_i32 s73, s72, 393216
    s_lshl_b32 s72, s72, 7
    s_add_u32 s74, s72, s70
    s_add_u32 s75, s73, s66
    s_add_u32 s76, s73, s67
    s_add_u32 m0, s71, 0
    s_add_u32 s77, s74, 0
    buffer_load_dwordx4 v10, s[24:27], s77 offen lds
    s_add_u32 m0, s71, 1024
    s_add_u32 s77, s74, 16384
    buffer_load_dwordx4 v11, s[24:27], s77 offen lds
    s_add_u32 m0, s71, 2048
    s_add_u32 s77, s74, 32768
    buffer_load_dwordx4 v10, s[24:27], s77 offen lds
    s_add_u32 m0, s71, 3072
    s_add_u32 s77, s74, 49152
    buffer_load_dwordx4 v11, s[24:27], s77 offen lds
    s_add_u32 m0, s68, 0
    s_add_u32 s77, s75, 0
    buffer_load_dwordx4 v12, s[28:31], s77 offen lds
    s_add_u32 m0, s68, 8192
    s_add_u32 s77, s75, 2048
    buffer_load_dwordx4 v12, s[28:31], s77 offen lds
    s_add_u32 m0, s68, 16384
    s_add_u32 s77, s75, 4096
    buffer_load_dwordx4 v12, s[28:31], s77 offen lds
    s_add_u32 m0, s69, 0
    s_add_u32 s77, s76, 0
    buffer_load_dwordx4 v12, s[28:31], s77 offen lds
    s_add_u32 m0, s69, 8192
    s_add_u32 s77, s76, 2048
    buffer_load_dwordx4 v12, s[28:31], s77 offen lds
    s_add_u32 m0, s69, 16384
    s_add_u32 s77, s76, 4096
    buffer_load_dwordx4 v12, s[28:31], s77 offen lds
    s_waitcnt vmcnt(11)
    s_barrier
    s_add_u32 s72, s64, 1
    s_and_b32 s72, s72, 3
    s_add_u32 s73, s65, 4
    s_and_b32 s73, s73, 15
    s_add_u32 s72, s72, s73
    s_mul_i32 s73, s72, 393216
    s_lshl_b32 s72, s72, 7
    s_add_u32 s74, s72, s70
    s_add_u32 s75, s73, s66
    s_add_u32 s76, s73, s67
    s_add_u32 m0, s71, 40960
    s_add_u32 s77, s74, 0
    buffer_load_dwordx4 v10, s[24:27], s77 offen lds
    s_add_u32 m0, s71, 41984
    s_add_u32 s77, s74, 16384
    buffer_load_dwordx4 v11, s[24:27], s77 offen lds
    s_add_u32 m0, s71, 43008
    s_add_u32 s77, s74, 32768
    buffer_load_dwordx4 v10, s[24:27], s77 offen lds
    s_add_u32 m0, s71, 44032
    s_add_u32 s77, s74, 49152
    buffer_load_dwordx4 v11, s[24:27], s77 offen lds
    s_add_u32 m0, s68, 40960
    s_add_u32 s77, s75, 0
    buffer_load_dwordx4 v12, s[28:31], s77 offen lds
    s_add_u32 m0, s68, 49152
    s_add_u32 s77, s75, 2048
    buffer_load_dwordx4 v12, s[28:31], s77 offen lds
    s_add_u32 m0, s68, 57344
    s_add_u32 s77, s75, 4096
    buffer_load_dwordx4 v12, s[28:31], s77 offen lds
    s_add_u32 m0, s69, 40960
    s_add_u32 s77, s76, 0
    buffer_load_dwordx4 v12, s[28:31], s77 offen lds
    s_add_u32 m0, s69, 49152
    s_add_u32 s77, s76, 2048
    buffer_load_dwordx4 v12, s[28:31], s77 offen lds
    s_add_u32 m0, s69, 57344
    s_add_u32 s77, s76, 4096
    buffer_load_dwordx4 v12, s[28:31], s77 offen lds
    s_waitcnt vmcnt(10)
    s_barrier
    s_add_u32 s72, s64, 2
    s_and_b32 s72, s72, 3
    s_add_u32 s73, s65, 4
    s_and_b32 s73, s73, 15
    s_add_u32 s72, s72, s73
    s_mul_i32 s73, s72, 393216
    s_lshl_b32 s72, s72, 7
    s_add_u32 s74, s72, s70
    s_add_u32 s75, s73, s66
    s_add_u32 s76, s73, s67
    s_add_u32 m0, s71, 81920
    s_add_u32 s77, s74, 0
    buffer_load_dwordx4 v10, s[24:27], s77 offen lds
    s_add_u32 m0, s71, 82944
    s_add_u32 s77, s74, 16384
    buffer_load_dwordx4 v11, s[24:27], s77 offen lds
    s_add_u32 m0, s71, 83968
    s_add_u32 s77, s74, 32768
    buffer_load_dwordx4 v10, s[24:27], s77 offen lds
    s_add_u32 m0, s71, 84992
    s_add_u32 s77, s74, 49152
    buffer_load_dwordx4 v11, s[24:27], s77 offen lds
    s_add_u32 m0, s68, 81920
    s_add_u32 s77, s75, 0
    buffer_load_dwordx4 v12, s[28:31], s77 offen lds
    s_add_u32 m0, s68, 90112
    s_add_u32 s77, s75, 2048
    buffer_load_dwordx4 v12, s[28:31], s77 offen lds
    s_add_u32 m0, s68, 98304
    s_add_u32 s77, s75, 4096
    buffer_load_dwordx4 v12, s[28:31], s77 offen lds
    s_add_u32 m0, s69, 81920
    s_add_u32 s77, s76, 0
    buffer_load_dwordx4 v12, s[28:31], s77 offen lds
    s_add_u32 m0, s69, 90112
    s_add_u32 s77, s76, 2048
    buffer_load_dwordx4 v12, s[28:31], s77 offen lds
    s_add_u32 m0, s69, 98304
    s_add_u32 s77, s76, 4096
    buffer_load_dwordx4 v12, s[28:31], s77 offen lds
    s_add_u32 s72, s64, 3
    s_and_b32 s72, s72, 3
    s_add_u32 s73, s65, 4
    s_and_b32 s73, s73, 15
    s_add_u32 s72, s72, s73
    s_mul_i32 s73, s72, 393216
    s_lshl_b32 s72, s72, 7
    s_add_u32 s74, s72, s70
    s_add_u32 s75, s73, s66
    s_add_u32 s76, s73, s67
    s_add_u32 m0, s71, 122880
    s_add_u32 s77, s74, 0
    buffer_load_dwordx4 v10, s[24:27], s77 offen lds
    s_add_u32 m0, s71, 123904
    s_add_u32 s77, s74, 16384
    buffer_load_dwordx4 v11, s[24:27], s77 offen lds
    s_waitcnt vmcnt(44)
    s_waitcnt vmcnt(32)
    v_readfirstlane_b32 s78, v14
L_tg1:
    s_nop 1
    s_cmp_lg_u32 s78, 0
    s_cbranch_scc1 L_tk2
    buffer_load_dword v14, v13, s[36:39], 0 offen offset:4 sc1
    s_waitcnt vmcnt(0)
    v_readfirstlane_b32 s78, v14
    s_add_u32 s79, s79, 1
    s_cmp_lt_u32 s79, 32768
    s_cbranch_scc1 L_tg1
L_tk2:
    s_mul_i32 s80, s78, 0x9e3779b1
    s_lshr_b32 s80, s80, 22
    s_mul_i32 s81, s78, 0x85ebca77
    s_lshr_b32 s81, s81, 22
    s_mul_i32 s82, s78, 0xc2b2ae3d
    s_lshr_b32 s82, s82, 22
    s_mul_i32 s83, s78, 0x27d4eb2f
    s_lshr_b32 s83, s83, 22
    v_and_b32 v72, 0xffff, v64
    v_and_b32 v80, 0xffff0000, v64
    v_and_b32 v73, 0xffff, v65
    v_and_b32 v81, 0xffff0000, v65
    v_dot2_f32_bf16 v92, v40, v72, 0
    v_dot2_f32_bf16 v93, v40, v80, 0
    v_and_b32 v74, 0xffff, v66
    v_and_b32 v82, 0xffff0000, v66
    v_dot2_f32_bf16 v94, v41, v73, 0
    v_dot2_f32_bf16 v95, v41, v81, 0
    v_and_b32 v75, 0xffff, v67
    v_and_b32 v83, 0xffff0000, v67
    v_cvt_pk_bf16_f32 v92, v92, v93
    v_dot2_f32_bf16 v96, v42, v74, 0
    v_dot2_f32_bf16 v97, v42, v82, 0
    s_mov_b32 s19, 0x3f803f80
    v_and_b32 v76, 0xffff, v68
    v_and_b32 v84, 0xffff0000, v68
    v_dot2_f32_bf16 v89, v92, s19, 0
    v_cvt_pk_bf16_f32 v94, v94, v95
    v_dot2_f32_bf16 v98, v43, v75, 0
    v_dot2_f32_bf16 v99, v43, v83, 0
    v_and_b32 v77, 0xffff, v69
    v_and_b32 v85, 0xffff0000, v69
    v_dot2_f32_bf16 v89, v94, s19, v89
    v_cvt_pk_bf16_f32 v96, v96, v97
    v_dot2_f32_bf16 v92, v44, v76, 0
    v_dot2_f32_bf16 v93, v44, v84, 0
    v_and_b32 v78, 0xffff, v70
    v_and_b32 v86, 0xffff0000, v70
    v_dot2_f32_bf16 v89, v96, s19, v89
    v_cvt_pk_bf16_f32 v98, v98, v99
    v_dot2_f32_bf16 v94, v45, v77, 0
    v_dot2_f32_bf16 v95, v45, v85, 0
    v_and_b32 v79, 0xffff, v71
    v_and_b32 v87, 0xffff0000, v71
    v_dot2_f32_bf16 v89, v98, s19, v89
    v_cvt_pk_bf16_f32 v92, v92, v93
    v_dot2_f32_bf16 v96, v46, v78, 0
    v_dot2_f32_bf16 v97, v46, v86, 0
    v_dot2_f32_bf16 v89, v92, s19, v89
    v_cvt_pk_bf16_f32 v94, v94, v95
    v_dot2_f32_bf16 v98, v47, v79, 0
    v_dot2_f32_bf16 v99, v47, v87, 0
    v_dot2_f32_bf16 v92, v48, v72, 0
    v_dot2_f32_bf16 v93, v48, v80, 0
    v_dot2_f32_bf16 v89, v94, s19, v89
    v_cvt_pk_bf16_f32 v96, v96, v97
    v_dot2_f32_bf16 v94, v49, v73, 0
    v_dot2_f32_bf16 v95, v49, v81, 0
    v_dot2_f32_bf16 v89, v96, s19, v89
    v_cvt_pk_bf16_f32 v98, v98, v99
    v_cvt_pk_bf16_f32 v92, v92, v93
    v_dot2_f32_bf16 v96, v50, v74, 0
    v_dot2_f32_bf16 v97, v50, v82, 0
    v_dot2_f32_bf16 v89, v98, s19, v89
    v_dot2_f32_bf16 v88, v40, v56, 0
    v_dot2_f32_bf16 v90, v48, v56, 0
    v_dot2_f32_bf16 v91, v92, s19, 0
    v_cvt_pk_bf16_f32 v94, v94, v95
    v_dot2_f32_bf16 v98, v51, v75, 0
    v_dot2_f32_bf16 v99, v51, v83, 0
    v_dot2_f32_bf16 v88, v41, v57, v88
    v_dot2_f32_bf16 v90, v49, v57, v90
    v_dot2_f32_bf16 v91, v94, s19, v91
    v_cvt_pk_bf16_f32 v96, v96, v97
    v_dot2_f32_bf16 v92, v52, v76, 0
    v_dot2_f32_bf16 v93, v52, v84, 0
    v_dot2_f32_bf16 v88, v42, v58, v88
    v_dot2_f32_bf16 v90, v50, v58, v90
    v_dot2_f32_bf16 v91, v96, s19, v91
    v_cvt_pk_bf16_f32 v98, v98, v99
    v_dot2_f32_bf16 v94, v53, v77, 0
    v_dot2_f32_bf16 v95, v53, v85, 0
    v_dot2_f32_bf16 v88, v43, v59, v88
    v_dot2_f32_bf16 v90, v51, v59, v90
    v_dot2_f32_bf16 v91, v98, s19, v91
    v_cvt_pk_bf16_f32 v92, v92, v93
    v_dot2_f32_bf16 v96, v54, v78, 0
    v_dot2_f32_bf16 v97, v54, v86, 0
    v_dot2_f32_bf16 v88, v44, v60, v88
    v_dot2_f32_bf16 v90, v52, v60, v90
    v_dot2_f32_bf16 v91, v92, s19, v91
    v_cvt_pk_bf16_f32 v94, v94, v95
    v_dot2_f32_bf16 v98, v55, v79, 0
    v_dot2_f32_bf16 v99, v55, v87, 0
    v_dot2_f32_bf16 v88, v45, v61, v88
    v_dot2_f32_bf16 v90, v53, v61, v90
    v_dot2_f32_bf16 v91, v94, s19, v91
    v_cvt_pk_bf16_f32 v96, v96, v97
    v_dot2_f32_bf16 v88, v46, v62, v88
    v_dot2_f32_bf16 v90, v54, v62, v90
    v_dot2_f32_bf16 v91, v96, s19, v91
    v_cvt_pk_bf16_f32 v98, v98, v99
    v_dot2_f32_bf16 v88, v47, v63, v88
    v_dot2_f32_bf16 v90, v55, v63, v90
    v_dot2_f32_bf16 v91, v98, s19, v91
    s_nop 1
    v_permlane32_swap_b32 v88, v90
    v_permlane32_swap_b32 v89, v91
    v_add_f32 v88, v88, v90
    v_add_f32 v89, v89, v91
    v_mov_b32 v91, s78
    s_nop 0
    v_permlane16_swap_b32 v88, v89
    v_add_f32 v88, v88, v89
    s_nop 1
    v_add_f32_dpp v88, v88, v88 row_ror:8 row_mask:0xf bank_mask:0xf
    s_nop 1
    v_add_f32_dpp v88, v88, v88 row_ror:4 row_mask:0xf bank_mask:0xf
    s_nop 1
    v_add_f32_dpp v88, v88, v88 row_ror:2 row_mask:0xf bank_mask:0xf
    s_nop 1
    v_add_f32_dpp v88, v88, v88 row_ror:1 row_mask:0xf bank_mask:0xf
    v_cvt_pk_bf16_f32 v88, v88, v88
    v_ashrrev_i32 v90, 31, v88
    v_and_b32 v89, 0xffff0000, v88
    v_or_b32 v90, 0x80000000, v90
    v_mul_f32 v89, 0xbfb8aa3b, v89
    v_xor_b32 v90, v90, v88
    v_exp_f32 v89, v89
    v_lshrrev_b32 v90, 16, v90
    v_add_f32 v89, 1.0, v89
    v_readlane_b32 s84, v90, 0
    v_readlane_b32 s85, v90, 32
    v_rcp_f32 v89, v89
    s_lshl_b32 s84, s84, 11
    s_lshl_b32 s85, s85, 11
    s_sub_u32 s3, 2047, s18
    v_cvt_pk_bf16_f32 v89, v89, v89
    s_or_b32 s84, s84, s3
    s_sub_u32 s3, s3, 1
    s_or_b32 s85, s85, s3
    v_readlane_b32 s20, v89, 16
    s_max_u32 s84, s84, s85
    v_readlane_b32 s21, v89, 48
    s_lshl_b32 s84, s84, 4
    s_or_b32 s84, s84, s23
    s_and_b32 s20, s20, 0xffff
    s_and_b32 s21, s21, 0xffff0000
    s_or_b32 s20, s20, s21
    s_lshl_b32 s3, s18, 2
    s_add_u32 s21, s3, 4472832
    s_add_u32 s3, s3, 4464640
    v_mov_b32 v88, s84
    v_mov_b32 v89, s78
    v_mov_b32 v90, s20
    s_mov_b64 exec, 1
    buffer_store_dwordx2 v[88:89], v13, s[32:35], s3 offen sc1
    buffer_store_dwordx2 v[90:91], v13, s[32:35], s21 offen sc1
    s_mov_b64 exec, -1
    s_waitcnt vmcnt(14)
    s_barrier
    s_add_u32 m0, s71, 124928
    s_add_u32 s77, s74, 32768
    buffer_load_dwordx4 v10, s[24:27], s77 offen lds
    s_add_u32 m0, s71, 125952
    s_add_u32 s77, s74, 49152
    buffer_load_dwordx4 v11, s[24:27], s77 offen lds
    s_add_u32 m0, s68, 122880
    s_add_u32 s77, s75, 0
    buffer_load_dwordx4 v12, s[28:31], s77 offen lds
    s_add_u32 m0, s68, 131072
    s_add_u32 s77, s75, 2048
    buffer_load_dwordx4 v12, s[28:31], s77 offen lds
    s_add_u32 m0, s68, 139264
    s_add_u32 s77, s75, 4096
    buffer_load_dwordx4 v12, s[28:31], s77 offen lds
    s_add_u32 m0, s69, 122880
    s_add_u32 s77, s76, 0
    buffer_load_dwordx4 v12, s[28:31], s77 offen lds
    s_add_u32 m0, s69, 131072
    s_add_u32 s77, s76, 2048
    buffer_load_dwordx4 v12, s[28:31], s77 offen lds
    s_add_u32 m0, s69, 139264
    s_add_u32 s77, s76, 4096
    buffer_load_dwordx4 v12, s[28:31], s77 offen lds
    s_add_u32 s72, s64, 0
    s_and_b32 s72, s72, 3
    s_add_u32 s73, s65, 8
    s_and_b32 s73, s73, 15
    s_add_u32 s72, s72, s73
    s_mul_i32 s73, s72, 393216
    s_lshl_b32 s72, s72, 7
    s_add_u32 s74, s72, s70
    s_add_u32 s75, s73, s66
    s_add_u32 s76, s73, s67
    s_add_u32 m0, s71, 0
    s_add_u32 s77, s74, 0
    buffer_load_dwordx4 v10, s[24:27], s77 offen lds
    s_add_u32 m0, s71, 1024
    s_add_u32 s77, s74, 16384
    buffer_load_dwordx4 v11, s[24:27], s77 offen lds
    s_add_u32 m0, s71, 2048
    s_add_u32 s77, s74, 32768
    buffer_load_dwordx4 v10, s[24:27], s77 offen lds
    s_add_u32 m0, s71, 3072
    s_add_u32 s77, s74, 49152
    buffer_load_dwordx4 v11, s[24:27], s77 offen lds
    s_waitcnt vmcnt(16)
    s_barrier
    s_add_u32 m0, s68, 0
    s_add_u32 s77, s75, 0
    buffer_load_dwordx4 v12, s[28:31], s77 offen lds
    s_add_u32 m0, s68, 8192
    s_add_u32 s77, s75, 2048
    buffer_load_dwordx4 v12, s[28:31], s77 offen lds
    s_add_u32 m0, s68, 16384
    s_add_u32 s77, s75, 4096
    buffer_load_dwordx4 v12, s[28:31], s77 offen lds
    s_add_u32 m0, s69, 0
    s_add_u32 s77, s76, 0
    buffer_load_dwordx4 v12, s[28:31], s77 offen lds
    s_add_u32 m0, s69, 8192
    s_add_u32 s77, s76, 2048
    buffer_load_dwordx4 v12, s[28:31], s77 offen lds
    s_add_u32 m0, s69, 16384
    s_add_u32 s77, s76, 4096
    buffer_load_dwordx4 v12, s[28:31], s77 offen lds
    s_add_u32 s72, s64, 1
    s_and_b32 s72, s72, 3
    s_add_u32 s73, s65, 8
    s_and_b32 s73, s73, 15
    s_add_u32 s72, s72, s73
    s_mul_i32 s73, s72, 393216
    s_lshl_b32 s72, s72, 7
    s_add_u32 s74, s72, s70
    s_add_u32 s75, s73, s66
    s_add_u32 s76, s73, s67
    s_add_u32 m0, s71, 40960
    s_add_u32 s77, s74, 0
    buffer_load_dwordx4 v10, s[24:27], s77 offen lds
    s_add_u32 m0, s71, 41984
    s_add_u32 s77, s74, 16384
    buffer_load_dwordx4 v11, s[24:27], s77 offen lds
    s_add_u32 m0, s71, 43008
    s_add_u32 s77, s74, 32768
    buffer_load_dwordx4 v10, s[24:27], s77 offen lds
    s_add_u32 m0, s71, 44032
    s_add_u32 s77, s74, 49152
    buffer_load_dwordx4 v11, s[24:27], s77 offen lds
    s_waitcnt vmcnt(14)
    s_barrier
    s_add_u32 m0, s68, 40960
    s_add_u32 s77, s75, 0
    buffer_load_dwordx4 v12, s[28:31], s77 offen lds
    s_add_u32 m0, s68, 49152
    s_add_u32 s77, s75, 2048
    buffer_load_dwordx4 v12, s[28:31], s77 offen lds
    s_add_u32 m0, s68, 57344
    s_add_u32 s77, s75, 4096
    buffer_load_dwordx4 v12, s[28:31], s77 offen lds
    s_add_u32 m0, s69, 40960
    s_add_u32 s77, s76, 0
    buffer_load_dwordx4 v12, s[28:31], s77 offen lds
    s_add_u32 m0, s69, 49152
    s_add_u32 s77, s76, 2048
    buffer_load_dwordx4 v12, s[28:31], s77 offen lds
    s_add_u32 m0, s69, 57344
    s_add_u32 s77, s76, 4096
    buffer_load_dwordx4 v12, s[28:31], s77 offen lds
    s_add_u32 s72, s64, 2
    s_and_b32 s72, s72, 3
    s_add_u32 s73, s65, 8
    s_and_b32 s73, s73, 15
    s_add_u32 s72, s72, s73
    s_mul_i32 s73, s72, 393216
    s_lshl_b32 s72, s72, 7
    s_add_u32 s74, s72, s70
    s_add_u32 s75, s73, s66
    s_add_u32 s76, s73, s67
    s_add_u32 m0, s71, 81920
    s_add_u32 s77, s74, 0
    buffer_load_dwordx4 v10, s[24:27], s77 offen lds
    s_add_u32 m0, s71, 82944
    s_add_u32 s77, s74, 16384
    buffer_load_dwordx4 v11, s[24:27], s77 offen lds
    s_add_u32 m0, s71, 83968
    s_add_u32 s77, s74, 32768
    buffer_load_dwordx4 v10, s[24:27], s77 offen lds
    s_add_u32 m0, s71, 84992
    s_add_u32 s77, s74, 49152
    buffer_load_dwordx4 v11, s[24:27], s77 offen lds
    s_waitcnt vmcnt(14)
    s_barrier
    s_add_u32 m0, s68, 81920
    s_add_u32 s77, s75, 0
    buffer_load_dwordx4 v12, s[28:31], s77 offen lds
    s_add_u32 m0, s68, 90112
    s_add_u32 s77, s75, 2048
    buffer_load_dwordx4 v12, s[28:31], s77 offen lds
    s_add_u32 m0, s68, 98304
    s_add_u32 s77, s75, 4096
    buffer_load_dwordx4 v12, s[28:31], s77 offen lds
    s_add_u32 m0, s69, 81920
    s_add_u32 s77, s76, 0
    buffer_load_dwordx4 v12, s[28:31], s77 offen lds
    s_add_u32 m0, s69, 90112
    s_add_u32 s77, s76, 2048
    buffer_load_dwordx4 v12, s[28:31], s77 offen lds
    s_add_u32 m0, s69, 98304
    s_add_u32 s77, s76, 4096
    buffer_load_dwordx4 v12, s[28:31], s77 offen lds
    s_add_u32 s72, s64, 3
    s_and_b32 s72, s72, 3
    s_add_u32 s73, s65, 8
    s_and_b32 s73, s73, 15
    s_add_u32 s72, s72, s73
    s_mul_i32 s73, s72, 393216
    s_lshl_b32 s72, s72, 7
    s_add_u32 s74, s72, s70
    s_add_u32 s75, s73, s66
    s_add_u32 s76, s73, s67
    s_add_u32 m0, s71, 122880
    s_add_u32 s77, s74, 0
    buffer_load_dwordx4 v10, s[24:27], s77 offen lds
    s_add_u32 m0, s71, 123904
    s_add_u32 s77, s74, 16384
    buffer_load_dwordx4 v11, s[24:27], s77 offen lds
    s_add_u32 m0, s71, 124928
    s_add_u32 s77, s74, 32768
    buffer_load_dwordx4 v10, s[24:27], s77 offen lds
    s_add_u32 m0, s71, 125952
    s_add_u32 s77, s74, 49152
    buffer_load_dwordx4 v11, s[24:27], s77 offen lds
    s_add_u32 m0, s68, 122880
    s_add_u32 s77, s75, 0
    buffer_load_dwordx4 v12, s[28:31], s77 offen lds
    s_add_u32 m0, s68, 131072
    s_add_u32 s77, s75, 2048
    buffer_load_dwordx4 v12, s[28:31], s77 offen lds
    s_waitcnt vmcnt(16)
    s_barrier
    s_add_u32 m0, s68, 139264
    s_add_u32 s77, s75, 4096
    buffer_load_dwordx4 v12, s[28:31], s77 offen lds
    s_add_u32 m0, s69, 122880
    s_add_u32 s77, s76, 0
    buffer_load_dwordx4 v12, s[28:31], s77 offen lds
    s_add_u32 m0, s69, 131072
    s_add_u32 s77, s76, 2048
    buffer_load_dwordx4 v12, s[28:31], s77 offen lds
    s_add_u32 m0, s69, 139264
    s_add_u32 s77, s76, 4096
    buffer_load_dwordx4 v12, s[28:31], s77 offen lds
    s_add_u32 s72, s64, 0
    s_and_b32 s72, s72, 3
    s_add_u32 s73, s65, 12
    s_and_b32 s73, s73, 15
    s_add_u32 s72, s72, s73
    s_mul_i32 s73, s72, 393216
    s_lshl_b32 s72, s72, 7
    s_add_u32 s74, s72, s70
    s_add_u32 s75, s73, s66
    s_add_u32 s76, s73, s67
    s_add_u32 m0, s71, 0
    s_add_u32 s77, s74, 0
    buffer_load_dwordx4 v10, s[24:27], s77 offen lds
    s_add_u32 m0, s71, 1024
    s_add_u32 s77, s74, 16384
    buffer_load_dwordx4 v11, s[24:27], s77 offen lds
    s_add_u32 m0, s71, 2048
    s_add_u32 s77, s74, 32768
    buffer_load_dwordx4 v10, s[24:27], s77 offen lds
    s_add_u32 m0, s71, 3072
    s_add_u32 s77, s74, 49152
    buffer_load_dwordx4 v11, s[24:27], s77 offen lds
    s_add_u32 m0, s68, 0
    s_add_u32 s77, s75, 0
    buffer_load_dwordx4 v12, s[28:31], s77 offen lds
    s_add_u32 m0, s68, 8192
    s_add_u32 s77, s75, 2048
    buffer_load_dwordx4 v12, s[28:31], s77 offen lds
    s_add_u32 m0, s68, 16384
    s_add_u32 s77, s75, 4096
    buffer_load_dwordx4 v12, s[28:31], s77 offen lds
    s_add_u32 m0, s69, 0
    s_add_u32 s77, s76, 0
    buffer_load_dwordx4 v12, s[28:31], s77 offen lds
    s_waitcnt vmcnt(18)
    s_barrier
    s_add_u32 m0, s69, 8192
    s_add_u32 s77, s76, 2048
    buffer_load_dwordx4 v12, s[28:31], s77 offen lds
    s_add_u32 m0, s69, 16384
    s_add_u32 s77, s76, 4096
    buffer_load_dwordx4 v12, s[28:31], s77 offen lds
    s_add_u32 s72, s64, 1
    s_and_b32 s72, s72, 3
    s_add_u32 s73, s65, 12
    s_and_b32 s73, s73, 15
    s_add_u32 s72, s72, s73
    s_mul_i32 s73, s72, 393216
    s_lshl_b32 s72, s72, 7
    s_add_u32 s74, s72, s70
    s_add_u32 s75, s73, s66
    s_add_u32 s76, s73, s67
    s_add_u32 m0, s71, 40960
    s_add_u32 s77, s74, 0
    buffer_load_dwordx4 v10, s[24:27], s77 offen lds
    s_add_u32 m0, s71, 41984
    s_add_u32 s77, s74, 16384
    buffer_load_dwordx4 v11, s[24:27], s77 offen lds
    s_add_u32 m0, s71, 43008
    s_add_u32 s77, s74, 32768
    buffer_load_dwordx4 v10, s[24:27], s77 offen lds
    s_add_u32 m0, s71, 44032
    s_add_u32 s77, s74, 49152
    buffer_load_dwordx4 v11, s[24:27], s77 offen lds
    s_add_u32 m0, s68, 40960
    s_add_u32 s77, s75, 0
    buffer_load_dwordx4 v12, s[28:31], s77 offen lds
    s_add_u32 m0, s68, 49152
    s_add_u32 s77, s75, 2048
    buffer_load_dwordx4 v12, s[28:31], s77 offen lds
    s_add_u32 m0, s68, 57344
    s_add_u32 s77, s75, 4096
    buffer_load_dwordx4 v12, s[28:31], s77 offen lds
    s_add_u32 m0, s69, 40960
    s_add_u32 s77, s76, 0
    buffer_load_dwordx4 v12, s[28:31], s77 offen lds
    s_getpc_b64 s[4:5]
L_ctp:
    s_lshl_b32 s7, s13, 2
    s_add_u32 s7, s7, s17
    s_lshl_b32 s7, s7, 8
    s_add_u32 s7, s7, L_lpost-L_ctp
    s_min_u32 s7, s7, L_end-L_ctp-252
    s_and_b32 s7, s7, -4
    s_add_u32 s4, s4, s7
    s_addc_u32 s5, s5, 0
    s_load_dword s7, s[4:5], 0
    s_load_dword s7, s[4:5], 64
    s_load_dword s7, s[4:5], 128
    s_load_dword s7, s[4:5], 192
    s_waitcnt vmcnt(18)
    s_barrier
    s_add_u32 m0, s69, 49152
    s_add_u32 s77, s76, 2048
    buffer_load_dwordx4 v12, s[28:31], s77 offen lds
    s_add_u32 m0, s69, 57344
    s_add_u32 s77, s76, 4096
    buffer_load_dwordx4 v12, s[28:31], s77 offen lds
    s_add_u32 s72, s64, 2
    s_and_b32 s72, s72, 3
    s_add_u32 s73, s65, 12
    s_and_b32 s73, s73, 15
    s_add_u32 s72, s72, s73
    s_mul_i32 s73, s72, 393216
    s_lshl_b32 s72, s72, 7
    s_add_u32 s74, s72, s70
    s_add_u32 s75, s73, s66
    s_add_u32 s76, s73, s67
    s_add_u32 m0, s71, 81920
    s_add_u32 s77, s74, 0
    buffer_load_dwordx4 v10, s[24:27], s77 offen lds
    s_add_u32 m0, s71, 82944
    s_add_u32 s77, s74, 16384
    buffer_load_dwordx4 v11, s[24:27], s77 offen lds
    s_add_u32 m0, s71, 83968
    s_add_u32 s77, s74, 32768
    buffer_load_dwordx4 v10, s[24:27], s77 offen lds
    s_add_u32 m0, s71, 84992
    s_add_u32 s77, s74, 49152
    buffer_load_dwordx4 v11, s[24:27], s77 offen lds
    s_add_u32 m0, s68, 81920
    s_add_u32 s77, s75, 0
    buffer_load_dwordx4 v12, s[28:31], s77 offen lds
    s_add_u32 m0, s68, 90112
    s_add_u32 s77, s75, 2048
    buffer_load_dwordx4 v12, s[28:31], s77 offen lds
    s_add_u32 m0, s68, 98304
    s_add_u32 s77, s75, 4096
    buffer_load_dwordx4 v12, s[28:31], s77 offen lds
    s_add_u32 m0, s69, 81920
    s_add_u32 s77, s76, 0
    buffer_load_dwordx4 v12, s[28:31], s77 offen lds
    s_lshl_b32 s19, s17, 11
    s_add_u32 s19, s19, 4464640
    buffer_load_dwordx4 v[28:31], v3, s[32:35], s19 offen offset:0 sc1
    buffer_load_dwordx4 v[32:35], v3, s[32:35], s19 offen offset:1024 sc1
    s_waitcnt vmcnt(20)
    s_barrier
    s_add_u32 m0, s69, 90112
    s_add_u32 s77, s76, 2048
    buffer_load_dwordx4 v12, s[28:31], s77 offen lds
    s_add_u32 m0, s69, 98304
    s_add_u32 s77, s76, 4096
    buffer_load_dwordx4 v12, s[28:31], s77 offen lds
    s_add_u32 s72, s64, 3
    s_and_b32 s72, s72, 3
    s_add_u32 s73, s65, 12
    s_and_b32 s73, s73, 15
    s_add_u32 s72, s72, s73
    s_mul_i32 s73, s72, 393216
    s_lshl_b32 s72, s72, 7
    s_add_u32 s74, s72, s70
    s_add_u32 s75, s73, s66
    s_add_u32 s76, s73, s67
    s_add_u32 m0, s71, 122880
    s_add_u32 s77, s74, 0
    buffer_load_dwordx4 v10, s[24:27], s77 offen lds
    s_add_u32 m0, s71, 123904
    s_add_u32 s77, s74, 16384
    buffer_load_dwordx4 v11, s[24:27], s77 offen lds
    s_add_u32 m0, s71, 124928
    s_add_u32 s77, s74, 32768
    buffer_load_dwordx4 v10, s[24:27], s77 offen lds
    s_add_u32 m0, s71, 125952
    s_add_u32 s77, s74, 49152
    buffer_load_dwordx4 v11, s[24:27], s77 offen lds
    s_add_u32 m0, s68, 122880
    s_add_u32 s77, s75, 0
    buffer_load_dwordx4 v12, s[28:31], s77 offen lds
    s_add_u32 m0, s68, 131072
    s_add_u32 s77, s75, 2048
    buffer_load_dwordx4 v12, s[28:31], s77 offen lds
    s_add_u32 m0, s68, 139264
    s_add_u32 s77, s75, 4096
    buffer_load_dwordx4 v12, s[28:31], s77 offen lds
    s_add_u32 m0, s69, 122880
    s_add_u32 s77, s76, 0
    buffer_load_dwordx4 v12, s[28:31], s77 offen lds
    s_add_u32 m0, s69, 131072
    s_add_u32 s77, s76, 2048
    buffer_load_dwordx4 v12, s[28:31], s77 offen lds
    s_add_u32 m0, s69, 139264
    s_add_u32 s77, s76, 4096
    buffer_load_dwordx4 v12, s[28:31], s77 offen lds
    s_waitcnt vmcnt(22)
    s_barrier
    buffer_load_dwordx4 v[96:99], v15, s[48:51], s1 offen nt
    buffer_load_dwordx4 v[128:131], v15, s[52:55], s1 offen nt
    s_add_u32 s1, s1, 28672
    buffer_load_dwordx4 v[100:103], v15, s[48:51], s1 offen nt
    buffer_load_dwordx4 v[132:135], v15, s[52:55], s1 offen nt
    s_add_u32 s1, s1, 28672
    buffer_load_dwordx4 v[104:107], v15, s[48:51], s1 offen nt
    buffer_load_dwordx4 v[136:139], v15, s[52:55], s1 offen nt
    s_add_u32 s1, s1, 28672
    s_mul_i32 s73, s13, 112
    s_mul_i32 s19, s17, 28
    s_add_u32 s73, s73, s19
    s_lshl_b32 s74, s73, 11
    s_lshl_b32 s19, s12, 8
    s_add_u32 s74, s74, s19
    s_lshr_b32 s67, s12, 2
    s_lshl_b32 s67, s67, 3
    s_lshr_b32 s19, s13, 2
    s_add_u32 s67, s67, s19
    s_lshl_b32 s68, s19, 2
    s_lshl_b32 s69, s67, 7
    s_lshl_b32 s19, s17, 14
    s_add_u32 s69, s69, s19
    s_and_b32 s19, s13, 3
    s_lshl_b32 s19, s19, 3
    s_add_u32 s68, s68, s19
    s_and_b32 s68, s68, 31
    s_waitcnt vmcnt(6)
    s_barrier
L_lpost:
    s_cmp_lg_u32 s17, 0
    s_cbranch_scc1 L_z3
    v_mov_b32 v76, 0
    v_mov_b32 v77, 0
    v_mov_b32 v78, 0
    v_mov_b32 v79, 0
    s_mov_b64 exec, 31
    ds_write_b128 v3, v[76:79] offset:0
    ds_write_b32 v13, v37 offset:128
    s_mov_b64 exec, -1
L_z3:
    s_waitcnt vmcnt(18)
L_kp4:
    v_xor_b32 v29, s78, v29
    v_mov_b32 v80, v28
    v_xor_b32 v31, s78, v31
    v_mov_b32 v81, v30
    v_xor_b32 v33, s78, v33
    v_mov_b32 v82, v32
    v_xor_b32 v35, s78, v35
    v_mov_b32 v83, v34
    v_or3_b32 v29, v29, v31, v33
    v_max3_u32 v28, v28, v30, v32
    v_or_b32 v29, v29, v35
    v_max_u32 v28, v28, v34
    v_cmp_ne_u32 vcc, 0, v29
    s_cbranch_vccz L_kk5
    s_lshl_b32 s19, s17, 11
    s_add_u32 s19, s19, 4464640
    buffer_load_dwordx4 v[28:31], v3, s[32:35], s19 offen offset:0 sc1
    buffer_load_dwordx4 v[32:35], v3, s[32:35], s19 offen offset:1024 sc1
    s_waitcnt vmcnt(0)
    s_add_u32 s79, s79, 1
    s_cmp_lt_u32 s79, 32768
    s_cbranch_scc1 L_kp4
L_kk5:
    v_xor_b32 v72, s23, v80
    v_xor_b32 v73, s23, v81
    v_xor_b32 v74, s23, v82
    v_xor_b32 v75, s23, v83
    v_or3_b32 v72, v72, v73, v74
    v_or_b32 v72, v72, v75
    v_and_b32 v72, 15, v72
    v_cmp_ne_u32 vcc, 0, v72
    s_lshl_b32 s19, s15, 1
    s_lshl_b32 s19, 3, s19
    s_or_b32 s3, vcc_lo, vcc_hi
    s_and_b32 s3, s3, s19
    s_cselect_b32 s3, 1, 0
    v_xor_b32 v72, s3, v37
    s_lshl_b64 exec, 1, s17
    ds_write_b32 v36, v72 offset:240
    s_mov_b64 exec, -1
    buffer_load_dwordx4 v[108:111], v15, s[48:51], s1 offen nt
    buffer_load_dwordx4 v[140:143], v15, s[52:55], s1 offen nt
    s_add_u32 s1, s1, 28672
    buffer_load_dwordx4 v[112:115], v15, s[48:51], s1 offen nt
    buffer_load_dwordx4 v[144:147], v15, s[52:55], s1 offen nt
    s_add_u32 s1, s1, 28672
    buffer_load_dwordx4 v[116:119], v15, s[48:51], s1 offen nt
    buffer_load_dwordx4 v[148:151], v15, s[52:55], s1 offen nt
    s_add_u32 s1, s1, 28672
    buffer_load_dwordx4 v[120:123], v15, s[48:51], s1 offen nt
    buffer_load_dwordx4 v[152:155], v15, s[52:55], s1 offen nt
    s_add_u32 s1, s1, 28672
    buffer_load_dwordx4 v[124:127], v15, s[48:51], s1 offen nt
    buffer_load_dwordx4 v[156:159], v15, s[52:55], s1 offen nt
    s_add_u32 s1, s1, 28672
L_fw6:
    ds_read_b32 v29, v13 offset:128
    s_waitcnt lgkmcnt(0)
    v_cmp_ne_u32 vcc, v29, v37
    s_cbranch_vccz L_fk7
    s_add_u32 s79, s79, 1
    s_cmp_lt_u32 s79, 32768
    s_cbranch_scc1 L_fw6
L_fk7:
    ds_max_u32 v13, v28 offset:16
    v_mov_b32 v26, 1
    s_mov_b64 exec, 1
    ds_add_u32 v13, v26 offset:0
    s_mov_b64 exec, -1
L_kc8:
    ds_read_b32 v26, v13 offset:0
    ds_read_b32 v27, v13 offset:16
    s_waitcnt lgkmcnt(0)
    v_readfirstlane_b32 s19, v26
    v_readfirstlane_b32 s71, v27
    s_nop 0
    s_cmp_ge_u32 s19, 4
    s_cbranch_scc1 L_kd9
    s_add_u32 s79, s79, 1
    s_cmp_lt_u32 s79, 32768
    s_cbranch_scc1 L_kc8
L_kd9:
    s_lshr_b32 s71, s71, 4
    s_and_b32 s72, s71, 2047
    s_sub_u32 s72, 2047, s72
    s_lshl_b32 s19, s72, 11
    s_lshl_b32 s3, s0, 1
    s_add_u32 s19, s19, s3
    v_lshlrev_b32 v26, 3, v20
    v_lshl_add_u32 v26, v9, 1, v26
    buffer_load_ushort v27, v26, s[24:27], s19 offen
    s_lshl_b32 s19, s68, 16
    s_add_u32 s19, s19, s69
    buffer_load_dwordx4 v[192:195], v17, s[60:63], s19 offen
    s_add_u32 s68, s68, 1
    s_and_b32 s68, s68, 31
    s_lshl_b32 s19, s68, 16
    s_add_u32 s19, s19, s69
    buffer_load_dwordx4 v[196:199], v17, s[60:63], s19 offen
    s_add_u32 s68, s68, 1
    s_and_b32 s68, s68, 31
    s_lshl_b32 s19, s68, 16
    s_add_u32 s19, s19, s69
    buffer_load_dwordx4 v[200:203], v17, s[60:63], s19 offen
    s_add_u32 s68, s68, 1
    s_and_b32 s68, s68, 31
    s_lshl_b32 s19, s68, 16
    s_add_u32 s19, s19, s69
    buffer_load_dwordx4 v[204:207], v17, s[60:63], s19 offen
    s_add_u32 s68, s68, 1
    s_and_b32 s68, s68, 31
    s_lshl_b32 s19, s68, 16
    s_add_u32 s19, s19, s69
    buffer_load_dwordx4 v[208:211], v17, s[60:63], s19 offen
    s_add_u32 s68, s68, 1
    s_and_b32 s68, s68, 31
    s_lshl_b32 s19, s68, 16
    s_add_u32 s19, s19, s69
    buffer_load_dwordx4 v[212:215], v17, s[60:63], s19 offen
    s_add_u32 s68, s68, 1
    s_and_b32 s68, s68, 31
    s_lshl_b32 s19, s68, 16
    s_add_u32 s19, s19, s69
    buffer_load_dwordx4 v[216:219], v17, s[60:63], s19 offen
    s_add_u32 s68, s68, 1
    s_and_b32 s68, s68, 31
    s_lshl_b32 s19, s68, 16
    s_add_u32 s19, s19, s69
    buffer_load_dwordx4 v[220:223], v17, s[60:63], s19 offen
    s_add_u32 s68, s68, 1
    s_and_b32 s68, s68, 31
    s_lshl_b32 s19, s68, 16
    s_add_u32 s19, s19, s69
    buffer_load_dwordx4 v[224:227], v17, s[60:63], s19 offen
    s_add_u32 s68, s68, 1
    s_and_b32 s68, s68, 31
    s_lshl_b32 s19, s68, 16
    s_add_u32 s19, s19, s69
    buffer_load_dwordx4 v[228:231], v17, s[60:63], s19 offen
    s_add_u32 s68, s68, 1
    s_and_b32 s68, s68, 31
    s_lshl_b32 s19, s68, 16
    s_add_u32 s19, s19, s69
    buffer_load_dwordx4 v[232:235], v17, s[60:63], s19 offen
    s_add_u32 s68, s68, 1
    s_and_b32 s68, s68, 31
    s_lshl_b32 s19, s68, 16
    s_add_u32 s19, s19, s69
    buffer_load_dwordx4 v[236:239], v17, s[60:63], s19 offen
    s_add_u32 s68, s68, 1
    s_and_b32 s68, s68, 31
    s_lshl_b32 s19, s68, 16
    s_add_u32 s19, s19, s69
    buffer_load_dwordx4 v[240:243], v17, s[60:63], s19 offen
    s_add_u32 s68, s68, 1
    s_and_b32 s68, s68, 31
    s_lshl_b32 s19, s68, 16
    s_add_u32 s19, s19, s69
    buffer_load_dwordx4 v[244:247], v17, s[60:63], s19 offen
    s_add_u32 s68, s68, 1
    s_and_b32 s68, s68, 31
    s_lshl_b32 s19, s68, 16
    s_add_u32 s19, s19, s69
    buffer_load_dwordx4 v[248:251], v17, s[60:63], s19 offen
    s_add_u32 s68, s68, 1
    s_and_b32 s68, s68, 31
    s_lshl_b32 s19, s68, 16
    s_add_u32 s19, s19, s69
    buffer_load_dwordx4 v[252:255], v17, s[60:63], s19 offen
    s_add_u32 s68, s68, 1
    s_and_b32 s68, s68, 31
    s_lshl_b32 s19, s68, 16
    s_add_u32 s19, s19, s69
    buffer_load_dwordx4 v[40:43], v17, s[60:63], s19 offen
    s_add_u32 s68, s68, 1
    s_and_b32 s68, s68, 31
    s_lshl_b32 s19, s68, 16
    s_add_u32 s19, s19, s69
    buffer_load_dwordx4 v[44:47], v17, s[60:63], s19 offen
    s_add_u32 s68, s68, 1
    s_and_b32 s68, s68, 31
    s_lshl_b32 s19, s68, 16
    s_add_u32 s19, s19, s69
    buffer_load_dwordx4 v[48:51], v17, s[60:63], s19 offen
    s_add_u32 s68, s68, 1
    s_and_b32 s68, s68, 31
    s_lshl_b32 s19, s68, 16
    s_add_u32 s19, s19, s69
    buffer_load_dwordx4 v[52:55], v17, s[60:63], s19 offen
    s_add_u32 s68, s68, 1
    s_and_b32 s68, s68, 31
    s_lshl_b32 s19, s68, 16
    s_add_u32 s19, s19, s69
    buffer_load_dwordx4 v[56:59], v17, s[60:63], s19 offen
    s_add_u32 s68, s68, 1
    s_and_b32 s68, s68, 31
    s_lshl_b32 s19, s68, 16
    s_add_u32 s19, s19, s69
    buffer_load_dwordx4 v[60:63], v17, s[60:63], s19 offen
    s_add_u32 s68, s68, 1
    s_and_b32 s68, s68, 31
    s_lshl_b32 s19, s68, 16
    s_add_u32 s19, s19, s69
    buffer_load_dwordx4 v[64:67], v17, s[60:63], s19 offen
    s_add_u32 s68, s68, 1
    s_and_b32 s68, s68, 31
    s_lshl_b32 s19, s68, 16
    s_add_u32 s19, s19, s69
    buffer_load_dwordx4 v[68:71], v17, s[60:63], s19 offen
    s_add_u32 s68, s68, 1
    s_and_b32 s68, s68, 31
    s_lshl_b32 s19, s68, 16
    s_add_u32 s19, s19, s69
    buffer_load_dwordx4 v[160:163], v17, s[60:63], s19 offen
    s_add_u32 s68, s68, 1
    s_and_b32 s68, s68, 31
    s_lshl_b32 s19, s68, 16
    s_add_u32 s19, s19, s69
    buffer_load_dwordx4 v[164:167], v17, s[60:63], s19 offen
    s_add_u32 s68, s68, 1
    s_and_b32 s68, s68, 31
    s_lshl_b32 s19, s68, 16
    s_add_u32 s19, s19, s69
    buffer_load_dwordx4 v[168:171], v17, s[60:63], s19 offen
    s_add_u32 s68, s68, 1
    s_and_b32 s68, s68, 31
    s_lshl_b32 s19, s68, 16
    s_add_u32 s19, s19, s69
    buffer_load_dwordx4 v[172:175], v17, s[60:63], s19 offen
    s_add_u32 s68, s68, 1
    s_and_b32 s68, s68, 31
    s_lshl_b32 s19, s68, 16
    s_add_u32 s19, s19, s69
    buffer_load_dwordx4 v[176:179], v17, s[60:63], s19 offen
    s_add_u32 s68, s68, 1
    s_and_b32 s68, s68, 31
    s_lshl_b32 s19, s68, 16
    s_add_u32 s19, s19, s69
    buffer_load_dwordx4 v[180:183], v17, s[60:63], s19 offen
    s_add_u32 s68, s68, 1
    s_and_b32 s68, s68, 31
    s_lshl_b32 s19, s68, 16
    s_add_u32 s19, s19, s69
    buffer_load_dwordx4 v[184:187], v17, s[60:63], s19 offen
    s_add_u32 s68, s68, 1
    s_and_b32 s68, s68, 31
    s_lshl_b32 s19, s68, 16
    s_add_u32 s19, s19, s69
    buffer_load_dwordx4 v[188:191], v17, s[60:63], s19 offen
    s_add_u32 s68, s68, 1
    s_and_b32 s68, s68, 31
    s_waitcnt vmcnt(32)
    s_waitcnt vmcnt(33)
    v_lshl_or_b32 v27, v27, 16, v27
    s_lshl_b32 s19, s17, 10
    s_add_u32 s19, s19, 26624
    v_and_b32_dpp v72, v27, v4 row_newbcast:0 row_mask:0xf bank_mask:0xf
    v_and_b32_dpp v73, v27, v5 row_newbcast:0 row_mask:0xf bank_mask:0xf
    v_and_b32_dpp v74, v27, v6 row_newbcast:0 row_mask:0xf bank_mask:0xf
    v_and_b32_dpp v75, v27, v7 row_newbcast:0 row_mask:0xf bank_mask:0xf
    v_and_b32_dpp v76, v27, v4 row_newbcast:1 row_mask:0xf bank_mask:0xf
    v_and_b32_dpp v77, v27, v5 row_newbcast:1 row_mask:0xf bank_mask:0xf
    v_mfma_f32_16x16x32_bf16 v[88:91], v[72:75], v[96:99], 0
    v_and_b32_dpp v78, v27, v6 row_newbcast:1 row_mask:0xf bank_mask:0xf
    v_and_b32_dpp v79, v27, v7 row_newbcast:1 row_mask:0xf bank_mask:0xf
    v_mfma_f32_16x16x32_bf16 v[92:95], v[72:75], v[128:131], 0
    v_and_b32_dpp v80, v27, v4 row_newbcast:2 row_mask:0xf bank_mask:0xf
    v_and_b32_dpp v81, v27, v5 row_newbcast:2 row_mask:0xf bank_mask:0xf
    v_mfma_f32_16x16x32_bf16 v[88:91], v[76:79], v[100:103], v[88:91]
    v_and_b32_dpp v82, v27, v6 row_newbcast:2 row_mask:0xf bank_mask:0xf
    v_and_b32_dpp v83, v27, v7 row_newbcast:2 row_mask:0xf bank_mask:0xf
    v_mfma_f32_16x16x32_bf16 v[92:95], v[76:79], v[132:135], v[92:95]
    v_and_b32_dpp v84, v27, v4 row_newbcast:3 row_mask:0xf bank_mask:0xf
    v_and_b32_dpp v85, v27, v5 row_newbcast:3 row_mask:0xf bank_mask:0xf
    v_mfma_f32_16x16x32_bf16 v[88:91], v[80:83], v[104:107], v[88:91]
    v_and_b32_dpp v86, v27, v6 row_newbcast:3 row_mask:0xf bank_mask:0xf
    v_and_b32_dpp v87, v27, v7 row_newbcast:3 row_mask:0xf bank_mask:0xf
    v_mfma_f32_16x16x32_bf16 v[92:95], v[80:83], v[136:139], v[92:95]
    v_and_b32_dpp v72, v27, v4 row_newbcast:4 row_mask:0xf bank_mask:0xf
    v_and_b32_dpp v73, v27, v5 row_newbcast:4 row_mask:0xf bank_mask:0xf
    v_mfma_f32_16x16x32_bf16 v[88:91], v[84:87], v[108:111], v[88:91]
    v_and_b32_dpp v74, v27, v6 row_newbcast:4 row_mask:0xf bank_mask:0xf
    v_and_b32_dpp v75, v27, v7 row_newbcast:4 row_mask:0xf bank_mask:0xf
    v_mfma_f32_16x16x32_bf16 v[92:95], v[84:87], v[140:143], v[92:95]
    v_and_b32_dpp v76, v27, v4 row_newbcast:5 row_mask:0xf bank_mask:0xf
    v_and_b32_dpp v77, v27, v5 row_newbcast:5 row_mask:0xf bank_mask:0xf
    v_mfma_f32_16x16x32_bf16 v[88:91], v[72:75], v[112:115], v[88:91]
    v_and_b32_dpp v78, v27, v6 row_newbcast:5 row_mask:0xf bank_mask:0xf
    v_and_b32_dpp v79, v27, v7 row_newbcast:5 row_mask:0xf bank_mask:0xf
    v_mfma_f32_16x16x32_bf16 v[92:95], v[72:75], v[144:147], v[92:95]
    v_and_b32_dpp v80, v27, v4 row_newbcast:6 row_mask:0xf bank_mask:0xf
    v_and_b32_dpp v81, v27, v5 row_newbcast:6 row_mask:0xf bank_mask:0xf
    v_mfma_f32_16x16x32_bf16 v[88:91], v[76:79], v[116:119], v[88:91]
    v_and_b32_dpp v82, v27, v6 row_newbcast:6 row_mask:0xf bank_mask:0xf
    v_and_b32_dpp v83, v27, v7 row_newbcast:6 row_mask:0xf bank_mask:0xf
    v_mfma_f32_16x16x32_bf16 v[92:95], v[76:79], v[148:151], v[92:95]
    v_and_b32_dpp v84, v27, v4 row_newbcast:7 row_mask:0xf bank_mask:0xf
    v_and_b32_dpp v85, v27, v5 row_newbcast:7 row_mask:0xf bank_mask:0xf
    v_mfma_f32_16x16x32_bf16 v[88:91], v[80:83], v[120:123], v[88:91]
    v_and_b32_dpp v86, v27, v6 row_newbcast:7 row_mask:0xf bank_mask:0xf
    v_and_b32_dpp v87, v27, v7 row_newbcast:7 row_mask:0xf bank_mask:0xf
    v_mfma_f32_16x16x32_bf16 v[92:95], v[80:83], v[152:155], v[92:95]
    v_add_u32 v26, s19, v3
    v_mov_b32 v28, 1
    v_mfma_f32_16x16x32_bf16 v[88:91], v[84:87], v[124:127], v[88:91]
    v_mfma_f32_16x16x32_bf16 v[92:95], v[84:87], v[156:159], v[92:95]
    s_nop 7
    v_permlane32_swap_b32 v88, v92
    v_permlane32_swap_b32 v89, v93
    v_permlane32_swap_b32 v90, v94
    v_permlane32_swap_b32 v91, v95
    ds_write_b128 v26, v[88:91]
    s_mov_b64 exec, 1
    ds_add_rtn_u32 v29, v13, v28 offset:32
    s_mov_b64 exec, -1
    s_waitcnt lgkmcnt(0)
    v_readfirstlane_b32 s19, v29
    s_nop 1
    s_cmp_lg_u32 s19, 3
    s_cbranch_scc1 L_gs10
    ds_read_b128 v[72:75], v3 offset:26624
    ds_read_b128 v[76:79], v3 offset:27648
    ds_read_b128 v[80:83], v3 offset:28672
    ds_read_b128 v[84:87], v3 offset:29696
    s_waitcnt lgkmcnt(0)
    v_pk_add_f32 v[72:73], v[72:73], v[76:77]
    v_pk_add_f32 v[74:75], v[74:75], v[78:79]
    v_pk_add_f32 v[80:81], v[80:81], v[84:85]
    v_pk_add_f32 v[82:83], v[82:83], v[86:87]
    v_pk_add_f32 v[72:73], v[72:73], v[80:81]
    v_pk_add_f32 v[74:75], v[74:75], v[82:83]
    v_bfi_b32 v72, v23, s80, v72
    v_bfi_b32 v73, v23, s81, v73
    v_bfi_b32 v74, v23, s82, v74
    v_bfi_b32 v75, v23, s83, v75
    s_cmp_ge_u32 s2, 224
    s_cbranch_scc1 L_gs10
    v_lshrrev_b32 v26, 5, v2
    v_mul_u32_u24 v26, 14336, v26
    v_lshl_add_u32 v26, v8, 5, v26
    v_and_b32 v29, 1, v9
    v_lshl_add_u32 v26, v29, 4, v26
    s_mul_i32 s19, s12, 28672
    s_lshl_b32 s3, s13, 9
    s_add_u32 s19, s19, s3
    s_add_u32 s19, s19, 4489216
    buffer_store_dwordx4 v[72:75], v26, s[32:35], s19 offen sc1
L_gs10:
    s_waitcnt vmcnt(24)
L_fw11:
    ds_read_b32 v29, v36 offset:144
    s_waitcnt lgkmcnt(0)
    v_cmp_ne_u32 vcc, v29, v37
    s_cbranch_vccz L_fk12
    s_add_u32 s79, s79, 1
    s_cmp_lt_u32 s79, 32768
    s_cbranch_scc1 L_fw11
L_fk12:
    ds_write_b128 v18, v[192:195] offset:0
    ds_write_b128 v18, v[196:199] offset:4096
    ds_write_b128 v18, v[200:203] offset:8192
    ds_write_b128 v18, v[204:207] offset:12288
    ds_write_b128 v18, v[208:211] offset:16384
    ds_write_b128 v18, v[212:215] offset:20480
    ds_write_b128 v18, v[216:219] offset:24576
    ds_write_b128 v18, v[220:223] offset:28672
    s_waitcnt vmcnt(16)
    ds_write_b128 v18, v[224:227] offset:32768
    ds_write_b128 v18, v[228:231] offset:36864
    ds_write_b128 v18, v[232:235] offset:40960
    ds_write_b128 v18, v[236:239] offset:45056
    ds_write_b128 v18, v[240:243] offset:49152
    ds_write_b128 v18, v[244:247] offset:53248
    ds_write_b128 v18, v[248:251] offset:57344
    ds_write_b128 v18, v[252:255] offset:61440
    v_min_u32 v26, 6, v20
    v_mul_u32_u24 v27, 28672, v19
    v_lshl_add_u32 v26, v26, 4, v27
    s_lshl_b32 s75, s73, 2
    s_add_u32 s75, s75, 4489216
    s_add_u32 s76, s75, 14336
    s_waitcnt vmcnt(8)
L_fw13:
    ds_read_b32 v29, v36 offset:160
    s_waitcnt lgkmcnt(0)
    v_cmp_ne_u32 vcc, v29, v37
    s_cbranch_vccz L_fk14
    s_add_u32 s79, s79, 1
    s_cmp_lt_u32 s79, 32768
    s_cbranch_scc1 L_fw13
L_fk14:
    ds_write_b128 v22, v[40:43] offset:0
    ds_write_b128 v22, v[44:47] offset:4096
    ds_write_b128 v22, v[48:51] offset:8192
    ds_write_b128 v22, v[52:55] offset:12288
    ds_write_b128 v22, v[56:59] offset:16384
    ds_write_b128 v22, v[60:63] offset:20480
    ds_write_b128 v22, v[64:67] offset:24576
    ds_write_b128 v22, v[68:71] offset:28672
    s_waitcnt vmcnt(0)
    ds_write_b128 v22, v[160:163] offset:32768
    ds_write_b128 v22, v[164:167] offset:36864
    ds_write_b128 v22, v[168:171] offset:40960
    ds_write_b128 v22, v[172:175] offset:45056
    ds_write_b128 v22, v[176:179] offset:49152
    ds_write_b128 v22, v[180:183] offset:53248
    ds_write_b128 v22, v[184:187] offset:57344
    ds_write_b128 v22, v[188:191] offset:61440
    s_lshl_b64 exec, 1, s17
    ds_write_b32 v36, v37 offset:208
    s_mov_b64 exec, -1
L_fw15:
    ds_read_b32 v29, v36 offset:192
    s_waitcnt lgkmcnt(0)
    v_cmp_ne_u32 vcc, v29, v37
    s_cbranch_vccz L_fk16
    s_add_u32 s79, s79, 1
    s_cmp_lt_u32 s79, 32768
    s_cbranch_scc1 L_fw15
L_fk16:
    buffer_load_dwordx4 v[96:99], v16, s[56:59], s74 offen nt
    s_add_u32 s74, s74, 8192
    buffer_load_dwordx4 v[100:103], v16, s[56:59], s74 offen nt
    s_add_u32 s74, s74, 8192
    buffer_load_dwordx4 v[104:107], v16, s[56:59], s74 offen nt
    s_add_u32 s74, s74, 8192
    buffer_load_dwordx4 v[108:111], v16, s[56:59], s74 offen nt
    s_add_u32 s74, s74, 8192
    buffer_load_dwordx4 v[112:115], v16, s[56:59], s74 offen nt
    s_add_u32 s74, s74, 8192
    buffer_load_dwordx4 v[116:119], v16, s[56:59], s74 offen nt
    s_add_u32 s74, s74, 8192
    buffer_load_dwordx4 v[120:123], v16, s[56:59], s74 offen nt
    s_add_u32 s74, s74, 8192
L_cw17:
    ds_read_b32 v29, v13 offset:64
    s_waitcnt lgkmcnt(0)
    v_cmp_gt_u32 vcc, 1, v29
    s_cbranch_vccz L_ck18
    s_add_u32 s79, s79, 1
    s_cmp_lt_u32 s79, 32768
    s_cbranch_scc1 L_cw17
L_ck18:
    buffer_load_dwordx4 v[72:75], v26, s[32:35], s75 offen sc1
    buffer_load_dwordx4 v[76:79], v26, s[32:35], s76 offen sc1
    s_waitcnt vmcnt(0)
L_gp19:
    v_xor_b32 v72, s80, v72
    v_xor_b32 v73, s81, v73
    v_xor_b32 v74, s82, v74
    v_xor_b32 v75, s83, v75
    v_xor_b32 v76, s80, v76
    v_xor_b32 v77, s81, v77
    v_xor_b32 v78, s82, v78
    v_xor_b32 v79, s83, v79
    v_or3_b32 v80, v72, v73, v74
    v_or3_b32 v81, v75, v76, v77
    v_or3_b32 v80, v80, v78, v79
    v_or_b32 v80, v80, v81
    v_and_b32 v80, v80, v23
    v_cmp_ne_u32 vcc, 0, v80
    s_cbranch_vccz L_gk20
    buffer_load_dwordx4 v[72:75], v26, s[32:35], s75 offen sc1
    buffer_load_dwordx4 v[76:79], v26, s[32:35], s76 offen sc1
    s_waitcnt vmcnt(0)
    s_add_u32 s79, s79, 1
    s_cmp_lt_u32 s79, 32768
    s_cbranch_scc1 L_gp19
L_gk20:
    s_waitcnt vmcnt(2)
    v_permlane32_swap_b32 v72, v74
    v_permlane32_swap_b32 v73, v75
    v_permlane32_swap_b32 v76, v78
    v_permlane32_swap_b32 v77, v79
    v_add_f32 v72, v72, v74
    v_add_f32 v73, v73, v75
    v_add_f32 v76, v76, v78
    v_add_f32 v77, v77, v79
    v_permlane16_swap_b32 v72, v73
    s_lshl_b32 s19, s17, 9
    v_permlane16_swap_b32 v76, v77
    v_add_f32 v72, v72, v73
    v_add_f32 v76, v76, v77
    s_add_u32 s19, s19, 30720
    v_add_f32_dpp v72, v72, v72 row_ror:8 row_mask:0xf bank_mask:0xf
    v_add_f32_dpp v76, v76, v76 row_ror:8 row_mask:0xf bank_mask:0xf
    v_add_u32 v26, s19, v3
    v_cvt_pk_bf16_f32 v72, v72, v76
    v_and_b32 v76, 0xffff0000, v72
    v_lshlrev_b32 v72, 16, v72
    v_mul_f32 v73, 0xbfb8aa3b, v72
    v_exp_f32 v73, v73
    s_nop 0
    v_add_f32 v73, 1.0, v73
    v_rcp_f32 v73, v73
    s_nop 0
    v_mul_f32 v73, v73, v72
    v_cvt_pk_bf16_f32 v73, v73, v73
    v_lshlrev_b32 v73, 16, v73
    v_mul_f32 v73, v73, v76
    v_cvt_pk_bf16_f32 v27, v73, v73
    s_nop 1
    v_and_b32_dpp v76, v27, v4 row_newbcast:0 row_mask:0xf bank_mask:0xf
    v_and_b32_dpp v77, v27, v5 row_newbcast:0 row_mask:0xf bank_mask:0xf
    v_and_b32_dpp v78, v27, v6 row_newbcast:0 row_mask:0xf bank_mask:0xf
    v_and_b32_dpp v79, v27, v7 row_newbcast:0 row_mask:0xf bank_mask:0xf
    v_and_b32_dpp v80, v27, v4 row_newbcast:1 row_mask:0xf bank_mask:0xf
    v_and_b32_dpp v81, v27, v5 row_newbcast:1 row_mask:0xf bank_mask:0xf
    v_mfma_f32_16x16x32_bf16 v[88:91], v[76:79], v[96:99], 0
    v_and_b32_dpp v82, v27, v6 row_newbcast:1 row_mask:0xf bank_mask:0xf
    v_and_b32_dpp v83, v27, v7 row_newbcast:1 row_mask:0xf bank_mask:0xf
    v_and_b32_dpp v84, v27, v4 row_newbcast:2 row_mask:0xf bank_mask:0xf
    v_and_b32_dpp v85, v27, v5 row_newbcast:2 row_mask:0xf bank_mask:0xf
    v_mfma_f32_16x16x32_bf16 v[88:91], v[80:83], v[100:103], v[88:91]
    v_and_b32_dpp v86, v27, v6 row_newbcast:2 row_mask:0xf bank_mask:0xf
    v_and_b32_dpp v87, v27, v7 row_newbcast:2 row_mask:0xf bank_mask:0xf
    v_and_b32_dpp v92, v27, v4 row_newbcast:3 row_mask:0xf bank_mask:0xf
    v_and_b32_dpp v93, v27, v5 row_newbcast:3 row_mask:0xf bank_mask:0xf
    v_mfma_f32_16x16x32_bf16 v[88:91], v[84:87], v[104:107], v[88:91]
    v_and_b32_dpp v94, v27, v6 row_newbcast:3 row_mask:0xf bank_mask:0xf
    v_and_b32_dpp v95, v27, v7 row_newbcast:3 row_mask:0xf bank_mask:0xf
    v_and_b32_dpp v76, v27, v4 row_newbcast:4 row_mask:0xf bank_mask:0xf
    v_and_b32_dpp v77, v27, v5 row_newbcast:4 row_mask:0xf bank_mask:0xf
    v_mfma_f32_16x16x32_bf16 v[88:91], v[92:95], v[108:111], v[88:91]
    v_and_b32_dpp v78, v27, v6 row_newbcast:4 row_mask:0xf bank_mask:0xf
    v_and_b32_dpp v79, v27, v7 row_newbcast:4 row_mask:0xf bank_mask:0xf
    v_and_b32_dpp v80, v27, v4 row_newbcast:5 row_mask:0xf bank_mask:0xf
    v_and_b32_dpp v81, v27, v5 row_newbcast:5 row_mask:0xf bank_mask:0xf
    v_mfma_f32_16x16x32_bf16 v[88:91], v[76:79], v[112:115], v[88:91]
    v_and_b32_dpp v82, v27, v6 row_newbcast:5 row_mask:0xf bank_mask:0xf
    v_and_b32_dpp v83, v27, v7 row_newbcast:5 row_mask:0xf bank_mask:0xf
    v_and_b32_dpp v84, v27, v4 row_newbcast:6 row_mask:0xf bank_mask:0xf
    v_and_b32_dpp v85, v27, v5 row_newbcast:6 row_mask:0xf bank_mask:0xf
    v_mfma_f32_16x16x32_bf16 v[88:91], v[80:83], v[116:119], v[88:91]
    v_and_b32_dpp v86, v27, v6 row_newbcast:6 row_mask:0xf bank_mask:0xf
    v_and_b32_dpp v87, v27, v7 row_newbcast:6 row_mask:0xf bank_mask:0xf
    s_nop 1
    v_mfma_f32_16x16x32_bf16 v[88:91], v[84:87], v[120:123], v[88:91]
    s_mov_b32 exec_hi, 0
    s_nop 6
    ds_write_b128 v26, v[88:91]
    s_mov_b64 exec, 1
    ds_add_rtn_u32 v29, v13, v28 offset:48
    s_mov_b64 exec, -1
    s_waitcnt lgkmcnt(0)
    v_readfirstlane_b32 s19, v29
    s_nop 1
    s_cmp_lg_u32 s19, 3
    s_cbranch_scc1 L_ys21
    ds_read_b128 v[72:75], v3 offset:30720
    ds_read_b128 v[76:79], v3 offset:31232
    ds_read_b128 v[80:83], v3 offset:31744
    ds_read_b128 v[84:87], v3 offset:32256
    s_waitcnt lgkmcnt(0)
    v_pk_add_f32 v[72:73], v[72:73], v[76:77]
    v_pk_add_f32 v[74:75], v[74:75], v[78:79]
    v_pk_add_f32 v[80:81], v[80:81], v[84:85]
    v_pk_add_f32 v[82:83], v[82:83], v[86:87]
    v_pk_add_f32 v[72:73], v[72:73], v[80:81]
    v_pk_add_f32 v[74:75], v[74:75], v[82:83]
    v_bfi_b32 v72, v23, s80, v72
    v_bfi_b32 v73, v23, s81, v73
    v_bfi_b32 v74, v23, s82, v74
    v_bfi_b32 v75, v23, s83, v75
    v_lshlrev_b32 v26, 5, v8
    v_lshl_add_u32 v26, v9, 4, v26
    s_lshl_b32 s19, s13, 12
    s_lshl_b32 s3, s12, 9
    s_add_u32 s19, s19, s3
    s_add_u32 s19, s19, 4718592
    s_mov_b32 exec_hi, 0
    buffer_store_dwordx4 v[72:75], v26, s[32:35], s19 offen sc1
    s_mov_b64 exec, -1
L_ys21:
    s_and_b32 s19, s12, 1
    s_lshl_b32 s19, s19, 1
    s_bfe_u32 s3, s12, 0x10001
    s_add_u32 s19, s19, s3
    s_lshl_b32 s19, s19, 2
    s_and_b32 s3, s13, 3
    s_add_u32 s19, s19, s3
    s_lshr_b32 s3, s72, 7
    s_xor_b32 s19, s19, s3
    s_or_b32 s19, s19, s17
    s_cmp_lg_u32 s19, 0
    s_cbranch_scc1 L_ldone
    v_lshlrev_b32 v26, 12, v9
    v_lshl_add_u32 v26, v8, 4, v26
    v_lshl_add_u32 v29, v8, 2, v9
    v_lshlrev_b32 v30, 1, v29
    v_lshlrev_b32 v29, 2, v29
    s_lshl_b32 s75, s67, 8
    s_add_u32 s75, s75, 4718592
    s_lshl_b32 s19, s72, 11
    s_lshl_b32 s3, s67, 7
    s_add_u32 s19, s19, s3
    s_lshr_b32 s76, s72, 1
    s_lshl_b32 s76, s76, 3
    s_add_u32 s76, s76, 4472832
    buffer_load_ushort v31, v30, s[24:27], s19 offen
L_yp22:
    buffer_load_dwordx2 v[32:33], v13, s[32:35], s76 offen sc1
    s_mov_b32 s19, s75
    buffer_load_dwordx4 v[100:103], v26, s[32:35], s19 offen sc1
    s_add_u32 s19, s19, 16384
    buffer_load_dwordx4 v[104:107], v26, s[32:35], s19 offen sc1
    s_add_u32 s19, s19, 16384
    buffer_load_dwordx4 v[108:111], v26, s[32:35], s19 offen sc1
    s_add_u32 s19, s19, 16384
    buffer_load_dwordx4 v[112:115], v26, s[32:35], s19 offen sc1
    s_add_u32 s19, s19, 16384
    buffer_load_dwordx4 v[116:119], v26, s[32:35], s19 offen sc1
    s_add_u32 s19, s19, 16384
    buffer_load_dwordx4 v[120:123], v26, s[32:35], s19 offen sc1
    s_add_u32 s19, s19, 16384
    buffer_load_dwordx4 v[124:127], v26, s[32:35], s19 offen sc1
    s_add_u32 s19, s19, 16384
    buffer_load_dwordx4 v[128:131], v26, s[32:35], s19 offen sc1
    s_add_u32 s19, s19, 16384
    s_waitcnt vmcnt(0)
    v_xor_b32 v33, s78, v33
    v_xor_b32 v100, s80, v100
    v_xor_b32 v101, s81, v101
    v_xor_b32 v102, s82, v102
    v_xor_b32 v103, s83, v103
    v_xor_b32 v104, s80, v104
    v_xor_b32 v105, s81, v105
    v_xor_b32 v106, s82, v106
    v_xor_b32 v107, s83, v107
    v_xor_b32 v108, s80, v108
    v_xor_b32 v109, s81, v109
    v_xor_b32 v110, s82, v110
    v_xor_b32 v111, s83, v111
    v_xor_b32 v112, s80, v112
    v_xor_b32 v113, s81, v113
    v_xor_b32 v114, s82, v114
    v_xor_b32 v115, s83, v115
    v_xor_b32 v116, s80, v116
    v_xor_b32 v117, s81, v117
    v_xor_b32 v118, s82, v118
    v_xor_b32 v119, s83, v119
    v_xor_b32 v120, s80, v120
    v_xor_b32 v121, s81, v121
    v_xor_b32 v122, s82, v122
    v_xor_b32 v123, s83, v123
    v_xor_b32 v124, s80, v124
    v_xor_b32 v125, s81, v125
    v_xor_b32 v126, s82, v126
    v_xor_b32 v127, s83, v127
    v_xor_b32 v128, s80, v128
    v_xor_b32 v129, s81, v129
    v_xor_b32 v130, s82, v130
    v_xor_b32 v131, s83, v131
    v_or_b32 v34, v100, v101
    v_or3_b32 v34, v34, v102, v103
    v_or3_b32 v34, v34, v104, v105
    v_or3_b32 v34, v34, v106, v107
    v_or3_b32 v34, v34, v108, v109
    v_or3_b32 v34, v34, v110, v111
    v_or3_b32 v34, v34, v112, v113
    v_or3_b32 v34, v34, v114, v115
    v_or3_b32 v34, v34, v116, v117
    v_or3_b32 v34, v34, v118, v119
    v_or3_b32 v34, v34, v120, v121
    v_or3_b32 v34, v34, v122, v123
    v_or3_b32 v34, v34, v124, v125
    v_or3_b32 v34, v34, v126, v127
    v_or3_b32 v34, v34, v128, v129
    v_or3_b32 v34, v34, v130, v131
    v_and_b32 v34, v34, v23
    v_or_b32 v34, v34, v33
    v_cmp_ne_u32 vcc, 0, v34
    s_cbranch_vccz L_yk23
    s_add_u32 s79, s79, 1
    s_cmp_lt_u32 s79, 32768
    s_cbranch_scc1 L_yp22
L_yk23:
    v_pk_add_f32 v[100:101], v[100:101], v[116:117]
    v_pk_add_f32 v[102:103], v[102:103], v[118:119]
    v_pk_add_f32 v[104:105], v[104:105], v[120:121]
    v_pk_add_f32 v[106:107], v[106:107], v[122:123]
    v_pk_add_f32 v[108:109], v[108:109], v[124:125]
    v_pk_add_f32 v[110:111], v[110:111], v[126:127]
    v_pk_add_f32 v[112:113], v[112:113], v[128:129]
    v_pk_add_f32 v[114:115], v[114:115], v[130:131]
    v_pk_add_f32 v[100:101], v[100:101], v[108:109]
    v_pk_add_f32 v[102:103], v[102:103], v[110:111]
    v_pk_add_f32 v[104:105], v[104:105], v[112:113]
    v_pk_add_f32 v[106:107], v[106:107], v[114:115]
    v_pk_add_f32 v[100:101], v[100:101], v[104:105]
    v_pk_add_f32 v[102:103], v[102:103], v[106:107]
    s_nop 1
    v_permlane32_swap_b32 v100, v102
    v_permlane32_swap_b32 v101, v103
    v_add_f32 v100, v100, v102
    v_add_f32 v101, v101, v103
    s_nop 1
    v_permlane16_swap_b32 v100, v101
    v_add_f32 v100, v100, v101
    s_lshr_b32 s19, s71, 11
    s_lshl_b32 s19, s19, 16
    s_not_b32 s3, s19
    s_ashr_i32 s3, s3, 31
    s_or_b32 s3, s3, 0x80000000
    s_xor_b32 s19, s19, s3
    s_and_b32 s19, s19, 0xffff0000
    v_mov_b32 v34, s19
    v_mul_f32 v34, 0xbfb8aa3b, v34
    v_exp_f32 v34, v34
    s_nop 0
    v_add_f32 v34, 1.0, v34
    v_rcp_f32 v34, v34
    s_nop 0
    v_cvt_pk_bf16_f32 v34, v34, v100
    v_and_b32 v35, 0xffff0000, v34
    v_lshlrev_b32 v34, 16, v34
    v_mul_f32 v34, v34, v35
    v_cvt_pk_bf16_f32 v34, v34, v34
    v_lshlrev_b32 v34, 16, v34
    v_lshlrev_b32 v31, 16, v31
    v_add_f32 v34, v34, v31
    s_and_b32 s3, s72, 1
    s_lshl_b32 s3, s3, 4
    v_lshrrev_b32 v32, s3, v32
    v_lshlrev_b32 v32, 16, v32
    v_sub_f32 v32, 1.0, v32
    v_cvt_pk_bf16_f32 v34, v34, v32
    v_and_b32 v35, 0xffff0000, v34
    v_lshlrev_b32 v34, 16, v34
    v_mul_f32 v34, v34, v35
    v_cvt_pk_bf16_f32 v34, v34, v34
    v_lshlrev_b32 v34, 16, v34
    v_mov_b32 v28, 1
    ds_write_b32 v29, v34 offset:512
    ds_write_b32 v13, v37 offset:224
    s_waitcnt lgkmcnt(0)
L_ldone:
    s_endpgm
L_compute:
    s_mov_b64 s[32:33], s[98:99]
    s_mov_b32 s34, 16777216
    s_mov_b32 s35, 0x00020000
    s_mov_b64 s[36:37], s[96:97]
    s_mov_b32 s38, 256
    s_mov_b32 s39, 0x00020000
    s_mov_b64 s[40:41], s[8:9]
    s_mov_b32 s42, 65536
    s_mov_b32 s43, 0x00020000
    s_mov_b64 s[44:45], s[94:95]
    s_mov_b32 s46, 4194304
    s_mov_b32 s47, 0x00020000
    s_mov_b64 s[60:61], s[98:99]
    s_mov_b32 s62, 16777216
    s_mov_b32 s63, 0x00020000
    s_mov_b32 s79, 0
    s_lshr_b32 s17, s16, 1
    s_and_b32 s18, s16, 1
    v_mov_b32 v13, 0
    v_and_b32 v4, 15, v2
    v_lshrrev_b32 v9, 4, v2
    s_or_b32 s19, s2, s16
    s_cmp_lg_u32 s19, 0
    s_cbranch_scc1 L_tp24
    s_memrealtime s[20:21]
    s_waitcnt lgkmcnt(0)
    s_or_b32 s20, s20, 1
    v_mov_b32 v3, s20
    s_mov_b64 exec, 1
    buffer_store_dword v3, v13, s[36:39], 0 offen offset:4 sc1
    s_mov_b64 exec, -1
L_tp24:
    s_lshl_b32 s67, s15, 1
    s_add_u32 s67, s67, s18
    s_lshl_b32 s19, s67, 11
    v_lshlrev_b32 v5, 6, v4
    v_lshl_add_u32 v5, v9, 3, v5
    buffer_load_dwordx2 v[60:61], v5, s[40:43], s19 offen offset:0
    buffer_load_dwordx2 v[62:63], v5, s[40:43], s19 offen offset:32
    buffer_load_dwordx2 v[64:65], v5, s[40:43], s19 offen offset:1024
    buffer_load_dwordx2 v[66:67], v5, s[40:43], s19 offen offset:1056
    s_lshl_b32 s19, s17, 13
    v_lshlrev_b32 v6, 7, v4
    v_add_u32 v6, s19, v6
    v_bfe_u32 v7, v2, 1, 3
    v_add_u32 v8, 0, v9
    v_xor_b32 v8, v8, v7
    v_lshl_add_u32 v20, v8, 4, v6
    v_add_u32 v8, 4, v9
    v_xor_b32 v8, v8, v7
    v_lshl_add_u32 v21, v8, 4, v6
    v_add_u32 v22, 40960, v20
    v_add_u32 v23, 40960, v21
    v_add_u32 v24, 81920, v20
    v_add_u32 v25, 81920, v21
    v_add_u32 v26, 122880, v20
    v_add_u32 v27, 122880, v21
    v_lshlrev_b32 v6, 10, v9
    v_bfe_u32 v7, v2, 2, 2
    v_lshl_add_u32 v6, v7, 7, v6
    v_bfe_u32 v7, v2, 3, 1
    v_xor_b32 v7, s18, v7
    v_lshl_add_u32 v6, v7, 6, v6
    v_bfe_u32 v7, v2, 4, 1
    v_lshl_add_u32 v6, v7, 5, v6
    v_and_b32 v7, 3, v2
    v_lshl_add_u32 v6, v7, 3, v6
    v_add_u32 v36, 16384, v6
    v_xor_b32 v37, 32, v36
    v_add_u32 v38, 57344, v6
    v_xor_b32 v39, 32, v38
    v_add_u32 v40, 98304, v6
    v_xor_b32 v41, 32, v40
    v_add_u32 v42, 139264, v6
    v_xor_b32 v43, 32, v42
    v_lshrrev_b32 v5, 2, v4
    v_and_b32 v6, 1, v4
    v_lshlrev_b32 v6, 4, v6
    v_mov_b32 v7, 0x3f80
    v_lshlrev_b32 v7, v6, v7
    v_cmp_eq_u32 vcc, v5, v9
    s_nop 1
    v_cndmask_b32 v7, 0, v7, vcc
    v_and_b32 v6, 2, v4
    v_cmp_eq_u32 vcc, 0, v6
    s_nop 1
    v_cndmask_b32 v52, 0, v7, vcc
    v_cndmask_b32 v53, v7, v13, vcc
    v_mov_b32 v56, 0x3f803f80
    v_mov_b32 v57, 0x3f803f80
    v_mov_b32 v58, 0x3f803f80
    v_mov_b32 v59, 0x3f803f80
    v_lshlrev_b32 v3, 4, v2
    v_lshlrev_b32 v12, 4, v9
    v_lshrrev_b32 v11, 5, v2
    v_lshlrev_b32 v8, 9, v11
    v_and_b32 v19, 16, v12
    v_add_u32 v8, v8, v19
    v_lshlrev_b32 v11, 2, v11
    v_lshl_add_u32 v11, v4, 4, v11
    v_lshlrev_b32 v9, 10, v9
    v_lshl_add_u32 v9, v4, 4, v9
    v_lshlrev_b32 v10, 3, v2
    s_xor_b32 s3, s16, 2
    s_mul_i32 s19, s3, 6144
    s_add_u32 s19, s19, 2048
    v_add_u32 v4, s19, v3
    s_mul_i32 s19, s16, 6144
    s_add_u32 s19, s19, 2048
    v_add_u32 v5, s19, v3
    v_lshlrev_b32 v7, 2, v2
    s_lshl_b32 s19, s3, 8
    s_add_u32 s19, s19, 1024
    v_add_u32 v6, s19, v7
    s_lshl_b32 s19, s16, 8
    s_add_u32 s19, s19, 1024
    v_add_u32 v7, s19, v7
    v_mov_b32 v15, 0x3ff
    v_mov_b32 v18, 0x7fc17fc1
    s_lshl_b32 s19, s16, 2
    v_mov_b32 v1, s19
    v_mov_b32 v19, -1
    s_lshl_b32 s19, s15, 2
    s_lshr_b32 s3, s14, 2
    s_add_u32 s19, s19, s3
    s_and_b32 s3, s14, 1
    s_bfe_u32 s20, s14, 0x10001
    s_lshl_b32 s20, s20, 3
    s_lshl_b32 s64, s19, 1
    s_add_u32 s64, s64, s3
    s_lshl_b32 s64, s64, 2
    s_add_u32 s64, s64, s16
    s_lshl_b32 s64, s64, 8
    s_add_u32 s64, s64, s20
    s_add_u32 s64, s64, 4325376
    s_lshl_b32 s65, s19, 1
    s_add_u32 s65, s65, s3
    s_lshl_b32 s65, s65, 1
    s_add_u32 s65, s65, s17
    s_lshl_b32 s65, s65, 4
    s_add_u32 s65, s65, s20
    s_lshl_b32 s3, s18, 2
    s_add_u32 s65, s65, s3
    s_add_u32 s65, s65, 4456448
    s_mov_b32 s74, 0x3fb8aa3b
    s_mov_b32 s76, 0xbfb8aa3b
    s_mov_b32 s75, 0
    s_mov_b32 s77, 0
    s_mov_b32 s69, 0
    s_mov_b32 s71, 0
    s_cmp_lg_u32 s17, 0
    s_cselect_b32 s68, s74, s76
    s_cselect_b32 s70, s76, s74
    s_cselect_b64 s[72:73], -1, 0
    s_mov_b32 s66, 0
    s_lshl_b32 s19, s15, 4
    s_lshl_b32 s3, s18, 3
    s_add_u32 s19, s19, s3
    s_lshl_b32 s3, s17, 2
    s_add_u32 s19, s19, s3
    s_lshl_b32 s19, s19, 4
    s_add_u32 s19, s19, s14
    s_lshl_b32 s48, s19, 10
    s_lshl_b32 s49, s19, 5
    s_add_u32 s49, s49, 4194304
    s_lshl_b32 s19, s15, 4
    s_add_u32 s19, s19, s14
    s_lshl_b32 s50, s19, 6
    s_add_u32 s50, s50, s16
    s_lshl_b32 s50, s50, 8
    s_lshl_b32 s51, s19, 9
    s_add_u32 s51, s51, 4194304
    s_lshl_b32 s19, s14, 1
    s_add_u32 s19, s19, s17
    s_lshl_b32 s52, s19, 17
    s_lshl_b32 s3, s67, 10
    s_add_u32 s52, s52, s3
    s_add_u32 s52, s52, 8388608
    s_lshl_b32 s53, s19, 5
    s_add_u32 s53, s53, s67
    s_lshl_b32 s53, s53, 2
    s_add_u32 s53, s53, 4481024
    s_and_b32 s19, s12, 1
    s_lshl_b32 s19, s19, 1
    s_bfe_u32 s3, s12, 0x10001
    s_add_u32 s19, s19, s3
    s_lshl_b32 s19, s19, 2
    s_and_b32 s3, s13, 3
    s_add_u32 s19, s19, s3
    s_lshl_b32 s58, s19, 2
    s_add_u32 s58, s58, s16
    s_lshr_b32 s19, s12, 2
    s_lshl_b32 s19, s19, 3
    s_lshr_b32 s3, s13, 2
    s_add_u32 s19, s19, s3
    s_lshl_b32 s54, s58, 16
    s_lshl_b32 s3, s19, 7
    s_add_u32 s54, s54, s3
    s_add_u32 s55, s54, 32768
    s_lshr_b32 s56, s58, 1
    s_lshl_b32 s56, s56, 7
    s_add_u32 s56, s56, 4481024
    s_lshl_b32 s57, s58, 7
    s_add_u32 s57, s57, 4472832
    s_lshl_b32 s59, s67, 12
    s_add_u32 s59, s59, 4325376
    s_lshl_b32 s28, s67, 7
    s_add_u32 s28, s28, 4456448
    s_mov_b32 s29, 0
    v_lshrrev_b32 v19, 4, v2
    v_and_b32 v54, 15, v2
    v_lshlrev_b32 v54, 6, v54
    v_lshl_add_u32 v76, v19, 14, v54
    v_lshl_add_u32 v77, v19, 15, v54
    v_lshrrev_b32 v19, 1, v2
    v_and_b32 v54, 1, v2
    v_lshlrev_b32 v54, 6, v54
    v_lshl_add_u32 v78, v19, 11, v54
    v_lshlrev_b32 v79, 9, v2
    v_lshrrev_b32 v54, 1, v2
    v_lshlrev_b32 v54, 10, v54
    v_and_b32 v19, 1, v2
    v_lshl_add_u32 v54, v19, 7, v54
    v_add_u32 v54, s50, v54
    v_lshlrev_b32 v19, 7, v2
    v_add_u32 v55, s51, v19
    s_sub_u32 s3, s59, 4096
    v_add_u32 v19, s3, v19
    v_cmp_gt_u32 vcc, 32, v2
    s_nop 1
    v_cndmask_b32 v54, v19, v54, vcc
    v_mov_b32 v19, s28
    v_cmp_gt_u32 vcc, 4, v2
    s_nop 1
    v_cndmask_b32 v55, v19, v55, vcc
    v_mov_b32 v19, -1
    s_lshl_b32 s19, s14, 4
    s_add_u32 s19, s19, s15
    s_lshl_b32 s53, s19, 7
    s_add_u32 s53, s53, 4849664
    s_lshr_b32 s19, s58, 2
    s_lshl_b32 s56, s19, 11
    s_add_u32 s56, s56, 4849664
    v_mov_b64 v[160:161], 0
    v_mov_b64 v[162:163], 0
    v_mov_b64 v[164:165], 0
    v_mov_b64 v[166:167], 0
    v_mov_b64 v[168:169], 0
    v_mov_b64 v[170:171], 0
    v_mov_b64 v[172:173], 0
    v_mov_b64 v[174:175], 0
    v_mov_b64 v[176:177], 0
    v_mov_b64 v[178:179], 0
    v_mov_b64 v[180:181], 0
    v_mov_b64 v[182:183], 0
    v_mov_b64 v[184:185], 0
    v_mov_b64 v[186:187], 0
    v_mov_b64 v[188:189], 0
    v_mov_b64 v[190:191], 0
    v_mov_b64 v[192:193], 0
    v_mov_b64 v[194:195], 0
    v_mov_b64 v[196:197], 0
    v_mov_b64 v[198:199], 0
    v_mov_b64 v[200:201], 0
    v_mov_b64 v[202:203], 0
    v_mov_b64 v[204:205], 0
    v_mov_b64 v[206:207], 0
    v_mov_b64 v[208:209], 0
    v_mov_b64 v[210:211], 0
    v_mov_b64 v[212:213], 0
    v_mov_b64 v[214:215], 0
    v_mov_b64 v[216:217], 0
    v_mov_b64 v[218:219], 0
    v_mov_b64 v[220:221], 0
    v_mov_b64 v[222:223], 0
    v_mov_b64 v[224:225], 0
    v_mov_b64 v[226:227], 0
    v_mov_b64 v[228:229], 0
    v_mov_b64 v[230:231], 0
    v_mov_b64 v[232:233], 0
    v_mov_b64 v[234:235], 0
    v_mov_b64 v[236:237], 0
    v_mov_b64 v[238:239], 0
    v_mov_b64 v[240:241], 0
    v_mov_b64 v[242:243], 0
    v_mov_b64 v[244:245], 0
    v_mov_b64 v[246:247], 0
    v_mov_b64 v[248:249], 0
    v_mov_b64 v[250:251], 0
    v_mov_b64 v[252:253], 0
    v_mov_b64 v[254:255], 0
    s_waitcnt vmcnt(4)
    s_barrier
    ds_read_b128 v[80:83], v20 offset:0
    ds_read_b64_tr_b16 v[96:97], v36 offset:0
    ds_read_b64_tr_b16 v[98:99], v36 offset:512
    ds_read_b128 v[84:87], v20 offset:2048
    ds_read_b128 v[88:91], v20 offset:4096
    ds_read_b128 v[92:95], v20 offset:6144
    ds_read_b64_tr_b16 v[100:101], v37 offset:0
    ds_read_b64_tr_b16 v[102:103], v37 offset:512
    ds_read_b64_tr_b16 v[104:105], v36 offset:8192
    ds_read_b64_tr_b16 v[106:107], v36 offset:8704
    ds_read_b64_tr_b16 v[108:109], v37 offset:8192
    ds_read_b64_tr_b16 v[110:111], v37 offset:8704
    ds_read_b64_tr_b16 v[112:113], v36 offset:16384
    ds_read_b64_tr_b16 v[114:115], v36 offset:16896
    ds_read_b64_tr_b16 v[116:117], v37 offset:16384
    ds_read_b64_tr_b16 v[118:119], v37 offset:16896
    s_mov_b32 exec_lo, 0xffff
    s_mov_b32 exec_hi, 0xffff
    buffer_store_dword v19, v11, s[32:35], s64 offen sc1
    s_lshl_b64 exec, 1, s16
    buffer_store_dword v19, v13, s[32:35], s65 offen sc1
    s_mov_b64 exec, -1
.p2align 7
L_loop:
    s_waitcnt lgkmcnt(10)
    v_mfma_f32_16x16x32_bf16 v[160:163], v[96:99], v[80:83], v[160:163]
    ds_read_b128 v[120:123], v21 offset:0
    v_mfma_f32_16x16x32_bf16 v[164:167], v[96:99], v[84:87], v[164:167]
    ds_read_b64_tr_b16 v[136:137], v36 offset:4096
    v_mfma_f32_16x16x32_bf16 v[168:171], v[96:99], v[88:91], v[168:171]
    ds_read_b64_tr_b16 v[138:139], v36 offset:4608
    v_mfma_f32_16x16x32_bf16 v[172:175], v[96:99], v[92:95], v[172:175]
    s_waitcnt lgkmcnt(11)
    v_mfma_f32_16x16x32_bf16 v[188:191], v[100:103], v[92:95], v[188:191]
    ds_read_b128 v[124:127], v21 offset:2048
    v_mfma_f32_16x16x32_bf16 v[184:187], v[100:103], v[88:91], v[184:187]
    ds_read_b128 v[128:131], v21 offset:4096
    v_mfma_f32_16x16x32_bf16 v[180:183], v[100:103], v[84:87], v[180:183]
    ds_read_b128 v[132:135], v21 offset:6144
    v_mfma_f32_16x16x32_bf16 v[176:179], v[100:103], v[80:83], v[176:179]
    s_waitcnt lgkmcnt(12)
    v_mfma_f32_16x16x32_bf16 v[192:195], v[104:107], v[80:83], v[192:195]
    ds_read_b64_tr_b16 v[140:141], v37 offset:4096
    v_mfma_f32_16x16x32_bf16 v[196:199], v[104:107], v[84:87], v[196:199]
    ds_read_b64_tr_b16 v[142:143], v37 offset:4608
    v_mfma_f32_16x16x32_bf16 v[200:203], v[104:107], v[88:91], v[200:203]
    ds_read_b64_tr_b16 v[144:145], v36 offset:12288
    v_mfma_f32_16x16x32_bf16 v[204:207], v[104:107], v[92:95], v[204:207]
    s_waitcnt lgkmcnt(13)
    v_mfma_f32_16x16x32_bf16 v[220:223], v[108:111], v[92:95], v[220:223]
    ds_read_b64_tr_b16 v[146:147], v36 offset:12800
    v_mfma_f32_16x16x32_bf16 v[216:219], v[108:111], v[88:91], v[216:219]
    ds_read_b64_tr_b16 v[148:149], v37 offset:12288
    v_mfma_f32_16x16x32_bf16 v[212:215], v[108:111], v[84:87], v[212:215]
    ds_read_b64_tr_b16 v[150:151], v37 offset:12800
    v_mfma_f32_16x16x32_bf16 v[208:211], v[108:111], v[80:83], v[208:211]
    s_waitcnt lgkmcnt(14)
    v_mfma_f32_16x16x32_bf16 v[224:227], v[80:83], v[112:115], v[224:227]
    ds_read_b64_tr_b16 v[152:153], v36 offset:20480
    v_mfma_f32_16x16x32_bf16 v[228:231], v[84:87], v[112:115], v[228:231]
    ds_read_b64_tr_b16 v[154:155], v36 offset:20992
    v_mfma_f32_16x16x32_bf16 v[232:235], v[88:91], v[112:115], v[232:235]
    ds_read_b64_tr_b16 v[156:157], v37 offset:20480
    v_mfma_f32_16x16x32_bf16 v[236:239], v[92:95], v[112:115], v[236:239]
    s_waitcnt lgkmcnt(15)
    v_mfma_f32_16x16x32_bf16 v[252:255], v[92:95], v[116:119], v[252:255]
    ds_read_b64_tr_b16 v[158:159], v37 offset:20992
    v_mfma_f32_16x16x32_bf16 v[248:251], v[88:91], v[116:119], v[248:251]
    v_mfma_f32_16x16x32_bf16 v[244:247], v[84:87], v[116:119], v[244:247]
    v_mfma_f32_16x16x32_bf16 v[240:243], v[80:83], v[116:119], v[240:243]
    s_waitcnt lgkmcnt(10)
    v_mfma_f32_16x16x32_bf16 v[160:163], v[136:139], v[120:123], v[160:163]
    v_mfma_f32_16x16x32_bf16 v[164:167], v[136:139], v[124:127], v[164:167]
    v_mfma_f32_16x16x32_bf16 v[168:171], v[136:139], v[128:131], v[168:171]
    v_mfma_f32_16x16x32_bf16 v[172:175], v[136:139], v[132:135], v[172:175]
    s_waitcnt lgkmcnt(0)
    s_barrier
    ds_read_b128 v[80:83], v22 offset:0
    v_mfma_f32_16x16x32_bf16 v[188:191], v[140:143], v[132:135], v[188:191]
    ds_read_b64_tr_b16 v[96:97], v38 offset:0
    v_mfma_f32_16x16x32_bf16 v[184:187], v[140:143], v[128:131], v[184:187]
    ds_read_b64_tr_b16 v[98:99], v38 offset:512
    v_mfma_f32_16x16x32_bf16 v[180:183], v[140:143], v[124:127], v[180:183]
    ds_read_b128 v[84:87], v22 offset:2048
    v_mfma_f32_16x16x32_bf16 v[176:179], v[140:143], v[120:123], v[176:179]
    ds_read_b128 v[88:91], v22 offset:4096
    v_mfma_f32_16x16x32_bf16 v[192:195], v[144:147], v[120:123], v[192:195]
    ds_read_b128 v[92:95], v22 offset:6144
    v_mfma_f32_16x16x32_bf16 v[196:199], v[144:147], v[124:127], v[196:199]
    ds_read_b64_tr_b16 v[100:101], v39 offset:0
    v_mfma_f32_16x16x32_bf16 v[200:203], v[144:147], v[128:131], v[200:203]
    ds_read_b64_tr_b16 v[102:103], v39 offset:512
    v_mfma_f32_16x16x32_bf16 v[204:207], v[144:147], v[132:135], v[204:207]
    ds_read_b64_tr_b16 v[104:105], v38 offset:8192
    v_mfma_f32_16x16x32_bf16 v[220:223], v[148:151], v[132:135], v[220:223]
    ds_read_b64_tr_b16 v[106:107], v38 offset:8704
    v_mfma_f32_16x16x32_bf16 v[216:219], v[148:151], v[128:131], v[216:219]
    ds_read_b64_tr_b16 v[108:109], v39 offset:8192
    v_mfma_f32_16x16x32_bf16 v[212:215], v[148:151], v[124:127], v[212:215]
    ds_read_b64_tr_b16 v[110:111], v39 offset:8704
    v_mfma_f32_16x16x32_bf16 v[208:211], v[148:151], v[120:123], v[208:211]
    ds_read_b64_tr_b16 v[112:113], v38 offset:16384
    v_mfma_f32_16x16x32_bf16 v[224:227], v[120:123], v[152:155], v[224:227]
    ds_read_b64_tr_b16 v[114:115], v38 offset:16896
    v_mfma_f32_16x16x32_bf16 v[228:231], v[124:127], v[152:155], v[228:231]
    ds_read_b64_tr_b16 v[116:117], v39 offset:16384
    v_mfma_f32_16x16x32_bf16 v[232:235], v[128:131], v[152:155], v[232:235]
    ds_read_b64_tr_b16 v[118:119], v39 offset:16896
    v_mfma_f32_16x16x32_bf16 v[236:239], v[132:135], v[152:155], v[236:239]
    v_mfma_f32_16x16x32_bf16 v[252:255], v[132:135], v[156:159], v[252:255]
    v_mfma_f32_16x16x32_bf16 v[248:251], v[128:131], v[156:159], v[248:251]
    v_mfma_f32_16x16x32_bf16 v[244:247], v[124:127], v[156:159], v[244:247]
    v_mfma_f32_16x16x32_bf16 v[240:243], v[120:123], v[156:159], v[240:243]
    s_cmp_eq_u32 s66, 2
    s_cbranch_scc1 L_mid
L_midret:
    s_waitcnt lgkmcnt(10)
    v_mfma_f32_16x16x32_bf16 v[160:163], v[96:99], v[80:83], v[160:163]
    ds_read_b128 v[120:123], v23 offset:0
    v_mfma_f32_16x16x32_bf16 v[164:167], v[96:99], v[84:87], v[164:167]
    ds_read_b64_tr_b16 v[136:137], v38 offset:4096
    v_mfma_f32_16x16x32_bf16 v[168:171], v[96:99], v[88:91], v[168:171]
    ds_read_b64_tr_b16 v[138:139], v38 offset:4608
    v_mfma_f32_16x16x32_bf16 v[172:175], v[96:99], v[92:95], v[172:175]
    s_waitcnt lgkmcnt(11)
    v_mfma_f32_16x16x32_bf16 v[188:191], v[100:103], v[92:95], v[188:191]
    ds_read_b128 v[124:127], v23 offset:2048
    v_mfma_f32_16x16x32_bf16 v[184:187], v[100:103], v[88:91], v[184:187]
    ds_read_b128 v[128:131], v23 offset:4096
    v_mfma_f32_16x16x32_bf16 v[180:183], v[100:103], v[84:87], v[180:183]
    ds_read_b128 v[132:135], v23 offset:6144
    v_mfma_f32_16x16x32_bf16 v[176:179], v[100:103], v[80:83], v[176:179]
    s_waitcnt lgkmcnt(12)
    v_mfma_f32_16x16x32_bf16 v[192:195], v[104:107], v[80:83], v[192:195]
    ds_read_b64_tr_b16 v[140:141], v39 offset:4096
    v_mfma_f32_16x16x32_bf16 v[196:199], v[104:107], v[84:87], v[196:199]
    ds_read_b64_tr_b16 v[142:143], v39 offset:4608
    v_mfma_f32_16x16x32_bf16 v[200:203], v[104:107], v[88:91], v[200:203]
    ds_read_b64_tr_b16 v[144:145], v38 offset:12288
    v_mfma_f32_16x16x32_bf16 v[204:207], v[104:107], v[92:95], v[204:207]
    s_waitcnt lgkmcnt(13)
    v_mfma_f32_16x16x32_bf16 v[220:223], v[108:111], v[92:95], v[220:223]
    ds_read_b64_tr_b16 v[146:147], v38 offset:12800
    v_mfma_f32_16x16x32_bf16 v[216:219], v[108:111], v[88:91], v[216:219]
    ds_read_b64_tr_b16 v[148:149], v39 offset:12288
    v_mfma_f32_16x16x32_bf16 v[212:215], v[108:111], v[84:87], v[212:215]
    ds_read_b64_tr_b16 v[150:151], v39 offset:12800
    v_mfma_f32_16x16x32_bf16 v[208:211], v[108:111], v[80:83], v[208:211]
    s_waitcnt lgkmcnt(14)
    v_mfma_f32_16x16x32_bf16 v[224:227], v[80:83], v[112:115], v[224:227]
    ds_read_b64_tr_b16 v[152:153], v38 offset:20480
    v_mfma_f32_16x16x32_bf16 v[228:231], v[84:87], v[112:115], v[228:231]
    ds_read_b64_tr_b16 v[154:155], v38 offset:20992
    v_mfma_f32_16x16x32_bf16 v[232:235], v[88:91], v[112:115], v[232:235]
    ds_read_b64_tr_b16 v[156:157], v39 offset:20480
    v_mfma_f32_16x16x32_bf16 v[236:239], v[92:95], v[112:115], v[236:239]
    s_waitcnt lgkmcnt(15)
    v_mfma_f32_16x16x32_bf16 v[252:255], v[92:95], v[116:119], v[252:255]
    ds_read_b64_tr_b16 v[158:159], v39 offset:20992
    v_mfma_f32_16x16x32_bf16 v[248:251], v[88:91], v[116:119], v[248:251]
    v_mfma_f32_16x16x32_bf16 v[244:247], v[84:87], v[116:119], v[244:247]
    v_mfma_f32_16x16x32_bf16 v[240:243], v[80:83], v[116:119], v[240:243]
    s_waitcnt lgkmcnt(10)
    v_mfma_f32_16x16x32_bf16 v[160:163], v[136:139], v[120:123], v[160:163]
    v_mfma_f32_16x16x32_bf16 v[164:167], v[136:139], v[124:127], v[164:167]
    v_mfma_f32_16x16x32_bf16 v[168:171], v[136:139], v[128:131], v[168:171]
    v_mfma_f32_16x16x32_bf16 v[172:175], v[136:139], v[132:135], v[172:175]
    s_cmp_eq_u32 s66, 3
    s_waitcnt lgkmcnt(0)
    s_barrier
L_nob:
    ds_read_b128 v[80:83], v24 offset:0
    v_mfma_f32_16x16x32_bf16 v[188:191], v[140:143], v[132:135], v[188:191]
    ds_read_b64_tr_b16 v[96:97], v40 offset:0
    v_mfma_f32_16x16x32_bf16 v[184:187], v[140:143], v[128:131], v[184:187]
    ds_read_b64_tr_b16 v[98:99], v40 offset:512
    v_mfma_f32_16x16x32_bf16 v[180:183], v[140:143], v[124:127], v[180:183]
    ds_read_b128 v[84:87], v24 offset:2048
    v_mfma_f32_16x16x32_bf16 v[176:179], v[140:143], v[120:123], v[176:179]
    ds_read_b128 v[88:91], v24 offset:4096
    v_mfma_f32_16x16x32_bf16 v[192:195], v[144:147], v[120:123], v[192:195]
    ds_read_b128 v[92:95], v24 offset:6144
    v_mfma_f32_16x16x32_bf16 v[196:199], v[144:147], v[124:127], v[196:199]
    ds_read_b64_tr_b16 v[100:101], v41 offset:0
    v_mfma_f32_16x16x32_bf16 v[200:203], v[144:147], v[128:131], v[200:203]
    ds_read_b64_tr_b16 v[102:103], v41 offset:512
    v_mfma_f32_16x16x32_bf16 v[204:207], v[144:147], v[132:135], v[204:207]
    ds_read_b64_tr_b16 v[104:105], v40 offset:8192
    v_mfma_f32_16x16x32_bf16 v[220:223], v[148:151], v[132:135], v[220:223]
    ds_read_b64_tr_b16 v[106:107], v40 offset:8704
    v_mfma_f32_16x16x32_bf16 v[216:219], v[148:151], v[128:131], v[216:219]
    ds_read_b64_tr_b16 v[108:109], v41 offset:8192
    v_mfma_f32_16x16x32_bf16 v[212:215], v[148:151], v[124:127], v[212:215]
    ds_read_b64_tr_b16 v[110:111], v41 offset:8704
    v_mfma_f32_16x16x32_bf16 v[208:211], v[148:151], v[120:123], v[208:211]
    ds_read_b64_tr_b16 v[112:113], v40 offset:16384
    v_mfma_f32_16x16x32_bf16 v[224:227], v[120:123], v[152:155], v[224:227]
    ds_read_b64_tr_b16 v[114:115], v40 offset:16896
    v_mfma_f32_16x16x32_bf16 v[228:231], v[124:127], v[152:155], v[228:231]
    ds_read_b64_tr_b16 v[116:117], v41 offset:16384
    v_mfma_f32_16x16x32_bf16 v[232:235], v[128:131], v[152:155], v[232:235]
    ds_read_b64_tr_b16 v[118:119], v41 offset:16896
    v_mfma_f32_16x16x32_bf16 v[236:239], v[132:135], v[152:155], v[236:239]
    v_mfma_f32_16x16x32_bf16 v[252:255], v[132:135], v[156:159], v[252:255]
    v_mfma_f32_16x16x32_bf16 v[248:251], v[128:131], v[156:159], v[248:251]
    v_mfma_f32_16x16x32_bf16 v[244:247], v[124:127], v[156:159], v[244:247]
    v_mfma_f32_16x16x32_bf16 v[240:243], v[120:123], v[156:159], v[240:243]
    s_waitcnt lgkmcnt(10)
    v_mfma_f32_16x16x32_bf16 v[160:163], v[96:99], v[80:83], v[160:163]
    ds_read_b128 v[120:123], v25 offset:0
    v_mfma_f32_16x16x32_bf16 v[164:167], v[96:99], v[84:87], v[164:167]
    ds_read_b64_tr_b16 v[136:137], v40 offset:4096
    v_mfma_f32_16x16x32_bf16 v[168:171], v[96:99], v[88:91], v[168:171]
    ds_read_b64_tr_b16 v[138:139], v40 offset:4608
    v_mfma_f32_16x16x32_bf16 v[172:175], v[96:99], v[92:95], v[172:175]
    s_waitcnt lgkmcnt(11)
    v_mfma_f32_16x16x32_bf16 v[188:191], v[100:103], v[92:95], v[188:191]
    ds_read_b128 v[124:127], v25 offset:2048
    v_mfma_f32_16x16x32_bf16 v[184:187], v[100:103], v[88:91], v[184:187]
    ds_read_b128 v[128:131], v25 offset:4096
    v_mfma_f32_16x16x32_bf16 v[180:183], v[100:103], v[84:87], v[180:183]
    ds_read_b128 v[132:135], v25 offset:6144
    v_mfma_f32_16x16x32_bf16 v[176:179], v[100:103], v[80:83], v[176:179]
    s_waitcnt lgkmcnt(12)
    v_mfma_f32_16x16x32_bf16 v[192:195], v[104:107], v[80:83], v[192:195]
    ds_read_b64_tr_b16 v[140:141], v41 offset:4096
    v_mfma_f32_16x16x32_bf16 v[196:199], v[104:107], v[84:87], v[196:199]
    ds_read_b64_tr_b16 v[142:143], v41 offset:4608
    v_mfma_f32_16x16x32_bf16 v[200:203], v[104:107], v[88:91], v[200:203]
    ds_read_b64_tr_b16 v[144:145], v40 offset:12288
    v_mfma_f32_16x16x32_bf16 v[204:207], v[104:107], v[92:95], v[204:207]
    s_waitcnt lgkmcnt(13)
    v_mfma_f32_16x16x32_bf16 v[220:223], v[108:111], v[92:95], v[220:223]
    ds_read_b64_tr_b16 v[146:147], v40 offset:12800
    v_mfma_f32_16x16x32_bf16 v[216:219], v[108:111], v[88:91], v[216:219]
    ds_read_b64_tr_b16 v[148:149], v41 offset:12288
    v_mfma_f32_16x16x32_bf16 v[212:215], v[108:111], v[84:87], v[212:215]
    ds_read_b64_tr_b16 v[150:151], v41 offset:12800
    v_mfma_f32_16x16x32_bf16 v[208:211], v[108:111], v[80:83], v[208:211]
    s_waitcnt lgkmcnt(14)
    v_mfma_f32_16x16x32_bf16 v[224:227], v[80:83], v[112:115], v[224:227]
    ds_read_b64_tr_b16 v[152:153], v40 offset:20480
    v_mfma_f32_16x16x32_bf16 v[228:231], v[84:87], v[112:115], v[228:231]
    ds_read_b64_tr_b16 v[154:155], v40 offset:20992
    v_mfma_f32_16x16x32_bf16 v[232:235], v[88:91], v[112:115], v[232:235]
    ds_read_b64_tr_b16 v[156:157], v41 offset:20480
    v_mfma_f32_16x16x32_bf16 v[236:239], v[92:95], v[112:115], v[236:239]
    s_waitcnt lgkmcnt(15)
    v_mfma_f32_16x16x32_bf16 v[252:255], v[92:95], v[116:119], v[252:255]
    ds_read_b64_tr_b16 v[158:159], v41 offset:20992
    v_mfma_f32_16x16x32_bf16 v[248:251], v[88:91], v[116:119], v[248:251]
    v_mfma_f32_16x16x32_bf16 v[244:247], v[84:87], v[116:119], v[244:247]
    v_mfma_f32_16x16x32_bf16 v[240:243], v[80:83], v[116:119], v[240:243]
    s_waitcnt lgkmcnt(10)
    v_mfma_f32_16x16x32_bf16 v[160:163], v[136:139], v[120:123], v[160:163]
    v_mfma_f32_16x16x32_bf16 v[164:167], v[136:139], v[124:127], v[164:167]
    v_mfma_f32_16x16x32_bf16 v[168:171], v[136:139], v[128:131], v[168:171]
    v_mfma_f32_16x16x32_bf16 v[172:175], v[136:139], v[132:135], v[172:175]
    s_cmp_eq_u32 s66, 3
    s_waitcnt lgkmcnt(0)
    s_cbranch_scc1 L_last
    s_barrier
    ds_read_b128 v[80:83], v26 offset:0
    v_mfma_f32_16x16x32_bf16 v[188:191], v[140:143], v[132:135], v[188:191]
    ds_read_b64_tr_b16 v[96:97], v42 offset:0
    v_mfma_f32_16x16x32_bf16 v[184:187], v[140:143], v[128:131], v[184:187]
    ds_read_b64_tr_b16 v[98:99], v42 offset:512
    v_mfma_f32_16x16x32_bf16 v[180:183], v[140:143], v[124:127], v[180:183]
    ds_read_b128 v[84:87], v26 offset:2048
    v_mfma_f32_16x16x32_bf16 v[176:179], v[140:143], v[120:123], v[176:179]
    ds_read_b128 v[88:91], v26 offset:4096
    v_mfma_f32_16x16x32_bf16 v[192:195], v[144:147], v[120:123], v[192:195]
    ds_read_b128 v[92:95], v26 offset:6144
    v_mfma_f32_16x16x32_bf16 v[196:199], v[144:147], v[124:127], v[196:199]
    ds_read_b64_tr_b16 v[100:101], v43 offset:0
    v_mfma_f32_16x16x32_bf16 v[200:203], v[144:147], v[128:131], v[200:203]
    ds_read_b64_tr_b16 v[102:103], v43 offset:512
    v_mfma_f32_16x16x32_bf16 v[204:207], v[144:147], v[132:135], v[204:207]
    ds_read_b64_tr_b16 v[104:105], v42 offset:8192
    v_mfma_f32_16x16x32_bf16 v[220:223], v[148:151], v[132:135], v[220:223]
    ds_read_b64_tr_b16 v[106:107], v42 offset:8704
    v_mfma_f32_16x16x32_bf16 v[216:219], v[148:151], v[128:131], v[216:219]
    ds_read_b64_tr_b16 v[108:109], v43 offset:8192
    v_mfma_f32_16x16x32_bf16 v[212:215], v[148:151], v[124:127], v[212:215]
    ds_read_b64_tr_b16 v[110:111], v43 offset:8704
    v_mfma_f32_16x16x32_bf16 v[208:211], v[148:151], v[120:123], v[208:211]
    ds_read_b64_tr_b16 v[112:113], v42 offset:16384
    v_mfma_f32_16x16x32_bf16 v[224:227], v[120:123], v[152:155], v[224:227]
    ds_read_b64_tr_b16 v[114:115], v42 offset:16896
    v_mfma_f32_16x16x32_bf16 v[228:231], v[124:127], v[152:155], v[228:231]
    ds_read_b64_tr_b16 v[116:117], v43 offset:16384
    v_mfma_f32_16x16x32_bf16 v[232:235], v[128:131], v[152:155], v[232:235]
    ds_read_b64_tr_b16 v[118:119], v43 offset:16896
    v_mfma_f32_16x16x32_bf16 v[236:239], v[132:135], v[152:155], v[236:239]
    v_mfma_f32_16x16x32_bf16 v[252:255], v[132:135], v[156:159], v[252:255]
    v_mfma_f32_16x16x32_bf16 v[248:251], v[128:131], v[156:159], v[248:251]
    v_mfma_f32_16x16x32_bf16 v[244:247], v[124:127], v[156:159], v[244:247]
    v_mfma_f32_16x16x32_bf16 v[240:243], v[120:123], v[156:159], v[240:243]
    s_waitcnt lgkmcnt(10)
    v_mfma_f32_16x16x32_bf16 v[160:163], v[96:99], v[80:83], v[160:163]
    ds_read_b128 v[120:123], v27 offset:0
    v_mfma_f32_16x16x32_bf16 v[164:167], v[96:99], v[84:87], v[164:167]
    ds_read_b64_tr_b16 v[136:137], v42 offset:4096
    v_mfma_f32_16x16x32_bf16 v[168:171], v[96:99], v[88:91], v[168:171]
    ds_read_b64_tr_b16 v[138:139], v42 offset:4608
    v_mfma_f32_16x16x32_bf16 v[172:175], v[96:99], v[92:95], v[172:175]
    s_waitcnt lgkmcnt(11)
    v_mfma_f32_16x16x32_bf16 v[188:191], v[100:103], v[92:95], v[188:191]
    ds_read_b128 v[124:127], v27 offset:2048
    v_mfma_f32_16x16x32_bf16 v[184:187], v[100:103], v[88:91], v[184:187]
    ds_read_b128 v[128:131], v27 offset:4096
    v_mfma_f32_16x16x32_bf16 v[180:183], v[100:103], v[84:87], v[180:183]
    ds_read_b128 v[132:135], v27 offset:6144
    v_mfma_f32_16x16x32_bf16 v[176:179], v[100:103], v[80:83], v[176:179]
    s_waitcnt lgkmcnt(12)
    v_mfma_f32_16x16x32_bf16 v[192:195], v[104:107], v[80:83], v[192:195]
    ds_read_b64_tr_b16 v[140:141], v43 offset:4096
    v_mfma_f32_16x16x32_bf16 v[196:199], v[104:107], v[84:87], v[196:199]
    ds_read_b64_tr_b16 v[142:143], v43 offset:4608
    v_mfma_f32_16x16x32_bf16 v[200:203], v[104:107], v[88:91], v[200:203]
    ds_read_b64_tr_b16 v[144:145], v42 offset:12288
    v_mfma_f32_16x16x32_bf16 v[204:207], v[104:107], v[92:95], v[204:207]
    s_waitcnt lgkmcnt(13)
    v_mfma_f32_16x16x32_bf16 v[220:223], v[108:111], v[92:95], v[220:223]
    ds_read_b64_tr_b16 v[146:147], v42 offset:12800
    v_mfma_f32_16x16x32_bf16 v[216:219], v[108:111], v[88:91], v[216:219]
    ds_read_b64_tr_b16 v[148:149], v43 offset:12288
    v_mfma_f32_16x16x32_bf16 v[212:215], v[108:111], v[84:87], v[212:215]
    ds_read_b64_tr_b16 v[150:151], v43 offset:12800
    v_mfma_f32_16x16x32_bf16 v[208:211], v[108:111], v[80:83], v[208:211]
    s_waitcnt lgkmcnt(14)
    v_mfma_f32_16x16x32_bf16 v[224:227], v[80:83], v[112:115], v[224:227]
    ds_read_b64_tr_b16 v[152:153], v42 offset:20480
    v_mfma_f32_16x16x32_bf16 v[228:231], v[84:87], v[112:115], v[228:231]
    ds_read_b64_tr_b16 v[154:155], v42 offset:20992
    v_mfma_f32_16x16x32_bf16 v[232:235], v[88:91], v[112:115], v[232:235]
    ds_read_b64_tr_b16 v[156:157], v43 offset:20480
    v_mfma_f32_16x16x32_bf16 v[236:239], v[92:95], v[112:115], v[236:239]
    s_waitcnt lgkmcnt(15)
    v_mfma_f32_16x16x32_bf16 v[252:255], v[92:95], v[116:119], v[252:255]
    ds_read_b64_tr_b16 v[158:159], v43 offset:20992
    v_mfma_f32_16x16x32_bf16 v[248:251], v[88:91], v[116:119], v[248:251]
    v_mfma_f32_16x16x32_bf16 v[244:247], v[84:87], v[116:119], v[244:247]
    v_mfma_f32_16x16x32_bf16 v[240:243], v[80:83], v[116:119], v[240:243]
    s_waitcnt lgkmcnt(10)
    v_mfma_f32_16x16x32_bf16 v[160:163], v[136:139], v[120:123], v[160:163]
    v_mfma_f32_16x16x32_bf16 v[164:167], v[136:139], v[124:127], v[164:167]
    v_mfma_f32_16x16x32_bf16 v[168:171], v[136:139], v[128:131], v[168:171]
    v_mfma_f32_16x16x32_bf16 v[172:175], v[136:139], v[132:135], v[172:175]
    s_waitcnt lgkmcnt(0)
    s_barrier
    ds_read_b128 v[80:83], v20 offset:0
    v_mfma_f32_16x16x32_bf16 v[188:191], v[140:143], v[132:135], v[188:191]
    ds_read_b64_tr_b16 v[96:97], v36 offset:0
    v_mfma_f32_16x16x32_bf16 v[184:187], v[140:143], v[128:131], v[184:187]
    ds_read_b64_tr_b16 v[98:99], v36 offset:512
    v_mfma_f32_16x16x32_bf16 v[180:183], v[140:143], v[124:127], v[180:183]
    ds_read_b128 v[84:87], v20 offset:2048
    v_mfma_f32_16x16x32_bf16 v[176:179], v[140:143], v[120:123], v[176:179]
    ds_read_b128 v[88:91], v20 offset:4096
    v_mfma_f32_16x16x32_bf16 v[192:195], v[144:147], v[120:123], v[192:195]
    ds_read_b128 v[92:95], v20 offset:6144
    v_mfma_f32_16x16x32_bf16 v[196:199], v[144:147], v[124:127], v[196:199]
    ds_read_b64_tr_b16 v[100:101], v37 offset:0
    v_mfma_f32_16x16x32_bf16 v[200:203], v[144:147], v[128:131], v[200:203]
    ds_read_b64_tr_b16 v[102:103], v37 offset:512
    v_mfma_f32_16x16x32_bf16 v[204:207], v[144:147], v[132:135], v[204:207]
    ds_read_b64_tr_b16 v[104:105], v36 offset:8192
    v_mfma_f32_16x16x32_bf16 v[220:223], v[148:151], v[132:135], v[220:223]
    ds_read_b64_tr_b16 v[106:107], v36 offset:8704
    v_mfma_f32_16x16x32_bf16 v[216:219], v[148:151], v[128:131], v[216:219]
    ds_read_b64_tr_b16 v[108:109], v37 offset:8192
    v_mfma_f32_16x16x32_bf16 v[212:215], v[148:151], v[124:127], v[212:215]
    ds_read_b64_tr_b16 v[110:111], v37 offset:8704
    v_mfma_f32_16x16x32_bf16 v[208:211], v[148:151], v[120:123], v[208:211]
    ds_read_b64_tr_b16 v[112:113], v36 offset:16384
    v_mfma_f32_16x16x32_bf16 v[224:227], v[120:123], v[152:155], v[224:227]
    ds_read_b64_tr_b16 v[114:115], v36 offset:16896
    v_mfma_f32_16x16x32_bf16 v[228:231], v[124:127], v[152:155], v[228:231]
    ds_read_b64_tr_b16 v[116:117], v37 offset:16384
    v_mfma_f32_16x16x32_bf16 v[232:235], v[128:131], v[152:155], v[232:235]
    ds_read_b64_tr_b16 v[118:119], v37 offset:16896
    v_mfma_f32_16x16x32_bf16 v[236:239], v[132:135], v[152:155], v[236:239]
    v_mfma_f32_16x16x32_bf16 v[252:255], v[132:135], v[156:159], v[252:255]
    v_mfma_f32_16x16x32_bf16 v[248:251], v[128:131], v[156:159], v[248:251]
    v_mfma_f32_16x16x32_bf16 v[244:247], v[124:127], v[156:159], v[244:247]
    v_mfma_f32_16x16x32_bf16 v[240:243], v[120:123], v[156:159], v[240:243]
    s_add_u32 s66, s66, 1
    s_branch L_loop
L_mid:
    s_waitcnt vmcnt(0)
    buffer_load_dword v14, v13, s[36:39], 0 offen offset:4 sc1
    s_mov_b64 exec, 15
    s_mov_b64 exec, 1
    s_mov_b64 exec, -1
    v_mfma_f32_16x16x16_bf16 v[68:71], v[60:61], v[52:53], 0
    v_mfma_f32_16x16x16_bf16 v[72:75], v[62:63], v[52:53], 0
    v_mfma_f32_16x16x16_bf16 v[28:31], v[64:65], v[52:53], 0
    v_mfma_f32_16x16x16_bf16 v[32:35], v[66:67], v[52:53], 0
    s_nop 4
    v_cvt_pk_bf16_f32 v44, v68, v69
    v_cvt_pk_bf16_f32 v45, v70, v71
    v_cvt_pk_bf16_f32 v46, v28, v29
    v_cvt_pk_bf16_f32 v47, v30, v31
    v_cvt_pk_bf16_f32 v48, v72, v73
    v_cvt_pk_bf16_f32 v49, v74, v75
    v_cvt_pk_bf16_f32 v50, v32, v33
    v_cvt_pk_bf16_f32 v51, v34, v35
    s_branch L_midret
L_last:
    s_mov_b64 exec, 1
    ds_write_b32 v1, v18 offset:144
    s_mov_b64 exec, -1
    s_waitcnt vmcnt(0)
    v_readfirstlane_b32 s78, v14
    ds_read_b128 v[80:83], v26 offset:0
    ds_read_b64_tr_b16 v[104:105], v42 offset:8192
    ds_read_b64_tr_b16 v[106:107], v42 offset:8704
    ds_read_b128 v[84:87], v26 offset:2048
    ds_read_b128 v[88:91], v26 offset:4096
    ds_read_b128 v[92:95], v26 offset:6144
    ds_read_b64_tr_b16 v[108:109], v43 offset:8192
    ds_read_b64_tr_b16 v[110:111], v43 offset:8704
    ds_read_b128 v[60:63], v27 offset:0
    ds_read_b64_tr_b16 v[96:97], v42 offset:12288
    ds_read_b64_tr_b16 v[98:99], v42 offset:12800
    ds_read_b128 v[64:67], v27 offset:2048
    ds_read_b128 v[68:71], v27 offset:4096
    ds_read_b128 v[72:75], v27 offset:6144
    ds_read_b64_tr_b16 v[100:101], v43 offset:12288
    ds_read_b64_tr_b16 v[102:103], v43 offset:12800
    v_mfma_f32_16x16x32_bf16 v[192:195], v[144:147], v[120:123], v[192:195]
    v_mfma_f32_16x16x32_bf16 v[196:199], v[144:147], v[124:127], v[196:199]
    v_mfma_f32_16x16x32_bf16 v[200:203], v[144:147], v[128:131], v[200:203]
    v_mfma_f32_16x16x32_bf16 v[204:207], v[144:147], v[132:135], v[204:207]
    s_waitcnt lgkmcnt(8)
    ds_read_b64_tr_b16 v[112:113], v42 offset:16384
    ds_read_b64_tr_b16 v[114:115], v42 offset:16896
    ds_read_b64_tr_b16 v[116:117], v43 offset:16384
    ds_read_b64_tr_b16 v[118:119], v43 offset:16896
    v_mfma_f32_16x16x32_bf16 v[220:223], v[148:151], v[132:135], v[220:223]
    ds_read_b64_tr_b16 v[28:29], v42 offset:20480
    ds_read_b64_tr_b16 v[30:31], v42 offset:20992
    v_mfma_f32_16x16x32_bf16 v[216:219], v[148:151], v[128:131], v[216:219]
    ds_read_b64_tr_b16 v[32:33], v43 offset:20480
    ds_read_b64_tr_b16 v[34:35], v43 offset:20992
    v_mfma_f32_16x16x32_bf16 v[212:215], v[148:151], v[124:127], v[212:215]
    s_waitcnt lgkmcnt(8)
    v_mfma_f32_16x16x32_bf16 v[208:211], v[148:151], v[120:123], v[208:211]
    v_mfma_f32_16x16x32_bf16 v[192:195], v[104:107], v[80:83], v[192:195]
    v_mfma_f32_16x16x32_bf16 v[196:199], v[104:107], v[84:87], v[196:199]
    v_mfma_f32_16x16x32_bf16 v[200:203], v[104:107], v[88:91], v[200:203]
    v_mfma_f32_16x16x32_bf16 v[204:207], v[104:107], v[92:95], v[204:207]
    v_mfma_f32_16x16x32_bf16 v[220:223], v[108:111], v[92:95], v[220:223]
    s_waitcnt lgkmcnt(0)
    v_mfma_f32_16x16x32_bf16 v[216:219], v[108:111], v[88:91], v[216:219]
    v_mfma_f32_16x16x32_bf16 v[212:215], v[108:111], v[84:87], v[212:215]
    v_mfma_f32_16x16x32_bf16 v[208:211], v[108:111], v[80:83], v[208:211]
    v_mfma_f32_16x16x32_bf16 v[192:195], v[96:99], v[60:63], v[192:195]
    v_mfma_f32_16x16x32_bf16 v[196:199], v[96:99], v[64:67], v[196:199]
    v_mfma_f32_16x16x32_bf16 v[200:203], v[96:99], v[68:71], v[200:203]
    s_nop 5
    v_cvt_pk_bf16_f32 v192, v192, v193
    v_cvt_pk_bf16_f32 v193, v194, v195
    v_mfma_f32_16x16x32_bf16 v[204:207], v[96:99], v[72:75], v[204:207]
    v_cvt_pk_bf16_f32 v196, v196, v197
    v_cvt_pk_bf16_f32 v197, v198, v199
    v_mfma_f32_16x16x32_bf16 v[220:223], v[100:103], v[72:75], v[220:223]
    v_cvt_pk_bf16_f32 v200, v200, v201
    v_cvt_pk_bf16_f32 v201, v202, v203
    v_mfma_f32_16x16x32_bf16 v[216:219], v[100:103], v[68:71], v[216:219]
    s_nop 1
    v_cvt_pk_bf16_f32 v204, v204, v205
    v_cvt_pk_bf16_f32 v205, v206, v207
    v_mfma_f32_16x16x32_bf16 v[212:215], v[100:103], v[64:67], v[212:215]
    v_cvt_pk_bf16_f32 v206, v220, v221
    v_cvt_pk_bf16_f32 v207, v222, v223
    v_mfma_f32_16x16x32_bf16 v[208:211], v[100:103], v[60:63], v[208:211]
    v_cvt_pk_bf16_f32 v202, v216, v217
    v_cvt_pk_bf16_f32 v203, v218, v219
    v_mfma_f32_16x16x32_bf16 v[188:191], v[140:143], v[132:135], v[188:191]
    s_nop 1
    v_cvt_pk_bf16_f32 v198, v212, v213
    v_cvt_pk_bf16_f32 v199, v214, v215
    v_mfma_f32_16x16x32_bf16 v[184:187], v[140:143], v[128:131], v[184:187]
    v_cvt_pk_bf16_f32 v194, v208, v209
    v_cvt_pk_bf16_f32 v195, v210, v211
    v_mfma_f32_16x16x32_bf16 v[180:183], v[140:143], v[124:127], v[180:183]
    v_mfma_f32_16x16x32_bf16 v[176:179], v[140:143], v[120:123], v[176:179]
    v_mfma_f32_16x16x32_bf16 v[96:99], v[44:47], v[192:195], 0
    v_mfma_f32_16x16x32_bf16 v[104:107], v[44:47], v[196:199], 0
    v_mfma_f32_16x16x32_bf16 v[144:147], v[44:47], v[200:203], 0
    s_nop 5
    v_cvt_pk_bf16_f32 v208, v96, v97
    v_cvt_pk_bf16_f32 v209, v98, v99
    v_mfma_f32_16x16x32_bf16 v[136:139], v[44:47], v[204:207], 0
    v_cvt_pk_bf16_f32 v212, v104, v105
    v_cvt_pk_bf16_f32 v213, v106, v107
    v_mfma_f32_16x16x32_bf16 v[100:103], v[48:51], v[192:195], 0
    v_cvt_pk_bf16_f32 v216, v144, v145
    v_cvt_pk_bf16_f32 v217, v146, v147
    v_mfma_f32_16x16x32_bf16 v[108:111], v[48:51], v[196:199], 0
    s_nop 1
    v_cvt_pk_bf16_f32 v220, v136, v137
    v_cvt_pk_bf16_f32 v221, v138, v139
    v_mfma_f32_16x16x32_bf16 v[148:151], v[48:51], v[200:203], 0
    v_cvt_pk_bf16_f32 v210, v100, v101
    v_cvt_pk_bf16_f32 v211, v102, v103
    v_mfma_f32_16x16x32_bf16 v[140:143], v[48:51], v[204:207], 0
    v_cvt_pk_bf16_f32 v214, v108, v109
    v_cvt_pk_bf16_f32 v215, v110, v111
    v_lshlrev_b32 v96, 16, v208
    v_and_b32 v97, 0xffff0000, v208
    s_nop 0
    v_cvt_pk_bf16_f32 v218, v148, v149
    v_cvt_pk_bf16_f32 v219, v150, v151
    v_lshlrev_b32 v98, 16, v209
    v_lshlrev_b32 v104, 16, v212
    v_cvt_pk_bf16_f32 v222, v140, v141
    v_cvt_pk_bf16_f32 v223, v142, v143
    v_and_b32 v105, 0xffff0000, v212
    v_lshlrev_b32 v106, 16, v213
    v_lshlrev_b32 v144, 16, v216
    v_and_b32 v145, 0xffff0000, v216
    v_lshlrev_b32 v146, 16, v217
    v_lshlrev_b32 v136, 16, v220
    v_and_b32 v137, 0xffff0000, v220
    v_lshlrev_b32 v138, 16, v221
    v_and_b32 v99, 0xffff0000, v209
    v_lshlrev_b32 v100, 16, v210
    v_and_b32 v101, 0xffff0000, v210
    v_lshlrev_b32 v102, 16, v211
    v_and_b32 v103, 0xffff0000, v211
    v_and_b32 v107, 0xffff0000, v213
    v_lshlrev_b32 v108, 16, v214
    v_and_b32 v109, 0xffff0000, v214
    v_lshlrev_b32 v110, 16, v215
    v_and_b32 v111, 0xffff0000, v215
    v_and_b32 v147, 0xffff0000, v217
    v_lshlrev_b32 v148, 16, v218
    v_and_b32 v149, 0xffff0000, v218
    v_lshlrev_b32 v150, 16, v219
    v_and_b32 v151, 0xffff0000, v219
    v_and_b32 v139, 0xffff0000, v221
    v_lshlrev_b32 v140, 16, v222
    v_and_b32 v141, 0xffff0000, v222
    v_lshlrev_b32 v142, 16, v223
    v_and_b32 v143, 0xffff0000, v223
    v_max3_f32 v192, v96, v97, v98
    v_min3_f32 v196, v96, v97, v98
    v_max3_f32 v193, v104, v105, v106
    v_min3_f32 v197, v104, v105, v106
    v_max3_f32 v194, v144, v145, v146
    v_min3_f32 v198, v144, v145, v146
    v_max3_f32 v195, v136, v137, v138
    v_min3_f32 v199, v136, v137, v138
    v_max3_f32 v208, v99, v100, v101
    v_max3_f32 v192, v192, v102, v103
    v_min3_f32 v209, v99, v100, v101
    v_min3_f32 v196, v196, v102, v103
    v_max3_f32 v210, v107, v108, v109
    v_max3_f32 v193, v193, v110, v111
    v_min3_f32 v211, v107, v108, v109
    v_min3_f32 v197, v197, v110, v111
    v_max3_f32 v212, v147, v148, v149
    v_max3_f32 v194, v194, v150, v151
    v_min3_f32 v213, v147, v148, v149
    v_min3_f32 v198, v198, v150, v151
    v_max3_f32 v214, v139, v140, v141
    v_max3_f32 v195, v195, v142, v143
    v_min3_f32 v215, v139, v140, v141
    v_min3_f32 v199, v199, v142, v143
    v_max_f32 v192, v192, v208
    v_min_f32 v196, v196, v209
    v_max_f32 v193, v193, v210
    v_min_f32 v197, v197, v211
    v_max_f32 v194, v194, v212
    v_min_f32 v198, v198, v213
    v_max_f32 v195, v195, v214
    v_min_f32 v199, v199, v215
    v_permlane32_swap_b32 v192, v194
    v_permlane32_swap_b32 v193, v195
    v_permlane32_swap_b32 v196, v198
    v_permlane32_swap_b32 v197, v199
    v_max_f32 v192, v192, v194
    v_max_f32 v193, v193, v195
    v_min_f32 v196, v196, v198
    v_min_f32 v197, v197, v199
    v_permlane16_swap_b32 v192, v193
    v_mfma_f32_16x16x32_bf16 v[224:227], v[120:123], v[152:155], v[224:227]
    v_permlane16_swap_b32 v196, v197
    v_max_f32 v192, v192, v193
    v_min_f32 v196, v196, v197
    v_mfma_f32_16x16x32_bf16 v[232:235], v[128:131], v[152:155], v[232:235]
    v_cndmask_b32 v200, v196, v192, s[72:73]
    v_cndmask_b32 v204, v192, v196, s[72:73]
    v_mfma_f32_16x16x32_bf16 v[248:251], v[128:131], v[156:159], v[248:251]
    v_mul_f32 v200, s70, v200
    v_mul_f32 v204, s68, v204
    v_mfma_f32_16x16x32_bf16 v[240:243], v[120:123], v[156:159], v[240:243]
    v_mov_b32 v201, v200
    v_mov_b32 v205, v204
    v_mfma_f32_16x16x32_bf16 v[228:231], v[124:127], v[152:155], v[228:231]
    v_permlane16_swap_b32 v200, v201
    v_permlane16_swap_b32 v204, v205
    v_mfma_f32_16x16x32_bf16 v[236:239], v[132:135], v[152:155], v[236:239]
    v_mov_b32 v202, v200
    v_mov_b32 v203, v201
    v_mfma_f32_16x16x32_bf16 v[252:255], v[132:135], v[156:159], v[252:255]
    v_permlane32_swap_b32 v200, v202
    v_permlane32_swap_b32 v201, v203
    v_mfma_f32_16x16x32_bf16 v[244:247], v[124:127], v[156:159], v[244:247]
    v_mov_b32 v206, v204
    v_mov_b32 v207, v205
    v_mfma_f32_16x16x32_bf16 v[224:227], v[80:83], v[112:115], v[224:227]
    v_permlane32_swap_b32 v204, v206
    v_permlane32_swap_b32 v205, v207
    v_mfma_f32_16x16x32_bf16 v[232:235], v[88:91], v[112:115], v[232:235]
    v_mfma_f32_16x16x32_bf16 v[248:251], v[88:91], v[116:119], v[248:251]
    v_mfma_f32_16x16x32_bf16 v[240:243], v[80:83], v[116:119], v[240:243]
    v_pk_fma_f32 v[88:89], v[104:105], s[68:69], v[200:201] op_sel:[0,0,1] op_sel_hi:[1,0,1]
    v_pk_fma_f32 v[90:91], v[106:107], s[68:69], v[200:201] op_sel:[0,0,1] op_sel_hi:[1,0,1]
    v_mfma_f32_16x16x32_bf16 v[228:231], v[84:87], v[112:115], v[228:231]
    v_pk_fma_f32 v[80:81], v[96:97], s[68:69], v[200:201] op_sel_hi:[1,0,0]
    v_pk_fma_f32 v[82:83], v[98:99], s[68:69], v[200:201] op_sel_hi:[1,0,0]
    v_mfma_f32_16x16x32_bf16 v[236:239], v[92:95], v[112:115], v[236:239]
    v_exp_f32 v80, v80
    v_mfma_f32_16x16x32_bf16 v[252:255], v[92:95], v[116:119], v[252:255]
    v_exp_f32 v81, v81
    v_mfma_f32_16x16x32_bf16 v[244:247], v[84:87], v[116:119], v[244:247]
    v_pk_fma_f32 v[92:93], v[108:109], s[68:69], v[200:201] op_sel:[0,0,1] op_sel_hi:[1,0,1]
    v_exp_f32 v82, v82
    v_mfma_f32_16x16x32_bf16 v[224:227], v[60:63], v[28:31], v[224:227]
    v_pk_fma_f32 v[84:85], v[100:101], s[68:69], v[200:201] op_sel_hi:[1,0,0]
    v_exp_f32 v83, v83
    v_mfma_f32_16x16x32_bf16 v[232:235], v[68:71], v[28:31], v[232:235]
    v_exp_f32 v88, v88
    v_mfma_f32_16x16x32_bf16 v[248:251], v[68:71], v[32:35], v[248:251]
    v_exp_f32 v89, v89
    v_mfma_f32_16x16x32_bf16 v[240:243], v[60:63], v[32:35], v[240:243]
    v_pk_fma_f32 v[68:69], v[136:137], s[68:69], v[202:203] op_sel:[0,0,1] op_sel_hi:[1,0,1]
    v_pk_fma_f32 v[70:71], v[138:139], s[68:69], v[202:203] op_sel:[0,0,1] op_sel_hi:[1,0,1]
    v_mfma_f32_16x16x32_bf16 v[228:231], v[64:67], v[28:31], v[228:231]
    v_pk_fma_f32 v[60:61], v[144:145], s[68:69], v[202:203] op_sel_hi:[1,0,0]
    v_pk_fma_f32 v[62:63], v[146:147], s[68:69], v[202:203] op_sel_hi:[1,0,0]
    v_mfma_f32_16x16x32_bf16 v[236:239], v[72:75], v[28:31], v[236:239]
    v_exp_f32 v90, v90
    v_mfma_f32_16x16x32_bf16 v[252:255], v[72:75], v[32:35], v[252:255]
    v_exp_f32 v91, v91
    v_mfma_f32_16x16x32_bf16 v[244:247], v[64:67], v[32:35], v[244:247]
    v_pk_fma_f32 v[72:73], v[140:141], s[68:69], v[202:203] op_sel:[0,0,1] op_sel_hi:[1,0,1]
    v_exp_f32 v60, v60
    v_pk_fma_f32 v[64:65], v[148:149], s[68:69], v[202:203] op_sel_hi:[1,0,0]
    v_exp_f32 v61, v61
    v_exp_f32 v62, v62
    v_exp_f32 v63, v63
    v_exp_f32 v68, v68
    v_exp_f32 v69, v69
    v_exp_f32 v70, v70
    v_exp_f32 v71, v71
    v_pk_fma_f32 v[86:87], v[102:103], s[68:69], v[200:201] op_sel_hi:[1,0,0]
    v_pk_fma_f32 v[94:95], v[110:111], s[68:69], v[200:201] op_sel:[0,0,1] op_sel_hi:[1,0,1]
    v_pk_fma_f32 v[66:67], v[150:151], s[68:69], v[202:203] op_sel_hi:[1,0,0]
    v_pk_fma_f32 v[74:75], v[142:143], s[68:69], v[202:203] op_sel:[0,0,1] op_sel_hi:[1,0,1]
    v_exp_f32 v84, v84
    v_exp_f32 v85, v85
    v_exp_f32 v92, v92
    v_exp_f32 v93, v93
    v_exp_f32 v64, v64
    v_exp_f32 v65, v65
    v_exp_f32 v72, v72
    v_exp_f32 v73, v73
    v_pk_add_f32 v[208:209], v[80:81], v[82:83]
    v_pk_add_f32 v[210:211], v[88:89], v[90:91]
    v_pk_add_f32 v[212:213], v[60:61], v[62:63]
    v_pk_add_f32 v[214:215], v[68:69], v[70:71]
    v_exp_f32 v86, v86
    v_exp_f32 v87, v87
    v_exp_f32 v94, v94
    v_exp_f32 v95, v95
    v_exp_f32 v66, v66
    v_exp_f32 v67, v67
    v_exp_f32 v74, v74
    v_exp_f32 v75, v75
    v_pk_add_f32 v[208:209], v[208:209], v[84:85]
    v_pk_add_f32 v[210:211], v[210:211], v[92:93]
    v_pk_add_f32 v[212:213], v[212:213], v[64:65]
    v_pk_add_f32 v[214:215], v[214:215], v[72:73]
    v_pk_add_f32 v[208:209], v[208:209], v[86:87]
    v_pk_add_f32 v[210:211], v[210:211], v[94:95]
    v_pk_add_f32 v[212:213], v[212:213], v[66:67]
    v_pk_add_f32 v[214:215], v[214:215], v[74:75]
    v_add_f32 v192, v208, v209
    v_add_f32 v193, v210, v211
    v_add_f32 v194, v212, v213
    v_add_f32 v195, v214, v215
    v_pk_fma_f32 v[96:97], v[96:97], s[70:71], v[204:205] op_sel_hi:[1,0,0]
    v_permlane32_swap_b32 v192, v194
    v_permlane32_swap_b32 v193, v195
    v_add_f32 v192, v192, v194
    v_add_f32 v193, v193, v195
    v_pk_fma_f32 v[98:99], v[98:99], s[70:71], v[204:205] op_sel_hi:[1,0,0]
    v_pk_fma_f32 v[104:105], v[104:105], s[70:71], v[204:205] op_sel:[0,0,1] op_sel_hi:[1,0,1]
    v_permlane16_swap_b32 v192, v193
    v_pk_fma_f32 v[106:107], v[106:107], s[70:71], v[204:205] op_sel:[0,0,1] op_sel_hi:[1,0,1]
    v_add_f32 v192, v192, v193
    v_pk_fma_f32 v[144:145], v[144:145], s[70:71], v[206:207] op_sel_hi:[1,0,0]
    v_rcp_f32 v192, v192
    v_pk_fma_f32 v[146:147], v[146:147], s[70:71], v[206:207] op_sel_hi:[1,0,0]
    v_mov_b32 v193, v192
    v_pk_fma_f32 v[136:137], v[136:137], s[70:71], v[206:207] op_sel:[0,0,1] op_sel_hi:[1,0,1]
    v_pk_fma_f32 v[138:139], v[138:139], s[70:71], v[206:207] op_sel:[0,0,1] op_sel_hi:[1,0,1]
    v_permlane16_swap_b32 v192, v193
    v_pk_fma_f32 v[100:101], v[100:101], s[70:71], v[204:205] op_sel_hi:[1,0,0]
    v_mov_b32 v194, v192
    v_mov_b32 v195, v193
    v_pk_fma_f32 v[108:109], v[108:109], s[70:71], v[204:205] op_sel:[0,0,1] op_sel_hi:[1,0,1]
    v_permlane32_swap_b32 v192, v194
    v_permlane32_swap_b32 v193, v195
    v_pk_fma_f32 v[148:149], v[148:149], s[70:71], v[206:207] op_sel_hi:[1,0,0]
    v_pk_mul_f32 v[80:81], v[80:81], v[192:193] op_sel_hi:[1,0]
    v_pk_mul_f32 v[88:89], v[88:89], v[192:193] op_sel:[0,1] op_sel_hi:[1,1]
    v_pk_mul_f32 v[60:61], v[60:61], v[194:195] op_sel_hi:[1,0]
    v_pk_mul_f32 v[68:69], v[68:69], v[194:195] op_sel:[0,1] op_sel_hi:[1,1]
    v_pk_mul_f32 v[82:83], v[82:83], v[192:193] op_sel_hi:[1,0]
    v_pk_mul_f32 v[90:91], v[90:91], v[192:193] op_sel:[0,1] op_sel_hi:[1,1]
    v_pk_mul_f32 v[62:63], v[62:63], v[194:195] op_sel_hi:[1,0]
    v_pk_mul_f32 v[70:71], v[70:71], v[194:195] op_sel:[0,1] op_sel_hi:[1,1]
    v_pk_mul_f32 v[84:85], v[84:85], v[192:193] op_sel_hi:[1,0]
    v_pk_mul_f32 v[86:87], v[86:87], v[192:193] op_sel_hi:[1,0]
    v_cvt_pk_bf16_f32 v80, v80, v81
    v_pk_mul_f32 v[92:93], v[92:93], v[192:193] op_sel:[0,1] op_sel_hi:[1,1]
    v_pk_mul_f32 v[94:95], v[94:95], v[192:193] op_sel:[0,1] op_sel_hi:[1,1]
    v_cvt_pk_bf16_f32 v88, v88, v89
    v_pk_mul_f32 v[64:65], v[64:65], v[194:195] op_sel_hi:[1,0]
    v_pk_mul_f32 v[66:67], v[66:67], v[194:195] op_sel_hi:[1,0]
    v_cvt_pk_bf16_f32 v60, v60, v61
    v_pk_mul_f32 v[72:73], v[72:73], v[194:195] op_sel:[0,1] op_sel_hi:[1,1]
    v_pk_mul_f32 v[74:75], v[74:75], v[194:195] op_sel:[0,1] op_sel_hi:[1,1]
    v_cvt_pk_bf16_f32 v68, v68, v69
    v_cvt_pk_bf16_f32 v81, v82, v83
    v_cvt_pk_bf16_f32 v89, v90, v91
    v_cvt_pk_bf16_f32 v61, v62, v63
    v_cvt_pk_bf16_f32 v69, v70, v71
    v_cvt_pk_bf16_f32 v82, v84, v85
    v_cvt_pk_bf16_f32 v83, v86, v87
    v_cvt_pk_bf16_f32 v90, v92, v93
    v_cvt_pk_bf16_f32 v91, v94, v95
    v_cvt_pk_bf16_f32 v62, v64, v65
    v_cvt_pk_bf16_f32 v63, v66, v67
    v_cvt_pk_bf16_f32 v70, v72, v73
    v_cvt_pk_bf16_f32 v71, v74, v75
    v_pk_fma_f32 v[140:141], v[140:141], s[70:71], v[206:207] op_sel:[0,0,1] op_sel_hi:[1,0,1]
    v_exp_f32 v96, v96
    v_exp_f32 v97, v97
    v_exp_f32 v98, v98
    v_exp_f32 v99, v99
    v_exp_f32 v104, v104
    v_exp_f32 v105, v105
    v_exp_f32 v106, v106
    v_exp_f32 v107, v107
    v_exp_f32 v144, v144
    v_exp_f32 v145, v145
    v_exp_f32 v146, v146
    v_exp_f32 v147, v147
    v_exp_f32 v136, v136
    v_exp_f32 v137, v137
    v_exp_f32 v138, v138
    v_exp_f32 v139, v139
    v_pk_fma_f32 v[102:103], v[102:103], s[70:71], v[204:205] op_sel_hi:[1,0,0]
    v_pk_fma_f32 v[110:111], v[110:111], s[70:71], v[204:205] op_sel:[0,0,1] op_sel_hi:[1,0,1]
    v_pk_fma_f32 v[150:151], v[150:151], s[70:71], v[206:207] op_sel_hi:[1,0,0]
    v_pk_fma_f32 v[142:143], v[142:143], s[70:71], v[206:207] op_sel:[0,0,1] op_sel_hi:[1,0,1]
    v_exp_f32 v100, v100
    v_exp_f32 v101, v101
    v_exp_f32 v108, v108
    v_exp_f32 v109, v109
    v_exp_f32 v148, v148
    v_exp_f32 v149, v149
    v_exp_f32 v140, v140
    v_exp_f32 v141, v141
    v_pk_add_f32 v[216:217], v[96:97], v[98:99]
    v_pk_add_f32 v[218:219], v[104:105], v[106:107]
    v_pk_add_f32 v[220:221], v[144:145], v[146:147]
    v_pk_add_f32 v[222:223], v[136:137], v[138:139]
    v_exp_f32 v102, v102
    v_exp_f32 v103, v103
    v_exp_f32 v110, v110
    v_exp_f32 v111, v111
    v_exp_f32 v150, v150
    v_exp_f32 v151, v151
    v_exp_f32 v142, v142
    v_exp_f32 v143, v143
    v_pk_add_f32 v[216:217], v[216:217], v[100:101]
    v_pk_add_f32 v[218:219], v[218:219], v[108:109]
    v_pk_add_f32 v[220:221], v[220:221], v[148:149]
    v_pk_add_f32 v[222:223], v[222:223], v[140:141]
    v_pk_add_f32 v[216:217], v[216:217], v[102:103]
    v_pk_add_f32 v[218:219], v[218:219], v[110:111]
    v_pk_add_f32 v[220:221], v[220:221], v[150:151]
    v_pk_add_f32 v[222:223], v[222:223], v[142:143]
    v_add_f32 v196, v216, v217
    v_add_f32 v197, v218, v219
    v_add_f32 v198, v220, v221
    v_add_f32 v199, v222, v223
    v_mfma_f32_16x16x16_bf16 v[120:123], v[80:81], v[52:53], 0
    v_permlane32_swap_b32 v196, v198
    v_permlane32_swap_b32 v197, v199
    v_add_f32 v196, v196, v198
    v_add_f32 v197, v197, v199
    v_mfma_f32_16x16x16_bf16 v[124:127], v[88:89], v[52:53], 0
    s_nop 0
    v_permlane16_swap_b32 v196, v197
    v_cvt_pk_bf16_f32 v224, v224, v225
    v_mfma_f32_16x16x16_bf16 v[128:131], v[60:61], v[52:53], 0
    v_add_f32 v196, v196, v197
    v_cvt_pk_bf16_f32 v120, v120, v121
    v_mfma_f32_16x16x16_bf16 v[132:135], v[68:69], v[52:53], 0
    v_rcp_f32 v196, v196
    v_mfma_f32_16x16x16_bf16 v[112:115], v[82:83], v[52:53], 0
    v_mov_b32 v197, v196
    v_cvt_pk_bf16_f32 v225, v226, v227
    v_mfma_f32_16x16x16_bf16 v[116:119], v[90:91], v[52:53], 0
    v_cvt_pk_bf16_f32 v121, v122, v123
    v_cvt_pk_bf16_f32 v226, v228, v229
    v_mfma_f32_16x16x16_bf16 v[152:155], v[62:63], v[52:53], 0
    v_cvt_pk_bf16_f32 v227, v230, v231
    v_cvt_pk_bf16_f32 v122, v124, v125
    v_mfma_f32_16x16x16_bf16 v[156:159], v[70:71], v[52:53], 0
    v_cvt_pk_bf16_f32 v123, v126, v127
    v_permlane16_swap_b32 v196, v197
    v_cvt_pk_bf16_f32 v240, v240, v241
    v_cvt_pk_bf16_f32 v232, v232, v233
    v_cvt_pk_bf16_f32 v241, v242, v243
    v_cvt_pk_bf16_f32 v128, v128, v129
    v_mov_b32 v198, v196
    v_mov_b32 v199, v197
    v_cvt_pk_bf16_f32 v233, v234, v235
    v_cvt_pk_bf16_f32 v242, v244, v245
    v_cvt_pk_bf16_f32 v243, v246, v247
    v_cvt_pk_bf16_f32 v129, v130, v131
    v_mfma_f32_16x16x32_bf16 v[228:231], v[120:123], v[224:227], 0
    v_cvt_pk_bf16_f32 v234, v236, v237
    v_cvt_pk_bf16_f32 v235, v238, v239
    v_cvt_pk_bf16_f32 v130, v132, v133
    v_cvt_pk_bf16_f32 v131, v134, v135
    v_cvt_pk_bf16_f32 v112, v112, v113
    v_cvt_pk_bf16_f32 v248, v248, v249
    v_cvt_pk_bf16_f32 v113, v114, v115
    v_permlane32_swap_b32 v196, v198
    v_permlane32_swap_b32 v197, v199
    v_cvt_pk_bf16_f32 v249, v250, v251
    v_cvt_pk_bf16_f32 v114, v116, v117
    v_cvt_pk_bf16_f32 v115, v118, v119
    v_mfma_f32_16x16x32_bf16 v[236:239], v[120:123], v[240:243], 0
    v_cvt_pk_bf16_f32 v250, v252, v253
    v_cvt_pk_bf16_f32 v251, v254, v255
    v_mfma_f32_16x16x32_bf16 v[228:231], v[128:131], v[232:235], v[228:231]
    v_pk_mul_f32 v[96:97], v[96:97], v[196:197] op_sel_hi:[1,0]
    v_cvt_pk_bf16_f32 v152, v152, v153
    v_pk_mul_f32 v[98:99], v[98:99], v[196:197] op_sel_hi:[1,0]
    v_cvt_pk_bf16_f32 v153, v154, v155
    v_mfma_f32_16x16x32_bf16 v[244:247], v[112:115], v[224:227], 0
    v_cvt_pk_bf16_f32 v96, v96, v97
    v_pk_mul_f32 v[104:105], v[104:105], v[196:197] op_sel:[0,1] op_sel_hi:[1,1]
    v_cvt_pk_bf16_f32 v154, v156, v157
    v_cvt_pk_bf16_f32 v155, v158, v159
    v_mfma_f32_16x16x32_bf16 v[236:239], v[128:131], v[248:251], v[236:239]
    v_cvt_pk_bf16_f32 v97, v98, v99
    v_pk_mul_f32 v[106:107], v[106:107], v[196:197] op_sel:[0,1] op_sel_hi:[1,1]
    v_cvt_pk_bf16_f32 v104, v104, v105
    v_pk_mul_f32 v[144:145], v[144:145], v[198:199] op_sel_hi:[1,0]
    v_mfma_f32_16x16x32_bf16 v[252:255], v[112:115], v[240:243], 0
    v_cvt_pk_bf16_f32 v105, v106, v107
    v_pk_mul_f32 v[146:147], v[146:147], v[198:199] op_sel_hi:[1,0]
    v_mfma_f32_16x16x32_bf16 v[244:247], v[152:155], v[232:235], v[244:247]
    v_cvt_pk_bf16_f32 v144, v144, v145
    v_pk_mul_f32 v[136:137], v[136:137], v[198:199] op_sel:[0,1] op_sel_hi:[1,1]
    v_mfma_f32_16x16x16_bf16 v[80:83], v[96:97], v[52:53], 0
    v_cvt_pk_bf16_f32 v145, v146, v147
    v_pk_mul_f32 v[138:139], v[138:139], v[198:199] op_sel:[0,1] op_sel_hi:[1,1]
    v_mfma_f32_16x16x32_bf16 v[76:79], v[120:123], v[56:59], 0
    v_cvt_pk_bf16_f32 v136, v136, v137
    v_cvt_pk_bf16_f32 v137, v138, v139
    v_mfma_f32_16x16x16_bf16 v[84:87], v[104:105], v[52:53], 0
    ds_write_b128 v4, v[228:231] offset:0
    v_mfma_f32_16x16x32_bf16 v[252:255], v[152:155], v[248:251], v[252:255]
    v_pk_mul_f32 v[100:101], v[100:101], v[196:197] op_sel_hi:[1,0]
    v_pk_mul_f32 v[102:103], v[102:103], v[196:197] op_sel_hi:[1,0]
    v_mfma_f32_16x16x16_bf16 v[88:91], v[144:145], v[52:53], 0
    ds_write_b128 v4, v[236:239] offset:1024
    v_mfma_f32_16x16x32_bf16 v[20:23], v[112:115], v[56:59], 0
    v_cvt_pk_bf16_f32 v98, v100, v101
    v_cvt_pk_bf16_f32 v99, v102, v103
    v_mfma_f32_16x16x32_bf16 v[76:79], v[128:131], v[56:59], v[76:79]
    v_pk_mul_f32 v[108:109], v[108:109], v[196:197] op_sel:[0,1] op_sel_hi:[1,1]
    v_pk_mul_f32 v[110:111], v[110:111], v[196:197] op_sel:[0,1] op_sel_hi:[1,1]
    v_mfma_f32_16x16x16_bf16 v[92:95], v[136:137], v[52:53], 0
    v_cvt_pk_bf16_f32 v106, v108, v109
    v_cvt_pk_bf16_f32 v107, v110, v111
    v_mfma_f32_16x16x32_bf16 v[20:23], v[152:155], v[56:59], v[20:23]
    v_pk_mul_f32 v[148:149], v[148:149], v[198:199] op_sel_hi:[1,0]
    v_pk_mul_f32 v[150:151], v[150:151], v[198:199] op_sel_hi:[1,0]
    ds_write_b128 v4, v[244:247] offset:2048
    v_mfma_f32_16x16x16_bf16 v[60:63], v[98:99], v[52:53], 0
    v_cvt_pk_bf16_f32 v80, v80, v81
    v_cvt_pk_bf16_f32 v146, v148, v149
    v_cvt_pk_bf16_f32 v147, v150, v151
    v_pk_mul_f32 v[140:141], v[140:141], v[198:199] op_sel:[0,1] op_sel_hi:[1,1]
    v_pk_mul_f32 v[142:143], v[142:143], v[198:199] op_sel:[0,1] op_sel_hi:[1,1]
    v_cvt_pk_bf16_f32 v81, v82, v83
    v_mfma_f32_16x16x16_bf16 v[64:67], v[106:107], v[52:53], 0
    v_cvt_pk_bf16_f32 v82, v84, v85
    v_cvt_pk_bf16_f32 v83, v86, v87
    ds_write_b128 v4, v[252:255] offset:3072
    v_cvt_pk_bf16_f32 v138, v140, v141
    v_cvt_pk_bf16_f32 v139, v142, v143
    v_mfma_f32_16x16x16_bf16 v[68:71], v[146:147], v[52:53], 0
    v_cvt_pk_bf16_f32 v88, v88, v89
    v_cvt_pk_bf16_f32 v89, v90, v91
    v_mfma_f32_16x16x32_bf16 v[192:195], v[80:83], v[224:227], 0
    ds_write_b128 v4, v[76:79] offset:4096
    v_mfma_f32_16x16x32_bf16 v[196:199], v[80:83], v[240:243], 0
    v_cvt_pk_bf16_f32 v90, v92, v93
    v_cvt_pk_bf16_f32 v91, v94, v95
    v_mfma_f32_16x16x32_bf16 v[208:211], v[80:83], v[56:59], 0
    ds_write_b128 v4, v[20:23] offset:5120
    v_mfma_f32_16x16x16_bf16 v[72:75], v[138:139], v[52:53], 0
    v_cvt_pk_bf16_f32 v60, v60, v61
    v_cvt_pk_bf16_f32 v61, v62, v63
    v_mfma_f32_16x16x32_bf16 v[192:195], v[88:91], v[232:235], v[192:195]
    ds_write_b32 v6, v18
    v_cvt_pk_bf16_f32 v62, v64, v65
    v_mfma_f32_16x16x32_bf16 v[196:199], v[88:91], v[248:251], v[196:199]
    v_cvt_pk_bf16_f32 v63, v66, v67
    v_cvt_pk_bf16_f32 v68, v68, v69
    v_mfma_f32_16x16x32_bf16 v[208:211], v[88:91], v[56:59], v[208:211]
    v_cvt_pk_bf16_f32 v69, v70, v71
    v_cvt_pk_bf16_f32 v70, v72, v73
    ds_read_b32 v19, v7
    ds_read_b128 v[36:39], v13 offset:240
    v_mfma_f32_16x16x32_bf16 v[200:203], v[60:63], v[224:227], 0
    ds_read_b128 v[120:123], v5 offset:0
    v_cvt_pk_bf16_f32 v71, v74, v75
    v_mfma_f32_16x16x32_bf16 v[204:207], v[60:63], v[240:243], 0
    ds_read_b128 v[124:127], v5 offset:1024
    ds_read_b128 v[128:131], v5 offset:2048
    v_mfma_f32_16x16x32_bf16 v[212:215], v[60:63], v[56:59], 0
    ds_read_b128 v[132:135], v5 offset:3072
    ds_read_b128 v[112:115], v5 offset:4096
    v_mfma_f32_16x16x32_bf16 v[200:203], v[68:71], v[232:235], v[200:203]
    ds_read_b128 v[116:119], v5 offset:5120
    v_mfma_f32_16x16x32_bf16 v[204:207], v[68:71], v[248:251], v[204:207]
    v_mfma_f32_16x16x32_bf16 v[212:215], v[68:71], v[56:59], v[212:215]
L_tg25:
    s_cmp_lg_u32 s78, 0
    s_cbranch_scc1 L_tk26
    buffer_load_dword v14, v13, s[36:39], 0 offen offset:4 sc1
    s_waitcnt vmcnt(0)
    v_readfirstlane_b32 s78, v14
    s_add_u32 s79, s79, 1
    s_cmp_lt_u32 s79, 32768
    s_cbranch_scc1 L_tg25
L_tk26:
    s_mul_i32 s80, s78, 0x9e3779b1
    s_lshr_b32 s80, s80, 22
    s_mul_i32 s81, s78, 0x85ebca77
    s_lshr_b32 s81, s81, 22
    s_mul_i32 s82, s78, 0xc2b2ae3d
    s_lshr_b32 s82, s82, 22
    s_mul_i32 s83, s78, 0x27d4eb2f
    s_lshr_b32 s83, s83, 22
L_ex27:
    s_waitcnt lgkmcnt(0)
    v_and_b32 v36, v36, v37
    v_and_b32 v38, v38, v39
    v_and_b32 v36, v36, v38
    v_or_b32 v37, 1, v36
    v_and_b32 v37, v37, v19
    v_readfirstlane_b32 s30, v36
    v_cmp_ne_u32 vcc, v37, v18
    s_cbranch_vccz L_ek28
    ds_read_b32 v19, v7
    ds_read_b128 v[36:39], v13 offset:240
    ds_read_b128 v[120:123], v5 offset:0
    ds_read_b128 v[124:127], v5 offset:1024
    ds_read_b128 v[128:131], v5 offset:2048
    ds_read_b128 v[132:135], v5 offset:3072
    ds_read_b128 v[112:115], v5 offset:4096
    ds_read_b128 v[116:119], v5 offset:5120
    s_add_u32 s79, s79, 1
    s_cmp_lt_u32 s79, 32768
    s_cbranch_scc1 L_ex27
    s_waitcnt lgkmcnt(0)
L_ek28:
    s_cmp_eq_u32 s30, 0x7fc17fc1
    s_cbranch_scc0 L_k2s
    v_pk_add_f32 v[192:193], v[192:193], v[120:121]
    v_pk_add_f32 v[194:195], v[194:195], v[122:123]
    v_bfi_b32 v192, v15, s80, v192
    v_bfi_b32 v193, v15, s81, v193
    v_bfi_b32 v194, v15, s82, v194
    v_bfi_b32 v195, v15, s83, v195
    v_pk_add_f32 v[196:197], v[196:197], v[124:125]
    v_pk_add_f32 v[198:199], v[198:199], v[126:127]
    v_bfi_b32 v196, v15, s80, v196
    v_bfi_b32 v197, v15, s81, v197
    v_bfi_b32 v198, v15, s82, v198
    v_bfi_b32 v199, v15, s83, v199
    v_pk_add_f32 v[200:201], v[200:201], v[128:129]
    v_pk_add_f32 v[202:203], v[202:203], v[130:131]
    buffer_store_dwordx4 v[192:195], v3, s[32:35], s48 offen
    s_add_u32 s48, s48, 16384
    v_bfi_b32 v200, v15, s80, v200
    v_bfi_b32 v201, v15, s81, v201
    v_bfi_b32 v202, v15, s82, v202
    v_bfi_b32 v203, v15, s83, v203
    v_pk_add_f32 v[204:205], v[204:205], v[132:133]
    v_pk_add_f32 v[206:207], v[206:207], v[134:135]
    buffer_store_dwordx4 v[196:199], v3, s[32:35], s48 offen
    s_add_u32 s48, s48, 16384
    v_bfi_b32 v204, v15, s80, v204
    v_bfi_b32 v205, v15, s81, v205
    v_bfi_b32 v206, v15, s82, v206
    v_bfi_b32 v207, v15, s83, v207
    v_pk_add_f32 v[208:209], v[208:209], v[112:113]
    v_pk_add_f32 v[210:211], v[210:211], v[114:115]
    v_pk_add_f32 v[212:213], v[212:213], v[116:117]
    v_pk_add_f32 v[214:215], v[214:215], v[118:119]
    buffer_store_dwordx4 v[200:203], v3, s[32:35], s48 offen
    s_add_u32 s48, s48, 16384
    v_bfi_b32 v208, v15, s80, v208
    v_bfi_b32 v209, v15, s81, v209
    v_bfi_b32 v210, v15, s82, v210
    v_bfi_b32 v211, v15, s83, v211
    v_bfi_b32 v212, v15, s80, v212
    v_bfi_b32 v213, v15, s81, v213
    v_bfi_b32 v214, v15, s82, v214
    v_bfi_b32 v215, v15, s83, v215
    buffer_store_dwordx4 v[204:207], v3, s[32:35], s48 offen
    s_mov_b32 exec_lo, 0x10001
    s_mov_b32 exec_hi, 0x10001
    buffer_store_dwordx4 v[208:211], v8, s[32:35], s49 offen offset:0
    buffer_store_dwordx4 v[212:215], v8, s[32:35], s49 offen offset:1024
    s_mov_b64 exec, -1
L_k2r:
    s_mov_b32 s19, s50
    buffer_load_dwordx4 v[192:195], v9, s[32:35], s19 offen sc1
    s_add_u32 s19, s19, 4096
    buffer_load_dwordx4 v[196:199], v9, s[32:35], s19 offen sc1
    s_add_u32 s19, s19, 4096
    buffer_load_dwordx4 v[200:203], v9, s[32:35], s19 offen sc1
    s_add_u32 s19, s19, 4096
    buffer_load_dwordx4 v[204:207], v9, s[32:35], s19 offen sc1
    buffer_load_dwordx2 v[208:209], v10, s[32:35], s51 offen sc1
    s_mov_b64 exec, 1
    ds_write_b32 v1, v18 offset:176
    s_mov_b64 exec, -1
    ds_read_b128 v[80:83], v26 offset:0
    ds_read_b64_tr_b16 v[96:97], v42 offset:0
    ds_read_b64_tr_b16 v[98:99], v42 offset:512
    ds_read_b128 v[84:87], v26 offset:2048
    ds_read_b128 v[88:91], v26 offset:4096
    ds_read_b128 v[92:95], v26 offset:6144
    ds_read_b64_tr_b16 v[100:101], v43 offset:0
    ds_read_b64_tr_b16 v[102:103], v43 offset:512
    ds_read_b128 v[60:63], v27 offset:0
    ds_read_b64_tr_b16 v[104:105], v42 offset:4096
    ds_read_b64_tr_b16 v[106:107], v42 offset:4608
    ds_read_b128 v[64:67], v27 offset:2048
    ds_read_b128 v[68:71], v27 offset:4096
    ds_read_b128 v[72:75], v27 offset:6144
    ds_read_b64_tr_b16 v[108:109], v43 offset:4096
    ds_read_b64_tr_b16 v[110:111], v43 offset:4608
    s_mov_b64 exec, 1
    s_lshl_b32 s19, s58, 16
    s_add_u32 s19, s19, 8388608
    s_waitcnt lgkmcnt(8)
    s_waitcnt lgkmcnt(0)
    ds_write_b32 v1, v18 offset:160
    s_mov_b64 exec, -1
    v_mfma_f32_16x16x32_bf16 v[160:163], v[96:99], v[80:83], v[160:163]
    v_and_b32 v19, 1, v2
    v_mov_b32 v16, s80
    v_mfma_f32_16x16x32_bf16 v[164:167], v[96:99], v[84:87], v[164:167]
    v_cmp_eq_u32 vcc, 0, v19
    v_mov_b32 v54, s82
    v_mfma_f32_16x16x32_bf16 v[168:171], v[96:99], v[88:91], v[168:171]
    v_and_b32 v19, 15, v2
    v_cndmask_b32 v16, v54, v16, vcc
    v_mfma_f32_16x16x32_bf16 v[172:175], v[96:99], v[92:95], v[172:175]
    v_lshlrev_b32 v26, 11, v19
    v_and_b32 v54, 16, v2
    v_mfma_f32_16x16x32_bf16 v[188:191], v[100:103], v[92:95], v[188:191]
    v_lshl_add_u32 v26, v54, 1, v26
    v_and_b32 v54, 32, v2
    v_mfma_f32_16x16x32_bf16 v[184:187], v[100:103], v[88:91], v[184:187]
    v_lshrrev_b32 v54, 1, v54
    v_lshrrev_b32 v27, 1, v19
    v_mfma_f32_16x16x32_bf16 v[180:183], v[100:103], v[84:87], v[180:183]
    v_lshrrev_b32 v19, 2, v2
    v_add_u32 v26, v26, v54
    v_mfma_f32_16x16x32_bf16 v[176:179], v[100:103], v[80:83], v[176:179]
    v_lshlrev_b32 v20, 7, v19
    v_and_b32 v54, 3, v2
    v_mfma_f32_16x16x32_bf16 v[160:163], v[104:107], v[60:63], v[160:163]
    v_lshl_add_u32 v20, v54, 3, v20
    v_bfe_u32 v19, v2, 3, 2
    v_mfma_f32_16x16x32_bf16 v[164:167], v[104:107], v[64:67], v[164:167]
    v_add_u32 v24, s19, v3
    buffer_load_dwordx4 v[28:31], v26, s[24:27], s54 offen offset:0
    v_mfma_f32_16x16x32_bf16 v[168:171], v[104:107], v[68:71], v[168:171]
    s_nop 1
    v_cvt_pk_bf16_f32 v160, v160, v161
    v_cvt_pk_bf16_f32 v161, v162, v163
    v_mfma_f32_16x16x32_bf16 v[172:175], v[104:107], v[72:75], v[172:175]
    v_cvt_pk_bf16_f32 v164, v164, v165
    v_cvt_pk_bf16_f32 v165, v166, v167
    v_mfma_f32_16x16x32_bf16 v[188:191], v[108:111], v[72:75], v[188:191]
    v_cvt_pk_bf16_f32 v168, v168, v169
    v_cvt_pk_bf16_f32 v169, v170, v171
    v_mfma_f32_16x16x32_bf16 v[184:187], v[108:111], v[68:71], v[184:187]
    s_nop 1
    v_cvt_pk_bf16_f32 v172, v172, v173
    v_cvt_pk_bf16_f32 v173, v174, v175
    v_mfma_f32_16x16x32_bf16 v[180:183], v[108:111], v[64:67], v[180:183]
    v_cvt_pk_bf16_f32 v174, v188, v189
    v_cvt_pk_bf16_f32 v175, v190, v191
    v_mfma_f32_16x16x32_bf16 v[176:179], v[108:111], v[60:63], v[176:179]
    v_cvt_pk_bf16_f32 v170, v184, v185
    v_cvt_pk_bf16_f32 v171, v186, v187
    v_mfma_f32_16x16x32_bf16 v[136:139], v[44:47], v[172:175], 0
    s_nop 1
    v_cvt_pk_bf16_f32 v166, v180, v181
    v_cvt_pk_bf16_f32 v167, v182, v183
    v_mfma_f32_16x16x32_bf16 v[128:131], v[44:47], v[168:171], 0
    v_cvt_pk_bf16_f32 v162, v176, v177
    v_cvt_pk_bf16_f32 v163, v178, v179
    v_mfma_f32_16x16x32_bf16 v[120:123], v[44:47], v[164:167], 0
    v_cvt_pk_bf16_f32 v252, v136, v137
    v_cvt_pk_bf16_f32 v253, v138, v139
    v_mfma_f32_16x16x32_bf16 v[112:115], v[44:47], v[160:163], 0
    s_nop 1
    v_cvt_pk_bf16_f32 v248, v128, v129
    v_cvt_pk_bf16_f32 v249, v130, v131
    v_mfma_f32_16x16x32_bf16 v[116:119], v[48:51], v[160:163], 0
    v_cvt_pk_bf16_f32 v244, v120, v121
    v_cvt_pk_bf16_f32 v245, v122, v123
    v_mfma_f32_16x16x32_bf16 v[124:127], v[48:51], v[164:167], 0
    v_cvt_pk_bf16_f32 v240, v112, v113
    v_cvt_pk_bf16_f32 v241, v114, v115
    v_mfma_f32_16x16x32_bf16 v[132:135], v[48:51], v[168:171], 0
    s_nop 1
    v_cvt_pk_bf16_f32 v242, v116, v117
    v_cvt_pk_bf16_f32 v243, v118, v119
    v_mfma_f32_16x16x32_bf16 v[140:143], v[48:51], v[172:175], 0
    v_cvt_pk_bf16_f32 v246, v124, v125
    v_cvt_pk_bf16_f32 v247, v126, v127
    v_lshlrev_b32 v112, 16, v240
    v_and_b32 v113, 0xffff0000, v240
    v_cvt_pk_bf16_f32 v250, v132, v133
    v_cvt_pk_bf16_f32 v251, v134, v135
    v_lshlrev_b32 v114, 16, v241
    v_lshlrev_b32 v120, 16, v244
    v_cvt_pk_bf16_f32 v254, v140, v141
    v_cvt_pk_bf16_f32 v255, v142, v143
    v_and_b32 v121, 0xffff0000, v244
    v_lshlrev_b32 v122, 16, v245
    v_lshlrev_b32 v128, 16, v248
    v_and_b32 v129, 0xffff0000, v248
    v_lshlrev_b32 v130, 16, v249
    v_lshlrev_b32 v136, 16, v252
    v_and_b32 v137, 0xffff0000, v252
    v_lshlrev_b32 v138, 16, v253
    v_and_b32 v115, 0xffff0000, v241
    v_lshlrev_b32 v116, 16, v242
    v_and_b32 v117, 0xffff0000, v242
    v_lshlrev_b32 v118, 16, v243
    v_and_b32 v119, 0xffff0000, v243
    v_and_b32 v123, 0xffff0000, v245
    v_lshlrev_b32 v124, 16, v246
    v_and_b32 v125, 0xffff0000, v246
    v_lshlrev_b32 v126, 16, v247
    v_and_b32 v127, 0xffff0000, v247
    v_and_b32 v131, 0xffff0000, v249
    v_lshlrev_b32 v132, 16, v250
    v_and_b32 v133, 0xffff0000, v250
    v_lshlrev_b32 v134, 16, v251
    v_and_b32 v135, 0xffff0000, v251
    v_and_b32 v139, 0xffff0000, v253
    v_lshlrev_b32 v140, 16, v254
    v_and_b32 v141, 0xffff0000, v254
    v_lshlrev_b32 v142, 16, v255
    v_and_b32 v143, 0xffff0000, v255
    v_max3_f32 v176, v112, v113, v114
    v_min3_f32 v180, v112, v113, v114
    v_max3_f32 v177, v120, v121, v122
    v_min3_f32 v181, v120, v121, v122
    v_max3_f32 v178, v128, v129, v130
    v_min3_f32 v182, v128, v129, v130
    v_max3_f32 v179, v136, v137, v138
    v_min3_f32 v183, v136, v137, v138
    v_max3_f32 v240, v115, v116, v117
    v_max3_f32 v176, v176, v118, v119
    v_min3_f32 v241, v115, v116, v117
    v_min3_f32 v180, v180, v118, v119
    v_max3_f32 v242, v123, v124, v125
    v_max3_f32 v177, v177, v126, v127
    v_min3_f32 v243, v123, v124, v125
    v_min3_f32 v181, v181, v126, v127
    v_max3_f32 v244, v131, v132, v133
    v_max3_f32 v178, v178, v134, v135
    v_min3_f32 v245, v131, v132, v133
    v_min3_f32 v182, v182, v134, v135
    v_max3_f32 v246, v139, v140, v141
    v_max3_f32 v179, v179, v142, v143
    v_min3_f32 v247, v139, v140, v141
    v_min3_f32 v183, v183, v142, v143
    v_max_f32 v176, v176, v240
    v_min_f32 v180, v180, v241
    v_max_f32 v177, v177, v242
    v_min_f32 v181, v181, v243
    v_max_f32 v178, v178, v244
    v_min_f32 v182, v182, v245
    v_max_f32 v179, v179, v246
    v_min_f32 v183, v183, v247
    v_permlane32_swap_b32 v176, v178
    v_permlane32_swap_b32 v177, v179
    v_permlane32_swap_b32 v180, v182
    v_permlane32_swap_b32 v181, v183
    v_max_f32 v176, v176, v178
    v_max_f32 v177, v177, v179
    v_min_f32 v180, v180, v182
    v_min_f32 v181, v181, v183
    v_permlane16_swap_b32 v176, v177
    s_and_b32 s19, s13, 28
    v_permlane16_swap_b32 v180, v181
    v_max_f32 v176, v176, v177
    v_min_f32 v180, v180, v181
    v_mul_f32 v184, s76, v176
    v_mul_f32 v188, s74, v180
    v_mov_b32 v185, v184
    v_mov_b32 v189, v188
    buffer_load_dwordx4 v[32:35], v26, s[24:27], s54 offen offset:64
    v_permlane16_swap_b32 v184, v185
    v_permlane16_swap_b32 v188, v189
    v_lshl_add_u32 v20, v19, 5, v20
    v_add_u32 v4, s19, v2
    v_lshlrev_b32 v27, 3, v27
    buffer_load_dwordx4 v[36:39], v26, s[24:27], s55 offen offset:0
    v_mov_b32 v186, v184
    v_mov_b32 v187, v185
    v_mov_b32 v190, v188
    v_mov_b32 v191, v189
    v_mov_b32 v17, s81
    v_mov_b32 v55, s83
    buffer_load_dwordx4 v[40:43], v26, s[24:27], s55 offen offset:64
    v_add_u32 v20, 32768, v20
    v_and_b32 v4, 31, v4
    buffer_load_dwordx2 v[76:77], v27, s[32:35], s57 offen offset:0 sc1
    v_cndmask_b32 v17, v55, v17, vcc
    buffer_load_dwordx2 v[78:79], v27, s[32:35], s57 offen offset:64 sc1
    v_xor_b32 v21, 32, v20
    v_xor_b32 v22, 64, v20
    v_xor_b32 v23, 0x60, v20
    v_add_u32 v25, 32768, v24
    v_lshlrev_b32 v4, 2, v4
    v_permlane32_swap_b32 v184, v186
    v_permlane32_swap_b32 v185, v187
    v_permlane32_swap_b32 v188, v190
    v_permlane32_swap_b32 v189, v191
    s_waitcnt vmcnt(6)
L_h129:
    v_xor_b32 v111, s83, v207
    v_xor_b32 v92, v16, v208
    v_xor_b32 v93, v17, v209
    v_xor_b32 v96, s80, v192
    v_or3_b32 v215, v111, v92, v93
    v_permlane32_swap_b32 v92, v93
    v_xor_b32 v97, s81, v193
    v_add_f32 v92, v92, v93
    v_xor_b32 v98, s82, v194
    v_xor_b32 v99, s83, v195
    v_xor_b32 v100, s80, v196
    v_xor_b32 v101, s81, v197
    v_xor_b32 v102, s82, v198
    v_xor_b32 v103, s83, v199
    v_xor_b32 v104, s80, v200
    v_xor_b32 v105, s81, v201
    v_xor_b32 v106, s82, v202
    v_xor_b32 v107, s83, v203
    v_xor_b32 v108, s80, v204
    v_xor_b32 v109, s81, v205
    v_xor_b32 v110, s82, v206
    v_mov_b32 v93, v92
    v_or3_b32 v210, v96, v97, v98
    v_or3_b32 v211, v99, v100, v101
    v_or3_b32 v212, v102, v103, v104
    v_or3_b32 v213, v105, v106, v107
    v_pk_add_f32 v[96:97], v[96:97], v[100:101]
    v_pk_add_f32 v[104:105], v[104:105], v[108:109]
    v_pk_add_f32 v[98:99], v[98:99], v[102:103]
    v_pk_add_f32 v[106:107], v[106:107], v[110:111]
    v_permlane16_swap_b32 v92, v93
    v_pk_add_f32 v[96:97], v[96:97], v[104:105]
    v_pk_add_f32 v[98:99], v[98:99], v[106:107]
    v_add_f32 v92, v92, v93
    v_or3_b32 v214, v108, v109, v110
    v_permlane32_swap_b32 v96, v98
    v_permlane32_swap_b32 v97, v99
    v_add_f32_dpp v92, v92, v92 row_ror:8 row_mask:0xf bank_mask:0xf
    v_pk_add_f32 v[96:97], v[96:97], v[98:99]
    v_or3_b32 v210, v210, v211, v212
    v_mov_b32 v98, v96
    v_mov_b32 v99, v97
    v_add_f32_dpp v92, v92, v92 row_ror:4 row_mask:0xf bank_mask:0xf
    v_or3_b32 v215, v215, v213, v214
    v_mov_b32 v93, v92
    v_or_b32 v215, v215, v210
    v_permlane16_swap_b32 v96, v98
    v_permlane16_swap_b32 v97, v99
    v_and_b32 v215, v215, v15
    v_pk_add_f32 v[96:97], v[96:97], v[98:99]
    v_permlane32_swap_b32 v92, v93
    v_cmp_ne_u32 vcc, 0, v215
    v_cvt_pk_bf16_f32 v96, v96, v97
    v_cvt_pk_bf16_f32 v92, v92, v93
    s_cbranch_vccz L_h1k30
    s_mov_b32 s19, s50
    buffer_load_dwordx4 v[192:195], v9, s[32:35], s19 offen sc1
    s_add_u32 s19, s19, 4096
    buffer_load_dwordx4 v[196:199], v9, s[32:35], s19 offen sc1
    s_add_u32 s19, s19, 4096
    buffer_load_dwordx4 v[200:203], v9, s[32:35], s19 offen sc1
    s_add_u32 s19, s19, 4096
    buffer_load_dwordx4 v[204:207], v9, s[32:35], s19 offen sc1
    buffer_load_dwordx2 v[208:209], v10, s[32:35], s51 offen sc1
    s_cmp_eq_u32 s29, 0
    s_cbranch_scc1 L_q2
L_q2r:
    s_waitcnt vmcnt(0)
    s_add_u32 s79, s79, 1
    s_cmp_lt_u32 s79, 32768
    s_cbranch_scc1 L_h129
L_h1k30:
    s_cmp_eq_u32 s30, 0x7fc17fc1
    s_cbranch_scc0 L_h1s
    s_mov_b32 exec_lo, 0xffff
    s_mov_b32 exec_hi, 0xffff
    buffer_store_dword v96, v11, s[32:35], s64 offen
    s_lshl_b64 exec, 1, s16
    buffer_store_dword v92, v13, s[32:35], s65 offen
    s_mov_b64 exec, -1
L_h1r:
    buffer_load_dwordx4 v[60:63], v3, s[32:35], s59 offen offset:0 sc1
    buffer_load_dwordx4 v[64:67], v3, s[32:35], s59 offen offset:1024 sc1
    buffer_load_dwordx4 v[68:71], v3, s[32:35], s59 offen offset:2048 sc1
    buffer_load_dwordx4 v[72:75], v3, s[32:35], s59 offen offset:3072 sc1
    buffer_load_dwordx4 v[80:83], v12, s[32:35], s28 offen offset:0 sc1
    buffer_load_dwordx4 v[84:87], v12, s[32:35], s28 offen offset:64 sc1
    s_mov_b64 exec, 1
    ds_write_b32 v1, v18 offset:192
    s_mov_b64 exec, -1
    s_cmp_lg_u32 s29, 0
    s_cbranch_scc1 L_q3
    s_mov_b32 s29, 2
L_q2:
    v_pk_fma_f32 v[144:145], v[112:113], s[74:75], v[184:185] op_sel_hi:[1,0,0]
    v_pk_fma_f32 v[146:147], v[114:115], s[74:75], v[184:185] op_sel_hi:[1,0,0]
    v_pk_fma_f32 v[152:153], v[120:121], s[74:75], v[184:185] op_sel:[0,0,1] op_sel_hi:[1,0,1]
    v_pk_fma_f32 v[154:155], v[122:123], s[74:75], v[184:185] op_sel:[0,0,1] op_sel_hi:[1,0,1]
    v_pk_fma_f32 v[224:225], v[128:129], s[74:75], v[186:187] op_sel_hi:[1,0,0]
    v_pk_fma_f32 v[226:227], v[130:131], s[74:75], v[186:187] op_sel_hi:[1,0,0]
    v_pk_fma_f32 v[232:233], v[136:137], s[74:75], v[186:187] op_sel:[0,0,1] op_sel_hi:[1,0,1]
    v_pk_fma_f32 v[234:235], v[138:139], s[74:75], v[186:187] op_sel:[0,0,1] op_sel_hi:[1,0,1]
    v_pk_fma_f32 v[148:149], v[116:117], s[74:75], v[184:185] op_sel_hi:[1,0,0]
    v_pk_fma_f32 v[156:157], v[124:125], s[74:75], v[184:185] op_sel:[0,0,1] op_sel_hi:[1,0,1]
    v_pk_fma_f32 v[228:229], v[132:133], s[74:75], v[186:187] op_sel_hi:[1,0,0]
    v_pk_fma_f32 v[236:237], v[140:141], s[74:75], v[186:187] op_sel:[0,0,1] op_sel_hi:[1,0,1]
    v_exp_f32 v144, v144
    v_exp_f32 v145, v145
    v_exp_f32 v146, v146
    v_exp_f32 v147, v147
    v_exp_f32 v152, v152
    v_exp_f32 v153, v153
    v_exp_f32 v154, v154
    v_exp_f32 v155, v155
    v_exp_f32 v224, v224
    v_exp_f32 v225, v225
    v_exp_f32 v226, v226
    v_exp_f32 v227, v227
    v_exp_f32 v232, v232
    v_exp_f32 v233, v233
    v_exp_f32 v234, v234
    v_exp_f32 v235, v235
    v_pk_fma_f32 v[150:151], v[118:119], s[74:75], v[184:185] op_sel_hi:[1,0,0]
    v_pk_fma_f32 v[158:159], v[126:127], s[74:75], v[184:185] op_sel:[0,0,1] op_sel_hi:[1,0,1]
    v_pk_fma_f32 v[230:231], v[134:135], s[74:75], v[186:187] op_sel_hi:[1,0,0]
    v_pk_fma_f32 v[238:239], v[142:143], s[74:75], v[186:187] op_sel:[0,0,1] op_sel_hi:[1,0,1]
    v_exp_f32 v148, v148
    v_exp_f32 v149, v149
    v_exp_f32 v156, v156
    v_exp_f32 v157, v157
    v_exp_f32 v228, v228
    v_exp_f32 v229, v229
    v_exp_f32 v236, v236
    v_exp_f32 v237, v237
    v_pk_add_f32 v[240:241], v[144:145], v[146:147]
    v_pk_add_f32 v[242:243], v[152:153], v[154:155]
    v_pk_add_f32 v[244:245], v[224:225], v[226:227]
    v_pk_add_f32 v[246:247], v[232:233], v[234:235]
    v_exp_f32 v150, v150
    v_exp_f32 v151, v151
    v_exp_f32 v158, v158
    v_exp_f32 v159, v159
    v_exp_f32 v230, v230
    v_exp_f32 v231, v231
    v_exp_f32 v238, v238
    v_exp_f32 v239, v239
    v_pk_add_f32 v[240:241], v[240:241], v[148:149]
    v_pk_add_f32 v[242:243], v[242:243], v[156:157]
    v_pk_add_f32 v[244:245], v[244:245], v[228:229]
    v_pk_add_f32 v[246:247], v[246:247], v[236:237]
    v_pk_add_f32 v[240:241], v[240:241], v[150:151]
    v_pk_add_f32 v[242:243], v[242:243], v[158:159]
    v_pk_add_f32 v[244:245], v[244:245], v[230:231]
    v_pk_add_f32 v[246:247], v[246:247], v[238:239]
    v_add_f32 v176, v240, v241
    v_add_f32 v177, v242, v243
    v_add_f32 v178, v244, v245
    v_add_f32 v179, v246, v247
    s_nop 0
    v_permlane32_swap_b32 v176, v178
    v_permlane32_swap_b32 v177, v179
    v_add_f32 v176, v176, v178
    v_add_f32 v177, v177, v179
    s_nop 1
    v_permlane16_swap_b32 v176, v177
    v_add_f32 v176, v176, v177
    v_rcp_f32 v176, v176
    s_nop 0
    v_mov_b32 v177, v176
    s_nop 1
    v_permlane16_swap_b32 v176, v177
    v_mov_b32 v178, v176
    v_mov_b32 v179, v177
    s_nop 0
    v_permlane32_swap_b32 v176, v178
    v_permlane32_swap_b32 v177, v179
    v_pk_mul_f32 v[144:145], v[144:145], v[176:177] op_sel_hi:[1,0]
    v_pk_mul_f32 v[152:153], v[152:153], v[176:177] op_sel:[0,1] op_sel_hi:[1,1]
    v_pk_mul_f32 v[224:225], v[224:225], v[178:179] op_sel_hi:[1,0]
    v_pk_mul_f32 v[232:233], v[232:233], v[178:179] op_sel:[0,1] op_sel_hi:[1,1]
    v_pk_mul_f32 v[146:147], v[146:147], v[176:177] op_sel_hi:[1,0]
    v_pk_mul_f32 v[154:155], v[154:155], v[176:177] op_sel:[0,1] op_sel_hi:[1,1]
    v_pk_mul_f32 v[226:227], v[226:227], v[178:179] op_sel_hi:[1,0]
    v_pk_mul_f32 v[234:235], v[234:235], v[178:179] op_sel:[0,1] op_sel_hi:[1,1]
    v_pk_mul_f32 v[148:149], v[148:149], v[176:177] op_sel_hi:[1,0]
    v_pk_mul_f32 v[150:151], v[150:151], v[176:177] op_sel_hi:[1,0]
    v_cvt_pk_bf16_f32 v144, v144, v145
    v_pk_mul_f32 v[156:157], v[156:157], v[176:177] op_sel:[0,1] op_sel_hi:[1,1]
    v_pk_mul_f32 v[158:159], v[158:159], v[176:177] op_sel:[0,1] op_sel_hi:[1,1]
    v_cvt_pk_bf16_f32 v152, v152, v153
    v_pk_mul_f32 v[228:229], v[228:229], v[178:179] op_sel_hi:[1,0]
    v_pk_mul_f32 v[230:231], v[230:231], v[178:179] op_sel_hi:[1,0]
    v_cvt_pk_bf16_f32 v224, v224, v225
    v_pk_mul_f32 v[236:237], v[236:237], v[178:179] op_sel:[0,1] op_sel_hi:[1,1]
    v_pk_mul_f32 v[238:239], v[238:239], v[178:179] op_sel:[0,1] op_sel_hi:[1,1]
    v_cvt_pk_bf16_f32 v232, v232, v233
    v_cvt_pk_bf16_f32 v145, v146, v147
    v_cvt_pk_bf16_f32 v153, v154, v155
    v_cvt_pk_bf16_f32 v225, v226, v227
    v_cvt_pk_bf16_f32 v233, v234, v235
    v_cvt_pk_bf16_f32 v146, v148, v149
    v_cvt_pk_bf16_f32 v147, v150, v151
    v_cvt_pk_bf16_f32 v154, v156, v157
    v_cvt_pk_bf16_f32 v155, v158, v159
    v_cvt_pk_bf16_f32 v226, v228, v229
    v_cvt_pk_bf16_f32 v227, v230, v231
    v_cvt_pk_bf16_f32 v234, v236, v237
    v_cvt_pk_bf16_f32 v235, v238, v239
    s_add_u32 s29, s29, 1
    s_cmp_eq_u32 s29, 1
    s_cbranch_scc1 L_q2r
L_q3:
    v_pk_fma_f32 v[112:113], v[112:113], s[76:77], v[188:189] op_sel_hi:[1,0,0]
    v_pk_fma_f32 v[114:115], v[114:115], s[76:77], v[188:189] op_sel_hi:[1,0,0]
    v_pk_fma_f32 v[120:121], v[120:121], s[76:77], v[188:189] op_sel:[0,0,1] op_sel_hi:[1,0,1]
    v_pk_fma_f32 v[122:123], v[122:123], s[76:77], v[188:189] op_sel:[0,0,1] op_sel_hi:[1,0,1]
    v_pk_fma_f32 v[128:129], v[128:129], s[76:77], v[190:191] op_sel_hi:[1,0,0]
    v_pk_fma_f32 v[130:131], v[130:131], s[76:77], v[190:191] op_sel_hi:[1,0,0]
    v_pk_fma_f32 v[136:137], v[136:137], s[76:77], v[190:191] op_sel:[0,0,1] op_sel_hi:[1,0,1]
    v_pk_fma_f32 v[138:139], v[138:139], s[76:77], v[190:191] op_sel:[0,0,1] op_sel_hi:[1,0,1]
    v_pk_fma_f32 v[116:117], v[116:117], s[76:77], v[188:189] op_sel_hi:[1,0,0]
    v_pk_fma_f32 v[124:125], v[124:125], s[76:77], v[188:189] op_sel:[0,0,1] op_sel_hi:[1,0,1]
    v_pk_fma_f32 v[132:133], v[132:133], s[76:77], v[190:191] op_sel_hi:[1,0,0]
    v_pk_fma_f32 v[140:141], v[140:141], s[76:77], v[190:191] op_sel:[0,0,1] op_sel_hi:[1,0,1]
    v_exp_f32 v112, v112
    v_exp_f32 v113, v113
    v_exp_f32 v114, v114
    v_exp_f32 v115, v115
    v_exp_f32 v120, v120
    v_exp_f32 v121, v121
    v_exp_f32 v122, v122
    v_exp_f32 v123, v123
    v_exp_f32 v128, v128
    v_exp_f32 v129, v129
    v_exp_f32 v130, v130
    v_exp_f32 v131, v131
    v_exp_f32 v136, v136
    v_exp_f32 v137, v137
    v_exp_f32 v138, v138
    v_exp_f32 v139, v139
    v_pk_fma_f32 v[118:119], v[118:119], s[76:77], v[188:189] op_sel_hi:[1,0,0]
    v_pk_fma_f32 v[126:127], v[126:127], s[76:77], v[188:189] op_sel:[0,0,1] op_sel_hi:[1,0,1]
    v_pk_fma_f32 v[134:135], v[134:135], s[76:77], v[190:191] op_sel_hi:[1,0,0]
    v_pk_fma_f32 v[142:143], v[142:143], s[76:77], v[190:191] op_sel:[0,0,1] op_sel_hi:[1,0,1]
    v_exp_f32 v116, v116
    v_exp_f32 v117, v117
    v_exp_f32 v124, v124
    v_exp_f32 v125, v125
    v_exp_f32 v132, v132
    v_exp_f32 v133, v133
    v_exp_f32 v140, v140
    v_exp_f32 v141, v141
    v_pk_add_f32 v[248:249], v[112:113], v[114:115]
    v_pk_add_f32 v[250:251], v[120:121], v[122:123]
    v_pk_add_f32 v[252:253], v[128:129], v[130:131]
    v_pk_add_f32 v[254:255], v[136:137], v[138:139]
    v_exp_f32 v118, v118
    v_exp_f32 v119, v119
    v_exp_f32 v126, v126
    v_exp_f32 v127, v127
    v_exp_f32 v134, v134
    v_exp_f32 v135, v135
    v_exp_f32 v142, v142
    v_exp_f32 v143, v143
    v_pk_add_f32 v[248:249], v[248:249], v[116:117]
    v_pk_add_f32 v[250:251], v[250:251], v[124:125]
    v_pk_add_f32 v[252:253], v[252:253], v[132:133]
    v_pk_add_f32 v[254:255], v[254:255], v[140:141]
    v_pk_add_f32 v[248:249], v[248:249], v[118:119]
    v_pk_add_f32 v[250:251], v[250:251], v[126:127]
    v_pk_add_f32 v[252:253], v[252:253], v[134:135]
    v_pk_add_f32 v[254:255], v[254:255], v[142:143]
    v_add_f32 v180, v248, v249
    v_add_f32 v181, v250, v251
    v_add_f32 v182, v252, v253
    v_add_f32 v183, v254, v255
    s_nop 0
    v_permlane32_swap_b32 v180, v182
    v_permlane32_swap_b32 v181, v183
    v_add_f32 v180, v180, v182
    v_add_f32 v181, v181, v183
    s_nop 1
    v_permlane16_swap_b32 v180, v181
    v_add_f32 v180, v180, v181
    v_rcp_f32 v180, v180
    s_nop 0
    v_mov_b32 v181, v180
    s_nop 1
    v_permlane16_swap_b32 v180, v181
    v_mov_b32 v182, v180
    v_mov_b32 v183, v181
    s_nop 0
    v_permlane32_swap_b32 v180, v182
    v_permlane32_swap_b32 v181, v183
    v_pk_mul_f32 v[112:113], v[112:113], v[180:181] op_sel_hi:[1,0]
    v_pk_mul_f32 v[120:121], v[120:121], v[180:181] op_sel:[0,1] op_sel_hi:[1,1]
    v_pk_mul_f32 v[128:129], v[128:129], v[182:183] op_sel_hi:[1,0]
    v_pk_mul_f32 v[136:137], v[136:137], v[182:183] op_sel:[0,1] op_sel_hi:[1,1]
    v_pk_mul_f32 v[114:115], v[114:115], v[180:181] op_sel_hi:[1,0]
    v_pk_mul_f32 v[122:123], v[122:123], v[180:181] op_sel:[0,1] op_sel_hi:[1,1]
    v_pk_mul_f32 v[130:131], v[130:131], v[182:183] op_sel_hi:[1,0]
    v_pk_mul_f32 v[138:139], v[138:139], v[182:183] op_sel:[0,1] op_sel_hi:[1,1]
    v_pk_mul_f32 v[116:117], v[116:117], v[180:181] op_sel_hi:[1,0]
    v_pk_mul_f32 v[118:119], v[118:119], v[180:181] op_sel_hi:[1,0]
    v_cvt_pk_bf16_f32 v112, v112, v113
    v_pk_mul_f32 v[124:125], v[124:125], v[180:181] op_sel:[0,1] op_sel_hi:[1,1]
    v_pk_mul_f32 v[126:127], v[126:127], v[180:181] op_sel:[0,1] op_sel_hi:[1,1]
    v_cvt_pk_bf16_f32 v120, v120, v121
    v_pk_mul_f32 v[132:133], v[132:133], v[182:183] op_sel_hi:[1,0]
    v_pk_mul_f32 v[134:135], v[134:135], v[182:183] op_sel_hi:[1,0]
    v_cvt_pk_bf16_f32 v128, v128, v129
    v_pk_mul_f32 v[140:141], v[140:141], v[182:183] op_sel:[0,1] op_sel_hi:[1,1]
    v_pk_mul_f32 v[142:143], v[142:143], v[182:183] op_sel:[0,1] op_sel_hi:[1,1]
    v_cvt_pk_bf16_f32 v136, v136, v137
    v_cvt_pk_bf16_f32 v113, v114, v115
    v_cvt_pk_bf16_f32 v121, v122, v123
    v_cvt_pk_bf16_f32 v129, v130, v131
    v_cvt_pk_bf16_f32 v137, v138, v139
    v_cvt_pk_bf16_f32 v114, v116, v117
    v_cvt_pk_bf16_f32 v115, v118, v119
    v_cvt_pk_bf16_f32 v122, v124, v125
    v_cvt_pk_bf16_f32 v123, v126, v127
    v_cvt_pk_bf16_f32 v130, v132, v133
    v_cvt_pk_bf16_f32 v131, v134, v135
    v_cvt_pk_bf16_f32 v138, v140, v141
    v_cvt_pk_bf16_f32 v139, v142, v143
L_h231:
    s_waitcnt vmcnt(0)
    v_max3_u32 v88, v60, v61, v62
    v_max3_u32 v89, v64, v65, v66
    v_max3_u32 v90, v68, v69, v70
    v_max3_u32 v91, v72, v73, v74
    v_max3_u32 v92, v80, v81, v82
    v_max3_u32 v93, v84, v85, v86
    v_max_u32 v88, v88, v63
    v_max_u32 v89, v89, v67
    v_max_u32 v90, v90, v71
    v_max_u32 v91, v91, v75
    v_max_u32 v92, v92, v83
    v_max_u32 v93, v93, v87
    v_max3_u32 v94, v88, v89, v90
    v_max3_u32 v95, v91, v92, v93
    v_max_u32 v94, v94, v95
    v_cmp_eq_u32 vcc, -1, v94
    s_cbranch_vccz L_h2k32
    v_cmp_eq_u32 s[68:69], -1, v88
    v_cmp_eq_u32 s[70:71], -1, v89
    v_cmp_eq_u32 s[72:73], -1, v90
    v_cmp_eq_u32 s[74:75], -1, v91
    v_cmp_eq_u32 s[76:77], -1, v92
    v_cmp_eq_u32 s[0:1], -1, v93
    s_mov_b64 exec, s[68:69]
    buffer_load_dwordx4 v[60:63], v3, s[32:35], s59 offen offset:0 sc1
    s_mov_b64 exec, s[70:71]
    buffer_load_dwordx4 v[64:67], v3, s[32:35], s59 offen offset:1024 sc1
    s_mov_b64 exec, s[72:73]
    buffer_load_dwordx4 v[68:71], v3, s[32:35], s59 offen offset:2048 sc1
    s_mov_b64 exec, s[74:75]
    buffer_load_dwordx4 v[72:75], v3, s[32:35], s59 offen offset:3072 sc1
    s_mov_b64 exec, s[76:77]
    buffer_load_dwordx4 v[80:83], v12, s[32:35], s28 offen offset:0 sc1
    s_mov_b64 exec, s[0:1]
    buffer_load_dwordx4 v[84:87], v12, s[32:35], s28 offen offset:64 sc1
    s_mov_b64 exec, -1
    s_add_u32 s79, s79, 1
    s_cmp_lt_u32 s79, 32768
    s_cbranch_scc1 L_h231
    s_waitcnt vmcnt(0)
L_h2k32:
    v_mfma_f32_16x16x32_bf16 v[160:163], v[80:83], v[144:147], 0
    s_mov_b32 s74, 0x358637bd
    v_mov_b32 v19, s78
    v_mfma_f32_16x16x32_bf16 v[164:167], v[80:83], v[152:155], 0
    v_mfma_f32_16x16x32_bf16 v[160:163], v[84:87], v[112:115], v[160:163]
    v_mfma_f32_16x16x32_bf16 v[164:167], v[84:87], v[120:123], v[164:167]
    v_mfma_f32_16x16x32_bf16 v[168:171], v[80:83], v[224:227], 0
    v_mfma_f32_16x16x32_bf16 v[172:175], v[80:83], v[232:235], 0
    s_nop 5
    v_cvt_pk_bf16_f32 v88, v160, v164
    v_mfma_f32_16x16x32_bf16 v[168:171], v[84:87], v[128:131], v[168:171]
    v_and_b32 v89, 0xffff0000, v88
    v_lshlrev_b32 v88, 16, v88
    v_mfma_f32_16x16x32_bf16 v[172:175], v[84:87], v[136:139], v[172:175]
    v_pk_add_f32 v[88:89], v[88:89], s[74:75] op_sel_hi:[1,0]
    v_mfma_f32_16x16x32_bf16 v[192:195], v[60:63], v[144:147], 0
    v_cvt_pk_bf16_f32 v88, v88, v89
    v_mfma_f32_16x16x32_bf16 v[196:199], v[64:67], v[144:147], 0
    s_nop 3
    v_cvt_pk_bf16_f32 v90, v168, v172
    v_and_b32 v89, 0xffff0000, v88
    v_mfma_f32_16x16x32_bf16 v[200:203], v[60:63], v[152:155], 0
    v_and_b32 v91, 0xffff0000, v90
    v_lshlrev_b32 v90, 16, v90
    v_mfma_f32_16x16x32_bf16 v[192:195], v[68:71], v[112:115], v[192:195]
    v_pk_add_f32 v[90:91], v[90:91], s[74:75] op_sel_hi:[1,0]
    v_lshlrev_b32 v88, 16, v88
    v_mfma_f32_16x16x32_bf16 v[204:207], v[64:67], v[152:155], 0
    v_cvt_pk_bf16_f32 v90, v90, v91
    v_rcp_f32 v88, v88
    v_mfma_f32_16x16x32_bf16 v[208:211], v[60:63], v[224:227], 0
    s_nop 1
    v_cvt_pk_bf16_f32 v96, v192, v193
    v_rcp_f32 v89, v89
    v_mfma_f32_16x16x32_bf16 v[196:199], v[72:75], v[112:115], v[196:199]
    v_cvt_pk_bf16_f32 v97, v194, v195
    v_and_b32 v91, 0xffff0000, v90
    v_mfma_f32_16x16x32_bf16 v[200:203], v[68:71], v[120:123], v[200:203]
    v_lshlrev_b32 v192, 16, v96
    v_and_b32 v193, 0xffff0000, v96
    v_mfma_f32_16x16x32_bf16 v[212:215], v[64:67], v[224:227], 0
    s_nop 1
    v_cvt_pk_bf16_f32 v98, v196, v197
    v_cvt_pk_bf16_f32 v99, v198, v199
    v_mfma_f32_16x16x32_bf16 v[216:219], v[60:63], v[232:235], 0
    v_cvt_pk_bf16_f32 v100, v200, v201
    v_lshlrev_b32 v90, 16, v90
    v_mfma_f32_16x16x32_bf16 v[204:207], v[72:75], v[120:123], v[204:207]
    v_lshlrev_b32 v194, 16, v97
    v_and_b32 v195, 0xffff0000, v97
    v_mfma_f32_16x16x32_bf16 v[208:211], v[68:71], v[128:131], v[208:211]
    v_cvt_pk_bf16_f32 v101, v202, v203
    v_lshlrev_b32 v196, 16, v98
    v_mfma_f32_16x16x32_bf16 v[220:223], v[64:67], v[232:235], 0
    v_and_b32 v197, 0xffff0000, v98
    v_lshlrev_b32 v198, 16, v99
    v_mfma_f32_16x16x32_bf16 v[212:215], v[72:75], v[128:131], v[212:215]
    v_and_b32 v199, 0xffff0000, v99
    v_pk_mul_f32 v[192:193], v[192:193], v[88:89] op_sel_hi:[1,0]
    v_mfma_f32_16x16x32_bf16 v[216:219], v[68:71], v[136:139], v[216:219]
    v_cvt_pk_bf16_f32 v102, v204, v205
    v_cvt_pk_bf16_f32 v103, v206, v207
    v_mfma_f32_16x16x32_bf16 v[220:223], v[72:75], v[136:139], v[220:223]
    v_lshlrev_b32 v200, 16, v100
    v_and_b32 v201, 0xffff0000, v100
    v_cvt_pk_bf16_f32 v104, v208, v209
    v_rcp_f32 v90, v90
    v_rcp_f32 v91, v91
    v_pk_mul_f32 v[194:195], v[194:195], v[88:89] op_sel_hi:[1,0]
    v_lshlrev_b32 v202, 16, v101
    v_and_b32 v203, 0xffff0000, v101
    v_cvt_pk_bf16_f32 v105, v210, v211
    v_pk_mul_f32 v[196:197], v[196:197], v[88:89] op_sel_hi:[1,0]
    v_pk_mul_f32 v[198:199], v[198:199], v[88:89] op_sel_hi:[1,0]
    v_cvt_pk_bf16_f32 v192, v192, v193
    v_lshlrev_b32 v204, 16, v102
    v_and_b32 v205, 0xffff0000, v102
    v_lshlrev_b32 v206, 16, v103
    v_and_b32 v207, 0xffff0000, v103
    v_pk_mul_f32 v[200:201], v[200:201], v[88:89] op_sel:[0,1] op_sel_hi:[1,1]
    v_cvt_pk_bf16_f32 v106, v212, v213
    v_cvt_pk_bf16_f32 v107, v214, v215
    v_lshlrev_b32 v208, 16, v104
    v_and_b32 v209, 0xffff0000, v104
    v_cvt_pk_bf16_f32 v108, v216, v217
    v_cvt_pk_bf16_f32 v193, v194, v195
    v_pk_mul_f32 v[202:203], v[202:203], v[88:89] op_sel:[0,1] op_sel_hi:[1,1]
    v_lshlrev_b32 v210, 16, v105
    v_and_b32 v211, 0xffff0000, v105
    v_cvt_pk_bf16_f32 v109, v218, v219
    v_cvt_pk_bf16_f32 v194, v196, v197
    v_cvt_pk_bf16_f32 v195, v198, v199
    v_pk_mul_f32 v[204:205], v[204:205], v[88:89] op_sel:[0,1] op_sel_hi:[1,1]
    v_pk_mul_f32 v[206:207], v[206:207], v[88:89] op_sel:[0,1] op_sel_hi:[1,1]
    v_cvt_pk_bf16_f32 v200, v200, v201
    v_lshlrev_b32 v212, 16, v106
    v_and_b32 v213, 0xffff0000, v106
    v_lshlrev_b32 v214, 16, v107
    v_and_b32 v215, 0xffff0000, v107
    v_pk_mul_f32 v[208:209], v[208:209], v[90:91] op_sel_hi:[1,0]
    v_cvt_pk_bf16_f32 v110, v220, v221
    v_cvt_pk_bf16_f32 v111, v222, v223
    v_lshlrev_b32 v216, 16, v108
    v_and_b32 v217, 0xffff0000, v108
    v_cvt_pk_bf16_f32 v201, v202, v203
    v_pk_mul_f32 v[210:211], v[210:211], v[90:91] op_sel_hi:[1,0]
    v_lshlrev_b32 v218, 16, v109
    v_and_b32 v219, 0xffff0000, v109
    buffer_store_dwordx4 v[192:195], v3, s[32:35], s52 offen sc1
    v_cvt_pk_bf16_f32 v202, v204, v205
    v_cvt_pk_bf16_f32 v203, v206, v207
    v_pk_mul_f32 v[212:213], v[212:213], v[90:91] op_sel_hi:[1,0]
    v_pk_mul_f32 v[214:215], v[214:215], v[90:91] op_sel_hi:[1,0]
    v_cvt_pk_bf16_f32 v208, v208, v209
    v_lshlrev_b32 v220, 16, v110
    v_and_b32 v221, 0xffff0000, v110
    v_lshlrev_b32 v222, 16, v111
    v_and_b32 v223, 0xffff0000, v111
    v_pk_mul_f32 v[216:217], v[216:217], v[90:91] op_sel:[0,1] op_sel_hi:[1,1]
    s_add_u32 s52, s52, 32768
    v_cvt_pk_bf16_f32 v209, v210, v211
    v_pk_mul_f32 v[218:219], v[218:219], v[90:91] op_sel:[0,1] op_sel_hi:[1,1]
    buffer_store_dwordx4 v[200:203], v3, s[32:35], s52 offen sc1
    v_cvt_pk_bf16_f32 v210, v212, v213
    v_cvt_pk_bf16_f32 v211, v214, v215
    v_pk_mul_f32 v[220:221], v[220:221], v[90:91] op_sel:[0,1] op_sel_hi:[1,1]
    v_pk_mul_f32 v[222:223], v[222:223], v[90:91] op_sel:[0,1] op_sel_hi:[1,1]
    v_cvt_pk_bf16_f32 v216, v216, v217
    s_add_u32 s52, s52, 32768
    v_cvt_pk_bf16_f32 v217, v218, v219
    buffer_store_dwordx4 v[208:211], v3, s[32:35], s52 offen sc1
    v_cvt_pk_bf16_f32 v218, v220, v221
    v_cvt_pk_bf16_f32 v219, v222, v223
    s_add_u32 s52, s52, 32768
    buffer_store_dwordx4 v[216:219], v3, s[32:35], s52 offen sc1
L_gc33:
    v_cmp_ne_u32 vcc, s78, v77
    v_cmp_ne_u32 s[84:85], s78, v79
    s_nop 1
    s_or_b64 vcc, vcc, s[84:85]
    s_cbranch_vccz L_gk34
    buffer_load_dwordx2 v[76:77], v27, s[32:35], s57 offen offset:0 sc1
    buffer_load_dwordx2 v[78:79], v27, s[32:35], s57 offen offset:64 sc1
    s_waitcnt vmcnt(0)
    s_add_u32 s79, s79, 1
    s_cmp_lt_u32 s79, 32768
    s_cbranch_scc1 L_gc33
L_gk34:
    v_and_b32 v54, 1, v2
    s_lshr_b32 s3, s13, 2
    v_lshlrev_b32 v54, 4, v54
    s_lshl_b32 s76, s3, 12
    v_lshrrev_b32 v80, v54, v76
    v_lshrrev_b32 v81, v54, v78
    v_lshlrev_b32 v82, 16, v80
    v_lshlrev_b32 v83, 16, v81
    v_sub_f32 v84, 1.0, v82
    v_sub_f32 v85, 1.0, v83
    v_cvt_pk_bf16_f32 v86, v13, v84
    v_cvt_pk_bf16_f32 v87, v13, v85
    v_lshrrev_b32 v84, 16, v86
    v_lshrrev_b32 v85, 16, v87
    v_dot2_f32_bf16 v128, v28, v84, 0
    v_dot2_f32_bf16 v129, v28, v86, 0
    v_dot2_f32_bf16 v130, v29, v84, 0
    v_dot2_f32_bf16 v131, v29, v86, 0
    v_dot2_f32_bf16 v132, v30, v84, 0
    v_dot2_f32_bf16 v133, v30, v86, 0
    v_dot2_f32_bf16 v134, v31, v84, 0
    v_dot2_f32_bf16 v135, v31, v86, 0
    v_dot2_f32_bf16 v136, v32, v84, 0
    v_dot2_f32_bf16 v137, v32, v86, 0
    v_dot2_f32_bf16 v138, v33, v84, 0
    v_dot2_f32_bf16 v139, v33, v86, 0
    v_dot2_f32_bf16 v140, v34, v84, 0
    v_dot2_f32_bf16 v141, v34, v86, 0
    v_dot2_f32_bf16 v142, v35, v84, 0
    v_dot2_f32_bf16 v143, v35, v86, 0
    v_dot2_f32_bf16 v144, v36, v85, 0
    v_dot2_f32_bf16 v145, v36, v87, 0
    v_dot2_f32_bf16 v146, v37, v85, 0
    v_dot2_f32_bf16 v147, v37, v87, 0
    v_dot2_f32_bf16 v148, v38, v85, 0
    v_dot2_f32_bf16 v149, v38, v87, 0
    v_dot2_f32_bf16 v150, v39, v85, 0
    v_dot2_f32_bf16 v151, v39, v87, 0
    v_dot2_f32_bf16 v152, v40, v85, 0
    v_dot2_f32_bf16 v153, v40, v87, 0
    v_dot2_f32_bf16 v154, v41, v85, 0
    v_dot2_f32_bf16 v155, v41, v87, 0
    v_dot2_f32_bf16 v156, v42, v85, 0
    v_dot2_f32_bf16 v157, v42, v87, 0
    v_dot2_f32_bf16 v158, v43, v85, 0
    v_dot2_f32_bf16 v159, v43, v87, 0
    s_and_b32 s3, s13, 3
    v_cvt_pk_bf16_f32 v28, v128, v129
    v_cvt_pk_bf16_f32 v29, v130, v131
    v_cvt_pk_bf16_f32 v30, v132, v133
    v_cvt_pk_bf16_f32 v31, v134, v135
    v_cvt_pk_bf16_f32 v32, v136, v137
    v_cvt_pk_bf16_f32 v33, v138, v139
    v_cvt_pk_bf16_f32 v34, v140, v141
    v_cvt_pk_bf16_f32 v35, v142, v143
    v_cvt_pk_bf16_f32 v36, v144, v145
    v_cvt_pk_bf16_f32 v37, v146, v147
    v_cvt_pk_bf16_f32 v38, v148, v149
    v_cvt_pk_bf16_f32 v39, v150, v151
    v_cvt_pk_bf16_f32 v40, v152, v153
    v_cvt_pk_bf16_f32 v41, v154, v155
    v_cvt_pk_bf16_f32 v42, v156, v157
    v_cvt_pk_bf16_f32 v43, v158, v159
    v_and_b32 v55, 15, v2
    v_lshlrev_b32 v90, 2, v2
    s_lshl_b32 s3, s3, 13
    s_add_u32 s76, s76, s3
    v_and_b32 v80, 0xffff, v80
    v_and_b32 v81, 0xffff, v81
    v_lshlrev_b32 v128, 16, v28
    v_and_b32 v129, 0xffff0000, v28
    v_lshlrev_b32 v130, 16, v29
    v_and_b32 v131, 0xffff0000, v29
    v_lshlrev_b32 v132, 16, v30
    v_and_b32 v133, 0xffff0000, v30
    v_lshlrev_b32 v134, 16, v31
    v_and_b32 v135, 0xffff0000, v31
    v_lshlrev_b32 v136, 16, v32
    v_and_b32 v137, 0xffff0000, v32
    v_lshlrev_b32 v138, 16, v33
    v_and_b32 v139, 0xffff0000, v33
    v_lshlrev_b32 v140, 16, v34
    v_and_b32 v141, 0xffff0000, v34
    v_lshlrev_b32 v142, 16, v35
    v_and_b32 v143, 0xffff0000, v35
    v_lshlrev_b32 v144, 16, v36
    v_and_b32 v145, 0xffff0000, v36
    v_lshlrev_b32 v146, 16, v37
    v_and_b32 v147, 0xffff0000, v37
    v_lshlrev_b32 v148, 16, v38
    v_and_b32 v149, 0xffff0000, v38
    v_lshlrev_b32 v150, 16, v39
    v_and_b32 v151, 0xffff0000, v39
    v_lshlrev_b32 v152, 16, v40
    v_and_b32 v153, 0xffff0000, v40
    v_lshlrev_b32 v154, 16, v41
    v_and_b32 v155, 0xffff0000, v41
    v_lshlrev_b32 v156, 16, v42
    v_and_b32 v157, 0xffff0000, v42
    v_lshlrev_b32 v158, 16, v43
    v_and_b32 v159, 0xffff0000, v43
    v_mov_b32 v160, 0
    v_mov_b32 v161, 0
    v_mov_b32 v162, 0
    v_mov_b32 v163, 0
    v_mov_b32 v164, 0
    v_mov_b32 v165, 0
    v_mov_b32 v166, 0
    v_mov_b32 v167, 0
    v_mov_b32 v168, 0
    v_mov_b32 v169, 0
    v_mov_b32 v170, 0
    v_mov_b32 v171, 0
    v_mov_b32 v172, 0
    v_mov_b32 v173, 0
    v_mov_b32 v174, 0
    v_mov_b32 v175, 0
    v_mov_b32 v176, 0
    v_mov_b32 v177, 0
    v_mov_b32 v178, 0
    v_mov_b32 v179, 0
    v_mov_b32 v180, 0
    v_mov_b32 v181, 0
    v_mov_b32 v182, 0
    v_mov_b32 v183, 0
    v_mov_b32 v184, 0
    v_mov_b32 v185, 0
    v_mov_b32 v186, 0
    v_mov_b32 v187, 0
    v_mov_b32 v188, 0
    v_mov_b32 v189, 0
    v_mov_b32 v190, 0
    v_mov_b32 v191, 0
    v_lshlrev_b32 v55, 7, v55
    v_and_b32 v90, 12, v90
    v_mov_b32 v91, 1
    s_and_b32 s76, s76, 0x7fff
    s_waitcnt vmcnt(0)
    s_mov_b64 exec, 1
    ds_add_rtn_u32 v88, v13, v91 offset:64
    s_mov_b64 exec, -1
    s_waitcnt lgkmcnt(0)
    v_readfirstlane_b32 s3, v88
    s_nop 1
    s_cmp_lg_u32 s3, 3
    s_cbranch_scc1 L_ow
    s_mov_b64 exec, 1
    buffer_store_dword v19, v13, s[32:35], s53 offen sc1
    s_mov_b64 exec, -1
L_of35:
    buffer_load_dword v54, v55, s[32:35], s56 offen sc1
    ds_read_b32 v88, v90 offset:208
    s_waitcnt vmcnt(0) lgkmcnt(0)
    v_cmp_ne_u32 vcc, s78, v54
    v_cmp_ne_u32 s[74:75], v88, v18
    s_nop 1
    s_or_b64 vcc, vcc, s[74:75]
    s_cbranch_vccz L_ofk36
    s_add_u32 s79, s79, 1
    s_cmp_lt_u32 s79, 32768
    s_cbranch_scc1 L_of35
L_ofk36:
    ds_write_b32 v13, v18 offset:112
L_ow:
    ds_read_b32 v88, v13 offset:112
    ds_read_b32 v89, v13 offset:16
    s_waitcnt lgkmcnt(0)
    v_cmp_ne_u32 vcc, v88, v18
    s_cbranch_vccz L_owk
    s_add_u32 s79, s79, 1
    s_cmp_lt_u32 s79, 262144
    s_cbranch_scc1 L_ow
L_owk:
    buffer_load_dwordx4 v[192:195], v24, s[60:63], s76 offen
    buffer_load_dwordx4 v[196:199], v25, s[60:63], s76 offen
    s_add_u32 s76, s76, 1024
    s_and_b32 s76, s76, 0x7fff
    buffer_load_dwordx4 v[200:203], v24, s[60:63], s76 offen
    buffer_load_dwordx4 v[204:207], v25, s[60:63], s76 offen
    s_add_u32 s76, s76, 1024
    s_and_b32 s76, s76, 0x7fff
    buffer_load_dwordx4 v[208:211], v24, s[60:63], s76 offen
    buffer_load_dwordx4 v[212:215], v25, s[60:63], s76 offen
    s_add_u32 s76, s76, 1024
    s_and_b32 s76, s76, 0x7fff
    buffer_load_dwordx4 v[216:219], v24, s[60:63], s76 offen
    buffer_load_dwordx4 v[220:223], v25, s[60:63], s76 offen
    s_add_u32 s76, s76, 1024
    s_and_b32 s76, s76, 0x7fff
    buffer_load_dwordx4 v[224:227], v24, s[60:63], s76 offen
    buffer_load_dwordx4 v[228:231], v25, s[60:63], s76 offen
    s_add_u32 s76, s76, 1024
    s_and_b32 s76, s76, 0x7fff
    buffer_load_dwordx4 v[232:235], v24, s[60:63], s76 offen
    buffer_load_dwordx4 v[236:239], v25, s[60:63], s76 offen
    s_add_u32 s76, s76, 1024
    s_and_b32 s76, s76, 0x7fff
    buffer_load_dwordx4 v[240:243], v24, s[60:63], s76 offen
    buffer_load_dwordx4 v[244:247], v25, s[60:63], s76 offen
    s_add_u32 s76, s76, 1024
    s_and_b32 s76, s76, 0x7fff
    buffer_load_dwordx4 v[248:251], v24, s[60:63], s76 offen
    buffer_load_dwordx4 v[252:255], v25, s[60:63], s76 offen
    s_add_u32 s76, s76, 1024
    s_and_b32 s76, s76, 0x7fff
    ds_read_b64_tr_b16 v[96:97], v20 offset:0
    ds_read_b64_tr_b16 v[98:99], v20 offset:2048
    ds_read_b64_tr_b16 v[100:101], v21 offset:0
    ds_read_b64_tr_b16 v[102:103], v21 offset:2048
    ds_read_b64_tr_b16 v[104:105], v22 offset:0
    ds_read_b64_tr_b16 v[106:107], v22 offset:2048
    ds_read_b64_tr_b16 v[108:109], v23 offset:0
    ds_read_b64_tr_b16 v[110:111], v23 offset:2048
    v_readfirstlane_b32 s77, v89
    s_mov_b32 s66, 0
    s_mov_b32 s3, 32768
.p2align 6
L_p5:
    s_cmp_eq_u32 s66, 3
    s_cselect_b32 s62, 0, s62
    s_cselect_b32 s3, 0, s3
    s_waitcnt vmcnt(14) lgkmcnt(6)
    v_mfma_f32_16x16x32_bf16 v[160:163], v[96:99], v[192:195], v[160:163]
    ds_read_b64_tr_b16 v[112:113], v20 offset:4096
    v_mfma_f32_16x16x32_bf16 v[176:179], v[96:99], v[196:199], v[176:179]
    ds_read_b64_tr_b16 v[114:115], v20 offset:6144
    s_waitcnt lgkmcnt(6)
    v_mfma_f32_16x16x32_bf16 v[164:167], v[100:103], v[192:195], v[164:167]
    ds_read_b64_tr_b16 v[116:117], v21 offset:4096
    v_mfma_f32_16x16x32_bf16 v[180:183], v[100:103], v[196:199], v[180:183]
    ds_read_b64_tr_b16 v[118:119], v21 offset:6144
    s_waitcnt lgkmcnt(6)
    v_mfma_f32_16x16x32_bf16 v[168:171], v[104:107], v[192:195], v[168:171]
    ds_read_b64_tr_b16 v[120:121], v22 offset:4096
    v_mfma_f32_16x16x32_bf16 v[184:187], v[104:107], v[196:199], v[184:187]
    ds_read_b64_tr_b16 v[122:123], v22 offset:6144
    s_waitcnt lgkmcnt(6)
    v_mfma_f32_16x16x32_bf16 v[172:175], v[108:111], v[192:195], v[172:175]
    ds_read_b64_tr_b16 v[124:125], v23 offset:4096
    v_mfma_f32_16x16x32_bf16 v[188:191], v[108:111], v[196:199], v[188:191]
    ds_read_b64_tr_b16 v[126:127], v23 offset:6144
    buffer_load_dwordx4 v[192:195], v24, s[60:63], s76 offen
    buffer_load_dwordx4 v[196:199], v25, s[60:63], s76 offen
    s_add_u32 s76, s76, 1024
    s_and_b32 s76, s76, 0x7fff
    s_waitcnt vmcnt(14) lgkmcnt(6)
    v_mfma_f32_16x16x32_bf16 v[160:163], v[112:115], v[200:203], v[160:163]
    ds_read_b64_tr_b16 v[96:97], v20 offset:8192
    v_mfma_f32_16x16x32_bf16 v[176:179], v[112:115], v[204:207], v[176:179]
    ds_read_b64_tr_b16 v[98:99], v20 offset:10240
    s_waitcnt lgkmcnt(6)
    v_mfma_f32_16x16x32_bf16 v[164:167], v[116:119], v[200:203], v[164:167]
    ds_read_b64_tr_b16 v[100:101], v21 offset:8192
    v_mfma_f32_16x16x32_bf16 v[180:183], v[116:119], v[204:207], v[180:183]
    ds_read_b64_tr_b16 v[102:103], v21 offset:10240
    s_waitcnt lgkmcnt(6)
    v_mfma_f32_16x16x32_bf16 v[168:171], v[120:123], v[200:203], v[168:171]
    ds_read_b64_tr_b16 v[104:105], v22 offset:8192
    v_mfma_f32_16x16x32_bf16 v[184:187], v[120:123], v[204:207], v[184:187]
    ds_read_b64_tr_b16 v[106:107], v22 offset:10240
    s_waitcnt lgkmcnt(6)
    v_mfma_f32_16x16x32_bf16 v[172:175], v[124:127], v[200:203], v[172:175]
    ds_read_b64_tr_b16 v[108:109], v23 offset:8192
    v_mfma_f32_16x16x32_bf16 v[188:191], v[124:127], v[204:207], v[188:191]
    ds_read_b64_tr_b16 v[110:111], v23 offset:10240
    buffer_load_dwordx4 v[200:203], v24, s[60:63], s76 offen
    buffer_load_dwordx4 v[204:207], v25, s[60:63], s76 offen
    s_add_u32 s76, s76, 1024
    s_and_b32 s76, s76, 0x7fff
    s_waitcnt vmcnt(14) lgkmcnt(6)
    v_mfma_f32_16x16x32_bf16 v[160:163], v[96:99], v[208:211], v[160:163]
    ds_read_b64_tr_b16 v[112:113], v20 offset:12288
    v_mfma_f32_16x16x32_bf16 v[176:179], v[96:99], v[212:215], v[176:179]
    ds_read_b64_tr_b16 v[114:115], v20 offset:14336
    s_waitcnt lgkmcnt(6)
    v_mfma_f32_16x16x32_bf16 v[164:167], v[100:103], v[208:211], v[164:167]
    ds_read_b64_tr_b16 v[116:117], v21 offset:12288
    v_mfma_f32_16x16x32_bf16 v[180:183], v[100:103], v[212:215], v[180:183]
    ds_read_b64_tr_b16 v[118:119], v21 offset:14336
    s_waitcnt lgkmcnt(6)
    v_mfma_f32_16x16x32_bf16 v[168:171], v[104:107], v[208:211], v[168:171]
    ds_read_b64_tr_b16 v[120:121], v22 offset:12288
    v_mfma_f32_16x16x32_bf16 v[184:187], v[104:107], v[212:215], v[184:187]
    ds_read_b64_tr_b16 v[122:123], v22 offset:14336
    s_waitcnt lgkmcnt(6)
    v_mfma_f32_16x16x32_bf16 v[172:175], v[108:111], v[208:211], v[172:175]
    ds_read_b64_tr_b16 v[124:125], v23 offset:12288
    v_mfma_f32_16x16x32_bf16 v[188:191], v[108:111], v[212:215], v[188:191]
    ds_read_b64_tr_b16 v[126:127], v23 offset:14336
    buffer_load_dwordx4 v[208:211], v24, s[60:63], s76 offen
    buffer_load_dwordx4 v[212:215], v25, s[60:63], s76 offen
    s_add_u32 s76, s76, 1024
    s_and_b32 s76, s76, 0x7fff
    s_waitcnt vmcnt(14) lgkmcnt(6)
    v_mfma_f32_16x16x32_bf16 v[160:163], v[112:115], v[216:219], v[160:163]
    ds_read_b64_tr_b16 v[96:97], v20 offset:16384
    v_mfma_f32_16x16x32_bf16 v[176:179], v[112:115], v[220:223], v[176:179]
    ds_read_b64_tr_b16 v[98:99], v20 offset:18432
    s_waitcnt lgkmcnt(6)
    v_mfma_f32_16x16x32_bf16 v[164:167], v[116:119], v[216:219], v[164:167]
    ds_read_b64_tr_b16 v[100:101], v21 offset:16384
    v_mfma_f32_16x16x32_bf16 v[180:183], v[116:119], v[220:223], v[180:183]
    ds_read_b64_tr_b16 v[102:103], v21 offset:18432
    s_waitcnt lgkmcnt(6)
    v_mfma_f32_16x16x32_bf16 v[168:171], v[120:123], v[216:219], v[168:171]
    ds_read_b64_tr_b16 v[104:105], v22 offset:16384
    v_mfma_f32_16x16x32_bf16 v[184:187], v[120:123], v[220:223], v[184:187]
    ds_read_b64_tr_b16 v[106:107], v22 offset:18432
    s_waitcnt lgkmcnt(6)
    v_mfma_f32_16x16x32_bf16 v[172:175], v[124:127], v[216:219], v[172:175]
    ds_read_b64_tr_b16 v[108:109], v23 offset:16384
    v_mfma_f32_16x16x32_bf16 v[188:191], v[124:127], v[220:223], v[188:191]
    ds_read_b64_tr_b16 v[110:111], v23 offset:18432
    buffer_load_dwordx4 v[216:219], v24, s[60:63], s76 offen
    buffer_load_dwordx4 v[220:223], v25, s[60:63], s76 offen
    s_add_u32 s76, s76, 1024
    s_and_b32 s76, s76, 0x7fff
    s_waitcnt vmcnt(14) lgkmcnt(6)
    v_mfma_f32_16x16x32_bf16 v[160:163], v[96:99], v[224:227], v[160:163]
    ds_read_b64_tr_b16 v[112:113], v20 offset:20480
    v_mfma_f32_16x16x32_bf16 v[176:179], v[96:99], v[228:231], v[176:179]
    ds_read_b64_tr_b16 v[114:115], v20 offset:22528
    s_waitcnt lgkmcnt(6)
    v_mfma_f32_16x16x32_bf16 v[164:167], v[100:103], v[224:227], v[164:167]
    ds_read_b64_tr_b16 v[116:117], v21 offset:20480
    v_mfma_f32_16x16x32_bf16 v[180:183], v[100:103], v[228:231], v[180:183]
    ds_read_b64_tr_b16 v[118:119], v21 offset:22528
    s_waitcnt lgkmcnt(6)
    v_mfma_f32_16x16x32_bf16 v[168:171], v[104:107], v[224:227], v[168:171]
    ds_read_b64_tr_b16 v[120:121], v22 offset:20480
    v_mfma_f32_16x16x32_bf16 v[184:187], v[104:107], v[228:231], v[184:187]
    ds_read_b64_tr_b16 v[122:123], v22 offset:22528
    s_waitcnt lgkmcnt(6)
    v_mfma_f32_16x16x32_bf16 v[172:175], v[108:111], v[224:227], v[172:175]
    ds_read_b64_tr_b16 v[124:125], v23 offset:20480
    v_mfma_f32_16x16x32_bf16 v[188:191], v[108:111], v[228:231], v[188:191]
    ds_read_b64_tr_b16 v[126:127], v23 offset:22528
    buffer_load_dwordx4 v[224:227], v24, s[60:63], s76 offen
    buffer_load_dwordx4 v[228:231], v25, s[60:63], s76 offen
    s_add_u32 s76, s76, 1024
    s_and_b32 s76, s76, 0x7fff
    s_waitcnt vmcnt(14) lgkmcnt(6)
    v_mfma_f32_16x16x32_bf16 v[160:163], v[112:115], v[232:235], v[160:163]
    ds_read_b64_tr_b16 v[96:97], v20 offset:24576
    v_mfma_f32_16x16x32_bf16 v[176:179], v[112:115], v[236:239], v[176:179]
    ds_read_b64_tr_b16 v[98:99], v20 offset:26624
    s_waitcnt lgkmcnt(6)
    v_mfma_f32_16x16x32_bf16 v[164:167], v[116:119], v[232:235], v[164:167]
    ds_read_b64_tr_b16 v[100:101], v21 offset:24576
    v_mfma_f32_16x16x32_bf16 v[180:183], v[116:119], v[236:239], v[180:183]
    ds_read_b64_tr_b16 v[102:103], v21 offset:26624
    s_waitcnt lgkmcnt(6)
    v_mfma_f32_16x16x32_bf16 v[168:171], v[120:123], v[232:235], v[168:171]
    ds_read_b64_tr_b16 v[104:105], v22 offset:24576
    v_mfma_f32_16x16x32_bf16 v[184:187], v[120:123], v[236:239], v[184:187]
    ds_read_b64_tr_b16 v[106:107], v22 offset:26624
    s_waitcnt lgkmcnt(6)
    v_mfma_f32_16x16x32_bf16 v[172:175], v[124:127], v[232:235], v[172:175]
    ds_read_b64_tr_b16 v[108:109], v23 offset:24576
    v_mfma_f32_16x16x32_bf16 v[188:191], v[124:127], v[236:239], v[188:191]
    ds_read_b64_tr_b16 v[110:111], v23 offset:26624
    buffer_load_dwordx4 v[232:235], v24, s[60:63], s76 offen
    buffer_load_dwordx4 v[236:239], v25, s[60:63], s76 offen
    s_add_u32 s76, s76, 1024
    s_and_b32 s76, s76, 0x7fff
    s_waitcnt vmcnt(14) lgkmcnt(6)
    v_mfma_f32_16x16x32_bf16 v[160:163], v[96:99], v[240:243], v[160:163]
    ds_read_b64_tr_b16 v[112:113], v20 offset:28672
    v_mfma_f32_16x16x32_bf16 v[176:179], v[96:99], v[244:247], v[176:179]
    ds_read_b64_tr_b16 v[114:115], v20 offset:30720
    s_waitcnt lgkmcnt(6)
    v_mfma_f32_16x16x32_bf16 v[164:167], v[100:103], v[240:243], v[164:167]
    ds_read_b64_tr_b16 v[116:117], v21 offset:28672
    v_mfma_f32_16x16x32_bf16 v[180:183], v[100:103], v[244:247], v[180:183]
    ds_read_b64_tr_b16 v[118:119], v21 offset:30720
    s_waitcnt lgkmcnt(6)
    v_mfma_f32_16x16x32_bf16 v[168:171], v[104:107], v[240:243], v[168:171]
    ds_read_b64_tr_b16 v[120:121], v22 offset:28672
    v_mfma_f32_16x16x32_bf16 v[184:187], v[104:107], v[244:247], v[184:187]
    ds_read_b64_tr_b16 v[122:123], v22 offset:30720
    s_waitcnt lgkmcnt(6)
    v_mfma_f32_16x16x32_bf16 v[172:175], v[108:111], v[240:243], v[172:175]
    ds_read_b64_tr_b16 v[124:125], v23 offset:28672
    v_mfma_f32_16x16x32_bf16 v[188:191], v[108:111], v[244:247], v[188:191]
    ds_read_b64_tr_b16 v[126:127], v23 offset:30720
    buffer_load_dwordx4 v[240:243], v24, s[60:63], s76 offen
    buffer_load_dwordx4 v[244:247], v25, s[60:63], s76 offen
    s_add_u32 s76, s76, 1024
    s_and_b32 s76, s76, 0x7fff
    v_add_u32 v20, s3, v20
    v_add_u32 v21, s3, v21
    v_add_u32 v22, s3, v22
    v_add_u32 v23, s3, v23
    s_waitcnt vmcnt(14) lgkmcnt(6)
    v_mfma_f32_16x16x32_bf16 v[160:163], v[112:115], v[248:251], v[160:163]
    ds_read_b64_tr_b16 v[96:97], v20 offset:0
    v_mfma_f32_16x16x32_bf16 v[176:179], v[112:115], v[252:255], v[176:179]
    ds_read_b64_tr_b16 v[98:99], v20 offset:2048
    s_waitcnt lgkmcnt(6)
    v_mfma_f32_16x16x32_bf16 v[164:167], v[116:119], v[248:251], v[164:167]
    ds_read_b64_tr_b16 v[100:101], v21 offset:0
    v_mfma_f32_16x16x32_bf16 v[180:183], v[116:119], v[252:255], v[180:183]
    ds_read_b64_tr_b16 v[102:103], v21 offset:2048
    s_waitcnt lgkmcnt(6)
    v_mfma_f32_16x16x32_bf16 v[168:171], v[120:123], v[248:251], v[168:171]
    ds_read_b64_tr_b16 v[104:105], v22 offset:0
    v_mfma_f32_16x16x32_bf16 v[184:187], v[120:123], v[252:255], v[184:187]
    ds_read_b64_tr_b16 v[106:107], v22 offset:2048
    s_waitcnt lgkmcnt(6)
    v_mfma_f32_16x16x32_bf16 v[172:175], v[124:127], v[248:251], v[172:175]
    ds_read_b64_tr_b16 v[108:109], v23 offset:0
    v_mfma_f32_16x16x32_bf16 v[188:191], v[124:127], v[252:255], v[188:191]
    ds_read_b64_tr_b16 v[110:111], v23 offset:2048
    buffer_load_dwordx4 v[248:251], v24, s[60:63], s76 offen
    buffer_load_dwordx4 v[252:255], v25, s[60:63], s76 offen
    s_add_u32 s76, s76, 1024
    s_and_b32 s76, s76, 0x7fff
    s_add_u32 s66, s66, 1
    s_cmp_lt_u32 s66, 4
    s_cbranch_scc1 L_p5
    s_waitcnt lgkmcnt(0)
    s_lshr_b32 s77, s77, 4
    s_and_b32 s77, s77, 2047
    s_sub_u32 s77, 2047, s77
    s_lshr_b32 s19, s77, 5
    s_cmp_eq_u32 s19, s58
    s_cbranch_scc1 L_own
L_ownret:
    v_cvt_pk_bf16_f32 v160, v160, v161
    v_cvt_pk_bf16_f32 v161, v162, v163
    v_cvt_pk_bf16_f32 v168, v168, v169
    v_cvt_pk_bf16_f32 v162, v164, v165
    v_cvt_pk_bf16_f32 v163, v166, v167
    v_cvt_pk_bf16_f32 v169, v170, v171
    v_cvt_pk_bf16_f32 v176, v176, v177
    v_cvt_pk_bf16_f32 v170, v172, v173
    v_cvt_pk_bf16_f32 v171, v174, v175
    v_cvt_pk_bf16_f32 v177, v178, v179
    v_cvt_pk_bf16_f32 v184, v184, v185
    v_cvt_pk_bf16_f32 v178, v180, v181
    v_cvt_pk_bf16_f32 v179, v182, v183
    v_cvt_pk_bf16_f32 v185, v186, v187
    v_permlane16_swap_b32 v160, v162
    v_permlane16_swap_b32 v161, v163
    v_cvt_pk_bf16_f32 v186, v188, v189
    v_cvt_pk_bf16_f32 v187, v190, v191
    v_permlane16_swap_b32 v168, v170
    v_permlane16_swap_b32 v169, v171
    v_dot2_f32_bf16 v96, v160, v80, 0
    v_dot2_f32_bf16 v97, v160, v82, 0
    v_dot2_f32_bf16 v98, v161, v80, 0
    v_dot2_f32_bf16 v99, v161, v82, 0
    v_dot2_f32_bf16 v100, v162, v80, 0
    v_dot2_f32_bf16 v101, v162, v82, 0
    v_dot2_f32_bf16 v102, v163, v80, 0
    v_dot2_f32_bf16 v103, v163, v82, 0
    v_permlane16_swap_b32 v176, v178
    v_permlane16_swap_b32 v177, v179
    v_dot2_f32_bf16 v104, v168, v80, 0
    v_dot2_f32_bf16 v105, v168, v82, 0
    v_dot2_f32_bf16 v106, v169, v80, 0
    v_dot2_f32_bf16 v107, v169, v82, 0
    v_dot2_f32_bf16 v108, v170, v80, 0
    v_dot2_f32_bf16 v109, v170, v82, 0
    v_dot2_f32_bf16 v110, v171, v80, 0
    v_dot2_f32_bf16 v111, v171, v82, 0
    v_permlane16_swap_b32 v184, v186
    v_permlane16_swap_b32 v185, v187
    v_dot2_f32_bf16 v112, v176, v81, 0
    v_dot2_f32_bf16 v113, v176, v83, 0
    v_dot2_f32_bf16 v114, v177, v81, 0
    v_dot2_f32_bf16 v115, v177, v83, 0
    v_dot2_f32_bf16 v116, v178, v81, 0
    v_dot2_f32_bf16 v117, v178, v83, 0
    v_dot2_f32_bf16 v118, v179, v81, 0
    v_dot2_f32_bf16 v119, v179, v83, 0
    v_dot2_f32_bf16 v120, v184, v81, 0
    v_dot2_f32_bf16 v121, v184, v83, 0
    v_dot2_f32_bf16 v122, v185, v81, 0
    v_dot2_f32_bf16 v123, v185, v83, 0
    v_dot2_f32_bf16 v124, v186, v81, 0
    v_dot2_f32_bf16 v125, v186, v83, 0
    v_dot2_f32_bf16 v126, v187, v81, 0
    v_dot2_f32_bf16 v127, v187, v83, 0
    v_cvt_pk_bf16_f32 v160, v96, v97
    v_cvt_pk_bf16_f32 v161, v98, v99
    v_cvt_pk_bf16_f32 v162, v100, v101
    v_cvt_pk_bf16_f32 v163, v102, v103
    s_mov_b32 s74, 0x3f80
    s_mov_b32 s75, 0x3f800000
    v_cvt_pk_bf16_f32 v168, v104, v105
    v_cvt_pk_bf16_f32 v169, v106, v107
    v_cvt_pk_bf16_f32 v170, v108, v109
    v_cvt_pk_bf16_f32 v171, v110, v111
    v_dot2_f32_bf16 v96, v160, s74, v128
    v_dot2_f32_bf16 v97, v160, s75, v129
    v_dot2_f32_bf16 v98, v161, s74, v130
    v_dot2_f32_bf16 v99, v161, s75, v131
    v_dot2_f32_bf16 v100, v162, s74, v132
    v_dot2_f32_bf16 v101, v162, s75, v133
    v_dot2_f32_bf16 v102, v163, s74, v134
    v_dot2_f32_bf16 v103, v163, s75, v135
    v_cvt_pk_bf16_f32 v176, v112, v113
    v_cvt_pk_bf16_f32 v177, v114, v115
    v_cvt_pk_bf16_f32 v178, v116, v117
    v_cvt_pk_bf16_f32 v179, v118, v119
    v_dot2_f32_bf16 v104, v168, s74, v136
    v_dot2_f32_bf16 v105, v168, s75, v137
    v_dot2_f32_bf16 v106, v169, s74, v138
    v_dot2_f32_bf16 v107, v169, s75, v139
    v_dot2_f32_bf16 v108, v170, s74, v140
    v_dot2_f32_bf16 v109, v170, s75, v141
    v_dot2_f32_bf16 v110, v171, s74, v142
    v_dot2_f32_bf16 v111, v171, s75, v143
    v_cvt_pk_bf16_f32 v184, v120, v121
    v_cvt_pk_bf16_f32 v185, v122, v123
    v_cvt_pk_bf16_f32 v186, v124, v125
    v_cvt_pk_bf16_f32 v187, v126, v127
    v_dot2_f32_bf16 v112, v176, s74, v144
    v_dot2_f32_bf16 v113, v176, s75, v145
    v_dot2_f32_bf16 v114, v177, s74, v146
    v_dot2_f32_bf16 v115, v177, s75, v147
    v_dot2_f32_bf16 v116, v178, s74, v148
    v_dot2_f32_bf16 v117, v178, s75, v149
    v_dot2_f32_bf16 v118, v179, s74, v150
    v_dot2_f32_bf16 v119, v179, s75, v151
    v_dot2_f32_bf16 v120, v184, s74, v152
    v_dot2_f32_bf16 v121, v184, s75, v153
    v_dot2_f32_bf16 v122, v185, s74, v154
    v_dot2_f32_bf16 v123, v185, s75, v155
    v_dot2_f32_bf16 v124, v186, s74, v156
    v_dot2_f32_bf16 v125, v186, s75, v157
    v_dot2_f32_bf16 v126, v187, s74, v158
    v_dot2_f32_bf16 v127, v187, s75, v159
    v_cvt_pk_bf16_f32 v160, v96, v97
    v_cvt_pk_bf16_f32 v161, v98, v99
    v_cvt_pk_bf16_f32 v162, v100, v101
    v_cvt_pk_bf16_f32 v163, v102, v103
    v_cvt_pk_bf16_f32 v168, v104, v105
    v_cvt_pk_bf16_f32 v169, v106, v107
    v_cvt_pk_bf16_f32 v170, v108, v109
    v_cvt_pk_bf16_f32 v171, v110, v111
    buffer_store_dwordx4 v[160:163], v26, s[44:47], s54 offen offset:0 sc1
    v_cvt_pk_bf16_f32 v176, v112, v113
    v_cvt_pk_bf16_f32 v177, v114, v115
    v_cvt_pk_bf16_f32 v178, v116, v117
    v_cvt_pk_bf16_f32 v179, v118, v119
    buffer_store_dwordx4 v[168:171], v26, s[44:47], s54 offen offset:64 sc1
    v_cvt_pk_bf16_f32 v184, v120, v121
    v_cvt_pk_bf16_f32 v185, v122, v123
    v_cvt_pk_bf16_f32 v186, v124, v125
    v_cvt_pk_bf16_f32 v187, v126, v127
    buffer_store_dwordx4 v[176:179], v26, s[44:47], s55 offen offset:0 sc1
    buffer_store_dwordx4 v[184:187], v26, s[44:47], s55 offen offset:64 sc1
    s_endpgm
L_own:
    v_and_b32 v54, 16, v2
    v_lshlrev_b32 v54, 2, v54
    v_and_b32 v55, 32, v2
    v_add_u32 v54, v54, v55
L_xo37:
    ds_read_b32 v88, v13 offset:224
    ds_read_b128 v[96:99], v54 offset:512
    ds_read_b128 v[100:103], v54 offset:528
    ds_read_b128 v[104:107], v54 offset:640
    ds_read_b128 v[108:111], v54 offset:656
    s_waitcnt lgkmcnt(0)
    v_cmp_ne_u32 vcc, v88, v18
    s_cbranch_vccz L_xk38
    s_add_u32 s79, s79, 1
    s_cmp_lt_u32 s79, 32768
    s_cbranch_scc1 L_xo37
L_xk38:
    s_and_b32 s77, s77, 31
    v_and_b32 v54, 15, v2
    v_cmp_eq_u32 vcc, s77, v54
    s_nop 1
    v_cndmask_b32 v128, v128, v96, vcc
    v_cndmask_b32 v129, v129, v97, vcc
    v_cndmask_b32 v130, v130, v98, vcc
    v_cndmask_b32 v131, v131, v99, vcc
    v_cndmask_b32 v132, v132, v100, vcc
    v_cndmask_b32 v133, v133, v101, vcc
    v_cndmask_b32 v134, v134, v102, vcc
    v_cndmask_b32 v135, v135, v103, vcc
    v_cndmask_b32 v136, v136, v104, vcc
    v_cndmask_b32 v137, v137, v105, vcc
    v_cndmask_b32 v138, v138, v106, vcc
    v_cndmask_b32 v139, v139, v107, vcc
    v_cndmask_b32 v140, v140, v108, vcc
    v_cndmask_b32 v141, v141, v109, vcc
    v_cndmask_b32 v142, v142, v110, vcc
    v_cndmask_b32 v143, v143, v111, vcc
    v_add_u32 v54, 16, v54
    v_cmp_eq_u32 vcc, s77, v54
    s_nop 1
    v_cndmask_b32 v144, v144, v96, vcc
    v_cndmask_b32 v145, v145, v97, vcc
    v_cndmask_b32 v146, v146, v98, vcc
    v_cndmask_b32 v147, v147, v99, vcc
    v_cndmask_b32 v148, v148, v100, vcc
    v_cndmask_b32 v149, v149, v101, vcc
    v_cndmask_b32 v150, v150, v102, vcc
    v_cndmask_b32 v151, v151, v103, vcc
    v_cndmask_b32 v152, v152, v104, vcc
    v_cndmask_b32 v153, v153, v105, vcc
    v_cndmask_b32 v154, v154, v106, vcc
    v_cndmask_b32 v155, v155, v107, vcc
    v_cndmask_b32 v156, v156, v108, vcc
    v_cndmask_b32 v157, v157, v109, vcc
    v_cndmask_b32 v158, v158, v110, vcc
    v_cndmask_b32 v159, v159, v111, vcc
    s_branch L_ownret
L_k2s:
    v_pk_add_f32 v[192:193], v[192:193], v[120:121]
    v_pk_add_f32 v[194:195], v[194:195], v[122:123]
    v_bfi_b32 v192, v15, s80, v192
    v_bfi_b32 v193, v15, s81, v193
    v_bfi_b32 v194, v15, s82, v194
    v_bfi_b32 v195, v15, s83, v195
    v_pk_add_f32 v[196:197], v[196:197], v[124:125]
    v_pk_add_f32 v[198:199], v[198:199], v[126:127]
    v_bfi_b32 v196, v15, s80, v196
    v_bfi_b32 v197, v15, s81, v197
    v_bfi_b32 v198, v15, s82, v198
    v_bfi_b32 v199, v15, s83, v199
    v_pk_add_f32 v[200:201], v[200:201], v[128:129]
    v_pk_add_f32 v[202:203], v[202:203], v[130:131]
    buffer_store_dwordx4 v[192:195], v3, s[32:35], s48 offen sc1
    s_add_u32 s48, s48, 16384
    v_bfi_b32 v200, v15, s80, v200
    v_bfi_b32 v201, v15, s81, v201
    v_bfi_b32 v202, v15, s82, v202
    v_bfi_b32 v203, v15, s83, v203
    v_pk_add_f32 v[204:205], v[204:205], v[132:133]
    v_pk_add_f32 v[206:207], v[206:207], v[134:135]
    buffer_store_dwordx4 v[196:199], v3, s[32:35], s48 offen sc1
    s_add_u32 s48, s48, 16384
    v_bfi_b32 v204, v15, s80, v204
    v_bfi_b32 v205, v15, s81, v205
    v_bfi_b32 v206, v15, s82, v206
    v_bfi_b32 v207, v15, s83, v207
    v_pk_add_f32 v[208:209], v[208:209], v[112:113]
    v_pk_add_f32 v[210:211], v[210:211], v[114:115]
    v_pk_add_f32 v[212:213], v[212:213], v[116:117]
    v_pk_add_f32 v[214:215], v[214:215], v[118:119]
    buffer_store_dwordx4 v[200:203], v3, s[32:35], s48 offen sc1
    s_add_u32 s48, s48, 16384
    v_bfi_b32 v208, v15, s80, v208
    v_bfi_b32 v209, v15, s81, v209
    v_bfi_b32 v210, v15, s82, v210
    v_bfi_b32 v211, v15, s83, v211
    v_bfi_b32 v212, v15, s80, v212
    v_bfi_b32 v213, v15, s81, v213
    v_bfi_b32 v214, v15, s82, v214
    v_bfi_b32 v215, v15, s83, v215
    buffer_store_dwordx4 v[204:207], v3, s[32:35], s48 offen sc1
    s_mov_b32 exec_lo, 0x10001
    s_mov_b32 exec_hi, 0x10001
    buffer_store_dwordx4 v[208:211], v8, s[32:35], s49 offen offset:0 sc1
    buffer_store_dwordx4 v[212:215], v8, s[32:35], s49 offen offset:1024 sc1
    s_mov_b64 exec, -1
    s_branch L_k2r
L_h1s:
    s_mov_b32 exec_lo, 0xffff
    s_mov_b32 exec_hi, 0xffff
    buffer_store_dword v96, v11, s[32:35], s64 offen sc1
    s_lshl_b64 exec, 1, s16
    buffer_store_dword v92, v13, s[32:35], s65 offen sc1
    s_mov_b64 exec, -1
    s_branch L_h1r
L_end:
    s_endpgm
.section .rodata,"a"
.p2align 6
.amdhsa_kernel fk_kernel
  .amdhsa_next_free_vgpr 256
  .amdhsa_next_free_sgpr 102
  .amdhsa_accum_offset 256
  .amdhsa_group_segment_fixed_size 0
  .amdhsa_kernarg_size 104
  .amdhsa_user_sgpr_count 2
  .amdhsa_user_sgpr_kernarg_segment_ptr 1
  .amdhsa_system_sgpr_workgroup_id_x 1
.end_amdhsa_kernel
```

```asm
; @launch kernel=fk_kernel grid=(256,1,1) block=(512,1,1) lds=163840
.amdgcn_target "amdgcn-amd-amdhsa--gfx950"
.text
.globl fk_kernel
.p2align 8
.type fk_kernel,@function
fk_kernel:
    s_load_dwordx4 s[4:7], s[0:1], 0
    s_load_dwordx4 s[8:11], s[0:1], 16
    s_load_dwordx16 s[84:99], s[0:1], 40
    s_getpc_b64 s[66:67]
L_cep:
    v_lshrrev_b32 v1, 6, v0
    s_and_b32 s3, s2, -8
    v_readfirstlane_b32 s16, v1
    s_nop 1
    s_add_u32 s3, s3, s16
    s_lshl_b32 s3, s3, 6
    s_min_u32 s3, s3, L_end-L_cep-4
    s_load_dword s68, s[66:67], s3
    s_cmp_ge_u32 s2, 256
    s_cbranch_scc1 L_end
    v_lshrrev_b32 v1, 6, v0
    v_and_b32 v2, 63, v0
    v_readfirstlane_b32 s16, v1
    v_lshrrev_b32 v4, 3, v2
    v_lshlrev_b32 v5, 11, v4
    v_and_b32 v6, 7, v2
    v_lshrrev_b32 v7, 4, v2
    v_xor_b32 v8, v6, v7
    v_lshl_add_u32 v10, v8, 4, v5
    v_xor_b32 v8, 4, v8
    v_lshl_add_u32 v11, v8, 4, v5
    v_mul_u32_u24 v5, 6144, v4
    v_and_b32 v7, 1, v7
    v_lshlrev_b32 v7, 2, v7
    v_xor_b32 v8, v6, v7
    s_and_b32 s12, s2, 7
    s_lshr_b32 s13, s2, 3
    s_and_b32 s14, s13, 15
    s_lshl_b32 s15, s12, 1
    s_lshr_b32 s19, s13, 4
    s_add_u32 s15, s15, s19
    s_and_b32 s17, s16, 3
    s_and_b32 s19, s16, 1
    s_lshl_b32 s19, s19, 1
    v_xor_b32 v8, s19, v8
    v_lshl_add_u32 v12, v8, 4, v5
    s_lshl_b32 s19, s14, 18
    v_add_u32 v10, s19, v10
    v_add_u32 v11, s19, v11
    s_lshl_b32 s19, s15, 7
    v_add_u32 v12, s19, v12
    s_lshl_b32 s64, s15, 1
    s_add_u32 s64, s64, s14
    s_andn2_b32 s76, 1, s15
    s_mul_i32 s76, s76, 0
    s_add_u32 s76, s76, s14
    s_bitcmp1_b32 3084, s15
    s_cselect_b32 s64, s76, s64
    s_and_b32 s64, s64, 3
    s_add_u32 s65, s12, 0
    s_and_b32 s65, s65, 3
    s_lshl_b32 s65, s65, 2
    s_and_b32 s72, s64, 3
    s_add_u32 s72, s72, s65
    s_mul_i32 s73, s72, 393216
    s_lshl_b32 s72, s72, 7
    s_lshl_b32 s74, s16, 15
    s_add_u32 s72, s72, s74
    s_mul_i32 s74, s16, 49152
    s_add_u32 s73, s73, s74
    s_lshl_b32 s75, s16, 10
    s_lshl_b32 m0, s16, 11
    s_add_u32 s74, s72, 16384
    s_waitcnt lgkmcnt(0)
    s_mov_b64 s[24:25], s[4:5]
    s_mov_b32 s26, 4194304
    s_mov_b32 s27, 0x00020000
    buffer_load_dwordx4 v10, s[24:27], s72 offen lds
    s_addk_i32 m0, 1024
    s_mov_b64 s[28:29], s[6:7]
    s_mov_b32 s30, 6291456
    s_mov_b32 s31, 0x00020000
    buffer_load_dwordx4 v11, s[24:27], s74 offen lds
    s_add_u32 m0, s75, 16384
    s_nop 0
    buffer_load_dwordx4 v12, s[28:31], s73 offen lds
    s_add_u32 m0, s75, 24576
    s_addk_i32 s73, 2048
    buffer_load_dwordx4 v12, s[28:31], s73 offen lds
    s_add_u32 m0, s75, 32768
    s_addk_i32 s73, 2048
    buffer_load_dwordx4 v12, s[28:31], s73 offen lds
    s_cmp_lt_u32 s16, 4
    s_cbranch_scc1 L_compute
    s_bfe_u32 s19, s14, 0x10002
    s_lshl_b32 s19, s19, 2
    s_add_u32 s19, s19, s17
    s_xor_b32 s3, s19, 4
    s_mul_i32 s66, s19, 49152
    s_mul_i32 s67, s3, 49152
    s_lshl_b32 s68, s19, 10
    s_add_u32 s68, s68, 16384
    s_lshl_b32 s69, s3, 10
    s_add_u32 s69, s69, 16384
    s_lshl_b32 s70, s17, 16
    s_lshl_b32 s71, s17, 12
    s_add_u32 s72, s64, 1
    s_and_b32 s72, s72, 3
    s_add_u32 s73, s65, 0
    s_and_b32 s73, s73, 15
    s_add_u32 s72, s72, s73
    s_mul_i32 s73, s72, 393216
    s_lshl_b32 s72, s72, 7
    s_add_u32 s74, s72, s70
    s_add_u32 s75, s73, s66
    s_add_u32 s76, s73, s67
    s_add_u32 m0, s71, 40960
    s_add_u32 s77, s74, 0
    buffer_load_dwordx4 v10, s[24:27], s77 offen lds
    s_add_u32 m0, s71, 41984
    s_add_u32 s77, s74, 16384
    buffer_load_dwordx4 v11, s[24:27], s77 offen lds
    s_add_u32 m0, s71, 43008
    s_add_u32 s77, s74, 32768
    buffer_load_dwordx4 v10, s[24:27], s77 offen lds
    s_add_u32 m0, s71, 44032
    s_add_u32 s77, s74, 49152
    buffer_load_dwordx4 v11, s[24:27], s77 offen lds
    s_add_u32 m0, s68, 40960
    s_add_u32 s77, s75, 0
    buffer_load_dwordx4 v12, s[28:31], s77 offen lds
    s_add_u32 m0, s68, 49152
    s_add_u32 s77, s75, 2048
    buffer_load_dwordx4 v12, s[28:31], s77 offen lds
    s_add_u32 m0, s68, 57344
    s_add_u32 s77, s75, 4096
    buffer_load_dwordx4 v12, s[28:31], s77 offen lds
    s_add_u32 m0, s69, 40960
    s_add_u32 s77, s76, 0
    buffer_load_dwordx4 v12, s[28:31], s77 offen lds
    s_mov_b64 s[32:33], s[98:99]
    s_mov_b32 s34, 16777216
    s_mov_b32 s35, 0x00020000
    s_mov_b64 s[36:37], s[96:97]
    s_mov_b32 s38, 256
    s_mov_b32 s39, 0x00020000
    s_mov_b64 s[40:41], s[84:85]
    s_mov_b32 s42, 2048
    s_mov_b32 s43, 0x00020000
    s_mov_b64 s[44:45], s[92:93]
    s_mov_b32 s46, 2048
    s_mov_b32 s47, 0x00020000
    s_mov_b64 s[48:49], s[86:87]
    s_mov_b32 s50, 7340032
    s_mov_b32 s51, 0x00020000
    s_mov_b64 s[52:53], s[88:89]
    s_mov_b32 s54, 7340032
    s_mov_b32 s55, 0x00020000
    s_mov_b64 s[56:57], s[90:91]
    s_mov_b32 s58, 7340032
    s_mov_b32 s59, 0x00020000
    s_mov_b64 s[60:61], s[10:11]
    s_mov_b32 s62, 2097152
    s_mov_b32 s63, 0x00020000
    s_mov_b32 s79, 0
    v_mov_b32 v13, 0
    v_lshlrev_b32 v3, 4, v2
    v_lshrrev_b32 v9, 4, v2
    v_and_b32 v8, 15, v2
    v_mul_u32_u24 v15, 7168, v9
    v_lshl_add_u32 v15, v8, 4, v15
    v_lshlrev_b32 v16, 11, v9
    v_lshl_add_u32 v16, v8, 4, v16
    v_lshrrev_b32 v19, 3, v2
    v_and_b32 v20, 7, v2
    v_lshlrev_b32 v17, 11, v19
    v_lshl_add_u32 v17, v20, 4, v17
    v_lshlrev_b32 v21, 1, v9
    v_xor_b32 v21, v20, v21
    v_lshlrev_b32 v18, 7, v19
    v_lshl_add_u32 v18, v21, 4, v18
    s_lshl_b32 s19, s17, 10
    s_add_u32 s19, s19, 32768
    v_add_u32 v18, s19, v18
    v_add_u32 v22, 65536, v18
    v_mov_b32 v23, 0xffff
    v_mov_b32 v24, 0xffff0000
    v_cmp_eq_u32 vcc, 0, v8
    s_nop 1
    v_cndmask_b32 v25, 0, v23, vcc
    v_cmp_eq_u32 vcc, 1, v8
    s_nop 1
    v_cndmask_b32 v4, v25, v24, vcc
    v_cmp_eq_u32 vcc, 2, v8
    s_nop 1
    v_cndmask_b32 v25, 0, v23, vcc
    v_cmp_eq_u32 vcc, 3, v8
    s_nop 1
    v_cndmask_b32 v5, v25, v24, vcc
    v_cmp_eq_u32 vcc, 4, v8
    s_nop 1
    v_cndmask_b32 v25, 0, v23, vcc
    v_cmp_eq_u32 vcc, 5, v8
    s_nop 1
    v_cndmask_b32 v6, v25, v24, vcc
    v_cmp_eq_u32 vcc, 6, v8
    s_nop 1
    v_cndmask_b32 v25, 0, v23, vcc
    v_cmp_eq_u32 vcc, 7, v8
    s_nop 1
    v_cndmask_b32 v7, v25, v24, vcc
    v_mov_b32 v23, 0x3ff
    s_getreg_b32 s23, hwreg(HW_REG_XCC_ID, 0, 4)
    v_and_b32 v36, 3, v2
    v_lshlrev_b32 v36, 2, v36
    v_mov_b32 v37, 0x7fc17fc1
    s_cmp_lt_u32 s2, 224
    s_cselect_b32 s50, s50, 0
    s_cselect_b32 s54, s54, 0
    s_lshl_b32 s0, s12, 7
    s_lshl_b32 s19, s17, 5
    s_add_u32 s0, s0, s19
    s_mul_i32 s1, s0, 7168
    s_lshl_b32 s19, s13, 8
    s_add_u32 s1, s1, s19
    s_waitcnt vmcnt(8)
    s_barrier
    s_add_u32 m0, s69, 49152
    s_add_u32 s77, s76, 2048
    buffer_load_dwordx4 v12, s[28:31], s77 offen lds
    s_add_u32 m0, s69, 57344
    s_add_u32 s77, s76, 4096
    buffer_load_dwordx4 v12, s[28:31], s77 offen lds
    s_add_u32 s72, s64, 2
    s_and_b32 s72, s72, 3
    s_add_u32 s73, s65, 0
    s_and_b32 s73, s73, 15
    s_add_u32 s72, s72, s73
    s_mul_i32 s73, s72, 393216
    s_lshl_b32 s72, s72, 7
    s_add_u32 s74, s72, s70
    s_add_u32 s75, s73, s66
    s_add_u32 s76, s73, s67
    s_add_u32 m0, s71, 81920
    s_add_u32 s77, s74, 0
    buffer_load_dwordx4 v10, s[24:27], s77 offen lds
    s_add_u32 m0, s71, 82944
    s_add_u32 s77, s74, 16384
    buffer_load_dwordx4 v11, s[24:27], s77 offen lds
    s_add_u32 m0, s71, 83968
    s_add_u32 s77, s74, 32768
    buffer_load_dwordx4 v10, s[24:27], s77 offen lds
    s_add_u32 m0, s71, 84992
    s_add_u32 s77, s74, 49152
    buffer_load_dwordx4 v11, s[24:27], s77 offen lds
    s_add_u32 m0, s68, 81920
    s_add_u32 s77, s75, 0
    buffer_load_dwordx4 v12, s[28:31], s77 offen lds
    s_add_u32 m0, s68, 90112
    s_add_u32 s77, s75, 2048
    buffer_load_dwordx4 v12, s[28:31], s77 offen lds
    s_add_u32 m0, s68, 98304
    s_add_u32 s77, s75, 4096
    buffer_load_dwordx4 v12, s[28:31], s77 offen lds
    s_add_u32 m0, s69, 81920
    s_add_u32 s77, s76, 0
    buffer_load_dwordx4 v12, s[28:31], s77 offen lds
    s_add_u32 m0, s69, 90112
    s_add_u32 s77, s76, 2048
    buffer_load_dwordx4 v12, s[28:31], s77 offen lds
    s_waitcnt vmcnt(9)
    s_barrier
    s_add_u32 m0, s69, 98304
    s_add_u32 s77, s76, 4096
    buffer_load_dwordx4 v12, s[28:31], s77 offen lds
    s_add_u32 s72, s64, 3
    s_and_b32 s72, s72, 3
    s_add_u32 s73, s65, 0
    s_and_b32 s73, s73, 15
    s_add_u32 s72, s72, s73
    s_mul_i32 s73, s72, 393216
    s_lshl_b32 s72, s72, 7
    s_add_u32 s74, s72, s70
    s_add_u32 s75, s73, s66
    s_add_u32 s76, s73, s67
    s_add_u32 m0, s71, 122880
    s_add_u32 s77, s74, 0
    buffer_load_dwordx4 v10, s[24:27], s77 offen lds
    s_add_u32 m0, s71, 123904
    s_add_u32 s77, s74, 16384
    buffer_load_dwordx4 v11, s[24:27], s77 offen lds
    s_add_u32 m0, s71, 124928
    s_add_u32 s77, s74, 32768
    buffer_load_dwordx4 v10, s[24:27], s77 offen lds
    s_add_u32 m0, s71, 125952
    s_add_u32 s77, s74, 49152
    buffer_load_dwordx4 v11, s[24:27], s77 offen lds
    s_add_u32 m0, s68, 122880
    s_add_u32 s77, s75, 0
    buffer_load_dwordx4 v12, s[28:31], s77 offen lds
    s_add_u32 m0, s68, 131072
    s_add_u32 s77, s75, 2048
    buffer_load_dwordx4 v12, s[28:31], s77 offen lds
    s_add_u32 m0, s68, 139264
    s_add_u32 s77, s75, 4096
    buffer_load_dwordx4 v12, s[28:31], s77 offen lds
    s_add_u32 m0, s69, 122880
    s_add_u32 s77, s76, 0
    buffer_load_dwordx4 v12, s[28:31], s77 offen lds
    s_add_u32 m0, s69, 131072
    s_add_u32 s77, s76, 2048
    buffer_load_dwordx4 v12, s[28:31], s77 offen lds
    s_add_u32 m0, s69, 139264
    s_add_u32 s77, s76, 4096
    buffer_load_dwordx4 v12, s[28:31], s77 offen lds
    s_lshl_b32 s18, s14, 7
    s_lshl_b32 s19, s15, 3
    s_add_u32 s18, s18, s19
    s_lshl_b32 s19, s17, 1
    s_add_u32 s18, s18, s19
    s_lshl_b32 s19, s18, 11
    buffer_load_dwordx4 v[40:43], v3, s[24:27], s19 offen offset:0
    buffer_load_dwordx4 v[44:47], v3, s[24:27], s19 offen offset:1024
    buffer_load_dwordx4 v[48:51], v3, s[24:27], s19 offen offset:2048
    buffer_load_dwordx4 v[52:55], v3, s[24:27], s19 offen offset:3072
    buffer_load_dwordx4 v[56:59], v3, s[40:43], 0 offen offset:0
    buffer_load_dwordx4 v[60:63], v3, s[40:43], 0 offen offset:1024
    buffer_load_dwordx4 v[64:67], v3, s[44:47], 0 offen offset:0
    buffer_load_dwordx4 v[68:71], v3, s[44:47], 0 offen offset:1024
    buffer_load_dword v14, v13, s[36:39], 0 offen offset:4 sc1
    s_waitcnt vmcnt(19)
    s_barrier
    s_add_u32 s72, s64, 0
    s_and_b32 s72, s72, 3
    s_add_u32 s73, s65, 4
    s_and_b32 s73, s73, 15
    s_add_u32 s72, s72, s73
    s_mul_i32 s73, s72, 393216
    s_lshl_b32 s72, s72, 7
    s_add_u32 s74, s72, s70
    s_add_u32 s75, s73, s66
    s_add_u32 s76, s73, s67
    s_add_u32 m0, s71, 0
    s_add_u32 s77, s74, 0
    buffer_load_dwordx4 v10, s[24:27], s77 offen lds
    s_add_u32 m0, s71, 1024
    s_add_u32 s77, s74, 16384
    buffer_load_dwordx4 v11, s[24:27], s77 offen lds
    s_add_u32 m0, s71, 2048
    s_add_u32 s77, s74, 32768
    buffer_load_dwordx4 v10, s[24:27], s77 offen lds
    s_add_u32 m0, s71, 3072
    s_add_u32 s77, s74, 49152
    buffer_load_dwordx4 v11, s[24:27], s77 offen lds
    s_add_u32 m0, s68, 0
    s_add_u32 s77, s75, 0
    buffer_load_dwordx4 v12, s[28:31], s77 offen lds
    s_add_u32 m0, s68, 8192
    s_add_u32 s77, s75, 2048
    buffer_load_dwordx4 v12, s[28:31], s77 offen lds
    s_add_u32 m0, s68, 16384
    s_add_u32 s77, s75, 4096
    buffer_load_dwordx4 v12, s[28:31], s77 offen lds
    s_add_u32 m0, s69, 0
    s_add_u32 s77, s76, 0
    buffer_load_dwordx4 v12, s[28:31], s77 offen lds
    s_add_u32 m0, s69, 8192
    s_add_u32 s77, s76, 2048
    buffer_load_dwordx4 v12, s[28:31], s77 offen lds
    s_add_u32 m0, s69, 16384
    s_add_u32 s77, s76, 4096
    buffer_load_dwordx4 v12, s[28:31], s77 offen lds
    s_waitcnt vmcnt(19)
    s_barrier
    s_add_u32 s72, s64, 1
    s_and_b32 s72, s72, 3
    s_add_u32 s73, s65, 4
    s_and_b32 s73, s73, 15
    s_add_u32 s72, s72, s73
    s_mul_i32 s73, s72, 393216
    s_lshl_b32 s72, s72, 7
    s_add_u32 s74, s72, s70
    s_add_u32 s75, s73, s66
    s_add_u32 s76, s73, s67
    s_add_u32 m0, s71, 40960
    s_add_u32 s77, s74, 0
    buffer_load_dwordx4 v10, s[24:27], s77 offen lds
    s_add_u32 m0, s71, 41984
    s_add_u32 s77, s74, 16384
    buffer_load_dwordx4 v11, s[24:27], s77 offen lds
    s_add_u32 m0, s71, 43008
    s_add_u32 s77, s74, 32768
    buffer_load_dwordx4 v10, s[24:27], s77 offen lds
    s_add_u32 m0, s71, 44032
    s_add_u32 s77, s74, 49152
    buffer_load_dwordx4 v11, s[24:27], s77 offen lds
    s_add_u32 m0, s68, 40960
    s_add_u32 s77, s75, 0
    buffer_load_dwordx4 v12, s[28:31], s77 offen lds
    s_add_u32 m0, s68, 49152
    s_add_u32 s77, s75, 2048
    buffer_load_dwordx4 v12, s[28:31], s77 offen lds
    s_add_u32 m0, s68, 57344
    s_add_u32 s77, s75, 4096
    buffer_load_dwordx4 v12, s[28:31], s77 offen lds
    s_add_u32 m0, s69, 40960
    s_add_u32 s77, s76, 0
    buffer_load_dwordx4 v12, s[28:31], s77 offen lds
    s_add_u32 m0, s69, 49152
    s_add_u32 s77, s76, 2048
    buffer_load_dwordx4 v12, s[28:31], s77 offen lds
    s_add_u32 m0, s69, 57344
    s_add_u32 s77, s76, 4096
    buffer_load_dwordx4 v12, s[28:31], s77 offen lds
    s_waitcnt vmcnt(21)
    s_waitcnt vmcnt(20)
    v_readfirstlane_b32 s78, v14
L_tg1:
    s_nop 1
    s_cmp_lg_u32 s78, 0
    s_cbranch_scc1 L_tk2
    buffer_load_dword v14, v13, s[36:39], 0 offen offset:4 sc1
    s_waitcnt vmcnt(0)
    v_readfirstlane_b32 s78, v14
    s_add_u32 s79, s79, 1
    s_cmp_lt_u32 s79, 32768
    s_cbranch_scc1 L_tg1
L_tk2:
    s_mul_i32 s80, s78, 0x9e3779b1
    s_lshr_b32 s80, s80, 22
    s_mul_i32 s81, s78, 0x85ebca77
    s_lshr_b32 s81, s81, 22
    s_mul_i32 s82, s78, 0xc2b2ae3d
    s_lshr_b32 s82, s82, 22
    s_mul_i32 s83, s78, 0x27d4eb2f
    s_lshr_b32 s83, s83, 22
    v_and_b32 v72, 0xffff, v64
    v_and_b32 v80, 0xffff0000, v64
    v_and_b32 v73, 0xffff, v65
    v_and_b32 v81, 0xffff0000, v65
    v_dot2_f32_bf16 v92, v40, v72, 0
    v_dot2_f32_bf16 v93, v40, v80, 0
    v_and_b32 v74, 0xffff, v66
    v_and_b32 v82, 0xffff0000, v66
    v_dot2_f32_bf16 v94, v41, v73, 0
    v_dot2_f32_bf16 v95, v41, v81, 0
    v_and_b32 v75, 0xffff, v67
    v_and_b32 v83, 0xffff0000, v67
    v_cvt_pk_bf16_f32 v92, v92, v93
    v_dot2_f32_bf16 v96, v42, v74, 0
    v_dot2_f32_bf16 v97, v42, v82, 0
    s_mov_b32 s19, 0x3f803f80
    v_and_b32 v76, 0xffff, v68
    v_and_b32 v84, 0xffff0000, v68
    v_dot2_f32_bf16 v89, v92, s19, 0
    v_cvt_pk_bf16_f32 v94, v94, v95
    v_dot2_f32_bf16 v98, v43, v75, 0
    v_dot2_f32_bf16 v99, v43, v83, 0
    v_and_b32 v77, 0xffff, v69
    v_and_b32 v85, 0xffff0000, v69
    v_dot2_f32_bf16 v89, v94, s19, v89
    v_cvt_pk_bf16_f32 v96, v96, v97
    v_dot2_f32_bf16 v92, v44, v76, 0
    v_dot2_f32_bf16 v93, v44, v84, 0
    v_and_b32 v78, 0xffff, v70
    v_and_b32 v86, 0xffff0000, v70
    v_dot2_f32_bf16 v89, v96, s19, v89
    v_cvt_pk_bf16_f32 v98, v98, v99
    v_dot2_f32_bf16 v94, v45, v77, 0
    v_dot2_f32_bf16 v95, v45, v85, 0
    v_and_b32 v79, 0xffff, v71
    v_and_b32 v87, 0xffff0000, v71
    v_dot2_f32_bf16 v89, v98, s19, v89
    v_cvt_pk_bf16_f32 v92, v92, v93
    v_dot2_f32_bf16 v96, v46, v78, 0
    v_dot2_f32_bf16 v97, v46, v86, 0
    v_dot2_f32_bf16 v89, v92, s19, v89
    v_cvt_pk_bf16_f32 v94, v94, v95
    v_dot2_f32_bf16 v98, v47, v79, 0
    v_dot2_f32_bf16 v99, v47, v87, 0
    v_dot2_f32_bf16 v92, v48, v72, 0
    v_dot2_f32_bf16 v93, v48, v80, 0
    v_dot2_f32_bf16 v89, v94, s19, v89
    v_cvt_pk_bf16_f32 v96, v96, v97
    v_dot2_f32_bf16 v94, v49, v73, 0
    v_dot2_f32_bf16 v95, v49, v81, 0
    v_dot2_f32_bf16 v89, v96, s19, v89
    v_cvt_pk_bf16_f32 v98, v98, v99
    v_cvt_pk_bf16_f32 v92, v92, v93
    v_dot2_f32_bf16 v96, v50, v74, 0
    v_dot2_f32_bf16 v97, v50, v82, 0
    v_dot2_f32_bf16 v89, v98, s19, v89
    v_dot2_f32_bf16 v88, v40, v56, 0
    v_dot2_f32_bf16 v90, v48, v56, 0
    v_dot2_f32_bf16 v91, v92, s19, 0
    v_cvt_pk_bf16_f32 v94, v94, v95
    v_dot2_f32_bf16 v98, v51, v75, 0
    v_dot2_f32_bf16 v99, v51, v83, 0
    v_dot2_f32_bf16 v88, v41, v57, v88
    v_dot2_f32_bf16 v90, v49, v57, v90
    v_dot2_f32_bf16 v91, v94, s19, v91
    v_cvt_pk_bf16_f32 v96, v96, v97
    v_dot2_f32_bf16 v92, v52, v76, 0
    v_dot2_f32_bf16 v93, v52, v84, 0
    v_dot2_f32_bf16 v88, v42, v58, v88
    v_dot2_f32_bf16 v90, v50, v58, v90
    v_dot2_f32_bf16 v91, v96, s19, v91
    v_cvt_pk_bf16_f32 v98, v98, v99
    v_dot2_f32_bf16 v94, v53, v77, 0
    v_dot2_f32_bf16 v95, v53, v85, 0
    v_dot2_f32_bf16 v88, v43, v59, v88
    v_dot2_f32_bf16 v90, v51, v59, v90
    v_dot2_f32_bf16 v91, v98, s19, v91
    v_cvt_pk_bf16_f32 v92, v92, v93
    v_dot2_f32_bf16 v96, v54, v78, 0
    v_dot2_f32_bf16 v97, v54, v86, 0
    v_dot2_f32_bf16 v88, v44, v60, v88
    v_dot2_f32_bf16 v90, v52, v60, v90
    v_dot2_f32_bf16 v91, v92, s19, v91
    v_cvt_pk_bf16_f32 v94, v94, v95
    v_dot2_f32_bf16 v98, v55, v79, 0
    v_dot2_f32_bf16 v99, v55, v87, 0
    v_dot2_f32_bf16 v88, v45, v61, v88
    v_dot2_f32_bf16 v90, v53, v61, v90
    v_dot2_f32_bf16 v91, v94, s19, v91
    v_cvt_pk_bf16_f32 v96, v96, v97
    v_dot2_f32_bf16 v88, v46, v62, v88
    v_dot2_f32_bf16 v90, v54, v62, v90
    v_dot2_f32_bf16 v91, v96, s19, v91
    v_cvt_pk_bf16_f32 v98, v98, v99
    v_dot2_f32_bf16 v88, v47, v63, v88
    v_dot2_f32_bf16 v90, v55, v63, v90
    v_dot2_f32_bf16 v91, v98, s19, v91
    s_nop 1
    v_permlane32_swap_b32 v88, v90
    v_permlane32_swap_b32 v89, v91
    v_add_f32 v88, v88, v90
    v_add_f32 v89, v89, v91
    v_mov_b32 v91, s78
    s_nop 0
    v_permlane16_swap_b32 v88, v89
    v_add_f32 v88, v88, v89
    s_nop 1
    v_add_f32_dpp v88, v88, v88 row_ror:8 row_mask:0xf bank_mask:0xf
    s_nop 1
    v_add_f32_dpp v88, v88, v88 row_ror:4 row_mask:0xf bank_mask:0xf
    s_nop 1
    v_add_f32_dpp v88, v88, v88 row_ror:2 row_mask:0xf bank_mask:0xf
    s_nop 1
    v_add_f32_dpp v88, v88, v88 row_ror:1 row_mask:0xf bank_mask:0xf
    v_cvt_pk_bf16_f32 v88, v88, v88
    v_ashrrev_i32 v90, 31, v88
    v_and_b32 v89, 0xffff0000, v88
    v_or_b32 v90, 0x80000000, v90
    v_mul_f32 v89, 0xbfb8aa3b, v89
    v_xor_b32 v90, v90, v88
    v_exp_f32 v89, v89
    v_lshrrev_b32 v90, 16, v90
    v_add_f32 v89, 1.0, v89
    v_readlane_b32 s84, v90, 0
    v_readlane_b32 s85, v90, 32
    v_rcp_f32 v89, v89
    s_lshl_b32 s84, s84, 11
    s_lshl_b32 s85, s85, 11
    s_sub_u32 s3, 2047, s18
    v_cvt_pk_bf16_f32 v89, v89, v89
    s_or_b32 s84, s84, s3
    s_sub_u32 s3, s3, 1
    s_or_b32 s85, s85, s3
    v_readlane_b32 s20, v89, 16
    s_max_u32 s84, s84, s85
    v_readlane_b32 s21, v89, 48
    s_lshl_b32 s84, s84, 4
    s_or_b32 s84, s84, s23
    s_and_b32 s20, s20, 0xffff
    s_and_b32 s21, s21, 0xffff0000
    s_or_b32 s20, s20, s21
    s_lshl_b32 s3, s18, 2
    s_add_u32 s21, s3, 4472832
    s_add_u32 s3, s3, 4464640
    v_mov_b32 v88, s84
    v_mov_b32 v89, s78
    v_mov_b32 v90, s20
    s_mov_b64 exec, 1
    buffer_store_dwordx2 v[88:89], v13, s[32:35], s3 offen sc1
    buffer_store_dwordx2 v[90:91], v13, s[32:35], s21 offen sc1
    s_mov_b64 exec, -1
    s_waitcnt vmcnt(12)
    s_barrier
    s_add_u32 s72, s64, 2
    s_and_b32 s72, s72, 3
    s_add_u32 s73, s65, 4
    s_and_b32 s73, s73, 15
    s_add_u32 s72, s72, s73
    s_mul_i32 s73, s72, 393216
    s_lshl_b32 s72, s72, 7
    s_add_u32 s74, s72, s70
    s_add_u32 s75, s73, s66
    s_add_u32 s76, s73, s67
    s_add_u32 m0, s71, 81920
    s_add_u32 s77, s74, 0
    buffer_load_dwordx4 v10, s[24:27], s77 offen lds
    s_add_u32 m0, s71, 82944
    s_add_u32 s77, s74, 16384
    buffer_load_dwordx4 v11, s[24:27], s77 offen lds
    s_add_u32 m0, s71, 83968
    s_add_u32 s77, s74, 32768
    buffer_load_dwordx4 v10, s[24:27], s77 offen lds
    s_add_u32 m0, s71, 84992
    s_add_u32 s77, s74, 49152
    buffer_load_dwordx4 v11, s[24:27], s77 offen lds
    s_add_u32 m0, s68, 81920
    s_add_u32 s77, s75, 0
    buffer_load_dwordx4 v12, s[28:31], s77 offen lds
    s_add_u32 m0, s68, 90112
    s_add_u32 s77, s75, 2048
    buffer_load_dwordx4 v12, s[28:31], s77 offen lds
    s_add_u32 m0, s68, 98304
    s_add_u32 s77, s75, 4096
    buffer_load_dwordx4 v12, s[28:31], s77 offen lds
    s_add_u32 m0, s69, 81920
    s_add_u32 s77, s76, 0
    buffer_load_dwordx4 v12, s[28:31], s77 offen lds
    s_add_u32 m0, s69, 90112
    s_add_u32 s77, s76, 2048
    buffer_load_dwordx4 v12, s[28:31], s77 offen lds
    s_add_u32 m0, s69, 98304
    s_add_u32 s77, s76, 4096
    buffer_load_dwordx4 v12, s[28:31], s77 offen lds
    s_add_u32 s72, s64, 3
    s_and_b32 s72, s72, 3
    s_add_u32 s73, s65, 4
    s_and_b32 s73, s73, 15
    s_add_u32 s72, s72, s73
    s_mul_i32 s73, s72, 393216
    s_lshl_b32 s72, s72, 7
    s_add_u32 s74, s72, s70
    s_add_u32 s75, s73, s66
    s_add_u32 s76, s73, s67
    s_add_u32 m0, s71, 122880
    s_add_u32 s77, s74, 0
    buffer_load_dwordx4 v10, s[24:27], s77 offen lds
    s_add_u32 m0, s71, 123904
    s_add_u32 s77, s74, 16384
    buffer_load_dwordx4 v11, s[24:27], s77 offen lds
    s_waitcnt vmcnt(14)
    s_barrier
    s_add_u32 m0, s71, 124928
    s_add_u32 s77, s74, 32768
    buffer_load_dwordx4 v10, s[24:27], s77 offen lds
    s_add_u32 m0, s71, 125952
    s_add_u32 s77, s74, 49152
    buffer_load_dwordx4 v11, s[24:27], s77 offen lds
    s_add_u32 m0, s68, 122880
    s_add_u32 s77, s75, 0
    buffer_load_dwordx4 v12, s[28:31], s77 offen lds
    s_add_u32 m0, s68, 131072
    s_add_u32 s77, s75, 2048
    buffer_load_dwordx4 v12, s[28:31], s77 offen lds
    s_add_u32 m0, s68, 139264
    s_add_u32 s77, s75, 4096
    buffer_load_dwordx4 v12, s[28:31], s77 offen lds
    s_add_u32 m0, s69, 122880
    s_add_u32 s77, s76, 0
    buffer_load_dwordx4 v12, s[28:31], s77 offen lds
    s_add_u32 m0, s69, 131072
    s_add_u32 s77, s76, 2048
    buffer_load_dwordx4 v12, s[28:31], s77 offen lds
    s_add_u32 m0, s69, 139264
    s_add_u32 s77, s76, 4096
    buffer_load_dwordx4 v12, s[28:31], s77 offen lds
    s_add_u32 s72, s64, 0
    s_and_b32 s72, s72, 3
    s_add_u32 s73, s65, 8
    s_and_b32 s73, s73, 15
    s_add_u32 s72, s72, s73
    s_mul_i32 s73, s72, 393216
    s_lshl_b32 s72, s72, 7
    s_add_u32 s74, s72, s70
    s_add_u32 s75, s73, s66
    s_add_u32 s76, s73, s67
    s_add_u32 m0, s71, 0
    s_add_u32 s77, s74, 0
    buffer_load_dwordx4 v10, s[24:27], s77 offen lds
    s_add_u32 m0, s71, 1024
    s_add_u32 s77, s74, 16384
    buffer_load_dwordx4 v11, s[24:27], s77 offen lds
    s_add_u32 m0, s71, 2048
    s_add_u32 s77, s74, 32768
    buffer_load_dwordx4 v10, s[24:27], s77 offen lds
    s_add_u32 m0, s71, 3072
    s_add_u32 s77, s74, 49152
    buffer_load_dwordx4 v11, s[24:27], s77 offen lds
    s_waitcnt vmcnt(14)
    s_barrier
    s_add_u32 m0, s68, 0
    s_add_u32 s77, s75, 0
    buffer_load_dwordx4 v12, s[28:31], s77 offen lds
    s_add_u32 m0, s68, 8192
    s_add_u32 s77, s75, 2048
    buffer_load_dwordx4 v12, s[28:31], s77 offen lds
    s_add_u32 m0, s68, 16384
    s_add_u32 s77, s75, 4096
    buffer_load_dwordx4 v12, s[28:31], s77 offen lds
    s_add_u32 m0, s69, 0
    s_add_u32 s77, s76, 0
    buffer_load_dwordx4 v12, s[28:31], s77 offen lds
    s_add_u32 m0, s69, 8192
    s_add_u32 s77, s76, 2048
    buffer_load_dwordx4 v12, s[28:31], s77 offen lds
    s_add_u32 m0, s69, 16384
    s_add_u32 s77, s76, 4096
    buffer_load_dwordx4 v12, s[28:31], s77 offen lds
    s_add_u32 s72, s64, 1
    s_and_b32 s72, s72, 3
    s_add_u32 s73, s65, 8
    s_and_b32 s73, s73, 15
    s_add_u32 s72, s72, s73
    s_mul_i32 s73, s72, 393216
    s_lshl_b32 s72, s72, 7
    s_add_u32 s74, s72, s70
    s_add_u32 s75, s73, s66
    s_add_u32 s76, s73, s67
    s_add_u32 m0, s71, 40960
    s_add_u32 s77, s74, 0
    buffer_load_dwordx4 v10, s[24:27], s77 offen lds
    s_add_u32 m0, s71, 41984
    s_add_u32 s77, s74, 16384
    buffer_load_dwordx4 v11, s[24:27], s77 offen lds
    s_add_u32 m0, s71, 43008
    s_add_u32 s77, s74, 32768
    buffer_load_dwordx4 v10, s[24:27], s77 offen lds
    s_add_u32 m0, s71, 44032
    s_add_u32 s77, s74, 49152
    buffer_load_dwordx4 v11, s[24:27], s77 offen lds
    s_waitcnt vmcnt(14)
    s_barrier
    s_add_u32 m0, s68, 40960
    s_add_u32 s77, s75, 0
    buffer_load_dwordx4 v12, s[28:31], s77 offen lds
    s_add_u32 m0, s68, 49152
    s_add_u32 s77, s75, 2048
    buffer_load_dwordx4 v12, s[28:31], s77 offen lds
    s_add_u32 m0, s68, 57344
    s_add_u32 s77, s75, 4096
    buffer_load_dwordx4 v12, s[28:31], s77 offen lds
    s_add_u32 m0, s69, 40960
    s_add_u32 s77, s76, 0
    buffer_load_dwordx4 v12, s[28:31], s77 offen lds
    s_add_u32 m0, s69, 49152
    s_add_u32 s77, s76, 2048
    buffer_load_dwordx4 v12, s[28:31], s77 offen lds
    s_add_u32 m0, s69, 57344
    s_add_u32 s77, s76, 4096
    buffer_load_dwordx4 v12, s[28:31], s77 offen lds
    s_add_u32 s72, s64, 2
    s_and_b32 s72, s72, 3
    s_add_u32 s73, s65, 8
    s_and_b32 s73, s73, 15
    s_add_u32 s72, s72, s73
    s_mul_i32 s73, s72, 393216
    s_lshl_b32 s72, s72, 7
    s_add_u32 s74, s72, s70
    s_add_u32 s75, s73, s66
    s_add_u32 s76, s73, s67
    s_add_u32 m0, s71, 81920
    s_add_u32 s77, s74, 0
    buffer_load_dwordx4 v10, s[24:27], s77 offen lds
    s_add_u32 m0, s71, 82944
    s_add_u32 s77, s74, 16384
    buffer_load_dwordx4 v11, s[24:27], s77 offen lds
    s_add_u32 m0, s71, 83968
    s_add_u32 s77, s74, 32768
    buffer_load_dwordx4 v10, s[24:27], s77 offen lds
    s_add_u32 m0, s71, 84992
    s_add_u32 s77, s74, 49152
    buffer_load_dwordx4 v11, s[24:27], s77 offen lds
    s_waitcnt vmcnt(14)
    s_barrier
    s_add_u32 m0, s68, 81920
    s_add_u32 s77, s75, 0
    buffer_load_dwordx4 v12, s[28:31], s77 offen lds
    s_add_u32 m0, s68, 90112
    s_add_u32 s77, s75, 2048
    buffer_load_dwordx4 v12, s[28:31], s77 offen lds
    s_add_u32 m0, s68, 98304
    s_add_u32 s77, s75, 4096
    buffer_load_dwordx4 v12, s[28:31], s77 offen lds
    s_add_u32 m0, s69, 81920
    s_add_u32 s77, s76, 0
    buffer_load_dwordx4 v12, s[28:31], s77 offen lds
    s_add_u32 m0, s69, 90112
    s_add_u32 s77, s76, 2048
    buffer_load_dwordx4 v12, s[28:31], s77 offen lds
    s_add_u32 m0, s69, 98304
    s_add_u32 s77, s76, 4096
    buffer_load_dwordx4 v12, s[28:31], s77 offen lds
    s_add_u32 s72, s64, 3
    s_and_b32 s72, s72, 3
    s_add_u32 s73, s65, 8
    s_and_b32 s73, s73, 15
    s_add_u32 s72, s72, s73
    s_mul_i32 s73, s72, 393216
    s_lshl_b32 s72, s72, 7
    s_add_u32 s74, s72, s70
    s_add_u32 s75, s73, s66
    s_add_u32 s76, s73, s67
    s_add_u32 m0, s71, 122880
    s_add_u32 s77, s74, 0
    buffer_load_dwordx4 v10, s[24:27], s77 offen lds
    s_add_u32 m0, s71, 123904
    s_add_u32 s77, s74, 16384
    buffer_load_dwordx4 v11, s[24:27], s77 offen lds
    s_add_u32 m0, s71, 124928
    s_add_u32 s77, s74, 32768
    buffer_load_dwordx4 v10, s[24:27], s77 offen lds
    s_add_u32 m0, s71, 125952
    s_add_u32 s77, s74, 49152
    buffer_load_dwordx4 v11, s[24:27], s77 offen lds
    s_add_u32 m0, s68, 122880
    s_add_u32 s77, s75, 0
    buffer_load_dwordx4 v12, s[28:31], s77 offen lds
    s_add_u32 m0, s68, 131072
    s_add_u32 s77, s75, 2048
    buffer_load_dwordx4 v12, s[28:31], s77 offen lds
    s_waitcnt vmcnt(16)
    s_barrier
    s_add_u32 m0, s68, 139264
    s_add_u32 s77, s75, 4096
    buffer_load_dwordx4 v12, s[28:31], s77 offen lds
    s_add_u32 m0, s69, 122880
    s_add_u32 s77, s76, 0
    buffer_load_dwordx4 v12, s[28:31], s77 offen lds
    s_add_u32 m0, s69, 131072
    s_add_u32 s77, s76, 2048
    buffer_load_dwordx4 v12, s[28:31], s77 offen lds
    s_add_u32 m0, s69, 139264
    s_add_u32 s77, s76, 4096
    buffer_load_dwordx4 v12, s[28:31], s77 offen lds
    s_add_u32 s72, s64, 0
    s_and_b32 s72, s72, 3
    s_add_u32 s73, s65, 12
    s_and_b32 s73, s73, 15
    s_add_u32 s72, s72, s73
    s_mul_i32 s73, s72, 393216
    s_lshl_b32 s72, s72, 7
    s_add_u32 s74, s72, s70
    s_add_u32 s75, s73, s66
    s_add_u32 s76, s73, s67
    s_add_u32 m0, s71, 0
    s_add_u32 s77, s74, 0
    buffer_load_dwordx4 v10, s[24:27], s77 offen lds
    s_add_u32 m0, s71, 1024
    s_add_u32 s77, s74, 16384
    buffer_load_dwordx4 v11, s[24:27], s77 offen lds
    s_add_u32 m0, s71, 2048
    s_add_u32 s77, s74, 32768
    buffer_load_dwordx4 v10, s[24:27], s77 offen lds
    s_add_u32 m0, s71, 3072
    s_add_u32 s77, s74, 49152
    buffer_load_dwordx4 v11, s[24:27], s77 offen lds
    s_add_u32 m0, s68, 0
    s_add_u32 s77, s75, 0
    buffer_load_dwordx4 v12, s[28:31], s77 offen lds
    s_add_u32 m0, s68, 8192
    s_add_u32 s77, s75, 2048
    buffer_load_dwordx4 v12, s[28:31], s77 offen lds
    s_add_u32 m0, s68, 16384
    s_add_u32 s77, s75, 4096
    buffer_load_dwordx4 v12, s[28:31], s77 offen lds
    s_add_u32 m0, s69, 0
    s_add_u32 s77, s76, 0
    buffer_load_dwordx4 v12, s[28:31], s77 offen lds
    s_waitcnt vmcnt(18)
    s_barrier
    s_add_u32 m0, s69, 8192
    s_add_u32 s77, s76, 2048
    buffer_load_dwordx4 v12, s[28:31], s77 offen lds
    s_add_u32 m0, s69, 16384
    s_add_u32 s77, s76, 4096
    buffer_load_dwordx4 v12, s[28:31], s77 offen lds
    s_add_u32 s72, s64, 1
    s_and_b32 s72, s72, 3
    s_add_u32 s73, s65, 12
    s_and_b32 s73, s73, 15
    s_add_u32 s72, s72, s73
    s_mul_i32 s73, s72, 393216
    s_lshl_b32 s72, s72, 7
    s_add_u32 s74, s72, s70
    s_add_u32 s75, s73, s66
    s_add_u32 s76, s73, s67
    s_add_u32 m0, s71, 40960
    s_add_u32 s77, s74, 0
    buffer_load_dwordx4 v10, s[24:27], s77 offen lds
    s_add_u32 m0, s71, 41984
    s_add_u32 s77, s74, 16384
    buffer_load_dwordx4 v11, s[24:27], s77 offen lds
    s_add_u32 m0, s71, 43008
    s_add_u32 s77, s74, 32768
    buffer_load_dwordx4 v10, s[24:27], s77 offen lds
    s_add_u32 m0, s71, 44032
    s_add_u32 s77, s74, 49152
    buffer_load_dwordx4 v11, s[24:27], s77 offen lds
    s_add_u32 m0, s68, 40960
    s_add_u32 s77, s75, 0
    buffer_load_dwordx4 v12, s[28:31], s77 offen lds
    s_add_u32 m0, s68, 49152
    s_add_u32 s77, s75, 2048
    buffer_load_dwordx4 v12, s[28:31], s77 offen lds
    s_add_u32 m0, s68, 57344
    s_add_u32 s77, s75, 4096
    buffer_load_dwordx4 v12, s[28:31], s77 offen lds
    s_add_u32 m0, s69, 40960
    s_add_u32 s77, s76, 0
    buffer_load_dwordx4 v12, s[28:31], s77 offen lds
    s_getpc_b64 s[4:5]
L_ctp:
    s_lshl_b32 s7, s13, 2
    s_add_u32 s7, s7, s17
    s_lshl_b32 s7, s7, 8
    s_add_u32 s7, s7, L_lpost-L_ctp
    s_min_u32 s7, s7, L_end-L_ctp-252
    s_and_b32 s7, s7, -4
    s_add_u32 s4, s4, s7
    s_addc_u32 s5, s5, 0
    s_load_dword s7, s[4:5], 0
    s_load_dword s7, s[4:5], 64
    s_load_dword s7, s[4:5], 128
    s_load_dword s7, s[4:5], 192
    s_waitcnt vmcnt(18)
    s_barrier
    s_add_u32 m0, s69, 49152
    s_add_u32 s77, s76, 2048
    buffer_load_dwordx4 v12, s[28:31], s77 offen lds
    s_add_u32 m0, s69, 57344
    s_add_u32 s77, s76, 4096
    buffer_load_dwordx4 v12, s[28:31], s77 offen lds
    s_add_u32 s72, s64, 2
    s_and_b32 s72, s72, 3
    s_add_u32 s73, s65, 12
    s_and_b32 s73, s73, 15
    s_add_u32 s72, s72, s73
    s_mul_i32 s73, s72, 393216
    s_lshl_b32 s72, s72, 7
    s_add_u32 s74, s72, s70
    s_add_u32 s75, s73, s66
    s_add_u32 s76, s73, s67
    s_add_u32 m0, s71, 81920
    s_add_u32 s77, s74, 0
    buffer_load_dwordx4 v10, s[24:27], s77 offen lds
    s_add_u32 m0, s71, 82944
    s_add_u32 s77, s74, 16384
    buffer_load_dwordx4 v11, s[24:27], s77 offen lds
    s_add_u32 m0, s71, 83968
    s_add_u32 s77, s74, 32768
    buffer_load_dwordx4 v10, s[24:27], s77 offen lds
    s_add_u32 m0, s71, 84992
    s_add_u32 s77, s74, 49152
    buffer_load_dwordx4 v11, s[24:27], s77 offen lds
    s_add_u32 m0, s68, 81920
    s_add_u32 s77, s75, 0
    buffer_load_dwordx4 v12, s[28:31], s77 offen lds
    s_add_u32 m0, s68, 90112
    s_add_u32 s77, s75, 2048
    buffer_load_dwordx4 v12, s[28:31], s77 offen lds
    s_add_u32 m0, s68, 98304
    s_add_u32 s77, s75, 4096
    buffer_load_dwordx4 v12, s[28:31], s77 offen lds
    s_add_u32 m0, s69, 81920
    s_add_u32 s77, s76, 0
    buffer_load_dwordx4 v12, s[28:31], s77 offen lds
    s_lshl_b32 s19, s17, 11
    s_add_u32 s19, s19, 4464640
    buffer_load_dwordx4 v[28:31], v3, s[32:35], s19 offen offset:0 sc1
    buffer_load_dwordx4 v[32:35], v3, s[32:35], s19 offen offset:1024 sc1
    s_waitcnt vmcnt(20)
    s_barrier
    s_add_u32 m0, s69, 90112
    s_add_u32 s77, s76, 2048
    buffer_load_dwordx4 v12, s[28:31], s77 offen lds
    s_add_u32 m0, s69, 98304
    s_add_u32 s77, s76, 4096
    buffer_load_dwordx4 v12, s[28:31], s77 offen lds
    s_add_u32 s72, s64, 3
    s_and_b32 s72, s72, 3
    s_add_u32 s73, s65, 12
    s_and_b32 s73, s73, 15
    s_add_u32 s72, s72, s73
    s_mul_i32 s73, s72, 393216
    s_lshl_b32 s72, s72, 7
    s_add_u32 s74, s72, s70
    s_add_u32 s75, s73, s66
    s_add_u32 s76, s73, s67
    s_add_u32 m0, s71, 122880
    s_add_u32 s77, s74, 0
    buffer_load_dwordx4 v10, s[24:27], s77 offen lds
    s_add_u32 m0, s71, 123904
    s_add_u32 s77, s74, 16384
    buffer_load_dwordx4 v11, s[24:27], s77 offen lds
    s_add_u32 m0, s71, 124928
    s_add_u32 s77, s74, 32768
    buffer_load_dwordx4 v10, s[24:27], s77 offen lds
    s_add_u32 m0, s71, 125952
    s_add_u32 s77, s74, 49152
    buffer_load_dwordx4 v11, s[24:27], s77 offen lds
    s_add_u32 m0, s68, 122880
    s_add_u32 s77, s75, 0
    buffer_load_dwordx4 v12, s[28:31], s77 offen lds
    s_add_u32 m0, s68, 131072
    s_add_u32 s77, s75, 2048
    buffer_load_dwordx4 v12, s[28:31], s77 offen lds
    s_add_u32 m0, s68, 139264
    s_add_u32 s77, s75, 4096
    buffer_load_dwordx4 v12, s[28:31], s77 offen lds
    s_add_u32 m0, s69, 122880
    s_add_u32 s77, s76, 0
    buffer_load_dwordx4 v12, s[28:31], s77 offen lds
    s_add_u32 m0, s69, 131072
    s_add_u32 s77, s76, 2048
    buffer_load_dwordx4 v12, s[28:31], s77 offen lds
    s_add_u32 m0, s69, 139264
    s_add_u32 s77, s76, 4096
    buffer_load_dwordx4 v12, s[28:31], s77 offen lds
    s_waitcnt vmcnt(22)
    s_barrier
    buffer_load_dwordx4 v[96:99], v15, s[48:51], s1 offen nt
    buffer_load_dwordx4 v[128:131], v15, s[52:55], s1 offen nt
    s_add_u32 s1, s1, 28672
    buffer_load_dwordx4 v[100:103], v15, s[48:51], s1 offen nt
    buffer_load_dwordx4 v[132:135], v15, s[52:55], s1 offen nt
    s_add_u32 s1, s1, 28672
    buffer_load_dwordx4 v[104:107], v15, s[48:51], s1 offen nt
    buffer_load_dwordx4 v[136:139], v15, s[52:55], s1 offen nt
    s_add_u32 s1, s1, 28672
    s_mul_i32 s73, s13, 112
    s_mul_i32 s19, s17, 28
    s_add_u32 s73, s73, s19
    s_lshl_b32 s74, s73, 11
    s_lshl_b32 s19, s12, 8
    s_add_u32 s74, s74, s19
    s_lshr_b32 s67, s12, 2
    s_lshl_b32 s67, s67, 3
    s_lshr_b32 s19, s13, 2
    s_add_u32 s67, s67, s19
    s_lshl_b32 s68, s19, 2
    s_lshl_b32 s69, s67, 7
    s_lshl_b32 s19, s17, 14
    s_add_u32 s69, s69, s19
    s_and_b32 s19, s13, 3
    s_lshl_b32 s19, s19, 3
    s_add_u32 s68, s68, s19
    s_and_b32 s68, s68, 31
    s_waitcnt vmcnt(6)
    s_barrier
L_lpost:
    s_cmp_lg_u32 s17, 0
    s_cbranch_scc1 L_z3
    v_mov_b32 v76, 0
    v_mov_b32 v77, 0
    v_mov_b32 v78, 0
    v_mov_b32 v79, 0
    s_mov_b64 exec, 31
    ds_write_b128 v3, v[76:79] offset:0
    ds_write_b32 v13, v37 offset:128
    s_mov_b64 exec, -1
L_z3:
    s_waitcnt vmcnt(18)
L_kp4:
    v_xor_b32 v29, s78, v29
    v_mov_b32 v80, v28
    v_xor_b32 v31, s78, v31
    v_mov_b32 v81, v30
    v_xor_b32 v33, s78, v33
    v_mov_b32 v82, v32
    v_xor_b32 v35, s78, v35
    v_mov_b32 v83, v34
    v_or3_b32 v29, v29, v31, v33
    v_max3_u32 v28, v28, v30, v32
    v_or_b32 v29, v29, v35
    v_max_u32 v28, v28, v34
    v_cmp_ne_u32 vcc, 0, v29
    s_cbranch_vccz L_kk5
    s_lshl_b32 s19, s17, 11
    s_add_u32 s19, s19, 4464640
    buffer_load_dwordx4 v[28:31], v3, s[32:35], s19 offen offset:0 sc1
    buffer_load_dwordx4 v[32:35], v3, s[32:35], s19 offen offset:1024 sc1
    s_waitcnt vmcnt(0)
    s_add_u32 s79, s79, 1
    s_cmp_lt_u32 s79, 32768
    s_cbranch_scc1 L_kp4
L_kk5:
    v_xor_b32 v72, s23, v80
    v_xor_b32 v73, s23, v81
    v_xor_b32 v74, s23, v82
    v_xor_b32 v75, s23, v83
    v_or3_b32 v72, v72, v73, v74
    v_or_b32 v72, v72, v75
    v_and_b32 v72, 15, v72
    v_cmp_ne_u32 vcc, 0, v72
    s_lshl_b32 s19, s15, 1
    s_lshl_b32 s19, 3, s19
    s_or_b32 s3, vcc_lo, vcc_hi
    s_and_b32 s3, s3, s19
    s_cselect_b32 s3, 1, 0
    v_xor_b32 v72, s3, v37
    s_lshl_b64 exec, 1, s17
    ds_write_b32 v36, v72 offset:240
    s_mov_b64 exec, -1
    buffer_load_dwordx4 v[108:111], v15, s[48:51], s1 offen nt
    buffer_load_dwordx4 v[140:143], v15, s[52:55], s1 offen nt
    s_add_u32 s1, s1, 28672
    buffer_load_dwordx4 v[112:115], v15, s[48:51], s1 offen nt
    buffer_load_dwordx4 v[144:147], v15, s[52:55], s1 offen nt
    s_add_u32 s1, s1, 28672
    buffer_load_dwordx4 v[116:119], v15, s[48:51], s1 offen nt
    buffer_load_dwordx4 v[148:151], v15, s[52:55], s1 offen nt
    s_add_u32 s1, s1, 28672
    buffer_load_dwordx4 v[120:123], v15, s[48:51], s1 offen nt
    buffer_load_dwordx4 v[152:155], v15, s[52:55], s1 offen nt
    s_add_u32 s1, s1, 28672
    buffer_load_dwordx4 v[124:127], v15, s[48:51], s1 offen nt
    buffer_load_dwordx4 v[156:159], v15, s[52:55], s1 offen nt
    s_add_u32 s1, s1, 28672
L_fw6:
    ds_read_b32 v29, v13 offset:128
    s_waitcnt lgkmcnt(0)
    v_cmp_ne_u32 vcc, v29, v37
    s_cbranch_vccz L_fk7
    s_add_u32 s79, s79, 1
    s_cmp_lt_u32 s79, 32768
    s_cbranch_scc1 L_fw6
L_fk7:
    ds_max_u32 v13, v28 offset:16
    v_mov_b32 v26, 1
    s_mov_b64 exec, 1
    ds_add_u32 v13, v26 offset:0
    s_mov_b64 exec, -1
L_kc8:
    ds_read_b32 v26, v13 offset:0
    ds_read_b32 v27, v13 offset:16
    s_waitcnt lgkmcnt(0)
    v_readfirstlane_b32 s19, v26
    v_readfirstlane_b32 s71, v27
    s_nop 0
    s_cmp_ge_u32 s19, 4
    s_cbranch_scc1 L_kd9
    s_add_u32 s79, s79, 1
    s_cmp_lt_u32 s79, 32768
    s_cbranch_scc1 L_kc8
L_kd9:
    s_lshr_b32 s71, s71, 4
    s_and_b32 s72, s71, 2047
    s_sub_u32 s72, 2047, s72
    s_lshl_b32 s19, s72, 11
    s_lshl_b32 s3, s0, 1
    s_add_u32 s19, s19, s3
    v_lshlrev_b32 v26, 3, v20
    v_lshl_add_u32 v26, v9, 1, v26
    buffer_load_ushort v27, v26, s[24:27], s19 offen
    s_lshl_b32 s19, s68, 16
    s_add_u32 s19, s19, s69
    buffer_load_dwordx4 v[192:195], v17, s[60:63], s19 offen
    s_add_u32 s68, s68, 1
    s_and_b32 s68, s68, 31
    s_lshl_b32 s19, s68, 16
    s_add_u32 s19, s19, s69
    buffer_load_dwordx4 v[196:199], v17, s[60:63], s19 offen
    s_add_u32 s68, s68, 1
    s_and_b32 s68, s68, 31
    s_lshl_b32 s19, s68, 16
    s_add_u32 s19, s19, s69
    buffer_load_dwordx4 v[200:203], v17, s[60:63], s19 offen
    s_add_u32 s68, s68, 1
    s_and_b32 s68, s68, 31
    s_lshl_b32 s19, s68, 16
    s_add_u32 s19, s19, s69
    buffer_load_dwordx4 v[204:207], v17, s[60:63], s19 offen
    s_add_u32 s68, s68, 1
    s_and_b32 s68, s68, 31
    s_lshl_b32 s19, s68, 16
    s_add_u32 s19, s19, s69
    buffer_load_dwordx4 v[208:211], v17, s[60:63], s19 offen
    s_add_u32 s68, s68, 1
    s_and_b32 s68, s68, 31
    s_lshl_b32 s19, s68, 16
    s_add_u32 s19, s19, s69
    buffer_load_dwordx4 v[212:215], v17, s[60:63], s19 offen
    s_add_u32 s68, s68, 1
    s_and_b32 s68, s68, 31
    s_lshl_b32 s19, s68, 16
    s_add_u32 s19, s19, s69
    buffer_load_dwordx4 v[216:219], v17, s[60:63], s19 offen
    s_add_u32 s68, s68, 1
    s_and_b32 s68, s68, 31
    s_lshl_b32 s19, s68, 16
    s_add_u32 s19, s19, s69
    buffer_load_dwordx4 v[220:223], v17, s[60:63], s19 offen
    s_add_u32 s68, s68, 1
    s_and_b32 s68, s68, 31
    s_lshl_b32 s19, s68, 16
    s_add_u32 s19, s19, s69
    buffer_load_dwordx4 v[224:227], v17, s[60:63], s19 offen
    s_add_u32 s68, s68, 1
    s_and_b32 s68, s68, 31
    s_lshl_b32 s19, s68, 16
    s_add_u32 s19, s19, s69
    buffer_load_dwordx4 v[228:231], v17, s[60:63], s19 offen
    s_add_u32 s68, s68, 1
    s_and_b32 s68, s68, 31
    s_lshl_b32 s19, s68, 16
    s_add_u32 s19, s19, s69
    buffer_load_dwordx4 v[232:235], v17, s[60:63], s19 offen
    s_add_u32 s68, s68, 1
    s_and_b32 s68, s68, 31
    s_lshl_b32 s19, s68, 16
    s_add_u32 s19, s19, s69
    buffer_load_dwordx4 v[236:239], v17, s[60:63], s19 offen
    s_add_u32 s68, s68, 1
    s_and_b32 s68, s68, 31
    s_lshl_b32 s19, s68, 16
    s_add_u32 s19, s19, s69
    buffer_load_dwordx4 v[240:243], v17, s[60:63], s19 offen
    s_add_u32 s68, s68, 1
    s_and_b32 s68, s68, 31
    s_lshl_b32 s19, s68, 16
    s_add_u32 s19, s19, s69
    buffer_load_dwordx4 v[244:247], v17, s[60:63], s19 offen
    s_add_u32 s68, s68, 1
    s_and_b32 s68, s68, 31
    s_lshl_b32 s19, s68, 16
    s_add_u32 s19, s19, s69
    buffer_load_dwordx4 v[248:251], v17, s[60:63], s19 offen
    s_add_u32 s68, s68, 1
    s_and_b32 s68, s68, 31
    s_lshl_b32 s19, s68, 16
    s_add_u32 s19, s19, s69
    buffer_load_dwordx4 v[252:255], v17, s[60:63], s19 offen
    s_add_u32 s68, s68, 1
    s_and_b32 s68, s68, 31
    s_lshl_b32 s19, s68, 16
    s_add_u32 s19, s19, s69
    buffer_load_dwordx4 v[40:43], v17, s[60:63], s19 offen
    s_add_u32 s68, s68, 1
    s_and_b32 s68, s68, 31
    s_lshl_b32 s19, s68, 16
    s_add_u32 s19, s19, s69
    buffer_load_dwordx4 v[44:47], v17, s[60:63], s19 offen
    s_add_u32 s68, s68, 1
    s_and_b32 s68, s68, 31
    s_lshl_b32 s19, s68, 16
    s_add_u32 s19, s19, s69
    buffer_load_dwordx4 v[48:51], v17, s[60:63], s19 offen
    s_add_u32 s68, s68, 1
    s_and_b32 s68, s68, 31
    s_lshl_b32 s19, s68, 16
    s_add_u32 s19, s19, s69
    buffer_load_dwordx4 v[52:55], v17, s[60:63], s19 offen
    s_add_u32 s68, s68, 1
    s_and_b32 s68, s68, 31
    s_lshl_b32 s19, s68, 16
    s_add_u32 s19, s19, s69
    buffer_load_dwordx4 v[56:59], v17, s[60:63], s19 offen
    s_add_u32 s68, s68, 1
    s_and_b32 s68, s68, 31
    s_lshl_b32 s19, s68, 16
    s_add_u32 s19, s19, s69
    buffer_load_dwordx4 v[60:63], v17, s[60:63], s19 offen
    s_add_u32 s68, s68, 1
    s_and_b32 s68, s68, 31
    s_lshl_b32 s19, s68, 16
    s_add_u32 s19, s19, s69
    buffer_load_dwordx4 v[64:67], v17, s[60:63], s19 offen
    s_add_u32 s68, s68, 1
    s_and_b32 s68, s68, 31
    s_lshl_b32 s19, s68, 16
    s_add_u32 s19, s19, s69
    buffer_load_dwordx4 v[68:71], v17, s[60:63], s19 offen
    s_add_u32 s68, s68, 1
    s_and_b32 s68, s68, 31
    s_lshl_b32 s19, s68, 16
    s_add_u32 s19, s19, s69
    buffer_load_dwordx4 v[160:163], v17, s[60:63], s19 offen
    s_add_u32 s68, s68, 1
    s_and_b32 s68, s68, 31
    s_lshl_b32 s19, s68, 16
    s_add_u32 s19, s19, s69
    buffer_load_dwordx4 v[164:167], v17, s[60:63], s19 offen
    s_add_u32 s68, s68, 1
    s_and_b32 s68, s68, 31
    s_lshl_b32 s19, s68, 16
    s_add_u32 s19, s19, s69
    buffer_load_dwordx4 v[168:171], v17, s[60:63], s19 offen
    s_add_u32 s68, s68, 1
    s_and_b32 s68, s68, 31
    s_lshl_b32 s19, s68, 16
    s_add_u32 s19, s19, s69
    buffer_load_dwordx4 v[172:175], v17, s[60:63], s19 offen
    s_add_u32 s68, s68, 1
    s_and_b32 s68, s68, 31
    s_lshl_b32 s19, s68, 16
    s_add_u32 s19, s19, s69
    buffer_load_dwordx4 v[176:179], v17, s[60:63], s19 offen
    s_add_u32 s68, s68, 1
    s_and_b32 s68, s68, 31
    s_lshl_b32 s19, s68, 16
    s_add_u32 s19, s19, s69
    buffer_load_dwordx4 v[180:183], v17, s[60:63], s19 offen
    s_add_u32 s68, s68, 1
    s_and_b32 s68, s68, 31
    s_lshl_b32 s19, s68, 16
    s_add_u32 s19, s19, s69
    buffer_load_dwordx4 v[184:187], v17, s[60:63], s19 offen
    s_add_u32 s68, s68, 1
    s_and_b32 s68, s68, 31
    s_lshl_b32 s19, s68, 16
    s_add_u32 s19, s19, s69
    buffer_load_dwordx4 v[188:191], v17, s[60:63], s19 offen
    s_add_u32 s68, s68, 1
    s_and_b32 s68, s68, 31
    s_waitcnt vmcnt(32)
    s_waitcnt vmcnt(33)
    v_lshl_or_b32 v27, v27, 16, v27
    s_lshl_b32 s19, s17, 10
    s_add_u32 s19, s19, 26624
    v_and_b32_dpp v72, v27, v4 row_newbcast:0 row_mask:0xf bank_mask:0xf
    v_and_b32_dpp v73, v27, v5 row_newbcast:0 row_mask:0xf bank_mask:0xf
    v_and_b32_dpp v74, v27, v6 row_newbcast:0 row_mask:0xf bank_mask:0xf
    v_and_b32_dpp v75, v27, v7 row_newbcast:0 row_mask:0xf bank_mask:0xf
    v_and_b32_dpp v76, v27, v4 row_newbcast:1 row_mask:0xf bank_mask:0xf
    v_and_b32_dpp v77, v27, v5 row_newbcast:1 row_mask:0xf bank_mask:0xf
    v_mfma_f32_16x16x32_bf16 v[88:91], v[72:75], v[96:99], 0
    v_and_b32_dpp v78, v27, v6 row_newbcast:1 row_mask:0xf bank_mask:0xf
    v_and_b32_dpp v79, v27, v7 row_newbcast:1 row_mask:0xf bank_mask:0xf
    v_mfma_f32_16x16x32_bf16 v[92:95], v[72:75], v[128:131], 0
    v_and_b32_dpp v80, v27, v4 row_newbcast:2 row_mask:0xf bank_mask:0xf
    v_and_b32_dpp v81, v27, v5 row_newbcast:2 row_mask:0xf bank_mask:0xf
    v_mfma_f32_16x16x32_bf16 v[88:91], v[76:79], v[100:103], v[88:91]
    v_and_b32_dpp v82, v27, v6 row_newbcast:2 row_mask:0xf bank_mask:0xf
    v_and_b32_dpp v83, v27, v7 row_newbcast:2 row_mask:0xf bank_mask:0xf
    v_mfma_f32_16x16x32_bf16 v[92:95], v[76:79], v[132:135], v[92:95]
    v_and_b32_dpp v84, v27, v4 row_newbcast:3 row_mask:0xf bank_mask:0xf
    v_and_b32_dpp v85, v27, v5 row_newbcast:3 row_mask:0xf bank_mask:0xf
    v_mfma_f32_16x16x32_bf16 v[88:91], v[80:83], v[104:107], v[88:91]
    v_and_b32_dpp v86, v27, v6 row_newbcast:3 row_mask:0xf bank_mask:0xf
    v_and_b32_dpp v87, v27, v7 row_newbcast:3 row_mask:0xf bank_mask:0xf
    v_mfma_f32_16x16x32_bf16 v[92:95], v[80:83], v[136:139], v[92:95]
    v_and_b32_dpp v72, v27, v4 row_newbcast:4 row_mask:0xf bank_mask:0xf
    v_and_b32_dpp v73, v27, v5 row_newbcast:4 row_mask:0xf bank_mask:0xf
    v_mfma_f32_16x16x32_bf16 v[88:91], v[84:87], v[108:111], v[88:91]
    v_and_b32_dpp v74, v27, v6 row_newbcast:4 row_mask:0xf bank_mask:0xf
    v_and_b32_dpp v75, v27, v7 row_newbcast:4 row_mask:0xf bank_mask:0xf
    v_mfma_f32_16x16x32_bf16 v[92:95], v[84:87], v[140:143], v[92:95]
    v_and_b32_dpp v76, v27, v4 row_newbcast:5 row_mask:0xf bank_mask:0xf
    v_and_b32_dpp v77, v27, v5 row_newbcast:5 row_mask:0xf bank_mask:0xf
    v_mfma_f32_16x16x32_bf16 v[88:91], v[72:75], v[112:115], v[88:91]
    v_and_b32_dpp v78, v27, v6 row_newbcast:5 row_mask:0xf bank_mask:0xf
    v_and_b32_dpp v79, v27, v7 row_newbcast:5 row_mask:0xf bank_mask:0xf
    v_mfma_f32_16x16x32_bf16 v[92:95], v[72:75], v[144:147], v[92:95]
    v_and_b32_dpp v80, v27, v4 row_newbcast:6 row_mask:0xf bank_mask:0xf
    v_and_b32_dpp v81, v27, v5 row_newbcast:6 row_mask:0xf bank_mask:0xf
    v_mfma_f32_16x16x32_bf16 v[88:91], v[76:79], v[116:119], v[88:91]
    v_and_b32_dpp v82, v27, v6 row_newbcast:6 row_mask:0xf bank_mask:0xf
    v_and_b32_dpp v83, v27, v7 row_newbcast:6 row_mask:0xf bank_mask:0xf
    v_mfma_f32_16x16x32_bf16 v[92:95], v[76:79], v[148:151], v[92:95]
    v_and_b32_dpp v84, v27, v4 row_newbcast:7 row_mask:0xf bank_mask:0xf
    v_and_b32_dpp v85, v27, v5 row_newbcast:7 row_mask:0xf bank_mask:0xf
    v_mfma_f32_16x16x32_bf16 v[88:91], v[80:83], v[120:123], v[88:91]
    v_and_b32_dpp v86, v27, v6 row_newbcast:7 row_mask:0xf bank_mask:0xf
    v_and_b32_dpp v87, v27, v7 row_newbcast:7 row_mask:0xf bank_mask:0xf
    v_mfma_f32_16x16x32_bf16 v[92:95], v[80:83], v[152:155], v[92:95]
    v_add_u32 v26, s19, v3
    v_mov_b32 v28, 1
    v_mfma_f32_16x16x32_bf16 v[88:91], v[84:87], v[124:127], v[88:91]
    v_mfma_f32_16x16x32_bf16 v[92:95], v[84:87], v[156:159], v[92:95]
    s_nop 7
    v_permlane32_swap_b32 v88, v92
    v_permlane32_swap_b32 v89, v93
    v_permlane32_swap_b32 v90, v94
    v_permlane32_swap_b32 v91, v95
    ds_write_b128 v26, v[88:91]
    s_mov_b64 exec, 1
    ds_add_rtn_u32 v29, v13, v28 offset:32
    s_mov_b64 exec, -1
    s_waitcnt lgkmcnt(0)
    v_readfirstlane_b32 s19, v29
    s_nop 1
    s_cmp_lg_u32 s19, 3
    s_cbranch_scc1 L_gs10
    ds_read_b128 v[72:75], v3 offset:26624
    ds_read_b128 v[76:79], v3 offset:27648
    ds_read_b128 v[80:83], v3 offset:28672
    ds_read_b128 v[84:87], v3 offset:29696
    s_waitcnt lgkmcnt(0)
    v_pk_add_f32 v[72:73], v[72:73], v[76:77]
    v_pk_add_f32 v[74:75], v[74:75], v[78:79]
    v_pk_add_f32 v[80:81], v[80:81], v[84:85]
    v_pk_add_f32 v[82:83], v[82:83], v[86:87]
    v_pk_add_f32 v[72:73], v[72:73], v[80:81]
    v_pk_add_f32 v[74:75], v[74:75], v[82:83]
    v_bfi_b32 v72, v23, s80, v72
    v_bfi_b32 v73, v23, s81, v73
    v_bfi_b32 v74, v23, s82, v74
    v_bfi_b32 v75, v23, s83, v75
    s_cmp_ge_u32 s2, 224
    s_cbranch_scc1 L_gs10
    v_lshrrev_b32 v26, 5, v2
    v_mul_u32_u24 v26, 14336, v26
    v_lshl_add_u32 v26, v8, 5, v26
    v_and_b32 v29, 1, v9
    v_lshl_add_u32 v26, v29, 4, v26
    s_mul_i32 s19, s12, 28672
    s_lshl_b32 s3, s13, 9
    s_add_u32 s19, s19, s3
    s_add_u32 s19, s19, 4489216
    buffer_store_dwordx4 v[72:75], v26, s[32:35], s19 offen sc1
L_gs10:
    s_waitcnt vmcnt(24)
L_fw11:
    ds_read_b32 v29, v36 offset:144
    s_waitcnt lgkmcnt(0)
    v_cmp_ne_u32 vcc, v29, v37
    s_cbranch_vccz L_fk12
    s_add_u32 s79, s79, 1
    s_cmp_lt_u32 s79, 32768
    s_cbranch_scc1 L_fw11
L_fk12:
    ds_write_b128 v18, v[192:195] offset:0
    ds_write_b128 v18, v[196:199] offset:4096
    ds_write_b128 v18, v[200:203] offset:8192
    ds_write_b128 v18, v[204:207] offset:12288
    ds_write_b128 v18, v[208:211] offset:16384
    ds_write_b128 v18, v[212:215] offset:20480
    ds_write_b128 v18, v[216:219] offset:24576
    ds_write_b128 v18, v[220:223] offset:28672
    s_waitcnt vmcnt(16)
    ds_write_b128 v18, v[224:227] offset:32768
    ds_write_b128 v18, v[228:231] offset:36864
    ds_write_b128 v18, v[232:235] offset:40960
    ds_write_b128 v18, v[236:239] offset:45056
    ds_write_b128 v18, v[240:243] offset:49152
    ds_write_b128 v18, v[244:247] offset:53248
    ds_write_b128 v18, v[248:251] offset:57344
    ds_write_b128 v18, v[252:255] offset:61440
    v_min_u32 v26, 6, v20
    v_mul_u32_u24 v27, 28672, v19
    v_lshl_add_u32 v26, v26, 4, v27
    s_lshl_b32 s75, s73, 2
    s_add_u32 s75, s75, 4489216
    s_add_u32 s76, s75, 14336
    s_waitcnt vmcnt(8)
L_fw13:
    ds_read_b32 v29, v36 offset:160
    s_waitcnt lgkmcnt(0)
    v_cmp_ne_u32 vcc, v29, v37
    s_cbranch_vccz L_fk14
    s_add_u32 s79, s79, 1
    s_cmp_lt_u32 s79, 32768
    s_cbranch_scc1 L_fw13
L_fk14:
    ds_write_b128 v22, v[40:43] offset:0
    ds_write_b128 v22, v[44:47] offset:4096
    ds_write_b128 v22, v[48:51] offset:8192
    ds_write_b128 v22, v[52:55] offset:12288
    ds_write_b128 v22, v[56:59] offset:16384
    ds_write_b128 v22, v[60:63] offset:20480
    ds_write_b128 v22, v[64:67] offset:24576
    ds_write_b128 v22, v[68:71] offset:28672
    s_waitcnt vmcnt(0)
    ds_write_b128 v22, v[160:163] offset:32768
    ds_write_b128 v22, v[164:167] offset:36864
    ds_write_b128 v22, v[168:171] offset:40960
    ds_write_b128 v22, v[172:175] offset:45056
    ds_write_b128 v22, v[176:179] offset:49152
    ds_write_b128 v22, v[180:183] offset:53248
    ds_write_b128 v22, v[184:187] offset:57344
    ds_write_b128 v22, v[188:191] offset:61440
    s_lshl_b64 exec, 1, s17
    ds_write_b32 v36, v37 offset:208
    s_mov_b64 exec, -1
L_fw15:
    ds_read_b32 v29, v36 offset:192
    s_waitcnt lgkmcnt(0)
    v_cmp_ne_u32 vcc, v29, v37
    s_cbranch_vccz L_fk16
    s_add_u32 s79, s79, 1
    s_cmp_lt_u32 s79, 32768
    s_cbranch_scc1 L_fw15
L_fk16:
    buffer_load_dwordx4 v[96:99], v16, s[56:59], s74 offen nt
    s_add_u32 s74, s74, 8192
    buffer_load_dwordx4 v[100:103], v16, s[56:59], s74 offen nt
    s_add_u32 s74, s74, 8192
    buffer_load_dwordx4 v[104:107], v16, s[56:59], s74 offen nt
    s_add_u32 s74, s74, 8192
    buffer_load_dwordx4 v[108:111], v16, s[56:59], s74 offen nt
    s_add_u32 s74, s74, 8192
    buffer_load_dwordx4 v[112:115], v16, s[56:59], s74 offen nt
    s_add_u32 s74, s74, 8192
    buffer_load_dwordx4 v[116:119], v16, s[56:59], s74 offen nt
    s_add_u32 s74, s74, 8192
    buffer_load_dwordx4 v[120:123], v16, s[56:59], s74 offen nt
    s_add_u32 s74, s74, 8192
L_cw17:
    ds_read_b32 v29, v13 offset:64
    s_waitcnt lgkmcnt(0)
    v_cmp_gt_u32 vcc, 1, v29
    s_cbranch_vccz L_ck18
    s_add_u32 s79, s79, 1
    s_cmp_lt_u32 s79, 32768
    s_cbranch_scc1 L_cw17
L_ck18:
    buffer_load_dwordx4 v[72:75], v26, s[32:35], s75 offen sc1
    buffer_load_dwordx4 v[76:79], v26, s[32:35], s76 offen sc1
    s_waitcnt vmcnt(0)
L_gp19:
    v_xor_b32 v72, s80, v72
    v_xor_b32 v73, s81, v73
    v_xor_b32 v74, s82, v74
    v_xor_b32 v75, s83, v75
    v_xor_b32 v76, s80, v76
    v_xor_b32 v77, s81, v77
    v_xor_b32 v78, s82, v78
    v_xor_b32 v79, s83, v79
    v_or3_b32 v80, v72, v73, v74
    v_or3_b32 v81, v75, v76, v77
    v_or3_b32 v80, v80, v78, v79
    v_or_b32 v80, v80, v81
    v_and_b32 v80, v80, v23
    v_cmp_ne_u32 vcc, 0, v80
    s_cbranch_vccz L_gk20
    buffer_load_dwordx4 v[72:75], v26, s[32:35], s75 offen sc1
    buffer_load_dwordx4 v[76:79], v26, s[32:35], s76 offen sc1
    s_waitcnt vmcnt(0)
    s_add_u32 s79, s79, 1
    s_cmp_lt_u32 s79, 32768
    s_cbranch_scc1 L_gp19
L_gk20:
    s_waitcnt vmcnt(2)
    v_permlane32_swap_b32 v72, v74
    v_permlane32_swap_b32 v73, v75
    v_permlane32_swap_b32 v76, v78
    v_permlane32_swap_b32 v77, v79
    v_add_f32 v72, v72, v74
    v_add_f32 v73, v73, v75
    v_add_f32 v76, v76, v78
    v_add_f32 v77, v77, v79
    v_permlane16_swap_b32 v72, v73
    s_lshl_b32 s19, s17, 9
    v_permlane16_swap_b32 v76, v77
    v_add_f32 v72, v72, v73
    v_add_f32 v76, v76, v77
    s_add_u32 s19, s19, 30720
    v_add_f32_dpp v72, v72, v72 row_ror:8 row_mask:0xf bank_mask:0xf
    v_add_f32_dpp v76, v76, v76 row_ror:8 row_mask:0xf bank_mask:0xf
    v_add_u32 v26, s19, v3
    v_cvt_pk_bf16_f32 v72, v72, v76
    v_and_b32 v76, 0xffff0000, v72
    v_lshlrev_b32 v72, 16, v72
    v_mul_f32 v73, 0xbfb8aa3b, v72
    v_exp_f32 v73, v73
    s_nop 0
    v_add_f32 v73, 1.0, v73
    v_rcp_f32 v73, v73
    s_nop 0
    v_mul_f32 v73, v73, v72
    v_cvt_pk_bf16_f32 v73, v73, v73
    v_lshlrev_b32 v73, 16, v73
    v_mul_f32 v73, v73, v76
    v_cvt_pk_bf16_f32 v27, v73, v73
    s_nop 1
    v_and_b32_dpp v76, v27, v4 row_newbcast:0 row_mask:0xf bank_mask:0xf
    v_and_b32_dpp v77, v27, v5 row_newbcast:0 row_mask:0xf bank_mask:0xf
    v_and_b32_dpp v78, v27, v6 row_newbcast:0 row_mask:0xf bank_mask:0xf
    v_and_b32_dpp v79, v27, v7 row_newbcast:0 row_mask:0xf bank_mask:0xf
    v_and_b32_dpp v80, v27, v4 row_newbcast:1 row_mask:0xf bank_mask:0xf
    v_and_b32_dpp v81, v27, v5 row_newbcast:1 row_mask:0xf bank_mask:0xf
    v_mfma_f32_16x16x32_bf16 v[88:91], v[76:79], v[96:99], 0
    v_and_b32_dpp v82, v27, v6 row_newbcast:1 row_mask:0xf bank_mask:0xf
    v_and_b32_dpp v83, v27, v7 row_newbcast:1 row_mask:0xf bank_mask:0xf
    v_and_b32_dpp v84, v27, v4 row_newbcast:2 row_mask:0xf bank_mask:0xf
    v_and_b32_dpp v85, v27, v5 row_newbcast:2 row_mask:0xf bank_mask:0xf
    v_mfma_f32_16x16x32_bf16 v[88:91], v[80:83], v[100:103], v[88:91]
    v_and_b32_dpp v86, v27, v6 row_newbcast:2 row_mask:0xf bank_mask:0xf
    v_and_b32_dpp v87, v27, v7 row_newbcast:2 row_mask:0xf bank_mask:0xf
    v_and_b32_dpp v92, v27, v4 row_newbcast:3 row_mask:0xf bank_mask:0xf
    v_and_b32_dpp v93, v27, v5 row_newbcast:3 row_mask:0xf bank_mask:0xf
    v_mfma_f32_16x16x32_bf16 v[88:91], v[84:87], v[104:107], v[88:91]
    v_and_b32_dpp v94, v27, v6 row_newbcast:3 row_mask:0xf bank_mask:0xf
    v_and_b32_dpp v95, v27, v7 row_newbcast:3 row_mask:0xf bank_mask:0xf
    v_and_b32_dpp v76, v27, v4 row_newbcast:4 row_mask:0xf bank_mask:0xf
    v_and_b32_dpp v77, v27, v5 row_newbcast:4 row_mask:0xf bank_mask:0xf
    v_mfma_f32_16x16x32_bf16 v[88:91], v[92:95], v[108:111], v[88:91]
    v_and_b32_dpp v78, v27, v6 row_newbcast:4 row_mask:0xf bank_mask:0xf
    v_and_b32_dpp v79, v27, v7 row_newbcast:4 row_mask:0xf bank_mask:0xf
    v_and_b32_dpp v80, v27, v4 row_newbcast:5 row_mask:0xf bank_mask:0xf
    v_and_b32_dpp v81, v27, v5 row_newbcast:5 row_mask:0xf bank_mask:0xf
    v_mfma_f32_16x16x32_bf16 v[88:91], v[76:79], v[112:115], v[88:91]
    v_and_b32_dpp v82, v27, v6 row_newbcast:5 row_mask:0xf bank_mask:0xf
    v_and_b32_dpp v83, v27, v7 row_newbcast:5 row_mask:0xf bank_mask:0xf
    v_and_b32_dpp v84, v27, v4 row_newbcast:6 row_mask:0xf bank_mask:0xf
    v_and_b32_dpp v85, v27, v5 row_newbcast:6 row_mask:0xf bank_mask:0xf
    v_mfma_f32_16x16x32_bf16 v[88:91], v[80:83], v[116:119], v[88:91]
    v_and_b32_dpp v86, v27, v6 row_newbcast:6 row_mask:0xf bank_mask:0xf
    v_and_b32_dpp v87, v27, v7 row_newbcast:6 row_mask:0xf bank_mask:0xf
    s_nop 1
    v_mfma_f32_16x16x32_bf16 v[88:91], v[84:87], v[120:123], v[88:91]
    s_mov_b32 exec_hi, 0
    s_nop 6
    ds_write_b128 v26, v[88:91]
    s_mov_b64 exec, 1
    ds_add_rtn_u32 v29, v13, v28 offset:48
    s_mov_b64 exec, -1
    s_waitcnt lgkmcnt(0)
    v_readfirstlane_b32 s19, v29
    s_nop 1
    s_cmp_lg_u32 s19, 3
    s_cbranch_scc1 L_ys21
    ds_read_b128 v[72:75], v3 offset:30720
    ds_read_b128 v[76:79], v3 offset:31232
    ds_read_b128 v[80:83], v3 offset:31744
    ds_read_b128 v[84:87], v3 offset:32256
    s_waitcnt lgkmcnt(0)
    v_pk_add_f32 v[72:73], v[72:73], v[76:77]
    v_pk_add_f32 v[74:75], v[74:75], v[78:79]
    v_pk_add_f32 v[80:81], v[80:81], v[84:85]
    v_pk_add_f32 v[82:83], v[82:83], v[86:87]
    v_pk_add_f32 v[72:73], v[72:73], v[80:81]
    v_pk_add_f32 v[74:75], v[74:75], v[82:83]
    v_bfi_b32 v72, v23, s80, v72
    v_bfi_b32 v73, v23, s81, v73
    v_bfi_b32 v74, v23, s82, v74
    v_bfi_b32 v75, v23, s83, v75
    v_lshlrev_b32 v26, 5, v8
    v_lshl_add_u32 v26, v9, 4, v26
    s_lshl_b32 s19, s13, 12
    s_lshl_b32 s3, s12, 9
    s_add_u32 s19, s19, s3
    s_add_u32 s19, s19, 4718592
    s_mov_b32 exec_hi, 0
    buffer_store_dwordx4 v[72:75], v26, s[32:35], s19 offen sc1
    s_mov_b64 exec, -1
L_ys21:
    s_and_b32 s19, s12, 1
    s_lshl_b32 s19, s19, 1
    s_bfe_u32 s3, s12, 0x10001
    s_add_u32 s19, s19, s3
    s_lshl_b32 s19, s19, 2
    s_and_b32 s3, s13, 3
    s_add_u32 s19, s19, s3
    s_lshr_b32 s3, s72, 7
    s_xor_b32 s19, s19, s3
    s_or_b32 s19, s19, s17
    s_cmp_lg_u32 s19, 0
    s_cbranch_scc1 L_ldone
    v_lshlrev_b32 v26, 12, v9
    v_lshl_add_u32 v26, v8, 4, v26
    v_lshl_add_u32 v29, v8, 2, v9
    v_lshlrev_b32 v30, 1, v29
    v_lshlrev_b32 v29, 2, v29
    s_lshl_b32 s75, s67, 8
    s_add_u32 s75, s75, 4718592
    s_lshl_b32 s19, s72, 11
    s_lshl_b32 s3, s67, 7
    s_add_u32 s19, s19, s3
    s_lshr_b32 s76, s72, 1
    s_lshl_b32 s76, s76, 3
    s_add_u32 s76, s76, 4472832
    buffer_load_ushort v31, v30, s[24:27], s19 offen
L_yp22:
    buffer_load_dwordx2 v[32:33], v13, s[32:35], s76 offen sc1
    s_mov_b32 s19, s75
    buffer_load_dwordx4 v[100:103], v26, s[32:35], s19 offen sc1
    s_add_u32 s19, s19, 16384
    buffer_load_dwordx4 v[104:107], v26, s[32:35], s19 offen sc1
    s_add_u32 s19, s19, 16384
    buffer_load_dwordx4 v[108:111], v26, s[32:35], s19 offen sc1
    s_add_u32 s19, s19, 16384
    buffer_load_dwordx4 v[112:115], v26, s[32:35], s19 offen sc1
    s_add_u32 s19, s19, 16384
    buffer_load_dwordx4 v[116:119], v26, s[32:35], s19 offen sc1
    s_add_u32 s19, s19, 16384
    buffer_load_dwordx4 v[120:123], v26, s[32:35], s19 offen sc1
    s_add_u32 s19, s19, 16384
    buffer_load_dwordx4 v[124:127], v26, s[32:35], s19 offen sc1
    s_add_u32 s19, s19, 16384
    buffer_load_dwordx4 v[128:131], v26, s[32:35], s19 offen sc1
    s_add_u32 s19, s19, 16384
    s_waitcnt vmcnt(0)
    v_xor_b32 v33, s78, v33
    v_xor_b32 v100, s80, v100
    v_xor_b32 v101, s81, v101
    v_xor_b32 v102, s82, v102
    v_xor_b32 v103, s83, v103
    v_xor_b32 v104, s80, v104
    v_xor_b32 v105, s81, v105
    v_xor_b32 v106, s82, v106
    v_xor_b32 v107, s83, v107
    v_xor_b32 v108, s80, v108
    v_xor_b32 v109, s81, v109
    v_xor_b32 v110, s82, v110
    v_xor_b32 v111, s83, v111
    v_xor_b32 v112, s80, v112
    v_xor_b32 v113, s81, v113
    v_xor_b32 v114, s82, v114
    v_xor_b32 v115, s83, v115
    v_xor_b32 v116, s80, v116
    v_xor_b32 v117, s81, v117
    v_xor_b32 v118, s82, v118
    v_xor_b32 v119, s83, v119
    v_xor_b32 v120, s80, v120
    v_xor_b32 v121, s81, v121
    v_xor_b32 v122, s82, v122
    v_xor_b32 v123, s83, v123
    v_xor_b32 v124, s80, v124
    v_xor_b32 v125, s81, v125
    v_xor_b32 v126, s82, v126
    v_xor_b32 v127, s83, v127
    v_xor_b32 v128, s80, v128
    v_xor_b32 v129, s81, v129
    v_xor_b32 v130, s82, v130
    v_xor_b32 v131, s83, v131
    v_or_b32 v34, v100, v101
    v_or3_b32 v34, v34, v102, v103
    v_or3_b32 v34, v34, v104, v105
    v_or3_b32 v34, v34, v106, v107
    v_or3_b32 v34, v34, v108, v109
    v_or3_b32 v34, v34, v110, v111
    v_or3_b32 v34, v34, v112, v113
    v_or3_b32 v34, v34, v114, v115
    v_or3_b32 v34, v34, v116, v117
    v_or3_b32 v34, v34, v118, v119
    v_or3_b32 v34, v34, v120, v121
    v_or3_b32 v34, v34, v122, v123
    v_or3_b32 v34, v34, v124, v125
    v_or3_b32 v34, v34, v126, v127
    v_or3_b32 v34, v34, v128, v129
    v_or3_b32 v34, v34, v130, v131
    v_and_b32 v34, v34, v23
    v_or_b32 v34, v34, v33
    v_cmp_ne_u32 vcc, 0, v34
    s_cbranch_vccz L_yk23
    s_add_u32 s79, s79, 1
    s_cmp_lt_u32 s79, 32768
    s_cbranch_scc1 L_yp22
L_yk23:
    v_pk_add_f32 v[100:101], v[100:101], v[116:117]
    v_pk_add_f32 v[102:103], v[102:103], v[118:119]
    v_pk_add_f32 v[104:105], v[104:105], v[120:121]
    v_pk_add_f32 v[106:107], v[106:107], v[122:123]
    v_pk_add_f32 v[108:109], v[108:109], v[124:125]
    v_pk_add_f32 v[110:111], v[110:111], v[126:127]
    v_pk_add_f32 v[112:113], v[112:113], v[128:129]
    v_pk_add_f32 v[114:115], v[114:115], v[130:131]
    v_pk_add_f32 v[100:101], v[100:101], v[108:109]
    v_pk_add_f32 v[102:103], v[102:103], v[110:111]
    v_pk_add_f32 v[104:105], v[104:105], v[112:113]
    v_pk_add_f32 v[106:107], v[106:107], v[114:115]
    v_pk_add_f32 v[100:101], v[100:101], v[104:105]
    v_pk_add_f32 v[102:103], v[102:103], v[106:107]
    s_nop 1
    v_permlane32_swap_b32 v100, v102
    v_permlane32_swap_b32 v101, v103
    v_add_f32 v100, v100, v102
    v_add_f32 v101, v101, v103
    s_nop 1
    v_permlane16_swap_b32 v100, v101
    v_add_f32 v100, v100, v101
    s_lshr_b32 s19, s71, 11
    s_lshl_b32 s19, s19, 16
    s_not_b32 s3, s19
    s_ashr_i32 s3, s3, 31
    s_or_b32 s3, s3, 0x80000000
    s_xor_b32 s19, s19, s3
    s_and_b32 s19, s19, 0xffff0000
    v_mov_b32 v34, s19
    v_mul_f32 v34, 0xbfb8aa3b, v34
    v_exp_f32 v34, v34
    s_nop 0
    v_add_f32 v34, 1.0, v34
    v_rcp_f32 v34, v34
    s_nop 0
    v_cvt_pk_bf16_f32 v34, v34, v100
    v_and_b32 v35, 0xffff0000, v34
    v_lshlrev_b32 v34, 16, v34
    v_mul_f32 v34, v34, v35
    v_cvt_pk_bf16_f32 v34, v34, v34
    v_lshlrev_b32 v34, 16, v34
    v_lshlrev_b32 v31, 16, v31
    v_add_f32 v34, v34, v31
    s_and_b32 s3, s72, 1
    s_lshl_b32 s3, s3, 4
    v_lshrrev_b32 v32, s3, v32
    v_lshlrev_b32 v32, 16, v32
    v_sub_f32 v32, 1.0, v32
    v_cvt_pk_bf16_f32 v34, v34, v32
    v_and_b32 v35, 0xffff0000, v34
    v_lshlrev_b32 v34, 16, v34
    v_mul_f32 v34, v34, v35
    v_cvt_pk_bf16_f32 v34, v34, v34
    v_lshlrev_b32 v34, 16, v34
    v_mov_b32 v28, 1
    ds_write_b32 v29, v34 offset:512
    ds_write_b32 v13, v37 offset:224
    s_waitcnt lgkmcnt(0)
L_ldone:
    s_endpgm
L_compute:
    s_mov_b64 s[32:33], s[98:99]
    s_mov_b32 s34, 16777216
    s_mov_b32 s35, 0x00020000
    s_mov_b64 s[36:37], s[96:97]
    s_mov_b32 s38, 256
    s_mov_b32 s39, 0x00020000
    s_mov_b64 s[40:41], s[8:9]
    s_mov_b32 s42, 65536
    s_mov_b32 s43, 0x00020000
    s_mov_b64 s[44:45], s[94:95]
    s_mov_b32 s46, 4194304
    s_mov_b32 s47, 0x00020000
    s_mov_b64 s[60:61], s[98:99]
    s_mov_b32 s62, 16777216
    s_mov_b32 s63, 0x00020000
    s_mov_b32 s79, 0
    s_lshr_b32 s17, s16, 1
    s_and_b32 s18, s16, 1
    v_mov_b32 v13, 0
    v_and_b32 v4, 15, v2
    v_lshrrev_b32 v9, 4, v2
    s_or_b32 s19, s2, s16
    s_cmp_lg_u32 s19, 0
    s_cbranch_scc1 L_tp24
    s_memrealtime s[20:21]
    s_waitcnt lgkmcnt(0)
    s_or_b32 s20, s20, 1
    v_mov_b32 v3, s20
    s_mov_b64 exec, 1
    buffer_store_dword v3, v13, s[36:39], 0 offen offset:4 sc1
    s_mov_b64 exec, -1
L_tp24:
    s_lshl_b32 s67, s15, 1
    s_add_u32 s67, s67, s18
    s_lshl_b32 s19, s67, 11
    v_lshlrev_b32 v5, 6, v4
    v_lshl_add_u32 v5, v9, 3, v5
    buffer_load_dwordx2 v[60:61], v5, s[40:43], s19 offen offset:0
    buffer_load_dwordx2 v[62:63], v5, s[40:43], s19 offen offset:32
    buffer_load_dwordx2 v[64:65], v5, s[40:43], s19 offen offset:1024
    buffer_load_dwordx2 v[66:67], v5, s[40:43], s19 offen offset:1056
    s_lshl_b32 s19, s17, 13
    v_lshlrev_b32 v6, 7, v4
    v_add_u32 v6, s19, v6
    v_bfe_u32 v7, v2, 1, 3
    v_add_u32 v8, 0, v9
    v_xor_b32 v8, v8, v7
    v_lshl_add_u32 v20, v8, 4, v6
    v_add_u32 v8, 4, v9
    v_xor_b32 v8, v8, v7
    v_lshl_add_u32 v21, v8, 4, v6
    v_add_u32 v22, 40960, v20
    v_add_u32 v23, 40960, v21
    v_add_u32 v24, 81920, v20
    v_add_u32 v25, 81920, v21
    v_add_u32 v26, 122880, v20
    v_add_u32 v27, 122880, v21
    v_lshlrev_b32 v6, 10, v9
    v_bfe_u32 v7, v2, 2, 2
    v_lshl_add_u32 v6, v7, 7, v6
    v_bfe_u32 v7, v2, 3, 1
    v_xor_b32 v7, s18, v7
    v_lshl_add_u32 v6, v7, 6, v6
    v_bfe_u32 v7, v2, 4, 1
    v_lshl_add_u32 v6, v7, 5, v6
    v_and_b32 v7, 3, v2
    v_lshl_add_u32 v6, v7, 3, v6
    v_add_u32 v36, 16384, v6
    v_xor_b32 v37, 32, v36
    v_add_u32 v38, 57344, v6
    v_xor_b32 v39, 32, v38
    v_add_u32 v40, 98304, v6
    v_xor_b32 v41, 32, v40
    v_add_u32 v42, 139264, v6
    v_xor_b32 v43, 32, v42
    v_lshrrev_b32 v5, 2, v4
    v_and_b32 v6, 1, v4
    v_lshlrev_b32 v6, 4, v6
    v_mov_b32 v7, 0x3f80
    v_lshlrev_b32 v7, v6, v7
    v_cmp_eq_u32 vcc, v5, v9
    s_nop 1
    v_cndmask_b32 v7, 0, v7, vcc
    v_and_b32 v6, 2, v4
    v_cmp_eq_u32 vcc, 0, v6
    s_nop 1
    v_cndmask_b32 v52, 0, v7, vcc
    v_cndmask_b32 v53, v7, v13, vcc
    v_mov_b32 v56, 0x3f803f80
    v_mov_b32 v57, 0x3f803f80
    v_mov_b32 v58, 0x3f803f80
    v_mov_b32 v59, 0x3f803f80
    v_lshlrev_b32 v3, 4, v2
    v_lshlrev_b32 v12, 4, v9
    v_lshrrev_b32 v11, 5, v2
    v_lshlrev_b32 v8, 9, v11
    v_and_b32 v19, 16, v12
    v_add_u32 v8, v8, v19
    v_lshlrev_b32 v11, 2, v11
    v_lshl_add_u32 v11, v4, 4, v11
    v_lshlrev_b32 v9, 10, v9
    v_lshl_add_u32 v9, v4, 4, v9
    v_lshlrev_b32 v10, 3, v2
    s_xor_b32 s3, s16, 2
    s_mul_i32 s19, s3, 6144
    s_add_u32 s19, s19, 2048
    v_add_u32 v4, s19, v3
    s_mul_i32 s19, s16, 6144
    s_add_u32 s19, s19, 2048
    v_add_u32 v5, s19, v3
    v_lshlrev_b32 v7, 2, v2
    s_lshl_b32 s19, s3, 8
    s_add_u32 s19, s19, 1024
    v_add_u32 v6, s19, v7
    s_lshl_b32 s19, s16, 8
    s_add_u32 s19, s19, 1024
    v_add_u32 v7, s19, v7
    v_mov_b32 v15, 0x3ff
    v_mov_b32 v18, 0x7fc17fc1
    s_lshl_b32 s19, s16, 2
    v_mov_b32 v1, s19
    v_mov_b32 v19, -1
    s_lshl_b32 s19, s15, 2
    s_lshr_b32 s3, s14, 2
    s_add_u32 s19, s19, s3
    s_and_b32 s3, s14, 1
    s_bfe_u32 s20, s14, 0x10001
    s_lshl_b32 s20, s20, 3
    s_lshl_b32 s64, s19, 1
    s_add_u32 s64, s64, s3
    s_lshl_b32 s64, s64, 2
    s_add_u32 s64, s64, s16
    s_lshl_b32 s64, s64, 8
    s_add_u32 s64, s64, s20
    s_add_u32 s64, s64, 4325376
    s_lshl_b32 s65, s19, 1
    s_add_u32 s65, s65, s3
    s_lshl_b32 s65, s65, 1
    s_add_u32 s65, s65, s17
    s_lshl_b32 s65, s65, 4
    s_add_u32 s65, s65, s20
    s_lshl_b32 s3, s18, 2
    s_add_u32 s65, s65, s3
    s_add_u32 s65, s65, 4456448
    s_mov_b32 s74, 0x3fb8aa3b
    s_mov_b32 s76, 0xbfb8aa3b
    s_mov_b32 s75, 0
    s_mov_b32 s77, 0
    s_mov_b32 s69, 0
    s_mov_b32 s71, 0
    s_cmp_lg_u32 s17, 0
    s_cselect_b32 s68, s74, s76
    s_cselect_b32 s70, s76, s74
    s_cselect_b64 s[72:73], -1, 0
    s_mov_b32 s66, 0
    s_lshl_b32 s19, s15, 4
    s_lshl_b32 s3, s18, 3
    s_add_u32 s19, s19, s3
    s_lshl_b32 s3, s17, 2
    s_add_u32 s19, s19, s3
    s_lshl_b32 s19, s19, 4
    s_add_u32 s19, s19, s14
    s_lshl_b32 s48, s19, 10
    s_lshl_b32 s49, s19, 5
    s_add_u32 s49, s49, 4194304
    s_lshl_b32 s19, s15, 4
    s_add_u32 s19, s19, s14
    s_lshl_b32 s50, s19, 6
    s_add_u32 s50, s50, s16
    s_lshl_b32 s50, s50, 8
    s_lshl_b32 s51, s19, 9
    s_add_u32 s51, s51, 4194304
    s_lshl_b32 s19, s14, 1
    s_add_u32 s19, s19, s17
    s_lshl_b32 s52, s19, 17
    s_lshl_b32 s3, s67, 10
    s_add_u32 s52, s52, s3
    s_add_u32 s52, s52, 8388608
    s_lshl_b32 s53, s19, 5
    s_add_u32 s53, s53, s67
    s_lshl_b32 s53, s53, 2
    s_add_u32 s53, s53, 4481024
    s_and_b32 s19, s12, 1
    s_lshl_b32 s19, s19, 1
    s_bfe_u32 s3, s12, 0x10001
    s_add_u32 s19, s19, s3
    s_lshl_b32 s19, s19, 2
    s_and_b32 s3, s13, 3
    s_add_u32 s19, s19, s3
    s_lshl_b32 s58, s19, 2
    s_add_u32 s58, s58, s16
    s_lshr_b32 s19, s12, 2
    s_lshl_b32 s19, s19, 3
    s_lshr_b32 s3, s13, 2
    s_add_u32 s19, s19, s3
    s_lshl_b32 s54, s58, 16
    s_lshl_b32 s3, s19, 7
    s_add_u32 s54, s54, s3
    s_add_u32 s55, s54, 32768
    s_lshr_b32 s56, s58, 1
    s_lshl_b32 s56, s56, 7
    s_add_u32 s56, s56, 4481024
    s_lshl_b32 s57, s58, 7
    s_add_u32 s57, s57, 4472832
    s_lshl_b32 s59, s67, 12
    s_add_u32 s59, s59, 4325376
    s_lshl_b32 s28, s67, 7
    s_add_u32 s28, s28, 4456448
    s_mov_b32 s29, 0
    v_lshrrev_b32 v19, 4, v2
    v_and_b32 v54, 15, v2
    v_lshlrev_b32 v54, 6, v54
    v_lshl_add_u32 v76, v19, 14, v54
    v_lshl_add_u32 v77, v19, 15, v54
    v_lshrrev_b32 v19, 1, v2
    v_and_b32 v54, 1, v2
    v_lshlrev_b32 v54, 6, v54
    v_lshl_add_u32 v78, v19, 11, v54
    v_lshlrev_b32 v79, 9, v2
    v_lshrrev_b32 v54, 1, v2
    v_lshlrev_b32 v54, 10, v54
    v_and_b32 v19, 1, v2
    v_lshl_add_u32 v54, v19, 7, v54
    v_add_u32 v54, s50, v54
    v_lshlrev_b32 v19, 7, v2
    v_add_u32 v55, s51, v19
    s_sub_u32 s3, s59, 4096
    v_add_u32 v19, s3, v19
    v_cmp_gt_u32 vcc, 32, v2
    s_nop 1
    v_cndmask_b32 v54, v19, v54, vcc
    v_mov_b32 v19, s28
    v_cmp_gt_u32 vcc, 4, v2
    s_nop 1
    v_cndmask_b32 v55, v19, v55, vcc
    v_mov_b32 v19, -1
    s_lshl_b32 s19, s14, 4
    s_add_u32 s19, s19, s15
    s_lshl_b32 s53, s19, 7
    s_add_u32 s53, s53, 4849664
    s_lshr_b32 s19, s58, 2
    s_lshl_b32 s56, s19, 11
    s_add_u32 s56, s56, 4849664
    v_mov_b64 v[160:161], 0
    v_mov_b64 v[162:163], 0
    v_mov_b64 v[164:165], 0
    v_mov_b64 v[166:167], 0
    v_mov_b64 v[168:169], 0
    v_mov_b64 v[170:171], 0
    v_mov_b64 v[172:173], 0
    v_mov_b64 v[174:175], 0
    v_mov_b64 v[176:177], 0
    v_mov_b64 v[178:179], 0
    v_mov_b64 v[180:181], 0
    v_mov_b64 v[182:183], 0
    v_mov_b64 v[184:185], 0
    v_mov_b64 v[186:187], 0
    v_mov_b64 v[188:189], 0
    v_mov_b64 v[190:191], 0
    v_mov_b64 v[192:193], 0
    v_mov_b64 v[194:195], 0
    v_mov_b64 v[196:197], 0
    v_mov_b64 v[198:199], 0
    v_mov_b64 v[200:201], 0
    v_mov_b64 v[202:203], 0
    v_mov_b64 v[204:205], 0
    v_mov_b64 v[206:207], 0
    v_mov_b64 v[208:209], 0
    v_mov_b64 v[210:211], 0
    v_mov_b64 v[212:213], 0
    v_mov_b64 v[214:215], 0
    v_mov_b64 v[216:217], 0
    v_mov_b64 v[218:219], 0
    v_mov_b64 v[220:221], 0
    v_mov_b64 v[222:223], 0
    v_mov_b64 v[224:225], 0
    v_mov_b64 v[226:227], 0
    v_mov_b64 v[228:229], 0
    v_mov_b64 v[230:231], 0
    v_mov_b64 v[232:233], 0
    v_mov_b64 v[234:235], 0
    v_mov_b64 v[236:237], 0
    v_mov_b64 v[238:239], 0
    v_mov_b64 v[240:241], 0
    v_mov_b64 v[242:243], 0
    v_mov_b64 v[244:245], 0
    v_mov_b64 v[246:247], 0
    v_mov_b64 v[248:249], 0
    v_mov_b64 v[250:251], 0
    v_mov_b64 v[252:253], 0
    v_mov_b64 v[254:255], 0
    s_waitcnt vmcnt(4)
    s_barrier
    ds_read_b128 v[80:83], v20 offset:0
    ds_read_b64_tr_b16 v[96:97], v36 offset:0
    ds_read_b64_tr_b16 v[98:99], v36 offset:512
    ds_read_b128 v[84:87], v20 offset:2048
    ds_read_b128 v[88:91], v20 offset:4096
    ds_read_b128 v[92:95], v20 offset:6144
    ds_read_b64_tr_b16 v[100:101], v37 offset:0
    ds_read_b64_tr_b16 v[102:103], v37 offset:512
    ds_read_b64_tr_b16 v[104:105], v36 offset:8192
    ds_read_b64_tr_b16 v[106:107], v36 offset:8704
    ds_read_b64_tr_b16 v[108:109], v37 offset:8192
    ds_read_b64_tr_b16 v[110:111], v37 offset:8704
    ds_read_b64_tr_b16 v[112:113], v36 offset:16384
    ds_read_b64_tr_b16 v[114:115], v36 offset:16896
    ds_read_b64_tr_b16 v[116:117], v37 offset:16384
    ds_read_b64_tr_b16 v[118:119], v37 offset:16896
    s_mov_b32 exec_lo, 0xffff
    s_mov_b32 exec_hi, 0xffff
    buffer_store_dword v19, v11, s[32:35], s64 offen sc1
    s_lshl_b64 exec, 1, s16
    buffer_store_dword v19, v13, s[32:35], s65 offen sc1
    s_mov_b64 exec, -1
.p2align 7
L_loop:
    s_waitcnt lgkmcnt(10)
    v_mfma_f32_16x16x32_bf16 v[160:163], v[96:99], v[80:83], v[160:163]
    ds_read_b128 v[120:123], v21 offset:0
    v_mfma_f32_16x16x32_bf16 v[164:167], v[96:99], v[84:87], v[164:167]
    ds_read_b64_tr_b16 v[136:137], v36 offset:4096
    v_mfma_f32_16x16x32_bf16 v[168:171], v[96:99], v[88:91], v[168:171]
    ds_read_b64_tr_b16 v[138:139], v36 offset:4608
    v_mfma_f32_16x16x32_bf16 v[172:175], v[96:99], v[92:95], v[172:175]
    s_waitcnt lgkmcnt(11)
    v_mfma_f32_16x16x32_bf16 v[188:191], v[100:103], v[92:95], v[188:191]
    ds_read_b128 v[124:127], v21 offset:2048
    v_mfma_f32_16x16x32_bf16 v[184:187], v[100:103], v[88:91], v[184:187]
    ds_read_b128 v[128:131], v21 offset:4096
    v_mfma_f32_16x16x32_bf16 v[180:183], v[100:103], v[84:87], v[180:183]
    ds_read_b128 v[132:135], v21 offset:6144
    v_mfma_f32_16x16x32_bf16 v[176:179], v[100:103], v[80:83], v[176:179]
    s_waitcnt lgkmcnt(12)
    v_mfma_f32_16x16x32_bf16 v[192:195], v[104:107], v[80:83], v[192:195]
    ds_read_b64_tr_b16 v[140:141], v37 offset:4096
    v_mfma_f32_16x16x32_bf16 v[196:199], v[104:107], v[84:87], v[196:199]
    ds_read_b64_tr_b16 v[142:143], v37 offset:4608
    v_mfma_f32_16x16x32_bf16 v[200:203], v[104:107], v[88:91], v[200:203]
    ds_read_b64_tr_b16 v[144:145], v36 offset:12288
    v_mfma_f32_16x16x32_bf16 v[204:207], v[104:107], v[92:95], v[204:207]
    s_waitcnt lgkmcnt(13)
    v_mfma_f32_16x16x32_bf16 v[220:223], v[108:111], v[92:95], v[220:223]
    ds_read_b64_tr_b16 v[146:147], v36 offset:12800
    v_mfma_f32_16x16x32_bf16 v[216:219], v[108:111], v[88:91], v[216:219]
    ds_read_b64_tr_b16 v[148:149], v37 offset:12288
    v_mfma_f32_16x16x32_bf16 v[212:215], v[108:111], v[84:87], v[212:215]
    ds_read_b64_tr_b16 v[150:151], v37 offset:12800
    v_mfma_f32_16x16x32_bf16 v[208:211], v[108:111], v[80:83], v[208:211]
    s_waitcnt lgkmcnt(14)
    v_mfma_f32_16x16x32_bf16 v[224:227], v[80:83], v[112:115], v[224:227]
    ds_read_b64_tr_b16 v[152:153], v36 offset:20480
    v_mfma_f32_16x16x32_bf16 v[228:231], v[84:87], v[112:115], v[228:231]
    ds_read_b64_tr_b16 v[154:155], v36 offset:20992
    v_mfma_f32_16x16x32_bf16 v[232:235], v[88:91], v[112:115], v[232:235]
    ds_read_b64_tr_b16 v[156:157], v37 offset:20480
    v_mfma_f32_16x16x32_bf16 v[236:239], v[92:95], v[112:115], v[236:239]
    s_waitcnt lgkmcnt(15)
    v_mfma_f32_16x16x32_bf16 v[252:255], v[92:95], v[116:119], v[252:255]
    ds_read_b64_tr_b16 v[158:159], v37 offset:20992
    v_mfma_f32_16x16x32_bf16 v[248:251], v[88:91], v[116:119], v[248:251]
    v_mfma_f32_16x16x32_bf16 v[244:247], v[84:87], v[116:119], v[244:247]
    v_mfma_f32_16x16x32_bf16 v[240:243], v[80:83], v[116:119], v[240:243]
    s_waitcnt lgkmcnt(10)
    v_mfma_f32_16x16x32_bf16 v[160:163], v[136:139], v[120:123], v[160:163]
    v_mfma_f32_16x16x32_bf16 v[164:167], v[136:139], v[124:127], v[164:167]
    v_mfma_f32_16x16x32_bf16 v[168:171], v[136:139], v[128:131], v[168:171]
    v_mfma_f32_16x16x32_bf16 v[172:175], v[136:139], v[132:135], v[172:175]
    s_waitcnt lgkmcnt(0)
    s_barrier
    ds_read_b128 v[80:83], v22 offset:0
    v_mfma_f32_16x16x32_bf16 v[188:191], v[140:143], v[132:135], v[188:191]
    ds_read_b64_tr_b16 v[96:97], v38 offset:0
    v_mfma_f32_16x16x32_bf16 v[184:187], v[140:143], v[128:131], v[184:187]
    ds_read_b64_tr_b16 v[98:99], v38 offset:512
    v_mfma_f32_16x16x32_bf16 v[180:183], v[140:143], v[124:127], v[180:183]
    ds_read_b128 v[84:87], v22 offset:2048
    v_mfma_f32_16x16x32_bf16 v[176:179], v[140:143], v[120:123], v[176:179]
    ds_read_b128 v[88:91], v22 offset:4096
    v_mfma_f32_16x16x32_bf16 v[192:195], v[144:147], v[120:123], v[192:195]
    ds_read_b128 v[92:95], v22 offset:6144
    v_mfma_f32_16x16x32_bf16 v[196:199], v[144:147], v[124:127], v[196:199]
    ds_read_b64_tr_b16 v[100:101], v39 offset:0
    v_mfma_f32_16x16x32_bf16 v[200:203], v[144:147], v[128:131], v[200:203]
    ds_read_b64_tr_b16 v[102:103], v39 offset:512
    v_mfma_f32_16x16x32_bf16 v[204:207], v[144:147], v[132:135], v[204:207]
    ds_read_b64_tr_b16 v[104:105], v38 offset:8192
    v_mfma_f32_16x16x32_bf16 v[220:223], v[148:151], v[132:135], v[220:223]
    ds_read_b64_tr_b16 v[106:107], v38 offset:8704
    v_mfma_f32_16x16x32_bf16 v[216:219], v[148:151], v[128:131], v[216:219]
    ds_read_b64_tr_b16 v[108:109], v39 offset:8192
    v_mfma_f32_16x16x32_bf16 v[212:215], v[148:151], v[124:127], v[212:215]
    ds_read_b64_tr_b16 v[110:111], v39 offset:8704
    v_mfma_f32_16x16x32_bf16 v[208:211], v[148:151], v[120:123], v[208:211]
    ds_read_b64_tr_b16 v[112:113], v38 offset:16384
    v_mfma_f32_16x16x32_bf16 v[224:227], v[120:123], v[152:155], v[224:227]
    ds_read_b64_tr_b16 v[114:115], v38 offset:16896
    v_mfma_f32_16x16x32_bf16 v[228:231], v[124:127], v[152:155], v[228:231]
    ds_read_b64_tr_b16 v[116:117], v39 offset:16384
    v_mfma_f32_16x16x32_bf16 v[232:235], v[128:131], v[152:155], v[232:235]
    ds_read_b64_tr_b16 v[118:119], v39 offset:16896
    v_mfma_f32_16x16x32_bf16 v[236:239], v[132:135], v[152:155], v[236:239]
    v_mfma_f32_16x16x32_bf16 v[252:255], v[132:135], v[156:159], v[252:255]
    v_mfma_f32_16x16x32_bf16 v[248:251], v[128:131], v[156:159], v[248:251]
    v_mfma_f32_16x16x32_bf16 v[244:247], v[124:127], v[156:159], v[244:247]
    v_mfma_f32_16x16x32_bf16 v[240:243], v[120:123], v[156:159], v[240:243]
    s_cmp_eq_u32 s66, 2
    s_cbranch_scc1 L_mid
L_midret:
    s_waitcnt lgkmcnt(10)
    v_mfma_f32_16x16x32_bf16 v[160:163], v[96:99], v[80:83], v[160:163]
    ds_read_b128 v[120:123], v23 offset:0
    v_mfma_f32_16x16x32_bf16 v[164:167], v[96:99], v[84:87], v[164:167]
    ds_read_b64_tr_b16 v[136:137], v38 offset:4096
    v_mfma_f32_16x16x32_bf16 v[168:171], v[96:99], v[88:91], v[168:171]
    ds_read_b64_tr_b16 v[138:139], v38 offset:4608
    v_mfma_f32_16x16x32_bf16 v[172:175], v[96:99], v[92:95], v[172:175]
    s_waitcnt lgkmcnt(11)
    v_mfma_f32_16x16x32_bf16 v[188:191], v[100:103], v[92:95], v[188:191]
    ds_read_b128 v[124:127], v23 offset:2048
    v_mfma_f32_16x16x32_bf16 v[184:187], v[100:103], v[88:91], v[184:187]
    ds_read_b128 v[128:131], v23 offset:4096
    v_mfma_f32_16x16x32_bf16 v[180:183], v[100:103], v[84:87], v[180:183]
    ds_read_b128 v[132:135], v23 offset:6144
    v_mfma_f32_16x16x32_bf16 v[176:179], v[100:103], v[80:83], v[176:179]
    s_waitcnt lgkmcnt(12)
    v_mfma_f32_16x16x32_bf16 v[192:195], v[104:107], v[80:83], v[192:195]
    ds_read_b64_tr_b16 v[140:141], v39 offset:4096
    v_mfma_f32_16x16x32_bf16 v[196:199], v[104:107], v[84:87], v[196:199]
    ds_read_b64_tr_b16 v[142:143], v39 offset:4608
    v_mfma_f32_16x16x32_bf16 v[200:203], v[104:107], v[88:91], v[200:203]
    ds_read_b64_tr_b16 v[144:145], v38 offset:12288
    v_mfma_f32_16x16x32_bf16 v[204:207], v[104:107], v[92:95], v[204:207]
    s_waitcnt lgkmcnt(13)
    v_mfma_f32_16x16x32_bf16 v[220:223], v[108:111], v[92:95], v[220:223]
    ds_read_b64_tr_b16 v[146:147], v38 offset:12800
    v_mfma_f32_16x16x32_bf16 v[216:219], v[108:111], v[88:91], v[216:219]
    ds_read_b64_tr_b16 v[148:149], v39 offset:12288
    v_mfma_f32_16x16x32_bf16 v[212:215], v[108:111], v[84:87], v[212:215]
    ds_read_b64_tr_b16 v[150:151], v39 offset:12800
    v_mfma_f32_16x16x32_bf16 v[208:211], v[108:111], v[80:83], v[208:211]
    s_waitcnt lgkmcnt(14)
    v_mfma_f32_16x16x32_bf16 v[224:227], v[80:83], v[112:115], v[224:227]
    ds_read_b64_tr_b16 v[152:153], v38 offset:20480
    v_mfma_f32_16x16x32_bf16 v[228:231], v[84:87], v[112:115], v[228:231]
    ds_read_b64_tr_b16 v[154:155], v38 offset:20992
    v_mfma_f32_16x16x32_bf16 v[232:235], v[88:91], v[112:115], v[232:235]
    ds_read_b64_tr_b16 v[156:157], v39 offset:20480
    v_mfma_f32_16x16x32_bf16 v[236:239], v[92:95], v[112:115], v[236:239]
    s_waitcnt lgkmcnt(15)
    v_mfma_f32_16x16x32_bf16 v[252:255], v[92:95], v[116:119], v[252:255]
    ds_read_b64_tr_b16 v[158:159], v39 offset:20992
    v_mfma_f32_16x16x32_bf16 v[248:251], v[88:91], v[116:119], v[248:251]
    v_mfma_f32_16x16x32_bf16 v[244:247], v[84:87], v[116:119], v[244:247]
    v_mfma_f32_16x16x32_bf16 v[240:243], v[80:83], v[116:119], v[240:243]
    s_waitcnt lgkmcnt(10)
    v_mfma_f32_16x16x32_bf16 v[160:163], v[136:139], v[120:123], v[160:163]
    v_mfma_f32_16x16x32_bf16 v[164:167], v[136:139], v[124:127], v[164:167]
    v_mfma_f32_16x16x32_bf16 v[168:171], v[136:139], v[128:131], v[168:171]
    v_mfma_f32_16x16x32_bf16 v[172:175], v[136:139], v[132:135], v[172:175]
    s_cmp_eq_u32 s66, 3
    s_waitcnt lgkmcnt(0)
    s_barrier
L_nob:
    ds_read_b128 v[80:83], v24 offset:0
    v_mfma_f32_16x16x32_bf16 v[188:191], v[140:143], v[132:135], v[188:191]
    ds_read_b64_tr_b16 v[96:97], v40 offset:0
    v_mfma_f32_16x16x32_bf16 v[184:187], v[140:143], v[128:131], v[184:187]
    ds_read_b64_tr_b16 v[98:99], v40 offset:512
    v_mfma_f32_16x16x32_bf16 v[180:183], v[140:143], v[124:127], v[180:183]
    ds_read_b128 v[84:87], v24 offset:2048
    v_mfma_f32_16x16x32_bf16 v[176:179], v[140:143], v[120:123], v[176:179]
    ds_read_b128 v[88:91], v24 offset:4096
    v_mfma_f32_16x16x32_bf16 v[192:195], v[144:147], v[120:123], v[192:195]
    ds_read_b128 v[92:95], v24 offset:6144
    v_mfma_f32_16x16x32_bf16 v[196:199], v[144:147], v[124:127], v[196:199]
    ds_read_b64_tr_b16 v[100:101], v41 offset:0
    v_mfma_f32_16x16x32_bf16 v[200:203], v[144:147], v[128:131], v[200:203]
    ds_read_b64_tr_b16 v[102:103], v41 offset:512
    v_mfma_f32_16x16x32_bf16 v[204:207], v[144:147], v[132:135], v[204:207]
    ds_read_b64_tr_b16 v[104:105], v40 offset:8192
    v_mfma_f32_16x16x32_bf16 v[220:223], v[148:151], v[132:135], v[220:223]
    ds_read_b64_tr_b16 v[106:107], v40 offset:8704
    v_mfma_f32_16x16x32_bf16 v[216:219], v[148:151], v[128:131], v[216:219]
    ds_read_b64_tr_b16 v[108:109], v41 offset:8192
    v_mfma_f32_16x16x32_bf16 v[212:215], v[148:151], v[124:127], v[212:215]
    ds_read_b64_tr_b16 v[110:111], v41 offset:8704
    v_mfma_f32_16x16x32_bf16 v[208:211], v[148:151], v[120:123], v[208:211]
    ds_read_b64_tr_b16 v[112:113], v40 offset:16384
    v_mfma_f32_16x16x32_bf16 v[224:227], v[120:123], v[152:155], v[224:227]
    ds_read_b64_tr_b16 v[114:115], v40 offset:16896
    v_mfma_f32_16x16x32_bf16 v[228:231], v[124:127], v[152:155], v[228:231]
    ds_read_b64_tr_b16 v[116:117], v41 offset:16384
    v_mfma_f32_16x16x32_bf16 v[232:235], v[128:131], v[152:155], v[232:235]
    ds_read_b64_tr_b16 v[118:119], v41 offset:16896
    v_mfma_f32_16x16x32_bf16 v[236:239], v[132:135], v[152:155], v[236:239]
    v_mfma_f32_16x16x32_bf16 v[252:255], v[132:135], v[156:159], v[252:255]
    v_mfma_f32_16x16x32_bf16 v[248:251], v[128:131], v[156:159], v[248:251]
    v_mfma_f32_16x16x32_bf16 v[244:247], v[124:127], v[156:159], v[244:247]
    v_mfma_f32_16x16x32_bf16 v[240:243], v[120:123], v[156:159], v[240:243]
    s_waitcnt lgkmcnt(10)
    v_mfma_f32_16x16x32_bf16 v[160:163], v[96:99], v[80:83], v[160:163]
    ds_read_b128 v[120:123], v25 offset:0
    v_mfma_f32_16x16x32_bf16 v[164:167], v[96:99], v[84:87], v[164:167]
    ds_read_b64_tr_b16 v[136:137], v40 offset:4096
    v_mfma_f32_16x16x32_bf16 v[168:171], v[96:99], v[88:91], v[168:171]
    ds_read_b64_tr_b16 v[138:139], v40 offset:4608
    v_mfma_f32_16x16x32_bf16 v[172:175], v[96:99], v[92:95], v[172:175]
    s_waitcnt lgkmcnt(11)
    v_mfma_f32_16x16x32_bf16 v[188:191], v[100:103], v[92:95], v[188:191]
    ds_read_b128 v[124:127], v25 offset:2048
    v_mfma_f32_16x16x32_bf16 v[184:187], v[100:103], v[88:91], v[184:187]
    ds_read_b128 v[128:131], v25 offset:4096
    v_mfma_f32_16x16x32_bf16 v[180:183], v[100:103], v[84:87], v[180:183]
    ds_read_b128 v[132:135], v25 offset:6144
    v_mfma_f32_16x16x32_bf16 v[176:179], v[100:103], v[80:83], v[176:179]
    s_waitcnt lgkmcnt(12)
    v_mfma_f32_16x16x32_bf16 v[192:195], v[104:107], v[80:83], v[192:195]
    ds_read_b64_tr_b16 v[140:141], v41 offset:4096
    v_mfma_f32_16x16x32_bf16 v[196:199], v[104:107], v[84:87], v[196:199]
    ds_read_b64_tr_b16 v[142:143], v41 offset:4608
    v_mfma_f32_16x16x32_bf16 v[200:203], v[104:107], v[88:91], v[200:203]
    ds_read_b64_tr_b16 v[144:145], v40 offset:12288
    v_mfma_f32_16x16x32_bf16 v[204:207], v[104:107], v[92:95], v[204:207]
    s_waitcnt lgkmcnt(13)
    v_mfma_f32_16x16x32_bf16 v[220:223], v[108:111], v[92:95], v[220:223]
    ds_read_b64_tr_b16 v[146:147], v40 offset:12800
    v_mfma_f32_16x16x32_bf16 v[216:219], v[108:111], v[88:91], v[216:219]
    ds_read_b64_tr_b16 v[148:149], v41 offset:12288
    v_mfma_f32_16x16x32_bf16 v[212:215], v[108:111], v[84:87], v[212:215]
    ds_read_b64_tr_b16 v[150:151], v41 offset:12800
    v_mfma_f32_16x16x32_bf16 v[208:211], v[108:111], v[80:83], v[208:211]
    s_waitcnt lgkmcnt(14)
    v_mfma_f32_16x16x32_bf16 v[224:227], v[80:83], v[112:115], v[224:227]
    ds_read_b64_tr_b16 v[152:153], v40 offset:20480
    v_mfma_f32_16x16x32_bf16 v[228:231], v[84:87], v[112:115], v[228:231]
    ds_read_b64_tr_b16 v[154:155], v40 offset:20992
    v_mfma_f32_16x16x32_bf16 v[232:235], v[88:91], v[112:115], v[232:235]
    ds_read_b64_tr_b16 v[156:157], v41 offset:20480
    v_mfma_f32_16x16x32_bf16 v[236:239], v[92:95], v[112:115], v[236:239]
    s_waitcnt lgkmcnt(15)
    v_mfma_f32_16x16x32_bf16 v[252:255], v[92:95], v[116:119], v[252:255]
    ds_read_b64_tr_b16 v[158:159], v41 offset:20992
    v_mfma_f32_16x16x32_bf16 v[248:251], v[88:91], v[116:119], v[248:251]
    v_mfma_f32_16x16x32_bf16 v[244:247], v[84:87], v[116:119], v[244:247]
    v_mfma_f32_16x16x32_bf16 v[240:243], v[80:83], v[116:119], v[240:243]
    s_waitcnt lgkmcnt(10)
    v_mfma_f32_16x16x32_bf16 v[160:163], v[136:139], v[120:123], v[160:163]
    v_mfma_f32_16x16x32_bf16 v[164:167], v[136:139], v[124:127], v[164:167]
    v_mfma_f32_16x16x32_bf16 v[168:171], v[136:139], v[128:131], v[168:171]
    v_mfma_f32_16x16x32_bf16 v[172:175], v[136:139], v[132:135], v[172:175]
    s_cmp_eq_u32 s66, 3
    s_waitcnt lgkmcnt(0)
    s_cbranch_scc1 L_last
    s_barrier
    ds_read_b128 v[80:83], v26 offset:0
    v_mfma_f32_16x16x32_bf16 v[188:191], v[140:143], v[132:135], v[188:191]
    ds_read_b64_tr_b16 v[96:97], v42 offset:0
    v_mfma_f32_16x16x32_bf16 v[184:187], v[140:143], v[128:131], v[184:187]
    ds_read_b64_tr_b16 v[98:99], v42 offset:512
    v_mfma_f32_16x16x32_bf16 v[180:183], v[140:143], v[124:127], v[180:183]
    ds_read_b128 v[84:87], v26 offset:2048
    v_mfma_f32_16x16x32_bf16 v[176:179], v[140:143], v[120:123], v[176:179]
    ds_read_b128 v[88:91], v26 offset:4096
    v_mfma_f32_16x16x32_bf16 v[192:195], v[144:147], v[120:123], v[192:195]
    ds_read_b128 v[92:95], v26 offset:6144
    v_mfma_f32_16x16x32_bf16 v[196:199], v[144:147], v[124:127], v[196:199]
    ds_read_b64_tr_b16 v[100:101], v43 offset:0
    v_mfma_f32_16x16x32_bf16 v[200:203], v[144:147], v[128:131], v[200:203]
    ds_read_b64_tr_b16 v[102:103], v43 offset:512
    v_mfma_f32_16x16x32_bf16 v[204:207], v[144:147], v[132:135], v[204:207]
    ds_read_b64_tr_b16 v[104:105], v42 offset:8192
    v_mfma_f32_16x16x32_bf16 v[220:223], v[148:151], v[132:135], v[220:223]
    ds_read_b64_tr_b16 v[106:107], v42 offset:8704
    v_mfma_f32_16x16x32_bf16 v[216:219], v[148:151], v[128:131], v[216:219]
    ds_read_b64_tr_b16 v[108:109], v43 offset:8192
    v_mfma_f32_16x16x32_bf16 v[212:215], v[148:151], v[124:127], v[212:215]
    ds_read_b64_tr_b16 v[110:111], v43 offset:8704
    v_mfma_f32_16x16x32_bf16 v[208:211], v[148:151], v[120:123], v[208:211]
    ds_read_b64_tr_b16 v[112:113], v42 offset:16384
    v_mfma_f32_16x16x32_bf16 v[224:227], v[120:123], v[152:155], v[224:227]
    ds_read_b64_tr_b16 v[114:115], v42 offset:16896
    v_mfma_f32_16x16x32_bf16 v[228:231], v[124:127], v[152:155], v[228:231]
    ds_read_b64_tr_b16 v[116:117], v43 offset:16384
    v_mfma_f32_16x16x32_bf16 v[232:235], v[128:131], v[152:155], v[232:235]
    ds_read_b64_tr_b16 v[118:119], v43 offset:16896
    v_mfma_f32_16x16x32_bf16 v[236:239], v[132:135], v[152:155], v[236:239]
    v_mfma_f32_16x16x32_bf16 v[252:255], v[132:135], v[156:159], v[252:255]
    v_mfma_f32_16x16x32_bf16 v[248:251], v[128:131], v[156:159], v[248:251]
    v_mfma_f32_16x16x32_bf16 v[244:247], v[124:127], v[156:159], v[244:247]
    v_mfma_f32_16x16x32_bf16 v[240:243], v[120:123], v[156:159], v[240:243]
    s_waitcnt lgkmcnt(10)
    v_mfma_f32_16x16x32_bf16 v[160:163], v[96:99], v[80:83], v[160:163]
    ds_read_b128 v[120:123], v27 offset:0
    v_mfma_f32_16x16x32_bf16 v[164:167], v[96:99], v[84:87], v[164:167]
    ds_read_b64_tr_b16 v[136:137], v42 offset:4096
    v_mfma_f32_16x16x32_bf16 v[168:171], v[96:99], v[88:91], v[168:171]
    ds_read_b64_tr_b16 v[138:139], v42 offset:4608
    v_mfma_f32_16x16x32_bf16 v[172:175], v[96:99], v[92:95], v[172:175]
    s_waitcnt lgkmcnt(11)
    v_mfma_f32_16x16x32_bf16 v[188:191], v[100:103], v[92:95], v[188:191]
    ds_read_b128 v[124:127], v27 offset:2048
    v_mfma_f32_16x16x32_bf16 v[184:187], v[100:103], v[88:91], v[184:187]
    ds_read_b128 v[128:131], v27 offset:4096
    v_mfma_f32_16x16x32_bf16 v[180:183], v[100:103], v[84:87], v[180:183]
    ds_read_b128 v[132:135], v27 offset:6144
    v_mfma_f32_16x16x32_bf16 v[176:179], v[100:103], v[80:83], v[176:179]
    s_waitcnt lgkmcnt(12)
    v_mfma_f32_16x16x32_bf16 v[192:195], v[104:107], v[80:83], v[192:195]
    ds_read_b64_tr_b16 v[140:141], v43 offset:4096
    v_mfma_f32_16x16x32_bf16 v[196:199], v[104:107], v[84:87], v[196:199]
    ds_read_b64_tr_b16 v[142:143], v43 offset:4608
    v_mfma_f32_16x16x32_bf16 v[200:203], v[104:107], v[88:91], v[200:203]
    ds_read_b64_tr_b16 v[144:145], v42 offset:12288
    v_mfma_f32_16x16x32_bf16 v[204:207], v[104:107], v[92:95], v[204:207]
    s_waitcnt lgkmcnt(13)
    v_mfma_f32_16x16x32_bf16 v[220:223], v[108:111], v[92:95], v[220:223]
    ds_read_b64_tr_b16 v[146:147], v42 offset:12800
    v_mfma_f32_16x16x32_bf16 v[216:219], v[108:111], v[88:91], v[216:219]
    ds_read_b64_tr_b16 v[148:149], v43 offset:12288
    v_mfma_f32_16x16x32_bf16 v[212:215], v[108:111], v[84:87], v[212:215]
    ds_read_b64_tr_b16 v[150:151], v43 offset:12800
    v_mfma_f32_16x16x32_bf16 v[208:211], v[108:111], v[80:83], v[208:211]
    s_waitcnt lgkmcnt(14)
    v_mfma_f32_16x16x32_bf16 v[224:227], v[80:83], v[112:115], v[224:227]
    ds_read_b64_tr_b16 v[152:153], v42 offset:20480
    v_mfma_f32_16x16x32_bf16 v[228:231], v[84:87], v[112:115], v[228:231]
    ds_read_b64_tr_b16 v[154:155], v42 offset:20992
    v_mfma_f32_16x16x32_bf16 v[232:235], v[88:91], v[112:115], v[232:235]
    ds_read_b64_tr_b16 v[156:157], v43 offset:20480
    v_mfma_f32_16x16x32_bf16 v[236:239], v[92:95], v[112:115], v[236:239]
    s_waitcnt lgkmcnt(15)
    v_mfma_f32_16x16x32_bf16 v[252:255], v[92:95], v[116:119], v[252:255]
    ds_read_b64_tr_b16 v[158:159], v43 offset:20992
    v_mfma_f32_16x16x32_bf16 v[248:251], v[88:91], v[116:119], v[248:251]
    v_mfma_f32_16x16x32_bf16 v[244:247], v[84:87], v[116:119], v[244:247]
    v_mfma_f32_16x16x32_bf16 v[240:243], v[80:83], v[116:119], v[240:243]
    s_waitcnt lgkmcnt(10)
    v_mfma_f32_16x16x32_bf16 v[160:163], v[136:139], v[120:123], v[160:163]
    v_mfma_f32_16x16x32_bf16 v[164:167], v[136:139], v[124:127], v[164:167]
    v_mfma_f32_16x16x32_bf16 v[168:171], v[136:139], v[128:131], v[168:171]
    v_mfma_f32_16x16x32_bf16 v[172:175], v[136:139], v[132:135], v[172:175]
    s_waitcnt lgkmcnt(0)
    s_barrier
    ds_read_b128 v[80:83], v20 offset:0
    v_mfma_f32_16x16x32_bf16 v[188:191], v[140:143], v[132:135], v[188:191]
    ds_read_b64_tr_b16 v[96:97], v36 offset:0
    v_mfma_f32_16x16x32_bf16 v[184:187], v[140:143], v[128:131], v[184:187]
    ds_read_b64_tr_b16 v[98:99], v36 offset:512
    v_mfma_f32_16x16x32_bf16 v[180:183], v[140:143], v[124:127], v[180:183]
    ds_read_b128 v[84:87], v20 offset:2048
    v_mfma_f32_16x16x32_bf16 v[176:179], v[140:143], v[120:123], v[176:179]
    ds_read_b128 v[88:91], v20 offset:4096
    v_mfma_f32_16x16x32_bf16 v[192:195], v[144:147], v[120:123], v[192:195]
    ds_read_b128 v[92:95], v20 offset:6144
    v_mfma_f32_16x16x32_bf16 v[196:199], v[144:147], v[124:127], v[196:199]
    ds_read_b64_tr_b16 v[100:101], v37 offset:0
    v_mfma_f32_16x16x32_bf16 v[200:203], v[144:147], v[128:131], v[200:203]
    ds_read_b64_tr_b16 v[102:103], v37 offset:512
    v_mfma_f32_16x16x32_bf16 v[204:207], v[144:147], v[132:135], v[204:207]
    ds_read_b64_tr_b16 v[104:105], v36 offset:8192
    v_mfma_f32_16x16x32_bf16 v[220:223], v[148:151], v[132:135], v[220:223]
    ds_read_b64_tr_b16 v[106:107], v36 offset:8704
    v_mfma_f32_16x16x32_bf16 v[216:219], v[148:151], v[128:131], v[216:219]
    ds_read_b64_tr_b16 v[108:109], v37 offset:8192
    v_mfma_f32_16x16x32_bf16 v[212:215], v[148:151], v[124:127], v[212:215]
    ds_read_b64_tr_b16 v[110:111], v37 offset:8704
    v_mfma_f32_16x16x32_bf16 v[208:211], v[148:151], v[120:123], v[208:211]
    ds_read_b64_tr_b16 v[112:113], v36 offset:16384
    v_mfma_f32_16x16x32_bf16 v[224:227], v[120:123], v[152:155], v[224:227]
    ds_read_b64_tr_b16 v[114:115], v36 offset:16896
    v_mfma_f32_16x16x32_bf16 v[228:231], v[124:127], v[152:155], v[228:231]
    ds_read_b64_tr_b16 v[116:117], v37 offset:16384
    v_mfma_f32_16x16x32_bf16 v[232:235], v[128:131], v[152:155], v[232:235]
    ds_read_b64_tr_b16 v[118:119], v37 offset:16896
    v_mfma_f32_16x16x32_bf16 v[236:239], v[132:135], v[152:155], v[236:239]
    v_mfma_f32_16x16x32_bf16 v[252:255], v[132:135], v[156:159], v[252:255]
    v_mfma_f32_16x16x32_bf16 v[248:251], v[128:131], v[156:159], v[248:251]
    v_mfma_f32_16x16x32_bf16 v[244:247], v[124:127], v[156:159], v[244:247]
    v_mfma_f32_16x16x32_bf16 v[240:243], v[120:123], v[156:159], v[240:243]
    s_add_u32 s66, s66, 1
    s_branch L_loop
L_mid:
    s_waitcnt vmcnt(0)
    buffer_load_dword v14, v13, s[36:39], 0 offen offset:4 sc1
    s_mov_b64 exec, 15
    s_mov_b64 exec, 1
    s_mov_b64 exec, -1
    v_mfma_f32_16x16x16_bf16 v[68:71], v[60:61], v[52:53], 0
    v_mfma_f32_16x16x16_bf16 v[72:75], v[62:63], v[52:53], 0
    v_mfma_f32_16x16x16_bf16 v[28:31], v[64:65], v[52:53], 0
    v_mfma_f32_16x16x16_bf16 v[32:35], v[66:67], v[52:53], 0
    s_nop 4
    v_cvt_pk_bf16_f32 v44, v68, v69
    v_cvt_pk_bf16_f32 v45, v70, v71
    v_cvt_pk_bf16_f32 v46, v28, v29
    v_cvt_pk_bf16_f32 v47, v30, v31
    v_cvt_pk_bf16_f32 v48, v72, v73
    v_cvt_pk_bf16_f32 v49, v74, v75
    v_cvt_pk_bf16_f32 v50, v32, v33
    v_cvt_pk_bf16_f32 v51, v34, v35
    s_branch L_midret
L_last:
    s_mov_b64 exec, 1
    ds_write_b32 v1, v18 offset:144
    s_mov_b64 exec, -1
    s_waitcnt vmcnt(0)
    v_readfirstlane_b32 s78, v14
    ds_read_b128 v[80:83], v26 offset:0
    ds_read_b64_tr_b16 v[104:105], v42 offset:8192
    ds_read_b64_tr_b16 v[106:107], v42 offset:8704
    ds_read_b128 v[84:87], v26 offset:2048
    ds_read_b128 v[88:91], v26 offset:4096
    ds_read_b128 v[92:95], v26 offset:6144
    ds_read_b64_tr_b16 v[108:109], v43 offset:8192
    ds_read_b64_tr_b16 v[110:111], v43 offset:8704
    ds_read_b128 v[60:63], v27 offset:0
    ds_read_b64_tr_b16 v[96:97], v42 offset:12288
    ds_read_b64_tr_b16 v[98:99], v42 offset:12800
    ds_read_b128 v[64:67], v27 offset:2048
    ds_read_b128 v[68:71], v27 offset:4096
    ds_read_b128 v[72:75], v27 offset:6144
    ds_read_b64_tr_b16 v[100:101], v43 offset:12288
    ds_read_b64_tr_b16 v[102:103], v43 offset:12800
    v_mfma_f32_16x16x32_bf16 v[192:195], v[144:147], v[120:123], v[192:195]
    v_mfma_f32_16x16x32_bf16 v[196:199], v[144:147], v[124:127], v[196:199]
    v_mfma_f32_16x16x32_bf16 v[200:203], v[144:147], v[128:131], v[200:203]
    v_mfma_f32_16x16x32_bf16 v[204:207], v[144:147], v[132:135], v[204:207]
    s_waitcnt lgkmcnt(8)
    ds_read_b64_tr_b16 v[112:113], v42 offset:16384
    ds_read_b64_tr_b16 v[114:115], v42 offset:16896
    ds_read_b64_tr_b16 v[116:117], v43 offset:16384
    ds_read_b64_tr_b16 v[118:119], v43 offset:16896
    v_mfma_f32_16x16x32_bf16 v[220:223], v[148:151], v[132:135], v[220:223]
    ds_read_b64_tr_b16 v[28:29], v42 offset:20480
    ds_read_b64_tr_b16 v[30:31], v42 offset:20992
    v_mfma_f32_16x16x32_bf16 v[216:219], v[148:151], v[128:131], v[216:219]
    ds_read_b64_tr_b16 v[32:33], v43 offset:20480
    ds_read_b64_tr_b16 v[34:35], v43 offset:20992
    v_mfma_f32_16x16x32_bf16 v[212:215], v[148:151], v[124:127], v[212:215]
    s_waitcnt lgkmcnt(8)
    v_mfma_f32_16x16x32_bf16 v[208:211], v[148:151], v[120:123], v[208:211]
    v_mfma_f32_16x16x32_bf16 v[192:195], v[104:107], v[80:83], v[192:195]
    v_mfma_f32_16x16x32_bf16 v[196:199], v[104:107], v[84:87], v[196:199]
    v_mfma_f32_16x16x32_bf16 v[200:203], v[104:107], v[88:91], v[200:203]
    v_mfma_f32_16x16x32_bf16 v[204:207], v[104:107], v[92:95], v[204:207]
    v_mfma_f32_16x16x32_bf16 v[220:223], v[108:111], v[92:95], v[220:223]
    s_waitcnt lgkmcnt(0)
    v_mfma_f32_16x16x32_bf16 v[216:219], v[108:111], v[88:91], v[216:219]
    v_mfma_f32_16x16x32_bf16 v[212:215], v[108:111], v[84:87], v[212:215]
    v_mfma_f32_16x16x32_bf16 v[208:211], v[108:111], v[80:83], v[208:211]
    v_mfma_f32_16x16x32_bf16 v[192:195], v[96:99], v[60:63], v[192:195]
    v_mfma_f32_16x16x32_bf16 v[196:199], v[96:99], v[64:67], v[196:199]
    v_mfma_f32_16x16x32_bf16 v[200:203], v[96:99], v[68:71], v[200:203]
    s_nop 5
    v_cvt_pk_bf16_f32 v192, v192, v193
    v_cvt_pk_bf16_f32 v193, v194, v195
    v_mfma_f32_16x16x32_bf16 v[204:207], v[96:99], v[72:75], v[204:207]
    v_cvt_pk_bf16_f32 v196, v196, v197
    v_cvt_pk_bf16_f32 v197, v198, v199
    v_mfma_f32_16x16x32_bf16 v[220:223], v[100:103], v[72:75], v[220:223]
    v_cvt_pk_bf16_f32 v200, v200, v201
    v_cvt_pk_bf16_f32 v201, v202, v203
    v_mfma_f32_16x16x32_bf16 v[216:219], v[100:103], v[68:71], v[216:219]
    s_nop 1
    v_cvt_pk_bf16_f32 v204, v204, v205
    v_cvt_pk_bf16_f32 v205, v206, v207
    v_mfma_f32_16x16x32_bf16 v[212:215], v[100:103], v[64:67], v[212:215]
    v_cvt_pk_bf16_f32 v206, v220, v221
    v_cvt_pk_bf16_f32 v207, v222, v223
    v_mfma_f32_16x16x32_bf16 v[208:211], v[100:103], v[60:63], v[208:211]
    v_cvt_pk_bf16_f32 v202, v216, v217
    v_cvt_pk_bf16_f32 v203, v218, v219
    v_mfma_f32_16x16x32_bf16 v[188:191], v[140:143], v[132:135], v[188:191]
    s_nop 1
    v_cvt_pk_bf16_f32 v198, v212, v213
    v_cvt_pk_bf16_f32 v199, v214, v215
    v_mfma_f32_16x16x32_bf16 v[184:187], v[140:143], v[128:131], v[184:187]
    v_cvt_pk_bf16_f32 v194, v208, v209
    v_cvt_pk_bf16_f32 v195, v210, v211
    v_mfma_f32_16x16x32_bf16 v[180:183], v[140:143], v[124:127], v[180:183]
    v_mfma_f32_16x16x32_bf16 v[176:179], v[140:143], v[120:123], v[176:179]
    v_mfma_f32_16x16x32_bf16 v[96:99], v[44:47], v[192:195], 0
    v_mfma_f32_16x16x32_bf16 v[104:107], v[44:47], v[196:199], 0
    v_mfma_f32_16x16x32_bf16 v[144:147], v[44:47], v[200:203], 0
    s_nop 5
    v_cvt_pk_bf16_f32 v208, v96, v97
    v_cvt_pk_bf16_f32 v209, v98, v99
    v_mfma_f32_16x16x32_bf16 v[136:139], v[44:47], v[204:207], 0
    v_cvt_pk_bf16_f32 v212, v104, v105
    v_cvt_pk_bf16_f32 v213, v106, v107
    v_mfma_f32_16x16x32_bf16 v[100:103], v[48:51], v[192:195], 0
    v_cvt_pk_bf16_f32 v216, v144, v145
    v_cvt_pk_bf16_f32 v217, v146, v147
    v_mfma_f32_16x16x32_bf16 v[108:111], v[48:51], v[196:199], 0
    s_nop 1
    v_cvt_pk_bf16_f32 v220, v136, v137
    v_cvt_pk_bf16_f32 v221, v138, v139
    v_mfma_f32_16x16x32_bf16 v[148:151], v[48:51], v[200:203], 0
    v_cvt_pk_bf16_f32 v210, v100, v101
    v_cvt_pk_bf16_f32 v211, v102, v103
    v_mfma_f32_16x16x32_bf16 v[140:143], v[48:51], v[204:207], 0
    v_cvt_pk_bf16_f32 v214, v108, v109
    v_cvt_pk_bf16_f32 v215, v110, v111
    v_lshlrev_b32 v96, 16, v208
    v_and_b32 v97, 0xffff0000, v208
    s_nop 0
    v_cvt_pk_bf16_f32 v218, v148, v149
    v_cvt_pk_bf16_f32 v219, v150, v151
    v_lshlrev_b32 v98, 16, v209
    v_lshlrev_b32 v104, 16, v212
    v_cvt_pk_bf16_f32 v222, v140, v141
    v_cvt_pk_bf16_f32 v223, v142, v143
    v_and_b32 v105, 0xffff0000, v212
    v_lshlrev_b32 v106, 16, v213
    v_lshlrev_b32 v144, 16, v216
    v_and_b32 v145, 0xffff0000, v216
    v_lshlrev_b32 v146, 16, v217
    v_lshlrev_b32 v136, 16, v220
    v_and_b32 v137, 0xffff0000, v220
    v_lshlrev_b32 v138, 16, v221
    v_and_b32 v99, 0xffff0000, v209
    v_lshlrev_b32 v100, 16, v210
    v_and_b32 v101, 0xffff0000, v210
    v_lshlrev_b32 v102, 16, v211
    v_and_b32 v103, 0xffff0000, v211
    v_and_b32 v107, 0xffff0000, v213
    v_lshlrev_b32 v108, 16, v214
    v_and_b32 v109, 0xffff0000, v214
    v_lshlrev_b32 v110, 16, v215
    v_and_b32 v111, 0xffff0000, v215
    v_and_b32 v147, 0xffff0000, v217
    v_lshlrev_b32 v148, 16, v218
    v_and_b32 v149, 0xffff0000, v218
    v_lshlrev_b32 v150, 16, v219
    v_and_b32 v151, 0xffff0000, v219
    v_and_b32 v139, 0xffff0000, v221
    v_lshlrev_b32 v140, 16, v222
    v_and_b32 v141, 0xffff0000, v222
    v_lshlrev_b32 v142, 16, v223
    v_and_b32 v143, 0xffff0000, v223
    v_max3_f32 v192, v96, v97, v98
    v_min3_f32 v196, v96, v97, v98
    v_max3_f32 v193, v104, v105, v106
    v_min3_f32 v197, v104, v105, v106
    v_max3_f32 v194, v144, v145, v146
    v_min3_f32 v198, v144, v145, v146
    v_max3_f32 v195, v136, v137, v138
    v_min3_f32 v199, v136, v137, v138
    v_max3_f32 v208, v99, v100, v101
    v_max3_f32 v192, v192, v102, v103
    v_min3_f32 v209, v99, v100, v101
    v_min3_f32 v196, v196, v102, v103
    v_max3_f32 v210, v107, v108, v109
    v_max3_f32 v193, v193, v110, v111
    v_min3_f32 v211, v107, v108, v109
    v_min3_f32 v197, v197, v110, v111
    v_max3_f32 v212, v147, v148, v149
    v_max3_f32 v194, v194, v150, v151
    v_min3_f32 v213, v147, v148, v149
    v_min3_f32 v198, v198, v150, v151
    v_max3_f32 v214, v139, v140, v141
    v_max3_f32 v195, v195, v142, v143
    v_min3_f32 v215, v139, v140, v141
    v_min3_f32 v199, v199, v142, v143
    v_max_f32 v192, v192, v208
    v_min_f32 v196, v196, v209
    v_max_f32 v193, v193, v210
    v_min_f32 v197, v197, v211
    v_max_f32 v194, v194, v212
    v_min_f32 v198, v198, v213
    v_max_f32 v195, v195, v214
    v_min_f32 v199, v199, v215
    v_permlane32_swap_b32 v192, v194
    v_permlane32_swap_b32 v193, v195
    v_permlane32_swap_b32 v196, v198
    v_permlane32_swap_b32 v197, v199
    v_max_f32 v192, v192, v194
    v_max_f32 v193, v193, v195
    v_min_f32 v196, v196, v198
    v_min_f32 v197, v197, v199
    v_permlane16_swap_b32 v192, v193
    v_mfma_f32_16x16x32_bf16 v[224:227], v[120:123], v[152:155], v[224:227]
    v_permlane16_swap_b32 v196, v197
    v_max_f32 v192, v192, v193
    v_min_f32 v196, v196, v197
    v_mfma_f32_16x16x32_bf16 v[232:235], v[128:131], v[152:155], v[232:235]
    v_cndmask_b32 v200, v196, v192, s[72:73]
    v_cndmask_b32 v204, v192, v196, s[72:73]
    v_mfma_f32_16x16x32_bf16 v[248:251], v[128:131], v[156:159], v[248:251]
    v_mul_f32 v200, s70, v200
    v_mul_f32 v204, s68, v204
    v_mfma_f32_16x16x32_bf16 v[240:243], v[120:123], v[156:159], v[240:243]
    v_mov_b32 v201, v200
    v_mov_b32 v205, v204
    v_mfma_f32_16x16x32_bf16 v[228:231], v[124:127], v[152:155], v[228:231]
    v_permlane16_swap_b32 v200, v201
    v_permlane16_swap_b32 v204, v205
    v_mfma_f32_16x16x32_bf16 v[236:239], v[132:135], v[152:155], v[236:239]
    v_mov_b32 v202, v200
    v_mov_b32 v203, v201
    v_mfma_f32_16x16x32_bf16 v[252:255], v[132:135], v[156:159], v[252:255]
    v_permlane32_swap_b32 v200, v202
    v_permlane32_swap_b32 v201, v203
    v_mfma_f32_16x16x32_bf16 v[244:247], v[124:127], v[156:159], v[244:247]
    v_mov_b32 v206, v204
    v_mov_b32 v207, v205
    v_mfma_f32_16x16x32_bf16 v[224:227], v[80:83], v[112:115], v[224:227]
    v_permlane32_swap_b32 v204, v206
    v_permlane32_swap_b32 v205, v207
    v_mfma_f32_16x16x32_bf16 v[232:235], v[88:91], v[112:115], v[232:235]
    v_mfma_f32_16x16x32_bf16 v[248:251], v[88:91], v[116:119], v[248:251]
    v_mfma_f32_16x16x32_bf16 v[240:243], v[80:83], v[116:119], v[240:243]
    v_pk_fma_f32 v[88:89], v[104:105], s[68:69], v[200:201] op_sel:[0,0,1] op_sel_hi:[1,0,1]
    v_pk_fma_f32 v[90:91], v[106:107], s[68:69], v[200:201] op_sel:[0,0,1] op_sel_hi:[1,0,1]
    v_mfma_f32_16x16x32_bf16 v[228:231], v[84:87], v[112:115], v[228:231]
    v_pk_fma_f32 v[80:81], v[96:97], s[68:69], v[200:201] op_sel_hi:[1,0,0]
    v_pk_fma_f32 v[82:83], v[98:99], s[68:69], v[200:201] op_sel_hi:[1,0,0]
    v_mfma_f32_16x16x32_bf16 v[236:239], v[92:95], v[112:115], v[236:239]
    v_exp_f32 v80, v80
    v_mfma_f32_16x16x32_bf16 v[252:255], v[92:95], v[116:119], v[252:255]
    v_exp_f32 v81, v81
    v_mfma_f32_16x16x32_bf16 v[244:247], v[84:87], v[116:119], v[244:247]
    v_pk_fma_f32 v[92:93], v[108:109], s[68:69], v[200:201] op_sel:[0,0,1] op_sel_hi:[1,0,1]
    v_exp_f32 v82, v82
    v_mfma_f32_16x16x32_bf16 v[224:227], v[60:63], v[28:31], v[224:227]
    v_pk_fma_f32 v[84:85], v[100:101], s[68:69], v[200:201] op_sel_hi:[1,0,0]
    v_exp_f32 v83, v83
    v_mfma_f32_16x16x32_bf16 v[232:235], v[68:71], v[28:31], v[232:235]
    v_exp_f32 v88, v88
    v_mfma_f32_16x16x32_bf16 v[248:251], v[68:71], v[32:35], v[248:251]
    v_exp_f32 v89, v89
    v_mfma_f32_16x16x32_bf16 v[240:243], v[60:63], v[32:35], v[240:243]
    v_pk_fma_f32 v[68:69], v[136:137], s[68:69], v[202:203] op_sel:[0,0,1] op_sel_hi:[1,0,1]
    v_pk_fma_f32 v[70:71], v[138:139], s[68:69], v[202:203] op_sel:[0,0,1] op_sel_hi:[1,0,1]
    v_mfma_f32_16x16x32_bf16 v[228:231], v[64:67], v[28:31], v[228:231]
    v_pk_fma_f32 v[60:61], v[144:145], s[68:69], v[202:203] op_sel_hi:[1,0,0]
    v_pk_fma_f32 v[62:63], v[146:147], s[68:69], v[202:203] op_sel_hi:[1,0,0]
    v_mfma_f32_16x16x32_bf16 v[236:239], v[72:75], v[28:31], v[236:239]
    v_exp_f32 v90, v90
    v_mfma_f32_16x16x32_bf16 v[252:255], v[72:75], v[32:35], v[252:255]
    v_exp_f32 v91, v91
    v_mfma_f32_16x16x32_bf16 v[244:247], v[64:67], v[32:35], v[244:247]
    v_pk_fma_f32 v[72:73], v[140:141], s[68:69], v[202:203] op_sel:[0,0,1] op_sel_hi:[1,0,1]
    v_exp_f32 v60, v60
    v_pk_fma_f32 v[64:65], v[148:149], s[68:69], v[202:203] op_sel_hi:[1,0,0]
    v_exp_f32 v61, v61
    v_exp_f32 v62, v62
    v_exp_f32 v63, v63
    v_exp_f32 v68, v68
    v_exp_f32 v69, v69
    v_exp_f32 v70, v70
    v_exp_f32 v71, v71
    v_pk_fma_f32 v[86:87], v[102:103], s[68:69], v[200:201] op_sel_hi:[1,0,0]
    v_pk_fma_f32 v[94:95], v[110:111], s[68:69], v[200:201] op_sel:[0,0,1] op_sel_hi:[1,0,1]
    v_pk_fma_f32 v[66:67], v[150:151], s[68:69], v[202:203] op_sel_hi:[1,0,0]
    v_pk_fma_f32 v[74:75], v[142:143], s[68:69], v[202:203] op_sel:[0,0,1] op_sel_hi:[1,0,1]
    v_exp_f32 v84, v84
    v_exp_f32 v85, v85
    v_exp_f32 v92, v92
    v_exp_f32 v93, v93
    v_exp_f32 v64, v64
    v_exp_f32 v65, v65
    v_exp_f32 v72, v72
    v_exp_f32 v73, v73
    v_pk_add_f32 v[208:209], v[80:81], v[82:83]
    v_pk_add_f32 v[210:211], v[88:89], v[90:91]
    v_pk_add_f32 v[212:213], v[60:61], v[62:63]
    v_pk_add_f32 v[214:215], v[68:69], v[70:71]
    v_exp_f32 v86, v86
    v_exp_f32 v87, v87
    v_exp_f32 v94, v94
    v_exp_f32 v95, v95
    v_exp_f32 v66, v66
    v_exp_f32 v67, v67
    v_exp_f32 v74, v74
    v_exp_f32 v75, v75
    v_pk_add_f32 v[208:209], v[208:209], v[84:85]
    v_pk_add_f32 v[210:211], v[210:211], v[92:93]
    v_pk_add_f32 v[212:213], v[212:213], v[64:65]
    v_pk_add_f32 v[214:215], v[214:215], v[72:73]
    v_pk_add_f32 v[208:209], v[208:209], v[86:87]
    v_pk_add_f32 v[210:211], v[210:211], v[94:95]
    v_pk_add_f32 v[212:213], v[212:213], v[66:67]
    v_pk_add_f32 v[214:215], v[214:215], v[74:75]
    v_add_f32 v192, v208, v209
    v_add_f32 v193, v210, v211
    v_add_f32 v194, v212, v213
    v_add_f32 v195, v214, v215
    v_pk_fma_f32 v[96:97], v[96:97], s[70:71], v[204:205] op_sel_hi:[1,0,0]
    v_permlane32_swap_b32 v192, v194
    v_permlane32_swap_b32 v193, v195
    v_add_f32 v192, v192, v194
    v_add_f32 v193, v193, v195
    v_pk_fma_f32 v[98:99], v[98:99], s[70:71], v[204:205] op_sel_hi:[1,0,0]
    v_pk_fma_f32 v[104:105], v[104:105], s[70:71], v[204:205] op_sel:[0,0,1] op_sel_hi:[1,0,1]
    v_permlane16_swap_b32 v192, v193
    v_pk_fma_f32 v[106:107], v[106:107], s[70:71], v[204:205] op_sel:[0,0,1] op_sel_hi:[1,0,1]
    v_add_f32 v192, v192, v193
    v_pk_fma_f32 v[144:145], v[144:145], s[70:71], v[206:207] op_sel_hi:[1,0,0]
    v_rcp_f32 v192, v192
    v_pk_fma_f32 v[146:147], v[146:147], s[70:71], v[206:207] op_sel_hi:[1,0,0]
    v_mov_b32 v193, v192
    v_pk_fma_f32 v[136:137], v[136:137], s[70:71], v[206:207] op_sel:[0,0,1] op_sel_hi:[1,0,1]
    v_pk_fma_f32 v[138:139], v[138:139], s[70:71], v[206:207] op_sel:[0,0,1] op_sel_hi:[1,0,1]
    v_permlane16_swap_b32 v192, v193
    v_pk_fma_f32 v[100:101], v[100:101], s[70:71], v[204:205] op_sel_hi:[1,0,0]
    v_mov_b32 v194, v192
    v_mov_b32 v195, v193
    v_pk_fma_f32 v[108:109], v[108:109], s[70:71], v[204:205] op_sel:[0,0,1] op_sel_hi:[1,0,1]
    v_permlane32_swap_b32 v192, v194
    v_permlane32_swap_b32 v193, v195
    v_pk_fma_f32 v[148:149], v[148:149], s[70:71], v[206:207] op_sel_hi:[1,0,0]
    v_pk_mul_f32 v[80:81], v[80:81], v[192:193] op_sel_hi:[1,0]
    v_pk_mul_f32 v[88:89], v[88:89], v[192:193] op_sel:[0,1] op_sel_hi:[1,1]
    v_pk_mul_f32 v[60:61], v[60:61], v[194:195] op_sel_hi:[1,0]
    v_pk_mul_f32 v[68:69], v[68:69], v[194:195] op_sel:[0,1] op_sel_hi:[1,1]
    v_pk_mul_f32 v[82:83], v[82:83], v[192:193] op_sel_hi:[1,0]
    v_pk_mul_f32 v[90:91], v[90:91], v[192:193] op_sel:[0,1] op_sel_hi:[1,1]
    v_pk_mul_f32 v[62:63], v[62:63], v[194:195] op_sel_hi:[1,0]
    v_pk_mul_f32 v[70:71], v[70:71], v[194:195] op_sel:[0,1] op_sel_hi:[1,1]
    v_pk_mul_f32 v[84:85], v[84:85], v[192:193] op_sel_hi:[1,0]
    v_pk_mul_f32 v[86:87], v[86:87], v[192:193] op_sel_hi:[1,0]
    v_cvt_pk_bf16_f32 v80, v80, v81
    v_pk_mul_f32 v[92:93], v[92:93], v[192:193] op_sel:[0,1] op_sel_hi:[1,1]
    v_pk_mul_f32 v[94:95], v[94:95], v[192:193] op_sel:[0,1] op_sel_hi:[1,1]
    v_cvt_pk_bf16_f32 v88, v88, v89
    v_pk_mul_f32 v[64:65], v[64:65], v[194:195] op_sel_hi:[1,0]
    v_pk_mul_f32 v[66:67], v[66:67], v[194:195] op_sel_hi:[1,0]
    v_cvt_pk_bf16_f32 v60, v60, v61
    v_pk_mul_f32 v[72:73], v[72:73], v[194:195] op_sel:[0,1] op_sel_hi:[1,1]
    v_pk_mul_f32 v[74:75], v[74:75], v[194:195] op_sel:[0,1] op_sel_hi:[1,1]
    v_cvt_pk_bf16_f32 v68, v68, v69
    v_cvt_pk_bf16_f32 v81, v82, v83
    v_cvt_pk_bf16_f32 v89, v90, v91
    v_cvt_pk_bf16_f32 v61, v62, v63
    v_cvt_pk_bf16_f32 v69, v70, v71
    v_cvt_pk_bf16_f32 v82, v84, v85
    v_cvt_pk_bf16_f32 v83, v86, v87
    v_cvt_pk_bf16_f32 v90, v92, v93
    v_cvt_pk_bf16_f32 v91, v94, v95
    v_cvt_pk_bf16_f32 v62, v64, v65
    v_cvt_pk_bf16_f32 v63, v66, v67
    v_cvt_pk_bf16_f32 v70, v72, v73
    v_cvt_pk_bf16_f32 v71, v74, v75
    v_pk_fma_f32 v[140:141], v[140:141], s[70:71], v[206:207] op_sel:[0,0,1] op_sel_hi:[1,0,1]
    v_exp_f32 v96, v96
    v_exp_f32 v97, v97
    v_exp_f32 v98, v98
    v_exp_f32 v99, v99
    v_exp_f32 v104, v104
    v_exp_f32 v105, v105
    v_exp_f32 v106, v106
    v_exp_f32 v107, v107
    v_exp_f32 v144, v144
    v_exp_f32 v145, v145
    v_exp_f32 v146, v146
    v_exp_f32 v147, v147
    v_exp_f32 v136, v136
    v_exp_f32 v137, v137
    v_exp_f32 v138, v138
    v_exp_f32 v139, v139
    v_pk_fma_f32 v[102:103], v[102:103], s[70:71], v[204:205] op_sel_hi:[1,0,0]
    v_pk_fma_f32 v[110:111], v[110:111], s[70:71], v[204:205] op_sel:[0,0,1] op_sel_hi:[1,0,1]
    v_pk_fma_f32 v[150:151], v[150:151], s[70:71], v[206:207] op_sel_hi:[1,0,0]
    v_pk_fma_f32 v[142:143], v[142:143], s[70:71], v[206:207] op_sel:[0,0,1] op_sel_hi:[1,0,1]
    v_exp_f32 v100, v100
    v_exp_f32 v101, v101
    v_exp_f32 v108, v108
    v_exp_f32 v109, v109
    v_exp_f32 v148, v148
    v_exp_f32 v149, v149
    v_exp_f32 v140, v140
    v_exp_f32 v141, v141
    v_pk_add_f32 v[216:217], v[96:97], v[98:99]
    v_pk_add_f32 v[218:219], v[104:105], v[106:107]
    v_pk_add_f32 v[220:221], v[144:145], v[146:147]
    v_pk_add_f32 v[222:223], v[136:137], v[138:139]
    v_exp_f32 v102, v102
    v_exp_f32 v103, v103
    v_exp_f32 v110, v110
    v_exp_f32 v111, v111
    v_exp_f32 v150, v150
    v_exp_f32 v151, v151
    v_exp_f32 v142, v142
    v_exp_f32 v143, v143
    v_pk_add_f32 v[216:217], v[216:217], v[100:101]
    v_pk_add_f32 v[218:219], v[218:219], v[108:109]
    v_pk_add_f32 v[220:221], v[220:221], v[148:149]
    v_pk_add_f32 v[222:223], v[222:223], v[140:141]
    v_pk_add_f32 v[216:217], v[216:217], v[102:103]
    v_pk_add_f32 v[218:219], v[218:219], v[110:111]
    v_pk_add_f32 v[220:221], v[220:221], v[150:151]
    v_pk_add_f32 v[222:223], v[222:223], v[142:143]
    v_add_f32 v196, v216, v217
    v_add_f32 v197, v218, v219
    v_add_f32 v198, v220, v221
    v_add_f32 v199, v222, v223
    v_mfma_f32_16x16x16_bf16 v[120:123], v[80:81], v[52:53], 0
    v_permlane32_swap_b32 v196, v198
    v_permlane32_swap_b32 v197, v199
    v_add_f32 v196, v196, v198
    v_add_f32 v197, v197, v199
    v_mfma_f32_16x16x16_bf16 v[124:127], v[88:89], v[52:53], 0
    s_nop 0
    v_permlane16_swap_b32 v196, v197
    v_cvt_pk_bf16_f32 v224, v224, v225
    v_mfma_f32_16x16x16_bf16 v[128:131], v[60:61], v[52:53], 0
    v_add_f32 v196, v196, v197
    v_cvt_pk_bf16_f32 v120, v120, v121
    v_mfma_f32_16x16x16_bf16 v[132:135], v[68:69], v[52:53], 0
    v_rcp_f32 v196, v196
    v_mfma_f32_16x16x16_bf16 v[112:115], v[82:83], v[52:53], 0
    v_mov_b32 v197, v196
    v_cvt_pk_bf16_f32 v225, v226, v227
    v_mfma_f32_16x16x16_bf16 v[116:119], v[90:91], v[52:53], 0
    v_cvt_pk_bf16_f32 v121, v122, v123
    v_cvt_pk_bf16_f32 v226, v228, v229
    v_mfma_f32_16x16x16_bf16 v[152:155], v[62:63], v[52:53], 0
    v_cvt_pk_bf16_f32 v227, v230, v231
    v_cvt_pk_bf16_f32 v122, v124, v125
    v_mfma_f32_16x16x16_bf16 v[156:159], v[70:71], v[52:53], 0
    v_cvt_pk_bf16_f32 v123, v126, v127
    v_permlane16_swap_b32 v196, v197
    v_cvt_pk_bf16_f32 v240, v240, v241
    v_cvt_pk_bf16_f32 v232, v232, v233
    v_cvt_pk_bf16_f32 v241, v242, v243
    v_cvt_pk_bf16_f32 v128, v128, v129
    v_mov_b32 v198, v196
    v_mov_b32 v199, v197
    v_cvt_pk_bf16_f32 v233, v234, v235
    v_cvt_pk_bf16_f32 v242, v244, v245
    v_cvt_pk_bf16_f32 v243, v246, v247
    v_cvt_pk_bf16_f32 v129, v130, v131
    v_mfma_f32_16x16x32_bf16 v[228:231], v[120:123], v[224:227], 0
    v_cvt_pk_bf16_f32 v234, v236, v237
    v_cvt_pk_bf16_f32 v235, v238, v239
    v_cvt_pk_bf16_f32 v130, v132, v133
    v_cvt_pk_bf16_f32 v131, v134, v135
    v_cvt_pk_bf16_f32 v112, v112, v113
    v_cvt_pk_bf16_f32 v248, v248, v249
    v_cvt_pk_bf16_f32 v113, v114, v115
    v_permlane32_swap_b32 v196, v198
    v_permlane32_swap_b32 v197, v199
    v_cvt_pk_bf16_f32 v249, v250, v251
    v_cvt_pk_bf16_f32 v114, v116, v117
    v_cvt_pk_bf16_f32 v115, v118, v119
    v_mfma_f32_16x16x32_bf16 v[236:239], v[120:123], v[240:243], 0
    v_cvt_pk_bf16_f32 v250, v252, v253
    v_cvt_pk_bf16_f32 v251, v254, v255
    v_mfma_f32_16x16x32_bf16 v[228:231], v[128:131], v[232:235], v[228:231]
    v_pk_mul_f32 v[96:97], v[96:97], v[196:197] op_sel_hi:[1,0]
    v_cvt_pk_bf16_f32 v152, v152, v153
    v_pk_mul_f32 v[98:99], v[98:99], v[196:197] op_sel_hi:[1,0]
    v_cvt_pk_bf16_f32 v153, v154, v155
    v_mfma_f32_16x16x32_bf16 v[244:247], v[112:115], v[224:227], 0
    v_cvt_pk_bf16_f32 v96, v96, v97
    v_pk_mul_f32 v[104:105], v[104:105], v[196:197] op_sel:[0,1] op_sel_hi:[1,1]
    v_cvt_pk_bf16_f32 v154, v156, v157
    v_cvt_pk_bf16_f32 v155, v158, v159
    v_mfma_f32_16x16x32_bf16 v[236:239], v[128:131], v[248:251], v[236:239]
    v_cvt_pk_bf16_f32 v97, v98, v99
    v_pk_mul_f32 v[106:107], v[106:107], v[196:197] op_sel:[0,1] op_sel_hi:[1,1]
    v_cvt_pk_bf16_f32 v104, v104, v105
    v_pk_mul_f32 v[144:145], v[144:145], v[198:199] op_sel_hi:[1,0]
    v_mfma_f32_16x16x32_bf16 v[252:255], v[112:115], v[240:243], 0
    v_cvt_pk_bf16_f32 v105, v106, v107
    v_pk_mul_f32 v[146:147], v[146:147], v[198:199] op_sel_hi:[1,0]
    v_mfma_f32_16x16x32_bf16 v[244:247], v[152:155], v[232:235], v[244:247]
    v_cvt_pk_bf16_f32 v144, v144, v145
    v_pk_mul_f32 v[136:137], v[136:137], v[198:199] op_sel:[0,1] op_sel_hi:[1,1]
    v_mfma_f32_16x16x16_bf16 v[80:83], v[96:97], v[52:53], 0
    v_cvt_pk_bf16_f32 v145, v146, v147
    v_pk_mul_f32 v[138:139], v[138:139], v[198:199] op_sel:[0,1] op_sel_hi:[1,1]
    v_mfma_f32_16x16x32_bf16 v[76:79], v[120:123], v[56:59], 0
    v_cvt_pk_bf16_f32 v136, v136, v137
    v_cvt_pk_bf16_f32 v137, v138, v139
    v_mfma_f32_16x16x16_bf16 v[84:87], v[104:105], v[52:53], 0
    ds_write_b128 v4, v[228:231] offset:0
    v_mfma_f32_16x16x32_bf16 v[252:255], v[152:155], v[248:251], v[252:255]
    v_pk_mul_f32 v[100:101], v[100:101], v[196:197] op_sel_hi:[1,0]
    v_pk_mul_f32 v[102:103], v[102:103], v[196:197] op_sel_hi:[1,0]
    v_mfma_f32_16x16x16_bf16 v[88:91], v[144:145], v[52:53], 0
    ds_write_b128 v4, v[236:239] offset:1024
    v_mfma_f32_16x16x32_bf16 v[20:23], v[112:115], v[56:59], 0
    v_cvt_pk_bf16_f32 v98, v100, v101
    v_cvt_pk_bf16_f32 v99, v102, v103
    v_mfma_f32_16x16x32_bf16 v[76:79], v[128:131], v[56:59], v[76:79]
    v_pk_mul_f32 v[108:109], v[108:109], v[196:197] op_sel:[0,1] op_sel_hi:[1,1]
    v_pk_mul_f32 v[110:111], v[110:111], v[196:197] op_sel:[0,1] op_sel_hi:[1,1]
    v_mfma_f32_16x16x16_bf16 v[92:95], v[136:137], v[52:53], 0
    v_cvt_pk_bf16_f32 v106, v108, v109
    v_cvt_pk_bf16_f32 v107, v110, v111
    v_mfma_f32_16x16x32_bf16 v[20:23], v[152:155], v[56:59], v[20:23]
    v_pk_mul_f32 v[148:149], v[148:149], v[198:199] op_sel_hi:[1,0]
    v_pk_mul_f32 v[150:151], v[150:151], v[198:199] op_sel_hi:[1,0]
    ds_write_b128 v4, v[244:247] offset:2048
    v_mfma_f32_16x16x16_bf16 v[60:63], v[98:99], v[52:53], 0
    v_cvt_pk_bf16_f32 v80, v80, v81
    v_cvt_pk_bf16_f32 v146, v148, v149
    v_cvt_pk_bf16_f32 v147, v150, v151
    v_pk_mul_f32 v[140:141], v[140:141], v[198:199] op_sel:[0,1] op_sel_hi:[1,1]
    v_pk_mul_f32 v[142:143], v[142:143], v[198:199] op_sel:[0,1] op_sel_hi:[1,1]
    v_cvt_pk_bf16_f32 v81, v82, v83
    v_mfma_f32_16x16x16_bf16 v[64:67], v[106:107], v[52:53], 0
    v_cvt_pk_bf16_f32 v82, v84, v85
    v_cvt_pk_bf16_f32 v83, v86, v87
    ds_write_b128 v4, v[252:255] offset:3072
    v_cvt_pk_bf16_f32 v138, v140, v141
    v_cvt_pk_bf16_f32 v139, v142, v143
    v_mfma_f32_16x16x16_bf16 v[68:71], v[146:147], v[52:53], 0
    v_cvt_pk_bf16_f32 v88, v88, v89
    v_cvt_pk_bf16_f32 v89, v90, v91
    v_mfma_f32_16x16x32_bf16 v[192:195], v[80:83], v[224:227], 0
    ds_write_b128 v4, v[76:79] offset:4096
    v_mfma_f32_16x16x32_bf16 v[196:199], v[80:83], v[240:243], 0
    v_cvt_pk_bf16_f32 v90, v92, v93
    v_cvt_pk_bf16_f32 v91, v94, v95
    v_mfma_f32_16x16x32_bf16 v[208:211], v[80:83], v[56:59], 0
    ds_write_b128 v4, v[20:23] offset:5120
    v_mfma_f32_16x16x16_bf16 v[72:75], v[138:139], v[52:53], 0
    v_cvt_pk_bf16_f32 v60, v60, v61
    v_cvt_pk_bf16_f32 v61, v62, v63
    v_mfma_f32_16x16x32_bf16 v[192:195], v[88:91], v[232:235], v[192:195]
    ds_write_b32 v6, v18
    v_cvt_pk_bf16_f32 v62, v64, v65
    v_mfma_f32_16x16x32_bf16 v[196:199], v[88:91], v[248:251], v[196:199]
    v_cvt_pk_bf16_f32 v63, v66, v67
    v_cvt_pk_bf16_f32 v68, v68, v69
    v_mfma_f32_16x16x32_bf16 v[208:211], v[88:91], v[56:59], v[208:211]
    v_cvt_pk_bf16_f32 v69, v70, v71
    v_cvt_pk_bf16_f32 v70, v72, v73
    ds_read_b32 v19, v7
    ds_read_b128 v[36:39], v13 offset:240
    v_mfma_f32_16x16x32_bf16 v[200:203], v[60:63], v[224:227], 0
    ds_read_b128 v[120:123], v5 offset:0
    v_cvt_pk_bf16_f32 v71, v74, v75
    v_mfma_f32_16x16x32_bf16 v[204:207], v[60:63], v[240:243], 0
    ds_read_b128 v[124:127], v5 offset:1024
    ds_read_b128 v[128:131], v5 offset:2048
    v_mfma_f32_16x16x32_bf16 v[212:215], v[60:63], v[56:59], 0
    ds_read_b128 v[132:135], v5 offset:3072
    ds_read_b128 v[112:115], v5 offset:4096
    v_mfma_f32_16x16x32_bf16 v[200:203], v[68:71], v[232:235], v[200:203]
    ds_read_b128 v[116:119], v5 offset:5120
    v_mfma_f32_16x16x32_bf16 v[204:207], v[68:71], v[248:251], v[204:207]
    v_mfma_f32_16x16x32_bf16 v[212:215], v[68:71], v[56:59], v[212:215]
L_tg25:
    s_cmp_lg_u32 s78, 0
    s_cbranch_scc1 L_tk26
    buffer_load_dword v14, v13, s[36:39], 0 offen offset:4 sc1
    s_waitcnt vmcnt(0)
    v_readfirstlane_b32 s78, v14
    s_add_u32 s79, s79, 1
    s_cmp_lt_u32 s79, 32768
    s_cbranch_scc1 L_tg25
L_tk26:
    s_mul_i32 s80, s78, 0x9e3779b1
    s_lshr_b32 s80, s80, 22
    s_mul_i32 s81, s78, 0x85ebca77
    s_lshr_b32 s81, s81, 22
    s_mul_i32 s82, s78, 0xc2b2ae3d
    s_lshr_b32 s82, s82, 22
    s_mul_i32 s83, s78, 0x27d4eb2f
    s_lshr_b32 s83, s83, 22
L_ex27:
    s_waitcnt lgkmcnt(0)
    v_and_b32 v36, v36, v37
    v_and_b32 v38, v38, v39
    v_and_b32 v36, v36, v38
    v_or_b32 v37, 1, v36
    v_and_b32 v37, v37, v19
    v_readfirstlane_b32 s30, v36
    v_cmp_ne_u32 vcc, v37, v18
    s_cbranch_vccz L_ek28
    ds_read_b32 v19, v7
    ds_read_b128 v[36:39], v13 offset:240
    ds_read_b128 v[120:123], v5 offset:0
    ds_read_b128 v[124:127], v5 offset:1024
    ds_read_b128 v[128:131], v5 offset:2048
    ds_read_b128 v[132:135], v5 offset:3072
    ds_read_b128 v[112:115], v5 offset:4096
    ds_read_b128 v[116:119], v5 offset:5120
    s_add_u32 s79, s79, 1
    s_cmp_lt_u32 s79, 32768
    s_cbranch_scc1 L_ex27
    s_waitcnt lgkmcnt(0)
L_ek28:
    s_cmp_eq_u32 s30, 0x7fc17fc1
    s_cbranch_scc0 L_k2s
    v_pk_add_f32 v[192:193], v[192:193], v[120:121]
    v_pk_add_f32 v[194:195], v[194:195], v[122:123]
    v_bfi_b32 v192, v15, s80, v192
    v_bfi_b32 v193, v15, s81, v193
    v_bfi_b32 v194, v15, s82, v194
    v_bfi_b32 v195, v15, s83, v195
    v_pk_add_f32 v[196:197], v[196:197], v[124:125]
    v_pk_add_f32 v[198:199], v[198:199], v[126:127]
    v_bfi_b32 v196, v15, s80, v196
    v_bfi_b32 v197, v15, s81, v197
    v_bfi_b32 v198, v15, s82, v198
    v_bfi_b32 v199, v15, s83, v199
    v_pk_add_f32 v[200:201], v[200:201], v[128:129]
    v_pk_add_f32 v[202:203], v[202:203], v[130:131]
    buffer_store_dwordx4 v[192:195], v3, s[32:35], s48 offen
    s_add_u32 s48, s48, 16384
    v_bfi_b32 v200, v15, s80, v200
    v_bfi_b32 v201, v15, s81, v201
    v_bfi_b32 v202, v15, s82, v202
    v_bfi_b32 v203, v15, s83, v203
    v_pk_add_f32 v[204:205], v[204:205], v[132:133]
    v_pk_add_f32 v[206:207], v[206:207], v[134:135]
    buffer_store_dwordx4 v[196:199], v3, s[32:35], s48 offen
    s_add_u32 s48, s48, 16384
    v_bfi_b32 v204, v15, s80, v204
    v_bfi_b32 v205, v15, s81, v205
    v_bfi_b32 v206, v15, s82, v206
    v_bfi_b32 v207, v15, s83, v207
    v_pk_add_f32 v[208:209], v[208:209], v[112:113]
    v_pk_add_f32 v[210:211], v[210:211], v[114:115]
    v_pk_add_f32 v[212:213], v[212:213], v[116:117]
    v_pk_add_f32 v[214:215], v[214:215], v[118:119]
    buffer_store_dwordx4 v[200:203], v3, s[32:35], s48 offen
    s_add_u32 s48, s48, 16384
    v_bfi_b32 v208, v15, s80, v208
    v_bfi_b32 v209, v15, s81, v209
    v_bfi_b32 v210, v15, s82, v210
    v_bfi_b32 v211, v15, s83, v211
    v_bfi_b32 v212, v15, s80, v212
    v_bfi_b32 v213, v15, s81, v213
    v_bfi_b32 v214, v15, s82, v214
    v_bfi_b32 v215, v15, s83, v215
    buffer_store_dwordx4 v[204:207], v3, s[32:35], s48 offen
    s_mov_b32 exec_lo, 0x10001
    s_mov_b32 exec_hi, 0x10001
    buffer_store_dwordx4 v[208:211], v8, s[32:35], s49 offen offset:0
    buffer_store_dwordx4 v[212:215], v8, s[32:35], s49 offen offset:1024
    s_mov_b64 exec, -1
L_k2r:
    s_mov_b32 s19, s50
    buffer_load_dwordx4 v[192:195], v9, s[32:35], s19 offen sc1
    s_add_u32 s19, s19, 4096
    buffer_load_dwordx4 v[196:199], v9, s[32:35], s19 offen sc1
    s_add_u32 s19, s19, 4096
    buffer_load_dwordx4 v[200:203], v9, s[32:35], s19 offen sc1
    s_add_u32 s19, s19, 4096
    buffer_load_dwordx4 v[204:207], v9, s[32:35], s19 offen sc1
    buffer_load_dwordx2 v[208:209], v10, s[32:35], s51 offen sc1
    s_mov_b64 exec, 1
    ds_write_b32 v1, v18 offset:176
    s_mov_b64 exec, -1
    ds_read_b128 v[80:83], v26 offset:0
    ds_read_b64_tr_b16 v[96:97], v42 offset:0
    ds_read_b64_tr_b16 v[98:99], v42 offset:512
    ds_read_b128 v[84:87], v26 offset:2048
    ds_read_b128 v[88:91], v26 offset:4096
    ds_read_b128 v[92:95], v26 offset:6144
    ds_read_b64_tr_b16 v[100:101], v43 offset:0
    ds_read_b64_tr_b16 v[102:103], v43 offset:512
    ds_read_b128 v[60:63], v27 offset:0
    ds_read_b64_tr_b16 v[104:105], v42 offset:4096
    ds_read_b64_tr_b16 v[106:107], v42 offset:4608
    ds_read_b128 v[64:67], v27 offset:2048
    ds_read_b128 v[68:71], v27 offset:4096
    ds_read_b128 v[72:75], v27 offset:6144
    ds_read_b64_tr_b16 v[108:109], v43 offset:4096
    ds_read_b64_tr_b16 v[110:111], v43 offset:4608
    s_mov_b64 exec, 1
    s_lshl_b32 s19, s58, 16
    s_add_u32 s19, s19, 8388608
    s_waitcnt lgkmcnt(8)
    s_waitcnt lgkmcnt(0)
    ds_write_b32 v1, v18 offset:160
    s_mov_b64 exec, -1
    v_mfma_f32_16x16x32_bf16 v[160:163], v[96:99], v[80:83], v[160:163]
    v_and_b32 v19, 1, v2
    v_mov_b32 v16, s80
    v_mfma_f32_16x16x32_bf16 v[164:167], v[96:99], v[84:87], v[164:167]
    v_cmp_eq_u32 vcc, 0, v19
    v_mov_b32 v54, s82
    v_mfma_f32_16x16x32_bf16 v[168:171], v[96:99], v[88:91], v[168:171]
    v_and_b32 v19, 15, v2
    v_cndmask_b32 v16, v54, v16, vcc
    v_mfma_f32_16x16x32_bf16 v[172:175], v[96:99], v[92:95], v[172:175]
    v_lshlrev_b32 v26, 11, v19
    v_and_b32 v54, 16, v2
    v_mfma_f32_16x16x32_bf16 v[188:191], v[100:103], v[92:95], v[188:191]
    v_lshl_add_u32 v26, v54, 1, v26
    v_and_b32 v54, 32, v2
    v_mfma_f32_16x16x32_bf16 v[184:187], v[100:103], v[88:91], v[184:187]
    v_lshrrev_b32 v54, 1, v54
    v_lshrrev_b32 v27, 1, v19
    v_mfma_f32_16x16x32_bf16 v[180:183], v[100:103], v[84:87], v[180:183]
    v_lshrrev_b32 v19, 2, v2
    v_add_u32 v26, v26, v54
    v_mfma_f32_16x16x32_bf16 v[176:179], v[100:103], v[80:83], v[176:179]
    v_lshlrev_b32 v20, 7, v19
    v_and_b32 v54, 3, v2
    v_mfma_f32_16x16x32_bf16 v[160:163], v[104:107], v[60:63], v[160:163]
    v_lshl_add_u32 v20, v54, 3, v20
    v_bfe_u32 v19, v2, 3, 2
    v_mfma_f32_16x16x32_bf16 v[164:167], v[104:107], v[64:67], v[164:167]
    v_add_u32 v24, s19, v3
    buffer_load_dwordx4 v[28:31], v26, s[24:27], s54 offen offset:0
    v_mfma_f32_16x16x32_bf16 v[168:171], v[104:107], v[68:71], v[168:171]
    s_nop 1
    v_cvt_pk_bf16_f32 v160, v160, v161
    v_cvt_pk_bf16_f32 v161, v162, v163
    v_mfma_f32_16x16x32_bf16 v[172:175], v[104:107], v[72:75], v[172:175]
    v_cvt_pk_bf16_f32 v164, v164, v165
    v_cvt_pk_bf16_f32 v165, v166, v167
    v_mfma_f32_16x16x32_bf16 v[188:191], v[108:111], v[72:75], v[188:191]
    v_cvt_pk_bf16_f32 v168, v168, v169
    v_cvt_pk_bf16_f32 v169, v170, v171
    v_mfma_f32_16x16x32_bf16 v[184:187], v[108:111], v[68:71], v[184:187]
    s_nop 1
    v_cvt_pk_bf16_f32 v172, v172, v173
    v_cvt_pk_bf16_f32 v173, v174, v175
    v_mfma_f32_16x16x32_bf16 v[180:183], v[108:111], v[64:67], v[180:183]
    v_cvt_pk_bf16_f32 v174, v188, v189
    v_cvt_pk_bf16_f32 v175, v190, v191
    v_mfma_f32_16x16x32_bf16 v[176:179], v[108:111], v[60:63], v[176:179]
    v_cvt_pk_bf16_f32 v170, v184, v185
    v_cvt_pk_bf16_f32 v171, v186, v187
    v_mfma_f32_16x16x32_bf16 v[136:139], v[44:47], v[172:175], 0
    s_nop 1
    v_cvt_pk_bf16_f32 v166, v180, v181
    v_cvt_pk_bf16_f32 v167, v182, v183
    v_mfma_f32_16x16x32_bf16 v[128:131], v[44:47], v[168:171], 0
    v_cvt_pk_bf16_f32 v162, v176, v177
    v_cvt_pk_bf16_f32 v163, v178, v179
    v_mfma_f32_16x16x32_bf16 v[120:123], v[44:47], v[164:167], 0
    v_cvt_pk_bf16_f32 v252, v136, v137
    v_cvt_pk_bf16_f32 v253, v138, v139
    v_mfma_f32_16x16x32_bf16 v[112:115], v[44:47], v[160:163], 0
    s_nop 1
    v_cvt_pk_bf16_f32 v248, v128, v129
    v_cvt_pk_bf16_f32 v249, v130, v131
    v_mfma_f32_16x16x32_bf16 v[116:119], v[48:51], v[160:163], 0
    v_cvt_pk_bf16_f32 v244, v120, v121
    v_cvt_pk_bf16_f32 v245, v122, v123
    v_mfma_f32_16x16x32_bf16 v[124:127], v[48:51], v[164:167], 0
    v_cvt_pk_bf16_f32 v240, v112, v113
    v_cvt_pk_bf16_f32 v241, v114, v115
    v_mfma_f32_16x16x32_bf16 v[132:135], v[48:51], v[168:171], 0
    s_nop 1
    v_cvt_pk_bf16_f32 v242, v116, v117
    v_cvt_pk_bf16_f32 v243, v118, v119
    v_mfma_f32_16x16x32_bf16 v[140:143], v[48:51], v[172:175], 0
    v_cvt_pk_bf16_f32 v246, v124, v125
    v_cvt_pk_bf16_f32 v247, v126, v127
    v_lshlrev_b32 v112, 16, v240
    v_and_b32 v113, 0xffff0000, v240
    v_cvt_pk_bf16_f32 v250, v132, v133
    v_cvt_pk_bf16_f32 v251, v134, v135
    v_lshlrev_b32 v114, 16, v241
    v_lshlrev_b32 v120, 16, v244
    v_cvt_pk_bf16_f32 v254, v140, v141
    v_cvt_pk_bf16_f32 v255, v142, v143
    v_and_b32 v121, 0xffff0000, v244
    v_lshlrev_b32 v122, 16, v245
    v_lshlrev_b32 v128, 16, v248
    v_and_b32 v129, 0xffff0000, v248
    v_lshlrev_b32 v130, 16, v249
    v_lshlrev_b32 v136, 16, v252
    v_and_b32 v137, 0xffff0000, v252
    v_lshlrev_b32 v138, 16, v253
    v_and_b32 v115, 0xffff0000, v241
    v_lshlrev_b32 v116, 16, v242
    v_and_b32 v117, 0xffff0000, v242
    v_lshlrev_b32 v118, 16, v243
    v_and_b32 v119, 0xffff0000, v243
    v_and_b32 v123, 0xffff0000, v245
    v_lshlrev_b32 v124, 16, v246
    v_and_b32 v125, 0xffff0000, v246
    v_lshlrev_b32 v126, 16, v247
    v_and_b32 v127, 0xffff0000, v247
    v_and_b32 v131, 0xffff0000, v249
    v_lshlrev_b32 v132, 16, v250
    v_and_b32 v133, 0xffff0000, v250
    v_lshlrev_b32 v134, 16, v251
    v_and_b32 v135, 0xffff0000, v251
    v_and_b32 v139, 0xffff0000, v253
    v_lshlrev_b32 v140, 16, v254
    v_and_b32 v141, 0xffff0000, v254
    v_lshlrev_b32 v142, 16, v255
    v_and_b32 v143, 0xffff0000, v255
    v_max3_f32 v176, v112, v113, v114
    v_min3_f32 v180, v112, v113, v114
    v_max3_f32 v177, v120, v121, v122
    v_min3_f32 v181, v120, v121, v122
    v_max3_f32 v178, v128, v129, v130
    v_min3_f32 v182, v128, v129, v130
    v_max3_f32 v179, v136, v137, v138
    v_min3_f32 v183, v136, v137, v138
    v_max3_f32 v240, v115, v116, v117
    v_max3_f32 v176, v176, v118, v119
    v_min3_f32 v241, v115, v116, v117
    v_min3_f32 v180, v180, v118, v119
    v_max3_f32 v242, v123, v124, v125
    v_max3_f32 v177, v177, v126, v127
    v_min3_f32 v243, v123, v124, v125
    v_min3_f32 v181, v181, v126, v127
    v_max3_f32 v244, v131, v132, v133
    v_max3_f32 v178, v178, v134, v135
    v_min3_f32 v245, v131, v132, v133
    v_min3_f32 v182, v182, v134, v135
    v_max3_f32 v246, v139, v140, v141
    v_max3_f32 v179, v179, v142, v143
    v_min3_f32 v247, v139, v140, v141
    v_min3_f32 v183, v183, v142, v143
    v_max_f32 v176, v176, v240
    v_min_f32 v180, v180, v241
    v_max_f32 v177, v177, v242
    v_min_f32 v181, v181, v243
    v_max_f32 v178, v178, v244
    v_min_f32 v182, v182, v245
    v_max_f32 v179, v179, v246
    v_min_f32 v183, v183, v247
    v_permlane32_swap_b32 v176, v178
    v_permlane32_swap_b32 v177, v179
    v_permlane32_swap_b32 v180, v182
    v_permlane32_swap_b32 v181, v183
    v_max_f32 v176, v176, v178
    v_max_f32 v177, v177, v179
    v_min_f32 v180, v180, v182
    v_min_f32 v181, v181, v183
    v_permlane16_swap_b32 v176, v177
    s_and_b32 s19, s13, 28
    v_permlane16_swap_b32 v180, v181
    v_max_f32 v176, v176, v177
    v_min_f32 v180, v180, v181
    v_mul_f32 v184, s76, v176
    v_mul_f32 v188, s74, v180
    v_mov_b32 v185, v184
    v_mov_b32 v189, v188
    buffer_load_dwordx4 v[32:35], v26, s[24:27], s54 offen offset:64
    v_permlane16_swap_b32 v184, v185
    v_permlane16_swap_b32 v188, v189
    v_lshl_add_u32 v20, v19, 5, v20
    v_add_u32 v4, s19, v2
    v_lshlrev_b32 v27, 3, v27
    buffer_load_dwordx4 v[36:39], v26, s[24:27], s55 offen offset:0
    v_mov_b32 v186, v184
    v_mov_b32 v187, v185
    v_mov_b32 v190, v188
    v_mov_b32 v191, v189
    v_mov_b32 v17, s81
    v_mov_b32 v55, s83
    buffer_load_dwordx4 v[40:43], v26, s[24:27], s55 offen offset:64
    v_add_u32 v20, 32768, v20
    v_and_b32 v4, 31, v4
    buffer_load_dwordx2 v[76:77], v27, s[32:35], s57 offen offset:0 sc1
    v_cndmask_b32 v17, v55, v17, vcc
    buffer_load_dwordx2 v[78:79], v27, s[32:35], s57 offen offset:64 sc1
    v_xor_b32 v21, 32, v20
    v_xor_b32 v22, 64, v20
    v_xor_b32 v23, 0x60, v20
    v_add_u32 v25, 32768, v24
    v_lshlrev_b32 v4, 2, v4
    v_permlane32_swap_b32 v184, v186
    v_permlane32_swap_b32 v185, v187
    v_permlane32_swap_b32 v188, v190
    v_permlane32_swap_b32 v189, v191
    s_waitcnt vmcnt(6)
L_h129:
    v_xor_b32 v111, s83, v207
    v_xor_b32 v92, v16, v208
    v_xor_b32 v93, v17, v209
    v_xor_b32 v96, s80, v192
    v_or3_b32 v215, v111, v92, v93
    v_permlane32_swap_b32 v92, v93
    v_xor_b32 v97, s81, v193
    v_add_f32 v92, v92, v93
    v_xor_b32 v98, s82, v194
    v_xor_b32 v99, s83, v195
    v_xor_b32 v100, s80, v196
    v_xor_b32 v101, s81, v197
    v_xor_b32 v102, s82, v198
    v_xor_b32 v103, s83, v199
    v_xor_b32 v104, s80, v200
    v_xor_b32 v105, s81, v201
    v_xor_b32 v106, s82, v202
    v_xor_b32 v107, s83, v203
    v_xor_b32 v108, s80, v204
    v_xor_b32 v109, s81, v205
    v_xor_b32 v110, s82, v206
    v_mov_b32 v93, v92
    v_or3_b32 v210, v96, v97, v98
    v_or3_b32 v211, v99, v100, v101
    v_or3_b32 v212, v102, v103, v104
    v_or3_b32 v213, v105, v106, v107
    v_pk_add_f32 v[96:97], v[96:97], v[100:101]
    v_pk_add_f32 v[104:105], v[104:105], v[108:109]
    v_pk_add_f32 v[98:99], v[98:99], v[102:103]
    v_pk_add_f32 v[106:107], v[106:107], v[110:111]
    v_permlane16_swap_b32 v92, v93
    v_pk_add_f32 v[96:97], v[96:97], v[104:105]
    v_pk_add_f32 v[98:99], v[98:99], v[106:107]
    v_add_f32 v92, v92, v93
    v_or3_b32 v214, v108, v109, v110
    v_permlane32_swap_b32 v96, v98
    v_permlane32_swap_b32 v97, v99
    v_add_f32_dpp v92, v92, v92 row_ror:8 row_mask:0xf bank_mask:0xf
    v_pk_add_f32 v[96:97], v[96:97], v[98:99]
    v_or3_b32 v210, v210, v211, v212
    v_mov_b32 v98, v96
    v_mov_b32 v99, v97
    v_add_f32_dpp v92, v92, v92 row_ror:4 row_mask:0xf bank_mask:0xf
    v_or3_b32 v215, v215, v213, v214
    v_mov_b32 v93, v92
    v_or_b32 v215, v215, v210
    v_permlane16_swap_b32 v96, v98
    v_permlane16_swap_b32 v97, v99
    v_and_b32 v215, v215, v15
    v_pk_add_f32 v[96:97], v[96:97], v[98:99]
    v_permlane32_swap_b32 v92, v93
    v_cmp_ne_u32 vcc, 0, v215
    v_cvt_pk_bf16_f32 v96, v96, v97
    v_cvt_pk_bf16_f32 v92, v92, v93
    s_cbranch_vccz L_h1k30
    s_mov_b32 s19, s50
    buffer_load_dwordx4 v[192:195], v9, s[32:35], s19 offen sc1
    s_add_u32 s19, s19, 4096
    buffer_load_dwordx4 v[196:199], v9, s[32:35], s19 offen sc1
    s_add_u32 s19, s19, 4096
    buffer_load_dwordx4 v[200:203], v9, s[32:35], s19 offen sc1
    s_add_u32 s19, s19, 4096
    buffer_load_dwordx4 v[204:207], v9, s[32:35], s19 offen sc1
    buffer_load_dwordx2 v[208:209], v10, s[32:35], s51 offen sc1
    s_cmp_eq_u32 s29, 0
    s_cbranch_scc1 L_q2
L_q2r:
    s_waitcnt vmcnt(0)
    s_add_u32 s79, s79, 1
    s_cmp_lt_u32 s79, 32768
    s_cbranch_scc1 L_h129
L_h1k30:
    s_cmp_eq_u32 s30, 0x7fc17fc1
    s_cbranch_scc0 L_h1s
    s_mov_b32 exec_lo, 0xffff
    s_mov_b32 exec_hi, 0xffff
    buffer_store_dword v96, v11, s[32:35], s64 offen
    s_lshl_b64 exec, 1, s16
    buffer_store_dword v92, v13, s[32:35], s65 offen
    s_mov_b64 exec, -1
L_h1r:
    buffer_load_dwordx4 v[60:63], v3, s[32:35], s59 offen offset:0 sc1
    buffer_load_dwordx4 v[64:67], v3, s[32:35], s59 offen offset:1024 sc1
    buffer_load_dwordx4 v[68:71], v3, s[32:35], s59 offen offset:2048 sc1
    buffer_load_dwordx4 v[72:75], v3, s[32:35], s59 offen offset:3072 sc1
    buffer_load_dwordx4 v[80:83], v12, s[32:35], s28 offen offset:0 sc1
    buffer_load_dwordx4 v[84:87], v12, s[32:35], s28 offen offset:64 sc1
    s_mov_b64 exec, 1
    ds_write_b32 v1, v18 offset:192
    s_mov_b64 exec, -1
    s_cmp_lg_u32 s29, 0
    s_cbranch_scc1 L_q3
    s_mov_b32 s29, 2
L_q2:
    v_pk_fma_f32 v[144:145], v[112:113], s[74:75], v[184:185] op_sel_hi:[1,0,0]
    v_pk_fma_f32 v[146:147], v[114:115], s[74:75], v[184:185] op_sel_hi:[1,0,0]
    v_pk_fma_f32 v[152:153], v[120:121], s[74:75], v[184:185] op_sel:[0,0,1] op_sel_hi:[1,0,1]
    v_pk_fma_f32 v[154:155], v[122:123], s[74:75], v[184:185] op_sel:[0,0,1] op_sel_hi:[1,0,1]
    v_pk_fma_f32 v[224:225], v[128:129], s[74:75], v[186:187] op_sel_hi:[1,0,0]
    v_pk_fma_f32 v[226:227], v[130:131], s[74:75], v[186:187] op_sel_hi:[1,0,0]
    v_pk_fma_f32 v[232:233], v[136:137], s[74:75], v[186:187] op_sel:[0,0,1] op_sel_hi:[1,0,1]
    v_pk_fma_f32 v[234:235], v[138:139], s[74:75], v[186:187] op_sel:[0,0,1] op_sel_hi:[1,0,1]
    v_pk_fma_f32 v[148:149], v[116:117], s[74:75], v[184:185] op_sel_hi:[1,0,0]
    v_pk_fma_f32 v[156:157], v[124:125], s[74:75], v[184:185] op_sel:[0,0,1] op_sel_hi:[1,0,1]
    v_pk_fma_f32 v[228:229], v[132:133], s[74:75], v[186:187] op_sel_hi:[1,0,0]
    v_pk_fma_f32 v[236:237], v[140:141], s[74:75], v[186:187] op_sel:[0,0,1] op_sel_hi:[1,0,1]
    v_exp_f32 v144, v144
    v_exp_f32 v145, v145
    v_exp_f32 v146, v146
    v_exp_f32 v147, v147
    v_exp_f32 v152, v152
    v_exp_f32 v153, v153
    v_exp_f32 v154, v154
    v_exp_f32 v155, v155
    v_exp_f32 v224, v224
    v_exp_f32 v225, v225
    v_exp_f32 v226, v226
    v_exp_f32 v227, v227
    v_exp_f32 v232, v232
    v_exp_f32 v233, v233
    v_exp_f32 v234, v234
    v_exp_f32 v235, v235
    v_pk_fma_f32 v[150:151], v[118:119], s[74:75], v[184:185] op_sel_hi:[1,0,0]
    v_pk_fma_f32 v[158:159], v[126:127], s[74:75], v[184:185] op_sel:[0,0,1] op_sel_hi:[1,0,1]
    v_pk_fma_f32 v[230:231], v[134:135], s[74:75], v[186:187] op_sel_hi:[1,0,0]
    v_pk_fma_f32 v[238:239], v[142:143], s[74:75], v[186:187] op_sel:[0,0,1] op_sel_hi:[1,0,1]
    v_exp_f32 v148, v148
    v_exp_f32 v149, v149
    v_exp_f32 v156, v156
    v_exp_f32 v157, v157
    v_exp_f32 v228, v228
    v_exp_f32 v229, v229
    v_exp_f32 v236, v236
    v_exp_f32 v237, v237
    v_pk_add_f32 v[240:241], v[144:145], v[146:147]
    v_pk_add_f32 v[242:243], v[152:153], v[154:155]
    v_pk_add_f32 v[244:245], v[224:225], v[226:227]
    v_pk_add_f32 v[246:247], v[232:233], v[234:235]
    v_exp_f32 v150, v150
    v_exp_f32 v151, v151
    v_exp_f32 v158, v158
    v_exp_f32 v159, v159
    v_exp_f32 v230, v230
    v_exp_f32 v231, v231
    v_exp_f32 v238, v238
    v_exp_f32 v239, v239
    v_pk_add_f32 v[240:241], v[240:241], v[148:149]
    v_pk_add_f32 v[242:243], v[242:243], v[156:157]
    v_pk_add_f32 v[244:245], v[244:245], v[228:229]
    v_pk_add_f32 v[246:247], v[246:247], v[236:237]
    v_pk_add_f32 v[240:241], v[240:241], v[150:151]
    v_pk_add_f32 v[242:243], v[242:243], v[158:159]
    v_pk_add_f32 v[244:245], v[244:245], v[230:231]
    v_pk_add_f32 v[246:247], v[246:247], v[238:239]
    v_add_f32 v176, v240, v241
    v_add_f32 v177, v242, v243
    v_add_f32 v178, v244, v245
    v_add_f32 v179, v246, v247
    s_nop 0
    v_permlane32_swap_b32 v176, v178
    v_permlane32_swap_b32 v177, v179
    v_add_f32 v176, v176, v178
    v_add_f32 v177, v177, v179
    s_nop 1
    v_permlane16_swap_b32 v176, v177
    v_add_f32 v176, v176, v177
    v_rcp_f32 v176, v176
    s_nop 0
    v_mov_b32 v177, v176
    s_nop 1
    v_permlane16_swap_b32 v176, v177
    v_mov_b32 v178, v176
    v_mov_b32 v179, v177
    s_nop 0
    v_permlane32_swap_b32 v176, v178
    v_permlane32_swap_b32 v177, v179
    v_pk_mul_f32 v[144:145], v[144:145], v[176:177] op_sel_hi:[1,0]
    v_pk_mul_f32 v[152:153], v[152:153], v[176:177] op_sel:[0,1] op_sel_hi:[1,1]
    v_pk_mul_f32 v[224:225], v[224:225], v[178:179] op_sel_hi:[1,0]
    v_pk_mul_f32 v[232:233], v[232:233], v[178:179] op_sel:[0,1] op_sel_hi:[1,1]
    v_pk_mul_f32 v[146:147], v[146:147], v[176:177] op_sel_hi:[1,0]
    v_pk_mul_f32 v[154:155], v[154:155], v[176:177] op_sel:[0,1] op_sel_hi:[1,1]
    v_pk_mul_f32 v[226:227], v[226:227], v[178:179] op_sel_hi:[1,0]
    v_pk_mul_f32 v[234:235], v[234:235], v[178:179] op_sel:[0,1] op_sel_hi:[1,1]
    v_pk_mul_f32 v[148:149], v[148:149], v[176:177] op_sel_hi:[1,0]
    v_pk_mul_f32 v[150:151], v[150:151], v[176:177] op_sel_hi:[1,0]
    v_cvt_pk_bf16_f32 v144, v144, v145
    v_pk_mul_f32 v[156:157], v[156:157], v[176:177] op_sel:[0,1] op_sel_hi:[1,1]
    v_pk_mul_f32 v[158:159], v[158:159], v[176:177] op_sel:[0,1] op_sel_hi:[1,1]
    v_cvt_pk_bf16_f32 v152, v152, v153
    v_pk_mul_f32 v[228:229], v[228:229], v[178:179] op_sel_hi:[1,0]
    v_pk_mul_f32 v[230:231], v[230:231], v[178:179] op_sel_hi:[1,0]
    v_cvt_pk_bf16_f32 v224, v224, v225
    v_pk_mul_f32 v[236:237], v[236:237], v[178:179] op_sel:[0,1] op_sel_hi:[1,1]
    v_pk_mul_f32 v[238:239], v[238:239], v[178:179] op_sel:[0,1] op_sel_hi:[1,1]
    v_cvt_pk_bf16_f32 v232, v232, v233
    v_cvt_pk_bf16_f32 v145, v146, v147
    v_cvt_pk_bf16_f32 v153, v154, v155
    v_cvt_pk_bf16_f32 v225, v226, v227
    v_cvt_pk_bf16_f32 v233, v234, v235
    v_cvt_pk_bf16_f32 v146, v148, v149
    v_cvt_pk_bf16_f32 v147, v150, v151
    v_cvt_pk_bf16_f32 v154, v156, v157
    v_cvt_pk_bf16_f32 v155, v158, v159
    v_cvt_pk_bf16_f32 v226, v228, v229
    v_cvt_pk_bf16_f32 v227, v230, v231
    v_cvt_pk_bf16_f32 v234, v236, v237
    v_cvt_pk_bf16_f32 v235, v238, v239
    s_add_u32 s29, s29, 1
    s_cmp_eq_u32 s29, 1
    s_cbranch_scc1 L_q2r
L_q3:
    v_pk_fma_f32 v[112:113], v[112:113], s[76:77], v[188:189] op_sel_hi:[1,0,0]
    v_pk_fma_f32 v[114:115], v[114:115], s[76:77], v[188:189] op_sel_hi:[1,0,0]
    v_pk_fma_f32 v[120:121], v[120:121], s[76:77], v[188:189] op_sel:[0,0,1] op_sel_hi:[1,0,1]
    v_pk_fma_f32 v[122:123], v[122:123], s[76:77], v[188:189] op_sel:[0,0,1] op_sel_hi:[1,0,1]
    v_pk_fma_f32 v[128:129], v[128:129], s[76:77], v[190:191] op_sel_hi:[1,0,0]
    v_pk_fma_f32 v[130:131], v[130:131], s[76:77], v[190:191] op_sel_hi:[1,0,0]
    v_pk_fma_f32 v[136:137], v[136:137], s[76:77], v[190:191] op_sel:[0,0,1] op_sel_hi:[1,0,1]
    v_pk_fma_f32 v[138:139], v[138:139], s[76:77], v[190:191] op_sel:[0,0,1] op_sel_hi:[1,0,1]
    v_pk_fma_f32 v[116:117], v[116:117], s[76:77], v[188:189] op_sel_hi:[1,0,0]
    v_pk_fma_f32 v[124:125], v[124:125], s[76:77], v[188:189] op_sel:[0,0,1] op_sel_hi:[1,0,1]
    v_pk_fma_f32 v[132:133], v[132:133], s[76:77], v[190:191] op_sel_hi:[1,0,0]
    v_pk_fma_f32 v[140:141], v[140:141], s[76:77], v[190:191] op_sel:[0,0,1] op_sel_hi:[1,0,1]
    v_exp_f32 v112, v112
    v_exp_f32 v113, v113
    v_exp_f32 v114, v114
    v_exp_f32 v115, v115
    v_exp_f32 v120, v120
    v_exp_f32 v121, v121
    v_exp_f32 v122, v122
    v_exp_f32 v123, v123
    v_exp_f32 v128, v128
    v_exp_f32 v129, v129
    v_exp_f32 v130, v130
    v_exp_f32 v131, v131
    v_exp_f32 v136, v136
    v_exp_f32 v137, v137
    v_exp_f32 v138, v138
    v_exp_f32 v139, v139
    v_pk_fma_f32 v[118:119], v[118:119], s[76:77], v[188:189] op_sel_hi:[1,0,0]
    v_pk_fma_f32 v[126:127], v[126:127], s[76:77], v[188:189] op_sel:[0,0,1] op_sel_hi:[1,0,1]
    v_pk_fma_f32 v[134:135], v[134:135], s[76:77], v[190:191] op_sel_hi:[1,0,0]
    v_pk_fma_f32 v[142:143], v[142:143], s[76:77], v[190:191] op_sel:[0,0,1] op_sel_hi:[1,0,1]
    v_exp_f32 v116, v116
    v_exp_f32 v117, v117
    v_exp_f32 v124, v124
    v_exp_f32 v125, v125
    v_exp_f32 v132, v132
    v_exp_f32 v133, v133
    v_exp_f32 v140, v140
    v_exp_f32 v141, v141
    v_pk_add_f32 v[248:249], v[112:113], v[114:115]
    v_pk_add_f32 v[250:251], v[120:121], v[122:123]
    v_pk_add_f32 v[252:253], v[128:129], v[130:131]
    v_pk_add_f32 v[254:255], v[136:137], v[138:139]
    v_exp_f32 v118, v118
    v_exp_f32 v119, v119
    v_exp_f32 v126, v126
    v_exp_f32 v127, v127
    v_exp_f32 v134, v134
    v_exp_f32 v135, v135
    v_exp_f32 v142, v142
    v_exp_f32 v143, v143
    v_pk_add_f32 v[248:249], v[248:249], v[116:117]
    v_pk_add_f32 v[250:251], v[250:251], v[124:125]
    v_pk_add_f32 v[252:253], v[252:253], v[132:133]
    v_pk_add_f32 v[254:255], v[254:255], v[140:141]
    v_pk_add_f32 v[248:249], v[248:249], v[118:119]
    v_pk_add_f32 v[250:251], v[250:251], v[126:127]
    v_pk_add_f32 v[252:253], v[252:253], v[134:135]
    v_pk_add_f32 v[254:255], v[254:255], v[142:143]
    v_add_f32 v180, v248, v249
    v_add_f32 v181, v250, v251
    v_add_f32 v182, v252, v253
    v_add_f32 v183, v254, v255
    s_nop 0
    v_permlane32_swap_b32 v180, v182
    v_permlane32_swap_b32 v181, v183
    v_add_f32 v180, v180, v182
    v_add_f32 v181, v181, v183
    s_nop 1
    v_permlane16_swap_b32 v180, v181
    v_add_f32 v180, v180, v181
    v_rcp_f32 v180, v180
    s_nop 0
    v_mov_b32 v181, v180
    s_nop 1
    v_permlane16_swap_b32 v180, v181
    v_mov_b32 v182, v180
    v_mov_b32 v183, v181
    s_nop 0
    v_permlane32_swap_b32 v180, v182
    v_permlane32_swap_b32 v181, v183
    v_pk_mul_f32 v[112:113], v[112:113], v[180:181] op_sel_hi:[1,0]
    v_pk_mul_f32 v[120:121], v[120:121], v[180:181] op_sel:[0,1] op_sel_hi:[1,1]
    v_pk_mul_f32 v[128:129], v[128:129], v[182:183] op_sel_hi:[1,0]
    v_pk_mul_f32 v[136:137], v[136:137], v[182:183] op_sel:[0,1] op_sel_hi:[1,1]
    v_pk_mul_f32 v[114:115], v[114:115], v[180:181] op_sel_hi:[1,0]
    v_pk_mul_f32 v[122:123], v[122:123], v[180:181] op_sel:[0,1] op_sel_hi:[1,1]
    v_pk_mul_f32 v[130:131], v[130:131], v[182:183] op_sel_hi:[1,0]
    v_pk_mul_f32 v[138:139], v[138:139], v[182:183] op_sel:[0,1] op_sel_hi:[1,1]
    v_pk_mul_f32 v[116:117], v[116:117], v[180:181] op_sel_hi:[1,0]
    v_pk_mul_f32 v[118:119], v[118:119], v[180:181] op_sel_hi:[1,0]
    v_cvt_pk_bf16_f32 v112, v112, v113
    v_pk_mul_f32 v[124:125], v[124:125], v[180:181] op_sel:[0,1] op_sel_hi:[1,1]
    v_pk_mul_f32 v[126:127], v[126:127], v[180:181] op_sel:[0,1] op_sel_hi:[1,1]
    v_cvt_pk_bf16_f32 v120, v120, v121
    v_pk_mul_f32 v[132:133], v[132:133], v[182:183] op_sel_hi:[1,0]
    v_pk_mul_f32 v[134:135], v[134:135], v[182:183] op_sel_hi:[1,0]
    v_cvt_pk_bf16_f32 v128, v128, v129
    v_pk_mul_f32 v[140:141], v[140:141], v[182:183] op_sel:[0,1] op_sel_hi:[1,1]
    v_pk_mul_f32 v[142:143], v[142:143], v[182:183] op_sel:[0,1] op_sel_hi:[1,1]
    v_cvt_pk_bf16_f32 v136, v136, v137
    v_cvt_pk_bf16_f32 v113, v114, v115
    v_cvt_pk_bf16_f32 v121, v122, v123
    v_cvt_pk_bf16_f32 v129, v130, v131
    v_cvt_pk_bf16_f32 v137, v138, v139
    v_cvt_pk_bf16_f32 v114, v116, v117
    v_cvt_pk_bf16_f32 v115, v118, v119
    v_cvt_pk_bf16_f32 v122, v124, v125
    v_cvt_pk_bf16_f32 v123, v126, v127
    v_cvt_pk_bf16_f32 v130, v132, v133
    v_cvt_pk_bf16_f32 v131, v134, v135
    v_cvt_pk_bf16_f32 v138, v140, v141
    v_cvt_pk_bf16_f32 v139, v142, v143
L_h231:
    s_waitcnt vmcnt(0)
    v_max3_u32 v88, v60, v61, v62
    v_max3_u32 v89, v64, v65, v66
    v_max3_u32 v90, v68, v69, v70
    v_max3_u32 v91, v72, v73, v74
    v_max3_u32 v92, v80, v81, v82
    v_max3_u32 v93, v84, v85, v86
    v_max_u32 v88, v88, v63
    v_max_u32 v89, v89, v67
    v_max_u32 v90, v90, v71
    v_max_u32 v91, v91, v75
    v_max_u32 v92, v92, v83
    v_max_u32 v93, v93, v87
    v_max3_u32 v94, v88, v89, v90
    v_max3_u32 v95, v91, v92, v93
    v_max_u32 v94, v94, v95
    v_cmp_eq_u32 vcc, -1, v94
    s_cbranch_vccz L_h2k32
    v_cmp_eq_u32 s[68:69], -1, v88
    v_cmp_eq_u32 s[70:71], -1, v89
    v_cmp_eq_u32 s[72:73], -1, v90
    v_cmp_eq_u32 s[74:75], -1, v91
    v_cmp_eq_u32 s[76:77], -1, v92
    v_cmp_eq_u32 s[0:1], -1, v93
    s_mov_b64 exec, s[68:69]
    buffer_load_dwordx4 v[60:63], v3, s[32:35], s59 offen offset:0 sc1
    s_mov_b64 exec, s[70:71]
    buffer_load_dwordx4 v[64:67], v3, s[32:35], s59 offen offset:1024 sc1
    s_mov_b64 exec, s[72:73]
    buffer_load_dwordx4 v[68:71], v3, s[32:35], s59 offen offset:2048 sc1
    s_mov_b64 exec, s[74:75]
    buffer_load_dwordx4 v[72:75], v3, s[32:35], s59 offen offset:3072 sc1
    s_mov_b64 exec, s[76:77]
    buffer_load_dwordx4 v[80:83], v12, s[32:35], s28 offen offset:0 sc1
    s_mov_b64 exec, s[0:1]
    buffer_load_dwordx4 v[84:87], v12, s[32:35], s28 offen offset:64 sc1
    s_mov_b64 exec, -1
    s_add_u32 s79, s79, 1
    s_cmp_lt_u32 s79, 32768
    s_cbranch_scc1 L_h231
    s_waitcnt vmcnt(0)
L_h2k32:
    v_mfma_f32_16x16x32_bf16 v[160:163], v[80:83], v[144:147], 0
    s_mov_b32 s74, 0x358637bd
    v_mov_b32 v19, s78
    v_mfma_f32_16x16x32_bf16 v[164:167], v[80:83], v[152:155], 0
    v_mfma_f32_16x16x32_bf16 v[160:163], v[84:87], v[112:115], v[160:163]
    v_mfma_f32_16x16x32_bf16 v[164:167], v[84:87], v[120:123], v[164:167]
    v_mfma_f32_16x16x32_bf16 v[168:171], v[80:83], v[224:227], 0
    v_mfma_f32_16x16x32_bf16 v[172:175], v[80:83], v[232:235], 0
    s_nop 5
    v_cvt_pk_bf16_f32 v88, v160, v164
    v_mfma_f32_16x16x32_bf16 v[168:171], v[84:87], v[128:131], v[168:171]
    v_and_b32 v89, 0xffff0000, v88
    v_lshlrev_b32 v88, 16, v88
    v_mfma_f32_16x16x32_bf16 v[172:175], v[84:87], v[136:139], v[172:175]
    v_pk_add_f32 v[88:89], v[88:89], s[74:75] op_sel_hi:[1,0]
    v_mfma_f32_16x16x32_bf16 v[192:195], v[60:63], v[144:147], 0
    v_cvt_pk_bf16_f32 v88, v88, v89
    v_mfma_f32_16x16x32_bf16 v[196:199], v[64:67], v[144:147], 0
    s_nop 3
    v_cvt_pk_bf16_f32 v90, v168, v172
    v_and_b32 v89, 0xffff0000, v88
    v_mfma_f32_16x16x32_bf16 v[200:203], v[60:63], v[152:155], 0
    v_and_b32 v91, 0xffff0000, v90
    v_lshlrev_b32 v90, 16, v90
    v_mfma_f32_16x16x32_bf16 v[192:195], v[68:71], v[112:115], v[192:195]
    v_pk_add_f32 v[90:91], v[90:91], s[74:75] op_sel_hi:[1,0]
    v_lshlrev_b32 v88, 16, v88
    v_mfma_f32_16x16x32_bf16 v[204:207], v[64:67], v[152:155], 0
    v_cvt_pk_bf16_f32 v90, v90, v91
    v_rcp_f32 v88, v88
    v_mfma_f32_16x16x32_bf16 v[208:211], v[60:63], v[224:227], 0
    s_nop 1
    v_cvt_pk_bf16_f32 v96, v192, v193
    v_rcp_f32 v89, v89
    v_mfma_f32_16x16x32_bf16 v[196:199], v[72:75], v[112:115], v[196:199]
    v_cvt_pk_bf16_f32 v97, v194, v195
    v_and_b32 v91, 0xffff0000, v90
    v_mfma_f32_16x16x32_bf16 v[200:203], v[68:71], v[120:123], v[200:203]
    v_lshlrev_b32 v192, 16, v96
    v_and_b32 v193, 0xffff0000, v96
    v_mfma_f32_16x16x32_bf16 v[212:215], v[64:67], v[224:227], 0
    s_nop 1
    v_cvt_pk_bf16_f32 v98, v196, v197
    v_cvt_pk_bf16_f32 v99, v198, v199
    v_mfma_f32_16x16x32_bf16 v[216:219], v[60:63], v[232:235], 0
    v_cvt_pk_bf16_f32 v100, v200, v201
    v_lshlrev_b32 v90, 16, v90
    v_mfma_f32_16x16x32_bf16 v[204:207], v[72:75], v[120:123], v[204:207]
    v_lshlrev_b32 v194, 16, v97
    v_and_b32 v195, 0xffff0000, v97
    v_mfma_f32_16x16x32_bf16 v[208:211], v[68:71], v[128:131], v[208:211]
    v_cvt_pk_bf16_f32 v101, v202, v203
    v_lshlrev_b32 v196, 16, v98
    v_mfma_f32_16x16x32_bf16 v[220:223], v[64:67], v[232:235], 0
    v_and_b32 v197, 0xffff0000, v98
    v_lshlrev_b32 v198, 16, v99
    v_mfma_f32_16x16x32_bf16 v[212:215], v[72:75], v[128:131], v[212:215]
    v_and_b32 v199, 0xffff0000, v99
    v_pk_mul_f32 v[192:193], v[192:193], v[88:89] op_sel_hi:[1,0]
    v_mfma_f32_16x16x32_bf16 v[216:219], v[68:71], v[136:139], v[216:219]
    v_cvt_pk_bf16_f32 v102, v204, v205
    v_cvt_pk_bf16_f32 v103, v206, v207
    v_mfma_f32_16x16x32_bf16 v[220:223], v[72:75], v[136:139], v[220:223]
    v_lshlrev_b32 v200, 16, v100
    v_and_b32 v201, 0xffff0000, v100
    v_cvt_pk_bf16_f32 v104, v208, v209
    v_rcp_f32 v90, v90
    v_rcp_f32 v91, v91
    v_pk_mul_f32 v[194:195], v[194:195], v[88:89] op_sel_hi:[1,0]
    v_lshlrev_b32 v202, 16, v101
    v_and_b32 v203, 0xffff0000, v101
    v_cvt_pk_bf16_f32 v105, v210, v211
    v_pk_mul_f32 v[196:197], v[196:197], v[88:89] op_sel_hi:[1,0]
    v_pk_mul_f32 v[198:199], v[198:199], v[88:89] op_sel_hi:[1,0]
    v_cvt_pk_bf16_f32 v192, v192, v193
    v_lshlrev_b32 v204, 16, v102
    v_and_b32 v205, 0xffff0000, v102
    v_lshlrev_b32 v206, 16, v103
    v_and_b32 v207, 0xffff0000, v103
    v_pk_mul_f32 v[200:201], v[200:201], v[88:89] op_sel:[0,1] op_sel_hi:[1,1]
    v_cvt_pk_bf16_f32 v106, v212, v213
    v_cvt_pk_bf16_f32 v107, v214, v215
    v_lshlrev_b32 v208, 16, v104
    v_and_b32 v209, 0xffff0000, v104
    v_cvt_pk_bf16_f32 v108, v216, v217
    v_cvt_pk_bf16_f32 v193, v194, v195
    v_pk_mul_f32 v[202:203], v[202:203], v[88:89] op_sel:[0,1] op_sel_hi:[1,1]
    v_lshlrev_b32 v210, 16, v105
    v_and_b32 v211, 0xffff0000, v105
    v_cvt_pk_bf16_f32 v109, v218, v219
    v_cvt_pk_bf16_f32 v194, v196, v197
    v_cvt_pk_bf16_f32 v195, v198, v199
    v_pk_mul_f32 v[204:205], v[204:205], v[88:89] op_sel:[0,1] op_sel_hi:[1,1]
    v_pk_mul_f32 v[206:207], v[206:207], v[88:89] op_sel:[0,1] op_sel_hi:[1,1]
    v_cvt_pk_bf16_f32 v200, v200, v201
    v_lshlrev_b32 v212, 16, v106
    v_and_b32 v213, 0xffff0000, v106
    v_lshlrev_b32 v214, 16, v107
    v_and_b32 v215, 0xffff0000, v107
    v_pk_mul_f32 v[208:209], v[208:209], v[90:91] op_sel_hi:[1,0]
    v_cvt_pk_bf16_f32 v110, v220, v221
    v_cvt_pk_bf16_f32 v111, v222, v223
    v_lshlrev_b32 v216, 16, v108
    v_and_b32 v217, 0xffff0000, v108
    v_cvt_pk_bf16_f32 v201, v202, v203
    v_pk_mul_f32 v[210:211], v[210:211], v[90:91] op_sel_hi:[1,0]
    v_lshlrev_b32 v218, 16, v109
    v_and_b32 v219, 0xffff0000, v109
    buffer_store_dwordx4 v[192:195], v3, s[32:35], s52 offen sc1
    v_cvt_pk_bf16_f32 v202, v204, v205
    v_cvt_pk_bf16_f32 v203, v206, v207
    v_pk_mul_f32 v[212:213], v[212:213], v[90:91] op_sel_hi:[1,0]
    v_pk_mul_f32 v[214:215], v[214:215], v[90:91] op_sel_hi:[1,0]
    v_cvt_pk_bf16_f32 v208, v208, v209
    v_lshlrev_b32 v220, 16, v110
    v_and_b32 v221, 0xffff0000, v110
    v_lshlrev_b32 v222, 16, v111
    v_and_b32 v223, 0xffff0000, v111
    v_pk_mul_f32 v[216:217], v[216:217], v[90:91] op_sel:[0,1] op_sel_hi:[1,1]
    s_add_u32 s52, s52, 32768
    v_cvt_pk_bf16_f32 v209, v210, v211
    v_pk_mul_f32 v[218:219], v[218:219], v[90:91] op_sel:[0,1] op_sel_hi:[1,1]
    buffer_store_dwordx4 v[200:203], v3, s[32:35], s52 offen sc1
    v_cvt_pk_bf16_f32 v210, v212, v213
    v_cvt_pk_bf16_f32 v211, v214, v215
    v_pk_mul_f32 v[220:221], v[220:221], v[90:91] op_sel:[0,1] op_sel_hi:[1,1]
    v_pk_mul_f32 v[222:223], v[222:223], v[90:91] op_sel:[0,1] op_sel_hi:[1,1]
    v_cvt_pk_bf16_f32 v216, v216, v217
    s_add_u32 s52, s52, 32768
    v_cvt_pk_bf16_f32 v217, v218, v219
    buffer_store_dwordx4 v[208:211], v3, s[32:35], s52 offen sc1
    v_cvt_pk_bf16_f32 v218, v220, v221
    v_cvt_pk_bf16_f32 v219, v222, v223
    s_add_u32 s52, s52, 32768
    buffer_store_dwordx4 v[216:219], v3, s[32:35], s52 offen sc1
L_gc33:
    v_cmp_ne_u32 vcc, s78, v77
    v_cmp_ne_u32 s[84:85], s78, v79
    s_nop 1
    s_or_b64 vcc, vcc, s[84:85]
    s_cbranch_vccz L_gk34
    buffer_load_dwordx2 v[76:77], v27, s[32:35], s57 offen offset:0 sc1
    buffer_load_dwordx2 v[78:79], v27, s[32:35], s57 offen offset:64 sc1
    s_waitcnt vmcnt(0)
    s_add_u32 s79, s79, 1
    s_cmp_lt_u32 s79, 32768
    s_cbranch_scc1 L_gc33
L_gk34:
    v_and_b32 v54, 1, v2
    s_lshr_b32 s3, s13, 2
    v_lshlrev_b32 v54, 4, v54
    s_lshl_b32 s76, s3, 12
    v_lshrrev_b32 v80, v54, v76
    v_lshrrev_b32 v81, v54, v78
    v_lshlrev_b32 v82, 16, v80
    v_lshlrev_b32 v83, 16, v81
    v_sub_f32 v84, 1.0, v82
    v_sub_f32 v85, 1.0, v83
    v_cvt_pk_bf16_f32 v86, v13, v84
    v_cvt_pk_bf16_f32 v87, v13, v85
    v_lshrrev_b32 v84, 16, v86
    v_lshrrev_b32 v85, 16, v87
    v_dot2_f32_bf16 v128, v28, v84, 0
    v_dot2_f32_bf16 v129, v28, v86, 0
    v_dot2_f32_bf16 v130, v29, v84, 0
    v_dot2_f32_bf16 v131, v29, v86, 0
    v_dot2_f32_bf16 v132, v30, v84, 0
    v_dot2_f32_bf16 v133, v30, v86, 0
    v_dot2_f32_bf16 v134, v31, v84, 0
    v_dot2_f32_bf16 v135, v31, v86, 0
    v_dot2_f32_bf16 v136, v32, v84, 0
    v_dot2_f32_bf16 v137, v32, v86, 0
    v_dot2_f32_bf16 v138, v33, v84, 0
    v_dot2_f32_bf16 v139, v33, v86, 0
    v_dot2_f32_bf16 v140, v34, v84, 0
    v_dot2_f32_bf16 v141, v34, v86, 0
    v_dot2_f32_bf16 v142, v35, v84, 0
    v_dot2_f32_bf16 v143, v35, v86, 0
    v_dot2_f32_bf16 v144, v36, v85, 0
    v_dot2_f32_bf16 v145, v36, v87, 0
    v_dot2_f32_bf16 v146, v37, v85, 0
    v_dot2_f32_bf16 v147, v37, v87, 0
    v_dot2_f32_bf16 v148, v38, v85, 0
    v_dot2_f32_bf16 v149, v38, v87, 0
    v_dot2_f32_bf16 v150, v39, v85, 0
    v_dot2_f32_bf16 v151, v39, v87, 0
    v_dot2_f32_bf16 v152, v40, v85, 0
    v_dot2_f32_bf16 v153, v40, v87, 0
    v_dot2_f32_bf16 v154, v41, v85, 0
    v_dot2_f32_bf16 v155, v41, v87, 0
    v_dot2_f32_bf16 v156, v42, v85, 0
    v_dot2_f32_bf16 v157, v42, v87, 0
    v_dot2_f32_bf16 v158, v43, v85, 0
    v_dot2_f32_bf16 v159, v43, v87, 0
    s_and_b32 s3, s13, 3
    v_cvt_pk_bf16_f32 v28, v128, v129
    v_cvt_pk_bf16_f32 v29, v130, v131
    v_cvt_pk_bf16_f32 v30, v132, v133
    v_cvt_pk_bf16_f32 v31, v134, v135
    v_cvt_pk_bf16_f32 v32, v136, v137
    v_cvt_pk_bf16_f32 v33, v138, v139
    v_cvt_pk_bf16_f32 v34, v140, v141
    v_cvt_pk_bf16_f32 v35, v142, v143
    v_cvt_pk_bf16_f32 v36, v144, v145
    v_cvt_pk_bf16_f32 v37, v146, v147
    v_cvt_pk_bf16_f32 v38, v148, v149
    v_cvt_pk_bf16_f32 v39, v150, v151
    v_cvt_pk_bf16_f32 v40, v152, v153
    v_cvt_pk_bf16_f32 v41, v154, v155
    v_cvt_pk_bf16_f32 v42, v156, v157
    v_cvt_pk_bf16_f32 v43, v158, v159
    v_and_b32 v55, 15, v2
    v_lshlrev_b32 v90, 2, v2
    s_lshl_b32 s3, s3, 13
    s_add_u32 s76, s76, s3
    v_and_b32 v80, 0xffff, v80
    v_and_b32 v81, 0xffff, v81
    v_lshlrev_b32 v128, 16, v28
    v_and_b32 v129, 0xffff0000, v28
    v_lshlrev_b32 v130, 16, v29
    v_and_b32 v131, 0xffff0000, v29
    v_lshlrev_b32 v132, 16, v30
    v_and_b32 v133, 0xffff0000, v30
    v_lshlrev_b32 v134, 16, v31
    v_and_b32 v135, 0xffff0000, v31
    v_lshlrev_b32 v136, 16, v32
    v_and_b32 v137, 0xffff0000, v32
    v_lshlrev_b32 v138, 16, v33
    v_and_b32 v139, 0xffff0000, v33
    v_lshlrev_b32 v140, 16, v34
    v_and_b32 v141, 0xffff0000, v34
    v_lshlrev_b32 v142, 16, v35
    v_and_b32 v143, 0xffff0000, v35
    v_lshlrev_b32 v144, 16, v36
    v_and_b32 v145, 0xffff0000, v36
    v_lshlrev_b32 v146, 16, v37
    v_and_b32 v147, 0xffff0000, v37
    v_lshlrev_b32 v148, 16, v38
    v_and_b32 v149, 0xffff0000, v38
    v_lshlrev_b32 v150, 16, v39
    v_and_b32 v151, 0xffff0000, v39
    v_lshlrev_b32 v152, 16, v40
    v_and_b32 v153, 0xffff0000, v40
    v_lshlrev_b32 v154, 16, v41
    v_and_b32 v155, 0xffff0000, v41
    v_lshlrev_b32 v156, 16, v42
    v_and_b32 v157, 0xffff0000, v42
    v_lshlrev_b32 v158, 16, v43
    v_and_b32 v159, 0xffff0000, v43
    v_mov_b32 v160, 0
    v_mov_b32 v161, 0
    v_mov_b32 v162, 0
    v_mov_b32 v163, 0
    v_mov_b32 v164, 0
    v_mov_b32 v165, 0
    v_mov_b32 v166, 0
    v_mov_b32 v167, 0
    v_mov_b32 v168, 0
    v_mov_b32 v169, 0
    v_mov_b32 v170, 0
    v_mov_b32 v171, 0
    v_mov_b32 v172, 0
    v_mov_b32 v173, 0
    v_mov_b32 v174, 0
    v_mov_b32 v175, 0
    v_mov_b32 v176, 0
    v_mov_b32 v177, 0
    v_mov_b32 v178, 0
    v_mov_b32 v179, 0
    v_mov_b32 v180, 0
    v_mov_b32 v181, 0
    v_mov_b32 v182, 0
    v_mov_b32 v183, 0
    v_mov_b32 v184, 0
    v_mov_b32 v185, 0
    v_mov_b32 v186, 0
    v_mov_b32 v187, 0
    v_mov_b32 v188, 0
    v_mov_b32 v189, 0
    v_mov_b32 v190, 0
    v_mov_b32 v191, 0
    v_lshlrev_b32 v55, 7, v55
    v_and_b32 v90, 12, v90
    v_mov_b32 v91, 1
    s_and_b32 s76, s76, 0x7fff
    s_waitcnt vmcnt(0)
    s_mov_b64 exec, 1
    ds_add_rtn_u32 v88, v13, v91 offset:64
    s_mov_b64 exec, -1
    s_waitcnt lgkmcnt(0)
    v_readfirstlane_b32 s3, v88
    s_nop 1
    s_cmp_lg_u32 s3, 3
    s_cbranch_scc1 L_ow
    s_mov_b64 exec, 1
    buffer_store_dword v19, v13, s[32:35], s53 offen sc1
    s_mov_b64 exec, -1
L_of35:
    buffer_load_dword v54, v55, s[32:35], s56 offen sc1
    ds_read_b32 v88, v90 offset:208
    s_waitcnt vmcnt(0) lgkmcnt(0)
    v_cmp_ne_u32 vcc, s78, v54
    v_cmp_ne_u32 s[74:75], v88, v18
    s_nop 1
    s_or_b64 vcc, vcc, s[74:75]
    s_cbranch_vccz L_ofk36
    s_add_u32 s79, s79, 1
    s_cmp_lt_u32 s79, 32768
    s_cbranch_scc1 L_of35
L_ofk36:
    ds_write_b32 v13, v18 offset:112
L_ow:
    ds_read_b32 v88, v13 offset:112
    ds_read_b32 v89, v13 offset:16
    s_waitcnt lgkmcnt(0)
    v_cmp_ne_u32 vcc, v88, v18
    s_cbranch_vccz L_owk
    s_add_u32 s79, s79, 1
    s_cmp_lt_u32 s79, 262144
    s_cbranch_scc1 L_ow
L_owk:
    buffer_load_dwordx4 v[192:195], v24, s[60:63], s76 offen
    buffer_load_dwordx4 v[196:199], v25, s[60:63], s76 offen
    s_add_u32 s76, s76, 1024
    s_and_b32 s76, s76, 0x7fff
    buffer_load_dwordx4 v[200:203], v24, s[60:63], s76 offen
    buffer_load_dwordx4 v[204:207], v25, s[60:63], s76 offen
    s_add_u32 s76, s76, 1024
    s_and_b32 s76, s76, 0x7fff
    buffer_load_dwordx4 v[208:211], v24, s[60:63], s76 offen
    buffer_load_dwordx4 v[212:215], v25, s[60:63], s76 offen
    s_add_u32 s76, s76, 1024
    s_and_b32 s76, s76, 0x7fff
    buffer_load_dwordx4 v[216:219], v24, s[60:63], s76 offen
    buffer_load_dwordx4 v[220:223], v25, s[60:63], s76 offen
    s_add_u32 s76, s76, 1024
    s_and_b32 s76, s76, 0x7fff
    buffer_load_dwordx4 v[224:227], v24, s[60:63], s76 offen
    buffer_load_dwordx4 v[228:231], v25, s[60:63], s76 offen
    s_add_u32 s76, s76, 1024
    s_and_b32 s76, s76, 0x7fff
    buffer_load_dwordx4 v[232:235], v24, s[60:63], s76 offen
    buffer_load_dwordx4 v[236:239], v25, s[60:63], s76 offen
    s_add_u32 s76, s76, 1024
    s_and_b32 s76, s76, 0x7fff
    buffer_load_dwordx4 v[240:243], v24, s[60:63], s76 offen
    buffer_load_dwordx4 v[244:247], v25, s[60:63], s76 offen
    s_add_u32 s76, s76, 1024
    s_and_b32 s76, s76, 0x7fff
    buffer_load_dwordx4 v[248:251], v24, s[60:63], s76 offen
    buffer_load_dwordx4 v[252:255], v25, s[60:63], s76 offen
    s_add_u32 s76, s76, 1024
    s_and_b32 s76, s76, 0x7fff
    ds_read_b64_tr_b16 v[96:97], v20 offset:0
    ds_read_b64_tr_b16 v[98:99], v20 offset:2048
    ds_read_b64_tr_b16 v[100:101], v21 offset:0
    ds_read_b64_tr_b16 v[102:103], v21 offset:2048
    ds_read_b64_tr_b16 v[104:105], v22 offset:0
    ds_read_b64_tr_b16 v[106:107], v22 offset:2048
    ds_read_b64_tr_b16 v[108:109], v23 offset:0
    ds_read_b64_tr_b16 v[110:111], v23 offset:2048
    v_readfirstlane_b32 s77, v89
    s_mov_b32 s66, 0
    s_mov_b32 s3, 32768
.p2align 6
L_p5:
    s_cmp_eq_u32 s66, 3
    s_cselect_b32 s62, 0, s62
    s_cselect_b32 s3, 0, s3
    s_waitcnt vmcnt(14) lgkmcnt(6)
    v_mfma_f32_16x16x32_bf16 v[160:163], v[96:99], v[192:195], v[160:163]
    ds_read_b64_tr_b16 v[112:113], v20 offset:4096
    v_mfma_f32_16x16x32_bf16 v[176:179], v[96:99], v[196:199], v[176:179]
    ds_read_b64_tr_b16 v[114:115], v20 offset:6144
    s_waitcnt lgkmcnt(6)
    v_mfma_f32_16x16x32_bf16 v[164:167], v[100:103], v[192:195], v[164:167]
    ds_read_b64_tr_b16 v[116:117], v21 offset:4096
    v_mfma_f32_16x16x32_bf16 v[180:183], v[100:103], v[196:199], v[180:183]
    ds_read_b64_tr_b16 v[118:119], v21 offset:6144
    s_waitcnt lgkmcnt(6)
    v_mfma_f32_16x16x32_bf16 v[168:171], v[104:107], v[192:195], v[168:171]
    ds_read_b64_tr_b16 v[120:121], v22 offset:4096
    v_mfma_f32_16x16x32_bf16 v[184:187], v[104:107], v[196:199], v[184:187]
    ds_read_b64_tr_b16 v[122:123], v22 offset:6144
    s_waitcnt lgkmcnt(6)
    v_mfma_f32_16x16x32_bf16 v[172:175], v[108:111], v[192:195], v[172:175]
    ds_read_b64_tr_b16 v[124:125], v23 offset:4096
    v_mfma_f32_16x16x32_bf16 v[188:191], v[108:111], v[196:199], v[188:191]
    ds_read_b64_tr_b16 v[126:127], v23 offset:6144
    buffer_load_dwordx4 v[192:195], v24, s[60:63], s76 offen
    buffer_load_dwordx4 v[196:199], v25, s[60:63], s76 offen
    s_add_u32 s76, s76, 1024
    s_and_b32 s76, s76, 0x7fff
    s_waitcnt vmcnt(14) lgkmcnt(6)
    v_mfma_f32_16x16x32_bf16 v[160:163], v[112:115], v[200:203], v[160:163]
    ds_read_b64_tr_b16 v[96:97], v20 offset:8192
    v_mfma_f32_16x16x32_bf16 v[176:179], v[112:115], v[204:207], v[176:179]
    ds_read_b64_tr_b16 v[98:99], v20 offset:10240
    s_waitcnt lgkmcnt(6)
    v_mfma_f32_16x16x32_bf16 v[164:167], v[116:119], v[200:203], v[164:167]
    ds_read_b64_tr_b16 v[100:101], v21 offset:8192
    v_mfma_f32_16x16x32_bf16 v[180:183], v[116:119], v[204:207], v[180:183]
    ds_read_b64_tr_b16 v[102:103], v21 offset:10240
    s_waitcnt lgkmcnt(6)
    v_mfma_f32_16x16x32_bf16 v[168:171], v[120:123], v[200:203], v[168:171]
    ds_read_b64_tr_b16 v[104:105], v22 offset:8192
    v_mfma_f32_16x16x32_bf16 v[184:187], v[120:123], v[204:207], v[184:187]
    ds_read_b64_tr_b16 v[106:107], v22 offset:10240
    s_waitcnt lgkmcnt(6)
    v_mfma_f32_16x16x32_bf16 v[172:175], v[124:127], v[200:203], v[172:175]
    ds_read_b64_tr_b16 v[108:109], v23 offset:8192
    v_mfma_f32_16x16x32_bf16 v[188:191], v[124:127], v[204:207], v[188:191]
    ds_read_b64_tr_b16 v[110:111], v23 offset:10240
    buffer_load_dwordx4 v[200:203], v24, s[60:63], s76 offen
    buffer_load_dwordx4 v[204:207], v25, s[60:63], s76 offen
    s_add_u32 s76, s76, 1024
    s_and_b32 s76, s76, 0x7fff
    s_waitcnt vmcnt(14) lgkmcnt(6)
    v_mfma_f32_16x16x32_bf16 v[160:163], v[96:99], v[208:211], v[160:163]
    ds_read_b64_tr_b16 v[112:113], v20 offset:12288
    v_mfma_f32_16x16x32_bf16 v[176:179], v[96:99], v[212:215], v[176:179]
    ds_read_b64_tr_b16 v[114:115], v20 offset:14336
    s_waitcnt lgkmcnt(6)
    v_mfma_f32_16x16x32_bf16 v[164:167], v[100:103], v[208:211], v[164:167]
    ds_read_b64_tr_b16 v[116:117], v21 offset:12288
    v_mfma_f32_16x16x32_bf16 v[180:183], v[100:103], v[212:215], v[180:183]
    ds_read_b64_tr_b16 v[118:119], v21 offset:14336
    s_waitcnt lgkmcnt(6)
    v_mfma_f32_16x16x32_bf16 v[168:171], v[104:107], v[208:211], v[168:171]
    ds_read_b64_tr_b16 v[120:121], v22 offset:12288
    v_mfma_f32_16x16x32_bf16 v[184:187], v[104:107], v[212:215], v[184:187]
    ds_read_b64_tr_b16 v[122:123], v22 offset:14336
    s_waitcnt lgkmcnt(6)
    v_mfma_f32_16x16x32_bf16 v[172:175], v[108:111], v[208:211], v[172:175]
    ds_read_b64_tr_b16 v[124:125], v23 offset:12288
    v_mfma_f32_16x16x32_bf16 v[188:191], v[108:111], v[212:215], v[188:191]
    ds_read_b64_tr_b16 v[126:127], v23 offset:14336
    buffer_load_dwordx4 v[208:211], v24, s[60:63], s76 offen
    buffer_load_dwordx4 v[212:215], v25, s[60:63], s76 offen
    s_add_u32 s76, s76, 1024
    s_and_b32 s76, s76, 0x7fff
    s_waitcnt vmcnt(14) lgkmcnt(6)
    v_mfma_f32_16x16x32_bf16 v[160:163], v[112:115], v[216:219], v[160:163]
    ds_read_b64_tr_b16 v[96:97], v20 offset:16384
    v_mfma_f32_16x16x32_bf16 v[176:179], v[112:115], v[220:223], v[176:179]
    ds_read_b64_tr_b16 v[98:99], v20 offset:18432
    s_waitcnt lgkmcnt(6)
    v_mfma_f32_16x16x32_bf16 v[164:167], v[116:119], v[216:219], v[164:167]
    ds_read_b64_tr_b16 v[100:101], v21 offset:16384
    v_mfma_f32_16x16x32_bf16 v[180:183], v[116:119], v[220:223], v[180:183]
    ds_read_b64_tr_b16 v[102:103], v21 offset:18432
    s_waitcnt lgkmcnt(6)
    v_mfma_f32_16x16x32_bf16 v[168:171], v[120:123], v[216:219], v[168:171]
    ds_read_b64_tr_b16 v[104:105], v22 offset:16384
    v_mfma_f32_16x16x32_bf16 v[184:187], v[120:123], v[220:223], v[184:187]
    ds_read_b64_tr_b16 v[106:107], v22 offset:18432
    s_waitcnt lgkmcnt(6)
    v_mfma_f32_16x16x32_bf16 v[172:175], v[124:127], v[216:219], v[172:175]
    ds_read_b64_tr_b16 v[108:109], v23 offset:16384
    v_mfma_f32_16x16x32_bf16 v[188:191], v[124:127], v[220:223], v[188:191]
    ds_read_b64_tr_b16 v[110:111], v23 offset:18432
    buffer_load_dwordx4 v[216:219], v24, s[60:63], s76 offen
    buffer_load_dwordx4 v[220:223], v25, s[60:63], s76 offen
    s_add_u32 s76, s76, 1024
    s_and_b32 s76, s76, 0x7fff
    s_waitcnt vmcnt(14) lgkmcnt(6)
    v_mfma_f32_16x16x32_bf16 v[160:163], v[96:99], v[224:227], v[160:163]
    ds_read_b64_tr_b16 v[112:113], v20 offset:20480
    v_mfma_f32_16x16x32_bf16 v[176:179], v[96:99], v[228:231], v[176:179]
    ds_read_b64_tr_b16 v[114:115], v20 offset:22528
    s_waitcnt lgkmcnt(6)
    v_mfma_f32_16x16x32_bf16 v[164:167], v[100:103], v[224:227], v[164:167]
    ds_read_b64_tr_b16 v[116:117], v21 offset:20480
    v_mfma_f32_16x16x32_bf16 v[180:183], v[100:103], v[228:231], v[180:183]
    ds_read_b64_tr_b16 v[118:119], v21 offset:22528
    s_waitcnt lgkmcnt(6)
    v_mfma_f32_16x16x32_bf16 v[168:171], v[104:107], v[224:227], v[168:171]
    ds_read_b64_tr_b16 v[120:121], v22 offset:20480
    v_mfma_f32_16x16x32_bf16 v[184:187], v[104:107], v[228:231], v[184:187]
    ds_read_b64_tr_b16 v[122:123], v22 offset:22528
    s_waitcnt lgkmcnt(6)
    v_mfma_f32_16x16x32_bf16 v[172:175], v[108:111], v[224:227], v[172:175]
    ds_read_b64_tr_b16 v[124:125], v23 offset:20480
    v_mfma_f32_16x16x32_bf16 v[188:191], v[108:111], v[228:231], v[188:191]
    ds_read_b64_tr_b16 v[126:127], v23 offset:22528
    buffer_load_dwordx4 v[224:227], v24, s[60:63], s76 offen
    buffer_load_dwordx4 v[228:231], v25, s[60:63], s76 offen
    s_add_u32 s76, s76, 1024
    s_and_b32 s76, s76, 0x7fff
    s_waitcnt vmcnt(14) lgkmcnt(6)
    v_mfma_f32_16x16x32_bf16 v[160:163], v[112:115], v[232:235], v[160:163]
    ds_read_b64_tr_b16 v[96:97], v20 offset:24576
    v_mfma_f32_16x16x32_bf16 v[176:179], v[112:115], v[236:239], v[176:179]
    ds_read_b64_tr_b16 v[98:99], v20 offset:26624
    s_waitcnt lgkmcnt(6)
    v_mfma_f32_16x16x32_bf16 v[164:167], v[116:119], v[232:235], v[164:167]
    ds_read_b64_tr_b16 v[100:101], v21 offset:24576
    v_mfma_f32_16x16x32_bf16 v[180:183], v[116:119], v[236:239], v[180:183]
    ds_read_b64_tr_b16 v[102:103], v21 offset:26624
    s_waitcnt lgkmcnt(6)
    v_mfma_f32_16x16x32_bf16 v[168:171], v[120:123], v[232:235], v[168:171]
    ds_read_b64_tr_b16 v[104:105], v22 offset:24576
    v_mfma_f32_16x16x32_bf16 v[184:187], v[120:123], v[236:239], v[184:187]
    ds_read_b64_tr_b16 v[106:107], v22 offset:26624
    s_waitcnt lgkmcnt(6)
    v_mfma_f32_16x16x32_bf16 v[172:175], v[124:127], v[232:235], v[172:175]
    ds_read_b64_tr_b16 v[108:109], v23 offset:24576
    v_mfma_f32_16x16x32_bf16 v[188:191], v[124:127], v[236:239], v[188:191]
    ds_read_b64_tr_b16 v[110:111], v23 offset:26624
    buffer_load_dwordx4 v[232:235], v24, s[60:63], s76 offen
    buffer_load_dwordx4 v[236:239], v25, s[60:63], s76 offen
    s_add_u32 s76, s76, 1024
    s_and_b32 s76, s76, 0x7fff
    s_waitcnt vmcnt(14) lgkmcnt(6)
    v_mfma_f32_16x16x32_bf16 v[160:163], v[96:99], v[240:243], v[160:163]
    ds_read_b64_tr_b16 v[112:113], v20 offset:28672
    v_mfma_f32_16x16x32_bf16 v[176:179], v[96:99], v[244:247], v[176:179]
    ds_read_b64_tr_b16 v[114:115], v20 offset:30720
    s_waitcnt lgkmcnt(6)
    v_mfma_f32_16x16x32_bf16 v[164:167], v[100:103], v[240:243], v[164:167]
    ds_read_b64_tr_b16 v[116:117], v21 offset:28672
    v_mfma_f32_16x16x32_bf16 v[180:183], v[100:103], v[244:247], v[180:183]
    ds_read_b64_tr_b16 v[118:119], v21 offset:30720
    s_waitcnt lgkmcnt(6)
    v_mfma_f32_16x16x32_bf16 v[168:171], v[104:107], v[240:243], v[168:171]
    ds_read_b64_tr_b16 v[120:121], v22 offset:28672
    v_mfma_f32_16x16x32_bf16 v[184:187], v[104:107], v[244:247], v[184:187]
    ds_read_b64_tr_b16 v[122:123], v22 offset:30720
    s_waitcnt lgkmcnt(6)
    v_mfma_f32_16x16x32_bf16 v[172:175], v[108:111], v[240:243], v[172:175]
    ds_read_b64_tr_b16 v[124:125], v23 offset:28672
    v_mfma_f32_16x16x32_bf16 v[188:191], v[108:111], v[244:247], v[188:191]
    ds_read_b64_tr_b16 v[126:127], v23 offset:30720
    buffer_load_dwordx4 v[240:243], v24, s[60:63], s76 offen
    buffer_load_dwordx4 v[244:247], v25, s[60:63], s76 offen
    s_add_u32 s76, s76, 1024
    s_and_b32 s76, s76, 0x7fff
    v_add_u32 v20, s3, v20
    v_add_u32 v21, s3, v21
    v_add_u32 v22, s3, v22
    v_add_u32 v23, s3, v23
    s_waitcnt vmcnt(14) lgkmcnt(6)
    v_mfma_f32_16x16x32_bf16 v[160:163], v[112:115], v[248:251], v[160:163]
    ds_read_b64_tr_b16 v[96:97], v20 offset:0
    v_mfma_f32_16x16x32_bf16 v[176:179], v[112:115], v[252:255], v[176:179]
    ds_read_b64_tr_b16 v[98:99], v20 offset:2048
    s_waitcnt lgkmcnt(6)
    v_mfma_f32_16x16x32_bf16 v[164:167], v[116:119], v[248:251], v[164:167]
    ds_read_b64_tr_b16 v[100:101], v21 offset:0
    v_mfma_f32_16x16x32_bf16 v[180:183], v[116:119], v[252:255], v[180:183]
    ds_read_b64_tr_b16 v[102:103], v21 offset:2048
    s_waitcnt lgkmcnt(6)
    v_mfma_f32_16x16x32_bf16 v[168:171], v[120:123], v[248:251], v[168:171]
    ds_read_b64_tr_b16 v[104:105], v22 offset:0
    v_mfma_f32_16x16x32_bf16 v[184:187], v[120:123], v[252:255], v[184:187]
    ds_read_b64_tr_b16 v[106:107], v22 offset:2048
    s_waitcnt lgkmcnt(6)
    v_mfma_f32_16x16x32_bf16 v[172:175], v[124:127], v[248:251], v[172:175]
    ds_read_b64_tr_b16 v[108:109], v23 offset:0
    v_mfma_f32_16x16x32_bf16 v[188:191], v[124:127], v[252:255], v[188:191]
    ds_read_b64_tr_b16 v[110:111], v23 offset:2048
    buffer_load_dwordx4 v[248:251], v24, s[60:63], s76 offen
    buffer_load_dwordx4 v[252:255], v25, s[60:63], s76 offen
    s_add_u32 s76, s76, 1024
    s_and_b32 s76, s76, 0x7fff
    s_add_u32 s66, s66, 1
    s_cmp_lt_u32 s66, 4
    s_cbranch_scc1 L_p5
    s_waitcnt lgkmcnt(0)
    s_lshr_b32 s77, s77, 4
    s_and_b32 s77, s77, 2047
    s_sub_u32 s77, 2047, s77
    s_lshr_b32 s19, s77, 5
    s_cmp_eq_u32 s19, s58
    s_cbranch_scc1 L_own
L_ownret:
    v_cvt_pk_bf16_f32 v160, v160, v161
    v_cvt_pk_bf16_f32 v161, v162, v163
    v_cvt_pk_bf16_f32 v168, v168, v169
    v_cvt_pk_bf16_f32 v162, v164, v165
    v_cvt_pk_bf16_f32 v163, v166, v167
    v_cvt_pk_bf16_f32 v169, v170, v171
    v_cvt_pk_bf16_f32 v176, v176, v177
    v_cvt_pk_bf16_f32 v170, v172, v173
    v_cvt_pk_bf16_f32 v171, v174, v175
    v_cvt_pk_bf16_f32 v177, v178, v179
    v_cvt_pk_bf16_f32 v184, v184, v185
    v_cvt_pk_bf16_f32 v178, v180, v181
    v_cvt_pk_bf16_f32 v179, v182, v183
    v_cvt_pk_bf16_f32 v185, v186, v187
    v_permlane16_swap_b32 v160, v162
    v_permlane16_swap_b32 v161, v163
    v_cvt_pk_bf16_f32 v186, v188, v189
    v_cvt_pk_bf16_f32 v187, v190, v191
    v_permlane16_swap_b32 v168, v170
    v_permlane16_swap_b32 v169, v171
    v_dot2_f32_bf16 v96, v160, v80, 0
    v_dot2_f32_bf16 v97, v160, v82, 0
    v_dot2_f32_bf16 v98, v161, v80, 0
    v_dot2_f32_bf16 v99, v161, v82, 0
    v_dot2_f32_bf16 v100, v162, v80, 0
    v_dot2_f32_bf16 v101, v162, v82, 0
    v_dot2_f32_bf16 v102, v163, v80, 0
    v_dot2_f32_bf16 v103, v163, v82, 0
    v_permlane16_swap_b32 v176, v178
    v_permlane16_swap_b32 v177, v179
    v_dot2_f32_bf16 v104, v168, v80, 0
    v_dot2_f32_bf16 v105, v168, v82, 0
    v_dot2_f32_bf16 v106, v169, v80, 0
    v_dot2_f32_bf16 v107, v169, v82, 0
    v_dot2_f32_bf16 v108, v170, v80, 0
    v_dot2_f32_bf16 v109, v170, v82, 0
    v_dot2_f32_bf16 v110, v171, v80, 0
    v_dot2_f32_bf16 v111, v171, v82, 0
    v_permlane16_swap_b32 v184, v186
    v_permlane16_swap_b32 v185, v187
    v_dot2_f32_bf16 v112, v176, v81, 0
    v_dot2_f32_bf16 v113, v176, v83, 0
    v_dot2_f32_bf16 v114, v177, v81, 0
    v_dot2_f32_bf16 v115, v177, v83, 0
    v_dot2_f32_bf16 v116, v178, v81, 0
    v_dot2_f32_bf16 v117, v178, v83, 0
    v_dot2_f32_bf16 v118, v179, v81, 0
    v_dot2_f32_bf16 v119, v179, v83, 0
    v_dot2_f32_bf16 v120, v184, v81, 0
    v_dot2_f32_bf16 v121, v184, v83, 0
    v_dot2_f32_bf16 v122, v185, v81, 0
    v_dot2_f32_bf16 v123, v185, v83, 0
    v_dot2_f32_bf16 v124, v186, v81, 0
    v_dot2_f32_bf16 v125, v186, v83, 0
    v_dot2_f32_bf16 v126, v187, v81, 0
    v_dot2_f32_bf16 v127, v187, v83, 0
    v_cvt_pk_bf16_f32 v160, v96, v97
    v_cvt_pk_bf16_f32 v161, v98, v99
    v_cvt_pk_bf16_f32 v162, v100, v101
    v_cvt_pk_bf16_f32 v163, v102, v103
    s_mov_b32 s74, 0x3f80
    s_mov_b32 s75, 0x3f800000
    v_cvt_pk_bf16_f32 v168, v104, v105
    v_cvt_pk_bf16_f32 v169, v106, v107
    v_cvt_pk_bf16_f32 v170, v108, v109
    v_cvt_pk_bf16_f32 v171, v110, v111
    v_dot2_f32_bf16 v96, v160, s74, v128
    v_dot2_f32_bf16 v97, v160, s75, v129
    v_dot2_f32_bf16 v98, v161, s74, v130
    v_dot2_f32_bf16 v99, v161, s75, v131
    v_dot2_f32_bf16 v100, v162, s74, v132
    v_dot2_f32_bf16 v101, v162, s75, v133
    v_dot2_f32_bf16 v102, v163, s74, v134
    v_dot2_f32_bf16 v103, v163, s75, v135
    v_cvt_pk_bf16_f32 v176, v112, v113
    v_cvt_pk_bf16_f32 v177, v114, v115
    v_cvt_pk_bf16_f32 v178, v116, v117
    v_cvt_pk_bf16_f32 v179, v118, v119
    v_dot2_f32_bf16 v104, v168, s74, v136
    v_dot2_f32_bf16 v105, v168, s75, v137
    v_dot2_f32_bf16 v106, v169, s74, v138
    v_dot2_f32_bf16 v107, v169, s75, v139
    v_dot2_f32_bf16 v108, v170, s74, v140
    v_dot2_f32_bf16 v109, v170, s75, v141
    v_dot2_f32_bf16 v110, v171, s74, v142
    v_dot2_f32_bf16 v111, v171, s75, v143
    v_cvt_pk_bf16_f32 v184, v120, v121
    v_cvt_pk_bf16_f32 v185, v122, v123
    v_cvt_pk_bf16_f32 v186, v124, v125
    v_cvt_pk_bf16_f32 v187, v126, v127
    v_dot2_f32_bf16 v112, v176, s74, v144
    v_dot2_f32_bf16 v113, v176, s75, v145
    v_dot2_f32_bf16 v114, v177, s74, v146
    v_dot2_f32_bf16 v115, v177, s75, v147
    v_dot2_f32_bf16 v116, v178, s74, v148
    v_dot2_f32_bf16 v117, v178, s75, v149
    v_dot2_f32_bf16 v118, v179, s74, v150
    v_dot2_f32_bf16 v119, v179, s75, v151
    v_dot2_f32_bf16 v120, v184, s74, v152
    v_dot2_f32_bf16 v121, v184, s75, v153
    v_dot2_f32_bf16 v122, v185, s74, v154
    v_dot2_f32_bf16 v123, v185, s75, v155
    v_dot2_f32_bf16 v124, v186, s74, v156
    v_dot2_f32_bf16 v125, v186, s75, v157
    v_dot2_f32_bf16 v126, v187, s74, v158
    v_dot2_f32_bf16 v127, v187, s75, v159
    v_cvt_pk_bf16_f32 v160, v96, v97
    v_cvt_pk_bf16_f32 v161, v98, v99
    v_cvt_pk_bf16_f32 v162, v100, v101
    v_cvt_pk_bf16_f32 v163, v102, v103
    v_cvt_pk_bf16_f32 v168, v104, v105
    v_cvt_pk_bf16_f32 v169, v106, v107
    v_cvt_pk_bf16_f32 v170, v108, v109
    v_cvt_pk_bf16_f32 v171, v110, v111
    buffer_store_dwordx4 v[160:163], v26, s[44:47], s54 offen offset:0 sc1
    v_cvt_pk_bf16_f32 v176, v112, v113
    v_cvt_pk_bf16_f32 v177, v114, v115
    v_cvt_pk_bf16_f32 v178, v116, v117
    v_cvt_pk_bf16_f32 v179, v118, v119
    buffer_store_dwordx4 v[168:171], v26, s[44:47], s54 offen offset:64 sc1
    v_cvt_pk_bf16_f32 v184, v120, v121
    v_cvt_pk_bf16_f32 v185, v122, v123
    v_cvt_pk_bf16_f32 v186, v124, v125
    v_cvt_pk_bf16_f32 v187, v126, v127
    buffer_store_dwordx4 v[176:179], v26, s[44:47], s55 offen offset:0 sc1
    buffer_store_dwordx4 v[184:187], v26, s[44:47], s55 offen offset:64 sc1
    s_endpgm
L_own:
    v_and_b32 v54, 16, v2
    v_lshlrev_b32 v54, 2, v54
    v_and_b32 v55, 32, v2
    v_add_u32 v54, v54, v55
L_xo37:
    ds_read_b32 v88, v13 offset:224
    ds_read_b128 v[96:99], v54 offset:512
    ds_read_b128 v[100:103], v54 offset:528
    ds_read_b128 v[104:107], v54 offset:640
    ds_read_b128 v[108:111], v54 offset:656
    s_waitcnt lgkmcnt(0)
    v_cmp_ne_u32 vcc, v88, v18
    s_cbranch_vccz L_xk38
    s_add_u32 s79, s79, 1
    s_cmp_lt_u32 s79, 32768
    s_cbranch_scc1 L_xo37
L_xk38:
    s_and_b32 s77, s77, 31
    v_and_b32 v54, 15, v2
    v_cmp_eq_u32 vcc, s77, v54
    s_nop 1
    v_cndmask_b32 v128, v128, v96, vcc
    v_cndmask_b32 v129, v129, v97, vcc
    v_cndmask_b32 v130, v130, v98, vcc
    v_cndmask_b32 v131, v131, v99, vcc
    v_cndmask_b32 v132, v132, v100, vcc
    v_cndmask_b32 v133, v133, v101, vcc
    v_cndmask_b32 v134, v134, v102, vcc
    v_cndmask_b32 v135, v135, v103, vcc
    v_cndmask_b32 v136, v136, v104, vcc
    v_cndmask_b32 v137, v137, v105, vcc
    v_cndmask_b32 v138, v138, v106, vcc
    v_cndmask_b32 v139, v139, v107, vcc
    v_cndmask_b32 v140, v140, v108, vcc
    v_cndmask_b32 v141, v141, v109, vcc
    v_cndmask_b32 v142, v142, v110, vcc
    v_cndmask_b32 v143, v143, v111, vcc
    v_add_u32 v54, 16, v54
    v_cmp_eq_u32 vcc, s77, v54
    s_nop 1
    v_cndmask_b32 v144, v144, v96, vcc
    v_cndmask_b32 v145, v145, v97, vcc
    v_cndmask_b32 v146, v146, v98, vcc
    v_cndmask_b32 v147, v147, v99, vcc
    v_cndmask_b32 v148, v148, v100, vcc
    v_cndmask_b32 v149, v149, v101, vcc
    v_cndmask_b32 v150, v150, v102, vcc
    v_cndmask_b32 v151, v151, v103, vcc
    v_cndmask_b32 v152, v152, v104, vcc
    v_cndmask_b32 v153, v153, v105, vcc
    v_cndmask_b32 v154, v154, v106, vcc
    v_cndmask_b32 v155, v155, v107, vcc
    v_cndmask_b32 v156, v156, v108, vcc
    v_cndmask_b32 v157, v157, v109, vcc
    v_cndmask_b32 v158, v158, v110, vcc
    v_cndmask_b32 v159, v159, v111, vcc
    s_branch L_ownret
L_k2s:
    v_pk_add_f32 v[192:193], v[192:193], v[120:121]
    v_pk_add_f32 v[194:195], v[194:195], v[122:123]
    v_bfi_b32 v192, v15, s80, v192
    v_bfi_b32 v193, v15, s81, v193
    v_bfi_b32 v194, v15, s82, v194
    v_bfi_b32 v195, v15, s83, v195
    v_pk_add_f32 v[196:197], v[196:197], v[124:125]
    v_pk_add_f32 v[198:199], v[198:199], v[126:127]
    v_bfi_b32 v196, v15, s80, v196
    v_bfi_b32 v197, v15, s81, v197
    v_bfi_b32 v198, v15, s82, v198
    v_bfi_b32 v199, v15, s83, v199
    v_pk_add_f32 v[200:201], v[200:201], v[128:129]
    v_pk_add_f32 v[202:203], v[202:203], v[130:131]
    buffer_store_dwordx4 v[192:195], v3, s[32:35], s48 offen sc1
    s_add_u32 s48, s48, 16384
    v_bfi_b32 v200, v15, s80, v200
    v_bfi_b32 v201, v15, s81, v201
    v_bfi_b32 v202, v15, s82, v202
    v_bfi_b32 v203, v15, s83, v203
    v_pk_add_f32 v[204:205], v[204:205], v[132:133]
    v_pk_add_f32 v[206:207], v[206:207], v[134:135]
    buffer_store_dwordx4 v[196:199], v3, s[32:35], s48 offen sc1
    s_add_u32 s48, s48, 16384
    v_bfi_b32 v204, v15, s80, v204
    v_bfi_b32 v205, v15, s81, v205
    v_bfi_b32 v206, v15, s82, v206
    v_bfi_b32 v207, v15, s83, v207
    v_pk_add_f32 v[208:209], v[208:209], v[112:113]
    v_pk_add_f32 v[210:211], v[210:211], v[114:115]
    v_pk_add_f32 v[212:213], v[212:213], v[116:117]
    v_pk_add_f32 v[214:215], v[214:215], v[118:119]
    buffer_store_dwordx4 v[200:203], v3, s[32:35], s48 offen sc1
    s_add_u32 s48, s48, 16384
    v_bfi_b32 v208, v15, s80, v208
    v_bfi_b32 v209, v15, s81, v209
    v_bfi_b32 v210, v15, s82, v210
    v_bfi_b32 v211, v15, s83, v211
    v_bfi_b32 v212, v15, s80, v212
    v_bfi_b32 v213, v15, s81, v213
    v_bfi_b32 v214, v15, s82, v214
    v_bfi_b32 v215, v15, s83, v215
    buffer_store_dwordx4 v[204:207], v3, s[32:35], s48 offen sc1
    s_mov_b32 exec_lo, 0x10001
    s_mov_b32 exec_hi, 0x10001
    buffer_store_dwordx4 v[208:211], v8, s[32:35], s49 offen offset:0 sc1
    buffer_store_dwordx4 v[212:215], v8, s[32:35], s49 offen offset:1024 sc1
    s_mov_b64 exec, -1
    s_branch L_k2r
L_h1s:
    s_mov_b32 exec_lo, 0xffff
    s_mov_b32 exec_hi, 0xffff
    buffer_store_dword v96, v11, s[32:35], s64 offen sc1
    s_lshl_b64 exec, 1, s16
    buffer_store_dword v92, v13, s[32:35], s65 offen sc1
    s_mov_b64 exec, -1
    s_branch L_h1r
L_end:
    s_endpgm
.section .rodata,"a"
.p2align 6
.amdhsa_kernel fk_kernel
  .amdhsa_next_free_vgpr 256
  .amdhsa_next_free_sgpr 102
  .amdhsa_accum_offset 256
  .amdhsa_group_segment_fixed_size 0
  .amdhsa_kernarg_size 104
  .amdhsa_user_sgpr_count 2
  .amdhsa_user_sgpr_kernarg_segment_ptr 1
  .amdhsa_system_sgpr_workgroup_id_x 1
.end_amdhsa_kernel
```

```asm
; @launch kernel=fk_kernel grid=(256,1,1) block=(512,1,1) lds=163840
.amdgcn_target "amdgcn-amd-amdhsa--gfx950"
.text
.globl fk_kernel
.p2align 8
.type fk_kernel,@function
fk_kernel:
    s_load_dwordx4 s[4:7], s[0:1], 0
    s_load_dwordx4 s[8:11], s[0:1], 16
    s_load_dwordx16 s[84:99], s[0:1], 40
    s_getpc_b64 s[66:67]
L_cep:
    v_lshrrev_b32 v1, 6, v0
    s_and_b32 s3, s2, -8
    v_readfirstlane_b32 s16, v1
    s_nop 1
    s_add_u32 s3, s3, s16
    s_lshl_b32 s3, s3, 6
    s_min_u32 s3, s3, L_end-L_cep-4
    s_load_dword s68, s[66:67], s3
    s_cmp_ge_u32 s2, 256
    s_cbranch_scc1 L_end
    v_lshrrev_b32 v1, 6, v0
    v_and_b32 v2, 63, v0
    v_readfirstlane_b32 s16, v1
    v_lshrrev_b32 v4, 3, v2
    v_lshlrev_b32 v5, 11, v4
    v_and_b32 v6, 7, v2
    v_lshrrev_b32 v7, 4, v2
    v_xor_b32 v8, v6, v7
    v_lshl_add_u32 v10, v8, 4, v5
    v_xor_b32 v8, 4, v8
    v_lshl_add_u32 v11, v8, 4, v5
    v_mul_u32_u24 v5, 6144, v4
    v_and_b32 v7, 1, v7
    v_lshlrev_b32 v7, 2, v7
    v_xor_b32 v8, v6, v7
    s_and_b32 s12, s2, 7
    s_lshr_b32 s13, s2, 3
    s_and_b32 s14, s13, 15
    s_lshl_b32 s15, s12, 1
    s_lshr_b32 s19, s13, 4
    s_add_u32 s15, s15, s19
    s_and_b32 s17, s16, 3
    s_and_b32 s19, s16, 1
    s_lshl_b32 s19, s19, 1
    v_xor_b32 v8, s19, v8
    v_lshl_add_u32 v12, v8, 4, v5
    s_lshl_b32 s19, s14, 18
    v_add_u32 v10, s19, v10
    v_add_u32 v11, s19, v11
    s_lshl_b32 s19, s15, 7
    v_add_u32 v12, s19, v12
    s_lshl_b32 s64, s15, 1
    s_add_u32 s64, s64, s14
    s_andn2_b32 s76, 1, s15
    s_mul_i32 s76, s76, 0
    s_add_u32 s76, s76, s14
    s_bitcmp1_b32 3084, s15
    s_cselect_b32 s64, s76, s64
    s_and_b32 s64, s64, 3
    s_add_u32 s65, s12, 0
    s_and_b32 s65, s65, 3
    s_lshl_b32 s65, s65, 2
    s_and_b32 s72, s64, 3
    s_add_u32 s72, s72, s65
    s_mul_i32 s73, s72, 393216
    s_lshl_b32 s72, s72, 7
    s_lshl_b32 s74, s16, 15
    s_add_u32 s72, s72, s74
    s_mul_i32 s74, s16, 49152
    s_add_u32 s73, s73, s74
    s_lshl_b32 s75, s16, 10
    s_lshl_b32 m0, s16, 11
    s_add_u32 s74, s72, 16384
    s_waitcnt lgkmcnt(0)
    s_mov_b64 s[24:25], s[4:5]
    s_mov_b32 s26, 4194304
    s_mov_b32 s27, 0x00020000
    buffer_load_dwordx4 v10, s[24:27], s72 offen lds
    s_addk_i32 m0, 1024
    s_mov_b64 s[28:29], s[6:7]
    s_mov_b32 s30, 6291456
    s_mov_b32 s31, 0x00020000
    buffer_load_dwordx4 v11, s[24:27], s74 offen lds
    s_add_u32 m0, s75, 16384
    s_nop 0
    buffer_load_dwordx4 v12, s[28:31], s73 offen lds
    s_add_u32 m0, s75, 24576
    s_addk_i32 s73, 2048
    buffer_load_dwordx4 v12, s[28:31], s73 offen lds
    s_add_u32 m0, s75, 32768
    s_addk_i32 s73, 2048
    buffer_load_dwordx4 v12, s[28:31], s73 offen lds
    s_cmp_lt_u32 s16, 4
    s_cbranch_scc1 L_compute
    s_bfe_u32 s19, s14, 0x10002
    s_lshl_b32 s19, s19, 2
    s_add_u32 s19, s19, s17
    s_xor_b32 s3, s19, 4
    s_mul_i32 s66, s19, 49152
    s_mul_i32 s67, s3, 49152
    s_lshl_b32 s68, s19, 10
    s_add_u32 s68, s68, 16384
    s_lshl_b32 s69, s3, 10
    s_add_u32 s69, s69, 16384
    s_lshl_b32 s70, s17, 16
    s_lshl_b32 s71, s17, 12
    s_add_u32 s72, s64, 1
    s_and_b32 s72, s72, 3
    s_add_u32 s73, s65, 0
    s_and_b32 s73, s73, 15
    s_add_u32 s72, s72, s73
    s_mul_i32 s73, s72, 393216
    s_lshl_b32 s72, s72, 7
    s_add_u32 s74, s72, s70
    s_add_u32 s75, s73, s66
    s_add_u32 s76, s73, s67
    s_add_u32 m0, s71, 40960
    s_add_u32 s77, s74, 0
    buffer_load_dwordx4 v10, s[24:27], s77 offen lds
    s_add_u32 m0, s71, 41984
    s_add_u32 s77, s74, 16384
    buffer_load_dwordx4 v11, s[24:27], s77 offen lds
    s_add_u32 m0, s71, 43008
    s_add_u32 s77, s74, 32768
    buffer_load_dwordx4 v10, s[24:27], s77 offen lds
    s_add_u32 m0, s71, 44032
    s_add_u32 s77, s74, 49152
    buffer_load_dwordx4 v11, s[24:27], s77 offen lds
    s_add_u32 m0, s68, 40960
    s_add_u32 s77, s75, 0
    buffer_load_dwordx4 v12, s[28:31], s77 offen lds
    s_add_u32 m0, s68, 49152
    s_add_u32 s77, s75, 2048
    buffer_load_dwordx4 v12, s[28:31], s77 offen lds
    s_add_u32 m0, s68, 57344
    s_add_u32 s77, s75, 4096
    buffer_load_dwordx4 v12, s[28:31], s77 offen lds
    s_add_u32 m0, s69, 40960
    s_add_u32 s77, s76, 0
    buffer_load_dwordx4 v12, s[28:31], s77 offen lds
    s_mov_b64 s[32:33], s[98:99]
    s_mov_b32 s34, 16777216
    s_mov_b32 s35, 0x00020000
    s_mov_b64 s[36:37], s[96:97]
    s_mov_b32 s38, 256
    s_mov_b32 s39, 0x00020000
    s_mov_b64 s[40:41], s[84:85]
    s_mov_b32 s42, 2048
    s_mov_b32 s43, 0x00020000
    s_mov_b64 s[44:45], s[92:93]
    s_mov_b32 s46, 2048
    s_mov_b32 s47, 0x00020000
    s_mov_b64 s[48:49], s[86:87]
    s_mov_b32 s50, 7340032
    s_mov_b32 s51, 0x00020000
    s_mov_b64 s[52:53], s[88:89]
    s_mov_b32 s54, 7340032
    s_mov_b32 s55, 0x00020000
    s_mov_b64 s[56:57], s[90:91]
    s_mov_b32 s58, 7340032
    s_mov_b32 s59, 0x00020000
    s_mov_b64 s[60:61], s[10:11]
    s_mov_b32 s62, 2097152
    s_mov_b32 s63, 0x00020000
    s_mov_b32 s79, 0
    v_mov_b32 v13, 0
    v_lshlrev_b32 v3, 4, v2
    v_lshrrev_b32 v9, 4, v2
    v_and_b32 v8, 15, v2
    v_mul_u32_u24 v15, 7168, v9
    v_lshl_add_u32 v15, v8, 4, v15
    v_lshlrev_b32 v16, 11, v9
    v_lshl_add_u32 v16, v8, 4, v16
    v_lshrrev_b32 v19, 3, v2
    v_and_b32 v20, 7, v2
    v_lshlrev_b32 v17, 11, v19
    v_lshl_add_u32 v17, v20, 4, v17
    v_lshlrev_b32 v21, 1, v9
    v_xor_b32 v21, v20, v21
    v_lshlrev_b32 v18, 7, v19
    v_lshl_add_u32 v18, v21, 4, v18
    s_lshl_b32 s19, s17, 10
    s_add_u32 s19, s19, 32768
    v_add_u32 v18, s19, v18
    v_add_u32 v22, 65536, v18
    v_mov_b32 v23, 0xffff
    v_mov_b32 v24, 0xffff0000
    v_cmp_eq_u32 vcc, 0, v8
    s_nop 1
    v_cndmask_b32 v25, 0, v23, vcc
    v_cmp_eq_u32 vcc, 1, v8
    s_nop 1
    v_cndmask_b32 v4, v25, v24, vcc
    v_cmp_eq_u32 vcc, 2, v8
    s_nop 1
    v_cndmask_b32 v25, 0, v23, vcc
    v_cmp_eq_u32 vcc, 3, v8
    s_nop 1
    v_cndmask_b32 v5, v25, v24, vcc
    v_cmp_eq_u32 vcc, 4, v8
    s_nop 1
    v_cndmask_b32 v25, 0, v23, vcc
    v_cmp_eq_u32 vcc, 5, v8
    s_nop 1
    v_cndmask_b32 v6, v25, v24, vcc
    v_cmp_eq_u32 vcc, 6, v8
    s_nop 1
    v_cndmask_b32 v25, 0, v23, vcc
    v_cmp_eq_u32 vcc, 7, v8
    s_nop 1
    v_cndmask_b32 v7, v25, v24, vcc
    v_mov_b32 v23, 0x3ff
    s_getreg_b32 s23, hwreg(HW_REG_XCC_ID, 0, 4)
    v_and_b32 v36, 3, v2
    v_lshlrev_b32 v36, 2, v36
    v_mov_b32 v37, 0x7fc17fc1
    s_cmp_lt_u32 s2, 224
    s_cselect_b32 s50, s50, 0
    s_cselect_b32 s54, s54, 0
    s_lshl_b32 s0, s12, 7
    s_lshl_b32 s19, s17, 5
    s_add_u32 s0, s0, s19
    s_mul_i32 s1, s0, 7168
    s_lshl_b32 s19, s13, 8
    s_add_u32 s1, s1, s19
    s_lshl_b32 s19, s13, 2
    s_add_u32 s19, s19, s17
    s_lshl_b32 s19, s19, 6
    s_sub_u32 s3, s19, 2048
    s_buffer_load_dword s8, s[40:43], s19
    s_buffer_load_dword s8, s[44:47], s3
    s_waitcnt vmcnt(8)
    s_barrier
    s_add_u32 m0, s69, 49152
    s_add_u32 s77, s76, 2048
    buffer_load_dwordx4 v12, s[28:31], s77 offen lds
    s_add_u32 m0, s69, 57344
    s_add_u32 s77, s76, 4096
    buffer_load_dwordx4 v12, s[28:31], s77 offen lds
    s_add_u32 s72, s64, 2
    s_and_b32 s72, s72, 3
    s_add_u32 s73, s65, 0
    s_and_b32 s73, s73, 15
    s_add_u32 s72, s72, s73
    s_mul_i32 s73, s72, 393216
    s_lshl_b32 s72, s72, 7
    s_add_u32 s74, s72, s70
    s_add_u32 s75, s73, s66
    s_add_u32 s76, s73, s67
    s_add_u32 m0, s71, 81920
    s_add_u32 s77, s74, 0
    buffer_load_dwordx4 v10, s[24:27], s77 offen lds
    s_add_u32 m0, s71, 82944
    s_add_u32 s77, s74, 16384
    buffer_load_dwordx4 v11, s[24:27], s77 offen lds
    s_add_u32 m0, s71, 83968
    s_add_u32 s77, s74, 32768
    buffer_load_dwordx4 v10, s[24:27], s77 offen lds
    s_add_u32 m0, s71, 84992
    s_add_u32 s77, s74, 49152
    buffer_load_dwordx4 v11, s[24:27], s77 offen lds
    s_add_u32 m0, s68, 81920
    s_add_u32 s77, s75, 0
    buffer_load_dwordx4 v12, s[28:31], s77 offen lds
    s_add_u32 m0, s68, 90112
    s_add_u32 s77, s75, 2048
    buffer_load_dwordx4 v12, s[28:31], s77 offen lds
    s_add_u32 m0, s68, 98304
    s_add_u32 s77, s75, 4096
    buffer_load_dwordx4 v12, s[28:31], s77 offen lds
    s_add_u32 m0, s69, 81920
    s_add_u32 s77, s76, 0
    buffer_load_dwordx4 v12, s[28:31], s77 offen lds
    s_add_u32 m0, s69, 90112
    s_add_u32 s77, s76, 2048
    buffer_load_dwordx4 v12, s[28:31], s77 offen lds
    s_waitcnt vmcnt(9)
    s_barrier
    s_add_u32 m0, s69, 98304
    s_add_u32 s77, s76, 4096
    buffer_load_dwordx4 v12, s[28:31], s77 offen lds
    s_add_u32 s72, s64, 3
    s_and_b32 s72, s72, 3
    s_add_u32 s73, s65, 0
    s_and_b32 s73, s73, 15
    s_add_u32 s72, s72, s73
    s_mul_i32 s73, s72, 393216
    s_lshl_b32 s72, s72, 7
    s_add_u32 s74, s72, s70
    s_add_u32 s75, s73, s66
    s_add_u32 s76, s73, s67
    s_add_u32 m0, s71, 122880
    s_add_u32 s77, s74, 0
    buffer_load_dwordx4 v10, s[24:27], s77 offen lds
    s_add_u32 m0, s71, 123904
    s_add_u32 s77, s74, 16384
    buffer_load_dwordx4 v11, s[24:27], s77 offen lds
    s_add_u32 m0, s71, 124928
    s_add_u32 s77, s74, 32768
    buffer_load_dwordx4 v10, s[24:27], s77 offen lds
    s_add_u32 m0, s71, 125952
    s_add_u32 s77, s74, 49152
    buffer_load_dwordx4 v11, s[24:27], s77 offen lds
    s_add_u32 m0, s68, 122880
    s_add_u32 s77, s75, 0
    buffer_load_dwordx4 v12, s[28:31], s77 offen lds
    s_add_u32 m0, s68, 131072
    s_add_u32 s77, s75, 2048
    buffer_load_dwordx4 v12, s[28:31], s77 offen lds
    s_add_u32 m0, s68, 139264
    s_add_u32 s77, s75, 4096
    buffer_load_dwordx4 v12, s[28:31], s77 offen lds
    s_add_u32 m0, s69, 122880
    s_add_u32 s77, s76, 0
    buffer_load_dwordx4 v12, s[28:31], s77 offen lds
    s_add_u32 m0, s69, 131072
    s_add_u32 s77, s76, 2048
    buffer_load_dwordx4 v12, s[28:31], s77 offen lds
    s_add_u32 m0, s69, 139264
    s_add_u32 s77, s76, 4096
    buffer_load_dwordx4 v12, s[28:31], s77 offen lds
    s_lshl_b32 s18, s14, 7
    s_lshl_b32 s19, s15, 3
    s_add_u32 s18, s18, s19
    s_lshl_b32 s19, s17, 1
    s_add_u32 s18, s18, s19
    s_lshl_b32 s19, s18, 11
    buffer_load_dwordx4 v[40:43], v3, s[24:27], s19 offen offset:0
    buffer_load_dwordx4 v[44:47], v3, s[24:27], s19 offen offset:1024
    buffer_load_dwordx4 v[48:51], v3, s[24:27], s19 offen offset:2048
    buffer_load_dwordx4 v[52:55], v3, s[24:27], s19 offen offset:3072
    buffer_load_dwordx4 v[56:59], v3, s[40:43], 0 offen offset:0
    buffer_load_dwordx4 v[60:63], v3, s[40:43], 0 offen offset:1024
    buffer_load_dwordx4 v[64:67], v3, s[44:47], 0 offen offset:0
    buffer_load_dwordx4 v[68:71], v3, s[44:47], 0 offen offset:1024
    buffer_load_dword v14, v13, s[36:39], 0 offen offset:4 sc1
    s_waitcnt vmcnt(19)
    s_barrier
    s_add_u32 s72, s64, 0
    s_and_b32 s72, s72, 3
    s_add_u32 s73, s65, 4
    s_and_b32 s73, s73, 15
    s_add_u32 s72, s72, s73
    s_mul_i32 s73, s72, 393216
    s_lshl_b32 s72, s72, 7
    s_add_u32 s74, s72, s70
    s_add_u32 s75, s73, s66
    s_add_u32 s76, s73, s67
    s_add_u32 m0, s71, 0
    s_add_u32 s77, s74, 0
    buffer_load_dwordx4 v10, s[24:27], s77 offen lds
    s_add_u32 m0, s71, 1024
    s_add_u32 s77, s74, 16384
    buffer_load_dwordx4 v11, s[24:27], s77 offen lds
    s_add_u32 m0, s71, 2048
    s_add_u32 s77, s74, 32768
    buffer_load_dwordx4 v10, s[24:27], s77 offen lds
    s_add_u32 m0, s71, 3072
    s_add_u32 s77, s74, 49152
    buffer_load_dwordx4 v11, s[24:27], s77 offen lds
    s_add_u32 m0, s68, 0
    s_add_u32 s77, s75, 0
    buffer_load_dwordx4 v12, s[28:31], s77 offen lds
    s_add_u32 m0, s68, 8192
    s_add_u32 s77, s75, 2048
    buffer_load_dwordx4 v12, s[28:31], s77 offen lds
    s_add_u32 m0, s68, 16384
    s_add_u32 s77, s75, 4096
    buffer_load_dwordx4 v12, s[28:31], s77 offen lds
    s_add_u32 m0, s69, 0
    s_add_u32 s77, s76, 0
    buffer_load_dwordx4 v12, s[28:31], s77 offen lds
    s_add_u32 m0, s69, 8192
    s_add_u32 s77, s76, 2048
    buffer_load_dwordx4 v12, s[28:31], s77 offen lds
    s_add_u32 m0, s69, 16384
    s_add_u32 s77, s76, 4096
    buffer_load_dwordx4 v12, s[28:31], s77 offen lds
    s_waitcnt vmcnt(19)
    s_barrier
    s_add_u32 s72, s64, 1
    s_and_b32 s72, s72, 3
    s_add_u32 s73, s65, 4
    s_and_b32 s73, s73, 15
    s_add_u32 s72, s72, s73
    s_mul_i32 s73, s72, 393216
    s_lshl_b32 s72, s72, 7
    s_add_u32 s74, s72, s70
    s_add_u32 s75, s73, s66
    s_add_u32 s76, s73, s67
    s_add_u32 m0, s71, 40960
    s_add_u32 s77, s74, 0
    buffer_load_dwordx4 v10, s[24:27], s77 offen lds
    s_add_u32 m0, s71, 41984
    s_add_u32 s77, s74, 16384
    buffer_load_dwordx4 v11, s[24:27], s77 offen lds
    s_add_u32 m0, s71, 43008
    s_add_u32 s77, s74, 32768
    buffer_load_dwordx4 v10, s[24:27], s77 offen lds
    s_add_u32 m0, s71, 44032
    s_add_u32 s77, s74, 49152
    buffer_load_dwordx4 v11, s[24:27], s77 offen lds
    s_add_u32 m0, s68, 40960
    s_add_u32 s77, s75, 0
    buffer_load_dwordx4 v12, s[28:31], s77 offen lds
    s_add_u32 m0, s68, 49152
    s_add_u32 s77, s75, 2048
    buffer_load_dwordx4 v12, s[28:31], s77 offen lds
    s_add_u32 m0, s68, 57344
    s_add_u32 s77, s75, 4096
    buffer_load_dwordx4 v12, s[28:31], s77 offen lds
    s_add_u32 m0, s69, 40960
    s_add_u32 s77, s76, 0
    buffer_load_dwordx4 v12, s[28:31], s77 offen lds
    s_add_u32 m0, s69, 49152
    s_add_u32 s77, s76, 2048
    buffer_load_dwordx4 v12, s[28:31], s77 offen lds
    s_add_u32 m0, s69, 57344
    s_add_u32 s77, s76, 4096
    buffer_load_dwordx4 v12, s[28:31], s77 offen lds
    s_waitcnt vmcnt(21)
    s_waitcnt vmcnt(20)
    v_readfirstlane_b32 s78, v14
L_tg1:
    s_nop 1
    s_cmp_lg_u32 s78, 0
    s_cbranch_scc1 L_tk2
    buffer_load_dword v14, v13, s[36:39], 0 offen offset:4 sc1
    s_waitcnt vmcnt(0)
    v_readfirstlane_b32 s78, v14
    s_add_u32 s79, s79, 1
    s_cmp_lt_u32 s79, 32768
    s_cbranch_scc1 L_tg1
L_tk2:
    s_mul_i32 s80, s78, 0x9e3779b1
    s_lshr_b32 s80, s80, 22
    s_mul_i32 s81, s78, 0x85ebca77
    s_lshr_b32 s81, s81, 22
    s_mul_i32 s82, s78, 0xc2b2ae3d
    s_lshr_b32 s82, s82, 22
    s_mul_i32 s83, s78, 0x27d4eb2f
    s_lshr_b32 s83, s83, 22
    v_and_b32 v72, 0xffff, v64
    v_and_b32 v80, 0xffff0000, v64
    v_and_b32 v73, 0xffff, v65
    v_and_b32 v81, 0xffff0000, v65
    v_dot2_f32_bf16 v92, v40, v72, 0
    v_dot2_f32_bf16 v93, v40, v80, 0
    v_and_b32 v74, 0xffff, v66
    v_and_b32 v82, 0xffff0000, v66
    v_dot2_f32_bf16 v94, v41, v73, 0
    v_dot2_f32_bf16 v95, v41, v81, 0
    v_and_b32 v75, 0xffff, v67
    v_and_b32 v83, 0xffff0000, v67
    v_cvt_pk_bf16_f32 v92, v92, v93
    v_dot2_f32_bf16 v96, v42, v74, 0
    v_dot2_f32_bf16 v97, v42, v82, 0
    s_mov_b32 s19, 0x3f803f80
    v_and_b32 v76, 0xffff, v68
    v_and_b32 v84, 0xffff0000, v68
    v_dot2_f32_bf16 v89, v92, s19, 0
    v_cvt_pk_bf16_f32 v94, v94, v95
    v_dot2_f32_bf16 v98, v43, v75, 0
    v_dot2_f32_bf16 v99, v43, v83, 0
    v_and_b32 v77, 0xffff, v69
    v_and_b32 v85, 0xffff0000, v69
    v_dot2_f32_bf16 v89, v94, s19, v89
    v_cvt_pk_bf16_f32 v96, v96, v97
    v_dot2_f32_bf16 v92, v44, v76, 0
    v_dot2_f32_bf16 v93, v44, v84, 0
    v_and_b32 v78, 0xffff, v70
    v_and_b32 v86, 0xffff0000, v70
    v_dot2_f32_bf16 v89, v96, s19, v89
    v_cvt_pk_bf16_f32 v98, v98, v99
    v_dot2_f32_bf16 v94, v45, v77, 0
    v_dot2_f32_bf16 v95, v45, v85, 0
    v_and_b32 v79, 0xffff, v71
    v_and_b32 v87, 0xffff0000, v71
    v_dot2_f32_bf16 v89, v98, s19, v89
    v_cvt_pk_bf16_f32 v92, v92, v93
    v_dot2_f32_bf16 v96, v46, v78, 0
    v_dot2_f32_bf16 v97, v46, v86, 0
    v_dot2_f32_bf16 v89, v92, s19, v89
    v_cvt_pk_bf16_f32 v94, v94, v95
    v_dot2_f32_bf16 v98, v47, v79, 0
    v_dot2_f32_bf16 v99, v47, v87, 0
    v_dot2_f32_bf16 v92, v48, v72, 0
    v_dot2_f32_bf16 v93, v48, v80, 0
    v_dot2_f32_bf16 v89, v94, s19, v89
    v_cvt_pk_bf16_f32 v96, v96, v97
    v_dot2_f32_bf16 v94, v49, v73, 0
    v_dot2_f32_bf16 v95, v49, v81, 0
    v_dot2_f32_bf16 v89, v96, s19, v89
    v_cvt_pk_bf16_f32 v98, v98, v99
    v_cvt_pk_bf16_f32 v92, v92, v93
    v_dot2_f32_bf16 v96, v50, v74, 0
    v_dot2_f32_bf16 v97, v50, v82, 0
    v_dot2_f32_bf16 v89, v98, s19, v89
    v_dot2_f32_bf16 v88, v40, v56, 0
    v_dot2_f32_bf16 v90, v48, v56, 0
    v_dot2_f32_bf16 v91, v92, s19, 0
    v_cvt_pk_bf16_f32 v94, v94, v95
    v_dot2_f32_bf16 v98, v51, v75, 0
    v_dot2_f32_bf16 v99, v51, v83, 0
    v_dot2_f32_bf16 v88, v41, v57, v88
    v_dot2_f32_bf16 v90, v49, v57, v90
    v_dot2_f32_bf16 v91, v94, s19, v91
    v_cvt_pk_bf16_f32 v96, v96, v97
    v_dot2_f32_bf16 v92, v52, v76, 0
    v_dot2_f32_bf16 v93, v52, v84, 0
    v_dot2_f32_bf16 v88, v42, v58, v88
    v_dot2_f32_bf16 v90, v50, v58, v90
    v_dot2_f32_bf16 v91, v96, s19, v91
    v_cvt_pk_bf16_f32 v98, v98, v99
    v_dot2_f32_bf16 v94, v53, v77, 0
    v_dot2_f32_bf16 v95, v53, v85, 0
    v_dot2_f32_bf16 v88, v43, v59, v88
    v_dot2_f32_bf16 v90, v51, v59, v90
    v_dot2_f32_bf16 v91, v98, s19, v91
    v_cvt_pk_bf16_f32 v92, v92, v93
    v_dot2_f32_bf16 v96, v54, v78, 0
    v_dot2_f32_bf16 v97, v54, v86, 0
    v_dot2_f32_bf16 v88, v44, v60, v88
    v_dot2_f32_bf16 v90, v52, v60, v90
    v_dot2_f32_bf16 v91, v92, s19, v91
    v_cvt_pk_bf16_f32 v94, v94, v95
    v_dot2_f32_bf16 v98, v55, v79, 0
    v_dot2_f32_bf16 v99, v55, v87, 0
    v_dot2_f32_bf16 v88, v45, v61, v88
    v_dot2_f32_bf16 v90, v53, v61, v90
    v_dot2_f32_bf16 v91, v94, s19, v91
    v_cvt_pk_bf16_f32 v96, v96, v97
    v_dot2_f32_bf16 v88, v46, v62, v88
    v_dot2_f32_bf16 v90, v54, v62, v90
    v_dot2_f32_bf16 v91, v96, s19, v91
    v_cvt_pk_bf16_f32 v98, v98, v99
    v_dot2_f32_bf16 v88, v47, v63, v88
    v_dot2_f32_bf16 v90, v55, v63, v90
    v_dot2_f32_bf16 v91, v98, s19, v91
    s_nop 1
    v_permlane32_swap_b32 v88, v90
    v_permlane32_swap_b32 v89, v91
    v_add_f32 v88, v88, v90
    v_add_f32 v89, v89, v91
    v_mov_b32 v91, s78
    s_nop 0
    v_permlane16_swap_b32 v88, v89
    v_add_f32 v88, v88, v89
    s_nop 1
    v_add_f32_dpp v88, v88, v88 row_ror:8 row_mask:0xf bank_mask:0xf
    s_nop 1
    v_add_f32_dpp v88, v88, v88 row_ror:4 row_mask:0xf bank_mask:0xf
    s_nop 1
    v_add_f32_dpp v88, v88, v88 row_ror:2 row_mask:0xf bank_mask:0xf
    s_nop 1
    v_add_f32_dpp v88, v88, v88 row_ror:1 row_mask:0xf bank_mask:0xf
    v_cvt_pk_bf16_f32 v88, v88, v88
    v_ashrrev_i32 v90, 31, v88
    v_and_b32 v89, 0xffff0000, v88
    v_or_b32 v90, 0x80000000, v90
    v_mul_f32 v89, 0xbfb8aa3b, v89
    v_xor_b32 v90, v90, v88
    v_exp_f32 v89, v89
    v_lshrrev_b32 v90, 16, v90
    v_add_f32 v89, 1.0, v89
    v_readlane_b32 s84, v90, 0
    v_readlane_b32 s85, v90, 32
    v_rcp_f32 v89, v89
    s_lshl_b32 s84, s84, 11
    s_lshl_b32 s85, s85, 11
    s_sub_u32 s3, 2047, s18
    v_cvt_pk_bf16_f32 v89, v89, v89
    s_or_b32 s84, s84, s3
    s_sub_u32 s3, s3, 1
    s_or_b32 s85, s85, s3
    v_readlane_b32 s20, v89, 16
    s_max_u32 s84, s84, s85
    v_readlane_b32 s21, v89, 48
    s_lshl_b32 s84, s84, 4
    s_or_b32 s84, s84, s23
    s_and_b32 s20, s20, 0xffff
    s_and_b32 s21, s21, 0xffff0000
    s_or_b32 s20, s20, s21
    s_lshl_b32 s3, s18, 2
    s_add_u32 s21, s3, 4472832
    s_add_u32 s3, s3, 4464640
    v_mov_b32 v88, s84
    v_mov_b32 v89, s78
    v_mov_b32 v90, s20
    s_mov_b64 exec, 1
    buffer_store_dwordx2 v[88:89], v13, s[32:35], s3 offen sc1
    buffer_store_dwordx2 v[90:91], v13, s[32:35], s21 offen sc1
    s_mov_b64 exec, -1
    s_waitcnt vmcnt(12)
    s_barrier
    s_add_u32 s72, s64, 2
    s_and_b32 s72, s72, 3
    s_add_u32 s73, s65, 4
    s_and_b32 s73, s73, 15
    s_add_u32 s72, s72, s73
    s_mul_i32 s73, s72, 393216
    s_lshl_b32 s72, s72, 7
    s_add_u32 s74, s72, s70
    s_add_u32 s75, s73, s66
    s_add_u32 s76, s73, s67
    s_add_u32 m0, s71, 81920
    s_add_u32 s77, s74, 0
    buffer_load_dwordx4 v10, s[24:27], s77 offen lds
    s_add_u32 m0, s71, 82944
    s_add_u32 s77, s74, 16384
    buffer_load_dwordx4 v11, s[24:27], s77 offen lds
    s_add_u32 m0, s71, 83968
    s_add_u32 s77, s74, 32768
    buffer_load_dwordx4 v10, s[24:27], s77 offen lds
    s_add_u32 m0, s71, 84992
    s_add_u32 s77, s74, 49152
    buffer_load_dwordx4 v11, s[24:27], s77 offen lds
    s_add_u32 m0, s68, 81920
    s_add_u32 s77, s75, 0
    buffer_load_dwordx4 v12, s[28:31], s77 offen lds
    s_add_u32 m0, s68, 90112
    s_add_u32 s77, s75, 2048
    buffer_load_dwordx4 v12, s[28:31], s77 offen lds
    s_add_u32 m0, s68, 98304
    s_add_u32 s77, s75, 4096
    buffer_load_dwordx4 v12, s[28:31], s77 offen lds
    s_add_u32 m0, s69, 81920
    s_add_u32 s77, s76, 0
    buffer_load_dwordx4 v12, s[28:31], s77 offen lds
    s_add_u32 m0, s69, 90112
    s_add_u32 s77, s76, 2048
    buffer_load_dwordx4 v12, s[28:31], s77 offen lds
    s_add_u32 m0, s69, 98304
    s_add_u32 s77, s76, 4096
    buffer_load_dwordx4 v12, s[28:31], s77 offen lds
    s_add_u32 s72, s64, 3
    s_and_b32 s72, s72, 3
    s_add_u32 s73, s65, 4
    s_and_b32 s73, s73, 15
    s_add_u32 s72, s72, s73
    s_mul_i32 s73, s72, 393216
    s_lshl_b32 s72, s72, 7
    s_add_u32 s74, s72, s70
    s_add_u32 s75, s73, s66
    s_add_u32 s76, s73, s67
    s_add_u32 m0, s71, 122880
    s_add_u32 s77, s74, 0
    buffer_load_dwordx4 v10, s[24:27], s77 offen lds
    s_add_u32 m0, s71, 123904
    s_add_u32 s77, s74, 16384
    buffer_load_dwordx4 v11, s[24:27], s77 offen lds
    s_waitcnt vmcnt(14)
    s_barrier
    s_add_u32 m0, s71, 124928
    s_add_u32 s77, s74, 32768
    buffer_load_dwordx4 v10, s[24:27], s77 offen lds
    s_add_u32 m0, s71, 125952
    s_add_u32 s77, s74, 49152
    buffer_load_dwordx4 v11, s[24:27], s77 offen lds
    s_add_u32 m0, s68, 122880
    s_add_u32 s77, s75, 0
    buffer_load_dwordx4 v12, s[28:31], s77 offen lds
    s_add_u32 m0, s68, 131072
    s_add_u32 s77, s75, 2048
    buffer_load_dwordx4 v12, s[28:31], s77 offen lds
    s_add_u32 m0, s68, 139264
    s_add_u32 s77, s75, 4096
    buffer_load_dwordx4 v12, s[28:31], s77 offen lds
    s_add_u32 m0, s69, 122880
    s_add_u32 s77, s76, 0
    buffer_load_dwordx4 v12, s[28:31], s77 offen lds
    s_add_u32 m0, s69, 131072
    s_add_u32 s77, s76, 2048
    buffer_load_dwordx4 v12, s[28:31], s77 offen lds
    s_add_u32 m0, s69, 139264
    s_add_u32 s77, s76, 4096
    buffer_load_dwordx4 v12, s[28:31], s77 offen lds
    s_add_u32 s72, s64, 0
    s_and_b32 s72, s72, 3
    s_add_u32 s73, s65, 8
    s_and_b32 s73, s73, 15
    s_add_u32 s72, s72, s73
    s_mul_i32 s73, s72, 393216
    s_lshl_b32 s72, s72, 7
    s_add_u32 s74, s72, s70
    s_add_u32 s75, s73, s66
    s_add_u32 s76, s73, s67
    s_add_u32 m0, s71, 0
    s_add_u32 s77, s74, 0
    buffer_load_dwordx4 v10, s[24:27], s77 offen lds
    s_add_u32 m0, s71, 1024
    s_add_u32 s77, s74, 16384
    buffer_load_dwordx4 v11, s[24:27], s77 offen lds
    s_add_u32 m0, s71, 2048
    s_add_u32 s77, s74, 32768
    buffer_load_dwordx4 v10, s[24:27], s77 offen lds
    s_add_u32 m0, s71, 3072
    s_add_u32 s77, s74, 49152
    buffer_load_dwordx4 v11, s[24:27], s77 offen lds
    s_waitcnt vmcnt(14)
    s_barrier
    s_add_u32 m0, s68, 0
    s_add_u32 s77, s75, 0
    buffer_load_dwordx4 v12, s[28:31], s77 offen lds
    s_add_u32 m0, s68, 8192
    s_add_u32 s77, s75, 2048
    buffer_load_dwordx4 v12, s[28:31], s77 offen lds
    s_add_u32 m0, s68, 16384
    s_add_u32 s77, s75, 4096
    buffer_load_dwordx4 v12, s[28:31], s77 offen lds
    s_add_u32 m0, s69, 0
    s_add_u32 s77, s76, 0
    buffer_load_dwordx4 v12, s[28:31], s77 offen lds
    s_add_u32 m0, s69, 8192
    s_add_u32 s77, s76, 2048
    buffer_load_dwordx4 v12, s[28:31], s77 offen lds
    s_add_u32 m0, s69, 16384
    s_add_u32 s77, s76, 4096
    buffer_load_dwordx4 v12, s[28:31], s77 offen lds
    s_add_u32 s72, s64, 1
    s_and_b32 s72, s72, 3
    s_add_u32 s73, s65, 8
    s_and_b32 s73, s73, 15
    s_add_u32 s72, s72, s73
    s_mul_i32 s73, s72, 393216
    s_lshl_b32 s72, s72, 7
    s_add_u32 s74, s72, s70
    s_add_u32 s75, s73, s66
    s_add_u32 s76, s73, s67
    s_add_u32 m0, s71, 40960
    s_add_u32 s77, s74, 0
    buffer_load_dwordx4 v10, s[24:27], s77 offen lds
    s_add_u32 m0, s71, 41984
    s_add_u32 s77, s74, 16384
    buffer_load_dwordx4 v11, s[24:27], s77 offen lds
    s_add_u32 m0, s71, 43008
    s_add_u32 s77, s74, 32768
    buffer_load_dwordx4 v10, s[24:27], s77 offen lds
    s_add_u32 m0, s71, 44032
    s_add_u32 s77, s74, 49152
    buffer_load_dwordx4 v11, s[24:27], s77 offen lds
    s_waitcnt vmcnt(14)
    s_barrier
    s_add_u32 m0, s68, 40960
    s_add_u32 s77, s75, 0
    buffer_load_dwordx4 v12, s[28:31], s77 offen lds
    s_add_u32 m0, s68, 49152
    s_add_u32 s77, s75, 2048
    buffer_load_dwordx4 v12, s[28:31], s77 offen lds
    s_add_u32 m0, s68, 57344
    s_add_u32 s77, s75, 4096
    buffer_load_dwordx4 v12, s[28:31], s77 offen lds
    s_add_u32 m0, s69, 40960
    s_add_u32 s77, s76, 0
    buffer_load_dwordx4 v12, s[28:31], s77 offen lds
    s_add_u32 m0, s69, 49152
    s_add_u32 s77, s76, 2048
    buffer_load_dwordx4 v12, s[28:31], s77 offen lds
    s_add_u32 m0, s69, 57344
    s_add_u32 s77, s76, 4096
    buffer_load_dwordx4 v12, s[28:31], s77 offen lds
    s_add_u32 s72, s64, 2
    s_and_b32 s72, s72, 3
    s_add_u32 s73, s65, 8
    s_and_b32 s73, s73, 15
    s_add_u32 s72, s72, s73
    s_mul_i32 s73, s72, 393216
    s_lshl_b32 s72, s72, 7
    s_add_u32 s74, s72, s70
    s_add_u32 s75, s73, s66
    s_add_u32 s76, s73, s67
    s_add_u32 m0, s71, 81920
    s_add_u32 s77, s74, 0
    buffer_load_dwordx4 v10, s[24:27], s77 offen lds
    s_add_u32 m0, s71, 82944
    s_add_u32 s77, s74, 16384
    buffer_load_dwordx4 v11, s[24:27], s77 offen lds
    s_add_u32 m0, s71, 83968
    s_add_u32 s77, s74, 32768
    buffer_load_dwordx4 v10, s[24:27], s77 offen lds
    s_add_u32 m0, s71, 84992
    s_add_u32 s77, s74, 49152
    buffer_load_dwordx4 v11, s[24:27], s77 offen lds
    s_waitcnt vmcnt(14)
    s_barrier
    s_add_u32 m0, s68, 81920
    s_add_u32 s77, s75, 0
    buffer_load_dwordx4 v12, s[28:31], s77 offen lds
    s_add_u32 m0, s68, 90112
    s_add_u32 s77, s75, 2048
    buffer_load_dwordx4 v12, s[28:31], s77 offen lds
    s_add_u32 m0, s68, 98304
    s_add_u32 s77, s75, 4096
    buffer_load_dwordx4 v12, s[28:31], s77 offen lds
    s_add_u32 m0, s69, 81920
    s_add_u32 s77, s76, 0
    buffer_load_dwordx4 v12, s[28:31], s77 offen lds
    s_add_u32 m0, s69, 90112
    s_add_u32 s77, s76, 2048
    buffer_load_dwordx4 v12, s[28:31], s77 offen lds
    s_add_u32 m0, s69, 98304
    s_add_u32 s77, s76, 4096
    buffer_load_dwordx4 v12, s[28:31], s77 offen lds
    s_add_u32 s72, s64, 3
    s_and_b32 s72, s72, 3
    s_add_u32 s73, s65, 8
    s_and_b32 s73, s73, 15
    s_add_u32 s72, s72, s73
    s_mul_i32 s73, s72, 393216
    s_lshl_b32 s72, s72, 7
    s_add_u32 s74, s72, s70
    s_add_u32 s75, s73, s66
    s_add_u32 s76, s73, s67
    s_add_u32 m0, s71, 122880
    s_add_u32 s77, s74, 0
    buffer_load_dwordx4 v10, s[24:27], s77 offen lds
    s_add_u32 m0, s71, 123904
    s_add_u32 s77, s74, 16384
    buffer_load_dwordx4 v11, s[24:27], s77 offen lds
    s_add_u32 m0, s71, 124928
    s_add_u32 s77, s74, 32768
    buffer_load_dwordx4 v10, s[24:27], s77 offen lds
    s_add_u32 m0, s71, 125952
    s_add_u32 s77, s74, 49152
    buffer_load_dwordx4 v11, s[24:27], s77 offen lds
    s_add_u32 m0, s68, 122880
    s_add_u32 s77, s75, 0
    buffer_load_dwordx4 v12, s[28:31], s77 offen lds
    s_add_u32 m0, s68, 131072
    s_add_u32 s77, s75, 2048
    buffer_load_dwordx4 v12, s[28:31], s77 offen lds
    s_waitcnt vmcnt(16)
    s_barrier
    s_add_u32 m0, s68, 139264
    s_add_u32 s77, s75, 4096
    buffer_load_dwordx4 v12, s[28:31], s77 offen lds
    s_add_u32 m0, s69, 122880
    s_add_u32 s77, s76, 0
    buffer_load_dwordx4 v12, s[28:31], s77 offen lds
    s_add_u32 m0, s69, 131072
    s_add_u32 s77, s76, 2048
    buffer_load_dwordx4 v12, s[28:31], s77 offen lds
    s_add_u32 m0, s69, 139264
    s_add_u32 s77, s76, 4096
    buffer_load_dwordx4 v12, s[28:31], s77 offen lds
    s_add_u32 s72, s64, 0
    s_and_b32 s72, s72, 3
    s_add_u32 s73, s65, 12
    s_and_b32 s73, s73, 15
    s_add_u32 s72, s72, s73
    s_mul_i32 s73, s72, 393216
    s_lshl_b32 s72, s72, 7
    s_add_u32 s74, s72, s70
    s_add_u32 s75, s73, s66
    s_add_u32 s76, s73, s67
    s_add_u32 m0, s71, 0
    s_add_u32 s77, s74, 0
    buffer_load_dwordx4 v10, s[24:27], s77 offen lds
    s_add_u32 m0, s71, 1024
    s_add_u32 s77, s74, 16384
    buffer_load_dwordx4 v11, s[24:27], s77 offen lds
    s_add_u32 m0, s71, 2048
    s_add_u32 s77, s74, 32768
    buffer_load_dwordx4 v10, s[24:27], s77 offen lds
    s_add_u32 m0, s71, 3072
    s_add_u32 s77, s74, 49152
    buffer_load_dwordx4 v11, s[24:27], s77 offen lds
    s_add_u32 m0, s68, 0
    s_add_u32 s77, s75, 0
    buffer_load_dwordx4 v12, s[28:31], s77 offen lds
    s_add_u32 m0, s68, 8192
    s_add_u32 s77, s75, 2048
    buffer_load_dwordx4 v12, s[28:31], s77 offen lds
    s_add_u32 m0, s68, 16384
    s_add_u32 s77, s75, 4096
    buffer_load_dwordx4 v12, s[28:31], s77 offen lds
    s_add_u32 m0, s69, 0
    s_add_u32 s77, s76, 0
    buffer_load_dwordx4 v12, s[28:31], s77 offen lds
    s_waitcnt vmcnt(18)
    s_barrier
    s_add_u32 m0, s69, 8192
    s_add_u32 s77, s76, 2048
    buffer_load_dwordx4 v12, s[28:31], s77 offen lds
    s_add_u32 m0, s69, 16384
    s_add_u32 s77, s76, 4096
    buffer_load_dwordx4 v12, s[28:31], s77 offen lds
    s_add_u32 s72, s64, 1
    s_and_b32 s72, s72, 3
    s_add_u32 s73, s65, 12
    s_and_b32 s73, s73, 15
    s_add_u32 s72, s72, s73
    s_mul_i32 s73, s72, 393216
    s_lshl_b32 s72, s72, 7
    s_add_u32 s74, s72, s70
    s_add_u32 s75, s73, s66
    s_add_u32 s76, s73, s67
    s_add_u32 m0, s71, 40960
    s_add_u32 s77, s74, 0
    buffer_load_dwordx4 v10, s[24:27], s77 offen lds
    s_add_u32 m0, s71, 41984
    s_add_u32 s77, s74, 16384
    buffer_load_dwordx4 v11, s[24:27], s77 offen lds
    s_add_u32 m0, s71, 43008
    s_add_u32 s77, s74, 32768
    buffer_load_dwordx4 v10, s[24:27], s77 offen lds
    s_add_u32 m0, s71, 44032
    s_add_u32 s77, s74, 49152
    buffer_load_dwordx4 v11, s[24:27], s77 offen lds
    s_add_u32 m0, s68, 40960
    s_add_u32 s77, s75, 0
    buffer_load_dwordx4 v12, s[28:31], s77 offen lds
    s_add_u32 m0, s68, 49152
    s_add_u32 s77, s75, 2048
    buffer_load_dwordx4 v12, s[28:31], s77 offen lds
    s_add_u32 m0, s68, 57344
    s_add_u32 s77, s75, 4096
    buffer_load_dwordx4 v12, s[28:31], s77 offen lds
    s_add_u32 m0, s69, 40960
    s_add_u32 s77, s76, 0
    buffer_load_dwordx4 v12, s[28:31], s77 offen lds
    s_getpc_b64 s[4:5]
L_ctp:
    s_lshl_b32 s7, s13, 2
    s_add_u32 s7, s7, s17
    s_lshl_b32 s7, s7, 8
    s_add_u32 s7, s7, L_lpost-L_ctp
    s_min_u32 s7, s7, L_end-L_ctp-252
    s_and_b32 s7, s7, -4
    s_add_u32 s4, s4, s7
    s_addc_u32 s5, s5, 0
    s_load_dword s7, s[4:5], 0
    s_load_dword s7, s[4:5], 64
    s_load_dword s7, s[4:5], 128
    s_load_dword s7, s[4:5], 192
    s_waitcnt vmcnt(18)
    s_barrier
    s_add_u32 m0, s69, 49152
    s_add_u32 s77, s76, 2048
    buffer_load_dwordx4 v12, s[28:31], s77 offen lds
    s_add_u32 m0, s69, 57344
    s_add_u32 s77, s76, 4096
    buffer_load_dwordx4 v12, s[28:31], s77 offen lds
    s_add_u32 s72, s64, 2
    s_and_b32 s72, s72, 3
    s_add_u32 s73, s65, 12
    s_and_b32 s73, s73, 15
    s_add_u32 s72, s72, s73
    s_mul_i32 s73, s72, 393216
    s_lshl_b32 s72, s72, 7
    s_add_u32 s74, s72, s70
    s_add_u32 s75, s73, s66
    s_add_u32 s76, s73, s67
    s_add_u32 m0, s71, 81920
    s_add_u32 s77, s74, 0
    buffer_load_dwordx4 v10, s[24:27], s77 offen lds
    s_add_u32 m0, s71, 82944
    s_add_u32 s77, s74, 16384
    buffer_load_dwordx4 v11, s[24:27], s77 offen lds
    s_add_u32 m0, s71, 83968
    s_add_u32 s77, s74, 32768
    buffer_load_dwordx4 v10, s[24:27], s77 offen lds
    s_add_u32 m0, s71, 84992
    s_add_u32 s77, s74, 49152
    buffer_load_dwordx4 v11, s[24:27], s77 offen lds
    s_add_u32 m0, s68, 81920
    s_add_u32 s77, s75, 0
    buffer_load_dwordx4 v12, s[28:31], s77 offen lds
    s_add_u32 m0, s68, 90112
    s_add_u32 s77, s75, 2048
    buffer_load_dwordx4 v12, s[28:31], s77 offen lds
    s_add_u32 m0, s68, 98304
    s_add_u32 s77, s75, 4096
    buffer_load_dwordx4 v12, s[28:31], s77 offen lds
    s_add_u32 m0, s69, 81920
    s_add_u32 s77, s76, 0
    buffer_load_dwordx4 v12, s[28:31], s77 offen lds
    s_lshl_b32 s19, s17, 11
    s_add_u32 s19, s19, 4464640
    buffer_load_dwordx4 v[28:31], v3, s[32:35], s19 offen offset:0 sc1
    buffer_load_dwordx4 v[32:35], v3, s[32:35], s19 offen offset:1024 sc1
    s_waitcnt vmcnt(20)
    s_barrier
    s_add_u32 m0, s69, 90112
    s_add_u32 s77, s76, 2048
    buffer_load_dwordx4 v12, s[28:31], s77 offen lds
    s_add_u32 m0, s69, 98304
    s_add_u32 s77, s76, 4096
    buffer_load_dwordx4 v12, s[28:31], s77 offen lds
    s_add_u32 s72, s64, 3
    s_and_b32 s72, s72, 3
    s_add_u32 s73, s65, 12
    s_and_b32 s73, s73, 15
    s_add_u32 s72, s72, s73
    s_mul_i32 s73, s72, 393216
    s_lshl_b32 s72, s72, 7
    s_add_u32 s74, s72, s70
    s_add_u32 s75, s73, s66
    s_add_u32 s76, s73, s67
    s_add_u32 m0, s71, 122880
    s_add_u32 s77, s74, 0
    buffer_load_dwordx4 v10, s[24:27], s77 offen lds
    s_add_u32 m0, s71, 123904
    s_add_u32 s77, s74, 16384
    buffer_load_dwordx4 v11, s[24:27], s77 offen lds
    s_add_u32 m0, s71, 124928
    s_add_u32 s77, s74, 32768
    buffer_load_dwordx4 v10, s[24:27], s77 offen lds
    s_add_u32 m0, s71, 125952
    s_add_u32 s77, s74, 49152
    buffer_load_dwordx4 v11, s[24:27], s77 offen lds
    s_add_u32 m0, s68, 122880
    s_add_u32 s77, s75, 0
    buffer_load_dwordx4 v12, s[28:31], s77 offen lds
    s_add_u32 m0, s68, 131072
    s_add_u32 s77, s75, 2048
    buffer_load_dwordx4 v12, s[28:31], s77 offen lds
    s_add_u32 m0, s68, 139264
    s_add_u32 s77, s75, 4096
    buffer_load_dwordx4 v12, s[28:31], s77 offen lds
    s_add_u32 m0, s69, 122880
    s_add_u32 s77, s76, 0
    buffer_load_dwordx4 v12, s[28:31], s77 offen lds
    s_add_u32 m0, s69, 131072
    s_add_u32 s77, s76, 2048
    buffer_load_dwordx4 v12, s[28:31], s77 offen lds
    s_add_u32 m0, s69, 139264
    s_add_u32 s77, s76, 4096
    buffer_load_dwordx4 v12, s[28:31], s77 offen lds
    s_waitcnt vmcnt(22)
    s_barrier
    buffer_load_dwordx4 v[96:99], v15, s[48:51], s1 offen nt
    buffer_load_dwordx4 v[128:131], v15, s[52:55], s1 offen nt
    s_add_u32 s1, s1, 28672
    buffer_load_dwordx4 v[100:103], v15, s[48:51], s1 offen nt
    buffer_load_dwordx4 v[132:135], v15, s[52:55], s1 offen nt
    s_add_u32 s1, s1, 28672
    buffer_load_dwordx4 v[104:107], v15, s[48:51], s1 offen nt
    buffer_load_dwordx4 v[136:139], v15, s[52:55], s1 offen nt
    s_add_u32 s1, s1, 28672
    s_mul_i32 s73, s13, 112
    s_mul_i32 s19, s17, 28
    s_add_u32 s73, s73, s19
    s_lshl_b32 s74, s73, 11
    s_lshl_b32 s19, s12, 8
    s_add_u32 s74, s74, s19
    s_bfe_u32 s67, s13, 0x10001
    s_lshl_b32 s67, s67, 3
    s_lshr_b32 s19, s13, 2
    s_add_u32 s67, s67, s19
    s_xor_b32 s67, s67, 4
    s_lshl_b32 s68, s19, 2
    s_lshl_b32 s69, s67, 7
    s_lshl_b32 s19, s17, 14
    s_add_u32 s69, s69, s19
    s_and_b32 s68, s13, 30
    s_and_b32 s19, s13, 1
    s_mul_i32 s19, s19, 16
    s_add_u32 s68, s68, s19
    s_and_b32 s68, s68, 31
    s_waitcnt vmcnt(6)
    s_barrier
L_lpost:
    s_cmp_lg_u32 s17, 0
    s_cbranch_scc1 L_z3
    v_mov_b32 v76, 0
    v_mov_b32 v77, 0
    v_mov_b32 v78, 0
    v_mov_b32 v79, 0
    s_mov_b64 exec, 31
    ds_write_b128 v3, v[76:79] offset:0
    ds_write_b32 v13, v37 offset:128
    s_mov_b64 exec, -1
L_z3:
    s_waitcnt vmcnt(18)
L_kp4:
    v_xor_b32 v29, s78, v29
    v_mov_b32 v80, v28
    v_xor_b32 v31, s78, v31
    v_mov_b32 v81, v30
    v_xor_b32 v33, s78, v33
    v_mov_b32 v82, v32
    v_xor_b32 v35, s78, v35
    v_mov_b32 v83, v34
    v_or3_b32 v29, v29, v31, v33
    v_max3_u32 v28, v28, v30, v32
    v_or_b32 v29, v29, v35
    v_max_u32 v28, v28, v34
    v_cmp_ne_u32 vcc, 0, v29
    s_cbranch_vccz L_kk5
    s_lshl_b32 s19, s17, 11
    s_add_u32 s19, s19, 4464640
    buffer_load_dwordx4 v[28:31], v3, s[32:35], s19 offen offset:0 sc1
    buffer_load_dwordx4 v[32:35], v3, s[32:35], s19 offen offset:1024 sc1
    s_waitcnt vmcnt(0)
    s_add_u32 s79, s79, 1
    s_cmp_lt_u32 s79, 32768
    s_cbranch_scc1 L_kp4
L_kk5:
    v_xor_b32 v72, s23, v80
    v_xor_b32 v73, s23, v81
    v_xor_b32 v74, s23, v82
    v_xor_b32 v75, s23, v83
    v_or3_b32 v72, v72, v73, v74
    v_or_b32 v72, v72, v75
    v_and_b32 v72, 15, v72
    v_cmp_ne_u32 vcc, 0, v72
    s_lshl_b32 s19, s15, 1
    s_lshl_b32 s19, 3, s19
    s_or_b32 s3, vcc_lo, vcc_hi
    s_and_b32 s3, s3, s19
    s_cselect_b32 s3, 1, 0
    v_xor_b32 v72, s3, v37
    s_lshl_b64 exec, 1, s17
    ds_write_b32 v36, v72 offset:240
    s_mov_b64 exec, -1
    buffer_load_dwordx4 v[108:111], v15, s[48:51], s1 offen nt
    buffer_load_dwordx4 v[140:143], v15, s[52:55], s1 offen nt
    s_add_u32 s1, s1, 28672
    buffer_load_dwordx4 v[112:115], v15, s[48:51], s1 offen nt
    buffer_load_dwordx4 v[144:147], v15, s[52:55], s1 offen nt
    s_add_u32 s1, s1, 28672
    buffer_load_dwordx4 v[116:119], v15, s[48:51], s1 offen nt
    buffer_load_dwordx4 v[148:151], v15, s[52:55], s1 offen nt
    s_add_u32 s1, s1, 28672
    buffer_load_dwordx4 v[120:123], v15, s[48:51], s1 offen nt
    buffer_load_dwordx4 v[152:155], v15, s[52:55], s1 offen nt
    s_add_u32 s1, s1, 28672
    buffer_load_dwordx4 v[124:127], v15, s[48:51], s1 offen nt
    buffer_load_dwordx4 v[156:159], v15, s[52:55], s1 offen nt
    s_add_u32 s1, s1, 28672
L_fw6:
    ds_read_b32 v29, v13 offset:128
    s_waitcnt lgkmcnt(0)
    v_cmp_ne_u32 vcc, v29, v37
    s_cbranch_vccz L_fk7
    s_add_u32 s79, s79, 1
    s_cmp_lt_u32 s79, 32768
    s_cbranch_scc1 L_fw6
L_fk7:
    ds_max_u32 v13, v28 offset:16
    v_mov_b32 v26, 1
    s_mov_b64 exec, 1
    ds_add_u32 v13, v26 offset:0
    s_mov_b64 exec, -1
L_kc8:
    ds_read_b32 v26, v13 offset:0
    ds_read_b32 v27, v13 offset:16
    s_waitcnt lgkmcnt(0)
    v_readfirstlane_b32 s19, v26
    v_readfirstlane_b32 s71, v27
    s_nop 0
    s_cmp_ge_u32 s19, 4
    s_cbranch_scc1 L_kd9
    s_add_u32 s79, s79, 1
    s_cmp_lt_u32 s79, 32768
    s_cbranch_scc1 L_kc8
L_kd9:
    s_lshr_b32 s71, s71, 4
    s_and_b32 s72, s71, 2047
    s_sub_u32 s72, 2047, s72
    s_lshl_b32 s19, s72, 11
    s_lshl_b32 s3, s0, 1
    s_add_u32 s19, s19, s3
    v_lshlrev_b32 v26, 3, v20
    v_lshl_add_u32 v26, v9, 1, v26
    buffer_load_ushort v27, v26, s[24:27], s19 offen
    s_lshl_b32 s19, s68, 16
    s_add_u32 s19, s19, s69
    buffer_load_dwordx4 v[192:195], v17, s[60:63], s19 offen
    s_add_u32 s68, s68, 1
    s_and_b32 s68, s68, 31
    s_lshl_b32 s19, s68, 16
    s_add_u32 s19, s19, s69
    buffer_load_dwordx4 v[196:199], v17, s[60:63], s19 offen
    s_add_u32 s68, s68, 1
    s_and_b32 s68, s68, 31
    s_lshl_b32 s19, s68, 16
    s_add_u32 s19, s19, s69
    buffer_load_dwordx4 v[200:203], v17, s[60:63], s19 offen
    s_add_u32 s68, s68, 1
    s_and_b32 s68, s68, 31
    s_lshl_b32 s19, s68, 16
    s_add_u32 s19, s19, s69
    buffer_load_dwordx4 v[204:207], v17, s[60:63], s19 offen
    s_add_u32 s68, s68, 1
    s_and_b32 s68, s68, 31
    s_lshl_b32 s19, s68, 16
    s_add_u32 s19, s19, s69
    buffer_load_dwordx4 v[208:211], v17, s[60:63], s19 offen
    s_add_u32 s68, s68, 1
    s_and_b32 s68, s68, 31
    s_lshl_b32 s19, s68, 16
    s_add_u32 s19, s19, s69
    buffer_load_dwordx4 v[212:215], v17, s[60:63], s19 offen
    s_add_u32 s68, s68, 1
    s_and_b32 s68, s68, 31
    s_lshl_b32 s19, s68, 16
    s_add_u32 s19, s19, s69
    buffer_load_dwordx4 v[216:219], v17, s[60:63], s19 offen
    s_add_u32 s68, s68, 1
    s_and_b32 s68, s68, 31
    s_lshl_b32 s19, s68, 16
    s_add_u32 s19, s19, s69
    buffer_load_dwordx4 v[220:223], v17, s[60:63], s19 offen
    s_add_u32 s68, s68, 1
    s_and_b32 s68, s68, 31
    s_lshl_b32 s19, s68, 16
    s_add_u32 s19, s19, s69
    buffer_load_dwordx4 v[224:227], v17, s[60:63], s19 offen
    s_add_u32 s68, s68, 1
    s_and_b32 s68, s68, 31
    s_lshl_b32 s19, s68, 16
    s_add_u32 s19, s19, s69
    buffer_load_dwordx4 v[228:231], v17, s[60:63], s19 offen
    s_add_u32 s68, s68, 1
    s_and_b32 s68, s68, 31
    s_lshl_b32 s19, s68, 16
    s_add_u32 s19, s19, s69
    buffer_load_dwordx4 v[232:235], v17, s[60:63], s19 offen
    s_add_u32 s68, s68, 1
    s_and_b32 s68, s68, 31
    s_lshl_b32 s19, s68, 16
    s_add_u32 s19, s19, s69
    buffer_load_dwordx4 v[236:239], v17, s[60:63], s19 offen
    s_add_u32 s68, s68, 1
    s_and_b32 s68, s68, 31
    s_lshl_b32 s19, s68, 16
    s_add_u32 s19, s19, s69
    buffer_load_dwordx4 v[240:243], v17, s[60:63], s19 offen
    s_add_u32 s68, s68, 1
    s_and_b32 s68, s68, 31
    s_lshl_b32 s19, s68, 16
    s_add_u32 s19, s19, s69
    buffer_load_dwordx4 v[244:247], v17, s[60:63], s19 offen
    s_add_u32 s68, s68, 1
    s_and_b32 s68, s68, 31
    s_lshl_b32 s19, s68, 16
    s_add_u32 s19, s19, s69
    buffer_load_dwordx4 v[248:251], v17, s[60:63], s19 offen
    s_add_u32 s68, s68, 1
    s_and_b32 s68, s68, 31
    s_lshl_b32 s19, s68, 16
    s_add_u32 s19, s19, s69
    buffer_load_dwordx4 v[252:255], v17, s[60:63], s19 offen
    s_add_u32 s68, s68, 1
    s_and_b32 s68, s68, 31
    s_lshl_b32 s19, s68, 16
    s_add_u32 s19, s19, s69
    buffer_load_dwordx4 v[40:43], v17, s[60:63], s19 offen
    s_add_u32 s68, s68, 1
    s_and_b32 s68, s68, 31
    s_lshl_b32 s19, s68, 16
    s_add_u32 s19, s19, s69
    buffer_load_dwordx4 v[44:47], v17, s[60:63], s19 offen
    s_add_u32 s68, s68, 1
    s_and_b32 s68, s68, 31
    s_lshl_b32 s19, s68, 16
    s_add_u32 s19, s19, s69
    buffer_load_dwordx4 v[48:51], v17, s[60:63], s19 offen
    s_add_u32 s68, s68, 1
    s_and_b32 s68, s68, 31
    s_lshl_b32 s19, s68, 16
    s_add_u32 s19, s19, s69
    buffer_load_dwordx4 v[52:55], v17, s[60:63], s19 offen
    s_add_u32 s68, s68, 1
    s_and_b32 s68, s68, 31
    s_lshl_b32 s19, s68, 16
    s_add_u32 s19, s19, s69
    buffer_load_dwordx4 v[56:59], v17, s[60:63], s19 offen
    s_add_u32 s68, s68, 1
    s_and_b32 s68, s68, 31
    s_lshl_b32 s19, s68, 16
    s_add_u32 s19, s19, s69
    buffer_load_dwordx4 v[60:63], v17, s[60:63], s19 offen
    s_add_u32 s68, s68, 1
    s_and_b32 s68, s68, 31
    s_lshl_b32 s19, s68, 16
    s_add_u32 s19, s19, s69
    buffer_load_dwordx4 v[64:67], v17, s[60:63], s19 offen
    s_add_u32 s68, s68, 1
    s_and_b32 s68, s68, 31
    s_lshl_b32 s19, s68, 16
    s_add_u32 s19, s19, s69
    buffer_load_dwordx4 v[68:71], v17, s[60:63], s19 offen
    s_add_u32 s68, s68, 1
    s_and_b32 s68, s68, 31
    s_lshl_b32 s19, s68, 16
    s_add_u32 s19, s19, s69
    buffer_load_dwordx4 v[160:163], v17, s[60:63], s19 offen
    s_add_u32 s68, s68, 1
    s_and_b32 s68, s68, 31
    s_lshl_b32 s19, s68, 16
    s_add_u32 s19, s19, s69
    buffer_load_dwordx4 v[164:167], v17, s[60:63], s19 offen
    s_add_u32 s68, s68, 1
    s_and_b32 s68, s68, 31
    s_lshl_b32 s19, s68, 16
    s_add_u32 s19, s19, s69
    buffer_load_dwordx4 v[168:171], v17, s[60:63], s19 offen
    s_add_u32 s68, s68, 1
    s_and_b32 s68, s68, 31
    s_lshl_b32 s19, s68, 16
    s_add_u32 s19, s19, s69
    buffer_load_dwordx4 v[172:175], v17, s[60:63], s19 offen
    s_add_u32 s68, s68, 1
    s_and_b32 s68, s68, 31
    s_lshl_b32 s19, s68, 16
    s_add_u32 s19, s19, s69
    buffer_load_dwordx4 v[176:179], v17, s[60:63], s19 offen
    s_add_u32 s68, s68, 1
    s_and_b32 s68, s68, 31
    s_lshl_b32 s19, s68, 16
    s_add_u32 s19, s19, s69
    buffer_load_dwordx4 v[180:183], v17, s[60:63], s19 offen
    s_add_u32 s68, s68, 1
    s_and_b32 s68, s68, 31
    s_lshl_b32 s19, s68, 16
    s_add_u32 s19, s19, s69
    buffer_load_dwordx4 v[184:187], v17, s[60:63], s19 offen
    s_add_u32 s68, s68, 1
    s_and_b32 s68, s68, 31
    s_lshl_b32 s19, s68, 16
    s_add_u32 s19, s19, s69
    buffer_load_dwordx4 v[188:191], v17, s[60:63], s19 offen
    s_add_u32 s68, s68, 1
    s_and_b32 s68, s68, 31
    s_waitcnt vmcnt(32)
    s_waitcnt vmcnt(33)
    v_lshl_or_b32 v27, v27, 16, v27
    s_lshl_b32 s19, s17, 10
    s_add_u32 s19, s19, 26624
    v_and_b32_dpp v72, v27, v4 row_newbcast:0 row_mask:0xf bank_mask:0xf
    v_and_b32_dpp v73, v27, v5 row_newbcast:0 row_mask:0xf bank_mask:0xf
    v_and_b32_dpp v74, v27, v6 row_newbcast:0 row_mask:0xf bank_mask:0xf
    v_and_b32_dpp v75, v27, v7 row_newbcast:0 row_mask:0xf bank_mask:0xf
    v_and_b32_dpp v76, v27, v4 row_newbcast:1 row_mask:0xf bank_mask:0xf
    v_and_b32_dpp v77, v27, v5 row_newbcast:1 row_mask:0xf bank_mask:0xf
    v_mfma_f32_16x16x32_bf16 v[88:91], v[72:75], v[96:99], 0
    v_and_b32_dpp v78, v27, v6 row_newbcast:1 row_mask:0xf bank_mask:0xf
    v_and_b32_dpp v79, v27, v7 row_newbcast:1 row_mask:0xf bank_mask:0xf
    v_mfma_f32_16x16x32_bf16 v[92:95], v[72:75], v[128:131], 0
    v_and_b32_dpp v80, v27, v4 row_newbcast:2 row_mask:0xf bank_mask:0xf
    v_and_b32_dpp v81, v27, v5 row_newbcast:2 row_mask:0xf bank_mask:0xf
    v_mfma_f32_16x16x32_bf16 v[88:91], v[76:79], v[100:103], v[88:91]
    v_and_b32_dpp v82, v27, v6 row_newbcast:2 row_mask:0xf bank_mask:0xf
    v_and_b32_dpp v83, v27, v7 row_newbcast:2 row_mask:0xf bank_mask:0xf
    v_mfma_f32_16x16x32_bf16 v[92:95], v[76:79], v[132:135], v[92:95]
    v_and_b32_dpp v84, v27, v4 row_newbcast:3 row_mask:0xf bank_mask:0xf
    v_and_b32_dpp v85, v27, v5 row_newbcast:3 row_mask:0xf bank_mask:0xf
    v_mfma_f32_16x16x32_bf16 v[88:91], v[80:83], v[104:107], v[88:91]
    v_and_b32_dpp v86, v27, v6 row_newbcast:3 row_mask:0xf bank_mask:0xf
    v_and_b32_dpp v87, v27, v7 row_newbcast:3 row_mask:0xf bank_mask:0xf
    v_mfma_f32_16x16x32_bf16 v[92:95], v[80:83], v[136:139], v[92:95]
    v_and_b32_dpp v72, v27, v4 row_newbcast:4 row_mask:0xf bank_mask:0xf
    v_and_b32_dpp v73, v27, v5 row_newbcast:4 row_mask:0xf bank_mask:0xf
    v_mfma_f32_16x16x32_bf16 v[88:91], v[84:87], v[108:111], v[88:91]
    v_and_b32_dpp v74, v27, v6 row_newbcast:4 row_mask:0xf bank_mask:0xf
    v_and_b32_dpp v75, v27, v7 row_newbcast:4 row_mask:0xf bank_mask:0xf
    v_mfma_f32_16x16x32_bf16 v[92:95], v[84:87], v[140:143], v[92:95]
    v_and_b32_dpp v76, v27, v4 row_newbcast:5 row_mask:0xf bank_mask:0xf
    v_and_b32_dpp v77, v27, v5 row_newbcast:5 row_mask:0xf bank_mask:0xf
    v_mfma_f32_16x16x32_bf16 v[88:91], v[72:75], v[112:115], v[88:91]
    v_and_b32_dpp v78, v27, v6 row_newbcast:5 row_mask:0xf bank_mask:0xf
    v_and_b32_dpp v79, v27, v7 row_newbcast:5 row_mask:0xf bank_mask:0xf
    v_mfma_f32_16x16x32_bf16 v[92:95], v[72:75], v[144:147], v[92:95]
    v_and_b32_dpp v80, v27, v4 row_newbcast:6 row_mask:0xf bank_mask:0xf
    v_and_b32_dpp v81, v27, v5 row_newbcast:6 row_mask:0xf bank_mask:0xf
    v_mfma_f32_16x16x32_bf16 v[88:91], v[76:79], v[116:119], v[88:91]
    v_and_b32_dpp v82, v27, v6 row_newbcast:6 row_mask:0xf bank_mask:0xf
    v_and_b32_dpp v83, v27, v7 row_newbcast:6 row_mask:0xf bank_mask:0xf
    v_mfma_f32_16x16x32_bf16 v[92:95], v[76:79], v[148:151], v[92:95]
    v_and_b32_dpp v84, v27, v4 row_newbcast:7 row_mask:0xf bank_mask:0xf
    v_and_b32_dpp v85, v27, v5 row_newbcast:7 row_mask:0xf bank_mask:0xf
    v_mfma_f32_16x16x32_bf16 v[88:91], v[80:83], v[120:123], v[88:91]
    v_and_b32_dpp v86, v27, v6 row_newbcast:7 row_mask:0xf bank_mask:0xf
    v_and_b32_dpp v87, v27, v7 row_newbcast:7 row_mask:0xf bank_mask:0xf
    v_mfma_f32_16x16x32_bf16 v[92:95], v[80:83], v[152:155], v[92:95]
    v_add_u32 v26, s19, v3
    v_mov_b32 v28, 1
    v_mfma_f32_16x16x32_bf16 v[88:91], v[84:87], v[124:127], v[88:91]
    v_mfma_f32_16x16x32_bf16 v[92:95], v[84:87], v[156:159], v[92:95]
    s_nop 7
    v_permlane32_swap_b32 v88, v92
    v_permlane32_swap_b32 v89, v93
    v_permlane32_swap_b32 v90, v94
    v_permlane32_swap_b32 v91, v95
    ds_write_b128 v26, v[88:91]
    s_mov_b64 exec, 1
    ds_add_rtn_u32 v29, v13, v28 offset:32
    s_mov_b64 exec, -1
    s_waitcnt lgkmcnt(0)
    v_readfirstlane_b32 s19, v29
    s_nop 1
    s_cmp_lg_u32 s19, 3
    s_cbranch_scc1 L_gs10
    ds_read_b128 v[72:75], v3 offset:26624
    ds_read_b128 v[76:79], v3 offset:27648
    ds_read_b128 v[80:83], v3 offset:28672
    ds_read_b128 v[84:87], v3 offset:29696
    s_waitcnt lgkmcnt(0)
    v_pk_add_f32 v[72:73], v[72:73], v[76:77]
    v_pk_add_f32 v[74:75], v[74:75], v[78:79]
    v_pk_add_f32 v[80:81], v[80:81], v[84:85]
    v_pk_add_f32 v[82:83], v[82:83], v[86:87]
    v_pk_add_f32 v[72:73], v[72:73], v[80:81]
    v_pk_add_f32 v[74:75], v[74:75], v[82:83]
    v_bfi_b32 v72, v23, s80, v72
    v_bfi_b32 v73, v23, s81, v73
    v_bfi_b32 v74, v23, s82, v74
    v_bfi_b32 v75, v23, s83, v75
    s_cmp_ge_u32 s2, 224
    s_cbranch_scc1 L_gs10
    v_lshrrev_b32 v26, 5, v2
    v_mul_u32_u24 v26, 14336, v26
    v_lshl_add_u32 v26, v8, 5, v26
    v_and_b32 v29, 1, v9
    v_lshl_add_u32 v26, v29, 4, v26
    s_mul_i32 s19, s12, 28672
    s_lshl_b32 s3, s13, 9
    s_add_u32 s19, s19, s3
    s_add_u32 s19, s19, 4489216
    buffer_store_dwordx4 v[72:75], v26, s[32:35], s19 offen sc1
L_gs10:
    s_waitcnt vmcnt(24)
L_fw11:
    ds_read_b32 v29, v36 offset:144
    s_waitcnt lgkmcnt(0)
    v_cmp_ne_u32 vcc, v29, v37
    s_cbranch_vccz L_fk12
    s_add_u32 s79, s79, 1
    s_cmp_lt_u32 s79, 32768
    s_cbranch_scc1 L_fw11
L_fk12:
    ds_write_b128 v18, v[192:195] offset:0
    ds_write_b128 v18, v[196:199] offset:4096
    ds_write_b128 v18, v[200:203] offset:8192
    ds_write_b128 v18, v[204:207] offset:12288
    ds_write_b128 v18, v[208:211] offset:16384
    ds_write_b128 v18, v[212:215] offset:20480
    ds_write_b128 v18, v[216:219] offset:24576
    ds_write_b128 v18, v[220:223] offset:28672
    s_waitcnt vmcnt(16)
    ds_write_b128 v18, v[224:227] offset:32768
    ds_write_b128 v18, v[228:231] offset:36864
    ds_write_b128 v18, v[232:235] offset:40960
    ds_write_b128 v18, v[236:239] offset:45056
    ds_write_b128 v18, v[240:243] offset:49152
    ds_write_b128 v18, v[244:247] offset:53248
    ds_write_b128 v18, v[248:251] offset:57344
    ds_write_b128 v18, v[252:255] offset:61440
    v_min_u32 v26, 6, v20
    v_mul_u32_u24 v27, 28672, v19
    v_lshl_add_u32 v26, v26, 4, v27
    s_lshl_b32 s75, s73, 2
    s_add_u32 s75, s75, 4489216
    s_add_u32 s76, s75, 14336
    s_waitcnt vmcnt(8)
L_fw13:
    ds_read_b32 v29, v36 offset:160
    s_waitcnt lgkmcnt(0)
    v_cmp_ne_u32 vcc, v29, v37
    s_cbranch_vccz L_fk14
    s_add_u32 s79, s79, 1
    s_cmp_lt_u32 s79, 32768
    s_cbranch_scc1 L_fw13
L_fk14:
    ds_write_b128 v22, v[40:43] offset:0
    ds_write_b128 v22, v[44:47] offset:4096
    ds_write_b128 v22, v[48:51] offset:8192
    ds_write_b128 v22, v[52:55] offset:12288
    ds_write_b128 v22, v[56:59] offset:16384
    ds_write_b128 v22, v[60:63] offset:20480
    ds_write_b128 v22, v[64:67] offset:24576
    ds_write_b128 v22, v[68:71] offset:28672
    s_waitcnt vmcnt(0)
    ds_write_b128 v22, v[160:163] offset:32768
    ds_write_b128 v22, v[164:167] offset:36864
    ds_write_b128 v22, v[168:171] offset:40960
    ds_write_b128 v22, v[172:175] offset:45056
    ds_write_b128 v22, v[176:179] offset:49152
    ds_write_b128 v22, v[180:183] offset:53248
    ds_write_b128 v22, v[184:187] offset:57344
    ds_write_b128 v22, v[188:191] offset:61440
    s_lshl_b64 exec, 1, s17
    ds_write_b32 v36, v37 offset:208
    s_mov_b64 exec, -1
L_fw15:
    ds_read_b32 v29, v36 offset:192
    s_waitcnt lgkmcnt(0)
    v_cmp_ne_u32 vcc, v29, v37
    s_cbranch_vccz L_fk16
    s_add_u32 s79, s79, 1
    s_cmp_lt_u32 s79, 32768
    s_cbranch_scc1 L_fw15
L_fk16:
    buffer_load_dwordx4 v[96:99], v16, s[56:59], s74 offen nt
    s_add_u32 s74, s74, 8192
    buffer_load_dwordx4 v[100:103], v16, s[56:59], s74 offen nt
    s_add_u32 s74, s74, 8192
    buffer_load_dwordx4 v[104:107], v16, s[56:59], s74 offen nt
    s_add_u32 s74, s74, 8192
    buffer_load_dwordx4 v[108:111], v16, s[56:59], s74 offen nt
    s_add_u32 s74, s74, 8192
    buffer_load_dwordx4 v[112:115], v16, s[56:59], s74 offen nt
    s_add_u32 s74, s74, 8192
    buffer_load_dwordx4 v[116:119], v16, s[56:59], s74 offen nt
    s_add_u32 s74, s74, 8192
    buffer_load_dwordx4 v[120:123], v16, s[56:59], s74 offen nt
    s_add_u32 s74, s74, 8192
L_cw17:
    ds_read_b32 v29, v13 offset:64
    s_waitcnt lgkmcnt(0)
    v_cmp_gt_u32 vcc, 1, v29
    s_cbranch_vccz L_ck18
    s_add_u32 s79, s79, 1
    s_cmp_lt_u32 s79, 32768
    s_cbranch_scc1 L_cw17
L_ck18:
    buffer_load_dwordx4 v[72:75], v26, s[32:35], s75 offen sc1
    buffer_load_dwordx4 v[76:79], v26, s[32:35], s76 offen sc1
    s_waitcnt vmcnt(0)
L_gp19:
    v_xor_b32 v72, s80, v72
    v_xor_b32 v73, s81, v73
    v_xor_b32 v74, s82, v74
    v_xor_b32 v75, s83, v75
    v_xor_b32 v76, s80, v76
    v_xor_b32 v77, s81, v77
    v_xor_b32 v78, s82, v78
    v_xor_b32 v79, s83, v79
    v_or3_b32 v80, v72, v73, v74
    v_or3_b32 v81, v75, v76, v77
    v_or3_b32 v80, v80, v78, v79
    v_or_b32 v80, v80, v81
    v_and_b32 v80, v80, v23
    v_cmp_ne_u32 vcc, 0, v80
    s_cbranch_vccz L_gk20
    buffer_load_dwordx4 v[72:75], v26, s[32:35], s75 offen sc1
    buffer_load_dwordx4 v[76:79], v26, s[32:35], s76 offen sc1
    s_waitcnt vmcnt(0)
    s_add_u32 s79, s79, 1
    s_cmp_lt_u32 s79, 32768
    s_cbranch_scc1 L_gp19
L_gk20:
    s_waitcnt vmcnt(2)
    v_permlane32_swap_b32 v72, v74
    v_permlane32_swap_b32 v73, v75
    v_permlane32_swap_b32 v76, v78
    v_permlane32_swap_b32 v77, v79
    v_add_f32 v72, v72, v74
    v_add_f32 v73, v73, v75
    v_add_f32 v76, v76, v78
    v_add_f32 v77, v77, v79
    v_permlane16_swap_b32 v72, v73
    s_lshl_b32 s19, s17, 9
    v_permlane16_swap_b32 v76, v77
    v_add_f32 v72, v72, v73
    v_add_f32 v76, v76, v77
    s_add_u32 s19, s19, 30720
    v_add_f32_dpp v72, v72, v72 row_ror:8 row_mask:0xf bank_mask:0xf
    v_add_f32_dpp v76, v76, v76 row_ror:8 row_mask:0xf bank_mask:0xf
    v_add_u32 v26, s19, v3
    v_cvt_pk_bf16_f32 v72, v72, v76
    v_and_b32 v76, 0xffff0000, v72
    v_lshlrev_b32 v72, 16, v72
    v_mul_f32 v73, 0xbfb8aa3b, v72
    v_exp_f32 v73, v73
    s_nop 0
    v_add_f32 v73, 1.0, v73
    v_rcp_f32 v73, v73
    s_nop 0
    v_mul_f32 v73, v73, v72
    v_cvt_pk_bf16_f32 v73, v73, v73
    v_lshlrev_b32 v73, 16, v73
    v_mul_f32 v73, v73, v76
    v_cvt_pk_bf16_f32 v27, v73, v73
    s_nop 1
    v_and_b32_dpp v76, v27, v4 row_newbcast:0 row_mask:0xf bank_mask:0xf
    v_and_b32_dpp v77, v27, v5 row_newbcast:0 row_mask:0xf bank_mask:0xf
    v_and_b32_dpp v78, v27, v6 row_newbcast:0 row_mask:0xf bank_mask:0xf
    v_and_b32_dpp v79, v27, v7 row_newbcast:0 row_mask:0xf bank_mask:0xf
    v_and_b32_dpp v80, v27, v4 row_newbcast:1 row_mask:0xf bank_mask:0xf
    v_and_b32_dpp v81, v27, v5 row_newbcast:1 row_mask:0xf bank_mask:0xf
    v_mfma_f32_16x16x32_bf16 v[88:91], v[76:79], v[96:99], 0
    v_and_b32_dpp v82, v27, v6 row_newbcast:1 row_mask:0xf bank_mask:0xf
    v_and_b32_dpp v83, v27, v7 row_newbcast:1 row_mask:0xf bank_mask:0xf
    v_and_b32_dpp v84, v27, v4 row_newbcast:2 row_mask:0xf bank_mask:0xf
    v_and_b32_dpp v85, v27, v5 row_newbcast:2 row_mask:0xf bank_mask:0xf
    v_mfma_f32_16x16x32_bf16 v[88:91], v[80:83], v[100:103], v[88:91]
    v_and_b32_dpp v86, v27, v6 row_newbcast:2 row_mask:0xf bank_mask:0xf
    v_and_b32_dpp v87, v27, v7 row_newbcast:2 row_mask:0xf bank_mask:0xf
    v_and_b32_dpp v92, v27, v4 row_newbcast:3 row_mask:0xf bank_mask:0xf
    v_and_b32_dpp v93, v27, v5 row_newbcast:3 row_mask:0xf bank_mask:0xf
    v_mfma_f32_16x16x32_bf16 v[88:91], v[84:87], v[104:107], v[88:91]
    v_and_b32_dpp v94, v27, v6 row_newbcast:3 row_mask:0xf bank_mask:0xf
    v_and_b32_dpp v95, v27, v7 row_newbcast:3 row_mask:0xf bank_mask:0xf
    v_and_b32_dpp v76, v27, v4 row_newbcast:4 row_mask:0xf bank_mask:0xf
    v_and_b32_dpp v77, v27, v5 row_newbcast:4 row_mask:0xf bank_mask:0xf
    v_mfma_f32_16x16x32_bf16 v[88:91], v[92:95], v[108:111], v[88:91]
    v_and_b32_dpp v78, v27, v6 row_newbcast:4 row_mask:0xf bank_mask:0xf
    v_and_b32_dpp v79, v27, v7 row_newbcast:4 row_mask:0xf bank_mask:0xf
    v_and_b32_dpp v80, v27, v4 row_newbcast:5 row_mask:0xf bank_mask:0xf
    v_and_b32_dpp v81, v27, v5 row_newbcast:5 row_mask:0xf bank_mask:0xf
    v_mfma_f32_16x16x32_bf16 v[88:91], v[76:79], v[112:115], v[88:91]
    v_and_b32_dpp v82, v27, v6 row_newbcast:5 row_mask:0xf bank_mask:0xf
    v_and_b32_dpp v83, v27, v7 row_newbcast:5 row_mask:0xf bank_mask:0xf
    v_and_b32_dpp v84, v27, v4 row_newbcast:6 row_mask:0xf bank_mask:0xf
    v_and_b32_dpp v85, v27, v5 row_newbcast:6 row_mask:0xf bank_mask:0xf
    v_mfma_f32_16x16x32_bf16 v[88:91], v[80:83], v[116:119], v[88:91]
    v_and_b32_dpp v86, v27, v6 row_newbcast:6 row_mask:0xf bank_mask:0xf
    v_and_b32_dpp v87, v27, v7 row_newbcast:6 row_mask:0xf bank_mask:0xf
    s_nop 1
    v_mfma_f32_16x16x32_bf16 v[88:91], v[84:87], v[120:123], v[88:91]
    s_mov_b32 exec_hi, 0
    s_nop 6
    ds_write_b128 v26, v[88:91]
    s_mov_b64 exec, 1
    ds_add_rtn_u32 v29, v13, v28 offset:48
    s_mov_b64 exec, -1
    s_waitcnt lgkmcnt(0)
    v_readfirstlane_b32 s19, v29
    s_nop 1
    s_cmp_lg_u32 s19, 3
    s_cbranch_scc1 L_ys21
    ds_read_b128 v[72:75], v3 offset:30720
    ds_read_b128 v[76:79], v3 offset:31232
    ds_read_b128 v[80:83], v3 offset:31744
    ds_read_b128 v[84:87], v3 offset:32256
    s_waitcnt lgkmcnt(0)
    v_pk_add_f32 v[72:73], v[72:73], v[76:77]
    v_pk_add_f32 v[74:75], v[74:75], v[78:79]
    v_pk_add_f32 v[80:81], v[80:81], v[84:85]
    v_pk_add_f32 v[82:83], v[82:83], v[86:87]
    v_pk_add_f32 v[72:73], v[72:73], v[80:81]
    v_pk_add_f32 v[74:75], v[74:75], v[82:83]
    v_bfi_b32 v72, v23, s80, v72
    v_bfi_b32 v73, v23, s81, v73
    v_bfi_b32 v74, v23, s82, v74
    v_bfi_b32 v75, v23, s83, v75
    v_lshlrev_b32 v26, 5, v8
    v_lshl_add_u32 v26, v9, 4, v26
    s_lshl_b32 s19, s13, 12
    s_lshl_b32 s3, s12, 9
    s_add_u32 s19, s19, s3
    s_add_u32 s19, s19, 4718592
    s_mov_b32 exec_hi, 0
    buffer_store_dwordx4 v[72:75], v26, s[32:35], s19 offen sc1
    s_mov_b64 exec, -1
L_ys21:
    s_lshl_b32 s19, s12, 1
    s_and_b32 s3, s13, 1
    s_add_u32 s19, s19, s3
    s_lshr_b32 s3, s72, 7
    s_xor_b32 s19, s19, s3
    s_or_b32 s19, s19, s17
    s_cmp_lg_u32 s19, 0
    s_cbranch_scc1 L_ldone
    v_lshlrev_b32 v26, 12, v9
    v_lshl_add_u32 v26, v8, 4, v26
    v_lshl_add_u32 v29, v8, 2, v9
    v_lshlrev_b32 v30, 1, v29
    v_lshlrev_b32 v29, 2, v29
    s_lshl_b32 s75, s67, 8
    s_add_u32 s75, s75, 4718592
    s_lshl_b32 s19, s72, 11
    s_lshl_b32 s3, s67, 7
    s_add_u32 s19, s19, s3
    s_lshr_b32 s76, s72, 1
    s_lshl_b32 s76, s76, 3
    s_add_u32 s76, s76, 4472832
    buffer_load_ushort v31, v30, s[24:27], s19 offen
L_yp22:
    buffer_load_dwordx2 v[32:33], v13, s[32:35], s76 offen sc1
    s_mov_b32 s19, s75
    buffer_load_dwordx4 v[100:103], v26, s[32:35], s19 offen sc1
    s_add_u32 s19, s19, 16384
    buffer_load_dwordx4 v[104:107], v26, s[32:35], s19 offen sc1
    s_add_u32 s19, s19, 16384
    buffer_load_dwordx4 v[108:111], v26, s[32:35], s19 offen sc1
    s_add_u32 s19, s19, 16384
    buffer_load_dwordx4 v[112:115], v26, s[32:35], s19 offen sc1
    s_add_u32 s19, s19, 16384
    buffer_load_dwordx4 v[116:119], v26, s[32:35], s19 offen sc1
    s_add_u32 s19, s19, 16384
    buffer_load_dwordx4 v[120:123], v26, s[32:35], s19 offen sc1
    s_add_u32 s19, s19, 16384
    buffer_load_dwordx4 v[124:127], v26, s[32:35], s19 offen sc1
    s_add_u32 s19, s19, 16384
    buffer_load_dwordx4 v[128:131], v26, s[32:35], s19 offen sc1
    s_add_u32 s19, s19, 16384
    s_waitcnt vmcnt(0)
    v_xor_b32 v33, s78, v33
    v_xor_b32 v100, s80, v100
    v_xor_b32 v101, s81, v101
    v_xor_b32 v102, s82, v102
    v_xor_b32 v103, s83, v103
    v_xor_b32 v104, s80, v104
    v_xor_b32 v105, s81, v105
    v_xor_b32 v106, s82, v106
    v_xor_b32 v107, s83, v107
    v_xor_b32 v108, s80, v108
    v_xor_b32 v109, s81, v109
    v_xor_b32 v110, s82, v110
    v_xor_b32 v111, s83, v111
    v_xor_b32 v112, s80, v112
    v_xor_b32 v113, s81, v113
    v_xor_b32 v114, s82, v114
    v_xor_b32 v115, s83, v115
    v_xor_b32 v116, s80, v116
    v_xor_b32 v117, s81, v117
    v_xor_b32 v118, s82, v118
    v_xor_b32 v119, s83, v119
    v_xor_b32 v120, s80, v120
    v_xor_b32 v121, s81, v121
    v_xor_b32 v122, s82, v122
    v_xor_b32 v123, s83, v123
    v_xor_b32 v124, s80, v124
    v_xor_b32 v125, s81, v125
    v_xor_b32 v126, s82, v126
    v_xor_b32 v127, s83, v127
    v_xor_b32 v128, s80, v128
    v_xor_b32 v129, s81, v129
    v_xor_b32 v130, s82, v130
    v_xor_b32 v131, s83, v131
    v_or_b32 v34, v100, v101
    v_or3_b32 v34, v34, v102, v103
    v_or3_b32 v34, v34, v104, v105
    v_or3_b32 v34, v34, v106, v107
    v_or3_b32 v34, v34, v108, v109
    v_or3_b32 v34, v34, v110, v111
    v_or3_b32 v34, v34, v112, v113
    v_or3_b32 v34, v34, v114, v115
    v_or3_b32 v34, v34, v116, v117
    v_or3_b32 v34, v34, v118, v119
    v_or3_b32 v34, v34, v120, v121
    v_or3_b32 v34, v34, v122, v123
    v_or3_b32 v34, v34, v124, v125
    v_or3_b32 v34, v34, v126, v127
    v_or3_b32 v34, v34, v128, v129
    v_or3_b32 v34, v34, v130, v131
    v_and_b32 v34, v34, v23
    v_or_b32 v34, v34, v33
    v_cmp_ne_u32 vcc, 0, v34
    s_cbranch_vccz L_yk23
    s_add_u32 s79, s79, 1
    s_cmp_lt_u32 s79, 32768
    s_cbranch_scc1 L_yp22
L_yk23:
    v_pk_add_f32 v[100:101], v[100:101], v[116:117]
    v_pk_add_f32 v[102:103], v[102:103], v[118:119]
    v_pk_add_f32 v[104:105], v[104:105], v[120:121]
    v_pk_add_f32 v[106:107], v[106:107], v[122:123]
    v_pk_add_f32 v[108:109], v[108:109], v[124:125]
    v_pk_add_f32 v[110:111], v[110:111], v[126:127]
    v_pk_add_f32 v[112:113], v[112:113], v[128:129]
    v_pk_add_f32 v[114:115], v[114:115], v[130:131]
    v_pk_add_f32 v[100:101], v[100:101], v[108:109]
    v_pk_add_f32 v[102:103], v[102:103], v[110:111]
    v_pk_add_f32 v[104:105], v[104:105], v[112:113]
    v_pk_add_f32 v[106:107], v[106:107], v[114:115]
    v_pk_add_f32 v[100:101], v[100:101], v[104:105]
    v_pk_add_f32 v[102:103], v[102:103], v[106:107]
    s_nop 1
    v_permlane32_swap_b32 v100, v102
    v_permlane32_swap_b32 v101, v103
    v_add_f32 v100, v100, v102
    v_add_f32 v101, v101, v103
    s_nop 1
    v_permlane16_swap_b32 v100, v101
    v_add_f32 v100, v100, v101
    s_lshr_b32 s19, s71, 11
    s_lshl_b32 s19, s19, 16
    s_not_b32 s3, s19
    s_ashr_i32 s3, s3, 31
    s_or_b32 s3, s3, 0x80000000
    s_xor_b32 s19, s19, s3
    s_and_b32 s19, s19, 0xffff0000
    v_mov_b32 v34, s19
    v_mul_f32 v34, 0xbfb8aa3b, v34
    v_exp_f32 v34, v34
    s_nop 0
    v_add_f32 v34, 1.0, v34
    v_rcp_f32 v34, v34
    s_nop 0
    v_cvt_pk_bf16_f32 v34, v34, v100
    v_and_b32 v35, 0xffff0000, v34
    v_lshlrev_b32 v34, 16, v34
    v_mul_f32 v34, v34, v35
    v_cvt_pk_bf16_f32 v34, v34, v34
    v_lshlrev_b32 v34, 16, v34
    v_lshlrev_b32 v31, 16, v31
    v_add_f32 v34, v34, v31
    s_and_b32 s3, s72, 1
    s_lshl_b32 s3, s3, 4
    v_lshrrev_b32 v32, s3, v32
    v_lshlrev_b32 v32, 16, v32
    v_sub_f32 v32, 1.0, v32
    v_cvt_pk_bf16_f32 v34, v34, v32
    v_and_b32 v35, 0xffff0000, v34
    v_lshlrev_b32 v34, 16, v34
    v_mul_f32 v34, v34, v35
    v_cvt_pk_bf16_f32 v34, v34, v34
    v_lshlrev_b32 v34, 16, v34
    v_mov_b32 v28, 1
    ds_write_b32 v29, v34 offset:512
    ds_write_b32 v13, v37 offset:224
    s_waitcnt lgkmcnt(0)
L_ldone:
    s_endpgm
L_compute:
    s_mov_b64 s[32:33], s[98:99]
    s_mov_b32 s34, 16777216
    s_mov_b32 s35, 0x00020000
    s_mov_b64 s[36:37], s[96:97]
    s_mov_b32 s38, 256
    s_mov_b32 s39, 0x00020000
    s_mov_b64 s[40:41], s[8:9]
    s_mov_b32 s42, 65536
    s_mov_b32 s43, 0x00020000
    s_mov_b64 s[44:45], s[94:95]
    s_mov_b32 s46, 4194304
    s_mov_b32 s47, 0x00020000
    s_mov_b64 s[60:61], s[98:99]
    s_mov_b32 s62, 16777216
    s_mov_b32 s63, 0x00020000
    s_mov_b32 s79, 0
    s_lshr_b32 s17, s16, 1
    s_and_b32 s18, s16, 1
    v_mov_b32 v13, 0
    v_and_b32 v4, 15, v2
    v_lshrrev_b32 v9, 4, v2
    s_or_b32 s19, s2, s16
    s_cmp_lg_u32 s19, 0
    s_cbranch_scc1 L_tp24
    s_memrealtime s[20:21]
    s_waitcnt lgkmcnt(0)
    s_or_b32 s20, s20, 1
    v_mov_b32 v3, s20
    s_mov_b64 exec, 1
    buffer_store_dword v3, v13, s[36:39], 0 offen offset:4 sc1
    s_mov_b64 exec, -1
L_tp24:
    s_lshl_b32 s67, s15, 1
    s_add_u32 s67, s67, s18
    s_lshl_b32 s19, s67, 11
    v_lshlrev_b32 v5, 6, v4
    v_lshl_add_u32 v5, v9, 3, v5
    buffer_load_dwordx2 v[60:61], v5, s[40:43], s19 offen offset:0
    buffer_load_dwordx2 v[62:63], v5, s[40:43], s19 offen offset:32
    buffer_load_dwordx2 v[64:65], v5, s[40:43], s19 offen offset:1024
    buffer_load_dwordx2 v[66:67], v5, s[40:43], s19 offen offset:1056
    s_lshl_b32 s19, s17, 13
    v_lshlrev_b32 v6, 7, v4
    v_add_u32 v6, s19, v6
    v_bfe_u32 v7, v2, 1, 3
    v_add_u32 v8, 0, v9
    v_xor_b32 v8, v8, v7
    v_lshl_add_u32 v20, v8, 4, v6
    v_add_u32 v8, 4, v9
    v_xor_b32 v8, v8, v7
    v_lshl_add_u32 v21, v8, 4, v6
    v_add_u32 v22, 40960, v20
    v_add_u32 v23, 40960, v21
    v_add_u32 v24, 81920, v20
    v_add_u32 v25, 81920, v21
    v_add_u32 v26, 122880, v20
    v_add_u32 v27, 122880, v21
    v_lshlrev_b32 v6, 10, v9
    v_bfe_u32 v7, v2, 2, 2
    v_lshl_add_u32 v6, v7, 7, v6
    v_bfe_u32 v7, v2, 3, 1
    v_xor_b32 v7, s18, v7
    v_lshl_add_u32 v6, v7, 6, v6
    v_bfe_u32 v7, v2, 4, 1
    v_lshl_add_u32 v6, v7, 5, v6
    v_and_b32 v7, 3, v2
    v_lshl_add_u32 v6, v7, 3, v6
    v_add_u32 v36, 16384, v6
    v_xor_b32 v37, 32, v36
    v_add_u32 v38, 57344, v6
    v_xor_b32 v39, 32, v38
    v_add_u32 v40, 98304, v6
    v_xor_b32 v41, 32, v40
    v_add_u32 v42, 139264, v6
    v_xor_b32 v43, 32, v42
    v_lshrrev_b32 v5, 2, v4
    v_and_b32 v6, 1, v4
    v_lshlrev_b32 v6, 4, v6
    v_mov_b32 v7, 0x3f80
    v_lshlrev_b32 v7, v6, v7
    v_cmp_eq_u32 vcc, v5, v9
    s_nop 1
    v_cndmask_b32 v7, 0, v7, vcc
    v_and_b32 v6, 2, v4
    v_cmp_eq_u32 vcc, 0, v6
    s_nop 1
    v_cndmask_b32 v52, 0, v7, vcc
    v_cndmask_b32 v53, v7, v13, vcc
    v_mov_b32 v56, 0x3f803f80
    v_mov_b32 v57, 0x3f803f80
    v_mov_b32 v58, 0x3f803f80
    v_mov_b32 v59, 0x3f803f80
    v_lshlrev_b32 v3, 4, v2
    v_lshlrev_b32 v12, 4, v9
    v_lshrrev_b32 v11, 5, v2
    v_lshlrev_b32 v8, 9, v11
    v_and_b32 v19, 16, v12
    v_add_u32 v8, v8, v19
    v_lshlrev_b32 v11, 2, v11
    v_lshl_add_u32 v11, v4, 4, v11
    v_lshlrev_b32 v9, 10, v9
    v_lshl_add_u32 v9, v4, 4, v9
    v_lshlrev_b32 v10, 3, v2
    s_xor_b32 s3, s16, 2
    s_mul_i32 s19, s3, 6144
    s_add_u32 s19, s19, 2048
    v_add_u32 v4, s19, v3
    s_mul_i32 s19, s16, 6144
    s_add_u32 s19, s19, 2048
    v_add_u32 v5, s19, v3
    v_lshlrev_b32 v7, 2, v2
    s_lshl_b32 s19, s3, 8
    s_add_u32 s19, s19, 1024
    v_add_u32 v6, s19, v7
    s_lshl_b32 s19, s16, 8
    s_add_u32 s19, s19, 1024
    v_add_u32 v7, s19, v7
    v_mov_b32 v15, 0x3ff
    v_mov_b32 v18, 0x7fc17fc1
    s_lshl_b32 s19, s16, 2
    v_mov_b32 v1, s19
    v_mov_b32 v19, -1
    s_lshl_b32 s19, s15, 2
    s_lshr_b32 s3, s14, 2
    s_add_u32 s19, s19, s3
    s_and_b32 s3, s14, 1
    s_bfe_u32 s20, s14, 0x10001
    s_lshl_b32 s20, s20, 3
    s_lshl_b32 s64, s19, 1
    s_add_u32 s64, s64, s3
    s_lshl_b32 s64, s64, 2
    s_add_u32 s64, s64, s16
    s_lshl_b32 s64, s64, 8
    s_add_u32 s64, s64, s20
    s_add_u32 s64, s64, 4325376
    s_lshl_b32 s65, s19, 1
    s_add_u32 s65, s65, s3
    s_lshl_b32 s65, s65, 1
    s_add_u32 s65, s65, s17
    s_lshl_b32 s65, s65, 4
    s_add_u32 s65, s65, s20
    s_lshl_b32 s3, s18, 2
    s_add_u32 s65, s65, s3
    s_add_u32 s65, s65, 4456448
    s_mov_b32 s74, 0x3fb8aa3b
    s_mov_b32 s76, 0xbfb8aa3b
    s_mov_b32 s75, 0
    s_mov_b32 s77, 0
    s_mov_b32 s69, 0
    s_mov_b32 s71, 0
    s_cmp_lg_u32 s17, 0
    s_cselect_b32 s68, s74, s76
    s_cselect_b32 s70, s76, s74
    s_cselect_b64 s[72:73], -1, 0
    s_mov_b32 s66, 0
    s_lshl_b32 s19, s15, 4
    s_lshl_b32 s3, s18, 3
    s_add_u32 s19, s19, s3
    s_lshl_b32 s3, s17, 2
    s_add_u32 s19, s19, s3
    s_lshl_b32 s19, s19, 4
    s_add_u32 s19, s19, s14
    s_lshl_b32 s48, s19, 10
    s_lshl_b32 s49, s19, 5
    s_add_u32 s49, s49, 4194304
    s_lshl_b32 s19, s15, 4
    s_add_u32 s19, s19, s14
    s_lshl_b32 s50, s19, 6
    s_add_u32 s50, s50, s16
    s_lshl_b32 s50, s50, 8
    s_lshl_b32 s51, s19, 9
    s_add_u32 s51, s51, 4194304
    s_lshl_b32 s19, s14, 1
    s_add_u32 s19, s19, s17
    s_lshl_b32 s52, s19, 17
    s_lshl_b32 s3, s67, 10
    s_add_u32 s52, s52, s3
    s_add_u32 s52, s52, 8388608
    s_lshl_b32 s53, s19, 5
    s_add_u32 s53, s53, s67
    s_lshl_b32 s53, s53, 2
    s_add_u32 s53, s53, 4481024
    s_lshl_b32 s19, s12, 1
    s_and_b32 s3, s13, 1
    s_add_u32 s19, s19, s3
    s_lshl_b32 s58, s19, 2
    s_add_u32 s58, s58, s16
    s_bfe_u32 s19, s13, 0x10001
    s_lshl_b32 s19, s19, 3
    s_lshr_b32 s3, s13, 2
    s_add_u32 s19, s19, s3
    s_xor_b32 s19, s19, 4
    s_lshl_b32 s54, s58, 16
    s_lshl_b32 s3, s19, 7
    s_add_u32 s54, s54, s3
    s_add_u32 s55, s54, 32768
    s_lshr_b32 s56, s58, 1
    s_lshl_b32 s56, s56, 7
    s_add_u32 s56, s56, 4481024
    s_lshl_b32 s57, s58, 7
    s_add_u32 s57, s57, 4472832
    s_lshl_b32 s59, s67, 12
    s_add_u32 s59, s59, 4325376
    s_lshl_b32 s28, s67, 7
    s_add_u32 s28, s28, 4456448
    s_mov_b32 s29, 0
    v_lshrrev_b32 v19, 4, v2
    v_and_b32 v54, 15, v2
    v_lshlrev_b32 v54, 6, v54
    v_lshl_add_u32 v76, v19, 14, v54
    v_lshl_add_u32 v77, v19, 15, v54
    v_lshrrev_b32 v19, 1, v2
    v_and_b32 v54, 1, v2
    v_lshlrev_b32 v54, 6, v54
    v_lshl_add_u32 v78, v19, 11, v54
    v_lshlrev_b32 v79, 9, v2
    v_lshrrev_b32 v54, 1, v2
    v_lshlrev_b32 v54, 10, v54
    v_and_b32 v19, 1, v2
    v_lshl_add_u32 v54, v19, 7, v54
    v_add_u32 v54, s50, v54
    v_lshlrev_b32 v19, 7, v2
    v_add_u32 v55, s51, v19
    s_sub_u32 s3, s59, 4096
    v_add_u32 v19, s3, v19
    v_cmp_gt_u32 vcc, 32, v2
    s_nop 1
    v_cndmask_b32 v54, v19, v54, vcc
    v_mov_b32 v19, s28
    v_cmp_gt_u32 vcc, 4, v2
    s_nop 1
    v_cndmask_b32 v55, v19, v55, vcc
    v_mov_b32 v19, -1
    s_lshl_b32 s19, s14, 4
    s_add_u32 s19, s19, s15
    s_lshl_b32 s53, s19, 7
    s_add_u32 s53, s53, 4849664
    s_lshr_b32 s19, s58, 2
    s_lshl_b32 s56, s19, 11
    s_add_u32 s56, s56, 4849664
    v_mov_b64 v[160:161], 0
    v_mov_b64 v[162:163], 0
    v_mov_b64 v[164:165], 0
    v_mov_b64 v[166:167], 0
    v_mov_b64 v[168:169], 0
    v_mov_b64 v[170:171], 0
    v_mov_b64 v[172:173], 0
    v_mov_b64 v[174:175], 0
    v_mov_b64 v[176:177], 0
    v_mov_b64 v[178:179], 0
    v_mov_b64 v[180:181], 0
    v_mov_b64 v[182:183], 0
    v_mov_b64 v[184:185], 0
    v_mov_b64 v[186:187], 0
    v_mov_b64 v[188:189], 0
    v_mov_b64 v[190:191], 0
    v_mov_b64 v[192:193], 0
    v_mov_b64 v[194:195], 0
    v_mov_b64 v[196:197], 0
    v_mov_b64 v[198:199], 0
    v_mov_b64 v[200:201], 0
    v_mov_b64 v[202:203], 0
    v_mov_b64 v[204:205], 0
    v_mov_b64 v[206:207], 0
    v_mov_b64 v[208:209], 0
    v_mov_b64 v[210:211], 0
    v_mov_b64 v[212:213], 0
    v_mov_b64 v[214:215], 0
    v_mov_b64 v[216:217], 0
    v_mov_b64 v[218:219], 0
    v_mov_b64 v[220:221], 0
    v_mov_b64 v[222:223], 0
    v_mov_b64 v[224:225], 0
    v_mov_b64 v[226:227], 0
    v_mov_b64 v[228:229], 0
    v_mov_b64 v[230:231], 0
    v_mov_b64 v[232:233], 0
    v_mov_b64 v[234:235], 0
    v_mov_b64 v[236:237], 0
    v_mov_b64 v[238:239], 0
    v_mov_b64 v[240:241], 0
    v_mov_b64 v[242:243], 0
    v_mov_b64 v[244:245], 0
    v_mov_b64 v[246:247], 0
    v_mov_b64 v[248:249], 0
    v_mov_b64 v[250:251], 0
    v_mov_b64 v[252:253], 0
    v_mov_b64 v[254:255], 0
    s_waitcnt vmcnt(4)
    s_barrier
    ds_read_b128 v[80:83], v20 offset:0
    ds_read_b64_tr_b16 v[96:97], v36 offset:0
    ds_read_b64_tr_b16 v[98:99], v36 offset:512
    ds_read_b128 v[84:87], v20 offset:2048
    ds_read_b128 v[88:91], v20 offset:4096
    ds_read_b128 v[92:95], v20 offset:6144
    ds_read_b64_tr_b16 v[100:101], v37 offset:0
    ds_read_b64_tr_b16 v[102:103], v37 offset:512
    ds_read_b64_tr_b16 v[104:105], v36 offset:8192
    ds_read_b64_tr_b16 v[106:107], v36 offset:8704
    ds_read_b64_tr_b16 v[108:109], v37 offset:8192
    ds_read_b64_tr_b16 v[110:111], v37 offset:8704
    ds_read_b64_tr_b16 v[112:113], v36 offset:16384
    ds_read_b64_tr_b16 v[114:115], v36 offset:16896
    ds_read_b64_tr_b16 v[116:117], v37 offset:16384
    ds_read_b64_tr_b16 v[118:119], v37 offset:16896
    s_mov_b32 exec_lo, 0xffff
    s_mov_b32 exec_hi, 0xffff
    buffer_store_dword v19, v11, s[32:35], s64 offen sc1
    s_lshl_b64 exec, 1, s16
    buffer_store_dword v19, v13, s[32:35], s65 offen sc1
    s_mov_b64 exec, -1
.p2align 7
L_loop:
    s_waitcnt lgkmcnt(10)
    v_mfma_f32_16x16x32_bf16 v[160:163], v[96:99], v[80:83], v[160:163]
    ds_read_b128 v[120:123], v21 offset:0
    v_mfma_f32_16x16x32_bf16 v[164:167], v[96:99], v[84:87], v[164:167]
    ds_read_b64_tr_b16 v[136:137], v36 offset:4096
    v_mfma_f32_16x16x32_bf16 v[168:171], v[96:99], v[88:91], v[168:171]
    ds_read_b64_tr_b16 v[138:139], v36 offset:4608
    v_mfma_f32_16x16x32_bf16 v[172:175], v[96:99], v[92:95], v[172:175]
    s_waitcnt lgkmcnt(11)
    v_mfma_f32_16x16x32_bf16 v[188:191], v[100:103], v[92:95], v[188:191]
    ds_read_b128 v[124:127], v21 offset:2048
    v_mfma_f32_16x16x32_bf16 v[184:187], v[100:103], v[88:91], v[184:187]
    ds_read_b128 v[128:131], v21 offset:4096
    v_mfma_f32_16x16x32_bf16 v[180:183], v[100:103], v[84:87], v[180:183]
    ds_read_b128 v[132:135], v21 offset:6144
    v_mfma_f32_16x16x32_bf16 v[176:179], v[100:103], v[80:83], v[176:179]
    s_waitcnt lgkmcnt(12)
    v_mfma_f32_16x16x32_bf16 v[192:195], v[104:107], v[80:83], v[192:195]
    ds_read_b64_tr_b16 v[140:141], v37 offset:4096
    v_mfma_f32_16x16x32_bf16 v[196:199], v[104:107], v[84:87], v[196:199]
    ds_read_b64_tr_b16 v[142:143], v37 offset:4608
    v_mfma_f32_16x16x32_bf16 v[200:203], v[104:107], v[88:91], v[200:203]
    ds_read_b64_tr_b16 v[144:145], v36 offset:12288
    v_mfma_f32_16x16x32_bf16 v[204:207], v[104:107], v[92:95], v[204:207]
    s_waitcnt lgkmcnt(13)
    v_mfma_f32_16x16x32_bf16 v[220:223], v[108:111], v[92:95], v[220:223]
    ds_read_b64_tr_b16 v[146:147], v36 offset:12800
    v_mfma_f32_16x16x32_bf16 v[216:219], v[108:111], v[88:91], v[216:219]
    ds_read_b64_tr_b16 v[148:149], v37 offset:12288
    v_mfma_f32_16x16x32_bf16 v[212:215], v[108:111], v[84:87], v[212:215]
    ds_read_b64_tr_b16 v[150:151], v37 offset:12800
    v_mfma_f32_16x16x32_bf16 v[208:211], v[108:111], v[80:83], v[208:211]
    s_waitcnt lgkmcnt(14)
    v_mfma_f32_16x16x32_bf16 v[224:227], v[80:83], v[112:115], v[224:227]
    ds_read_b64_tr_b16 v[152:153], v36 offset:20480
    v_mfma_f32_16x16x32_bf16 v[228:231], v[84:87], v[112:115], v[228:231]
    ds_read_b64_tr_b16 v[154:155], v36 offset:20992
    v_mfma_f32_16x16x32_bf16 v[232:235], v[88:91], v[112:115], v[232:235]
    ds_read_b64_tr_b16 v[156:157], v37 offset:20480
    v_mfma_f32_16x16x32_bf16 v[236:239], v[92:95], v[112:115], v[236:239]
    s_waitcnt lgkmcnt(15)
    v_mfma_f32_16x16x32_bf16 v[252:255], v[92:95], v[116:119], v[252:255]
    ds_read_b64_tr_b16 v[158:159], v37 offset:20992
    v_mfma_f32_16x16x32_bf16 v[248:251], v[88:91], v[116:119], v[248:251]
    v_mfma_f32_16x16x32_bf16 v[244:247], v[84:87], v[116:119], v[244:247]
    v_mfma_f32_16x16x32_bf16 v[240:243], v[80:83], v[116:119], v[240:243]
    s_waitcnt lgkmcnt(10)
    v_mfma_f32_16x16x32_bf16 v[160:163], v[136:139], v[120:123], v[160:163]
    v_mfma_f32_16x16x32_bf16 v[164:167], v[136:139], v[124:127], v[164:167]
    v_mfma_f32_16x16x32_bf16 v[168:171], v[136:139], v[128:131], v[168:171]
    v_mfma_f32_16x16x32_bf16 v[172:175], v[136:139], v[132:135], v[172:175]
    s_waitcnt lgkmcnt(0)
    s_barrier
    ds_read_b128 v[80:83], v22 offset:0
    v_mfma_f32_16x16x32_bf16 v[188:191], v[140:143], v[132:135], v[188:191]
    ds_read_b64_tr_b16 v[96:97], v38 offset:0
    v_mfma_f32_16x16x32_bf16 v[184:187], v[140:143], v[128:131], v[184:187]
    ds_read_b64_tr_b16 v[98:99], v38 offset:512
    v_mfma_f32_16x16x32_bf16 v[180:183], v[140:143], v[124:127], v[180:183]
    ds_read_b128 v[84:87], v22 offset:2048
    v_mfma_f32_16x16x32_bf16 v[176:179], v[140:143], v[120:123], v[176:179]
    ds_read_b128 v[88:91], v22 offset:4096
    v_mfma_f32_16x16x32_bf16 v[192:195], v[144:147], v[120:123], v[192:195]
    ds_read_b128 v[92:95], v22 offset:6144
    v_mfma_f32_16x16x32_bf16 v[196:199], v[144:147], v[124:127], v[196:199]
    ds_read_b64_tr_b16 v[100:101], v39 offset:0
    v_mfma_f32_16x16x32_bf16 v[200:203], v[144:147], v[128:131], v[200:203]
    ds_read_b64_tr_b16 v[102:103], v39 offset:512
    v_mfma_f32_16x16x32_bf16 v[204:207], v[144:147], v[132:135], v[204:207]
    ds_read_b64_tr_b16 v[104:105], v38 offset:8192
    v_mfma_f32_16x16x32_bf16 v[220:223], v[148:151], v[132:135], v[220:223]
    ds_read_b64_tr_b16 v[106:107], v38 offset:8704
    v_mfma_f32_16x16x32_bf16 v[216:219], v[148:151], v[128:131], v[216:219]
    ds_read_b64_tr_b16 v[108:109], v39 offset:8192
    v_mfma_f32_16x16x32_bf16 v[212:215], v[148:151], v[124:127], v[212:215]
    ds_read_b64_tr_b16 v[110:111], v39 offset:8704
    v_mfma_f32_16x16x32_bf16 v[208:211], v[148:151], v[120:123], v[208:211]
    ds_read_b64_tr_b16 v[112:113], v38 offset:16384
    v_mfma_f32_16x16x32_bf16 v[224:227], v[120:123], v[152:155], v[224:227]
    ds_read_b64_tr_b16 v[114:115], v38 offset:16896
    v_mfma_f32_16x16x32_bf16 v[228:231], v[124:127], v[152:155], v[228:231]
    ds_read_b64_tr_b16 v[116:117], v39 offset:16384
    v_mfma_f32_16x16x32_bf16 v[232:235], v[128:131], v[152:155], v[232:235]
    ds_read_b64_tr_b16 v[118:119], v39 offset:16896
    v_mfma_f32_16x16x32_bf16 v[236:239], v[132:135], v[152:155], v[236:239]
    v_mfma_f32_16x16x32_bf16 v[252:255], v[132:135], v[156:159], v[252:255]
    v_mfma_f32_16x16x32_bf16 v[248:251], v[128:131], v[156:159], v[248:251]
    v_mfma_f32_16x16x32_bf16 v[244:247], v[124:127], v[156:159], v[244:247]
    v_mfma_f32_16x16x32_bf16 v[240:243], v[120:123], v[156:159], v[240:243]
    s_cmp_eq_u32 s66, 2
    s_cbranch_scc1 L_mid
L_midret:
    s_waitcnt lgkmcnt(10)
    v_mfma_f32_16x16x32_bf16 v[160:163], v[96:99], v[80:83], v[160:163]
    ds_read_b128 v[120:123], v23 offset:0
    v_mfma_f32_16x16x32_bf16 v[164:167], v[96:99], v[84:87], v[164:167]
    ds_read_b64_tr_b16 v[136:137], v38 offset:4096
    v_mfma_f32_16x16x32_bf16 v[168:171], v[96:99], v[88:91], v[168:171]
    ds_read_b64_tr_b16 v[138:139], v38 offset:4608
    v_mfma_f32_16x16x32_bf16 v[172:175], v[96:99], v[92:95], v[172:175]
    s_waitcnt lgkmcnt(11)
    v_mfma_f32_16x16x32_bf16 v[188:191], v[100:103], v[92:95], v[188:191]
    ds_read_b128 v[124:127], v23 offset:2048
    v_mfma_f32_16x16x32_bf16 v[184:187], v[100:103], v[88:91], v[184:187]
    ds_read_b128 v[128:131], v23 offset:4096
    v_mfma_f32_16x16x32_bf16 v[180:183], v[100:103], v[84:87], v[180:183]
    ds_read_b128 v[132:135], v23 offset:6144
    v_mfma_f32_16x16x32_bf16 v[176:179], v[100:103], v[80:83], v[176:179]
    s_waitcnt lgkmcnt(12)
    v_mfma_f32_16x16x32_bf16 v[192:195], v[104:107], v[80:83], v[192:195]
    ds_read_b64_tr_b16 v[140:141], v39 offset:4096
    v_mfma_f32_16x16x32_bf16 v[196:199], v[104:107], v[84:87], v[196:199]
    ds_read_b64_tr_b16 v[142:143], v39 offset:4608
    v_mfma_f32_16x16x32_bf16 v[200:203], v[104:107], v[88:91], v[200:203]
    ds_read_b64_tr_b16 v[144:145], v38 offset:12288
    v_mfma_f32_16x16x32_bf16 v[204:207], v[104:107], v[92:95], v[204:207]
    s_waitcnt lgkmcnt(13)
    v_mfma_f32_16x16x32_bf16 v[220:223], v[108:111], v[92:95], v[220:223]
    ds_read_b64_tr_b16 v[146:147], v38 offset:12800
    v_mfma_f32_16x16x32_bf16 v[216:219], v[108:111], v[88:91], v[216:219]
    ds_read_b64_tr_b16 v[148:149], v39 offset:12288
    v_mfma_f32_16x16x32_bf16 v[212:215], v[108:111], v[84:87], v[212:215]
    ds_read_b64_tr_b16 v[150:151], v39 offset:12800
    v_mfma_f32_16x16x32_bf16 v[208:211], v[108:111], v[80:83], v[208:211]
    s_waitcnt lgkmcnt(14)
    v_mfma_f32_16x16x32_bf16 v[224:227], v[80:83], v[112:115], v[224:227]
    ds_read_b64_tr_b16 v[152:153], v38 offset:20480
    v_mfma_f32_16x16x32_bf16 v[228:231], v[84:87], v[112:115], v[228:231]
    ds_read_b64_tr_b16 v[154:155], v38 offset:20992
    v_mfma_f32_16x16x32_bf16 v[232:235], v[88:91], v[112:115], v[232:235]
    ds_read_b64_tr_b16 v[156:157], v39 offset:20480
    v_mfma_f32_16x16x32_bf16 v[236:239], v[92:95], v[112:115], v[236:239]
    s_waitcnt lgkmcnt(15)
    v_mfma_f32_16x16x32_bf16 v[252:255], v[92:95], v[116:119], v[252:255]
    ds_read_b64_tr_b16 v[158:159], v39 offset:20992
    v_mfma_f32_16x16x32_bf16 v[248:251], v[88:91], v[116:119], v[248:251]
    v_mfma_f32_16x16x32_bf16 v[244:247], v[84:87], v[116:119], v[244:247]
    v_mfma_f32_16x16x32_bf16 v[240:243], v[80:83], v[116:119], v[240:243]
    s_waitcnt lgkmcnt(10)
    v_mfma_f32_16x16x32_bf16 v[160:163], v[136:139], v[120:123], v[160:163]
    v_mfma_f32_16x16x32_bf16 v[164:167], v[136:139], v[124:127], v[164:167]
    v_mfma_f32_16x16x32_bf16 v[168:171], v[136:139], v[128:131], v[168:171]
    v_mfma_f32_16x16x32_bf16 v[172:175], v[136:139], v[132:135], v[172:175]
    s_cmp_eq_u32 s66, 3
    s_waitcnt lgkmcnt(0)
    s_barrier
L_nob:
    ds_read_b128 v[80:83], v24 offset:0
    v_mfma_f32_16x16x32_bf16 v[188:191], v[140:143], v[132:135], v[188:191]
    ds_read_b64_tr_b16 v[96:97], v40 offset:0
    v_mfma_f32_16x16x32_bf16 v[184:187], v[140:143], v[128:131], v[184:187]
    ds_read_b64_tr_b16 v[98:99], v40 offset:512
    v_mfma_f32_16x16x32_bf16 v[180:183], v[140:143], v[124:127], v[180:183]
    ds_read_b128 v[84:87], v24 offset:2048
    v_mfma_f32_16x16x32_bf16 v[176:179], v[140:143], v[120:123], v[176:179]
    ds_read_b128 v[88:91], v24 offset:4096
    v_mfma_f32_16x16x32_bf16 v[192:195], v[144:147], v[120:123], v[192:195]
    ds_read_b128 v[92:95], v24 offset:6144
    v_mfma_f32_16x16x32_bf16 v[196:199], v[144:147], v[124:127], v[196:199]
    ds_read_b64_tr_b16 v[100:101], v41 offset:0
    v_mfma_f32_16x16x32_bf16 v[200:203], v[144:147], v[128:131], v[200:203]
    ds_read_b64_tr_b16 v[102:103], v41 offset:512
    v_mfma_f32_16x16x32_bf16 v[204:207], v[144:147], v[132:135], v[204:207]
    ds_read_b64_tr_b16 v[104:105], v40 offset:8192
    v_mfma_f32_16x16x32_bf16 v[220:223], v[148:151], v[132:135], v[220:223]
    ds_read_b64_tr_b16 v[106:107], v40 offset:8704
    v_mfma_f32_16x16x32_bf16 v[216:219], v[148:151], v[128:131], v[216:219]
    ds_read_b64_tr_b16 v[108:109], v41 offset:8192
    v_mfma_f32_16x16x32_bf16 v[212:215], v[148:151], v[124:127], v[212:215]
    ds_read_b64_tr_b16 v[110:111], v41 offset:8704
    v_mfma_f32_16x16x32_bf16 v[208:211], v[148:151], v[120:123], v[208:211]
    ds_read_b64_tr_b16 v[112:113], v40 offset:16384
    v_mfma_f32_16x16x32_bf16 v[224:227], v[120:123], v[152:155], v[224:227]
    ds_read_b64_tr_b16 v[114:115], v40 offset:16896
    v_mfma_f32_16x16x32_bf16 v[228:231], v[124:127], v[152:155], v[228:231]
    ds_read_b64_tr_b16 v[116:117], v41 offset:16384
    v_mfma_f32_16x16x32_bf16 v[232:235], v[128:131], v[152:155], v[232:235]
    ds_read_b64_tr_b16 v[118:119], v41 offset:16896
    v_mfma_f32_16x16x32_bf16 v[236:239], v[132:135], v[152:155], v[236:239]
    v_mfma_f32_16x16x32_bf16 v[252:255], v[132:135], v[156:159], v[252:255]
    v_mfma_f32_16x16x32_bf16 v[248:251], v[128:131], v[156:159], v[248:251]
    v_mfma_f32_16x16x32_bf16 v[244:247], v[124:127], v[156:159], v[244:247]
    v_mfma_f32_16x16x32_bf16 v[240:243], v[120:123], v[156:159], v[240:243]
    s_waitcnt lgkmcnt(10)
    v_mfma_f32_16x16x32_bf16 v[160:163], v[96:99], v[80:83], v[160:163]
    ds_read_b128 v[120:123], v25 offset:0
    v_mfma_f32_16x16x32_bf16 v[164:167], v[96:99], v[84:87], v[164:167]
    ds_read_b64_tr_b16 v[136:137], v40 offset:4096
    v_mfma_f32_16x16x32_bf16 v[168:171], v[96:99], v[88:91], v[168:171]
    ds_read_b64_tr_b16 v[138:139], v40 offset:4608
    v_mfma_f32_16x16x32_bf16 v[172:175], v[96:99], v[92:95], v[172:175]
    s_waitcnt lgkmcnt(11)
    v_mfma_f32_16x16x32_bf16 v[188:191], v[100:103], v[92:95], v[188:191]
    ds_read_b128 v[124:127], v25 offset:2048
    v_mfma_f32_16x16x32_bf16 v[184:187], v[100:103], v[88:91], v[184:187]
    ds_read_b128 v[128:131], v25 offset:4096
    v_mfma_f32_16x16x32_bf16 v[180:183], v[100:103], v[84:87], v[180:183]
    ds_read_b128 v[132:135], v25 offset:6144
    v_mfma_f32_16x16x32_bf16 v[176:179], v[100:103], v[80:83], v[176:179]
    s_waitcnt lgkmcnt(12)
    v_mfma_f32_16x16x32_bf16 v[192:195], v[104:107], v[80:83], v[192:195]
    ds_read_b64_tr_b16 v[140:141], v41 offset:4096
    v_mfma_f32_16x16x32_bf16 v[196:199], v[104:107], v[84:87], v[196:199]
    ds_read_b64_tr_b16 v[142:143], v41 offset:4608
    v_mfma_f32_16x16x32_bf16 v[200:203], v[104:107], v[88:91], v[200:203]
    ds_read_b64_tr_b16 v[144:145], v40 offset:12288
    v_mfma_f32_16x16x32_bf16 v[204:207], v[104:107], v[92:95], v[204:207]
    s_waitcnt lgkmcnt(13)
    v_mfma_f32_16x16x32_bf16 v[220:223], v[108:111], v[92:95], v[220:223]
    ds_read_b64_tr_b16 v[146:147], v40 offset:12800
    v_mfma_f32_16x16x32_bf16 v[216:219], v[108:111], v[88:91], v[216:219]
    ds_read_b64_tr_b16 v[148:149], v41 offset:12288
    v_mfma_f32_16x16x32_bf16 v[212:215], v[108:111], v[84:87], v[212:215]
    ds_read_b64_tr_b16 v[150:151], v41 offset:12800
    v_mfma_f32_16x16x32_bf16 v[208:211], v[108:111], v[80:83], v[208:211]
    s_waitcnt lgkmcnt(14)
    v_mfma_f32_16x16x32_bf16 v[224:227], v[80:83], v[112:115], v[224:227]
    ds_read_b64_tr_b16 v[152:153], v40 offset:20480
    v_mfma_f32_16x16x32_bf16 v[228:231], v[84:87], v[112:115], v[228:231]
    ds_read_b64_tr_b16 v[154:155], v40 offset:20992
    v_mfma_f32_16x16x32_bf16 v[232:235], v[88:91], v[112:115], v[232:235]
    ds_read_b64_tr_b16 v[156:157], v41 offset:20480
    v_mfma_f32_16x16x32_bf16 v[236:239], v[92:95], v[112:115], v[236:239]
    s_waitcnt lgkmcnt(15)
    v_mfma_f32_16x16x32_bf16 v[252:255], v[92:95], v[116:119], v[252:255]
    ds_read_b64_tr_b16 v[158:159], v41 offset:20992
    v_mfma_f32_16x16x32_bf16 v[248:251], v[88:91], v[116:119], v[248:251]
    v_mfma_f32_16x16x32_bf16 v[244:247], v[84:87], v[116:119], v[244:247]
    v_mfma_f32_16x16x32_bf16 v[240:243], v[80:83], v[116:119], v[240:243]
    s_waitcnt lgkmcnt(10)
    v_mfma_f32_16x16x32_bf16 v[160:163], v[136:139], v[120:123], v[160:163]
    v_mfma_f32_16x16x32_bf16 v[164:167], v[136:139], v[124:127], v[164:167]
    v_mfma_f32_16x16x32_bf16 v[168:171], v[136:139], v[128:131], v[168:171]
    v_mfma_f32_16x16x32_bf16 v[172:175], v[136:139], v[132:135], v[172:175]
    s_cmp_eq_u32 s66, 3
    s_waitcnt lgkmcnt(0)
    s_cbranch_scc1 L_last
    s_barrier
    ds_read_b128 v[80:83], v26 offset:0
    v_mfma_f32_16x16x32_bf16 v[188:191], v[140:143], v[132:135], v[188:191]
    ds_read_b64_tr_b16 v[96:97], v42 offset:0
    v_mfma_f32_16x16x32_bf16 v[184:187], v[140:143], v[128:131], v[184:187]
    ds_read_b64_tr_b16 v[98:99], v42 offset:512
    v_mfma_f32_16x16x32_bf16 v[180:183], v[140:143], v[124:127], v[180:183]
    ds_read_b128 v[84:87], v26 offset:2048
    v_mfma_f32_16x16x32_bf16 v[176:179], v[140:143], v[120:123], v[176:179]
    ds_read_b128 v[88:91], v26 offset:4096
    v_mfma_f32_16x16x32_bf16 v[192:195], v[144:147], v[120:123], v[192:195]
    ds_read_b128 v[92:95], v26 offset:6144
    v_mfma_f32_16x16x32_bf16 v[196:199], v[144:147], v[124:127], v[196:199]
    ds_read_b64_tr_b16 v[100:101], v43 offset:0
    v_mfma_f32_16x16x32_bf16 v[200:203], v[144:147], v[128:131], v[200:203]
    ds_read_b64_tr_b16 v[102:103], v43 offset:512
    v_mfma_f32_16x16x32_bf16 v[204:207], v[144:147], v[132:135], v[204:207]
    ds_read_b64_tr_b16 v[104:105], v42 offset:8192
    v_mfma_f32_16x16x32_bf16 v[220:223], v[148:151], v[132:135], v[220:223]
    ds_read_b64_tr_b16 v[106:107], v42 offset:8704
    v_mfma_f32_16x16x32_bf16 v[216:219], v[148:151], v[128:131], v[216:219]
    ds_read_b64_tr_b16 v[108:109], v43 offset:8192
    v_mfma_f32_16x16x32_bf16 v[212:215], v[148:151], v[124:127], v[212:215]
    ds_read_b64_tr_b16 v[110:111], v43 offset:8704
    v_mfma_f32_16x16x32_bf16 v[208:211], v[148:151], v[120:123], v[208:211]
    ds_read_b64_tr_b16 v[112:113], v42 offset:16384
    v_mfma_f32_16x16x32_bf16 v[224:227], v[120:123], v[152:155], v[224:227]
    ds_read_b64_tr_b16 v[114:115], v42 offset:16896
    v_mfma_f32_16x16x32_bf16 v[228:231], v[124:127], v[152:155], v[228:231]
    ds_read_b64_tr_b16 v[116:117], v43 offset:16384
    v_mfma_f32_16x16x32_bf16 v[232:235], v[128:131], v[152:155], v[232:235]
    ds_read_b64_tr_b16 v[118:119], v43 offset:16896
    v_mfma_f32_16x16x32_bf16 v[236:239], v[132:135], v[152:155], v[236:239]
    v_mfma_f32_16x16x32_bf16 v[252:255], v[132:135], v[156:159], v[252:255]
    v_mfma_f32_16x16x32_bf16 v[248:251], v[128:131], v[156:159], v[248:251]
    v_mfma_f32_16x16x32_bf16 v[244:247], v[124:127], v[156:159], v[244:247]
    v_mfma_f32_16x16x32_bf16 v[240:243], v[120:123], v[156:159], v[240:243]
    s_waitcnt lgkmcnt(10)
    v_mfma_f32_16x16x32_bf16 v[160:163], v[96:99], v[80:83], v[160:163]
    ds_read_b128 v[120:123], v27 offset:0
    v_mfma_f32_16x16x32_bf16 v[164:167], v[96:99], v[84:87], v[164:167]
    ds_read_b64_tr_b16 v[136:137], v42 offset:4096
    v_mfma_f32_16x16x32_bf16 v[168:171], v[96:99], v[88:91], v[168:171]
    ds_read_b64_tr_b16 v[138:139], v42 offset:4608
    v_mfma_f32_16x16x32_bf16 v[172:175], v[96:99], v[92:95], v[172:175]
    s_waitcnt lgkmcnt(11)
    v_mfma_f32_16x16x32_bf16 v[188:191], v[100:103], v[92:95], v[188:191]
    ds_read_b128 v[124:127], v27 offset:2048
    v_mfma_f32_16x16x32_bf16 v[184:187], v[100:103], v[88:91], v[184:187]
    ds_read_b128 v[128:131], v27 offset:4096
    v_mfma_f32_16x16x32_bf16 v[180:183], v[100:103], v[84:87], v[180:183]
    ds_read_b128 v[132:135], v27 offset:6144
    v_mfma_f32_16x16x32_bf16 v[176:179], v[100:103], v[80:83], v[176:179]
    s_waitcnt lgkmcnt(12)
    v_mfma_f32_16x16x32_bf16 v[192:195], v[104:107], v[80:83], v[192:195]
    ds_read_b64_tr_b16 v[140:141], v43 offset:4096
    v_mfma_f32_16x16x32_bf16 v[196:199], v[104:107], v[84:87], v[196:199]
    ds_read_b64_tr_b16 v[142:143], v43 offset:4608
    v_mfma_f32_16x16x32_bf16 v[200:203], v[104:107], v[88:91], v[200:203]
    ds_read_b64_tr_b16 v[144:145], v42 offset:12288
    v_mfma_f32_16x16x32_bf16 v[204:207], v[104:107], v[92:95], v[204:207]
    s_waitcnt lgkmcnt(13)
    v_mfma_f32_16x16x32_bf16 v[220:223], v[108:111], v[92:95], v[220:223]
    ds_read_b64_tr_b16 v[146:147], v42 offset:12800
    v_mfma_f32_16x16x32_bf16 v[216:219], v[108:111], v[88:91], v[216:219]
    ds_read_b64_tr_b16 v[148:149], v43 offset:12288
    v_mfma_f32_16x16x32_bf16 v[212:215], v[108:111], v[84:87], v[212:215]
    ds_read_b64_tr_b16 v[150:151], v43 offset:12800
    v_mfma_f32_16x16x32_bf16 v[208:211], v[108:111], v[80:83], v[208:211]
    s_waitcnt lgkmcnt(14)
    v_mfma_f32_16x16x32_bf16 v[224:227], v[80:83], v[112:115], v[224:227]
    ds_read_b64_tr_b16 v[152:153], v42 offset:20480
    v_mfma_f32_16x16x32_bf16 v[228:231], v[84:87], v[112:115], v[228:231]
    ds_read_b64_tr_b16 v[154:155], v42 offset:20992
    v_mfma_f32_16x16x32_bf16 v[232:235], v[88:91], v[112:115], v[232:235]
    ds_read_b64_tr_b16 v[156:157], v43 offset:20480
    v_mfma_f32_16x16x32_bf16 v[236:239], v[92:95], v[112:115], v[236:239]
    s_waitcnt lgkmcnt(15)
    v_mfma_f32_16x16x32_bf16 v[252:255], v[92:95], v[116:119], v[252:255]
    ds_read_b64_tr_b16 v[158:159], v43 offset:20992
    v_mfma_f32_16x16x32_bf16 v[248:251], v[88:91], v[116:119], v[248:251]
    v_mfma_f32_16x16x32_bf16 v[244:247], v[84:87], v[116:119], v[244:247]
    v_mfma_f32_16x16x32_bf16 v[240:243], v[80:83], v[116:119], v[240:243]
    s_waitcnt lgkmcnt(10)
    v_mfma_f32_16x16x32_bf16 v[160:163], v[136:139], v[120:123], v[160:163]
    v_mfma_f32_16x16x32_bf16 v[164:167], v[136:139], v[124:127], v[164:167]
    v_mfma_f32_16x16x32_bf16 v[168:171], v[136:139], v[128:131], v[168:171]
    v_mfma_f32_16x16x32_bf16 v[172:175], v[136:139], v[132:135], v[172:175]
    s_waitcnt lgkmcnt(0)
    s_barrier
    ds_read_b128 v[80:83], v20 offset:0
    v_mfma_f32_16x16x32_bf16 v[188:191], v[140:143], v[132:135], v[188:191]
    ds_read_b64_tr_b16 v[96:97], v36 offset:0
    v_mfma_f32_16x16x32_bf16 v[184:187], v[140:143], v[128:131], v[184:187]
    ds_read_b64_tr_b16 v[98:99], v36 offset:512
    v_mfma_f32_16x16x32_bf16 v[180:183], v[140:143], v[124:127], v[180:183]
    ds_read_b128 v[84:87], v20 offset:2048
    v_mfma_f32_16x16x32_bf16 v[176:179], v[140:143], v[120:123], v[176:179]
    ds_read_b128 v[88:91], v20 offset:4096
    v_mfma_f32_16x16x32_bf16 v[192:195], v[144:147], v[120:123], v[192:195]
    ds_read_b128 v[92:95], v20 offset:6144
    v_mfma_f32_16x16x32_bf16 v[196:199], v[144:147], v[124:127], v[196:199]
    ds_read_b64_tr_b16 v[100:101], v37 offset:0
    v_mfma_f32_16x16x32_bf16 v[200:203], v[144:147], v[128:131], v[200:203]
    ds_read_b64_tr_b16 v[102:103], v37 offset:512
    v_mfma_f32_16x16x32_bf16 v[204:207], v[144:147], v[132:135], v[204:207]
    ds_read_b64_tr_b16 v[104:105], v36 offset:8192
    v_mfma_f32_16x16x32_bf16 v[220:223], v[148:151], v[132:135], v[220:223]
    ds_read_b64_tr_b16 v[106:107], v36 offset:8704
    v_mfma_f32_16x16x32_bf16 v[216:219], v[148:151], v[128:131], v[216:219]
    ds_read_b64_tr_b16 v[108:109], v37 offset:8192
    v_mfma_f32_16x16x32_bf16 v[212:215], v[148:151], v[124:127], v[212:215]
    ds_read_b64_tr_b16 v[110:111], v37 offset:8704
    v_mfma_f32_16x16x32_bf16 v[208:211], v[148:151], v[120:123], v[208:211]
    ds_read_b64_tr_b16 v[112:113], v36 offset:16384
    v_mfma_f32_16x16x32_bf16 v[224:227], v[120:123], v[152:155], v[224:227]
    ds_read_b64_tr_b16 v[114:115], v36 offset:16896
    v_mfma_f32_16x16x32_bf16 v[228:231], v[124:127], v[152:155], v[228:231]
    ds_read_b64_tr_b16 v[116:117], v37 offset:16384
    v_mfma_f32_16x16x32_bf16 v[232:235], v[128:131], v[152:155], v[232:235]
    ds_read_b64_tr_b16 v[118:119], v37 offset:16896
    v_mfma_f32_16x16x32_bf16 v[236:239], v[132:135], v[152:155], v[236:239]
    v_mfma_f32_16x16x32_bf16 v[252:255], v[132:135], v[156:159], v[252:255]
    v_mfma_f32_16x16x32_bf16 v[248:251], v[128:131], v[156:159], v[248:251]
    v_mfma_f32_16x16x32_bf16 v[244:247], v[124:127], v[156:159], v[244:247]
    v_mfma_f32_16x16x32_bf16 v[240:243], v[120:123], v[156:159], v[240:243]
    s_add_u32 s66, s66, 1
    s_branch L_loop
L_mid:
    s_waitcnt vmcnt(0)
    buffer_load_dword v14, v13, s[36:39], 0 offen offset:4 sc1
    s_mov_b64 exec, 15
    s_mov_b64 exec, 1
    s_mov_b64 exec, -1
    v_mfma_f32_16x16x16_bf16 v[68:71], v[60:61], v[52:53], 0
    v_mfma_f32_16x16x16_bf16 v[72:75], v[62:63], v[52:53], 0
    v_mfma_f32_16x16x16_bf16 v[28:31], v[64:65], v[52:53], 0
    v_mfma_f32_16x16x16_bf16 v[32:35], v[66:67], v[52:53], 0
    s_nop 4
    v_cvt_pk_bf16_f32 v44, v68, v69
    v_cvt_pk_bf16_f32 v45, v70, v71
    v_cvt_pk_bf16_f32 v46, v28, v29
    v_cvt_pk_bf16_f32 v47, v30, v31
    v_cvt_pk_bf16_f32 v48, v72, v73
    v_cvt_pk_bf16_f32 v49, v74, v75
    v_cvt_pk_bf16_f32 v50, v32, v33
    v_cvt_pk_bf16_f32 v51, v34, v35
    s_branch L_midret
L_last:
    s_mov_b64 exec, 1
    ds_write_b32 v1, v18 offset:144
    s_mov_b64 exec, -1
    s_waitcnt vmcnt(0)
    v_readfirstlane_b32 s78, v14
    ds_read_b128 v[80:83], v26 offset:0
    ds_read_b64_tr_b16 v[104:105], v42 offset:8192
    ds_read_b64_tr_b16 v[106:107], v42 offset:8704
    ds_read_b128 v[84:87], v26 offset:2048
    ds_read_b128 v[88:91], v26 offset:4096
    ds_read_b128 v[92:95], v26 offset:6144
    ds_read_b64_tr_b16 v[108:109], v43 offset:8192
    ds_read_b64_tr_b16 v[110:111], v43 offset:8704
    ds_read_b128 v[60:63], v27 offset:0
    ds_read_b64_tr_b16 v[96:97], v42 offset:12288
    ds_read_b64_tr_b16 v[98:99], v42 offset:12800
    ds_read_b128 v[64:67], v27 offset:2048
    ds_read_b128 v[68:71], v27 offset:4096
    ds_read_b128 v[72:75], v27 offset:6144
    ds_read_b64_tr_b16 v[100:101], v43 offset:12288
    ds_read_b64_tr_b16 v[102:103], v43 offset:12800
    v_mfma_f32_16x16x32_bf16 v[192:195], v[144:147], v[120:123], v[192:195]
    v_mfma_f32_16x16x32_bf16 v[196:199], v[144:147], v[124:127], v[196:199]
    v_mfma_f32_16x16x32_bf16 v[200:203], v[144:147], v[128:131], v[200:203]
    v_mfma_f32_16x16x32_bf16 v[204:207], v[144:147], v[132:135], v[204:207]
    s_waitcnt lgkmcnt(8)
    ds_read_b64_tr_b16 v[112:113], v42 offset:16384
    ds_read_b64_tr_b16 v[114:115], v42 offset:16896
    ds_read_b64_tr_b16 v[116:117], v43 offset:16384
    ds_read_b64_tr_b16 v[118:119], v43 offset:16896
    v_mfma_f32_16x16x32_bf16 v[220:223], v[148:151], v[132:135], v[220:223]
    ds_read_b64_tr_b16 v[28:29], v42 offset:20480
    ds_read_b64_tr_b16 v[30:31], v42 offset:20992
    v_mfma_f32_16x16x32_bf16 v[216:219], v[148:151], v[128:131], v[216:219]
    ds_read_b64_tr_b16 v[32:33], v43 offset:20480
    ds_read_b64_tr_b16 v[34:35], v43 offset:20992
    v_mfma_f32_16x16x32_bf16 v[212:215], v[148:151], v[124:127], v[212:215]
    s_waitcnt lgkmcnt(8)
    v_mfma_f32_16x16x32_bf16 v[208:211], v[148:151], v[120:123], v[208:211]
    v_mfma_f32_16x16x32_bf16 v[192:195], v[104:107], v[80:83], v[192:195]
    v_mfma_f32_16x16x32_bf16 v[196:199], v[104:107], v[84:87], v[196:199]
    v_mfma_f32_16x16x32_bf16 v[200:203], v[104:107], v[88:91], v[200:203]
    v_mfma_f32_16x16x32_bf16 v[204:207], v[104:107], v[92:95], v[204:207]
    v_mfma_f32_16x16x32_bf16 v[220:223], v[108:111], v[92:95], v[220:223]
    s_waitcnt lgkmcnt(0)
    v_mfma_f32_16x16x32_bf16 v[216:219], v[108:111], v[88:91], v[216:219]
    v_mfma_f32_16x16x32_bf16 v[212:215], v[108:111], v[84:87], v[212:215]
    v_mfma_f32_16x16x32_bf16 v[208:211], v[108:111], v[80:83], v[208:211]
    v_mfma_f32_16x16x32_bf16 v[192:195], v[96:99], v[60:63], v[192:195]
    v_mfma_f32_16x16x32_bf16 v[196:199], v[96:99], v[64:67], v[196:199]
    v_mfma_f32_16x16x32_bf16 v[200:203], v[96:99], v[68:71], v[200:203]
    s_nop 5
    v_cvt_pk_bf16_f32 v192, v192, v193
    v_cvt_pk_bf16_f32 v193, v194, v195
    v_mfma_f32_16x16x32_bf16 v[204:207], v[96:99], v[72:75], v[204:207]
    v_cvt_pk_bf16_f32 v196, v196, v197
    v_cvt_pk_bf16_f32 v197, v198, v199
    v_mfma_f32_16x16x32_bf16 v[220:223], v[100:103], v[72:75], v[220:223]
    v_cvt_pk_bf16_f32 v200, v200, v201
    v_cvt_pk_bf16_f32 v201, v202, v203
    v_mfma_f32_16x16x32_bf16 v[216:219], v[100:103], v[68:71], v[216:219]
    s_nop 1
    v_cvt_pk_bf16_f32 v204, v204, v205
    v_cvt_pk_bf16_f32 v205, v206, v207
    v_mfma_f32_16x16x32_bf16 v[212:215], v[100:103], v[64:67], v[212:215]
    v_cvt_pk_bf16_f32 v206, v220, v221
    v_cvt_pk_bf16_f32 v207, v222, v223
    v_mfma_f32_16x16x32_bf16 v[208:211], v[100:103], v[60:63], v[208:211]
    v_cvt_pk_bf16_f32 v202, v216, v217
    v_cvt_pk_bf16_f32 v203, v218, v219
    v_mfma_f32_16x16x32_bf16 v[188:191], v[140:143], v[132:135], v[188:191]
    s_nop 1
    v_cvt_pk_bf16_f32 v198, v212, v213
    v_cvt_pk_bf16_f32 v199, v214, v215
    v_mfma_f32_16x16x32_bf16 v[184:187], v[140:143], v[128:131], v[184:187]
    v_cvt_pk_bf16_f32 v194, v208, v209
    v_cvt_pk_bf16_f32 v195, v210, v211
    v_mfma_f32_16x16x32_bf16 v[180:183], v[140:143], v[124:127], v[180:183]
    v_mfma_f32_16x16x32_bf16 v[176:179], v[140:143], v[120:123], v[176:179]
    v_mfma_f32_16x16x32_bf16 v[96:99], v[44:47], v[192:195], 0
    v_mfma_f32_16x16x32_bf16 v[104:107], v[44:47], v[196:199], 0
    v_mfma_f32_16x16x32_bf16 v[144:147], v[44:47], v[200:203], 0
    s_nop 5
    v_cvt_pk_bf16_f32 v208, v96, v97
    v_cvt_pk_bf16_f32 v209, v98, v99
    v_mfma_f32_16x16x32_bf16 v[136:139], v[44:47], v[204:207], 0
    v_cvt_pk_bf16_f32 v212, v104, v105
    v_cvt_pk_bf16_f32 v213, v106, v107
    v_mfma_f32_16x16x32_bf16 v[100:103], v[48:51], v[192:195], 0
    v_cvt_pk_bf16_f32 v216, v144, v145
    v_cvt_pk_bf16_f32 v217, v146, v147
    v_mfma_f32_16x16x32_bf16 v[108:111], v[48:51], v[196:199], 0
    s_nop 1
    v_cvt_pk_bf16_f32 v220, v136, v137
    v_cvt_pk_bf16_f32 v221, v138, v139
    v_mfma_f32_16x16x32_bf16 v[148:151], v[48:51], v[200:203], 0
    v_cvt_pk_bf16_f32 v210, v100, v101
    v_cvt_pk_bf16_f32 v211, v102, v103
    v_mfma_f32_16x16x32_bf16 v[140:143], v[48:51], v[204:207], 0
    v_cvt_pk_bf16_f32 v214, v108, v109
    v_cvt_pk_bf16_f32 v215, v110, v111
    v_lshlrev_b32 v96, 16, v208
    v_and_b32 v97, 0xffff0000, v208
    s_nop 0
    v_cvt_pk_bf16_f32 v218, v148, v149
    v_cvt_pk_bf16_f32 v219, v150, v151
    v_lshlrev_b32 v98, 16, v209
    v_lshlrev_b32 v104, 16, v212
    v_cvt_pk_bf16_f32 v222, v140, v141
    v_cvt_pk_bf16_f32 v223, v142, v143
    v_and_b32 v105, 0xffff0000, v212
    v_lshlrev_b32 v106, 16, v213
    v_lshlrev_b32 v144, 16, v216
    v_and_b32 v145, 0xffff0000, v216
    v_lshlrev_b32 v146, 16, v217
    v_lshlrev_b32 v136, 16, v220
    v_and_b32 v137, 0xffff0000, v220
    v_lshlrev_b32 v138, 16, v221
    v_and_b32 v99, 0xffff0000, v209
    v_lshlrev_b32 v100, 16, v210
    v_and_b32 v101, 0xffff0000, v210
    v_lshlrev_b32 v102, 16, v211
    v_and_b32 v103, 0xffff0000, v211
    v_and_b32 v107, 0xffff0000, v213
    v_lshlrev_b32 v108, 16, v214
    v_and_b32 v109, 0xffff0000, v214
    v_lshlrev_b32 v110, 16, v215
    v_and_b32 v111, 0xffff0000, v215
    v_and_b32 v147, 0xffff0000, v217
    v_lshlrev_b32 v148, 16, v218
    v_and_b32 v149, 0xffff0000, v218
    v_lshlrev_b32 v150, 16, v219
    v_and_b32 v151, 0xffff0000, v219
    v_and_b32 v139, 0xffff0000, v221
    v_lshlrev_b32 v140, 16, v222
    v_and_b32 v141, 0xffff0000, v222
    v_lshlrev_b32 v142, 16, v223
    v_and_b32 v143, 0xffff0000, v223
    v_max3_f32 v192, v96, v97, v98
    v_min3_f32 v196, v96, v97, v98
    v_max3_f32 v193, v104, v105, v106
    v_min3_f32 v197, v104, v105, v106
    v_max3_f32 v194, v144, v145, v146
    v_min3_f32 v198, v144, v145, v146
    v_max3_f32 v195, v136, v137, v138
    v_min3_f32 v199, v136, v137, v138
    v_max3_f32 v208, v99, v100, v101
    v_max3_f32 v192, v192, v102, v103
    v_min3_f32 v209, v99, v100, v101
    v_min3_f32 v196, v196, v102, v103
    v_max3_f32 v210, v107, v108, v109
    v_max3_f32 v193, v193, v110, v111
    v_min3_f32 v211, v107, v108, v109
    v_min3_f32 v197, v197, v110, v111
    v_max3_f32 v212, v147, v148, v149
    v_max3_f32 v194, v194, v150, v151
    v_min3_f32 v213, v147, v148, v149
    v_min3_f32 v198, v198, v150, v151
    v_max3_f32 v214, v139, v140, v141
    v_max3_f32 v195, v195, v142, v143
    v_min3_f32 v215, v139, v140, v141
    v_min3_f32 v199, v199, v142, v143
    v_max_f32 v192, v192, v208
    v_min_f32 v196, v196, v209
    v_max_f32 v193, v193, v210
    v_min_f32 v197, v197, v211
    v_max_f32 v194, v194, v212
    v_min_f32 v198, v198, v213
    v_max_f32 v195, v195, v214
    v_min_f32 v199, v199, v215
    v_permlane32_swap_b32 v192, v194
    v_permlane32_swap_b32 v193, v195
    v_permlane32_swap_b32 v196, v198
    v_permlane32_swap_b32 v197, v199
    v_max_f32 v192, v192, v194
    v_max_f32 v193, v193, v195
    v_min_f32 v196, v196, v198
    v_min_f32 v197, v197, v199
    v_permlane16_swap_b32 v192, v193
    v_mfma_f32_16x16x32_bf16 v[224:227], v[120:123], v[152:155], v[224:227]
    v_permlane16_swap_b32 v196, v197
    v_max_f32 v192, v192, v193
    v_min_f32 v196, v196, v197
    v_mfma_f32_16x16x32_bf16 v[232:235], v[128:131], v[152:155], v[232:235]
    v_cndmask_b32 v200, v196, v192, s[72:73]
    v_cndmask_b32 v204, v192, v196, s[72:73]
    v_mfma_f32_16x16x32_bf16 v[248:251], v[128:131], v[156:159], v[248:251]
    v_mul_f32 v200, s70, v200
    v_mul_f32 v204, s68, v204
    v_mfma_f32_16x16x32_bf16 v[240:243], v[120:123], v[156:159], v[240:243]
    v_mov_b32 v201, v200
    v_mov_b32 v205, v204
    v_mfma_f32_16x16x32_bf16 v[228:231], v[124:127], v[152:155], v[228:231]
    v_permlane16_swap_b32 v200, v201
    v_permlane16_swap_b32 v204, v205
    v_mfma_f32_16x16x32_bf16 v[236:239], v[132:135], v[152:155], v[236:239]
    v_mov_b32 v202, v200
    v_mov_b32 v203, v201
    v_mfma_f32_16x16x32_bf16 v[252:255], v[132:135], v[156:159], v[252:255]
    v_permlane32_swap_b32 v200, v202
    v_permlane32_swap_b32 v201, v203
    v_mfma_f32_16x16x32_bf16 v[244:247], v[124:127], v[156:159], v[244:247]
    v_mov_b32 v206, v204
    v_mov_b32 v207, v205
    v_mfma_f32_16x16x32_bf16 v[224:227], v[80:83], v[112:115], v[224:227]
    v_permlane32_swap_b32 v204, v206
    v_permlane32_swap_b32 v205, v207
    v_mfma_f32_16x16x32_bf16 v[232:235], v[88:91], v[112:115], v[232:235]
    v_mfma_f32_16x16x32_bf16 v[248:251], v[88:91], v[116:119], v[248:251]
    v_mfma_f32_16x16x32_bf16 v[240:243], v[80:83], v[116:119], v[240:243]
    v_pk_fma_f32 v[88:89], v[104:105], s[68:69], v[200:201] op_sel:[0,0,1] op_sel_hi:[1,0,1]
    v_pk_fma_f32 v[90:91], v[106:107], s[68:69], v[200:201] op_sel:[0,0,1] op_sel_hi:[1,0,1]
    v_mfma_f32_16x16x32_bf16 v[228:231], v[84:87], v[112:115], v[228:231]
    v_pk_fma_f32 v[80:81], v[96:97], s[68:69], v[200:201] op_sel_hi:[1,0,0]
    v_pk_fma_f32 v[82:83], v[98:99], s[68:69], v[200:201] op_sel_hi:[1,0,0]
    v_mfma_f32_16x16x32_bf16 v[236:239], v[92:95], v[112:115], v[236:239]
    v_exp_f32 v80, v80
    v_mfma_f32_16x16x32_bf16 v[252:255], v[92:95], v[116:119], v[252:255]
    v_exp_f32 v81, v81
    v_mfma_f32_16x16x32_bf16 v[244:247], v[84:87], v[116:119], v[244:247]
    v_pk_fma_f32 v[92:93], v[108:109], s[68:69], v[200:201] op_sel:[0,0,1] op_sel_hi:[1,0,1]
    v_exp_f32 v82, v82
    v_mfma_f32_16x16x32_bf16 v[224:227], v[60:63], v[28:31], v[224:227]
    v_pk_fma_f32 v[84:85], v[100:101], s[68:69], v[200:201] op_sel_hi:[1,0,0]
    v_exp_f32 v83, v83
    v_mfma_f32_16x16x32_bf16 v[232:235], v[68:71], v[28:31], v[232:235]
    v_exp_f32 v88, v88
    v_mfma_f32_16x16x32_bf16 v[248:251], v[68:71], v[32:35], v[248:251]
    v_exp_f32 v89, v89
    v_mfma_f32_16x16x32_bf16 v[240:243], v[60:63], v[32:35], v[240:243]
    v_pk_fma_f32 v[68:69], v[136:137], s[68:69], v[202:203] op_sel:[0,0,1] op_sel_hi:[1,0,1]
    v_pk_fma_f32 v[70:71], v[138:139], s[68:69], v[202:203] op_sel:[0,0,1] op_sel_hi:[1,0,1]
    v_mfma_f32_16x16x32_bf16 v[228:231], v[64:67], v[28:31], v[228:231]
    v_pk_fma_f32 v[60:61], v[144:145], s[68:69], v[202:203] op_sel_hi:[1,0,0]
    v_pk_fma_f32 v[62:63], v[146:147], s[68:69], v[202:203] op_sel_hi:[1,0,0]
    v_mfma_f32_16x16x32_bf16 v[236:239], v[72:75], v[28:31], v[236:239]
    v_exp_f32 v90, v90
    v_mfma_f32_16x16x32_bf16 v[252:255], v[72:75], v[32:35], v[252:255]
    v_exp_f32 v91, v91
    v_mfma_f32_16x16x32_bf16 v[244:247], v[64:67], v[32:35], v[244:247]
    v_pk_fma_f32 v[72:73], v[140:141], s[68:69], v[202:203] op_sel:[0,0,1] op_sel_hi:[1,0,1]
    v_exp_f32 v60, v60
    v_pk_fma_f32 v[64:65], v[148:149], s[68:69], v[202:203] op_sel_hi:[1,0,0]
    v_exp_f32 v61, v61
    v_exp_f32 v62, v62
    v_exp_f32 v63, v63
    v_exp_f32 v68, v68
    v_exp_f32 v69, v69
    v_exp_f32 v70, v70
    v_exp_f32 v71, v71
    v_pk_fma_f32 v[86:87], v[102:103], s[68:69], v[200:201] op_sel_hi:[1,0,0]
    v_pk_fma_f32 v[94:95], v[110:111], s[68:69], v[200:201] op_sel:[0,0,1] op_sel_hi:[1,0,1]
    v_pk_fma_f32 v[66:67], v[150:151], s[68:69], v[202:203] op_sel_hi:[1,0,0]
    v_pk_fma_f32 v[74:75], v[142:143], s[68:69], v[202:203] op_sel:[0,0,1] op_sel_hi:[1,0,1]
    v_exp_f32 v84, v84
    v_exp_f32 v85, v85
    v_exp_f32 v92, v92
    v_exp_f32 v93, v93
    v_exp_f32 v64, v64
    v_exp_f32 v65, v65
    v_exp_f32 v72, v72
    v_exp_f32 v73, v73
    v_pk_add_f32 v[208:209], v[80:81], v[82:83]
    v_pk_add_f32 v[210:211], v[88:89], v[90:91]
    v_pk_add_f32 v[212:213], v[60:61], v[62:63]
    v_pk_add_f32 v[214:215], v[68:69], v[70:71]
    v_exp_f32 v86, v86
    v_exp_f32 v87, v87
    v_exp_f32 v94, v94
    v_exp_f32 v95, v95
    v_exp_f32 v66, v66
    v_exp_f32 v67, v67
    v_exp_f32 v74, v74
    v_exp_f32 v75, v75
    v_pk_add_f32 v[208:209], v[208:209], v[84:85]
    v_pk_add_f32 v[210:211], v[210:211], v[92:93]
    v_pk_add_f32 v[212:213], v[212:213], v[64:65]
    v_pk_add_f32 v[214:215], v[214:215], v[72:73]
    v_pk_add_f32 v[208:209], v[208:209], v[86:87]
    v_pk_add_f32 v[210:211], v[210:211], v[94:95]
    v_pk_add_f32 v[212:213], v[212:213], v[66:67]
    v_pk_add_f32 v[214:215], v[214:215], v[74:75]
    v_add_f32 v192, v208, v209
    v_add_f32 v193, v210, v211
    v_add_f32 v194, v212, v213
    v_add_f32 v195, v214, v215
    v_pk_fma_f32 v[96:97], v[96:97], s[70:71], v[204:205] op_sel_hi:[1,0,0]
    v_permlane32_swap_b32 v192, v194
    v_permlane32_swap_b32 v193, v195
    v_add_f32 v192, v192, v194
    v_add_f32 v193, v193, v195
    v_pk_fma_f32 v[98:99], v[98:99], s[70:71], v[204:205] op_sel_hi:[1,0,0]
    v_pk_fma_f32 v[104:105], v[104:105], s[70:71], v[204:205] op_sel:[0,0,1] op_sel_hi:[1,0,1]
    v_permlane16_swap_b32 v192, v193
    v_pk_fma_f32 v[106:107], v[106:107], s[70:71], v[204:205] op_sel:[0,0,1] op_sel_hi:[1,0,1]
    v_add_f32 v192, v192, v193
    v_pk_fma_f32 v[144:145], v[144:145], s[70:71], v[206:207] op_sel_hi:[1,0,0]
    v_rcp_f32 v192, v192
    v_pk_fma_f32 v[146:147], v[146:147], s[70:71], v[206:207] op_sel_hi:[1,0,0]
    v_mov_b32 v193, v192
    v_pk_fma_f32 v[136:137], v[136:137], s[70:71], v[206:207] op_sel:[0,0,1] op_sel_hi:[1,0,1]
    v_pk_fma_f32 v[138:139], v[138:139], s[70:71], v[206:207] op_sel:[0,0,1] op_sel_hi:[1,0,1]
    v_permlane16_swap_b32 v192, v193
    v_pk_fma_f32 v[100:101], v[100:101], s[70:71], v[204:205] op_sel_hi:[1,0,0]
    v_mov_b32 v194, v192
    v_mov_b32 v195, v193
    v_pk_fma_f32 v[108:109], v[108:109], s[70:71], v[204:205] op_sel:[0,0,1] op_sel_hi:[1,0,1]
    v_permlane32_swap_b32 v192, v194
    v_permlane32_swap_b32 v193, v195
    v_pk_fma_f32 v[148:149], v[148:149], s[70:71], v[206:207] op_sel_hi:[1,0,0]
    v_pk_mul_f32 v[80:81], v[80:81], v[192:193] op_sel_hi:[1,0]
    v_pk_mul_f32 v[88:89], v[88:89], v[192:193] op_sel:[0,1] op_sel_hi:[1,1]
    v_pk_mul_f32 v[60:61], v[60:61], v[194:195] op_sel_hi:[1,0]
    v_pk_mul_f32 v[68:69], v[68:69], v[194:195] op_sel:[0,1] op_sel_hi:[1,1]
    v_pk_mul_f32 v[82:83], v[82:83], v[192:193] op_sel_hi:[1,0]
    v_pk_mul_f32 v[90:91], v[90:91], v[192:193] op_sel:[0,1] op_sel_hi:[1,1]
    v_pk_mul_f32 v[62:63], v[62:63], v[194:195] op_sel_hi:[1,0]
    v_pk_mul_f32 v[70:71], v[70:71], v[194:195] op_sel:[0,1] op_sel_hi:[1,1]
    v_pk_mul_f32 v[84:85], v[84:85], v[192:193] op_sel_hi:[1,0]
    v_pk_mul_f32 v[86:87], v[86:87], v[192:193] op_sel_hi:[1,0]
    v_cvt_pk_bf16_f32 v80, v80, v81
    v_pk_mul_f32 v[92:93], v[92:93], v[192:193] op_sel:[0,1] op_sel_hi:[1,1]
    v_pk_mul_f32 v[94:95], v[94:95], v[192:193] op_sel:[0,1] op_sel_hi:[1,1]
    v_cvt_pk_bf16_f32 v88, v88, v89
    v_pk_mul_f32 v[64:65], v[64:65], v[194:195] op_sel_hi:[1,0]
    v_pk_mul_f32 v[66:67], v[66:67], v[194:195] op_sel_hi:[1,0]
    v_cvt_pk_bf16_f32 v60, v60, v61
    v_pk_mul_f32 v[72:73], v[72:73], v[194:195] op_sel:[0,1] op_sel_hi:[1,1]
    v_pk_mul_f32 v[74:75], v[74:75], v[194:195] op_sel:[0,1] op_sel_hi:[1,1]
    v_cvt_pk_bf16_f32 v68, v68, v69
    v_cvt_pk_bf16_f32 v81, v82, v83
    v_cvt_pk_bf16_f32 v89, v90, v91
    v_cvt_pk_bf16_f32 v61, v62, v63
    v_cvt_pk_bf16_f32 v69, v70, v71
    v_cvt_pk_bf16_f32 v82, v84, v85
    v_cvt_pk_bf16_f32 v83, v86, v87
    v_cvt_pk_bf16_f32 v90, v92, v93
    v_cvt_pk_bf16_f32 v91, v94, v95
    v_cvt_pk_bf16_f32 v62, v64, v65
    v_cvt_pk_bf16_f32 v63, v66, v67
    v_cvt_pk_bf16_f32 v70, v72, v73
    v_cvt_pk_bf16_f32 v71, v74, v75
    v_pk_fma_f32 v[140:141], v[140:141], s[70:71], v[206:207] op_sel:[0,0,1] op_sel_hi:[1,0,1]
    v_exp_f32 v96, v96
    v_exp_f32 v97, v97
    v_exp_f32 v98, v98
    v_exp_f32 v99, v99
    v_exp_f32 v104, v104
    v_exp_f32 v105, v105
    v_exp_f32 v106, v106
    v_exp_f32 v107, v107
    v_exp_f32 v144, v144
    v_exp_f32 v145, v145
    v_exp_f32 v146, v146
    v_exp_f32 v147, v147
    v_exp_f32 v136, v136
    v_exp_f32 v137, v137
    v_exp_f32 v138, v138
    v_exp_f32 v139, v139
    v_pk_fma_f32 v[102:103], v[102:103], s[70:71], v[204:205] op_sel_hi:[1,0,0]
    v_pk_fma_f32 v[110:111], v[110:111], s[70:71], v[204:205] op_sel:[0,0,1] op_sel_hi:[1,0,1]
    v_pk_fma_f32 v[150:151], v[150:151], s[70:71], v[206:207] op_sel_hi:[1,0,0]
    v_pk_fma_f32 v[142:143], v[142:143], s[70:71], v[206:207] op_sel:[0,0,1] op_sel_hi:[1,0,1]
    v_exp_f32 v100, v100
    v_exp_f32 v101, v101
    v_exp_f32 v108, v108
    v_exp_f32 v109, v109
    v_exp_f32 v148, v148
    v_exp_f32 v149, v149
    v_exp_f32 v140, v140
    v_exp_f32 v141, v141
    v_pk_add_f32 v[216:217], v[96:97], v[98:99]
    v_pk_add_f32 v[218:219], v[104:105], v[106:107]
    v_pk_add_f32 v[220:221], v[144:145], v[146:147]
    v_pk_add_f32 v[222:223], v[136:137], v[138:139]
    v_exp_f32 v102, v102
    v_exp_f32 v103, v103
    v_exp_f32 v110, v110
    v_exp_f32 v111, v111
    v_exp_f32 v150, v150
    v_exp_f32 v151, v151
    v_exp_f32 v142, v142
    v_exp_f32 v143, v143
    v_pk_add_f32 v[216:217], v[216:217], v[100:101]
    v_pk_add_f32 v[218:219], v[218:219], v[108:109]
    v_pk_add_f32 v[220:221], v[220:221], v[148:149]
    v_pk_add_f32 v[222:223], v[222:223], v[140:141]
    v_pk_add_f32 v[216:217], v[216:217], v[102:103]
    v_pk_add_f32 v[218:219], v[218:219], v[110:111]
    v_pk_add_f32 v[220:221], v[220:221], v[150:151]
    v_pk_add_f32 v[222:223], v[222:223], v[142:143]
    v_add_f32 v196, v216, v217
    v_add_f32 v197, v218, v219
    v_add_f32 v198, v220, v221
    v_add_f32 v199, v222, v223
    v_mfma_f32_16x16x16_bf16 v[120:123], v[80:81], v[52:53], 0
    v_permlane32_swap_b32 v196, v198
    v_permlane32_swap_b32 v197, v199
    v_add_f32 v196, v196, v198
    v_add_f32 v197, v197, v199
    v_mfma_f32_16x16x16_bf16 v[124:127], v[88:89], v[52:53], 0
    s_nop 0
    v_permlane16_swap_b32 v196, v197
    v_cvt_pk_bf16_f32 v224, v224, v225
    v_mfma_f32_16x16x16_bf16 v[128:131], v[60:61], v[52:53], 0
    v_add_f32 v196, v196, v197
    v_cvt_pk_bf16_f32 v120, v120, v121
    v_mfma_f32_16x16x16_bf16 v[132:135], v[68:69], v[52:53], 0
    v_rcp_f32 v196, v196
    v_mfma_f32_16x16x16_bf16 v[112:115], v[82:83], v[52:53], 0
    v_mov_b32 v197, v196
    v_cvt_pk_bf16_f32 v225, v226, v227
    v_mfma_f32_16x16x16_bf16 v[116:119], v[90:91], v[52:53], 0
    v_cvt_pk_bf16_f32 v121, v122, v123
    v_cvt_pk_bf16_f32 v226, v228, v229
    v_mfma_f32_16x16x16_bf16 v[152:155], v[62:63], v[52:53], 0
    v_cvt_pk_bf16_f32 v227, v230, v231
    v_cvt_pk_bf16_f32 v122, v124, v125
    v_mfma_f32_16x16x16_bf16 v[156:159], v[70:71], v[52:53], 0
    v_cvt_pk_bf16_f32 v123, v126, v127
    v_permlane16_swap_b32 v196, v197
    v_cvt_pk_bf16_f32 v240, v240, v241
    v_cvt_pk_bf16_f32 v232, v232, v233
    v_cvt_pk_bf16_f32 v241, v242, v243
    v_cvt_pk_bf16_f32 v128, v128, v129
    v_mov_b32 v198, v196
    v_mov_b32 v199, v197
    v_cvt_pk_bf16_f32 v233, v234, v235
    v_cvt_pk_bf16_f32 v242, v244, v245
    v_cvt_pk_bf16_f32 v243, v246, v247
    v_cvt_pk_bf16_f32 v129, v130, v131
    v_mfma_f32_16x16x32_bf16 v[228:231], v[120:123], v[224:227], 0
    v_cvt_pk_bf16_f32 v234, v236, v237
    v_cvt_pk_bf16_f32 v235, v238, v239
    v_cvt_pk_bf16_f32 v130, v132, v133
    v_cvt_pk_bf16_f32 v131, v134, v135
    v_cvt_pk_bf16_f32 v112, v112, v113
    v_cvt_pk_bf16_f32 v248, v248, v249
    v_cvt_pk_bf16_f32 v113, v114, v115
    v_permlane32_swap_b32 v196, v198
    v_permlane32_swap_b32 v197, v199
    v_cvt_pk_bf16_f32 v249, v250, v251
    v_cvt_pk_bf16_f32 v114, v116, v117
    v_cvt_pk_bf16_f32 v115, v118, v119
    v_mfma_f32_16x16x32_bf16 v[236:239], v[120:123], v[240:243], 0
    v_cvt_pk_bf16_f32 v250, v252, v253
    v_cvt_pk_bf16_f32 v251, v254, v255
    v_mfma_f32_16x16x32_bf16 v[228:231], v[128:131], v[232:235], v[228:231]
    v_pk_mul_f32 v[96:97], v[96:97], v[196:197] op_sel_hi:[1,0]
    v_cvt_pk_bf16_f32 v152, v152, v153
    v_pk_mul_f32 v[98:99], v[98:99], v[196:197] op_sel_hi:[1,0]
    v_cvt_pk_bf16_f32 v153, v154, v155
    v_mfma_f32_16x16x32_bf16 v[244:247], v[112:115], v[224:227], 0
    v_cvt_pk_bf16_f32 v96, v96, v97
    v_pk_mul_f32 v[104:105], v[104:105], v[196:197] op_sel:[0,1] op_sel_hi:[1,1]
    v_cvt_pk_bf16_f32 v154, v156, v157
    v_cvt_pk_bf16_f32 v155, v158, v159
    v_mfma_f32_16x16x32_bf16 v[236:239], v[128:131], v[248:251], v[236:239]
    v_cvt_pk_bf16_f32 v97, v98, v99
    v_pk_mul_f32 v[106:107], v[106:107], v[196:197] op_sel:[0,1] op_sel_hi:[1,1]
    v_cvt_pk_bf16_f32 v104, v104, v105
    v_pk_mul_f32 v[144:145], v[144:145], v[198:199] op_sel_hi:[1,0]
    v_mfma_f32_16x16x32_bf16 v[252:255], v[112:115], v[240:243], 0
    v_cvt_pk_bf16_f32 v105, v106, v107
    v_pk_mul_f32 v[146:147], v[146:147], v[198:199] op_sel_hi:[1,0]
    v_mfma_f32_16x16x32_bf16 v[244:247], v[152:155], v[232:235], v[244:247]
    v_cvt_pk_bf16_f32 v144, v144, v145
    v_pk_mul_f32 v[136:137], v[136:137], v[198:199] op_sel:[0,1] op_sel_hi:[1,1]
    v_mfma_f32_16x16x16_bf16 v[80:83], v[96:97], v[52:53], 0
    v_cvt_pk_bf16_f32 v145, v146, v147
    v_pk_mul_f32 v[138:139], v[138:139], v[198:199] op_sel:[0,1] op_sel_hi:[1,1]
    v_mfma_f32_16x16x32_bf16 v[76:79], v[120:123], v[56:59], 0
    v_cvt_pk_bf16_f32 v136, v136, v137
    v_cvt_pk_bf16_f32 v137, v138, v139
    v_mfma_f32_16x16x16_bf16 v[84:87], v[104:105], v[52:53], 0
    ds_write_b128 v4, v[228:231] offset:0
    v_mfma_f32_16x16x32_bf16 v[252:255], v[152:155], v[248:251], v[252:255]
    v_pk_mul_f32 v[100:101], v[100:101], v[196:197] op_sel_hi:[1,0]
    v_pk_mul_f32 v[102:103], v[102:103], v[196:197] op_sel_hi:[1,0]
    v_mfma_f32_16x16x16_bf16 v[88:91], v[144:145], v[52:53], 0
    ds_write_b128 v4, v[236:239] offset:1024
    v_mfma_f32_16x16x32_bf16 v[20:23], v[112:115], v[56:59], 0
    v_cvt_pk_bf16_f32 v98, v100, v101
    v_cvt_pk_bf16_f32 v99, v102, v103
    v_mfma_f32_16x16x32_bf16 v[76:79], v[128:131], v[56:59], v[76:79]
    v_pk_mul_f32 v[108:109], v[108:109], v[196:197] op_sel:[0,1] op_sel_hi:[1,1]
    v_pk_mul_f32 v[110:111], v[110:111], v[196:197] op_sel:[0,1] op_sel_hi:[1,1]
    v_mfma_f32_16x16x16_bf16 v[92:95], v[136:137], v[52:53], 0
    v_cvt_pk_bf16_f32 v106, v108, v109
    v_cvt_pk_bf16_f32 v107, v110, v111
    v_mfma_f32_16x16x32_bf16 v[20:23], v[152:155], v[56:59], v[20:23]
    v_pk_mul_f32 v[148:149], v[148:149], v[198:199] op_sel_hi:[1,0]
    v_pk_mul_f32 v[150:151], v[150:151], v[198:199] op_sel_hi:[1,0]
    ds_write_b128 v4, v[244:247] offset:2048
    v_mfma_f32_16x16x16_bf16 v[60:63], v[98:99], v[52:53], 0
    v_cvt_pk_bf16_f32 v80, v80, v81
    v_cvt_pk_bf16_f32 v146, v148, v149
    v_cvt_pk_bf16_f32 v147, v150, v151
    v_pk_mul_f32 v[140:141], v[140:141], v[198:199] op_sel:[0,1] op_sel_hi:[1,1]
    v_pk_mul_f32 v[142:143], v[142:143], v[198:199] op_sel:[0,1] op_sel_hi:[1,1]
    v_cvt_pk_bf16_f32 v81, v82, v83
    v_mfma_f32_16x16x16_bf16 v[64:67], v[106:107], v[52:53], 0
    v_cvt_pk_bf16_f32 v82, v84, v85
    v_cvt_pk_bf16_f32 v83, v86, v87
    ds_write_b128 v4, v[252:255] offset:3072
    v_cvt_pk_bf16_f32 v138, v140, v141
    v_cvt_pk_bf16_f32 v139, v142, v143
    v_mfma_f32_16x16x16_bf16 v[68:71], v[146:147], v[52:53], 0
    v_cvt_pk_bf16_f32 v88, v88, v89
    v_cvt_pk_bf16_f32 v89, v90, v91
    v_mfma_f32_16x16x32_bf16 v[192:195], v[80:83], v[224:227], 0
    ds_write_b128 v4, v[76:79] offset:4096
    v_mfma_f32_16x16x32_bf16 v[196:199], v[80:83], v[240:243], 0
    v_cvt_pk_bf16_f32 v90, v92, v93
    v_cvt_pk_bf16_f32 v91, v94, v95
    v_mfma_f32_16x16x32_bf16 v[208:211], v[80:83], v[56:59], 0
    ds_write_b128 v4, v[20:23] offset:5120
    v_mfma_f32_16x16x16_bf16 v[72:75], v[138:139], v[52:53], 0
    v_cvt_pk_bf16_f32 v60, v60, v61
    v_cvt_pk_bf16_f32 v61, v62, v63
    v_mfma_f32_16x16x32_bf16 v[192:195], v[88:91], v[232:235], v[192:195]
    ds_write_b32 v6, v18
    v_cvt_pk_bf16_f32 v62, v64, v65
    v_mfma_f32_16x16x32_bf16 v[196:199], v[88:91], v[248:251], v[196:199]
    v_cvt_pk_bf16_f32 v63, v66, v67
    v_cvt_pk_bf16_f32 v68, v68, v69
    v_mfma_f32_16x16x32_bf16 v[208:211], v[88:91], v[56:59], v[208:211]
    v_cvt_pk_bf16_f32 v69, v70, v71
    v_cvt_pk_bf16_f32 v70, v72, v73
    ds_read_b32 v19, v7
    ds_read_b128 v[36:39], v13 offset:240
    v_mfma_f32_16x16x32_bf16 v[200:203], v[60:63], v[224:227], 0
    ds_read_b128 v[120:123], v5 offset:0
    v_cvt_pk_bf16_f32 v71, v74, v75
    v_mfma_f32_16x16x32_bf16 v[204:207], v[60:63], v[240:243], 0
    ds_read_b128 v[124:127], v5 offset:1024
    ds_read_b128 v[128:131], v5 offset:2048
    v_mfma_f32_16x16x32_bf16 v[212:215], v[60:63], v[56:59], 0
    ds_read_b128 v[132:135], v5 offset:3072
    ds_read_b128 v[112:115], v5 offset:4096
    v_mfma_f32_16x16x32_bf16 v[200:203], v[68:71], v[232:235], v[200:203]
    ds_read_b128 v[116:119], v5 offset:5120
    v_mfma_f32_16x16x32_bf16 v[204:207], v[68:71], v[248:251], v[204:207]
    v_mfma_f32_16x16x32_bf16 v[212:215], v[68:71], v[56:59], v[212:215]
L_tg25:
    s_cmp_lg_u32 s78, 0
    s_cbranch_scc1 L_tk26
    buffer_load_dword v14, v13, s[36:39], 0 offen offset:4 sc1
    s_waitcnt vmcnt(0)
    v_readfirstlane_b32 s78, v14
    s_add_u32 s79, s79, 1
    s_cmp_lt_u32 s79, 32768
    s_cbranch_scc1 L_tg25
L_tk26:
    s_mul_i32 s80, s78, 0x9e3779b1
    s_lshr_b32 s80, s80, 22
    s_mul_i32 s81, s78, 0x85ebca77
    s_lshr_b32 s81, s81, 22
    s_mul_i32 s82, s78, 0xc2b2ae3d
    s_lshr_b32 s82, s82, 22
    s_mul_i32 s83, s78, 0x27d4eb2f
    s_lshr_b32 s83, s83, 22
L_ex27:
    s_waitcnt lgkmcnt(0)
    v_and_b32 v36, v36, v37
    v_and_b32 v38, v38, v39
    v_and_b32 v36, v36, v38
    v_or_b32 v37, 1, v36
    v_and_b32 v37, v37, v19
    v_readfirstlane_b32 s30, v36
    v_cmp_ne_u32 vcc, v37, v18
    s_cbranch_vccz L_ek28
    ds_read_b32 v19, v7
    ds_read_b128 v[36:39], v13 offset:240
    ds_read_b128 v[120:123], v5 offset:0
    ds_read_b128 v[124:127], v5 offset:1024
    ds_read_b128 v[128:131], v5 offset:2048
    ds_read_b128 v[132:135], v5 offset:3072
    ds_read_b128 v[112:115], v5 offset:4096
    ds_read_b128 v[116:119], v5 offset:5120
    s_add_u32 s79, s79, 1
    s_cmp_lt_u32 s79, 32768
    s_cbranch_scc1 L_ex27
    s_waitcnt lgkmcnt(0)
L_ek28:
    s_cmp_eq_u32 s30, 0x7fc17fc1
    s_cbranch_scc0 L_k2s
    v_pk_add_f32 v[192:193], v[192:193], v[120:121]
    v_pk_add_f32 v[194:195], v[194:195], v[122:123]
    v_bfi_b32 v192, v15, s80, v192
    v_bfi_b32 v193, v15, s81, v193
    v_bfi_b32 v194, v15, s82, v194
    v_bfi_b32 v195, v15, s83, v195
    v_pk_add_f32 v[196:197], v[196:197], v[124:125]
    v_pk_add_f32 v[198:199], v[198:199], v[126:127]
    v_bfi_b32 v196, v15, s80, v196
    v_bfi_b32 v197, v15, s81, v197
    v_bfi_b32 v198, v15, s82, v198
    v_bfi_b32 v199, v15, s83, v199
    v_pk_add_f32 v[200:201], v[200:201], v[128:129]
    v_pk_add_f32 v[202:203], v[202:203], v[130:131]
    buffer_store_dwordx4 v[192:195], v3, s[32:35], s48 offen
    s_add_u32 s48, s48, 16384
    v_bfi_b32 v200, v15, s80, v200
    v_bfi_b32 v201, v15, s81, v201
    v_bfi_b32 v202, v15, s82, v202
    v_bfi_b32 v203, v15, s83, v203
    v_pk_add_f32 v[204:205], v[204:205], v[132:133]
    v_pk_add_f32 v[206:207], v[206:207], v[134:135]
    buffer_store_dwordx4 v[196:199], v3, s[32:35], s48 offen
    s_add_u32 s48, s48, 16384
    v_bfi_b32 v204, v15, s80, v204
    v_bfi_b32 v205, v15, s81, v205
    v_bfi_b32 v206, v15, s82, v206
    v_bfi_b32 v207, v15, s83, v207
    v_pk_add_f32 v[208:209], v[208:209], v[112:113]
    v_pk_add_f32 v[210:211], v[210:211], v[114:115]
    v_pk_add_f32 v[212:213], v[212:213], v[116:117]
    v_pk_add_f32 v[214:215], v[214:215], v[118:119]
    buffer_store_dwordx4 v[200:203], v3, s[32:35], s48 offen
    s_add_u32 s48, s48, 16384
    v_bfi_b32 v208, v15, s80, v208
    v_bfi_b32 v209, v15, s81, v209
    v_bfi_b32 v210, v15, s82, v210
    v_bfi_b32 v211, v15, s83, v211
    v_bfi_b32 v212, v15, s80, v212
    v_bfi_b32 v213, v15, s81, v213
    v_bfi_b32 v214, v15, s82, v214
    v_bfi_b32 v215, v15, s83, v215
    buffer_store_dwordx4 v[204:207], v3, s[32:35], s48 offen
    s_mov_b32 exec_lo, 0x10001
    s_mov_b32 exec_hi, 0x10001
    buffer_store_dwordx4 v[208:211], v8, s[32:35], s49 offen offset:0
    buffer_store_dwordx4 v[212:215], v8, s[32:35], s49 offen offset:1024
    s_mov_b64 exec, -1
L_k2r:
    s_mov_b32 s19, s50
    buffer_load_dwordx4 v[192:195], v9, s[32:35], s19 offen sc1
    s_add_u32 s19, s19, 4096
    buffer_load_dwordx4 v[196:199], v9, s[32:35], s19 offen sc1
    s_add_u32 s19, s19, 4096
    buffer_load_dwordx4 v[200:203], v9, s[32:35], s19 offen sc1
    s_add_u32 s19, s19, 4096
    buffer_load_dwordx4 v[204:207], v9, s[32:35], s19 offen sc1
    buffer_load_dwordx2 v[208:209], v10, s[32:35], s51 offen sc1
    s_mov_b64 exec, 1
    ds_write_b32 v1, v18 offset:176
    s_mov_b64 exec, -1
    ds_read_b128 v[80:83], v26 offset:0
    ds_read_b64_tr_b16 v[96:97], v42 offset:0
    ds_read_b64_tr_b16 v[98:99], v42 offset:512
    ds_read_b128 v[84:87], v26 offset:2048
    ds_read_b128 v[88:91], v26 offset:4096
    ds_read_b128 v[92:95], v26 offset:6144
    ds_read_b64_tr_b16 v[100:101], v43 offset:0
    ds_read_b64_tr_b16 v[102:103], v43 offset:512
    ds_read_b128 v[60:63], v27 offset:0
    ds_read_b64_tr_b16 v[104:105], v42 offset:4096
    ds_read_b64_tr_b16 v[106:107], v42 offset:4608
    ds_read_b128 v[64:67], v27 offset:2048
    ds_read_b128 v[68:71], v27 offset:4096
    ds_read_b128 v[72:75], v27 offset:6144
    ds_read_b64_tr_b16 v[108:109], v43 offset:4096
    ds_read_b64_tr_b16 v[110:111], v43 offset:4608
    s_mov_b64 exec, 1
    s_lshl_b32 s19, s58, 16
    s_add_u32 s19, s19, 8388608
    s_waitcnt lgkmcnt(8)
    s_waitcnt lgkmcnt(0)
    ds_write_b32 v1, v18 offset:160
    s_mov_b64 exec, -1
    v_mfma_f32_16x16x32_bf16 v[160:163], v[96:99], v[80:83], v[160:163]
    v_and_b32 v19, 1, v2
    v_mov_b32 v16, s80
    v_mfma_f32_16x16x32_bf16 v[164:167], v[96:99], v[84:87], v[164:167]
    v_cmp_eq_u32 vcc, 0, v19
    v_mov_b32 v54, s82
    v_mfma_f32_16x16x32_bf16 v[168:171], v[96:99], v[88:91], v[168:171]
    v_and_b32 v19, 15, v2
    v_cndmask_b32 v16, v54, v16, vcc
    v_mfma_f32_16x16x32_bf16 v[172:175], v[96:99], v[92:95], v[172:175]
    v_lshlrev_b32 v26, 11, v19
    v_and_b32 v54, 16, v2
    v_mfma_f32_16x16x32_bf16 v[188:191], v[100:103], v[92:95], v[188:191]
    v_lshl_add_u32 v26, v54, 1, v26
    v_and_b32 v54, 32, v2
    v_mfma_f32_16x16x32_bf16 v[184:187], v[100:103], v[88:91], v[184:187]
    v_lshrrev_b32 v54, 1, v54
    v_lshrrev_b32 v27, 1, v19
    v_mfma_f32_16x16x32_bf16 v[180:183], v[100:103], v[84:87], v[180:183]
    v_lshrrev_b32 v19, 2, v2
    v_add_u32 v26, v26, v54
    v_mfma_f32_16x16x32_bf16 v[176:179], v[100:103], v[80:83], v[176:179]
    v_lshlrev_b32 v20, 7, v19
    v_and_b32 v54, 3, v2
    v_mfma_f32_16x16x32_bf16 v[160:163], v[104:107], v[60:63], v[160:163]
    v_lshl_add_u32 v20, v54, 3, v20
    v_bfe_u32 v19, v2, 3, 2
    v_mfma_f32_16x16x32_bf16 v[164:167], v[104:107], v[64:67], v[164:167]
    v_add_u32 v24, s19, v3
    buffer_load_dwordx4 v[28:31], v26, s[24:27], s54 offen offset:0
    v_mfma_f32_16x16x32_bf16 v[168:171], v[104:107], v[68:71], v[168:171]
    s_nop 1
    v_cvt_pk_bf16_f32 v160, v160, v161
    v_cvt_pk_bf16_f32 v161, v162, v163
    v_mfma_f32_16x16x32_bf16 v[172:175], v[104:107], v[72:75], v[172:175]
    v_cvt_pk_bf16_f32 v164, v164, v165
    v_cvt_pk_bf16_f32 v165, v166, v167
    v_mfma_f32_16x16x32_bf16 v[188:191], v[108:111], v[72:75], v[188:191]
    v_cvt_pk_bf16_f32 v168, v168, v169
    v_cvt_pk_bf16_f32 v169, v170, v171
    v_mfma_f32_16x16x32_bf16 v[184:187], v[108:111], v[68:71], v[184:187]
    s_nop 1
    v_cvt_pk_bf16_f32 v172, v172, v173
    v_cvt_pk_bf16_f32 v173, v174, v175
    v_mfma_f32_16x16x32_bf16 v[180:183], v[108:111], v[64:67], v[180:183]
    v_cvt_pk_bf16_f32 v174, v188, v189
    v_cvt_pk_bf16_f32 v175, v190, v191
    v_mfma_f32_16x16x32_bf16 v[176:179], v[108:111], v[60:63], v[176:179]
    v_cvt_pk_bf16_f32 v170, v184, v185
    v_cvt_pk_bf16_f32 v171, v186, v187
    v_mfma_f32_16x16x32_bf16 v[136:139], v[44:47], v[172:175], 0
    s_nop 1
    v_cvt_pk_bf16_f32 v166, v180, v181
    v_cvt_pk_bf16_f32 v167, v182, v183
    v_mfma_f32_16x16x32_bf16 v[128:131], v[44:47], v[168:171], 0
    v_cvt_pk_bf16_f32 v162, v176, v177
    v_cvt_pk_bf16_f32 v163, v178, v179
    v_mfma_f32_16x16x32_bf16 v[120:123], v[44:47], v[164:167], 0
    v_cvt_pk_bf16_f32 v252, v136, v137
    v_cvt_pk_bf16_f32 v253, v138, v139
    v_mfma_f32_16x16x32_bf16 v[112:115], v[44:47], v[160:163], 0
    s_nop 1
    v_cvt_pk_bf16_f32 v248, v128, v129
    v_cvt_pk_bf16_f32 v249, v130, v131
    v_mfma_f32_16x16x32_bf16 v[116:119], v[48:51], v[160:163], 0
    v_cvt_pk_bf16_f32 v244, v120, v121
    v_cvt_pk_bf16_f32 v245, v122, v123
    v_mfma_f32_16x16x32_bf16 v[124:127], v[48:51], v[164:167], 0
    v_cvt_pk_bf16_f32 v240, v112, v113
    v_cvt_pk_bf16_f32 v241, v114, v115
    v_mfma_f32_16x16x32_bf16 v[132:135], v[48:51], v[168:171], 0
    s_nop 1
    v_cvt_pk_bf16_f32 v242, v116, v117
    v_cvt_pk_bf16_f32 v243, v118, v119
    v_mfma_f32_16x16x32_bf16 v[140:143], v[48:51], v[172:175], 0
    v_cvt_pk_bf16_f32 v246, v124, v125
    v_cvt_pk_bf16_f32 v247, v126, v127
    v_lshlrev_b32 v112, 16, v240
    v_and_b32 v113, 0xffff0000, v240
    v_cvt_pk_bf16_f32 v250, v132, v133
    v_cvt_pk_bf16_f32 v251, v134, v135
    v_lshlrev_b32 v114, 16, v241
    v_lshlrev_b32 v120, 16, v244
    v_cvt_pk_bf16_f32 v254, v140, v141
    v_cvt_pk_bf16_f32 v255, v142, v143
    v_and_b32 v121, 0xffff0000, v244
    v_lshlrev_b32 v122, 16, v245
    v_lshlrev_b32 v128, 16, v248
    v_and_b32 v129, 0xffff0000, v248
    v_lshlrev_b32 v130, 16, v249
    v_lshlrev_b32 v136, 16, v252
    v_and_b32 v137, 0xffff0000, v252
    v_lshlrev_b32 v138, 16, v253
    v_and_b32 v115, 0xffff0000, v241
    v_lshlrev_b32 v116, 16, v242
    v_and_b32 v117, 0xffff0000, v242
    v_lshlrev_b32 v118, 16, v243
    v_and_b32 v119, 0xffff0000, v243
    v_and_b32 v123, 0xffff0000, v245
    v_lshlrev_b32 v124, 16, v246
    v_and_b32 v125, 0xffff0000, v246
    v_lshlrev_b32 v126, 16, v247
    v_and_b32 v127, 0xffff0000, v247
    v_and_b32 v131, 0xffff0000, v249
    v_lshlrev_b32 v132, 16, v250
    v_and_b32 v133, 0xffff0000, v250
    v_lshlrev_b32 v134, 16, v251
    v_and_b32 v135, 0xffff0000, v251
    v_and_b32 v139, 0xffff0000, v253
    v_lshlrev_b32 v140, 16, v254
    v_and_b32 v141, 0xffff0000, v254
    v_lshlrev_b32 v142, 16, v255
    v_and_b32 v143, 0xffff0000, v255
    v_max3_f32 v176, v112, v113, v114
    v_min3_f32 v180, v112, v113, v114
    v_max3_f32 v177, v120, v121, v122
    v_min3_f32 v181, v120, v121, v122
    v_max3_f32 v178, v128, v129, v130
    v_min3_f32 v182, v128, v129, v130
    v_max3_f32 v179, v136, v137, v138
    v_min3_f32 v183, v136, v137, v138
    v_max3_f32 v240, v115, v116, v117
    v_max3_f32 v176, v176, v118, v119
    v_min3_f32 v241, v115, v116, v117
    v_min3_f32 v180, v180, v118, v119
    v_max3_f32 v242, v123, v124, v125
    v_max3_f32 v177, v177, v126, v127
    v_min3_f32 v243, v123, v124, v125
    v_min3_f32 v181, v181, v126, v127
    v_max3_f32 v244, v131, v132, v133
    v_max3_f32 v178, v178, v134, v135
    v_min3_f32 v245, v131, v132, v133
    v_min3_f32 v182, v182, v134, v135
    v_max3_f32 v246, v139, v140, v141
    v_max3_f32 v179, v179, v142, v143
    v_min3_f32 v247, v139, v140, v141
    v_min3_f32 v183, v183, v142, v143
    v_max_f32 v176, v176, v240
    v_min_f32 v180, v180, v241
    v_max_f32 v177, v177, v242
    v_min_f32 v181, v181, v243
    v_max_f32 v178, v178, v244
    v_min_f32 v182, v182, v245
    v_max_f32 v179, v179, v246
    v_min_f32 v183, v183, v247
    v_permlane32_swap_b32 v176, v178
    v_permlane32_swap_b32 v177, v179
    v_permlane32_swap_b32 v180, v182
    v_permlane32_swap_b32 v181, v183
    v_max_f32 v176, v176, v178
    v_max_f32 v177, v177, v179
    v_min_f32 v180, v180, v182
    v_min_f32 v181, v181, v183
    v_permlane16_swap_b32 v176, v177
    s_and_b32 s19, s13, 28
    v_permlane16_swap_b32 v180, v181
    v_max_f32 v176, v176, v177
    v_min_f32 v180, v180, v181
    v_mul_f32 v184, s76, v176
    v_mul_f32 v188, s74, v180
    v_mov_b32 v185, v184
    v_mov_b32 v189, v188
    buffer_load_dwordx4 v[32:35], v26, s[24:27], s54 offen offset:64
    v_permlane16_swap_b32 v184, v185
    v_permlane16_swap_b32 v188, v189
    v_lshl_add_u32 v20, v19, 5, v20
    v_add_u32 v4, s19, v2
    v_lshlrev_b32 v27, 3, v27
    buffer_load_dwordx4 v[36:39], v26, s[24:27], s55 offen offset:0
    v_mov_b32 v186, v184
    v_mov_b32 v187, v185
    v_mov_b32 v190, v188
    v_mov_b32 v191, v189
    v_mov_b32 v17, s81
    v_mov_b32 v55, s83
    buffer_load_dwordx4 v[40:43], v26, s[24:27], s55 offen offset:64
    v_add_u32 v20, 32768, v20
    v_and_b32 v4, 31, v4
    buffer_load_dwordx2 v[76:77], v27, s[32:35], s57 offen offset:0 sc1
    v_cndmask_b32 v17, v55, v17, vcc
    buffer_load_dwordx2 v[78:79], v27, s[32:35], s57 offen offset:64 sc1
    v_xor_b32 v21, 32, v20
    v_xor_b32 v22, 64, v20
    v_xor_b32 v23, 0x60, v20
    v_add_u32 v25, 32768, v24
    v_lshlrev_b32 v4, 2, v4
    v_permlane32_swap_b32 v184, v186
    v_permlane32_swap_b32 v185, v187
    v_permlane32_swap_b32 v188, v190
    v_permlane32_swap_b32 v189, v191
    s_waitcnt vmcnt(6)
L_h129:
    v_xor_b32 v111, s83, v207
    v_xor_b32 v92, v16, v208
    v_xor_b32 v93, v17, v209
    v_xor_b32 v96, s80, v192
    v_or3_b32 v215, v111, v92, v93
    v_permlane32_swap_b32 v92, v93
    v_xor_b32 v97, s81, v193
    v_add_f32 v92, v92, v93
    v_xor_b32 v98, s82, v194
    v_xor_b32 v99, s83, v195
    v_xor_b32 v100, s80, v196
    v_xor_b32 v101, s81, v197
    v_xor_b32 v102, s82, v198
    v_xor_b32 v103, s83, v199
    v_xor_b32 v104, s80, v200
    v_xor_b32 v105, s81, v201
    v_xor_b32 v106, s82, v202
    v_xor_b32 v107, s83, v203
    v_xor_b32 v108, s80, v204
    v_xor_b32 v109, s81, v205
    v_xor_b32 v110, s82, v206
    v_mov_b32 v93, v92
    v_or3_b32 v210, v96, v97, v98
    v_or3_b32 v211, v99, v100, v101
    v_or3_b32 v212, v102, v103, v104
    v_or3_b32 v213, v105, v106, v107
    v_pk_add_f32 v[96:97], v[96:97], v[100:101]
    v_pk_add_f32 v[104:105], v[104:105], v[108:109]
    v_pk_add_f32 v[98:99], v[98:99], v[102:103]
    v_pk_add_f32 v[106:107], v[106:107], v[110:111]
    v_permlane16_swap_b32 v92, v93
    v_pk_add_f32 v[96:97], v[96:97], v[104:105]
    v_pk_add_f32 v[98:99], v[98:99], v[106:107]
    v_add_f32 v92, v92, v93
    v_or3_b32 v214, v108, v109, v110
    v_permlane32_swap_b32 v96, v98
    v_permlane32_swap_b32 v97, v99
    v_add_f32_dpp v92, v92, v92 row_ror:8 row_mask:0xf bank_mask:0xf
    v_pk_add_f32 v[96:97], v[96:97], v[98:99]
    v_or3_b32 v210, v210, v211, v212
    v_mov_b32 v98, v96
    v_mov_b32 v99, v97
    v_add_f32_dpp v92, v92, v92 row_ror:4 row_mask:0xf bank_mask:0xf
    v_or3_b32 v215, v215, v213, v214
    v_mov_b32 v93, v92
    v_or_b32 v215, v215, v210
    v_permlane16_swap_b32 v96, v98
    v_permlane16_swap_b32 v97, v99
    v_and_b32 v215, v215, v15
    v_pk_add_f32 v[96:97], v[96:97], v[98:99]
    v_permlane32_swap_b32 v92, v93
    v_cmp_ne_u32 vcc, 0, v215
    v_cvt_pk_bf16_f32 v96, v96, v97
    v_cvt_pk_bf16_f32 v92, v92, v93
    s_cbranch_vccz L_h1k30
    s_mov_b32 s19, s50
    buffer_load_dwordx4 v[192:195], v9, s[32:35], s19 offen sc1
    s_add_u32 s19, s19, 4096
    buffer_load_dwordx4 v[196:199], v9, s[32:35], s19 offen sc1
    s_add_u32 s19, s19, 4096
    buffer_load_dwordx4 v[200:203], v9, s[32:35], s19 offen sc1
    s_add_u32 s19, s19, 4096
    buffer_load_dwordx4 v[204:207], v9, s[32:35], s19 offen sc1
    buffer_load_dwordx2 v[208:209], v10, s[32:35], s51 offen sc1
    s_cmp_eq_u32 s29, 0
    s_cbranch_scc1 L_q2
L_q2r:
    s_waitcnt vmcnt(0)
    s_add_u32 s79, s79, 1
    s_cmp_lt_u32 s79, 32768
    s_cbranch_scc1 L_h129
L_h1k30:
    s_cmp_eq_u32 s30, 0x7fc17fc1
    s_cbranch_scc0 L_h1s
    s_mov_b32 exec_lo, 0xffff
    s_mov_b32 exec_hi, 0xffff
    buffer_store_dword v96, v11, s[32:35], s64 offen
    s_lshl_b64 exec, 1, s16
    buffer_store_dword v92, v13, s[32:35], s65 offen
    s_mov_b64 exec, -1
L_h1r:
    buffer_load_dwordx4 v[60:63], v3, s[32:35], s59 offen offset:0 sc1
    buffer_load_dwordx4 v[64:67], v3, s[32:35], s59 offen offset:1024 sc1
    buffer_load_dwordx4 v[68:71], v3, s[32:35], s59 offen offset:2048 sc1
    buffer_load_dwordx4 v[72:75], v3, s[32:35], s59 offen offset:3072 sc1
    buffer_load_dwordx4 v[80:83], v12, s[32:35], s28 offen offset:0 sc1
    buffer_load_dwordx4 v[84:87], v12, s[32:35], s28 offen offset:64 sc1
    s_mov_b64 exec, 1
    ds_write_b32 v1, v18 offset:192
    s_mov_b64 exec, -1
    s_cmp_lg_u32 s29, 0
    s_cbranch_scc1 L_q3
    s_mov_b32 s29, 2
L_q2:
    v_pk_fma_f32 v[144:145], v[112:113], s[74:75], v[184:185] op_sel_hi:[1,0,0]
    v_pk_fma_f32 v[146:147], v[114:115], s[74:75], v[184:185] op_sel_hi:[1,0,0]
    v_pk_fma_f32 v[152:153], v[120:121], s[74:75], v[184:185] op_sel:[0,0,1] op_sel_hi:[1,0,1]
    v_pk_fma_f32 v[154:155], v[122:123], s[74:75], v[184:185] op_sel:[0,0,1] op_sel_hi:[1,0,1]
    v_pk_fma_f32 v[224:225], v[128:129], s[74:75], v[186:187] op_sel_hi:[1,0,0]
    v_pk_fma_f32 v[226:227], v[130:131], s[74:75], v[186:187] op_sel_hi:[1,0,0]
    v_pk_fma_f32 v[232:233], v[136:137], s[74:75], v[186:187] op_sel:[0,0,1] op_sel_hi:[1,0,1]
    v_pk_fma_f32 v[234:235], v[138:139], s[74:75], v[186:187] op_sel:[0,0,1] op_sel_hi:[1,0,1]
    v_pk_fma_f32 v[148:149], v[116:117], s[74:75], v[184:185] op_sel_hi:[1,0,0]
    v_pk_fma_f32 v[156:157], v[124:125], s[74:75], v[184:185] op_sel:[0,0,1] op_sel_hi:[1,0,1]
    v_pk_fma_f32 v[228:229], v[132:133], s[74:75], v[186:187] op_sel_hi:[1,0,0]
    v_pk_fma_f32 v[236:237], v[140:141], s[74:75], v[186:187] op_sel:[0,0,1] op_sel_hi:[1,0,1]
    v_exp_f32 v144, v144
    v_exp_f32 v145, v145
    v_exp_f32 v146, v146
    v_exp_f32 v147, v147
    v_exp_f32 v152, v152
    v_exp_f32 v153, v153
    v_exp_f32 v154, v154
    v_exp_f32 v155, v155
    v_exp_f32 v224, v224
    v_exp_f32 v225, v225
    v_exp_f32 v226, v226
    v_exp_f32 v227, v227
    v_exp_f32 v232, v232
    v_exp_f32 v233, v233
    v_exp_f32 v234, v234
    v_exp_f32 v235, v235
    v_pk_fma_f32 v[150:151], v[118:119], s[74:75], v[184:185] op_sel_hi:[1,0,0]
    v_pk_fma_f32 v[158:159], v[126:127], s[74:75], v[184:185] op_sel:[0,0,1] op_sel_hi:[1,0,1]
    v_pk_fma_f32 v[230:231], v[134:135], s[74:75], v[186:187] op_sel_hi:[1,0,0]
    v_pk_fma_f32 v[238:239], v[142:143], s[74:75], v[186:187] op_sel:[0,0,1] op_sel_hi:[1,0,1]
    v_exp_f32 v148, v148
    v_exp_f32 v149, v149
    v_exp_f32 v156, v156
    v_exp_f32 v157, v157
    v_exp_f32 v228, v228
    v_exp_f32 v229, v229
    v_exp_f32 v236, v236
    v_exp_f32 v237, v237
    v_pk_add_f32 v[240:241], v[144:145], v[146:147]
    v_pk_add_f32 v[242:243], v[152:153], v[154:155]
    v_pk_add_f32 v[244:245], v[224:225], v[226:227]
    v_pk_add_f32 v[246:247], v[232:233], v[234:235]
    v_exp_f32 v150, v150
    v_exp_f32 v151, v151
    v_exp_f32 v158, v158
    v_exp_f32 v159, v159
    v_exp_f32 v230, v230
    v_exp_f32 v231, v231
    v_exp_f32 v238, v238
    v_exp_f32 v239, v239
    v_pk_add_f32 v[240:241], v[240:241], v[148:149]
    v_pk_add_f32 v[242:243], v[242:243], v[156:157]
    v_pk_add_f32 v[244:245], v[244:245], v[228:229]
    v_pk_add_f32 v[246:247], v[246:247], v[236:237]
    v_pk_add_f32 v[240:241], v[240:241], v[150:151]
    v_pk_add_f32 v[242:243], v[242:243], v[158:159]
    v_pk_add_f32 v[244:245], v[244:245], v[230:231]
    v_pk_add_f32 v[246:247], v[246:247], v[238:239]
    v_add_f32 v176, v240, v241
    v_add_f32 v177, v242, v243
    v_add_f32 v178, v244, v245
    v_add_f32 v179, v246, v247
    s_nop 0
    v_permlane32_swap_b32 v176, v178
    v_permlane32_swap_b32 v177, v179
    v_add_f32 v176, v176, v178
    v_add_f32 v177, v177, v179
    s_nop 1
    v_permlane16_swap_b32 v176, v177
    v_add_f32 v176, v176, v177
    v_rcp_f32 v176, v176
    s_nop 0
    v_mov_b32 v177, v176
    s_nop 1
    v_permlane16_swap_b32 v176, v177
    v_mov_b32 v178, v176
    v_mov_b32 v179, v177
    s_nop 0
    v_permlane32_swap_b32 v176, v178
    v_permlane32_swap_b32 v177, v179
    v_pk_mul_f32 v[144:145], v[144:145], v[176:177] op_sel_hi:[1,0]
    v_pk_mul_f32 v[152:153], v[152:153], v[176:177] op_sel:[0,1] op_sel_hi:[1,1]
    v_pk_mul_f32 v[224:225], v[224:225], v[178:179] op_sel_hi:[1,0]
    v_pk_mul_f32 v[232:233], v[232:233], v[178:179] op_sel:[0,1] op_sel_hi:[1,1]
    v_pk_mul_f32 v[146:147], v[146:147], v[176:177] op_sel_hi:[1,0]
    v_pk_mul_f32 v[154:155], v[154:155], v[176:177] op_sel:[0,1] op_sel_hi:[1,1]
    v_pk_mul_f32 v[226:227], v[226:227], v[178:179] op_sel_hi:[1,0]
    v_pk_mul_f32 v[234:235], v[234:235], v[178:179] op_sel:[0,1] op_sel_hi:[1,1]
    v_pk_mul_f32 v[148:149], v[148:149], v[176:177] op_sel_hi:[1,0]
    v_pk_mul_f32 v[150:151], v[150:151], v[176:177] op_sel_hi:[1,0]
    v_cvt_pk_bf16_f32 v144, v144, v145
    v_pk_mul_f32 v[156:157], v[156:157], v[176:177] op_sel:[0,1] op_sel_hi:[1,1]
    v_pk_mul_f32 v[158:159], v[158:159], v[176:177] op_sel:[0,1] op_sel_hi:[1,1]
    v_cvt_pk_bf16_f32 v152, v152, v153
    v_pk_mul_f32 v[228:229], v[228:229], v[178:179] op_sel_hi:[1,0]
    v_pk_mul_f32 v[230:231], v[230:231], v[178:179] op_sel_hi:[1,0]
    v_cvt_pk_bf16_f32 v224, v224, v225
    v_pk_mul_f32 v[236:237], v[236:237], v[178:179] op_sel:[0,1] op_sel_hi:[1,1]
    v_pk_mul_f32 v[238:239], v[238:239], v[178:179] op_sel:[0,1] op_sel_hi:[1,1]
    v_cvt_pk_bf16_f32 v232, v232, v233
    v_cvt_pk_bf16_f32 v145, v146, v147
    v_cvt_pk_bf16_f32 v153, v154, v155
    v_cvt_pk_bf16_f32 v225, v226, v227
    v_cvt_pk_bf16_f32 v233, v234, v235
    v_cvt_pk_bf16_f32 v146, v148, v149
    v_cvt_pk_bf16_f32 v147, v150, v151
    v_cvt_pk_bf16_f32 v154, v156, v157
    v_cvt_pk_bf16_f32 v155, v158, v159
    v_cvt_pk_bf16_f32 v226, v228, v229
    v_cvt_pk_bf16_f32 v227, v230, v231
    v_cvt_pk_bf16_f32 v234, v236, v237
    v_cvt_pk_bf16_f32 v235, v238, v239
    s_add_u32 s29, s29, 1
    s_cmp_eq_u32 s29, 1
    s_cbranch_scc1 L_q2r
L_q3:
    v_pk_fma_f32 v[112:113], v[112:113], s[76:77], v[188:189] op_sel_hi:[1,0,0]
    v_pk_fma_f32 v[114:115], v[114:115], s[76:77], v[188:189] op_sel_hi:[1,0,0]
    v_pk_fma_f32 v[120:121], v[120:121], s[76:77], v[188:189] op_sel:[0,0,1] op_sel_hi:[1,0,1]
    v_pk_fma_f32 v[122:123], v[122:123], s[76:77], v[188:189] op_sel:[0,0,1] op_sel_hi:[1,0,1]
    v_pk_fma_f32 v[128:129], v[128:129], s[76:77], v[190:191] op_sel_hi:[1,0,0]
    v_pk_fma_f32 v[130:131], v[130:131], s[76:77], v[190:191] op_sel_hi:[1,0,0]
    v_pk_fma_f32 v[136:137], v[136:137], s[76:77], v[190:191] op_sel:[0,0,1] op_sel_hi:[1,0,1]
    v_pk_fma_f32 v[138:139], v[138:139], s[76:77], v[190:191] op_sel:[0,0,1] op_sel_hi:[1,0,1]
    v_pk_fma_f32 v[116:117], v[116:117], s[76:77], v[188:189] op_sel_hi:[1,0,0]
    v_pk_fma_f32 v[124:125], v[124:125], s[76:77], v[188:189] op_sel:[0,0,1] op_sel_hi:[1,0,1]
    v_pk_fma_f32 v[132:133], v[132:133], s[76:77], v[190:191] op_sel_hi:[1,0,0]
    v_pk_fma_f32 v[140:141], v[140:141], s[76:77], v[190:191] op_sel:[0,0,1] op_sel_hi:[1,0,1]
    v_exp_f32 v112, v112
    v_exp_f32 v113, v113
    v_exp_f32 v114, v114
    v_exp_f32 v115, v115
    v_exp_f32 v120, v120
    v_exp_f32 v121, v121
    v_exp_f32 v122, v122
    v_exp_f32 v123, v123
    v_exp_f32 v128, v128
    v_exp_f32 v129, v129
    v_exp_f32 v130, v130
    v_exp_f32 v131, v131
    v_exp_f32 v136, v136
    v_exp_f32 v137, v137
    v_exp_f32 v138, v138
    v_exp_f32 v139, v139
    v_pk_fma_f32 v[118:119], v[118:119], s[76:77], v[188:189] op_sel_hi:[1,0,0]
    v_pk_fma_f32 v[126:127], v[126:127], s[76:77], v[188:189] op_sel:[0,0,1] op_sel_hi:[1,0,1]
    v_pk_fma_f32 v[134:135], v[134:135], s[76:77], v[190:191] op_sel_hi:[1,0,0]
    v_pk_fma_f32 v[142:143], v[142:143], s[76:77], v[190:191] op_sel:[0,0,1] op_sel_hi:[1,0,1]
    v_exp_f32 v116, v116
    v_exp_f32 v117, v117
    v_exp_f32 v124, v124
    v_exp_f32 v125, v125
    v_exp_f32 v132, v132
    v_exp_f32 v133, v133
    v_exp_f32 v140, v140
    v_exp_f32 v141, v141
    v_pk_add_f32 v[248:249], v[112:113], v[114:115]
    v_pk_add_f32 v[250:251], v[120:121], v[122:123]
    v_pk_add_f32 v[252:253], v[128:129], v[130:131]
    v_pk_add_f32 v[254:255], v[136:137], v[138:139]
    v_exp_f32 v118, v118
    v_exp_f32 v119, v119
    v_exp_f32 v126, v126
    v_exp_f32 v127, v127
    v_exp_f32 v134, v134
    v_exp_f32 v135, v135
    v_exp_f32 v142, v142
    v_exp_f32 v143, v143
    v_pk_add_f32 v[248:249], v[248:249], v[116:117]
    v_pk_add_f32 v[250:251], v[250:251], v[124:125]
    v_pk_add_f32 v[252:253], v[252:253], v[132:133]
    v_pk_add_f32 v[254:255], v[254:255], v[140:141]
    v_pk_add_f32 v[248:249], v[248:249], v[118:119]
    v_pk_add_f32 v[250:251], v[250:251], v[126:127]
    v_pk_add_f32 v[252:253], v[252:253], v[134:135]
    v_pk_add_f32 v[254:255], v[254:255], v[142:143]
    v_add_f32 v180, v248, v249
    v_add_f32 v181, v250, v251
    v_add_f32 v182, v252, v253
    v_add_f32 v183, v254, v255
    s_nop 0
    v_permlane32_swap_b32 v180, v182
    v_permlane32_swap_b32 v181, v183
    v_add_f32 v180, v180, v182
    v_add_f32 v181, v181, v183
    s_nop 1
    v_permlane16_swap_b32 v180, v181
    v_add_f32 v180, v180, v181
    v_rcp_f32 v180, v180
    s_nop 0
    v_mov_b32 v181, v180
    s_nop 1
    v_permlane16_swap_b32 v180, v181
    v_mov_b32 v182, v180
    v_mov_b32 v183, v181
    s_nop 0
    v_permlane32_swap_b32 v180, v182
    v_permlane32_swap_b32 v181, v183
    v_pk_mul_f32 v[112:113], v[112:113], v[180:181] op_sel_hi:[1,0]
    v_pk_mul_f32 v[120:121], v[120:121], v[180:181] op_sel:[0,1] op_sel_hi:[1,1]
    v_pk_mul_f32 v[128:129], v[128:129], v[182:183] op_sel_hi:[1,0]
    v_pk_mul_f32 v[136:137], v[136:137], v[182:183] op_sel:[0,1] op_sel_hi:[1,1]
    v_pk_mul_f32 v[114:115], v[114:115], v[180:181] op_sel_hi:[1,0]
    v_pk_mul_f32 v[122:123], v[122:123], v[180:181] op_sel:[0,1] op_sel_hi:[1,1]
    v_pk_mul_f32 v[130:131], v[130:131], v[182:183] op_sel_hi:[1,0]
    v_pk_mul_f32 v[138:139], v[138:139], v[182:183] op_sel:[0,1] op_sel_hi:[1,1]
    v_pk_mul_f32 v[116:117], v[116:117], v[180:181] op_sel_hi:[1,0]
    v_pk_mul_f32 v[118:119], v[118:119], v[180:181] op_sel_hi:[1,0]
    v_cvt_pk_bf16_f32 v112, v112, v113
    v_pk_mul_f32 v[124:125], v[124:125], v[180:181] op_sel:[0,1] op_sel_hi:[1,1]
    v_pk_mul_f32 v[126:127], v[126:127], v[180:181] op_sel:[0,1] op_sel_hi:[1,1]
    v_cvt_pk_bf16_f32 v120, v120, v121
    v_pk_mul_f32 v[132:133], v[132:133], v[182:183] op_sel_hi:[1,0]
    v_pk_mul_f32 v[134:135], v[134:135], v[182:183] op_sel_hi:[1,0]
    v_cvt_pk_bf16_f32 v128, v128, v129
    v_pk_mul_f32 v[140:141], v[140:141], v[182:183] op_sel:[0,1] op_sel_hi:[1,1]
    v_pk_mul_f32 v[142:143], v[142:143], v[182:183] op_sel:[0,1] op_sel_hi:[1,1]
    v_cvt_pk_bf16_f32 v136, v136, v137
    v_cvt_pk_bf16_f32 v113, v114, v115
    v_cvt_pk_bf16_f32 v121, v122, v123
    v_cvt_pk_bf16_f32 v129, v130, v131
    v_cvt_pk_bf16_f32 v137, v138, v139
    v_cvt_pk_bf16_f32 v114, v116, v117
    v_cvt_pk_bf16_f32 v115, v118, v119
    v_cvt_pk_bf16_f32 v122, v124, v125
    v_cvt_pk_bf16_f32 v123, v126, v127
    v_cvt_pk_bf16_f32 v130, v132, v133
    v_cvt_pk_bf16_f32 v131, v134, v135
    v_cvt_pk_bf16_f32 v138, v140, v141
    v_cvt_pk_bf16_f32 v139, v142, v143
L_h231:
    s_waitcnt vmcnt(0)
    v_max3_u32 v88, v60, v61, v62
    v_max3_u32 v89, v64, v65, v66
    v_max3_u32 v90, v68, v69, v70
    v_max3_u32 v91, v72, v73, v74
    v_max3_u32 v92, v80, v81, v82
    v_max3_u32 v93, v84, v85, v86
    v_max_u32 v88, v88, v63
    v_max_u32 v89, v89, v67
    v_max_u32 v90, v90, v71
    v_max_u32 v91, v91, v75
    v_max_u32 v92, v92, v83
    v_max_u32 v93, v93, v87
    v_max3_u32 v94, v88, v89, v90
    v_max3_u32 v95, v91, v92, v93
    v_max_u32 v94, v94, v95
    v_cmp_eq_u32 vcc, -1, v94
    s_cbranch_vccz L_h2k32
    v_cmp_eq_u32 s[68:69], -1, v88
    v_cmp_eq_u32 s[70:71], -1, v89
    v_cmp_eq_u32 s[72:73], -1, v90
    v_cmp_eq_u32 s[74:75], -1, v91
    v_cmp_eq_u32 s[76:77], -1, v92
    v_cmp_eq_u32 s[0:1], -1, v93
    s_mov_b64 exec, s[68:69]
    buffer_load_dwordx4 v[60:63], v3, s[32:35], s59 offen offset:0 sc1
    s_mov_b64 exec, s[70:71]
    buffer_load_dwordx4 v[64:67], v3, s[32:35], s59 offen offset:1024 sc1
    s_mov_b64 exec, s[72:73]
    buffer_load_dwordx4 v[68:71], v3, s[32:35], s59 offen offset:2048 sc1
    s_mov_b64 exec, s[74:75]
    buffer_load_dwordx4 v[72:75], v3, s[32:35], s59 offen offset:3072 sc1
    s_mov_b64 exec, s[76:77]
    buffer_load_dwordx4 v[80:83], v12, s[32:35], s28 offen offset:0 sc1
    s_mov_b64 exec, s[0:1]
    buffer_load_dwordx4 v[84:87], v12, s[32:35], s28 offen offset:64 sc1
    s_mov_b64 exec, -1
    s_add_u32 s79, s79, 1
    s_cmp_lt_u32 s79, 32768
    s_cbranch_scc1 L_h231
    s_waitcnt vmcnt(0)
L_h2k32:
    v_mfma_f32_16x16x32_bf16 v[160:163], v[80:83], v[144:147], 0
    s_mov_b32 s74, 0x358637bd
    v_mov_b32 v19, s78
    v_mfma_f32_16x16x32_bf16 v[164:167], v[80:83], v[152:155], 0
    v_mfma_f32_16x16x32_bf16 v[160:163], v[84:87], v[112:115], v[160:163]
    v_mfma_f32_16x16x32_bf16 v[164:167], v[84:87], v[120:123], v[164:167]
    v_mfma_f32_16x16x32_bf16 v[168:171], v[80:83], v[224:227], 0
    v_mfma_f32_16x16x32_bf16 v[172:175], v[80:83], v[232:235], 0
    s_nop 5
    v_cvt_pk_bf16_f32 v88, v160, v164
    v_mfma_f32_16x16x32_bf16 v[168:171], v[84:87], v[128:131], v[168:171]
    v_and_b32 v89, 0xffff0000, v88
    v_lshlrev_b32 v88, 16, v88
    v_mfma_f32_16x16x32_bf16 v[172:175], v[84:87], v[136:139], v[172:175]
    v_pk_add_f32 v[88:89], v[88:89], s[74:75] op_sel_hi:[1,0]
    v_mfma_f32_16x16x32_bf16 v[192:195], v[60:63], v[144:147], 0
    v_cvt_pk_bf16_f32 v88, v88, v89
    v_mfma_f32_16x16x32_bf16 v[196:199], v[64:67], v[144:147], 0
    s_nop 3
    v_cvt_pk_bf16_f32 v90, v168, v172
    v_and_b32 v89, 0xffff0000, v88
    v_mfma_f32_16x16x32_bf16 v[200:203], v[60:63], v[152:155], 0
    v_and_b32 v91, 0xffff0000, v90
    v_lshlrev_b32 v90, 16, v90
    v_mfma_f32_16x16x32_bf16 v[192:195], v[68:71], v[112:115], v[192:195]
    v_pk_add_f32 v[90:91], v[90:91], s[74:75] op_sel_hi:[1,0]
    v_lshlrev_b32 v88, 16, v88
    v_mfma_f32_16x16x32_bf16 v[204:207], v[64:67], v[152:155], 0
    v_cvt_pk_bf16_f32 v90, v90, v91
    v_rcp_f32 v88, v88
    v_mfma_f32_16x16x32_bf16 v[208:211], v[60:63], v[224:227], 0
    s_nop 1
    v_cvt_pk_bf16_f32 v96, v192, v193
    v_rcp_f32 v89, v89
    v_mfma_f32_16x16x32_bf16 v[196:199], v[72:75], v[112:115], v[196:199]
    v_cvt_pk_bf16_f32 v97, v194, v195
    v_and_b32 v91, 0xffff0000, v90
    v_mfma_f32_16x16x32_bf16 v[200:203], v[68:71], v[120:123], v[200:203]
    v_lshlrev_b32 v192, 16, v96
    v_and_b32 v193, 0xffff0000, v96
    v_mfma_f32_16x16x32_bf16 v[212:215], v[64:67], v[224:227], 0
    s_nop 1
    v_cvt_pk_bf16_f32 v98, v196, v197
    v_cvt_pk_bf16_f32 v99, v198, v199
    v_mfma_f32_16x16x32_bf16 v[216:219], v[60:63], v[232:235], 0
    v_cvt_pk_bf16_f32 v100, v200, v201
    v_lshlrev_b32 v90, 16, v90
    v_mfma_f32_16x16x32_bf16 v[204:207], v[72:75], v[120:123], v[204:207]
    v_lshlrev_b32 v194, 16, v97
    v_and_b32 v195, 0xffff0000, v97
    v_mfma_f32_16x16x32_bf16 v[208:211], v[68:71], v[128:131], v[208:211]
    v_cvt_pk_bf16_f32 v101, v202, v203
    v_lshlrev_b32 v196, 16, v98
    v_mfma_f32_16x16x32_bf16 v[220:223], v[64:67], v[232:235], 0
    v_and_b32 v197, 0xffff0000, v98
    v_lshlrev_b32 v198, 16, v99
    v_mfma_f32_16x16x32_bf16 v[212:215], v[72:75], v[128:131], v[212:215]
    v_and_b32 v199, 0xffff0000, v99
    v_pk_mul_f32 v[192:193], v[192:193], v[88:89] op_sel_hi:[1,0]
    v_mfma_f32_16x16x32_bf16 v[216:219], v[68:71], v[136:139], v[216:219]
    v_cvt_pk_bf16_f32 v102, v204, v205
    v_cvt_pk_bf16_f32 v103, v206, v207
    v_mfma_f32_16x16x32_bf16 v[220:223], v[72:75], v[136:139], v[220:223]
    v_lshlrev_b32 v200, 16, v100
    v_and_b32 v201, 0xffff0000, v100
    v_cvt_pk_bf16_f32 v104, v208, v209
    v_rcp_f32 v90, v90
    v_rcp_f32 v91, v91
    v_pk_mul_f32 v[194:195], v[194:195], v[88:89] op_sel_hi:[1,0]
    v_lshlrev_b32 v202, 16, v101
    v_and_b32 v203, 0xffff0000, v101
    v_cvt_pk_bf16_f32 v105, v210, v211
    v_pk_mul_f32 v[196:197], v[196:197], v[88:89] op_sel_hi:[1,0]
    v_pk_mul_f32 v[198:199], v[198:199], v[88:89] op_sel_hi:[1,0]
    v_cvt_pk_bf16_f32 v192, v192, v193
    v_lshlrev_b32 v204, 16, v102
    v_and_b32 v205, 0xffff0000, v102
    v_lshlrev_b32 v206, 16, v103
    v_and_b32 v207, 0xffff0000, v103
    v_pk_mul_f32 v[200:201], v[200:201], v[88:89] op_sel:[0,1] op_sel_hi:[1,1]
    v_cvt_pk_bf16_f32 v106, v212, v213
    v_cvt_pk_bf16_f32 v107, v214, v215
    v_lshlrev_b32 v208, 16, v104
    v_and_b32 v209, 0xffff0000, v104
    v_cvt_pk_bf16_f32 v108, v216, v217
    v_cvt_pk_bf16_f32 v193, v194, v195
    v_pk_mul_f32 v[202:203], v[202:203], v[88:89] op_sel:[0,1] op_sel_hi:[1,1]
    v_lshlrev_b32 v210, 16, v105
    v_and_b32 v211, 0xffff0000, v105
    v_cvt_pk_bf16_f32 v109, v218, v219
    v_cvt_pk_bf16_f32 v194, v196, v197
    v_cvt_pk_bf16_f32 v195, v198, v199
    v_pk_mul_f32 v[204:205], v[204:205], v[88:89] op_sel:[0,1] op_sel_hi:[1,1]
    v_pk_mul_f32 v[206:207], v[206:207], v[88:89] op_sel:[0,1] op_sel_hi:[1,1]
    v_cvt_pk_bf16_f32 v200, v200, v201
    v_lshlrev_b32 v212, 16, v106
    v_and_b32 v213, 0xffff0000, v106
    v_lshlrev_b32 v214, 16, v107
    v_and_b32 v215, 0xffff0000, v107
    v_pk_mul_f32 v[208:209], v[208:209], v[90:91] op_sel_hi:[1,0]
    v_cvt_pk_bf16_f32 v110, v220, v221
    v_cvt_pk_bf16_f32 v111, v222, v223
    v_lshlrev_b32 v216, 16, v108
    v_and_b32 v217, 0xffff0000, v108
    v_cvt_pk_bf16_f32 v201, v202, v203
    v_pk_mul_f32 v[210:211], v[210:211], v[90:91] op_sel_hi:[1,0]
    v_lshlrev_b32 v218, 16, v109
    v_and_b32 v219, 0xffff0000, v109
    buffer_store_dwordx4 v[192:195], v3, s[32:35], s52 offen sc1
    v_cvt_pk_bf16_f32 v202, v204, v205
    v_cvt_pk_bf16_f32 v203, v206, v207
    v_pk_mul_f32 v[212:213], v[212:213], v[90:91] op_sel_hi:[1,0]
    v_pk_mul_f32 v[214:215], v[214:215], v[90:91] op_sel_hi:[1,0]
    v_cvt_pk_bf16_f32 v208, v208, v209
    v_lshlrev_b32 v220, 16, v110
    v_and_b32 v221, 0xffff0000, v110
    v_lshlrev_b32 v222, 16, v111
    v_and_b32 v223, 0xffff0000, v111
    v_pk_mul_f32 v[216:217], v[216:217], v[90:91] op_sel:[0,1] op_sel_hi:[1,1]
    s_add_u32 s52, s52, 32768
    v_cvt_pk_bf16_f32 v209, v210, v211
    v_pk_mul_f32 v[218:219], v[218:219], v[90:91] op_sel:[0,1] op_sel_hi:[1,1]
    buffer_store_dwordx4 v[200:203], v3, s[32:35], s52 offen sc1
    v_cvt_pk_bf16_f32 v210, v212, v213
    v_cvt_pk_bf16_f32 v211, v214, v215
    v_pk_mul_f32 v[220:221], v[220:221], v[90:91] op_sel:[0,1] op_sel_hi:[1,1]
    v_pk_mul_f32 v[222:223], v[222:223], v[90:91] op_sel:[0,1] op_sel_hi:[1,1]
    v_cvt_pk_bf16_f32 v216, v216, v217
    s_add_u32 s52, s52, 32768
    v_cvt_pk_bf16_f32 v217, v218, v219
    buffer_store_dwordx4 v[208:211], v3, s[32:35], s52 offen sc1
    v_cvt_pk_bf16_f32 v218, v220, v221
    v_cvt_pk_bf16_f32 v219, v222, v223
    s_add_u32 s52, s52, 32768
    buffer_store_dwordx4 v[216:219], v3, s[32:35], s52 offen sc1
L_gc33:
    v_cmp_ne_u32 vcc, s78, v77
    v_cmp_ne_u32 s[84:85], s78, v79
    s_nop 1
    s_or_b64 vcc, vcc, s[84:85]
    s_cbranch_vccz L_gk34
    buffer_load_dwordx2 v[76:77], v27, s[32:35], s57 offen offset:0 sc1
    buffer_load_dwordx2 v[78:79], v27, s[32:35], s57 offen offset:64 sc1
    s_waitcnt vmcnt(0)
    s_add_u32 s79, s79, 1
    s_cmp_lt_u32 s79, 32768
    s_cbranch_scc1 L_gc33
L_gk34:
    v_and_b32 v54, 1, v2
    s_and_b32 s76, s13, 30
    v_lshlrev_b32 v54, 4, v54
    s_and_b32 s3, s13, 1
    v_lshrrev_b32 v80, v54, v76
    v_lshrrev_b32 v81, v54, v78
    v_lshlrev_b32 v82, 16, v80
    v_lshlrev_b32 v83, 16, v81
    v_sub_f32 v84, 1.0, v82
    v_sub_f32 v85, 1.0, v83
    v_cvt_pk_bf16_f32 v86, v13, v84
    v_cvt_pk_bf16_f32 v87, v13, v85
    v_lshrrev_b32 v84, 16, v86
    v_lshrrev_b32 v85, 16, v87
    v_dot2_f32_bf16 v128, v28, v84, 0
    v_dot2_f32_bf16 v129, v28, v86, 0
    v_dot2_f32_bf16 v130, v29, v84, 0
    v_dot2_f32_bf16 v131, v29, v86, 0
    v_dot2_f32_bf16 v132, v30, v84, 0
    v_dot2_f32_bf16 v133, v30, v86, 0
    v_dot2_f32_bf16 v134, v31, v84, 0
    v_dot2_f32_bf16 v135, v31, v86, 0
    v_dot2_f32_bf16 v136, v32, v84, 0
    v_dot2_f32_bf16 v137, v32, v86, 0
    v_dot2_f32_bf16 v138, v33, v84, 0
    v_dot2_f32_bf16 v139, v33, v86, 0
    v_dot2_f32_bf16 v140, v34, v84, 0
    v_dot2_f32_bf16 v141, v34, v86, 0
    v_dot2_f32_bf16 v142, v35, v84, 0
    v_dot2_f32_bf16 v143, v35, v86, 0
    v_dot2_f32_bf16 v144, v36, v85, 0
    v_dot2_f32_bf16 v145, v36, v87, 0
    v_dot2_f32_bf16 v146, v37, v85, 0
    v_dot2_f32_bf16 v147, v37, v87, 0
    v_dot2_f32_bf16 v148, v38, v85, 0
    v_dot2_f32_bf16 v149, v38, v87, 0
    v_dot2_f32_bf16 v150, v39, v85, 0
    v_dot2_f32_bf16 v151, v39, v87, 0
    v_dot2_f32_bf16 v152, v40, v85, 0
    v_dot2_f32_bf16 v153, v40, v87, 0
    v_dot2_f32_bf16 v154, v41, v85, 0
    v_dot2_f32_bf16 v155, v41, v87, 0
    v_dot2_f32_bf16 v156, v42, v85, 0
    v_dot2_f32_bf16 v157, v42, v87, 0
    v_dot2_f32_bf16 v158, v43, v85, 0
    v_dot2_f32_bf16 v159, v43, v87, 0
    s_mul_i32 s3, s3, 16
    v_cvt_pk_bf16_f32 v28, v128, v129
    v_cvt_pk_bf16_f32 v29, v130, v131
    v_cvt_pk_bf16_f32 v30, v132, v133
    v_cvt_pk_bf16_f32 v31, v134, v135
    v_cvt_pk_bf16_f32 v32, v136, v137
    v_cvt_pk_bf16_f32 v33, v138, v139
    v_cvt_pk_bf16_f32 v34, v140, v141
    v_cvt_pk_bf16_f32 v35, v142, v143
    v_cvt_pk_bf16_f32 v36, v144, v145
    v_cvt_pk_bf16_f32 v37, v146, v147
    v_cvt_pk_bf16_f32 v38, v148, v149
    v_cvt_pk_bf16_f32 v39, v150, v151
    v_cvt_pk_bf16_f32 v40, v152, v153
    v_cvt_pk_bf16_f32 v41, v154, v155
    v_cvt_pk_bf16_f32 v42, v156, v157
    v_cvt_pk_bf16_f32 v43, v158, v159
    v_and_b32 v55, 15, v2
    v_lshlrev_b32 v90, 2, v2
    s_add_u32 s76, s76, s3
    s_and_b32 s76, s76, 31
    v_and_b32 v80, 0xffff, v80
    v_and_b32 v81, 0xffff, v81
    v_lshlrev_b32 v128, 16, v28
    v_and_b32 v129, 0xffff0000, v28
    v_lshlrev_b32 v130, 16, v29
    v_and_b32 v131, 0xffff0000, v29
    v_lshlrev_b32 v132, 16, v30
    v_and_b32 v133, 0xffff0000, v30
    v_lshlrev_b32 v134, 16, v31
    v_and_b32 v135, 0xffff0000, v31
    v_lshlrev_b32 v136, 16, v32
    v_and_b32 v137, 0xffff0000, v32
    v_lshlrev_b32 v138, 16, v33
    v_and_b32 v139, 0xffff0000, v33
    v_lshlrev_b32 v140, 16, v34
    v_and_b32 v141, 0xffff0000, v34
    v_lshlrev_b32 v142, 16, v35
    v_and_b32 v143, 0xffff0000, v35
    v_lshlrev_b32 v144, 16, v36
    v_and_b32 v145, 0xffff0000, v36
    v_lshlrev_b32 v146, 16, v37
    v_and_b32 v147, 0xffff0000, v37
    v_lshlrev_b32 v148, 16, v38
    v_and_b32 v149, 0xffff0000, v38
    v_lshlrev_b32 v150, 16, v39
    v_and_b32 v151, 0xffff0000, v39
    v_lshlrev_b32 v152, 16, v40
    v_and_b32 v153, 0xffff0000, v40
    v_lshlrev_b32 v154, 16, v41
    v_and_b32 v155, 0xffff0000, v41
    v_lshlrev_b32 v156, 16, v42
    v_and_b32 v157, 0xffff0000, v42
    v_lshlrev_b32 v158, 16, v43
    v_and_b32 v159, 0xffff0000, v43
    v_mov_b32 v160, 0
    v_mov_b32 v161, 0
    v_mov_b32 v162, 0
    v_mov_b32 v163, 0
    v_mov_b32 v164, 0
    v_mov_b32 v165, 0
    v_mov_b32 v166, 0
    v_mov_b32 v167, 0
    v_mov_b32 v168, 0
    v_mov_b32 v169, 0
    v_mov_b32 v170, 0
    v_mov_b32 v171, 0
    v_mov_b32 v172, 0
    v_mov_b32 v173, 0
    v_mov_b32 v174, 0
    v_mov_b32 v175, 0
    v_mov_b32 v176, 0
    v_mov_b32 v177, 0
    v_mov_b32 v178, 0
    v_mov_b32 v179, 0
    v_mov_b32 v180, 0
    v_mov_b32 v181, 0
    v_mov_b32 v182, 0
    v_mov_b32 v183, 0
    v_mov_b32 v184, 0
    v_mov_b32 v185, 0
    v_mov_b32 v186, 0
    v_mov_b32 v187, 0
    v_mov_b32 v188, 0
    v_mov_b32 v189, 0
    v_mov_b32 v190, 0
    v_mov_b32 v191, 0
    v_lshlrev_b32 v55, 7, v55
    v_and_b32 v90, 12, v90
    v_mov_b32 v91, 1
    s_lshl_b32 s76, s76, 10
    s_waitcnt vmcnt(0)
    s_mov_b64 exec, 1
    ds_add_rtn_u32 v88, v13, v91 offset:64
    s_mov_b64 exec, -1
    s_waitcnt lgkmcnt(0)
    v_readfirstlane_b32 s3, v88
    s_nop 1
    s_cmp_lg_u32 s3, 3
    s_cbranch_scc1 L_ow
    s_mov_b64 exec, 1
    buffer_store_dword v19, v13, s[32:35], s53 offen sc1
    s_mov_b64 exec, -1
L_of35:
    buffer_load_dword v54, v55, s[32:35], s56 offen sc1
    ds_read_b32 v88, v90 offset:208
    s_waitcnt vmcnt(0) lgkmcnt(0)
    v_cmp_ne_u32 vcc, s78, v54
    v_cmp_ne_u32 s[74:75], v88, v18
    s_nop 1
    s_or_b64 vcc, vcc, s[74:75]
    s_cbranch_vccz L_ofk36
    s_add_u32 s79, s79, 1
    s_cmp_lt_u32 s79, 32768
    s_cbranch_scc1 L_of35
L_ofk36:
    ds_write_b32 v13, v18 offset:112
L_ow:
    ds_read_b32 v88, v13 offset:112
    ds_read_b32 v89, v13 offset:16
    s_waitcnt lgkmcnt(0)
    v_cmp_ne_u32 vcc, v88, v18
    s_cbranch_vccz L_owk
    s_add_u32 s79, s79, 1
    s_cmp_lt_u32 s79, 262144
    s_cbranch_scc1 L_ow
L_owk:
    buffer_load_dwordx4 v[192:195], v24, s[60:63], s76 offen
    buffer_load_dwordx4 v[196:199], v25, s[60:63], s76 offen
    s_add_u32 s76, s76, 1024
    s_and_b32 s76, s76, 0x7fff
    buffer_load_dwordx4 v[200:203], v24, s[60:63], s76 offen
    buffer_load_dwordx4 v[204:207], v25, s[60:63], s76 offen
    s_add_u32 s76, s76, 1024
    s_and_b32 s76, s76, 0x7fff
    buffer_load_dwordx4 v[208:211], v24, s[60:63], s76 offen
    buffer_load_dwordx4 v[212:215], v25, s[60:63], s76 offen
    s_add_u32 s76, s76, 1024
    s_and_b32 s76, s76, 0x7fff
    buffer_load_dwordx4 v[216:219], v24, s[60:63], s76 offen
    buffer_load_dwordx4 v[220:223], v25, s[60:63], s76 offen
    s_add_u32 s76, s76, 1024
    s_and_b32 s76, s76, 0x7fff
    buffer_load_dwordx4 v[224:227], v24, s[60:63], s76 offen
    buffer_load_dwordx4 v[228:231], v25, s[60:63], s76 offen
    s_add_u32 s76, s76, 1024
    s_and_b32 s76, s76, 0x7fff
    buffer_load_dwordx4 v[232:235], v24, s[60:63], s76 offen
    buffer_load_dwordx4 v[236:239], v25, s[60:63], s76 offen
    s_add_u32 s76, s76, 1024
    s_and_b32 s76, s76, 0x7fff
    buffer_load_dwordx4 v[240:243], v24, s[60:63], s76 offen
    buffer_load_dwordx4 v[244:247], v25, s[60:63], s76 offen
    s_add_u32 s76, s76, 1024
    s_and_b32 s76, s76, 0x7fff
    buffer_load_dwordx4 v[248:251], v24, s[60:63], s76 offen
    buffer_load_dwordx4 v[252:255], v25, s[60:63], s76 offen
    s_add_u32 s76, s76, 1024
    s_and_b32 s76, s76, 0x7fff
    ds_read_b64_tr_b16 v[96:97], v20 offset:0
    ds_read_b64_tr_b16 v[98:99], v20 offset:2048
    ds_read_b64_tr_b16 v[100:101], v21 offset:0
    ds_read_b64_tr_b16 v[102:103], v21 offset:2048
    ds_read_b64_tr_b16 v[104:105], v22 offset:0
    ds_read_b64_tr_b16 v[106:107], v22 offset:2048
    ds_read_b64_tr_b16 v[108:109], v23 offset:0
    ds_read_b64_tr_b16 v[110:111], v23 offset:2048
    v_readfirstlane_b32 s77, v89
    s_mov_b32 s66, 0
    s_mov_b32 s3, 32768
.p2align 6
L_p5:
    s_cmp_eq_u32 s66, 3
    s_cselect_b32 s62, 0, s62
    s_cselect_b32 s3, 0, s3
    s_waitcnt vmcnt(14) lgkmcnt(6)
    v_mfma_f32_16x16x32_bf16 v[160:163], v[96:99], v[192:195], v[160:163]
    ds_read_b64_tr_b16 v[112:113], v20 offset:4096
    v_mfma_f32_16x16x32_bf16 v[176:179], v[96:99], v[196:199], v[176:179]
    ds_read_b64_tr_b16 v[114:115], v20 offset:6144
    s_waitcnt lgkmcnt(6)
    v_mfma_f32_16x16x32_bf16 v[164:167], v[100:103], v[192:195], v[164:167]
    ds_read_b64_tr_b16 v[116:117], v21 offset:4096
    v_mfma_f32_16x16x32_bf16 v[180:183], v[100:103], v[196:199], v[180:183]
    ds_read_b64_tr_b16 v[118:119], v21 offset:6144
    s_waitcnt lgkmcnt(6)
    v_mfma_f32_16x16x32_bf16 v[168:171], v[104:107], v[192:195], v[168:171]
    ds_read_b64_tr_b16 v[120:121], v22 offset:4096
    v_mfma_f32_16x16x32_bf16 v[184:187], v[104:107], v[196:199], v[184:187]
    ds_read_b64_tr_b16 v[122:123], v22 offset:6144
    s_waitcnt lgkmcnt(6)
    v_mfma_f32_16x16x32_bf16 v[172:175], v[108:111], v[192:195], v[172:175]
    ds_read_b64_tr_b16 v[124:125], v23 offset:4096
    v_mfma_f32_16x16x32_bf16 v[188:191], v[108:111], v[196:199], v[188:191]
    ds_read_b64_tr_b16 v[126:127], v23 offset:6144
    buffer_load_dwordx4 v[192:195], v24, s[60:63], s76 offen
    buffer_load_dwordx4 v[196:199], v25, s[60:63], s76 offen
    s_add_u32 s76, s76, 1024
    s_and_b32 s76, s76, 0x7fff
    s_waitcnt vmcnt(14) lgkmcnt(6)
    v_mfma_f32_16x16x32_bf16 v[160:163], v[112:115], v[200:203], v[160:163]
    ds_read_b64_tr_b16 v[96:97], v20 offset:8192
    v_mfma_f32_16x16x32_bf16 v[176:179], v[112:115], v[204:207], v[176:179]
    ds_read_b64_tr_b16 v[98:99], v20 offset:10240
    s_waitcnt lgkmcnt(6)
    v_mfma_f32_16x16x32_bf16 v[164:167], v[116:119], v[200:203], v[164:167]
    ds_read_b64_tr_b16 v[100:101], v21 offset:8192
    v_mfma_f32_16x16x32_bf16 v[180:183], v[116:119], v[204:207], v[180:183]
    ds_read_b64_tr_b16 v[102:103], v21 offset:10240
    s_waitcnt lgkmcnt(6)
    v_mfma_f32_16x16x32_bf16 v[168:171], v[120:123], v[200:203], v[168:171]
    ds_read_b64_tr_b16 v[104:105], v22 offset:8192
    v_mfma_f32_16x16x32_bf16 v[184:187], v[120:123], v[204:207], v[184:187]
    ds_read_b64_tr_b16 v[106:107], v22 offset:10240
    s_waitcnt lgkmcnt(6)
    v_mfma_f32_16x16x32_bf16 v[172:175], v[124:127], v[200:203], v[172:175]
    ds_read_b64_tr_b16 v[108:109], v23 offset:8192
    v_mfma_f32_16x16x32_bf16 v[188:191], v[124:127], v[204:207], v[188:191]
    ds_read_b64_tr_b16 v[110:111], v23 offset:10240
    buffer_load_dwordx4 v[200:203], v24, s[60:63], s76 offen
    buffer_load_dwordx4 v[204:207], v25, s[60:63], s76 offen
    s_add_u32 s76, s76, 1024
    s_and_b32 s76, s76, 0x7fff
    s_waitcnt vmcnt(14) lgkmcnt(6)
    v_mfma_f32_16x16x32_bf16 v[160:163], v[96:99], v[208:211], v[160:163]
    ds_read_b64_tr_b16 v[112:113], v20 offset:12288
    v_mfma_f32_16x16x32_bf16 v[176:179], v[96:99], v[212:215], v[176:179]
    ds_read_b64_tr_b16 v[114:115], v20 offset:14336
    s_waitcnt lgkmcnt(6)
    v_mfma_f32_16x16x32_bf16 v[164:167], v[100:103], v[208:211], v[164:167]
    ds_read_b64_tr_b16 v[116:117], v21 offset:12288
    v_mfma_f32_16x16x32_bf16 v[180:183], v[100:103], v[212:215], v[180:183]
    ds_read_b64_tr_b16 v[118:119], v21 offset:14336
    s_waitcnt lgkmcnt(6)
    v_mfma_f32_16x16x32_bf16 v[168:171], v[104:107], v[208:211], v[168:171]
    ds_read_b64_tr_b16 v[120:121], v22 offset:12288
    v_mfma_f32_16x16x32_bf16 v[184:187], v[104:107], v[212:215], v[184:187]
    ds_read_b64_tr_b16 v[122:123], v22 offset:14336
    s_waitcnt lgkmcnt(6)
    v_mfma_f32_16x16x32_bf16 v[172:175], v[108:111], v[208:211], v[172:175]
    ds_read_b64_tr_b16 v[124:125], v23 offset:12288
    v_mfma_f32_16x16x32_bf16 v[188:191], v[108:111], v[212:215], v[188:191]
    ds_read_b64_tr_b16 v[126:127], v23 offset:14336
    buffer_load_dwordx4 v[208:211], v24, s[60:63], s76 offen
    buffer_load_dwordx4 v[212:215], v25, s[60:63], s76 offen
    s_add_u32 s76, s76, 1024
    s_and_b32 s76, s76, 0x7fff
    s_waitcnt vmcnt(14) lgkmcnt(6)
    v_mfma_f32_16x16x32_bf16 v[160:163], v[112:115], v[216:219], v[160:163]
    ds_read_b64_tr_b16 v[96:97], v20 offset:16384
    v_mfma_f32_16x16x32_bf16 v[176:179], v[112:115], v[220:223], v[176:179]
    ds_read_b64_tr_b16 v[98:99], v20 offset:18432
    s_waitcnt lgkmcnt(6)
    v_mfma_f32_16x16x32_bf16 v[164:167], v[116:119], v[216:219], v[164:167]
    ds_read_b64_tr_b16 v[100:101], v21 offset:16384
    v_mfma_f32_16x16x32_bf16 v[180:183], v[116:119], v[220:223], v[180:183]
    ds_read_b64_tr_b16 v[102:103], v21 offset:18432
    s_waitcnt lgkmcnt(6)
    v_mfma_f32_16x16x32_bf16 v[168:171], v[120:123], v[216:219], v[168:171]
    ds_read_b64_tr_b16 v[104:105], v22 offset:16384
    v_mfma_f32_16x16x32_bf16 v[184:187], v[120:123], v[220:223], v[184:187]
    ds_read_b64_tr_b16 v[106:107], v22 offset:18432
    s_waitcnt lgkmcnt(6)
    v_mfma_f32_16x16x32_bf16 v[172:175], v[124:127], v[216:219], v[172:175]
    ds_read_b64_tr_b16 v[108:109], v23 offset:16384
    v_mfma_f32_16x16x32_bf16 v[188:191], v[124:127], v[220:223], v[188:191]
    ds_read_b64_tr_b16 v[110:111], v23 offset:18432
    buffer_load_dwordx4 v[216:219], v24, s[60:63], s76 offen
    buffer_load_dwordx4 v[220:223], v25, s[60:63], s76 offen
    s_add_u32 s76, s76, 1024
    s_and_b32 s76, s76, 0x7fff
    s_waitcnt vmcnt(14) lgkmcnt(6)
    v_mfma_f32_16x16x32_bf16 v[160:163], v[96:99], v[224:227], v[160:163]
    ds_read_b64_tr_b16 v[112:113], v20 offset:20480
    v_mfma_f32_16x16x32_bf16 v[176:179], v[96:99], v[228:231], v[176:179]
    ds_read_b64_tr_b16 v[114:115], v20 offset:22528
    s_waitcnt lgkmcnt(6)
    v_mfma_f32_16x16x32_bf16 v[164:167], v[100:103], v[224:227], v[164:167]
    ds_read_b64_tr_b16 v[116:117], v21 offset:20480
    v_mfma_f32_16x16x32_bf16 v[180:183], v[100:103], v[228:231], v[180:183]
    ds_read_b64_tr_b16 v[118:119], v21 offset:22528
    s_waitcnt lgkmcnt(6)
    v_mfma_f32_16x16x32_bf16 v[168:171], v[104:107], v[224:227], v[168:171]
    ds_read_b64_tr_b16 v[120:121], v22 offset:20480
    v_mfma_f32_16x16x32_bf16 v[184:187], v[104:107], v[228:231], v[184:187]
    ds_read_b64_tr_b16 v[122:123], v22 offset:22528
    s_waitcnt lgkmcnt(6)
    v_mfma_f32_16x16x32_bf16 v[172:175], v[108:111], v[224:227], v[172:175]
    ds_read_b64_tr_b16 v[124:125], v23 offset:20480
    v_mfma_f32_16x16x32_bf16 v[188:191], v[108:111], v[228:231], v[188:191]
    ds_read_b64_tr_b16 v[126:127], v23 offset:22528
    buffer_load_dwordx4 v[224:227], v24, s[60:63], s76 offen
    buffer_load_dwordx4 v[228:231], v25, s[60:63], s76 offen
    s_add_u32 s76, s76, 1024
    s_and_b32 s76, s76, 0x7fff
    s_waitcnt vmcnt(14) lgkmcnt(6)
    v_mfma_f32_16x16x32_bf16 v[160:163], v[112:115], v[232:235], v[160:163]
    ds_read_b64_tr_b16 v[96:97], v20 offset:24576
    v_mfma_f32_16x16x32_bf16 v[176:179], v[112:115], v[236:239], v[176:179]
    ds_read_b64_tr_b16 v[98:99], v20 offset:26624
    s_waitcnt lgkmcnt(6)
    v_mfma_f32_16x16x32_bf16 v[164:167], v[116:119], v[232:235], v[164:167]
    ds_read_b64_tr_b16 v[100:101], v21 offset:24576
    v_mfma_f32_16x16x32_bf16 v[180:183], v[116:119], v[236:239], v[180:183]
    ds_read_b64_tr_b16 v[102:103], v21 offset:26624
    s_waitcnt lgkmcnt(6)
    v_mfma_f32_16x16x32_bf16 v[168:171], v[120:123], v[232:235], v[168:171]
    ds_read_b64_tr_b16 v[104:105], v22 offset:24576
    v_mfma_f32_16x16x32_bf16 v[184:187], v[120:123], v[236:239], v[184:187]
    ds_read_b64_tr_b16 v[106:107], v22 offset:26624
    s_waitcnt lgkmcnt(6)
    v_mfma_f32_16x16x32_bf16 v[172:175], v[124:127], v[232:235], v[172:175]
    ds_read_b64_tr_b16 v[108:109], v23 offset:24576
    v_mfma_f32_16x16x32_bf16 v[188:191], v[124:127], v[236:239], v[188:191]
    ds_read_b64_tr_b16 v[110:111], v23 offset:26624
    buffer_load_dwordx4 v[232:235], v24, s[60:63], s76 offen
    buffer_load_dwordx4 v[236:239], v25, s[60:63], s76 offen
    s_add_u32 s76, s76, 1024
    s_and_b32 s76, s76, 0x7fff
    s_waitcnt vmcnt(14) lgkmcnt(6)
    v_mfma_f32_16x16x32_bf16 v[160:163], v[96:99], v[240:243], v[160:163]
    ds_read_b64_tr_b16 v[112:113], v20 offset:28672
    v_mfma_f32_16x16x32_bf16 v[176:179], v[96:99], v[244:247], v[176:179]
    ds_read_b64_tr_b16 v[114:115], v20 offset:30720
    s_waitcnt lgkmcnt(6)
    v_mfma_f32_16x16x32_bf16 v[164:167], v[100:103], v[240:243], v[164:167]
    ds_read_b64_tr_b16 v[116:117], v21 offset:28672
    v_mfma_f32_16x16x32_bf16 v[180:183], v[100:103], v[244:247], v[180:183]
    ds_read_b64_tr_b16 v[118:119], v21 offset:30720
    s_waitcnt lgkmcnt(6)
    v_mfma_f32_16x16x32_bf16 v[168:171], v[104:107], v[240:243], v[168:171]
    ds_read_b64_tr_b16 v[120:121], v22 offset:28672
    v_mfma_f32_16x16x32_bf16 v[184:187], v[104:107], v[244:247], v[184:187]
    ds_read_b64_tr_b16 v[122:123], v22 offset:30720
    s_waitcnt lgkmcnt(6)
    v_mfma_f32_16x16x32_bf16 v[172:175], v[108:111], v[240:243], v[172:175]
    ds_read_b64_tr_b16 v[124:125], v23 offset:28672
    v_mfma_f32_16x16x32_bf16 v[188:191], v[108:111], v[244:247], v[188:191]
    ds_read_b64_tr_b16 v[126:127], v23 offset:30720
    buffer_load_dwordx4 v[240:243], v24, s[60:63], s76 offen
    buffer_load_dwordx4 v[244:247], v25, s[60:63], s76 offen
    s_add_u32 s76, s76, 1024
    s_and_b32 s76, s76, 0x7fff
    v_add_u32 v20, s3, v20
    v_add_u32 v21, s3, v21
    v_add_u32 v22, s3, v22
    v_add_u32 v23, s3, v23
    s_waitcnt vmcnt(14) lgkmcnt(6)
    v_mfma_f32_16x16x32_bf16 v[160:163], v[112:115], v[248:251], v[160:163]
    ds_read_b64_tr_b16 v[96:97], v20 offset:0
    v_mfma_f32_16x16x32_bf16 v[176:179], v[112:115], v[252:255], v[176:179]
    ds_read_b64_tr_b16 v[98:99], v20 offset:2048
    s_waitcnt lgkmcnt(6)
    v_mfma_f32_16x16x32_bf16 v[164:167], v[116:119], v[248:251], v[164:167]
    ds_read_b64_tr_b16 v[100:101], v21 offset:0
    v_mfma_f32_16x16x32_bf16 v[180:183], v[116:119], v[252:255], v[180:183]
    ds_read_b64_tr_b16 v[102:103], v21 offset:2048
    s_waitcnt lgkmcnt(6)
    v_mfma_f32_16x16x32_bf16 v[168:171], v[120:123], v[248:251], v[168:171]
    ds_read_b64_tr_b16 v[104:105], v22 offset:0
    v_mfma_f32_16x16x32_bf16 v[184:187], v[120:123], v[252:255], v[184:187]
    ds_read_b64_tr_b16 v[106:107], v22 offset:2048
    s_waitcnt lgkmcnt(6)
    v_mfma_f32_16x16x32_bf16 v[172:175], v[124:127], v[248:251], v[172:175]
    ds_read_b64_tr_b16 v[108:109], v23 offset:0
    v_mfma_f32_16x16x32_bf16 v[188:191], v[124:127], v[252:255], v[188:191]
    ds_read_b64_tr_b16 v[110:111], v23 offset:2048
    buffer_load_dwordx4 v[248:251], v24, s[60:63], s76 offen
    buffer_load_dwordx4 v[252:255], v25, s[60:63], s76 offen
    s_add_u32 s76, s76, 1024
    s_and_b32 s76, s76, 0x7fff
    s_add_u32 s66, s66, 1
    s_cmp_lt_u32 s66, 4
    s_cbranch_scc1 L_p5
    s_waitcnt lgkmcnt(0)
    s_lshr_b32 s77, s77, 4
    s_and_b32 s77, s77, 2047
    s_sub_u32 s77, 2047, s77
    s_lshr_b32 s19, s77, 5
    s_cmp_eq_u32 s19, s58
    s_cbranch_scc1 L_own
L_ownret:
    v_cvt_pk_bf16_f32 v160, v160, v161
    v_cvt_pk_bf16_f32 v161, v162, v163
    v_cvt_pk_bf16_f32 v168, v168, v169
    v_cvt_pk_bf16_f32 v162, v164, v165
    v_cvt_pk_bf16_f32 v163, v166, v167
    v_cvt_pk_bf16_f32 v169, v170, v171
    v_cvt_pk_bf16_f32 v176, v176, v177
    v_cvt_pk_bf16_f32 v170, v172, v173
    v_cvt_pk_bf16_f32 v171, v174, v175
    v_cvt_pk_bf16_f32 v177, v178, v179
    v_cvt_pk_bf16_f32 v184, v184, v185
    v_cvt_pk_bf16_f32 v178, v180, v181
    v_cvt_pk_bf16_f32 v179, v182, v183
    v_cvt_pk_bf16_f32 v185, v186, v187
    v_permlane16_swap_b32 v160, v162
    v_permlane16_swap_b32 v161, v163
    v_cvt_pk_bf16_f32 v186, v188, v189
    v_cvt_pk_bf16_f32 v187, v190, v191
    v_permlane16_swap_b32 v168, v170
    v_permlane16_swap_b32 v169, v171
    v_dot2_f32_bf16 v96, v160, v80, 0
    v_dot2_f32_bf16 v97, v160, v82, 0
    v_dot2_f32_bf16 v98, v161, v80, 0
    v_dot2_f32_bf16 v99, v161, v82, 0
    v_dot2_f32_bf16 v100, v162, v80, 0
    v_dot2_f32_bf16 v101, v162, v82, 0
    v_dot2_f32_bf16 v102, v163, v80, 0
    v_dot2_f32_bf16 v103, v163, v82, 0
    v_permlane16_swap_b32 v176, v178
    v_permlane16_swap_b32 v177, v179
    v_dot2_f32_bf16 v104, v168, v80, 0
    v_dot2_f32_bf16 v105, v168, v82, 0
    v_dot2_f32_bf16 v106, v169, v80, 0
    v_dot2_f32_bf16 v107, v169, v82, 0
    v_dot2_f32_bf16 v108, v170, v80, 0
    v_dot2_f32_bf16 v109, v170, v82, 0
    v_dot2_f32_bf16 v110, v171, v80, 0
    v_dot2_f32_bf16 v111, v171, v82, 0
    v_permlane16_swap_b32 v184, v186
    v_permlane16_swap_b32 v185, v187
    v_dot2_f32_bf16 v112, v176, v81, 0
    v_dot2_f32_bf16 v113, v176, v83, 0
    v_dot2_f32_bf16 v114, v177, v81, 0
    v_dot2_f32_bf16 v115, v177, v83, 0
    v_dot2_f32_bf16 v116, v178, v81, 0
    v_dot2_f32_bf16 v117, v178, v83, 0
    v_dot2_f32_bf16 v118, v179, v81, 0
    v_dot2_f32_bf16 v119, v179, v83, 0
    v_dot2_f32_bf16 v120, v184, v81, 0
    v_dot2_f32_bf16 v121, v184, v83, 0
    v_dot2_f32_bf16 v122, v185, v81, 0
    v_dot2_f32_bf16 v123, v185, v83, 0
    v_dot2_f32_bf16 v124, v186, v81, 0
    v_dot2_f32_bf16 v125, v186, v83, 0
    v_dot2_f32_bf16 v126, v187, v81, 0
    v_dot2_f32_bf16 v127, v187, v83, 0
    v_cvt_pk_bf16_f32 v160, v96, v97
    v_cvt_pk_bf16_f32 v161, v98, v99
    v_cvt_pk_bf16_f32 v162, v100, v101
    v_cvt_pk_bf16_f32 v163, v102, v103
    s_mov_b32 s74, 0x3f80
    s_mov_b32 s75, 0x3f800000
    v_cvt_pk_bf16_f32 v168, v104, v105
    v_cvt_pk_bf16_f32 v169, v106, v107
    v_cvt_pk_bf16_f32 v170, v108, v109
    v_cvt_pk_bf16_f32 v171, v110, v111
    v_dot2_f32_bf16 v96, v160, s74, v128
    v_dot2_f32_bf16 v97, v160, s75, v129
    v_dot2_f32_bf16 v98, v161, s74, v130
    v_dot2_f32_bf16 v99, v161, s75, v131
    v_dot2_f32_bf16 v100, v162, s74, v132
    v_dot2_f32_bf16 v101, v162, s75, v133
    v_dot2_f32_bf16 v102, v163, s74, v134
    v_dot2_f32_bf16 v103, v163, s75, v135
    v_cvt_pk_bf16_f32 v176, v112, v113
    v_cvt_pk_bf16_f32 v177, v114, v115
    v_cvt_pk_bf16_f32 v178, v116, v117
    v_cvt_pk_bf16_f32 v179, v118, v119
    v_dot2_f32_bf16 v104, v168, s74, v136
    v_dot2_f32_bf16 v105, v168, s75, v137
    v_dot2_f32_bf16 v106, v169, s74, v138
    v_dot2_f32_bf16 v107, v169, s75, v139
    v_dot2_f32_bf16 v108, v170, s74, v140
    v_dot2_f32_bf16 v109, v170, s75, v141
    v_dot2_f32_bf16 v110, v171, s74, v142
    v_dot2_f32_bf16 v111, v171, s75, v143
    v_cvt_pk_bf16_f32 v184, v120, v121
    v_cvt_pk_bf16_f32 v185, v122, v123
    v_cvt_pk_bf16_f32 v186, v124, v125
    v_cvt_pk_bf16_f32 v187, v126, v127
    v_dot2_f32_bf16 v112, v176, s74, v144
    v_dot2_f32_bf16 v113, v176, s75, v145
    v_dot2_f32_bf16 v114, v177, s74, v146
    v_dot2_f32_bf16 v115, v177, s75, v147
    v_dot2_f32_bf16 v116, v178, s74, v148
    v_dot2_f32_bf16 v117, v178, s75, v149
    v_dot2_f32_bf16 v118, v179, s74, v150
    v_dot2_f32_bf16 v119, v179, s75, v151
    v_dot2_f32_bf16 v120, v184, s74, v152
    v_dot2_f32_bf16 v121, v184, s75, v153
    v_dot2_f32_bf16 v122, v185, s74, v154
    v_dot2_f32_bf16 v123, v185, s75, v155
    v_dot2_f32_bf16 v124, v186, s74, v156
    v_dot2_f32_bf16 v125, v186, s75, v157
    v_dot2_f32_bf16 v126, v187, s74, v158
    v_dot2_f32_bf16 v127, v187, s75, v159
    v_cvt_pk_bf16_f32 v160, v96, v97
    v_cvt_pk_bf16_f32 v161, v98, v99
    v_cvt_pk_bf16_f32 v162, v100, v101
    v_cvt_pk_bf16_f32 v163, v102, v103
    v_cvt_pk_bf16_f32 v168, v104, v105
    v_cvt_pk_bf16_f32 v169, v106, v107
    v_cvt_pk_bf16_f32 v170, v108, v109
    v_cvt_pk_bf16_f32 v171, v110, v111
    buffer_store_dwordx4 v[160:163], v26, s[44:47], s54 offen offset:0 nt
    v_cvt_pk_bf16_f32 v176, v112, v113
    v_cvt_pk_bf16_f32 v177, v114, v115
    v_cvt_pk_bf16_f32 v178, v116, v117
    v_cvt_pk_bf16_f32 v179, v118, v119
    buffer_store_dwordx4 v[168:171], v26, s[44:47], s54 offen offset:64 nt
    v_cvt_pk_bf16_f32 v184, v120, v121
    v_cvt_pk_bf16_f32 v185, v122, v123
    v_cvt_pk_bf16_f32 v186, v124, v125
    v_cvt_pk_bf16_f32 v187, v126, v127
    buffer_store_dwordx4 v[176:179], v26, s[44:47], s55 offen offset:0 nt
    buffer_store_dwordx4 v[184:187], v26, s[44:47], s55 offen offset:64 nt
    s_endpgm
L_own:
    v_and_b32 v54, 16, v2
    v_lshlrev_b32 v54, 2, v54
    v_and_b32 v55, 32, v2
    v_add_u32 v54, v54, v55
L_xo37:
    ds_read_b32 v88, v13 offset:224
    ds_read_b128 v[96:99], v54 offset:512
    ds_read_b128 v[100:103], v54 offset:528
    ds_read_b128 v[104:107], v54 offset:640
    ds_read_b128 v[108:111], v54 offset:656
    s_waitcnt lgkmcnt(0)
    v_cmp_ne_u32 vcc, v88, v18
    s_cbranch_vccz L_xk38
    s_add_u32 s79, s79, 1
    s_cmp_lt_u32 s79, 32768
    s_cbranch_scc1 L_xo37
L_xk38:
    s_and_b32 s77, s77, 31
    v_and_b32 v54, 15, v2
    v_cmp_eq_u32 vcc, s77, v54
    s_nop 1
    v_cndmask_b32 v128, v128, v96, vcc
    v_cndmask_b32 v129, v129, v97, vcc
    v_cndmask_b32 v130, v130, v98, vcc
    v_cndmask_b32 v131, v131, v99, vcc
    v_cndmask_b32 v132, v132, v100, vcc
    v_cndmask_b32 v133, v133, v101, vcc
    v_cndmask_b32 v134, v134, v102, vcc
    v_cndmask_b32 v135, v135, v103, vcc
    v_cndmask_b32 v136, v136, v104, vcc
    v_cndmask_b32 v137, v137, v105, vcc
    v_cndmask_b32 v138, v138, v106, vcc
    v_cndmask_b32 v139, v139, v107, vcc
    v_cndmask_b32 v140, v140, v108, vcc
    v_cndmask_b32 v141, v141, v109, vcc
    v_cndmask_b32 v142, v142, v110, vcc
    v_cndmask_b32 v143, v143, v111, vcc
    v_add_u32 v54, 16, v54
    v_cmp_eq_u32 vcc, s77, v54
    s_nop 1
    v_cndmask_b32 v144, v144, v96, vcc
    v_cndmask_b32 v145, v145, v97, vcc
    v_cndmask_b32 v146, v146, v98, vcc
    v_cndmask_b32 v147, v147, v99, vcc
    v_cndmask_b32 v148, v148, v100, vcc
    v_cndmask_b32 v149, v149, v101, vcc
    v_cndmask_b32 v150, v150, v102, vcc
    v_cndmask_b32 v151, v151, v103, vcc
    v_cndmask_b32 v152, v152, v104, vcc
    v_cndmask_b32 v153, v153, v105, vcc
    v_cndmask_b32 v154, v154, v106, vcc
    v_cndmask_b32 v155, v155, v107, vcc
    v_cndmask_b32 v156, v156, v108, vcc
    v_cndmask_b32 v157, v157, v109, vcc
    v_cndmask_b32 v158, v158, v110, vcc
    v_cndmask_b32 v159, v159, v111, vcc
    s_branch L_ownret
L_k2s:
    v_pk_add_f32 v[192:193], v[192:193], v[120:121]
    v_pk_add_f32 v[194:195], v[194:195], v[122:123]
    v_bfi_b32 v192, v15, s80, v192
    v_bfi_b32 v193, v15, s81, v193
    v_bfi_b32 v194, v15, s82, v194
    v_bfi_b32 v195, v15, s83, v195
    v_pk_add_f32 v[196:197], v[196:197], v[124:125]
    v_pk_add_f32 v[198:199], v[198:199], v[126:127]
    v_bfi_b32 v196, v15, s80, v196
    v_bfi_b32 v197, v15, s81, v197
    v_bfi_b32 v198, v15, s82, v198
    v_bfi_b32 v199, v15, s83, v199
    v_pk_add_f32 v[200:201], v[200:201], v[128:129]
    v_pk_add_f32 v[202:203], v[202:203], v[130:131]
    buffer_store_dwordx4 v[192:195], v3, s[32:35], s48 offen sc1
    s_add_u32 s48, s48, 16384
    v_bfi_b32 v200, v15, s80, v200
    v_bfi_b32 v201, v15, s81, v201
    v_bfi_b32 v202, v15, s82, v202
    v_bfi_b32 v203, v15, s83, v203
    v_pk_add_f32 v[204:205], v[204:205], v[132:133]
    v_pk_add_f32 v[206:207], v[206:207], v[134:135]
    buffer_store_dwordx4 v[196:199], v3, s[32:35], s48 offen sc1
    s_add_u32 s48, s48, 16384
    v_bfi_b32 v204, v15, s80, v204
    v_bfi_b32 v205, v15, s81, v205
    v_bfi_b32 v206, v15, s82, v206
    v_bfi_b32 v207, v15, s83, v207
    v_pk_add_f32 v[208:209], v[208:209], v[112:113]
    v_pk_add_f32 v[210:211], v[210:211], v[114:115]
    v_pk_add_f32 v[212:213], v[212:213], v[116:117]
    v_pk_add_f32 v[214:215], v[214:215], v[118:119]
    buffer_store_dwordx4 v[200:203], v3, s[32:35], s48 offen sc1
    s_add_u32 s48, s48, 16384
    v_bfi_b32 v208, v15, s80, v208
    v_bfi_b32 v209, v15, s81, v209
    v_bfi_b32 v210, v15, s82, v210
    v_bfi_b32 v211, v15, s83, v211
    v_bfi_b32 v212, v15, s80, v212
    v_bfi_b32 v213, v15, s81, v213
    v_bfi_b32 v214, v15, s82, v214
    v_bfi_b32 v215, v15, s83, v215
    buffer_store_dwordx4 v[204:207], v3, s[32:35], s48 offen sc1
    s_mov_b32 exec_lo, 0x10001
    s_mov_b32 exec_hi, 0x10001
    buffer_store_dwordx4 v[208:211], v8, s[32:35], s49 offen offset:0 sc1
    buffer_store_dwordx4 v[212:215], v8, s[32:35], s49 offen offset:1024 sc1
    s_mov_b64 exec, -1
    s_branch L_k2r
L_h1s:
    s_mov_b32 exec_lo, 0xffff
    s_mov_b32 exec_hi, 0xffff
    buffer_store_dword v96, v11, s[32:35], s64 offen sc1
    s_lshl_b64 exec, 1, s16
    buffer_store_dword v92, v13, s[32:35], s65 offen sc1
    s_mov_b64 exec, -1
    s_branch L_h1r
L_end:
    s_endpgm
.section .rodata,"a"
.p2align 6
.amdhsa_kernel fk_kernel
  .amdhsa_next_free_vgpr 256
  .amdhsa_next_free_sgpr 102
  .amdhsa_accum_offset 256
  .amdhsa_group_segment_fixed_size 0
  .amdhsa_kernarg_size 104
  .amdhsa_user_sgpr_count 2
  .amdhsa_user_sgpr_kernarg_segment_ptr 1
  .amdhsa_system_sgpr_workgroup_id_x 1
.end_amdhsa_kernel
```
